```python
import torch

def _softmax(x, axis=-1):
    return torch.softmax(x, dim=axis)

def _gelu(x):
    return torch.nn.functional.gelu(x, approximate='tanh')

def _silu(x):
    return torch.nn.functional.silu(x)

def _sigmoid(x):
    return torch.sigmoid(x)

def _layernorm(x, axis=-1, eps=1e-05):
    m = x.mean(dim=axis, keepdim=True)
    v = x.var(dim=axis, keepdim=True, unbiased=False)
    return (x - m) / torch.sqrt(v + eps)

def _scatter_add(tgt, idx, src, axis=0):
    return tgt.clone().index_add_(axis, idx, src)

def _segment_sum(src, seg, n):
    out = torch.zeros((n,) + src.shape[1:], dtype=src.dtype)
    return out.index_add_(0, seg, src)

def _pad(x, pw):
    flat = tuple((v for pair in reversed(pw) for v in pair))
    return torch.nn.functional.pad(x, flat)
kernel_name = 'adaLN_cond__compressed_kv_cla__dense_activation_silu__prompt'

def setup_inputs():

    _w = lambda a: (lambda t: t.to(torch.bfloat16) if t.is_floating_point() else t)(torch.as_tensor(a))

    def _A_setup():
        B, H, Sq, Sk, D, M = (1, 16, 2048, 2048, 256, 448)
        Dc = 4 * D
        return {'x': _w((lambda *s: torch.randn(*s, dtype=torch.bfloat16) * 0.05)(B, Sq, M)), 'c_kv': _w((lambda *s: torch.randn(*s, dtype=torch.bfloat16) * 0.8)(B, Sk, Dc)), 'w_q': _w((lambda *s: torch.randn(*s, dtype=torch.bfloat16) * 1.6)(M, H, D) * M ** (-0.5)), 'w_uk': _w((lambda *s: torch.randn(*s, dtype=torch.bfloat16) * 1.6)(Dc, H, D) * Dc ** (-0.5)), 'w_uv': _w((lambda *s: torch.randn(*s, dtype=torch.bfloat16) * 0.8)(Dc, H, D) * Dc ** (-0.5)), 'w_o': _w((lambda *s: torch.randn(*s, dtype=torch.bfloat16) * 0.8)(H, D, M) * (H * D) ** (-0.5))}
    _A_in = _A_setup()

    def _B_setup():
        B, S, D, F = (1, 2048, 448, 1792)
        return {'x': _w((lambda *s: torch.randn(*s, dtype=torch.bfloat16) * 0.05)(B, S, D)), 'w1': _w((lambda *s: torch.randn(*s, dtype=torch.bfloat16) * 1.6)(D, F) * D ** (-0.5)), 'w2': _w((lambda *s: torch.randn(*s, dtype=torch.bfloat16) * 0.2)(F, D) * F ** (-0.5))}
    _B_in = _B_setup()
    return {'A_x': _A_in['x'], 'A_c_kv': _A_in['c_kv'], 'A_w_q': _A_in['w_q'], 'A_w_uk': _A_in['w_uk'], 'A_w_uv': _A_in['w_uv'], 'A_w_o': _A_in['w_o'], 'B_x': _B_in['x'], 'B_w1': _B_in['w1'], 'B_w2': _B_in['w2'], 'c': _w((lambda *s: torch.randn(*s, dtype=torch.bfloat16) * 0.1)(1, 448) * 8.0), 'w_mod': _w((lambda *s: torch.randn(*s, dtype=torch.bfloat16) * 0.1)(448, 6 * 448) * 448 ** (-0.5) * 8.0)}

def reference(A_x, A_c_kv, A_w_q, A_w_uk, A_w_uv, A_w_o, B_x, B_w1, B_w2, c, w_mod):

    def _A_ref(x, c_kv, w_q, w_uk, w_uv, w_o):
        B, Sq, M = (x.shape[0], x.shape[1], x.shape[2])
        Sk = c_kv.shape[1]
        H, D = (w_q.shape[1], w_q.shape[2])
        q = torch.einsum('bqm,mhd->bhqd', x, w_q)
        k = torch.einsum('bkc,chd->bhkd', c_kv, w_uk)
        v = torch.einsum('bkc,chd->bhkd', c_kv, w_uv)
        scores = torch.einsum('bhqd,bhkd->bhqk', q, k) * D ** (-0.5)
        off = Sk - Sq
        qi = torch.arange(Sq)[:, None]
        kj = torch.arange(Sk)[None, :]
        cmask = kj <= qi + off
        scores = torch.where(cmask[None, None], scores, -1000000000.0)
        p = _softmax(scores, axis=-1)
        ctx = torch.einsum('bhqk,bhkd->bhqd', p, v)
        return torch.einsum('bhqd,hdm->bqm', ctx, w_o)

    def _B_ref(x, w1, w2):
        h = torch.einsum('bsd,df->bsf', x, w1)
        h = _silu(h)
        out = torch.einsum('bsf,fd->bsd', h, w2)
        return out
    x = A_x
    mod = (_silu(c) @ w_mod).reshape(c.shape[0], 6, 1, -1)
    sa, ca, ga, sb, cb, gb = (mod[:, 0].clone(), mod[:, 1].clone(), mod[:, 2].clone(), mod[:, 3].clone(), mod[:, 4].clone(), mod[:, 5].clone())
    h = _layernorm(x, axis=-1) * (1 + ca) + sa
    x = x + ga * _A_ref(h, A_c_kv, A_w_q, A_w_uk, A_w_uv, A_w_o)
    h = _layernorm(x, axis=-1) * (1 + cb) + sb
    x = x + gb * _B_ref(h, B_w1, B_w2)
    return x
```

```asm
; @launch kernel=kvattn_kernel grid=(256,1,1) block=(256,1,1) lds=163840
.amdgcn_target "amdgcn-amd-amdhsa--gfx950"
.text
.globl kvattn_kernel
.p2align 8
.type kvattn_kernel,@function
kvattn_kernel:
s_cmp_ge_u32 s2, 256
s_cbranch_scc1 kv_end
s_load_dwordx16 s[4:19], s[0:1], 0
s_load_dwordx8 s[32:39], s[0:1], 64
s_load_dwordx2 s[28:29], s[0:1], 104
s_load_dwordx2 s[42:43], s[0:1], 96
v_lshrrev_b32 v56, 6, v0
v_and_b32 v1, 63, v0
v_readfirstlane_b32 s55, v56
v_lshlrev_b32 v2, 4, v1
s_getpc_b64 s[74:75]
kv_pc:
s_sub_u32 s74, s74, kv_pc-kvattn_kernel
s_subb_u32 s75, s75, 0
s_lshr_b32 s70, s2, 3
s_lshl_b32 s70, s70, 2
s_add_u32 s70, s70, s55
s_lshl_b32 s70, s70, 10
v_and_b32 v56, 7, v1
v_lshlrev_b32 v56, 7, v56
v_add_u32 v56, s70, v56
v_min_u32 v56, all_code_end-kvattn_kernel, v56
v_mov_b32 v27, s75
v_add_co_u32 v26, vcc, s74, v56
s_nop 1
v_addc_co_u32 v27, vcc, 0, v27, vcc
global_load_dword a255, v[26:27], off
s_and_b32 s70, s2, 7
s_lshr_b32 s71, s2, 3
s_lshr_b32 s73, s71, 3
s_lshl_b32 s70, s70, 2
s_add_u32 s73, s73, s70
s_and_b32 s56, s71, 7
s_lshr_b32 s72, s73, 1
s_and_b32 s73, s73, 1
v_lshrrev_b32 v56, 3, v1
v_and_b32 v57, 7, v1
v_lshrrev_b32 v58, 4, v1
v_xor_b32 v57, v57, v58
v_lshlrev_b32 v57, 4, v57
v_lshl_add_u32 v4, v56, 11, v57
v_xor_b32 v57, 64, v4
v_add_u32 v5, 15360, v57
v_add_u32 v6, 30720, v4
v_add_u32 v7, 46080, v57
s_and_b32 s70, s55, 1
s_lshl_b32 s71, s70, 2
v_lshrrev_b32 v56, 5, v1
v_bfe_u32 v57, v1, 1, 4
v_and_b32 v58, 1, v1
v_or_b32 v59, s71, v56
v_xor_b32 v59, v59, v57
v_lshlrev_b32 v59, 5, v59
v_lshl_add_u32 v59, v58, 4, v59
v_lshl_add_u32 v8, v56, 13, v59
v_xor_b32 v57, 64, v8
v_add_u32 v9, 15360, v57
v_add_u32 v10, 30720, v8
v_add_u32 v11, 46080, v57
s_lshl_b32 s48, s56, 5
s_lshl_b32 s70, s55, 9
s_add_u32 s48, s48, s70
s_lshl_b32 s48, s48, 11
s_add_u32 s49, s48, 524288
s_lshl_b32 s52, s55, 13
s_add_u32 s52, s52, 98304
s_lshr_b32 s70, s55, 1
s_lshl_b32 s70, s70, 5
s_and_b32 s71, s55, 1
s_lshl_b32 s71, s71, 3
s_add_u32 s70, s70, s71
s_lshl_b32 s69, s70, 9
s_mov_b32 s53, s69
s_add_u32 s68, s69, 98304
s_lshl_b32 s50, s70, 13
s_lshl_b32 s71, s72, 9
s_add_u32 s50, s50, s71
s_add_u32 s51, s50, 131072
s_mov_b32 s22, 4194304
s_mov_b32 s23, 0x00020000
s_mov_b32 s26, 8388608
s_mov_b32 s27, 0x00020000
s_lshl_b32 s70, s56, 2
s_add_u32 s70, s70, s55
s_lshl_b32 s70, s70, 14
s_lshl_b32 s71, s72, 9
s_add_u32 s70, s70, s71
s_add_u32 s70, s70, 524288
v_lshrrev_b32 v56, 3, v1
v_bfe_u32 v57, v1, 2, 1
v_lshl_add_u32 v56, v56, 6, v57
v_and_b32 v57, 3, v1
v_lshlrev_b32 v57, 7, v57
v_lshl_add_u32 v22, v56, 13, v57
v_add_u32 v22, s70, v22
v_cmp_gt_u32 vcc, 24, v1
v_mov_b32 v62, 0x40000000
s_nop 0
v_cndmask_b32 v60, v62, v22, vcc
s_lshl_b32 s70, s72, 1
s_add_u32 s70, s70, s73
s_lshl_b32 s70, s70, 2
s_add_u32 s70, s70, s55
s_lshl_b32 s70, s70, 1
s_lshl_b32 s71, s56, 8
s_add_u32 s70, s70, s71
s_lshl_b32 s70, s70, 11
s_add_u32 s70, s70, 128
v_and_b32 v56, 1, v1
v_lshlrev_b32 v56, 11, v56
v_lshrrev_b32 v57, 1, v1
v_lshl_add_u32 v23, v57, 7, v56
v_add_u32 v23, s70, v23
v_cmp_gt_u32 vcc, 6, v1
s_nop 1
v_cndmask_b32 v61, v62, v23, vcc
v_subrev_u32 v24, 524288, v22
v_cmp_gt_u32 vcc, 8, v1
s_nop 1
v_cndmask_b32 v24, v62, v24, vcc
v_subrev_u32 v25, 128, v23
v_cmp_gt_u32 vcc, 2, v1
s_nop 1
v_cndmask_b32 v25, v62, v25, vcc
s_lshl_b32 s57, s72, 3
s_add_u32 s57, s57, s56
s_lshl_b32 s57, s57, 2
s_add_u32 s57, s57, s55
s_mul_i32 s71, s57, 3584
v_cmp_gt_u32 s[78:79], 56, v1
v_mov_b32 v29, 0x1000000
s_nop 0
v_cndmask_b32 v28, v29, v2, s[78:79]
s_cmp_eq_u32 s73, 0
s_waitcnt lgkmcnt(0)
s_mov_b32 s20, s6
s_mov_b32 s21, s7
s_cselect_b32 s24, s10, s12
s_cselect_b32 s25, s11, s13
s_mov_b32 s76, s42
s_mov_b32 s77, s43
s_mov_b32 s40, s4
s_mov_b32 s41, s5
s_cselect_b32 s42, 1835008, 0
s_mov_b32 s43, 0x00020000
buffer_load_dwordx4 v[32:35], v28, s[40:43], s71 offen offset:0
buffer_load_dwordx4 v[36:39], v28, s[40:43], s71 offen offset:896
buffer_load_dwordx4 v[40:43], v28, s[40:43], s71 offen offset:1792
buffer_load_dwordx4 v[44:47], v28, s[40:43], s71 offen offset:2688
buffer_load_dword a255, v24, s[24:27], 0 offen
buffer_load_dword a255, v25, s[20:23], 0 offen
s_mov_b32 m0, s52
s_nop 0
buffer_load_dwordx4 v4, s[20:23], s48 offen offset:0 lds
buffer_load_dwordx4 v5, s[20:23], s48 offen offset:1024 lds
buffer_load_dwordx4 v6, s[20:23], s48 offen offset:2048 lds
buffer_load_dwordx4 v7, s[20:23], s48 offen offset:3072 lds
s_add_u32 s48, s48, 128
s_mov_b32 m0, s53
s_nop 0
buffer_load_dwordx4 v8, s[24:27], s50 offen offset:0 lds
buffer_load_dwordx4 v9, s[24:27], s50 offen offset:1024 lds
buffer_load_dwordx4 v10, s[24:27], s50 offen offset:2048 lds
buffer_load_dwordx4 v11, s[24:27], s50 offen offset:3072 lds
s_add_u32 s50, s50, 524288
buffer_load_dword a255, v60, s[24:27], 0 offen
buffer_load_dword a255, v61, s[20:23], 0 offen
v_add_u32 v22, 1572864, v22
v_cmp_gt_u32 vcc, 8, v1
s_nop 1
v_cndmask_b32 v22, v62, v22, vcc
v_add_u32 v23, 384, v23
v_cmp_gt_u32 vcc, 2, v1
s_nop 1
v_cndmask_b32 v23, v62, v23, vcc
v_mov_b32 v58, 0x40000000
s_add_u32 s44, s28, 36700160
s_addc_u32 s45, s29, 0
s_mov_b32 s46, 131072
s_mov_b32 s47, 0x00020000
s_bfe_u32 s70, s2, 0x40003
s_or_b32 s70, s70, s55
s_cmp_eq_u32 s70, 0
s_cselect_b32 s46, s46, 0
s_lshl_b32 s71, s72, 13
v_lshlrev_b32 v56, 7, v1
v_add_u32 v56, s71, v56
v_mov_b32 v57, 0
buffer_store_dword v57, v56, s[44:47], 0 offen sc1
s_cmp_eq_u32 s2, 64
s_cselect_b32 s46, 159744, 0
s_mul_i32 s71, s55, 7168
s_add_u32 s71, s71, 131072
v_add_u32 v56, s71, v2
v_mov_b64 v[80:81], 0
v_mov_b64 v[82:83], 0
buffer_store_dwordx4 v[80:83], v56, s[44:47], 0 offen offset:0 sc1
buffer_store_dwordx4 v[80:83], v56, s[44:47], 0 offen offset:1024 sc1
buffer_store_dwordx4 v[80:83], v56, s[44:47], 0 offen offset:2048 sc1
buffer_store_dwordx4 v[80:83], v56, s[44:47], 0 offen offset:3072 sc1
v_add_u32 v56, 4096, v56
buffer_store_dwordx4 v[80:83], v56, s[44:47], 0 offen offset:0 sc1
buffer_store_dwordx4 v[80:83], v56, s[44:47], 0 offen offset:1024 sc1
buffer_store_dwordx4 v[80:83], v56, s[44:47], 0 offen offset:2048 sc1
s_lshl_b32 s70, s2, 2
s_add_u32 s70, s70, s55
s_mov_b32 s44, s8
s_mov_b32 s45, s9
s_mov_b32 s46, 3670016
s_mov_b32 s71, 0
s_cmp_ge_u32 s70, 342
s_cselect_b32 s44, s14, s44
s_cselect_b32 s45, s15, s45
s_cselect_b32 s46, 3670016, s46
s_cselect_b32 s71, 342, s71
s_cmp_ge_u32 s70, 684
s_cselect_b32 s44, s18, s44
s_cselect_b32 s45, s19, s45
s_cselect_b32 s46, 1605632, s46
s_cselect_b32 s71, 684, s71
s_cmp_ge_u32 s70, 834
s_cselect_b32 s44, s32, s44
s_cselect_b32 s45, s33, s45
s_cselect_b32 s46, 1605632, s46
s_cselect_b32 s71, 834, s71
s_sub_u32 s70, s70, s71
s_mul_i32 s70, s70, 10752
v_lshlrev_b32 v3, 7, v1
v_add_u32 v3, s70, v3
v_cmp_gt_u32 vcc, 11, v1
s_nop 1
v_cndmask_b32 v3, v58, v3, vcc
s_mov_b32 s17, s46
s_mov_b32 s16, -3
s_mov_b32 s18, s8
s_mov_b32 s19, s9
s_mov_b32 s80, s14
s_mov_b32 s81, s15
s_mov_b32 s82, s4
s_mov_b32 s83, s5
v_lshrrev_b32 v56, 4, v1
v_bfe_u32 v57, v1, 2, 2
v_and_b32 v58, 3, v1
v_lshl_add_u32 v59, v56, 3, v57
v_lshlrev_b32 v59, 9, v59
v_lshl_add_u32 v59, v58, 3, v59
s_and_b32 s70, s55, 1
s_lshl_b32 s70, s70, 8
v_add_u32 v59, s70, v59
v_and_b32 v60, 1, v56
v_lshl_or_b32 v60, v60, 2, v57
v_xor_b32 v61, 0, v60
v_lshl_add_u32 v12, v61, 5, v59
v_xor_b32 v61, 1, v60
v_lshl_add_u32 v13, v61, 5, v59
v_xor_b32 v61, 2, v60
v_lshl_add_u32 v14, v61, 5, v59
v_xor_b32 v61, 3, v60
v_lshl_add_u32 v15, v61, 5, v59
v_xor_b32 v61, 4, v60
v_lshl_add_u32 v16, v61, 5, v59
v_xor_b32 v61, 5, v60
v_lshl_add_u32 v17, v61, 5, v59
v_xor_b32 v61, 6, v60
v_lshl_add_u32 v18, v61, 5, v59
v_xor_b32 v61, 7, v60
v_lshl_add_u32 v19, v61, 5, v59
v_and_b32 v57, 15, v1
v_lshrrev_b32 v58, 1, v57
s_lshr_b32 s70, s55, 1
s_lshl_b32 s70, s70, 14
s_add_u32 s70, s70, 98304
v_add_u32 v59, 0, v56
v_xor_b32 v59, v59, v58
v_lshlrev_b32 v59, 4, v59
v_lshl_add_u32 v59, v57, 7, v59
v_add_u32 v20, s70, v59
v_add_u32 v59, 4, v56
v_xor_b32 v59, v59, v58
v_lshlrev_b32 v59, 4, v59
v_lshl_add_u32 v59, v57, 7, v59
v_add_u32 v21, s70, v59
s_mov_b32 s58, 0xffff0000
s_mov_b32 s59, 32768
s_mov_b32 s54, 32768
s_lshl_b32 s60, s72, 20
s_lshl_b32 s70, s56, 14
s_add_u32 s60, s60, s70
s_lshr_b32 s70, s55, 1
s_lshl_b32 s70, s70, 19
s_add_u32 s60, s60, s70
s_and_b32 s71, s55, 1
s_add_u32 m0, s52, 4096
s_nop 0
buffer_load_dwordx4 v4, s[20:23], s49 offen offset:0 lds
buffer_load_dwordx4 v5, s[20:23], s49 offen offset:1024 lds
buffer_load_dwordx4 v6, s[20:23], s49 offen offset:2048 lds
buffer_load_dwordx4 v7, s[20:23], s49 offen offset:3072 lds
s_add_u32 s49, s49, 128
s_add_u32 m0, s53, 8192
s_nop 0
buffer_load_dwordx4 v8, s[24:27], s51 offen offset:0 lds
buffer_load_dwordx4 v9, s[24:27], s51 offen offset:1024 lds
buffer_load_dwordx4 v10, s[24:27], s51 offen offset:2048 lds
buffer_load_dwordx4 v11, s[24:27], s51 offen offset:3072 lds
s_add_u32 s51, s51, 524288
s_add_u32 s53, s53, 32768
s_xor_b32 s52, s52, 0x38000
s_cmp_eq_u32 s73, 0
s_cbranch_scc0 kv_v
s_lshl_b32 s71, s71, 12
s_add_u32 s60, s60, s71
s_add_u32 s32, s28, 35651584
s_addc_u32 s33, s29, 0
s_mov_b32 s34, 3584
s_mov_b32 s35, 0x00020000
s_add_u32 s40, s28, 33554432
s_addc_u32 s41, s29, 0
s_mov_b32 s42, 1835008
s_mov_b32 s43, 0x00020000
s_waitcnt vmcnt(28)
v_lshlrev_b32 v72, 16, v32
v_and_b32 v73, 0xffff0000, v32
v_add_f32 v64, v72, v73
v_lshlrev_b32 v74, 16, v36
v_and_b32 v75, 0xffff0000, v36
v_add_f32 v65, v74, v75
v_lshlrev_b32 v76, 16, v40
v_and_b32 v77, 0xffff0000, v40
v_add_f32 v66, v76, v77
v_lshlrev_b32 v78, 16, v44
v_and_b32 v79, 0xffff0000, v44
v_add_f32 v67, v78, v79
v_lshlrev_b32 v72, 16, v33
v_and_b32 v73, 0xffff0000, v33
v_add_f32 v64, v64, v72
v_add_f32 v64, v64, v73
v_lshlrev_b32 v74, 16, v37
v_and_b32 v75, 0xffff0000, v37
v_add_f32 v65, v65, v74
v_add_f32 v65, v65, v75
v_lshlrev_b32 v76, 16, v41
v_and_b32 v77, 0xffff0000, v41
v_add_f32 v66, v66, v76
v_add_f32 v66, v66, v77
v_lshlrev_b32 v78, 16, v45
v_and_b32 v79, 0xffff0000, v45
v_add_f32 v67, v67, v78
v_add_f32 v67, v67, v79
v_lshlrev_b32 v72, 16, v34
v_and_b32 v73, 0xffff0000, v34
v_add_f32 v64, v64, v72
v_add_f32 v64, v64, v73
v_lshlrev_b32 v74, 16, v38
v_and_b32 v75, 0xffff0000, v38
v_add_f32 v65, v65, v74
v_add_f32 v65, v65, v75
v_lshlrev_b32 v76, 16, v42
v_and_b32 v77, 0xffff0000, v42
v_add_f32 v66, v66, v76
v_add_f32 v66, v66, v77
v_lshlrev_b32 v78, 16, v46
v_and_b32 v79, 0xffff0000, v46
v_add_f32 v67, v67, v78
v_add_f32 v67, v67, v79
v_lshlrev_b32 v72, 16, v35
v_and_b32 v73, 0xffff0000, v35
v_add_f32 v64, v64, v72
v_add_f32 v64, v64, v73
v_lshlrev_b32 v74, 16, v39
v_and_b32 v75, 0xffff0000, v39
v_add_f32 v65, v65, v74
v_add_f32 v65, v65, v75
v_lshlrev_b32 v76, 16, v43
v_and_b32 v77, 0xffff0000, v43
v_add_f32 v66, v66, v76
v_add_f32 v66, v66, v77
v_lshlrev_b32 v78, 16, v47
v_and_b32 v79, 0xffff0000, v47
v_add_f32 v67, v67, v78
v_add_f32 v67, v67, v79
v_add_f32_dpp v64, v64, v64 quad_perm:[1,0,3,2] row_mask:0xf bank_mask:0xf
v_add_f32_dpp v65, v65, v65 quad_perm:[1,0,3,2] row_mask:0xf bank_mask:0xf
v_add_f32_dpp v66, v66, v66 quad_perm:[1,0,3,2] row_mask:0xf bank_mask:0xf
v_add_f32_dpp v67, v67, v67 quad_perm:[1,0,3,2] row_mask:0xf bank_mask:0xf
v_add_f32_dpp v64, v64, v64 quad_perm:[2,3,0,1] row_mask:0xf bank_mask:0xf
v_add_f32_dpp v65, v65, v65 quad_perm:[2,3,0,1] row_mask:0xf bank_mask:0xf
v_add_f32_dpp v66, v66, v66 quad_perm:[2,3,0,1] row_mask:0xf bank_mask:0xf
v_add_f32_dpp v67, v67, v67 quad_perm:[2,3,0,1] row_mask:0xf bank_mask:0xf
v_add_f32_dpp v64, v64, v64 row_half_mirror row_mask:0xf bank_mask:0xf
v_add_f32_dpp v65, v65, v65 row_half_mirror row_mask:0xf bank_mask:0xf
v_add_f32_dpp v66, v66, v66 row_half_mirror row_mask:0xf bank_mask:0xf
v_add_f32_dpp v67, v67, v67 row_half_mirror row_mask:0xf bank_mask:0xf
v_add_f32_dpp v64, v64, v64 row_mirror row_mask:0xf bank_mask:0xf
v_add_f32_dpp v65, v65, v65 row_mirror row_mask:0xf bank_mask:0xf
v_add_f32_dpp v66, v66, v66 row_mirror row_mask:0xf bank_mask:0xf
v_add_f32_dpp v67, v67, v67 row_mirror row_mask:0xf bank_mask:0xf
v_add_f32_dpp v64, v64, v64 row_bcast:15 row_mask:0xa bank_mask:0xf
v_add_f32_dpp v65, v65, v65 row_bcast:15 row_mask:0xa bank_mask:0xf
v_add_f32_dpp v66, v66, v66 row_bcast:15 row_mask:0xa bank_mask:0xf
v_add_f32_dpp v67, v67, v67 row_bcast:15 row_mask:0xa bank_mask:0xf
v_add_f32_dpp v64, v64, v64 row_bcast:31 row_mask:0xc bank_mask:0xf
v_add_f32_dpp v65, v65, v65 row_bcast:31 row_mask:0xc bank_mask:0xf
v_add_f32_dpp v66, v66, v66 row_bcast:31 row_mask:0xc bank_mask:0xf
v_add_f32_dpp v67, v67, v67 row_bcast:31 row_mask:0xc bank_mask:0xf
v_mul_f32 v64, 0x3b124925, v64
v_mul_f32 v65, 0x3b124925, v65
v_mul_f32 v66, 0x3b124925, v66
v_mul_f32 v67, 0x3b124925, v67
v_readlane_b32 s8, v64, 63
v_readlane_b32 s9, v65, 63
v_readlane_b32 s10, v66, 63
v_readlane_b32 s11, v67, 63
v_cvt_pk_bf16_f32 v64, v64, v64
v_and_b32 v64, 0xffff0000, v64
v_cvt_pk_bf16_f32 v65, v65, v65
v_and_b32 v65, 0xffff0000, v65
v_cvt_pk_bf16_f32 v66, v66, v66
v_and_b32 v66, 0xffff0000, v66
v_cvt_pk_bf16_f32 v67, v67, v67
v_and_b32 v67, 0xffff0000, v67
v_readlane_b32 s12, v64, 63
v_readlane_b32 s13, v65, 63
v_readlane_b32 s14, v66, 63
v_readlane_b32 s15, v67, 63
v_mov_b32 v68, s8
v_mov_b32 v69, s9
v_mov_b32 v70, s10
v_mov_b32 v71, s11
v_cndmask_b32 v68, 0, v68, s[78:79]
v_cndmask_b32 v69, 0, v69, s[78:79]
v_cndmask_b32 v70, 0, v70, s[78:79]
v_cndmask_b32 v71, 0, v71, s[78:79]
v_lshlrev_b32 v72, 16, v32
v_and_b32 v73, 0xffff0000, v32
v_sub_f32 v72, v72, v68
v_sub_f32 v73, v73, v68
v_mul_f32 v64, v72, v72
v_fmac_f32 v64, v73, v73
v_lshlrev_b32 v74, 16, v36
v_and_b32 v75, 0xffff0000, v36
v_sub_f32 v74, v74, v69
v_sub_f32 v75, v75, v69
v_mul_f32 v65, v74, v74
v_fmac_f32 v65, v75, v75
v_lshlrev_b32 v76, 16, v40
v_and_b32 v77, 0xffff0000, v40
v_sub_f32 v76, v76, v70
v_sub_f32 v77, v77, v70
v_mul_f32 v66, v76, v76
v_fmac_f32 v66, v77, v77
v_lshlrev_b32 v78, 16, v44
v_and_b32 v79, 0xffff0000, v44
v_sub_f32 v78, v78, v71
v_sub_f32 v79, v79, v71
v_mul_f32 v67, v78, v78
v_fmac_f32 v67, v79, v79
v_lshlrev_b32 v72, 16, v33
v_and_b32 v73, 0xffff0000, v33
v_sub_f32 v72, v72, v68
v_sub_f32 v73, v73, v68
v_fmac_f32 v64, v72, v72
v_fmac_f32 v64, v73, v73
v_lshlrev_b32 v74, 16, v37
v_and_b32 v75, 0xffff0000, v37
v_sub_f32 v74, v74, v69
v_sub_f32 v75, v75, v69
v_fmac_f32 v65, v74, v74
v_fmac_f32 v65, v75, v75
v_lshlrev_b32 v76, 16, v41
v_and_b32 v77, 0xffff0000, v41
v_sub_f32 v76, v76, v70
v_sub_f32 v77, v77, v70
v_fmac_f32 v66, v76, v76
v_fmac_f32 v66, v77, v77
v_lshlrev_b32 v78, 16, v45
v_and_b32 v79, 0xffff0000, v45
v_sub_f32 v78, v78, v71
v_sub_f32 v79, v79, v71
v_fmac_f32 v67, v78, v78
v_fmac_f32 v67, v79, v79
v_lshlrev_b32 v72, 16, v34
v_and_b32 v73, 0xffff0000, v34
v_sub_f32 v72, v72, v68
v_sub_f32 v73, v73, v68
v_fmac_f32 v64, v72, v72
v_fmac_f32 v64, v73, v73
v_lshlrev_b32 v74, 16, v38
v_and_b32 v75, 0xffff0000, v38
v_sub_f32 v74, v74, v69
v_sub_f32 v75, v75, v69
v_fmac_f32 v65, v74, v74
v_fmac_f32 v65, v75, v75
v_lshlrev_b32 v76, 16, v42
v_and_b32 v77, 0xffff0000, v42
v_sub_f32 v76, v76, v70
v_sub_f32 v77, v77, v70
v_fmac_f32 v66, v76, v76
v_fmac_f32 v66, v77, v77
v_lshlrev_b32 v78, 16, v46
v_and_b32 v79, 0xffff0000, v46
v_sub_f32 v78, v78, v71
v_sub_f32 v79, v79, v71
v_fmac_f32 v67, v78, v78
v_fmac_f32 v67, v79, v79
v_lshlrev_b32 v72, 16, v35
v_and_b32 v73, 0xffff0000, v35
v_sub_f32 v72, v72, v68
v_sub_f32 v73, v73, v68
v_fmac_f32 v64, v72, v72
v_fmac_f32 v64, v73, v73
v_lshlrev_b32 v74, 16, v39
v_and_b32 v75, 0xffff0000, v39
v_sub_f32 v74, v74, v69
v_sub_f32 v75, v75, v69
v_fmac_f32 v65, v74, v74
v_fmac_f32 v65, v75, v75
v_lshlrev_b32 v76, 16, v43
v_and_b32 v77, 0xffff0000, v43
v_sub_f32 v76, v76, v70
v_sub_f32 v77, v77, v70
v_fmac_f32 v66, v76, v76
v_fmac_f32 v66, v77, v77
v_lshlrev_b32 v78, 16, v47
v_and_b32 v79, 0xffff0000, v47
v_sub_f32 v78, v78, v71
v_sub_f32 v79, v79, v71
v_fmac_f32 v67, v78, v78
v_fmac_f32 v67, v79, v79
v_add_f32_dpp v64, v64, v64 quad_perm:[1,0,3,2] row_mask:0xf bank_mask:0xf
v_add_f32_dpp v65, v65, v65 quad_perm:[1,0,3,2] row_mask:0xf bank_mask:0xf
v_add_f32_dpp v66, v66, v66 quad_perm:[1,0,3,2] row_mask:0xf bank_mask:0xf
v_add_f32_dpp v67, v67, v67 quad_perm:[1,0,3,2] row_mask:0xf bank_mask:0xf
v_add_f32_dpp v64, v64, v64 quad_perm:[2,3,0,1] row_mask:0xf bank_mask:0xf
v_add_f32_dpp v65, v65, v65 quad_perm:[2,3,0,1] row_mask:0xf bank_mask:0xf
v_add_f32_dpp v66, v66, v66 quad_perm:[2,3,0,1] row_mask:0xf bank_mask:0xf
v_add_f32_dpp v67, v67, v67 quad_perm:[2,3,0,1] row_mask:0xf bank_mask:0xf
v_add_f32_dpp v64, v64, v64 row_half_mirror row_mask:0xf bank_mask:0xf
v_add_f32_dpp v65, v65, v65 row_half_mirror row_mask:0xf bank_mask:0xf
v_add_f32_dpp v66, v66, v66 row_half_mirror row_mask:0xf bank_mask:0xf
v_add_f32_dpp v67, v67, v67 row_half_mirror row_mask:0xf bank_mask:0xf
v_add_f32_dpp v64, v64, v64 row_mirror row_mask:0xf bank_mask:0xf
v_add_f32_dpp v65, v65, v65 row_mirror row_mask:0xf bank_mask:0xf
v_add_f32_dpp v66, v66, v66 row_mirror row_mask:0xf bank_mask:0xf
v_add_f32_dpp v67, v67, v67 row_mirror row_mask:0xf bank_mask:0xf
v_add_f32_dpp v64, v64, v64 row_bcast:15 row_mask:0xa bank_mask:0xf
v_add_f32_dpp v65, v65, v65 row_bcast:15 row_mask:0xa bank_mask:0xf
v_add_f32_dpp v66, v66, v66 row_bcast:15 row_mask:0xa bank_mask:0xf
v_add_f32_dpp v67, v67, v67 row_bcast:15 row_mask:0xa bank_mask:0xf
v_add_f32_dpp v64, v64, v64 row_bcast:31 row_mask:0xc bank_mask:0xf
v_add_f32_dpp v65, v65, v65 row_bcast:31 row_mask:0xc bank_mask:0xf
v_add_f32_dpp v66, v66, v66 row_bcast:31 row_mask:0xc bank_mask:0xf
v_add_f32_dpp v67, v67, v67 row_bcast:31 row_mask:0xc bank_mask:0xf
v_mul_f32 v64, 0x3b124925, v64
v_mul_f32 v65, 0x3b124925, v65
v_mul_f32 v66, 0x3b124925, v66
v_mul_f32 v67, 0x3b124925, v67
v_cvt_pk_bf16_f32 v64, v64, v64
v_and_b32 v64, 0xffff0000, v64
v_cvt_pk_bf16_f32 v65, v65, v65
v_and_b32 v65, 0xffff0000, v65
v_cvt_pk_bf16_f32 v66, v66, v66
v_and_b32 v66, 0xffff0000, v66
v_cvt_pk_bf16_f32 v67, v67, v67
v_and_b32 v67, 0xffff0000, v67
v_add_f32 v64, 0x3727c5ac, v64
v_add_f32 v65, 0x3727c5ac, v65
v_add_f32 v66, 0x3727c5ac, v66
v_add_f32 v67, 0x3727c5ac, v67
v_cvt_pk_bf16_f32 v64, v64, v64
v_and_b32 v64, 0xffff0000, v64
v_cvt_pk_bf16_f32 v65, v65, v65
v_and_b32 v65, 0xffff0000, v65
v_cvt_pk_bf16_f32 v66, v66, v66
v_and_b32 v66, 0xffff0000, v66
v_cvt_pk_bf16_f32 v67, v67, v67
v_and_b32 v67, 0xffff0000, v67
v_sqrt_f32 v64, v64
v_sqrt_f32 v65, v65
v_sqrt_f32 v66, v66
v_sqrt_f32 v67, v67
v_cvt_pk_bf16_f32 v64, v64, v64
v_and_b32 v64, 0xffff0000, v64
v_cvt_pk_bf16_f32 v65, v65, v65
v_and_b32 v65, 0xffff0000, v65
v_cvt_pk_bf16_f32 v66, v66, v66
v_and_b32 v66, 0xffff0000, v66
v_cvt_pk_bf16_f32 v67, v67, v67
v_and_b32 v67, 0xffff0000, v67
v_rcp_f32 v64, v64
v_rcp_f32 v65, v65
v_rcp_f32 v66, v66
v_rcp_f32 v67, v67
v_readlane_b32 s8, v64, 63
v_readlane_b32 s9, v65, 63
v_readlane_b32 s10, v66, 63
v_readlane_b32 s11, v67, 63
v_lshrrev_b32 v28, 2, v1
v_and_b32 v30, 3, v1
v_lshlrev_b32 v30, 4, v30
v_lshl_add_u32 v28, v28, 10, v30
v_cndmask_b32 v28, v29, v28, s[78:79]
s_lshr_b32 s7, s57, 2
s_mul_i32 s7, s7, 14336
s_and_b32 s70, s57, 3
s_lshl_b32 s70, s70, 8
s_add_u32 s7, s7, s70
v_lshlrev_b32 v72, 16, v32
v_and_b32 v73, 0xffff0000, v32
v_subrev_f32 v72, s12, v72
v_subrev_f32 v73, s12, v73
v_cvt_pk_bf16_f32 v68, v72, v73
v_lshlrev_b32 v72, 16, v68
v_and_b32 v73, 0xffff0000, v68
v_mul_f32 v72, s8, v72
v_mul_f32 v73, s8, v73
v_cvt_pk_bf16_f32 v32, v72, v73
v_lshlrev_b32 v74, 16, v33
v_and_b32 v75, 0xffff0000, v33
v_subrev_f32 v74, s12, v74
v_subrev_f32 v75, s12, v75
v_cvt_pk_bf16_f32 v69, v74, v75
v_lshlrev_b32 v74, 16, v69
v_and_b32 v75, 0xffff0000, v69
v_mul_f32 v74, s8, v74
v_mul_f32 v75, s8, v75
v_cvt_pk_bf16_f32 v33, v74, v75
v_lshlrev_b32 v76, 16, v34
v_and_b32 v77, 0xffff0000, v34
v_subrev_f32 v76, s12, v76
v_subrev_f32 v77, s12, v77
v_cvt_pk_bf16_f32 v68, v76, v77
v_lshlrev_b32 v76, 16, v68
v_and_b32 v77, 0xffff0000, v68
v_mul_f32 v76, s8, v76
v_mul_f32 v77, s8, v77
v_cvt_pk_bf16_f32 v34, v76, v77
v_lshlrev_b32 v78, 16, v35
v_and_b32 v79, 0xffff0000, v35
v_subrev_f32 v78, s12, v78
v_subrev_f32 v79, s12, v79
v_cvt_pk_bf16_f32 v69, v78, v79
v_lshlrev_b32 v78, 16, v69
v_and_b32 v79, 0xffff0000, v69
v_mul_f32 v78, s8, v78
v_mul_f32 v79, s8, v79
v_cvt_pk_bf16_f32 v35, v78, v79
v_lshlrev_b32 v72, 16, v36
v_and_b32 v73, 0xffff0000, v36
v_subrev_f32 v72, s13, v72
v_subrev_f32 v73, s13, v73
v_cvt_pk_bf16_f32 v68, v72, v73
v_lshlrev_b32 v72, 16, v68
v_and_b32 v73, 0xffff0000, v68
v_mul_f32 v72, s9, v72
v_mul_f32 v73, s9, v73
v_cvt_pk_bf16_f32 v36, v72, v73
v_lshlrev_b32 v74, 16, v37
v_and_b32 v75, 0xffff0000, v37
v_subrev_f32 v74, s13, v74
v_subrev_f32 v75, s13, v75
v_cvt_pk_bf16_f32 v69, v74, v75
v_lshlrev_b32 v74, 16, v69
v_and_b32 v75, 0xffff0000, v69
v_mul_f32 v74, s9, v74
v_mul_f32 v75, s9, v75
v_cvt_pk_bf16_f32 v37, v74, v75
v_lshlrev_b32 v76, 16, v38
v_and_b32 v77, 0xffff0000, v38
v_subrev_f32 v76, s13, v76
v_subrev_f32 v77, s13, v77
v_cvt_pk_bf16_f32 v68, v76, v77
v_lshlrev_b32 v76, 16, v68
v_and_b32 v77, 0xffff0000, v68
v_mul_f32 v76, s9, v76
v_mul_f32 v77, s9, v77
v_cvt_pk_bf16_f32 v38, v76, v77
v_lshlrev_b32 v78, 16, v39
v_and_b32 v79, 0xffff0000, v39
v_subrev_f32 v78, s13, v78
v_subrev_f32 v79, s13, v79
v_cvt_pk_bf16_f32 v69, v78, v79
v_lshlrev_b32 v78, 16, v69
v_and_b32 v79, 0xffff0000, v69
v_mul_f32 v78, s9, v78
v_mul_f32 v79, s9, v79
v_cvt_pk_bf16_f32 v39, v78, v79
v_lshlrev_b32 v72, 16, v40
v_and_b32 v73, 0xffff0000, v40
v_subrev_f32 v72, s14, v72
v_subrev_f32 v73, s14, v73
v_cvt_pk_bf16_f32 v68, v72, v73
v_lshlrev_b32 v72, 16, v68
v_and_b32 v73, 0xffff0000, v68
v_mul_f32 v72, s10, v72
v_mul_f32 v73, s10, v73
v_cvt_pk_bf16_f32 v40, v72, v73
v_lshlrev_b32 v74, 16, v41
v_and_b32 v75, 0xffff0000, v41
v_subrev_f32 v74, s14, v74
v_subrev_f32 v75, s14, v75
v_cvt_pk_bf16_f32 v69, v74, v75
v_lshlrev_b32 v74, 16, v69
v_and_b32 v75, 0xffff0000, v69
v_mul_f32 v74, s10, v74
v_mul_f32 v75, s10, v75
v_cvt_pk_bf16_f32 v41, v74, v75
v_lshlrev_b32 v76, 16, v42
v_and_b32 v77, 0xffff0000, v42
v_subrev_f32 v76, s14, v76
v_subrev_f32 v77, s14, v77
v_cvt_pk_bf16_f32 v68, v76, v77
v_lshlrev_b32 v76, 16, v68
v_and_b32 v77, 0xffff0000, v68
v_mul_f32 v76, s10, v76
v_mul_f32 v77, s10, v77
v_cvt_pk_bf16_f32 v42, v76, v77
v_lshlrev_b32 v78, 16, v43
v_and_b32 v79, 0xffff0000, v43
v_subrev_f32 v78, s14, v78
v_subrev_f32 v79, s14, v79
v_cvt_pk_bf16_f32 v69, v78, v79
v_lshlrev_b32 v78, 16, v69
v_and_b32 v79, 0xffff0000, v69
v_mul_f32 v78, s10, v78
v_mul_f32 v79, s10, v79
v_cvt_pk_bf16_f32 v43, v78, v79
v_lshlrev_b32 v72, 16, v44
v_and_b32 v73, 0xffff0000, v44
v_subrev_f32 v72, s15, v72
v_subrev_f32 v73, s15, v73
v_cvt_pk_bf16_f32 v68, v72, v73
v_lshlrev_b32 v72, 16, v68
v_and_b32 v73, 0xffff0000, v68
v_mul_f32 v72, s11, v72
v_mul_f32 v73, s11, v73
v_cvt_pk_bf16_f32 v44, v72, v73
v_lshlrev_b32 v74, 16, v45
v_and_b32 v75, 0xffff0000, v45
v_subrev_f32 v74, s15, v74
v_subrev_f32 v75, s15, v75
v_cvt_pk_bf16_f32 v69, v74, v75
v_lshlrev_b32 v74, 16, v69
v_and_b32 v75, 0xffff0000, v69
v_mul_f32 v74, s11, v74
v_mul_f32 v75, s11, v75
v_cvt_pk_bf16_f32 v45, v74, v75
v_lshlrev_b32 v76, 16, v46
v_and_b32 v77, 0xffff0000, v46
v_subrev_f32 v76, s15, v76
v_subrev_f32 v77, s15, v77
v_cvt_pk_bf16_f32 v68, v76, v77
v_lshlrev_b32 v76, 16, v68
v_and_b32 v77, 0xffff0000, v68
v_mul_f32 v76, s11, v76
v_mul_f32 v77, s11, v77
v_cvt_pk_bf16_f32 v46, v76, v77
v_lshlrev_b32 v78, 16, v47
v_and_b32 v79, 0xffff0000, v47
v_subrev_f32 v78, s15, v78
v_subrev_f32 v79, s15, v79
v_cvt_pk_bf16_f32 v69, v78, v79
v_lshlrev_b32 v78, 16, v69
v_and_b32 v79, 0xffff0000, v69
v_mul_f32 v78, s11, v78
v_mul_f32 v79, s11, v79
v_cvt_pk_bf16_f32 v47, v78, v79
s_mov_b32 s4, s28
s_mov_b32 s5, s29
s_mov_b32 s12, s28
s_mov_b32 s13, s29
s_mov_b32 s14, 268435456
s_mov_b32 s15, 0x00020000
s_mov_b32 s8, s76
s_mov_b32 s9, s77
s_cmp_eq_u32 s55, 0
s_cselect_b32 s10, 256, 0
s_mov_b32 s11, 0x00020000
s_waitcnt vmcnt(0)
s_barrier
ds_read_b128 a[64:67], v20 offset:0
ds_read_b128 a[68:71], v21 offset:0
ds_read_b128 a[72:75], v20 offset:2048
ds_read_b128 a[76:79], v21 offset:2048
ds_read_b128 a[80:83], v20 offset:4096
ds_read_b128 a[84:87], v21 offset:4096
ds_read_b128 a[88:91], v20 offset:6144
ds_read_b128 a[92:95], v21 offset:6144
ds_read_b128 a[96:99], v20 offset:8192
ds_read_b128 a[100:103], v21 offset:8192
ds_read_b128 a[104:107], v20 offset:10240
ds_read_b128 a[108:111], v21 offset:10240
ds_read_b128 a[112:115], v20 offset:12288
ds_read_b128 a[116:119], v21 offset:12288
ds_read_b128 a[120:123], v20 offset:14336
ds_read_b128 a[124:127], v21 offset:14336
ds_read_b64_tr_b16 a[128:129], v12 offset:0
ds_read_b64_tr_b16 a[130:131], v12 offset:2048
ds_read_b64_tr_b16 a[132:133], v12 offset:16384
ds_read_b64_tr_b16 a[134:135], v12 offset:18432
v_add_u32 v12, s54, v12
v_xor_b32 v20, 0x38000, v20
v_xor_b32 v21, 0x38000, v21
s_waitcnt lgkmcnt(0)
v_mfma_f32_16x16x32_bf16 a[0:3], a[128:131], a[64:67], 0
ds_read_b64_tr_b16 a[136:137], v13 offset:0
v_mfma_f32_16x16x32_bf16 a[0:3], a[132:135], a[68:71], a[0:3]
ds_read_b64_tr_b16 a[138:139], v13 offset:2048
v_mfma_f32_16x16x32_bf16 a[4:7], a[128:131], a[72:75], 0
ds_read_b64_tr_b16 a[140:141], v13 offset:16384
v_mfma_f32_16x16x32_bf16 a[4:7], a[132:135], a[76:79], a[4:7]
ds_read_b64_tr_b16 a[142:143], v13 offset:18432
v_mfma_f32_16x16x32_bf16 a[8:11], a[128:131], a[80:83], 0
v_add_u32 v13, s54, v13
s_mov_b32 m0, s52
v_mfma_f32_16x16x32_bf16 a[8:11], a[132:135], a[84:87], a[8:11]
buffer_load_dwordx4 v4, s[20:23], s48 offen offset:0 lds
v_mfma_f32_16x16x32_bf16 a[12:15], a[128:131], a[88:91], 0
v_mfma_f32_16x16x32_bf16 a[12:15], a[132:135], a[92:95], a[12:15]
buffer_load_dwordx4 v5, s[20:23], s48 offen offset:1024 lds
v_mfma_f32_16x16x32_bf16 a[16:19], a[128:131], a[96:99], 0
v_mfma_f32_16x16x32_bf16 a[16:19], a[132:135], a[100:103], a[16:19]
buffer_load_dwordx4 v6, s[20:23], s48 offen offset:2048 lds
v_mfma_f32_16x16x32_bf16 a[20:23], a[128:131], a[104:107], 0
v_mfma_f32_16x16x32_bf16 a[20:23], a[132:135], a[108:111], a[20:23]
buffer_load_dwordx4 v7, s[20:23], s48 offen offset:3072 lds
s_add_u32 s48, s48, 128
v_mfma_f32_16x16x32_bf16 a[24:27], a[128:131], a[112:115], 0
s_mov_b32 m0, s53
v_mfma_f32_16x16x32_bf16 a[24:27], a[132:135], a[116:119], a[24:27]
buffer_load_dwordx4 v8, s[24:27], s50 offen offset:0 lds
v_mfma_f32_16x16x32_bf16 a[28:31], a[128:131], a[120:123], 0
v_mfma_f32_16x16x32_bf16 a[28:31], a[132:135], a[124:127], a[28:31]
s_waitcnt lgkmcnt(0)
s_barrier
buffer_load_dwordx4 v9, s[24:27], s50 offen offset:1024 lds
v_mfma_f32_16x16x32_bf16 a[32:35], a[136:139], a[64:67], 0
ds_read_b64_tr_b16 a[128:129], v14 offset:0
v_mfma_f32_16x16x32_bf16 a[32:35], a[140:143], a[68:71], a[32:35]
ds_read_b64_tr_b16 a[130:131], v14 offset:2048
buffer_load_dwordx4 v10, s[24:27], s50 offen offset:2048 lds
v_mfma_f32_16x16x32_bf16 a[36:39], a[136:139], a[72:75], 0
ds_read_b64_tr_b16 a[132:133], v14 offset:16384
v_mfma_f32_16x16x32_bf16 a[36:39], a[140:143], a[76:79], a[36:39]
ds_read_b64_tr_b16 a[134:135], v14 offset:18432
buffer_load_dwordx4 v11, s[24:27], s50 offen offset:3072 lds
s_add_u32 s50, s50, 524288
v_mfma_f32_16x16x32_bf16 a[40:43], a[136:139], a[80:83], 0
v_add_u32 v14, s54, v14
s_add_u32 m0, s52, 4096
v_mfma_f32_16x16x32_bf16 a[40:43], a[140:143], a[84:87], a[40:43]
buffer_load_dwordx4 v4, s[20:23], s49 offen offset:0 lds
v_mfma_f32_16x16x32_bf16 a[44:47], a[136:139], a[88:91], 0
v_mfma_f32_16x16x32_bf16 a[44:47], a[140:143], a[92:95], a[44:47]
buffer_load_dwordx4 v5, s[20:23], s49 offen offset:1024 lds
v_mfma_f32_16x16x32_bf16 a[48:51], a[136:139], a[96:99], 0
v_mfma_f32_16x16x32_bf16 a[48:51], a[140:143], a[100:103], a[48:51]
buffer_load_dwordx4 v6, s[20:23], s49 offen offset:2048 lds
v_mfma_f32_16x16x32_bf16 a[52:55], a[136:139], a[104:107], 0
v_mfma_f32_16x16x32_bf16 a[52:55], a[140:143], a[108:111], a[52:55]
buffer_load_dwordx4 v7, s[20:23], s49 offen offset:3072 lds
s_add_u32 s49, s49, 128
v_mfma_f32_16x16x32_bf16 a[56:59], a[136:139], a[112:115], 0
s_add_u32 m0, s53, 8192
v_mfma_f32_16x16x32_bf16 a[56:59], a[140:143], a[116:119], a[56:59]
buffer_load_dwordx4 v8, s[24:27], s51 offen offset:0 lds
v_mfma_f32_16x16x32_bf16 a[60:63], a[136:139], a[120:123], 0
v_mfma_f32_16x16x32_bf16 a[60:63], a[140:143], a[124:127], a[60:63]
s_waitcnt lgkmcnt(0)
buffer_load_dwordx4 v9, s[24:27], s51 offen offset:1024 lds
v_mfma_f32_16x16x32_bf16 v[64:67], a[128:131], a[64:67], 0
ds_read_b64_tr_b16 a[136:137], v15 offset:0
v_mfma_f32_16x16x32_bf16 v[64:67], a[132:135], a[68:71], v[64:67]
ds_read_b64_tr_b16 a[138:139], v15 offset:2048
buffer_load_dwordx4 v10, s[24:27], s51 offen offset:2048 lds
v_mfma_f32_16x16x32_bf16 v[68:71], a[128:131], a[72:75], 0
ds_read_b64_tr_b16 a[140:141], v15 offset:16384
v_mfma_f32_16x16x32_bf16 v[68:71], a[132:135], a[76:79], v[68:71]
ds_read_b64_tr_b16 a[142:143], v15 offset:18432
buffer_load_dwordx4 v11, s[24:27], s51 offen offset:3072 lds
s_add_u32 s51, s51, 524288
v_mfma_f32_16x16x32_bf16 v[72:75], a[128:131], a[80:83], 0
v_add_u32 v15, s54, v15
v_mfma_f32_16x16x32_bf16 v[72:75], a[132:135], a[84:87], v[72:75]
s_add_u32 s53, s53, 32768
s_xor_b32 s52, s52, 0x38000
v_mfma_f32_16x16x32_bf16 v[76:79], a[128:131], a[88:91], 0
v_mfma_f32_16x16x32_bf16 v[76:79], a[132:135], a[92:95], v[76:79]
v_mfma_f32_16x16x32_bf16 v[80:83], a[128:131], a[96:99], 0
s_mov_b32 m0, s52
v_mfma_f32_16x16x32_bf16 v[80:83], a[132:135], a[100:103], v[80:83]
buffer_load_dwordx4 v4, s[20:23], s48 offen offset:0 lds
v_mfma_f32_16x16x32_bf16 v[84:87], a[128:131], a[104:107], 0
v_mfma_f32_16x16x32_bf16 v[84:87], a[132:135], a[108:111], v[84:87]
v_mfma_f32_16x16x32_bf16 v[88:91], a[128:131], a[112:115], 0
buffer_load_dwordx4 v5, s[20:23], s48 offen offset:1024 lds
v_mfma_f32_16x16x32_bf16 v[88:91], a[132:135], a[116:119], v[88:91]
v_mfma_f32_16x16x32_bf16 v[92:95], a[128:131], a[120:123], 0
v_mfma_f32_16x16x32_bf16 v[92:95], a[132:135], a[124:127], v[92:95]
s_waitcnt lgkmcnt(0)
buffer_load_dwordx4 v6, s[20:23], s48 offen offset:2048 lds
v_mfma_f32_16x16x32_bf16 v[96:99], a[136:139], a[64:67], 0
ds_read_b64_tr_b16 a[128:129], v16 offset:0
v_mfma_f32_16x16x32_bf16 v[96:99], a[140:143], a[68:71], v[96:99]
ds_read_b64_tr_b16 a[130:131], v16 offset:2048
v_mfma_f32_16x16x32_bf16 v[100:103], a[136:139], a[72:75], 0
ds_read_b64_tr_b16 a[132:133], v16 offset:16384
buffer_load_dwordx4 v7, s[20:23], s48 offen offset:3072 lds
v_mfma_f32_16x16x32_bf16 v[100:103], a[140:143], a[76:79], v[100:103]
ds_read_b64_tr_b16 a[134:135], v16 offset:18432
s_add_u32 s48, s48, 128
v_mfma_f32_16x16x32_bf16 v[104:107], a[136:139], a[80:83], 0
v_add_u32 v16, s54, v16
s_add_u32 m0, s52, 4096
v_mfma_f32_16x16x32_bf16 v[104:107], a[140:143], a[84:87], v[104:107]
buffer_load_dwordx4 v4, s[20:23], s49 offen offset:0 lds
v_mfma_f32_16x16x32_bf16 v[108:111], a[136:139], a[88:91], 0
v_mfma_f32_16x16x32_bf16 v[108:111], a[140:143], a[92:95], v[108:111]
v_mfma_f32_16x16x32_bf16 v[112:115], a[136:139], a[96:99], 0
buffer_load_dwordx4 v5, s[20:23], s49 offen offset:1024 lds
v_mfma_f32_16x16x32_bf16 v[112:115], a[140:143], a[100:103], v[112:115]
v_mfma_f32_16x16x32_bf16 v[116:119], a[136:139], a[104:107], 0
v_mfma_f32_16x16x32_bf16 v[116:119], a[140:143], a[108:111], v[116:119]
buffer_load_dwordx4 v6, s[20:23], s49 offen offset:2048 lds
v_mfma_f32_16x16x32_bf16 v[120:123], a[136:139], a[112:115], 0
v_mfma_f32_16x16x32_bf16 v[120:123], a[140:143], a[116:119], v[120:123]
v_mfma_f32_16x16x32_bf16 v[124:127], a[136:139], a[120:123], 0
buffer_load_dwordx4 v7, s[20:23], s49 offen offset:3072 lds
v_mfma_f32_16x16x32_bf16 v[124:127], a[140:143], a[124:127], v[124:127]
s_waitcnt lgkmcnt(0)
s_add_u32 s49, s49, 128
v_mfma_f32_16x16x32_bf16 v[128:131], a[128:131], a[64:67], 0
ds_read_b64_tr_b16 a[136:137], v17 offset:0
s_mov_b32 m0, s53
v_mfma_f32_16x16x32_bf16 v[128:131], a[132:135], a[68:71], v[128:131]
ds_read_b64_tr_b16 a[138:139], v17 offset:2048
buffer_load_dwordx4 v8, s[24:27], s50 offen offset:0 lds
v_mfma_f32_16x16x32_bf16 v[132:135], a[128:131], a[72:75], 0
ds_read_b64_tr_b16 a[140:141], v17 offset:16384
v_mfma_f32_16x16x32_bf16 v[132:135], a[132:135], a[76:79], v[132:135]
ds_read_b64_tr_b16 a[142:143], v17 offset:18432
v_mfma_f32_16x16x32_bf16 v[136:139], a[128:131], a[80:83], 0
v_add_u32 v17, s54, v17
buffer_load_dwordx4 v9, s[24:27], s50 offen offset:1024 lds
v_mfma_f32_16x16x32_bf16 v[136:139], a[132:135], a[84:87], v[136:139]
v_mfma_f32_16x16x32_bf16 v[140:143], a[128:131], a[88:91], 0
v_mfma_f32_16x16x32_bf16 v[140:143], a[132:135], a[92:95], v[140:143]
buffer_load_dwordx4 v10, s[24:27], s50 offen offset:2048 lds
v_mfma_f32_16x16x32_bf16 v[144:147], a[128:131], a[96:99], 0
v_mfma_f32_16x16x32_bf16 v[144:147], a[132:135], a[100:103], v[144:147]
v_mfma_f32_16x16x32_bf16 v[148:151], a[128:131], a[104:107], 0
buffer_load_dwordx4 v11, s[24:27], s50 offen offset:3072 lds
v_mfma_f32_16x16x32_bf16 v[148:151], a[132:135], a[108:111], v[148:151]
s_add_u32 s50, s50, 524288
v_mfma_f32_16x16x32_bf16 v[152:155], a[128:131], a[112:115], 0
s_add_u32 m0, s53, 8192
v_mfma_f32_16x16x32_bf16 v[152:155], a[132:135], a[116:119], v[152:155]
buffer_load_dwordx4 v8, s[24:27], s51 offen offset:0 lds
v_mfma_f32_16x16x32_bf16 v[156:159], a[128:131], a[120:123], 0
v_mfma_f32_16x16x32_bf16 v[156:159], a[132:135], a[124:127], v[156:159]
s_waitcnt lgkmcnt(0)
v_mfma_f32_16x16x32_bf16 v[160:163], a[136:139], a[64:67], 0
ds_read_b64_tr_b16 a[128:129], v18 offset:0
buffer_load_dwordx4 v9, s[24:27], s51 offen offset:1024 lds
v_mfma_f32_16x16x32_bf16 v[160:163], a[140:143], a[68:71], v[160:163]
ds_read_b64_tr_b16 a[130:131], v18 offset:2048
v_mfma_f32_16x16x32_bf16 v[164:167], a[136:139], a[72:75], 0
ds_read_b64_tr_b16 a[132:133], v18 offset:16384
v_mfma_f32_16x16x32_bf16 v[164:167], a[140:143], a[76:79], v[164:167]
ds_read_b64_tr_b16 a[134:135], v18 offset:18432
buffer_load_dwordx4 v10, s[24:27], s51 offen offset:2048 lds
v_mfma_f32_16x16x32_bf16 v[168:171], a[136:139], a[80:83], 0
v_add_u32 v18, s54, v18
v_mfma_f32_16x16x32_bf16 v[168:171], a[140:143], a[84:87], v[168:171]
v_mfma_f32_16x16x32_bf16 v[172:175], a[136:139], a[88:91], 0
buffer_load_dwordx4 v11, s[24:27], s51 offen offset:3072 lds
v_mfma_f32_16x16x32_bf16 v[172:175], a[140:143], a[92:95], v[172:175]
s_add_u32 s51, s51, 524288
v_mfma_f32_16x16x32_bf16 v[176:179], a[136:139], a[96:99], 0
v_mfma_f32_16x16x32_bf16 v[176:179], a[140:143], a[100:103], v[176:179]
v_mfma_f32_16x16x32_bf16 v[180:183], a[136:139], a[104:107], 0
v_mfma_f32_16x16x32_bf16 v[180:183], a[140:143], a[108:111], v[180:183]
buffer_load_dword a255, v22, s[24:27], 0 offen
v_add_u32 v22, 524288, v22
v_mfma_f32_16x16x32_bf16 v[184:187], a[136:139], a[112:115], 0
buffer_load_dword a255, v23, s[20:23], 0 offen
v_add_u32 v23, 128, v23
v_mfma_f32_16x16x32_bf16 v[184:187], a[140:143], a[116:119], v[184:187]
s_cmp_lt_u32 s16, 8
s_cselect_b32 s46, s17, 0
s_cselect_b32 s6, 1408, 0
v_mfma_f32_16x16x32_bf16 v[188:191], a[136:139], a[120:123], 0
s_add_u32 s16, s16, 1
buffer_load_dword a255, v3, s[44:47], 0 offen
v_mfma_f32_16x16x32_bf16 v[188:191], a[140:143], a[124:127], v[188:191]
s_waitcnt lgkmcnt(0)
v_add_u32 v3, s6, v3
v_mfma_f32_16x16x32_bf16 v[192:195], a[128:131], a[64:67], 0
ds_read_b64_tr_b16 a[136:137], v19 offset:0
v_mfma_f32_16x16x32_bf16 v[192:195], a[132:135], a[68:71], v[192:195]
ds_read_b64_tr_b16 a[138:139], v19 offset:2048
v_mfma_f32_16x16x32_bf16 v[196:199], a[128:131], a[72:75], 0
ds_read_b64_tr_b16 a[140:141], v19 offset:16384
v_mfma_f32_16x16x32_bf16 v[196:199], a[132:135], a[76:79], v[196:199]
ds_read_b64_tr_b16 a[142:143], v19 offset:18432
v_mfma_f32_16x16x32_bf16 v[200:203], a[128:131], a[80:83], 0
v_add_u32 v19, s54, v19
v_mfma_f32_16x16x32_bf16 v[200:203], a[132:135], a[84:87], v[200:203]
v_mfma_f32_16x16x32_bf16 v[204:207], a[128:131], a[88:91], 0
v_mfma_f32_16x16x32_bf16 v[204:207], a[132:135], a[92:95], v[204:207]
v_mfma_f32_16x16x32_bf16 v[208:211], a[128:131], a[96:99], 0
v_mfma_f32_16x16x32_bf16 v[208:211], a[132:135], a[100:103], v[208:211]
v_mfma_f32_16x16x32_bf16 v[212:215], a[128:131], a[104:107], 0
v_mfma_f32_16x16x32_bf16 v[212:215], a[132:135], a[108:111], v[212:215]
s_cmp_eq_u32 s53, s69
s_cselect_b32 s54, s58, s59
v_mfma_f32_16x16x32_bf16 v[216:219], a[128:131], a[112:115], 0
s_add_u32 s53, s53, 32768
s_cmp_eq_u32 s53, s68
s_cselect_b32 s53, s69, s53
v_mfma_f32_16x16x32_bf16 v[216:219], a[132:135], a[116:119], v[216:219]
s_xor_b32 s52, s52, 0x38000
v_mfma_f32_16x16x32_bf16 v[220:223], a[128:131], a[120:123], 0
v_mfma_f32_16x16x32_bf16 v[220:223], a[132:135], a[124:127], v[220:223]
s_waitcnt vmcnt(19)
s_barrier
s_waitcnt lgkmcnt(0)
v_mfma_f32_16x16x32_bf16 v[224:227], a[136:139], a[64:67], 0
ds_read_b64_tr_b16 a[128:129], v12 offset:0
ds_read_b128 a[64:67], v20 offset:0
v_mfma_f32_16x16x32_bf16 v[224:227], a[140:143], a[68:71], v[224:227]
ds_read_b64_tr_b16 a[130:131], v12 offset:2048
ds_read_b128 a[68:71], v21 offset:0
v_mfma_f32_16x16x32_bf16 v[228:231], a[136:139], a[72:75], 0
ds_read_b64_tr_b16 a[132:133], v12 offset:16384
ds_read_b128 a[72:75], v20 offset:2048
v_mfma_f32_16x16x32_bf16 v[228:231], a[140:143], a[76:79], v[228:231]
ds_read_b64_tr_b16 a[134:135], v12 offset:18432
ds_read_b128 a[76:79], v21 offset:2048
v_mfma_f32_16x16x32_bf16 v[232:235], a[136:139], a[80:83], 0
v_add_u32 v12, s54, v12
ds_read_b128 a[80:83], v20 offset:4096
v_mfma_f32_16x16x32_bf16 v[232:235], a[140:143], a[84:87], v[232:235]
ds_read_b128 a[84:87], v21 offset:4096
v_mfma_f32_16x16x32_bf16 v[236:239], a[136:139], a[88:91], 0
ds_read_b128 a[88:91], v20 offset:6144
v_mfma_f32_16x16x32_bf16 v[236:239], a[140:143], a[92:95], v[236:239]
ds_read_b128 a[92:95], v21 offset:6144
v_mfma_f32_16x16x32_bf16 v[240:243], a[136:139], a[96:99], 0
ds_read_b128 a[96:99], v20 offset:8192
v_mfma_f32_16x16x32_bf16 v[240:243], a[140:143], a[100:103], v[240:243]
ds_read_b128 a[100:103], v21 offset:8192
v_mfma_f32_16x16x32_bf16 v[244:247], a[136:139], a[104:107], 0
ds_read_b128 a[104:107], v20 offset:10240
v_mfma_f32_16x16x32_bf16 v[244:247], a[140:143], a[108:111], v[244:247]
ds_read_b128 a[108:111], v21 offset:10240
v_mfma_f32_16x16x32_bf16 v[248:251], a[136:139], a[112:115], 0
ds_read_b128 a[112:115], v20 offset:12288
v_mfma_f32_16x16x32_bf16 v[248:251], a[140:143], a[116:119], v[248:251]
ds_read_b128 a[116:119], v21 offset:12288
v_mfma_f32_16x16x32_bf16 v[252:255], a[136:139], a[120:123], 0
ds_read_b128 a[120:123], v20 offset:14336
v_mfma_f32_16x16x32_bf16 v[252:255], a[140:143], a[124:127], v[252:255]
ds_read_b128 a[124:127], v21 offset:14336
v_xor_b32 v20, 0x38000, v20
v_xor_b32 v21, 0x38000, v21
s_mov_b32 s56, 8
kv_loop0:
s_waitcnt lgkmcnt(12)
v_mfma_f32_16x16x32_bf16 a[0:3], a[128:131], a[64:67], a[0:3]
ds_read_b64_tr_b16 a[136:137], v13 offset:0
v_mfma_f32_16x16x32_bf16 a[0:3], a[132:135], a[68:71], a[0:3]
ds_read_b64_tr_b16 a[138:139], v13 offset:2048
v_mfma_f32_16x16x32_bf16 a[4:7], a[128:131], a[72:75], a[4:7]
ds_read_b64_tr_b16 a[140:141], v13 offset:16384
v_mfma_f32_16x16x32_bf16 a[4:7], a[132:135], a[76:79], a[4:7]
s_waitcnt lgkmcnt(11)
ds_read_b64_tr_b16 a[142:143], v13 offset:18432
v_mfma_f32_16x16x32_bf16 a[8:11], a[128:131], a[80:83], a[8:11]
v_add_u32 v13, s54, v13
v_mfma_f32_16x16x32_bf16 a[8:11], a[132:135], a[84:87], a[8:11]
v_mfma_f32_16x16x32_bf16 a[12:15], a[128:131], a[88:91], a[12:15]
v_mfma_f32_16x16x32_bf16 a[12:15], a[132:135], a[92:95], a[12:15]
s_waitcnt lgkmcnt(8)
v_mfma_f32_16x16x32_bf16 a[16:19], a[128:131], a[96:99], a[16:19]
v_mfma_f32_16x16x32_bf16 a[16:19], a[132:135], a[100:103], a[16:19]
v_mfma_f32_16x16x32_bf16 a[20:23], a[128:131], a[104:107], a[20:23]
v_mfma_f32_16x16x32_bf16 a[20:23], a[132:135], a[108:111], a[20:23]
s_waitcnt lgkmcnt(4)
v_mfma_f32_16x16x32_bf16 a[24:27], a[128:131], a[112:115], a[24:27]
v_mfma_f32_16x16x32_bf16 a[24:27], a[132:135], a[116:119], a[24:27]
v_mfma_f32_16x16x32_bf16 a[28:31], a[128:131], a[120:123], a[28:31]
v_mfma_f32_16x16x32_bf16 a[28:31], a[132:135], a[124:127], a[28:31]
s_waitcnt lgkmcnt(0)
s_barrier
v_mfma_f32_16x16x32_bf16 a[32:35], a[136:139], a[64:67], a[32:35]
ds_read_b64_tr_b16 a[128:129], v14 offset:0
v_mfma_f32_16x16x32_bf16 a[32:35], a[140:143], a[68:71], a[32:35]
ds_read_b64_tr_b16 a[130:131], v14 offset:2048
v_mfma_f32_16x16x32_bf16 a[36:39], a[136:139], a[72:75], a[36:39]
ds_read_b64_tr_b16 a[132:133], v14 offset:16384
v_mfma_f32_16x16x32_bf16 a[36:39], a[140:143], a[76:79], a[36:39]
ds_read_b64_tr_b16 a[134:135], v14 offset:18432
v_mfma_f32_16x16x32_bf16 a[40:43], a[136:139], a[80:83], a[40:43]
v_add_u32 v14, s54, v14
s_mov_b32 m0, s52
v_mfma_f32_16x16x32_bf16 a[40:43], a[140:143], a[84:87], a[40:43]
buffer_load_dwordx4 v4, s[20:23], s48 offen offset:0 lds
v_mfma_f32_16x16x32_bf16 a[44:47], a[136:139], a[88:91], a[44:47]
v_mfma_f32_16x16x32_bf16 a[44:47], a[140:143], a[92:95], a[44:47]
v_mfma_f32_16x16x32_bf16 a[48:51], a[136:139], a[96:99], a[48:51]
v_mfma_f32_16x16x32_bf16 a[48:51], a[140:143], a[100:103], a[48:51]
buffer_load_dwordx4 v5, s[20:23], s48 offen offset:1024 lds
v_mfma_f32_16x16x32_bf16 a[52:55], a[136:139], a[104:107], a[52:55]
v_mfma_f32_16x16x32_bf16 a[52:55], a[140:143], a[108:111], a[52:55]
v_mfma_f32_16x16x32_bf16 a[56:59], a[136:139], a[112:115], a[56:59]
v_mfma_f32_16x16x32_bf16 a[56:59], a[140:143], a[116:119], a[56:59]
buffer_load_dwordx4 v6, s[20:23], s48 offen offset:2048 lds
v_mfma_f32_16x16x32_bf16 a[60:63], a[136:139], a[120:123], a[60:63]
v_mfma_f32_16x16x32_bf16 a[60:63], a[140:143], a[124:127], a[60:63]
s_waitcnt lgkmcnt(0)
v_mfma_f32_16x16x32_bf16 v[64:67], a[128:131], a[64:67], v[64:67]
ds_read_b64_tr_b16 a[136:137], v15 offset:0
v_mfma_f32_16x16x32_bf16 v[64:67], a[132:135], a[68:71], v[64:67]
ds_read_b64_tr_b16 a[138:139], v15 offset:2048
buffer_load_dwordx4 v7, s[20:23], s48 offen offset:3072 lds
v_mfma_f32_16x16x32_bf16 v[68:71], a[128:131], a[72:75], v[68:71]
ds_read_b64_tr_b16 a[140:141], v15 offset:16384
s_add_u32 s48, s48, 128
v_mfma_f32_16x16x32_bf16 v[68:71], a[132:135], a[76:79], v[68:71]
ds_read_b64_tr_b16 a[142:143], v15 offset:18432
v_mfma_f32_16x16x32_bf16 v[72:75], a[128:131], a[80:83], v[72:75]
v_add_u32 v15, s54, v15
s_add_u32 m0, s52, 4096
v_mfma_f32_16x16x32_bf16 v[72:75], a[132:135], a[84:87], v[72:75]
buffer_load_dwordx4 v4, s[20:23], s49 offen offset:0 lds
v_mfma_f32_16x16x32_bf16 v[76:79], a[128:131], a[88:91], v[76:79]
v_mfma_f32_16x16x32_bf16 v[76:79], a[132:135], a[92:95], v[76:79]
v_mfma_f32_16x16x32_bf16 v[80:83], a[128:131], a[96:99], v[80:83]
v_mfma_f32_16x16x32_bf16 v[80:83], a[132:135], a[100:103], v[80:83]
buffer_load_dwordx4 v5, s[20:23], s49 offen offset:1024 lds
v_mfma_f32_16x16x32_bf16 v[84:87], a[128:131], a[104:107], v[84:87]
v_mfma_f32_16x16x32_bf16 v[84:87], a[132:135], a[108:111], v[84:87]
v_mfma_f32_16x16x32_bf16 v[88:91], a[128:131], a[112:115], v[88:91]
v_mfma_f32_16x16x32_bf16 v[88:91], a[132:135], a[116:119], v[88:91]
buffer_load_dwordx4 v6, s[20:23], s49 offen offset:2048 lds
v_mfma_f32_16x16x32_bf16 v[92:95], a[128:131], a[120:123], v[92:95]
v_mfma_f32_16x16x32_bf16 v[92:95], a[132:135], a[124:127], v[92:95]
s_waitcnt lgkmcnt(0)
v_mfma_f32_16x16x32_bf16 v[96:99], a[136:139], a[64:67], v[96:99]
ds_read_b64_tr_b16 a[128:129], v16 offset:0
v_mfma_f32_16x16x32_bf16 v[96:99], a[140:143], a[68:71], v[96:99]
ds_read_b64_tr_b16 a[130:131], v16 offset:2048
buffer_load_dwordx4 v7, s[20:23], s49 offen offset:3072 lds
v_mfma_f32_16x16x32_bf16 v[100:103], a[136:139], a[72:75], v[100:103]
ds_read_b64_tr_b16 a[132:133], v16 offset:16384
s_add_u32 s49, s49, 128
v_mfma_f32_16x16x32_bf16 v[100:103], a[140:143], a[76:79], v[100:103]
ds_read_b64_tr_b16 a[134:135], v16 offset:18432
v_mfma_f32_16x16x32_bf16 v[104:107], a[136:139], a[80:83], v[104:107]
v_add_u32 v16, s54, v16
s_mov_b32 m0, s53
v_mfma_f32_16x16x32_bf16 v[104:107], a[140:143], a[84:87], v[104:107]
buffer_load_dwordx4 v8, s[24:27], s50 offen offset:0 lds
v_mfma_f32_16x16x32_bf16 v[108:111], a[136:139], a[88:91], v[108:111]
v_mfma_f32_16x16x32_bf16 v[108:111], a[140:143], a[92:95], v[108:111]
v_mfma_f32_16x16x32_bf16 v[112:115], a[136:139], a[96:99], v[112:115]
v_mfma_f32_16x16x32_bf16 v[112:115], a[140:143], a[100:103], v[112:115]
buffer_load_dwordx4 v9, s[24:27], s50 offen offset:1024 lds
v_mfma_f32_16x16x32_bf16 v[116:119], a[136:139], a[104:107], v[116:119]
v_mfma_f32_16x16x32_bf16 v[116:119], a[140:143], a[108:111], v[116:119]
v_mfma_f32_16x16x32_bf16 v[120:123], a[136:139], a[112:115], v[120:123]
v_mfma_f32_16x16x32_bf16 v[120:123], a[140:143], a[116:119], v[120:123]
buffer_load_dwordx4 v10, s[24:27], s50 offen offset:2048 lds
v_mfma_f32_16x16x32_bf16 v[124:127], a[136:139], a[120:123], v[124:127]
v_mfma_f32_16x16x32_bf16 v[124:127], a[140:143], a[124:127], v[124:127]
s_waitcnt lgkmcnt(0)
v_mfma_f32_16x16x32_bf16 v[128:131], a[128:131], a[64:67], v[128:131]
ds_read_b64_tr_b16 a[136:137], v17 offset:0
v_mfma_f32_16x16x32_bf16 v[128:131], a[132:135], a[68:71], v[128:131]
ds_read_b64_tr_b16 a[138:139], v17 offset:2048
buffer_load_dwordx4 v11, s[24:27], s50 offen offset:3072 lds
v_mfma_f32_16x16x32_bf16 v[132:135], a[128:131], a[72:75], v[132:135]
ds_read_b64_tr_b16 a[140:141], v17 offset:16384
s_add_u32 s50, s50, 524288
v_mfma_f32_16x16x32_bf16 v[132:135], a[132:135], a[76:79], v[132:135]
ds_read_b64_tr_b16 a[142:143], v17 offset:18432
v_mfma_f32_16x16x32_bf16 v[136:139], a[128:131], a[80:83], v[136:139]
v_add_u32 v17, s54, v17
s_add_u32 m0, s53, 8192
v_mfma_f32_16x16x32_bf16 v[136:139], a[132:135], a[84:87], v[136:139]
buffer_load_dwordx4 v8, s[24:27], s51 offen offset:0 lds
v_mfma_f32_16x16x32_bf16 v[140:143], a[128:131], a[88:91], v[140:143]
v_mfma_f32_16x16x32_bf16 v[140:143], a[132:135], a[92:95], v[140:143]
v_mfma_f32_16x16x32_bf16 v[144:147], a[128:131], a[96:99], v[144:147]
v_mfma_f32_16x16x32_bf16 v[144:147], a[132:135], a[100:103], v[144:147]
buffer_load_dwordx4 v9, s[24:27], s51 offen offset:1024 lds
v_mfma_f32_16x16x32_bf16 v[148:151], a[128:131], a[104:107], v[148:151]
v_mfma_f32_16x16x32_bf16 v[148:151], a[132:135], a[108:111], v[148:151]
v_mfma_f32_16x16x32_bf16 v[152:155], a[128:131], a[112:115], v[152:155]
v_mfma_f32_16x16x32_bf16 v[152:155], a[132:135], a[116:119], v[152:155]
buffer_load_dwordx4 v10, s[24:27], s51 offen offset:2048 lds
v_mfma_f32_16x16x32_bf16 v[156:159], a[128:131], a[120:123], v[156:159]
v_mfma_f32_16x16x32_bf16 v[156:159], a[132:135], a[124:127], v[156:159]
s_waitcnt lgkmcnt(0)
v_mfma_f32_16x16x32_bf16 v[160:163], a[136:139], a[64:67], v[160:163]
ds_read_b64_tr_b16 a[128:129], v18 offset:0
v_mfma_f32_16x16x32_bf16 v[160:163], a[140:143], a[68:71], v[160:163]
ds_read_b64_tr_b16 a[130:131], v18 offset:2048
buffer_load_dwordx4 v11, s[24:27], s51 offen offset:3072 lds
v_mfma_f32_16x16x32_bf16 v[164:167], a[136:139], a[72:75], v[164:167]
ds_read_b64_tr_b16 a[132:133], v18 offset:16384
s_add_u32 s51, s51, 524288
v_mfma_f32_16x16x32_bf16 v[164:167], a[140:143], a[76:79], v[164:167]
ds_read_b64_tr_b16 a[134:135], v18 offset:18432
v_mfma_f32_16x16x32_bf16 v[168:171], a[136:139], a[80:83], v[168:171]
v_add_u32 v18, s54, v18
v_mfma_f32_16x16x32_bf16 v[168:171], a[140:143], a[84:87], v[168:171]
v_mfma_f32_16x16x32_bf16 v[172:175], a[136:139], a[88:91], v[172:175]
v_mfma_f32_16x16x32_bf16 v[172:175], a[140:143], a[92:95], v[172:175]
v_mfma_f32_16x16x32_bf16 v[176:179], a[136:139], a[96:99], v[176:179]
v_mfma_f32_16x16x32_bf16 v[176:179], a[140:143], a[100:103], v[176:179]
v_mfma_f32_16x16x32_bf16 v[180:183], a[136:139], a[104:107], v[180:183]
v_mfma_f32_16x16x32_bf16 v[180:183], a[140:143], a[108:111], v[180:183]
buffer_load_dword a255, v22, s[24:27], 0 offen
v_add_u32 v22, 524288, v22
v_mfma_f32_16x16x32_bf16 v[184:187], a[136:139], a[112:115], v[184:187]
buffer_load_dword a255, v23, s[20:23], 0 offen
v_add_u32 v23, 128, v23
v_mfma_f32_16x16x32_bf16 v[184:187], a[140:143], a[116:119], v[184:187]
s_cmp_lt_u32 s16, 8
s_cselect_b32 s46, s17, 0
s_cselect_b32 s6, 1408, 0
v_mfma_f32_16x16x32_bf16 v[188:191], a[136:139], a[120:123], v[188:191]
s_add_u32 s16, s16, 1
buffer_load_dword a255, v3, s[44:47], 0 offen
v_mfma_f32_16x16x32_bf16 v[188:191], a[140:143], a[124:127], v[188:191]
s_waitcnt lgkmcnt(0)
v_add_u32 v3, s6, v3
v_mfma_f32_16x16x32_bf16 v[192:195], a[128:131], a[64:67], v[192:195]
ds_read_b64_tr_b16 a[136:137], v19 offset:0
v_mfma_f32_16x16x32_bf16 v[192:195], a[132:135], a[68:71], v[192:195]
ds_read_b64_tr_b16 a[138:139], v19 offset:2048
v_mfma_f32_16x16x32_bf16 v[196:199], a[128:131], a[72:75], v[196:199]
ds_read_b64_tr_b16 a[140:141], v19 offset:16384
v_mfma_f32_16x16x32_bf16 v[196:199], a[132:135], a[76:79], v[196:199]
ds_read_b64_tr_b16 a[142:143], v19 offset:18432
v_mfma_f32_16x16x32_bf16 v[200:203], a[128:131], a[80:83], v[200:203]
v_add_u32 v19, s54, v19
v_mfma_f32_16x16x32_bf16 v[200:203], a[132:135], a[84:87], v[200:203]
v_mfma_f32_16x16x32_bf16 v[204:207], a[128:131], a[88:91], v[204:207]
v_mfma_f32_16x16x32_bf16 v[204:207], a[132:135], a[92:95], v[204:207]
v_mfma_f32_16x16x32_bf16 v[208:211], a[128:131], a[96:99], v[208:211]
v_mfma_f32_16x16x32_bf16 v[208:211], a[132:135], a[100:103], v[208:211]
v_mfma_f32_16x16x32_bf16 v[212:215], a[128:131], a[104:107], v[212:215]
v_mfma_f32_16x16x32_bf16 v[212:215], a[132:135], a[108:111], v[212:215]
s_cmp_eq_u32 s53, s69
s_cselect_b32 s54, s58, s59
v_mfma_f32_16x16x32_bf16 v[216:219], a[128:131], a[112:115], v[216:219]
s_add_u32 s53, s53, 32768
s_cmp_eq_u32 s53, s68
s_cselect_b32 s53, s69, s53
v_mfma_f32_16x16x32_bf16 v[216:219], a[132:135], a[116:119], v[216:219]
s_xor_b32 s52, s52, 0x38000
v_mfma_f32_16x16x32_bf16 v[220:223], a[128:131], a[120:123], v[220:223]
v_mfma_f32_16x16x32_bf16 v[220:223], a[132:135], a[124:127], v[220:223]
s_waitcnt vmcnt(22)
s_barrier
s_waitcnt lgkmcnt(0)
v_mfma_f32_16x16x32_bf16 v[224:227], a[136:139], a[64:67], v[224:227]
ds_read_b64_tr_b16 a[128:129], v12 offset:0
ds_read_b128 a[64:67], v20 offset:0
v_mfma_f32_16x16x32_bf16 v[224:227], a[140:143], a[68:71], v[224:227]
ds_read_b64_tr_b16 a[130:131], v12 offset:2048
ds_read_b128 a[68:71], v21 offset:0
v_mfma_f32_16x16x32_bf16 v[228:231], a[136:139], a[72:75], v[228:231]
ds_read_b64_tr_b16 a[132:133], v12 offset:16384
ds_read_b128 a[72:75], v20 offset:2048
v_mfma_f32_16x16x32_bf16 v[228:231], a[140:143], a[76:79], v[228:231]
ds_read_b64_tr_b16 a[134:135], v12 offset:18432
ds_read_b128 a[76:79], v21 offset:2048
v_mfma_f32_16x16x32_bf16 v[232:235], a[136:139], a[80:83], v[232:235]
v_add_u32 v12, s54, v12
ds_read_b128 a[80:83], v20 offset:4096
v_mfma_f32_16x16x32_bf16 v[232:235], a[140:143], a[84:87], v[232:235]
ds_read_b128 a[84:87], v21 offset:4096
v_mfma_f32_16x16x32_bf16 v[236:239], a[136:139], a[88:91], v[236:239]
ds_read_b128 a[88:91], v20 offset:6144
v_mfma_f32_16x16x32_bf16 v[236:239], a[140:143], a[92:95], v[236:239]
ds_read_b128 a[92:95], v21 offset:6144
v_mfma_f32_16x16x32_bf16 v[240:243], a[136:139], a[96:99], v[240:243]
ds_read_b128 a[96:99], v20 offset:8192
v_mfma_f32_16x16x32_bf16 v[240:243], a[140:143], a[100:103], v[240:243]
ds_read_b128 a[100:103], v21 offset:8192
v_mfma_f32_16x16x32_bf16 v[244:247], a[136:139], a[104:107], v[244:247]
ds_read_b128 a[104:107], v20 offset:10240
v_mfma_f32_16x16x32_bf16 v[244:247], a[140:143], a[108:111], v[244:247]
ds_read_b128 a[108:111], v21 offset:10240
v_mfma_f32_16x16x32_bf16 v[248:251], a[136:139], a[112:115], v[248:251]
ds_read_b128 a[112:115], v20 offset:12288
v_mfma_f32_16x16x32_bf16 v[248:251], a[140:143], a[116:119], v[248:251]
ds_read_b128 a[116:119], v21 offset:12288
v_mfma_f32_16x16x32_bf16 v[252:255], a[136:139], a[120:123], v[252:255]
ds_read_b128 a[120:123], v20 offset:14336
v_mfma_f32_16x16x32_bf16 v[252:255], a[140:143], a[124:127], v[252:255]
ds_read_b128 a[124:127], v21 offset:14336
v_xor_b32 v20, 0x38000, v20
v_xor_b32 v21, 0x38000, v21
s_sub_u32 s56, s56, 1
s_cmp_lg_u32 s56, 0
s_cbranch_scc1 kv_loop0
s_waitcnt lgkmcnt(12)
v_mfma_f32_16x16x32_bf16 a[0:3], a[128:131], a[64:67], a[0:3]
ds_read_b64_tr_b16 a[136:137], v13 offset:0
v_mfma_f32_16x16x32_bf16 a[0:3], a[132:135], a[68:71], a[0:3]
ds_read_b64_tr_b16 a[138:139], v13 offset:2048
v_mfma_f32_16x16x32_bf16 a[4:7], a[128:131], a[72:75], a[4:7]
ds_read_b64_tr_b16 a[140:141], v13 offset:16384
v_mfma_f32_16x16x32_bf16 a[4:7], a[132:135], a[76:79], a[4:7]
s_waitcnt lgkmcnt(11)
ds_read_b64_tr_b16 a[142:143], v13 offset:18432
v_mfma_f32_16x16x32_bf16 a[8:11], a[128:131], a[80:83], a[8:11]
v_add_u32 v13, s54, v13
v_mfma_f32_16x16x32_bf16 a[8:11], a[132:135], a[84:87], a[8:11]
v_mfma_f32_16x16x32_bf16 a[12:15], a[128:131], a[88:91], a[12:15]
v_mfma_f32_16x16x32_bf16 a[12:15], a[132:135], a[92:95], a[12:15]
s_waitcnt lgkmcnt(8)
v_mfma_f32_16x16x32_bf16 a[16:19], a[128:131], a[96:99], a[16:19]
v_mfma_f32_16x16x32_bf16 a[16:19], a[132:135], a[100:103], a[16:19]
v_mfma_f32_16x16x32_bf16 a[20:23], a[128:131], a[104:107], a[20:23]
v_mfma_f32_16x16x32_bf16 a[20:23], a[132:135], a[108:111], a[20:23]
s_waitcnt lgkmcnt(4)
v_mfma_f32_16x16x32_bf16 a[24:27], a[128:131], a[112:115], a[24:27]
v_mfma_f32_16x16x32_bf16 a[24:27], a[132:135], a[116:119], a[24:27]
v_mfma_f32_16x16x32_bf16 a[28:31], a[128:131], a[120:123], a[28:31]
v_mfma_f32_16x16x32_bf16 a[28:31], a[132:135], a[124:127], a[28:31]
s_waitcnt lgkmcnt(0)
s_barrier
v_mfma_f32_16x16x32_bf16 a[32:35], a[136:139], a[64:67], a[32:35]
ds_read_b64_tr_b16 a[128:129], v14 offset:0
v_mfma_f32_16x16x32_bf16 a[32:35], a[140:143], a[68:71], a[32:35]
ds_read_b64_tr_b16 a[130:131], v14 offset:2048
v_mfma_f32_16x16x32_bf16 a[36:39], a[136:139], a[72:75], a[36:39]
ds_read_b64_tr_b16 a[132:133], v14 offset:16384
v_mfma_f32_16x16x32_bf16 a[36:39], a[140:143], a[76:79], a[36:39]
ds_read_b64_tr_b16 a[134:135], v14 offset:18432
v_mfma_f32_16x16x32_bf16 a[40:43], a[136:139], a[80:83], a[40:43]
v_add_u32 v14, s54, v14
s_mov_b32 m0, s52
v_mfma_f32_16x16x32_bf16 a[40:43], a[140:143], a[84:87], a[40:43]
buffer_load_dwordx4 v4, s[20:23], s48 offen offset:0 lds
v_mfma_f32_16x16x32_bf16 a[44:47], a[136:139], a[88:91], a[44:47]
v_mfma_f32_16x16x32_bf16 a[44:47], a[140:143], a[92:95], a[44:47]
v_mfma_f32_16x16x32_bf16 a[48:51], a[136:139], a[96:99], a[48:51]
v_mfma_f32_16x16x32_bf16 a[48:51], a[140:143], a[100:103], a[48:51]
buffer_load_dwordx4 v5, s[20:23], s48 offen offset:1024 lds
v_mfma_f32_16x16x32_bf16 a[52:55], a[136:139], a[104:107], a[52:55]
v_mfma_f32_16x16x32_bf16 a[52:55], a[140:143], a[108:111], a[52:55]
v_mfma_f32_16x16x32_bf16 a[56:59], a[136:139], a[112:115], a[56:59]
v_mfma_f32_16x16x32_bf16 a[56:59], a[140:143], a[116:119], a[56:59]
buffer_load_dwordx4 v6, s[20:23], s48 offen offset:2048 lds
v_mfma_f32_16x16x32_bf16 a[60:63], a[136:139], a[120:123], a[60:63]
v_mfma_f32_16x16x32_bf16 a[60:63], a[140:143], a[124:127], a[60:63]
s_waitcnt lgkmcnt(0)
v_mfma_f32_16x16x32_bf16 v[64:67], a[128:131], a[64:67], v[64:67]
ds_read_b64_tr_b16 a[136:137], v15 offset:0
v_mfma_f32_16x16x32_bf16 v[64:67], a[132:135], a[68:71], v[64:67]
ds_read_b64_tr_b16 a[138:139], v15 offset:2048
buffer_load_dwordx4 v7, s[20:23], s48 offen offset:3072 lds
v_mfma_f32_16x16x32_bf16 v[68:71], a[128:131], a[72:75], v[68:71]
ds_read_b64_tr_b16 a[140:141], v15 offset:16384
s_add_u32 s48, s48, 128
v_mfma_f32_16x16x32_bf16 v[68:71], a[132:135], a[76:79], v[68:71]
ds_read_b64_tr_b16 a[142:143], v15 offset:18432
v_mfma_f32_16x16x32_bf16 v[72:75], a[128:131], a[80:83], v[72:75]
v_add_u32 v15, s54, v15
s_add_u32 m0, s52, 4096
v_mfma_f32_16x16x32_bf16 v[72:75], a[132:135], a[84:87], v[72:75]
buffer_load_dwordx4 v4, s[20:23], s49 offen offset:0 lds
v_mfma_f32_16x16x32_bf16 v[76:79], a[128:131], a[88:91], v[76:79]
v_mfma_f32_16x16x32_bf16 v[76:79], a[132:135], a[92:95], v[76:79]
v_mfma_f32_16x16x32_bf16 v[80:83], a[128:131], a[96:99], v[80:83]
v_mfma_f32_16x16x32_bf16 v[80:83], a[132:135], a[100:103], v[80:83]
buffer_load_dwordx4 v5, s[20:23], s49 offen offset:1024 lds
v_mfma_f32_16x16x32_bf16 v[84:87], a[128:131], a[104:107], v[84:87]
v_mfma_f32_16x16x32_bf16 v[84:87], a[132:135], a[108:111], v[84:87]
v_mfma_f32_16x16x32_bf16 v[88:91], a[128:131], a[112:115], v[88:91]
v_mfma_f32_16x16x32_bf16 v[88:91], a[132:135], a[116:119], v[88:91]
buffer_load_dwordx4 v6, s[20:23], s49 offen offset:2048 lds
v_mfma_f32_16x16x32_bf16 v[92:95], a[128:131], a[120:123], v[92:95]
v_mfma_f32_16x16x32_bf16 v[92:95], a[132:135], a[124:127], v[92:95]
s_waitcnt lgkmcnt(0)
v_mfma_f32_16x16x32_bf16 v[96:99], a[136:139], a[64:67], v[96:99]
ds_read_b64_tr_b16 a[128:129], v16 offset:0
v_mfma_f32_16x16x32_bf16 v[96:99], a[140:143], a[68:71], v[96:99]
ds_read_b64_tr_b16 a[130:131], v16 offset:2048
buffer_load_dwordx4 v7, s[20:23], s49 offen offset:3072 lds
v_mfma_f32_16x16x32_bf16 v[100:103], a[136:139], a[72:75], v[100:103]
ds_read_b64_tr_b16 a[132:133], v16 offset:16384
s_add_u32 s49, s49, 128
v_mfma_f32_16x16x32_bf16 v[100:103], a[140:143], a[76:79], v[100:103]
ds_read_b64_tr_b16 a[134:135], v16 offset:18432
v_mfma_f32_16x16x32_bf16 v[104:107], a[136:139], a[80:83], v[104:107]
v_add_u32 v16, s54, v16
s_mov_b32 m0, s53
v_mfma_f32_16x16x32_bf16 v[104:107], a[140:143], a[84:87], v[104:107]
buffer_load_dwordx4 v8, s[24:27], s50 offen offset:0 lds
v_mfma_f32_16x16x32_bf16 v[108:111], a[136:139], a[88:91], v[108:111]
v_mfma_f32_16x16x32_bf16 v[108:111], a[140:143], a[92:95], v[108:111]
v_mfma_f32_16x16x32_bf16 v[112:115], a[136:139], a[96:99], v[112:115]
v_mfma_f32_16x16x32_bf16 v[112:115], a[140:143], a[100:103], v[112:115]
buffer_load_dwordx4 v9, s[24:27], s50 offen offset:1024 lds
v_mfma_f32_16x16x32_bf16 v[116:119], a[136:139], a[104:107], v[116:119]
v_mfma_f32_16x16x32_bf16 v[116:119], a[140:143], a[108:111], v[116:119]
v_mfma_f32_16x16x32_bf16 v[120:123], a[136:139], a[112:115], v[120:123]
v_mfma_f32_16x16x32_bf16 v[120:123], a[140:143], a[116:119], v[120:123]
buffer_load_dwordx4 v10, s[24:27], s50 offen offset:2048 lds
v_mfma_f32_16x16x32_bf16 v[124:127], a[136:139], a[120:123], v[124:127]
v_mfma_f32_16x16x32_bf16 v[124:127], a[140:143], a[124:127], v[124:127]
s_waitcnt lgkmcnt(0)
v_mfma_f32_16x16x32_bf16 v[128:131], a[128:131], a[64:67], v[128:131]
ds_read_b64_tr_b16 a[136:137], v17 offset:0
v_mfma_f32_16x16x32_bf16 v[128:131], a[132:135], a[68:71], v[128:131]
ds_read_b64_tr_b16 a[138:139], v17 offset:2048
buffer_load_dwordx4 v11, s[24:27], s50 offen offset:3072 lds
v_mfma_f32_16x16x32_bf16 v[132:135], a[128:131], a[72:75], v[132:135]
ds_read_b64_tr_b16 a[140:141], v17 offset:16384
s_add_u32 s50, s50, 524288
v_mfma_f32_16x16x32_bf16 v[132:135], a[132:135], a[76:79], v[132:135]
ds_read_b64_tr_b16 a[142:143], v17 offset:18432
v_mfma_f32_16x16x32_bf16 v[136:139], a[128:131], a[80:83], v[136:139]
v_add_u32 v17, s54, v17
s_add_u32 m0, s53, 8192
v_mfma_f32_16x16x32_bf16 v[136:139], a[132:135], a[84:87], v[136:139]
buffer_load_dwordx4 v8, s[24:27], s51 offen offset:0 lds
v_mfma_f32_16x16x32_bf16 v[140:143], a[128:131], a[88:91], v[140:143]
v_mfma_f32_16x16x32_bf16 v[140:143], a[132:135], a[92:95], v[140:143]
v_mfma_f32_16x16x32_bf16 v[144:147], a[128:131], a[96:99], v[144:147]
v_mfma_f32_16x16x32_bf16 v[144:147], a[132:135], a[100:103], v[144:147]
buffer_load_dwordx4 v9, s[24:27], s51 offen offset:1024 lds
v_mfma_f32_16x16x32_bf16 v[148:151], a[128:131], a[104:107], v[148:151]
v_mfma_f32_16x16x32_bf16 v[148:151], a[132:135], a[108:111], v[148:151]
v_mfma_f32_16x16x32_bf16 v[152:155], a[128:131], a[112:115], v[152:155]
v_mfma_f32_16x16x32_bf16 v[152:155], a[132:135], a[116:119], v[152:155]
buffer_load_dwordx4 v10, s[24:27], s51 offen offset:2048 lds
v_mfma_f32_16x16x32_bf16 v[156:159], a[128:131], a[120:123], v[156:159]
v_mfma_f32_16x16x32_bf16 v[156:159], a[132:135], a[124:127], v[156:159]
s_waitcnt lgkmcnt(0)
v_mfma_f32_16x16x32_bf16 v[160:163], a[136:139], a[64:67], v[160:163]
ds_read_b64_tr_b16 a[128:129], v18 offset:0
v_mfma_f32_16x16x32_bf16 v[160:163], a[140:143], a[68:71], v[160:163]
ds_read_b64_tr_b16 a[130:131], v18 offset:2048
buffer_load_dwordx4 v11, s[24:27], s51 offen offset:3072 lds
v_mfma_f32_16x16x32_bf16 v[164:167], a[136:139], a[72:75], v[164:167]
ds_read_b64_tr_b16 a[132:133], v18 offset:16384
s_add_u32 s51, s51, 524288
v_mfma_f32_16x16x32_bf16 v[164:167], a[140:143], a[76:79], v[164:167]
ds_read_b64_tr_b16 a[134:135], v18 offset:18432
v_mfma_f32_16x16x32_bf16 v[168:171], a[136:139], a[80:83], v[168:171]
v_add_u32 v18, s54, v18
v_mfma_f32_16x16x32_bf16 v[168:171], a[140:143], a[84:87], v[168:171]
v_mfma_f32_16x16x32_bf16 v[172:175], a[136:139], a[88:91], v[172:175]
v_mfma_f32_16x16x32_bf16 v[172:175], a[140:143], a[92:95], v[172:175]
v_mfma_f32_16x16x32_bf16 v[176:179], a[136:139], a[96:99], v[176:179]
v_mfma_f32_16x16x32_bf16 v[176:179], a[140:143], a[100:103], v[176:179]
v_mfma_f32_16x16x32_bf16 v[180:183], a[136:139], a[104:107], v[180:183]
v_mfma_f32_16x16x32_bf16 v[180:183], a[140:143], a[108:111], v[180:183]
v_lshlrev_b32 v30, 12, v1
buffer_load_dword v31, v30, s[8:11], 0 offen offset:4 sc1
v_mfma_f32_16x16x32_bf16 v[184:187], a[136:139], a[112:115], v[184:187]
buffer_load_dword a255, v22, s[24:27], 0 offen
v_add_u32 v22, 524288, v22
v_mfma_f32_16x16x32_bf16 v[184:187], a[140:143], a[116:119], v[184:187]
buffer_load_dword a255, v23, s[20:23], 0 offen
v_add_u32 v23, 128, v23
v_mfma_f32_16x16x32_bf16 v[188:191], a[136:139], a[120:123], v[188:191]
s_cmp_lt_u32 s16, 8
s_cselect_b32 s46, s17, 0
s_cselect_b32 s6, 1408, 0
v_mfma_f32_16x16x32_bf16 v[188:191], a[140:143], a[124:127], v[188:191]
s_waitcnt lgkmcnt(0)
s_add_u32 s16, s16, 1
v_mfma_f32_16x16x32_bf16 v[192:195], a[128:131], a[64:67], v[192:195]
ds_read_b64_tr_b16 a[136:137], v19 offset:0
buffer_load_dword a255, v3, s[44:47], 0 offen
v_mfma_f32_16x16x32_bf16 v[192:195], a[132:135], a[68:71], v[192:195]
ds_read_b64_tr_b16 a[138:139], v19 offset:2048
v_add_u32 v3, s6, v3
v_mfma_f32_16x16x32_bf16 v[196:199], a[128:131], a[72:75], v[196:199]
ds_read_b64_tr_b16 a[140:141], v19 offset:16384
v_mfma_f32_16x16x32_bf16 v[196:199], a[132:135], a[76:79], v[196:199]
ds_read_b64_tr_b16 a[142:143], v19 offset:18432
v_mfma_f32_16x16x32_bf16 v[200:203], a[128:131], a[80:83], v[200:203]
v_add_u32 v19, s54, v19
v_mfma_f32_16x16x32_bf16 v[200:203], a[132:135], a[84:87], v[200:203]
v_mfma_f32_16x16x32_bf16 v[204:207], a[128:131], a[88:91], v[204:207]
v_mfma_f32_16x16x32_bf16 v[204:207], a[132:135], a[92:95], v[204:207]
v_mfma_f32_16x16x32_bf16 v[208:211], a[128:131], a[96:99], v[208:211]
v_mfma_f32_16x16x32_bf16 v[208:211], a[132:135], a[100:103], v[208:211]
v_mfma_f32_16x16x32_bf16 v[212:215], a[128:131], a[104:107], v[212:215]
v_mfma_f32_16x16x32_bf16 v[212:215], a[132:135], a[108:111], v[212:215]
s_cmp_eq_u32 s53, s69
s_cselect_b32 s54, s58, s59
v_mfma_f32_16x16x32_bf16 v[216:219], a[128:131], a[112:115], v[216:219]
s_add_u32 s53, s53, 32768
s_cmp_eq_u32 s53, s68
s_cselect_b32 s53, s69, s53
v_mfma_f32_16x16x32_bf16 v[216:219], a[132:135], a[116:119], v[216:219]
s_xor_b32 s52, s52, 0x38000
v_mfma_f32_16x16x32_bf16 v[220:223], a[128:131], a[120:123], v[220:223]
v_mfma_f32_16x16x32_bf16 v[220:223], a[132:135], a[124:127], v[220:223]
s_waitcnt vmcnt(23)
s_barrier
s_waitcnt lgkmcnt(0)
v_mfma_f32_16x16x32_bf16 v[224:227], a[136:139], a[64:67], v[224:227]
ds_read_b64_tr_b16 a[128:129], v12 offset:0
ds_read_b128 a[64:67], v20 offset:0
v_mfma_f32_16x16x32_bf16 v[224:227], a[140:143], a[68:71], v[224:227]
ds_read_b64_tr_b16 a[130:131], v12 offset:2048
ds_read_b128 a[68:71], v21 offset:0
v_mfma_f32_16x16x32_bf16 v[228:231], a[136:139], a[72:75], v[228:231]
ds_read_b64_tr_b16 a[132:133], v12 offset:16384
ds_read_b128 a[72:75], v20 offset:2048
v_mfma_f32_16x16x32_bf16 v[228:231], a[140:143], a[76:79], v[228:231]
ds_read_b64_tr_b16 a[134:135], v12 offset:18432
ds_read_b128 a[76:79], v21 offset:2048
v_mfma_f32_16x16x32_bf16 v[232:235], a[136:139], a[80:83], v[232:235]
v_add_u32 v12, s54, v12
ds_read_b128 a[80:83], v20 offset:4096
v_mfma_f32_16x16x32_bf16 v[232:235], a[140:143], a[84:87], v[232:235]
ds_read_b128 a[84:87], v21 offset:4096
v_mfma_f32_16x16x32_bf16 v[236:239], a[136:139], a[88:91], v[236:239]
ds_read_b128 a[88:91], v20 offset:6144
v_mfma_f32_16x16x32_bf16 v[236:239], a[140:143], a[92:95], v[236:239]
ds_read_b128 a[92:95], v21 offset:6144
v_mfma_f32_16x16x32_bf16 v[240:243], a[136:139], a[96:99], v[240:243]
ds_read_b128 a[96:99], v20 offset:8192
v_mfma_f32_16x16x32_bf16 v[240:243], a[140:143], a[100:103], v[240:243]
ds_read_b128 a[100:103], v21 offset:8192
v_mfma_f32_16x16x32_bf16 v[244:247], a[136:139], a[104:107], v[244:247]
ds_read_b128 a[104:107], v20 offset:10240
v_mfma_f32_16x16x32_bf16 v[244:247], a[140:143], a[108:111], v[244:247]
ds_read_b128 a[108:111], v21 offset:10240
v_mfma_f32_16x16x32_bf16 v[248:251], a[136:139], a[112:115], v[248:251]
ds_read_b128 a[112:115], v20 offset:12288
v_mfma_f32_16x16x32_bf16 v[248:251], a[140:143], a[116:119], v[248:251]
ds_read_b128 a[116:119], v21 offset:12288
v_mfma_f32_16x16x32_bf16 v[252:255], a[136:139], a[120:123], v[252:255]
ds_read_b128 a[120:123], v20 offset:14336
v_mfma_f32_16x16x32_bf16 v[252:255], a[140:143], a[124:127], v[252:255]
ds_read_b128 a[124:127], v21 offset:14336
v_xor_b32 v20, 0x38000, v20
v_xor_b32 v21, 0x38000, v21
s_waitcnt lgkmcnt(12)
v_mfma_f32_16x16x32_bf16 a[0:3], a[128:131], a[64:67], a[0:3]
ds_read_b64_tr_b16 a[136:137], v13 offset:0
v_mfma_f32_16x16x32_bf16 a[0:3], a[132:135], a[68:71], a[0:3]
ds_read_b64_tr_b16 a[138:139], v13 offset:2048
v_mfma_f32_16x16x32_bf16 a[4:7], a[128:131], a[72:75], a[4:7]
ds_read_b64_tr_b16 a[140:141], v13 offset:16384
v_mfma_f32_16x16x32_bf16 a[4:7], a[132:135], a[76:79], a[4:7]
s_waitcnt lgkmcnt(11)
ds_read_b64_tr_b16 a[142:143], v13 offset:18432
v_mfma_f32_16x16x32_bf16 a[8:11], a[128:131], a[80:83], a[8:11]
v_add_u32 v13, s54, v13
v_mfma_f32_16x16x32_bf16 a[8:11], a[132:135], a[84:87], a[8:11]
s_waitcnt vmcnt(3)
v_readfirstlane_b32 s70, v31
s_cmp_eq_u32 s55, 0
s_cselect_b32 s70, s70, 112
s_cmp_ge_u32 s70, 112
s_cbranch_scc0 kv_spin
kv_spun:
v_mfma_f32_16x16x32_bf16 a[12:15], a[128:131], a[88:91], a[12:15]
v_mfma_f32_16x16x32_bf16 a[12:15], a[132:135], a[92:95], a[12:15]
s_waitcnt lgkmcnt(8)
v_mfma_f32_16x16x32_bf16 a[16:19], a[128:131], a[96:99], a[16:19]
v_mfma_f32_16x16x32_bf16 a[16:19], a[132:135], a[100:103], a[16:19]
v_mfma_f32_16x16x32_bf16 a[20:23], a[128:131], a[104:107], a[20:23]
v_mfma_f32_16x16x32_bf16 a[20:23], a[132:135], a[108:111], a[20:23]
s_waitcnt lgkmcnt(4)
v_mfma_f32_16x16x32_bf16 a[24:27], a[128:131], a[112:115], a[24:27]
v_mfma_f32_16x16x32_bf16 a[24:27], a[132:135], a[116:119], a[24:27]
v_mfma_f32_16x16x32_bf16 a[28:31], a[128:131], a[120:123], a[28:31]
v_mfma_f32_16x16x32_bf16 a[28:31], a[132:135], a[124:127], a[28:31]
s_waitcnt lgkmcnt(0)
s_barrier
v_mfma_f32_16x16x32_bf16 a[32:35], a[136:139], a[64:67], a[32:35]
ds_read_b64_tr_b16 a[128:129], v14 offset:0
v_lshlrev_b32 v30, 5, v1
v_mfma_f32_16x16x32_bf16 a[32:35], a[140:143], a[68:71], a[32:35]
ds_read_b64_tr_b16 a[130:131], v14 offset:2048
buffer_load_dwordx4 v[48:51], v30, s[32:35], 0 offen offset:0 sc1
v_mfma_f32_16x16x32_bf16 a[36:39], a[136:139], a[72:75], a[36:39]
ds_read_b64_tr_b16 a[132:133], v14 offset:16384
buffer_load_dwordx4 v[52:55], v30, s[32:35], 0 offen offset:16 sc1
v_mfma_f32_16x16x32_bf16 a[36:39], a[140:143], a[76:79], a[36:39]
ds_read_b64_tr_b16 a[134:135], v14 offset:18432
buffer_load_dwordx4 v[56:59], v30, s[32:35], 0 offen offset:1792 sc1
v_mfma_f32_16x16x32_bf16 a[40:43], a[136:139], a[80:83], a[40:43]
v_add_u32 v14, s54, v14
s_mov_b32 m0, s52
v_mfma_f32_16x16x32_bf16 a[40:43], a[140:143], a[84:87], a[40:43]
buffer_load_dwordx4 v4, s[20:23], s48 offen offset:0 lds
buffer_load_dwordx4 v[60:63], v30, s[32:35], 0 offen offset:1808 sc1
v_mfma_f32_16x16x32_bf16 a[44:47], a[136:139], a[88:91], a[44:47]
v_mfma_f32_16x16x32_bf16 a[44:47], a[140:143], a[92:95], a[44:47]
v_mfma_f32_16x16x32_bf16 a[48:51], a[136:139], a[96:99], a[48:51]
v_mfma_f32_16x16x32_bf16 a[48:51], a[140:143], a[100:103], a[48:51]
buffer_load_dwordx4 v5, s[20:23], s48 offen offset:1024 lds
v_mfma_f32_16x16x32_bf16 a[52:55], a[136:139], a[104:107], a[52:55]
v_mfma_f32_16x16x32_bf16 a[52:55], a[140:143], a[108:111], a[52:55]
v_mfma_f32_16x16x32_bf16 a[56:59], a[136:139], a[112:115], a[56:59]
v_mfma_f32_16x16x32_bf16 a[56:59], a[140:143], a[116:119], a[56:59]
buffer_load_dwordx4 v6, s[20:23], s48 offen offset:2048 lds
v_mfma_f32_16x16x32_bf16 a[60:63], a[136:139], a[120:123], a[60:63]
v_mfma_f32_16x16x32_bf16 a[60:63], a[140:143], a[124:127], a[60:63]
s_waitcnt lgkmcnt(0)
v_mfma_f32_16x16x32_bf16 v[64:67], a[128:131], a[64:67], v[64:67]
ds_read_b64_tr_b16 a[136:137], v15 offset:0
v_mfma_f32_16x16x32_bf16 v[64:67], a[132:135], a[68:71], v[64:67]
ds_read_b64_tr_b16 a[138:139], v15 offset:2048
buffer_load_dwordx4 v7, s[20:23], s48 offen offset:3072 lds
v_mfma_f32_16x16x32_bf16 v[68:71], a[128:131], a[72:75], v[68:71]
ds_read_b64_tr_b16 a[140:141], v15 offset:16384
s_add_u32 s48, s48, 128
v_mfma_f32_16x16x32_bf16 v[68:71], a[132:135], a[76:79], v[68:71]
ds_read_b64_tr_b16 a[142:143], v15 offset:18432
v_mfma_f32_16x16x32_bf16 v[72:75], a[128:131], a[80:83], v[72:75]
v_add_u32 v15, s54, v15
s_add_u32 m0, s52, 4096
v_mfma_f32_16x16x32_bf16 v[72:75], a[132:135], a[84:87], v[72:75]
buffer_load_dwordx4 v4, s[20:23], s49 offen offset:0 lds
v_mfma_f32_16x16x32_bf16 v[76:79], a[128:131], a[88:91], v[76:79]
v_mfma_f32_16x16x32_bf16 v[76:79], a[132:135], a[92:95], v[76:79]
v_mfma_f32_16x16x32_bf16 v[80:83], a[128:131], a[96:99], v[80:83]
v_mfma_f32_16x16x32_bf16 v[80:83], a[132:135], a[100:103], v[80:83]
buffer_load_dwordx4 v5, s[20:23], s49 offen offset:1024 lds
v_mfma_f32_16x16x32_bf16 v[84:87], a[128:131], a[104:107], v[84:87]
v_mfma_f32_16x16x32_bf16 v[84:87], a[132:135], a[108:111], v[84:87]
v_mfma_f32_16x16x32_bf16 v[88:91], a[128:131], a[112:115], v[88:91]
v_mfma_f32_16x16x32_bf16 v[88:91], a[132:135], a[116:119], v[88:91]
buffer_load_dwordx4 v6, s[20:23], s49 offen offset:2048 lds
v_mfma_f32_16x16x32_bf16 v[92:95], a[128:131], a[120:123], v[92:95]
v_mfma_f32_16x16x32_bf16 v[92:95], a[132:135], a[124:127], v[92:95]
s_waitcnt lgkmcnt(0)
v_mfma_f32_16x16x32_bf16 v[96:99], a[136:139], a[64:67], v[96:99]
ds_read_b64_tr_b16 a[128:129], v16 offset:0
v_mfma_f32_16x16x32_bf16 v[96:99], a[140:143], a[68:71], v[96:99]
ds_read_b64_tr_b16 a[130:131], v16 offset:2048
buffer_load_dwordx4 v7, s[20:23], s49 offen offset:3072 lds
v_mfma_f32_16x16x32_bf16 v[100:103], a[136:139], a[72:75], v[100:103]
ds_read_b64_tr_b16 a[132:133], v16 offset:16384
s_add_u32 s49, s49, 128
v_mfma_f32_16x16x32_bf16 v[100:103], a[140:143], a[76:79], v[100:103]
ds_read_b64_tr_b16 a[134:135], v16 offset:18432
v_mfma_f32_16x16x32_bf16 v[104:107], a[136:139], a[80:83], v[104:107]
v_add_u32 v16, s54, v16
s_mov_b32 m0, s53
v_mfma_f32_16x16x32_bf16 v[104:107], a[140:143], a[84:87], v[104:107]
buffer_load_dwordx4 v8, s[24:27], s50 offen offset:0 lds
v_mfma_f32_16x16x32_bf16 v[108:111], a[136:139], a[88:91], v[108:111]
v_mfma_f32_16x16x32_bf16 v[108:111], a[140:143], a[92:95], v[108:111]
v_mfma_f32_16x16x32_bf16 v[112:115], a[136:139], a[96:99], v[112:115]
v_mfma_f32_16x16x32_bf16 v[112:115], a[140:143], a[100:103], v[112:115]
buffer_load_dwordx4 v9, s[24:27], s50 offen offset:1024 lds
v_mfma_f32_16x16x32_bf16 v[116:119], a[136:139], a[104:107], v[116:119]
v_mfma_f32_16x16x32_bf16 v[116:119], a[140:143], a[108:111], v[116:119]
v_mfma_f32_16x16x32_bf16 v[120:123], a[136:139], a[112:115], v[120:123]
v_mfma_f32_16x16x32_bf16 v[120:123], a[140:143], a[116:119], v[120:123]
buffer_load_dwordx4 v10, s[24:27], s50 offen offset:2048 lds
v_mfma_f32_16x16x32_bf16 v[124:127], a[136:139], a[120:123], v[124:127]
v_mfma_f32_16x16x32_bf16 v[124:127], a[140:143], a[124:127], v[124:127]
s_waitcnt lgkmcnt(0)
v_mfma_f32_16x16x32_bf16 v[128:131], a[128:131], a[64:67], v[128:131]
ds_read_b64_tr_b16 a[136:137], v17 offset:0
v_mfma_f32_16x16x32_bf16 v[128:131], a[132:135], a[68:71], v[128:131]
ds_read_b64_tr_b16 a[138:139], v17 offset:2048
buffer_load_dwordx4 v11, s[24:27], s50 offen offset:3072 lds
v_mfma_f32_16x16x32_bf16 v[132:135], a[128:131], a[72:75], v[132:135]
ds_read_b64_tr_b16 a[140:141], v17 offset:16384
s_add_u32 s50, s50, 524288
v_mfma_f32_16x16x32_bf16 v[132:135], a[132:135], a[76:79], v[132:135]
ds_read_b64_tr_b16 a[142:143], v17 offset:18432
v_mfma_f32_16x16x32_bf16 v[136:139], a[128:131], a[80:83], v[136:139]
v_add_u32 v17, s54, v17
s_add_u32 m0, s53, 8192
v_mfma_f32_16x16x32_bf16 v[136:139], a[132:135], a[84:87], v[136:139]
buffer_load_dwordx4 v8, s[24:27], s51 offen offset:0 lds
v_mfma_f32_16x16x32_bf16 v[140:143], a[128:131], a[88:91], v[140:143]
v_mfma_f32_16x16x32_bf16 v[140:143], a[132:135], a[92:95], v[140:143]
v_mfma_f32_16x16x32_bf16 v[144:147], a[128:131], a[96:99], v[144:147]
v_mfma_f32_16x16x32_bf16 v[144:147], a[132:135], a[100:103], v[144:147]
buffer_load_dwordx4 v9, s[24:27], s51 offen offset:1024 lds
v_mfma_f32_16x16x32_bf16 v[148:151], a[128:131], a[104:107], v[148:151]
v_mfma_f32_16x16x32_bf16 v[148:151], a[132:135], a[108:111], v[148:151]
v_mfma_f32_16x16x32_bf16 v[152:155], a[128:131], a[112:115], v[152:155]
v_mfma_f32_16x16x32_bf16 v[152:155], a[132:135], a[116:119], v[152:155]
buffer_load_dwordx4 v10, s[24:27], s51 offen offset:2048 lds
v_mfma_f32_16x16x32_bf16 v[156:159], a[128:131], a[120:123], v[156:159]
v_mfma_f32_16x16x32_bf16 v[156:159], a[132:135], a[124:127], v[156:159]
s_waitcnt lgkmcnt(0)
v_mfma_f32_16x16x32_bf16 v[160:163], a[136:139], a[64:67], v[160:163]
ds_read_b64_tr_b16 a[128:129], v18 offset:0
v_mfma_f32_16x16x32_bf16 v[160:163], a[140:143], a[68:71], v[160:163]
ds_read_b64_tr_b16 a[130:131], v18 offset:2048
buffer_load_dwordx4 v11, s[24:27], s51 offen offset:3072 lds
v_mfma_f32_16x16x32_bf16 v[164:167], a[136:139], a[72:75], v[164:167]
ds_read_b64_tr_b16 a[132:133], v18 offset:16384
s_add_u32 s51, s51, 524288
v_mfma_f32_16x16x32_bf16 v[164:167], a[140:143], a[76:79], v[164:167]
ds_read_b64_tr_b16 a[134:135], v18 offset:18432
v_mfma_f32_16x16x32_bf16 v[168:171], a[136:139], a[80:83], v[168:171]
v_add_u32 v18, s54, v18
v_mfma_f32_16x16x32_bf16 v[168:171], a[140:143], a[84:87], v[168:171]
v_mfma_f32_16x16x32_bf16 v[172:175], a[136:139], a[88:91], v[172:175]
v_mfma_f32_16x16x32_bf16 v[172:175], a[140:143], a[92:95], v[172:175]
v_mfma_f32_16x16x32_bf16 v[176:179], a[136:139], a[96:99], v[176:179]
v_mfma_f32_16x16x32_bf16 v[176:179], a[140:143], a[100:103], v[176:179]
v_mfma_f32_16x16x32_bf16 v[180:183], a[136:139], a[104:107], v[180:183]
v_mfma_f32_16x16x32_bf16 v[180:183], a[140:143], a[108:111], v[180:183]
buffer_load_dword a255, v22, s[24:27], 0 offen
v_add_u32 v22, 524288, v22
v_mfma_f32_16x16x32_bf16 v[184:187], a[136:139], a[112:115], v[184:187]
buffer_load_dword a255, v23, s[20:23], 0 offen
v_add_u32 v23, 128, v23
v_mfma_f32_16x16x32_bf16 v[184:187], a[140:143], a[116:119], v[184:187]
s_cmp_lt_u32 s16, 8
s_cselect_b32 s46, s17, 0
s_cselect_b32 s6, 1408, 0
v_mfma_f32_16x16x32_bf16 v[188:191], a[136:139], a[120:123], v[188:191]
s_add_u32 s16, s16, 1
buffer_load_dword a255, v3, s[44:47], 0 offen
v_mfma_f32_16x16x32_bf16 v[188:191], a[140:143], a[124:127], v[188:191]
s_waitcnt lgkmcnt(0)
v_add_u32 v3, s6, v3
v_mfma_f32_16x16x32_bf16 v[192:195], a[128:131], a[64:67], v[192:195]
ds_read_b64_tr_b16 a[136:137], v19 offset:0
v_mfma_f32_16x16x32_bf16 v[192:195], a[132:135], a[68:71], v[192:195]
ds_read_b64_tr_b16 a[138:139], v19 offset:2048
v_mfma_f32_16x16x32_bf16 v[196:199], a[128:131], a[72:75], v[196:199]
ds_read_b64_tr_b16 a[140:141], v19 offset:16384
v_mfma_f32_16x16x32_bf16 v[196:199], a[132:135], a[76:79], v[196:199]
ds_read_b64_tr_b16 a[142:143], v19 offset:18432
v_mfma_f32_16x16x32_bf16 v[200:203], a[128:131], a[80:83], v[200:203]
v_add_u32 v19, s54, v19
v_mfma_f32_16x16x32_bf16 v[200:203], a[132:135], a[84:87], v[200:203]
v_mfma_f32_16x16x32_bf16 v[204:207], a[128:131], a[88:91], v[204:207]
v_mfma_f32_16x16x32_bf16 v[204:207], a[132:135], a[92:95], v[204:207]
v_mfma_f32_16x16x32_bf16 v[208:211], a[128:131], a[96:99], v[208:211]
v_mfma_f32_16x16x32_bf16 v[208:211], a[132:135], a[100:103], v[208:211]
v_mfma_f32_16x16x32_bf16 v[212:215], a[128:131], a[104:107], v[212:215]
v_mfma_f32_16x16x32_bf16 v[212:215], a[132:135], a[108:111], v[212:215]
s_cmp_eq_u32 s53, s69
s_cselect_b32 s54, s58, s59
v_mfma_f32_16x16x32_bf16 v[216:219], a[128:131], a[112:115], v[216:219]
s_add_u32 s53, s53, 32768
s_cmp_eq_u32 s53, s68
s_cselect_b32 s53, s69, s53
v_mfma_f32_16x16x32_bf16 v[216:219], a[132:135], a[116:119], v[216:219]
s_xor_b32 s52, s52, 0x38000
v_mfma_f32_16x16x32_bf16 v[220:223], a[128:131], a[120:123], v[220:223]
v_mfma_f32_16x16x32_bf16 v[220:223], a[132:135], a[124:127], v[220:223]
s_barrier
s_waitcnt lgkmcnt(0)
v_mfma_f32_16x16x32_bf16 v[224:227], a[136:139], a[64:67], v[224:227]
ds_read_b64_tr_b16 a[128:129], v12 offset:0
ds_read_b128 a[64:67], v20 offset:0
v_mfma_f32_16x16x32_bf16 v[224:227], a[140:143], a[68:71], v[224:227]
ds_read_b64_tr_b16 a[130:131], v12 offset:2048
ds_read_b128 a[68:71], v21 offset:0
v_mfma_f32_16x16x32_bf16 v[228:231], a[136:139], a[72:75], v[228:231]
ds_read_b64_tr_b16 a[132:133], v12 offset:16384
ds_read_b128 a[72:75], v20 offset:2048
v_mfma_f32_16x16x32_bf16 v[228:231], a[140:143], a[76:79], v[228:231]
ds_read_b64_tr_b16 a[134:135], v12 offset:18432
ds_read_b128 a[76:79], v21 offset:2048
v_mfma_f32_16x16x32_bf16 v[232:235], a[136:139], a[80:83], v[232:235]
v_add_u32 v12, s54, v12
ds_read_b128 a[80:83], v20 offset:4096
v_mfma_f32_16x16x32_bf16 v[232:235], a[140:143], a[84:87], v[232:235]
ds_read_b128 a[84:87], v21 offset:4096
v_mfma_f32_16x16x32_bf16 v[236:239], a[136:139], a[88:91], v[236:239]
ds_read_b128 a[88:91], v20 offset:6144
v_mfma_f32_16x16x32_bf16 v[236:239], a[140:143], a[92:95], v[236:239]
ds_read_b128 a[92:95], v21 offset:6144
v_mfma_f32_16x16x32_bf16 v[240:243], a[136:139], a[96:99], v[240:243]
ds_read_b128 a[96:99], v20 offset:8192
v_mfma_f32_16x16x32_bf16 v[240:243], a[140:143], a[100:103], v[240:243]
ds_read_b128 a[100:103], v21 offset:8192
v_mfma_f32_16x16x32_bf16 v[244:247], a[136:139], a[104:107], v[244:247]
ds_read_b128 a[104:107], v20 offset:10240
v_mfma_f32_16x16x32_bf16 v[244:247], a[140:143], a[108:111], v[244:247]
ds_read_b128 a[108:111], v21 offset:10240
v_mfma_f32_16x16x32_bf16 v[248:251], a[136:139], a[112:115], v[248:251]
ds_read_b128 a[112:115], v20 offset:12288
v_mfma_f32_16x16x32_bf16 v[248:251], a[140:143], a[116:119], v[248:251]
ds_read_b128 a[116:119], v21 offset:12288
v_mfma_f32_16x16x32_bf16 v[252:255], a[136:139], a[120:123], v[252:255]
ds_read_b128 a[120:123], v20 offset:14336
v_mfma_f32_16x16x32_bf16 v[252:255], a[140:143], a[124:127], v[252:255]
ds_read_b128 a[124:127], v21 offset:14336
v_xor_b32 v20, 0x38000, v20
v_xor_b32 v21, 0x38000, v21
s_waitcnt lgkmcnt(12)
v_mfma_f32_16x16x32_bf16 a[0:3], a[128:131], a[64:67], a[0:3]
ds_read_b64_tr_b16 a[136:137], v13 offset:0
s_waitcnt vmcnt(18)
v_mfma_f32_16x16x32_bf16 a[0:3], a[132:135], a[68:71], a[0:3]
ds_read_b64_tr_b16 a[138:139], v13 offset:2048
v_lshlrev_b32 v24, 16, v32
v_mfma_f32_16x16x32_bf16 a[4:7], a[128:131], a[72:75], a[4:7]
ds_read_b64_tr_b16 a[140:141], v13 offset:16384
v_and_b32 v25, 0xffff0000, v32
v_mfma_f32_16x16x32_bf16 a[4:7], a[132:135], a[76:79], a[4:7]
s_waitcnt lgkmcnt(11)
ds_read_b64_tr_b16 a[142:143], v13 offset:18432
v_mfma_f32_16x16x32_bf16 a[8:11], a[128:131], a[80:83], a[8:11]
v_add_u32 v13, s54, v13
v_fma_f32 v24, v24, v56, v48
v_mfma_f32_16x16x32_bf16 a[8:11], a[132:135], a[84:87], a[8:11]
v_fma_f32 v25, v25, v57, v49
v_cvt_pk_bf16_f32 v32, v24, v25
v_mfma_f32_16x16x32_bf16 a[12:15], a[128:131], a[88:91], a[12:15]
v_lshlrev_b32 v26, 16, v33
v_and_b32 v27, 0xffff0000, v33
v_mfma_f32_16x16x32_bf16 a[12:15], a[132:135], a[92:95], a[12:15]
s_waitcnt lgkmcnt(8)
v_fma_f32 v26, v26, v58, v50
v_mfma_f32_16x16x32_bf16 a[16:19], a[128:131], a[96:99], a[16:19]
v_fma_f32 v27, v27, v59, v51
v_cvt_pk_bf16_f32 v33, v26, v27
v_mfma_f32_16x16x32_bf16 a[16:19], a[132:135], a[100:103], a[16:19]
v_lshlrev_b32 v24, 16, v34
v_and_b32 v25, 0xffff0000, v34
v_mfma_f32_16x16x32_bf16 a[20:23], a[128:131], a[104:107], a[20:23]
v_fma_f32 v24, v24, v60, v52
v_fma_f32 v25, v25, v61, v53
v_mfma_f32_16x16x32_bf16 a[20:23], a[132:135], a[108:111], a[20:23]
s_waitcnt lgkmcnt(4)
v_cvt_pk_bf16_f32 v34, v24, v25
v_mfma_f32_16x16x32_bf16 a[24:27], a[128:131], a[112:115], a[24:27]
v_lshlrev_b32 v26, 16, v35
v_and_b32 v27, 0xffff0000, v35
v_mfma_f32_16x16x32_bf16 a[24:27], a[132:135], a[116:119], a[24:27]
v_fma_f32 v26, v26, v62, v54
v_fma_f32 v27, v27, v63, v55
v_mfma_f32_16x16x32_bf16 a[28:31], a[128:131], a[120:123], a[28:31]
v_cvt_pk_bf16_f32 v35, v26, v27
v_lshlrev_b32 v24, 16, v36
v_mfma_f32_16x16x32_bf16 a[28:31], a[132:135], a[124:127], a[28:31]
s_waitcnt lgkmcnt(0)
s_barrier
v_mfma_f32_16x16x32_bf16 a[32:35], a[136:139], a[64:67], a[32:35]
ds_read_b64_tr_b16 a[128:129], v14 offset:0
v_and_b32 v25, 0xffff0000, v36
v_mfma_f32_16x16x32_bf16 a[32:35], a[140:143], a[68:71], a[32:35]
ds_read_b64_tr_b16 a[130:131], v14 offset:2048
v_fma_f32 v24, v24, v56, v48
v_mfma_f32_16x16x32_bf16 a[36:39], a[136:139], a[72:75], a[36:39]
ds_read_b64_tr_b16 a[132:133], v14 offset:16384
v_fma_f32 v25, v25, v57, v49
v_mfma_f32_16x16x32_bf16 a[36:39], a[140:143], a[76:79], a[36:39]
ds_read_b64_tr_b16 a[134:135], v14 offset:18432
v_cvt_pk_bf16_f32 v36, v24, v25
v_mfma_f32_16x16x32_bf16 a[40:43], a[136:139], a[80:83], a[40:43]
v_add_u32 v14, s54, v14
s_mov_b32 m0, s52
v_mfma_f32_16x16x32_bf16 a[40:43], a[140:143], a[84:87], a[40:43]
buffer_load_dwordx4 v4, s[20:23], s48 offen offset:0 lds
v_lshlrev_b32 v26, 16, v37
v_mfma_f32_16x16x32_bf16 a[44:47], a[136:139], a[88:91], a[44:47]
v_and_b32 v27, 0xffff0000, v37
v_fma_f32 v26, v26, v58, v50
v_mfma_f32_16x16x32_bf16 a[44:47], a[140:143], a[92:95], a[44:47]
v_fma_f32 v27, v27, v59, v51
v_cvt_pk_bf16_f32 v37, v26, v27
v_mfma_f32_16x16x32_bf16 a[48:51], a[136:139], a[96:99], a[48:51]
v_lshlrev_b32 v24, 16, v38
v_and_b32 v25, 0xffff0000, v38
v_mfma_f32_16x16x32_bf16 a[48:51], a[140:143], a[100:103], a[48:51]
buffer_load_dwordx4 v5, s[20:23], s48 offen offset:1024 lds
v_fma_f32 v24, v24, v60, v52
v_mfma_f32_16x16x32_bf16 a[52:55], a[136:139], a[104:107], a[52:55]
v_fma_f32 v25, v25, v61, v53
v_cvt_pk_bf16_f32 v38, v24, v25
v_mfma_f32_16x16x32_bf16 a[52:55], a[140:143], a[108:111], a[52:55]
v_lshlrev_b32 v26, 16, v39
v_and_b32 v27, 0xffff0000, v39
v_mfma_f32_16x16x32_bf16 a[56:59], a[136:139], a[112:115], a[56:59]
v_fma_f32 v26, v26, v62, v54
v_fma_f32 v27, v27, v63, v55
v_mfma_f32_16x16x32_bf16 a[56:59], a[140:143], a[116:119], a[56:59]
buffer_load_dwordx4 v6, s[20:23], s48 offen offset:2048 lds
v_cvt_pk_bf16_f32 v39, v26, v27
v_mfma_f32_16x16x32_bf16 a[60:63], a[136:139], a[120:123], a[60:63]
v_lshlrev_b32 v24, 16, v40
v_and_b32 v25, 0xffff0000, v40
v_mfma_f32_16x16x32_bf16 a[60:63], a[140:143], a[124:127], a[60:63]
s_waitcnt lgkmcnt(0)
v_fma_f32 v24, v24, v56, v48
v_mfma_f32_16x16x32_bf16 v[64:67], a[128:131], a[64:67], v[64:67]
ds_read_b64_tr_b16 a[136:137], v15 offset:0
v_fma_f32 v25, v25, v57, v49
v_mfma_f32_16x16x32_bf16 v[64:67], a[132:135], a[68:71], v[64:67]
ds_read_b64_tr_b16 a[138:139], v15 offset:2048
buffer_load_dwordx4 v7, s[20:23], s48 offen offset:3072 lds
v_mfma_f32_16x16x32_bf16 v[68:71], a[128:131], a[72:75], v[68:71]
ds_read_b64_tr_b16 a[140:141], v15 offset:16384
s_add_u32 s48, s48, 128
v_mfma_f32_16x16x32_bf16 v[68:71], a[132:135], a[76:79], v[68:71]
ds_read_b64_tr_b16 a[142:143], v15 offset:18432
v_cvt_pk_bf16_f32 v40, v24, v25
v_mfma_f32_16x16x32_bf16 v[72:75], a[128:131], a[80:83], v[72:75]
v_add_u32 v15, s54, v15
s_add_u32 m0, s52, 4096
v_mfma_f32_16x16x32_bf16 v[72:75], a[132:135], a[84:87], v[72:75]
buffer_load_dwordx4 v4, s[20:23], s49 offen offset:0 lds
v_lshlrev_b32 v26, 16, v41
v_mfma_f32_16x16x32_bf16 v[76:79], a[128:131], a[88:91], v[76:79]
v_and_b32 v27, 0xffff0000, v41
v_fma_f32 v26, v26, v58, v50
v_mfma_f32_16x16x32_bf16 v[76:79], a[132:135], a[92:95], v[76:79]
v_fma_f32 v27, v27, v59, v51
v_cvt_pk_bf16_f32 v41, v26, v27
v_mfma_f32_16x16x32_bf16 v[80:83], a[128:131], a[96:99], v[80:83]
v_lshlrev_b32 v24, 16, v42
v_and_b32 v25, 0xffff0000, v42
v_mfma_f32_16x16x32_bf16 v[80:83], a[132:135], a[100:103], v[80:83]
buffer_load_dwordx4 v5, s[20:23], s49 offen offset:1024 lds
v_fma_f32 v24, v24, v60, v52
v_mfma_f32_16x16x32_bf16 v[84:87], a[128:131], a[104:107], v[84:87]
v_fma_f32 v25, v25, v61, v53
v_cvt_pk_bf16_f32 v42, v24, v25
v_mfma_f32_16x16x32_bf16 v[84:87], a[132:135], a[108:111], v[84:87]
v_lshlrev_b32 v26, 16, v43
v_and_b32 v27, 0xffff0000, v43
v_mfma_f32_16x16x32_bf16 v[88:91], a[128:131], a[112:115], v[88:91]
v_fma_f32 v26, v26, v62, v54
v_fma_f32 v27, v27, v63, v55
v_mfma_f32_16x16x32_bf16 v[88:91], a[132:135], a[116:119], v[88:91]
buffer_load_dwordx4 v6, s[20:23], s49 offen offset:2048 lds
v_cvt_pk_bf16_f32 v43, v26, v27
v_mfma_f32_16x16x32_bf16 v[92:95], a[128:131], a[120:123], v[92:95]
v_lshlrev_b32 v24, 16, v44
v_and_b32 v25, 0xffff0000, v44
v_mfma_f32_16x16x32_bf16 v[92:95], a[132:135], a[124:127], v[92:95]
s_waitcnt lgkmcnt(0)
v_fma_f32 v24, v24, v56, v48
v_mfma_f32_16x16x32_bf16 v[96:99], a[136:139], a[64:67], v[96:99]
ds_read_b64_tr_b16 a[128:129], v16 offset:0
v_fma_f32 v25, v25, v57, v49
v_mfma_f32_16x16x32_bf16 v[96:99], a[140:143], a[68:71], v[96:99]
ds_read_b64_tr_b16 a[130:131], v16 offset:2048
buffer_load_dwordx4 v7, s[20:23], s49 offen offset:3072 lds
v_mfma_f32_16x16x32_bf16 v[100:103], a[136:139], a[72:75], v[100:103]
ds_read_b64_tr_b16 a[132:133], v16 offset:16384
s_add_u32 s49, s49, 128
v_mfma_f32_16x16x32_bf16 v[100:103], a[140:143], a[76:79], v[100:103]
ds_read_b64_tr_b16 a[134:135], v16 offset:18432
v_cvt_pk_bf16_f32 v44, v24, v25
v_mfma_f32_16x16x32_bf16 v[104:107], a[136:139], a[80:83], v[104:107]
v_add_u32 v16, s54, v16
s_mov_b32 m0, s53
v_mfma_f32_16x16x32_bf16 v[104:107], a[140:143], a[84:87], v[104:107]
buffer_load_dwordx4 v8, s[24:27], s50 offen offset:0 lds
v_lshlrev_b32 v26, 16, v45
v_mfma_f32_16x16x32_bf16 v[108:111], a[136:139], a[88:91], v[108:111]
v_and_b32 v27, 0xffff0000, v45
v_fma_f32 v26, v26, v58, v50
v_mfma_f32_16x16x32_bf16 v[108:111], a[140:143], a[92:95], v[108:111]
v_fma_f32 v27, v27, v59, v51
v_cvt_pk_bf16_f32 v45, v26, v27
v_mfma_f32_16x16x32_bf16 v[112:115], a[136:139], a[96:99], v[112:115]
v_lshlrev_b32 v24, 16, v46
v_and_b32 v25, 0xffff0000, v46
v_mfma_f32_16x16x32_bf16 v[112:115], a[140:143], a[100:103], v[112:115]
buffer_load_dwordx4 v9, s[24:27], s50 offen offset:1024 lds
v_fma_f32 v24, v24, v60, v52
v_mfma_f32_16x16x32_bf16 v[116:119], a[136:139], a[104:107], v[116:119]
v_fma_f32 v25, v25, v61, v53
v_cvt_pk_bf16_f32 v46, v24, v25
v_mfma_f32_16x16x32_bf16 v[116:119], a[140:143], a[108:111], v[116:119]
v_lshlrev_b32 v26, 16, v47
v_and_b32 v27, 0xffff0000, v47
v_mfma_f32_16x16x32_bf16 v[120:123], a[136:139], a[112:115], v[120:123]
v_fma_f32 v26, v26, v62, v54
v_fma_f32 v27, v27, v63, v55
v_mfma_f32_16x16x32_bf16 v[120:123], a[140:143], a[116:119], v[120:123]
buffer_load_dwordx4 v10, s[24:27], s50 offen offset:2048 lds
v_cvt_pk_bf16_f32 v47, v26, v27
v_mfma_f32_16x16x32_bf16 v[124:127], a[136:139], a[120:123], v[124:127]
v_mfma_f32_16x16x32_bf16 v[124:127], a[140:143], a[124:127], v[124:127]
s_waitcnt lgkmcnt(0)
v_mfma_f32_16x16x32_bf16 v[128:131], a[128:131], a[64:67], v[128:131]
ds_read_b64_tr_b16 a[136:137], v17 offset:0
v_mfma_f32_16x16x32_bf16 v[128:131], a[132:135], a[68:71], v[128:131]
ds_read_b64_tr_b16 a[138:139], v17 offset:2048
buffer_load_dwordx4 v11, s[24:27], s50 offen offset:3072 lds
v_mfma_f32_16x16x32_bf16 v[132:135], a[128:131], a[72:75], v[132:135]
ds_read_b64_tr_b16 a[140:141], v17 offset:16384
s_add_u32 s50, s50, 524288
v_mfma_f32_16x16x32_bf16 v[132:135], a[132:135], a[76:79], v[132:135]
ds_read_b64_tr_b16 a[142:143], v17 offset:18432
v_mfma_f32_16x16x32_bf16 v[136:139], a[128:131], a[80:83], v[136:139]
v_add_u32 v17, s54, v17
s_add_u32 m0, s53, 8192
v_mfma_f32_16x16x32_bf16 v[136:139], a[132:135], a[84:87], v[136:139]
buffer_load_dwordx4 v8, s[24:27], s51 offen offset:0 lds
v_mfma_f32_16x16x32_bf16 v[140:143], a[128:131], a[88:91], v[140:143]
v_mfma_f32_16x16x32_bf16 v[140:143], a[132:135], a[92:95], v[140:143]
v_mfma_f32_16x16x32_bf16 v[144:147], a[128:131], a[96:99], v[144:147]
v_mfma_f32_16x16x32_bf16 v[144:147], a[132:135], a[100:103], v[144:147]
buffer_load_dwordx4 v9, s[24:27], s51 offen offset:1024 lds
v_mfma_f32_16x16x32_bf16 v[148:151], a[128:131], a[104:107], v[148:151]
v_mfma_f32_16x16x32_bf16 v[148:151], a[132:135], a[108:111], v[148:151]
v_mfma_f32_16x16x32_bf16 v[152:155], a[128:131], a[112:115], v[152:155]
v_mfma_f32_16x16x32_bf16 v[152:155], a[132:135], a[116:119], v[152:155]
buffer_load_dwordx4 v10, s[24:27], s51 offen offset:2048 lds
v_mfma_f32_16x16x32_bf16 v[156:159], a[128:131], a[120:123], v[156:159]
v_mfma_f32_16x16x32_bf16 v[156:159], a[132:135], a[124:127], v[156:159]
s_waitcnt lgkmcnt(0)
v_mfma_f32_16x16x32_bf16 v[160:163], a[136:139], a[64:67], v[160:163]
ds_read_b64_tr_b16 a[128:129], v18 offset:0
v_mfma_f32_16x16x32_bf16 v[160:163], a[140:143], a[68:71], v[160:163]
ds_read_b64_tr_b16 a[130:131], v18 offset:2048
buffer_load_dwordx4 v11, s[24:27], s51 offen offset:3072 lds
v_mfma_f32_16x16x32_bf16 v[164:167], a[136:139], a[72:75], v[164:167]
ds_read_b64_tr_b16 a[132:133], v18 offset:16384
s_add_u32 s51, s51, 524288
v_mfma_f32_16x16x32_bf16 v[164:167], a[140:143], a[76:79], v[164:167]
ds_read_b64_tr_b16 a[134:135], v18 offset:18432
v_mfma_f32_16x16x32_bf16 v[168:171], a[136:139], a[80:83], v[168:171]
v_add_u32 v18, s54, v18
v_mfma_f32_16x16x32_bf16 v[168:171], a[140:143], a[84:87], v[168:171]
buffer_store_dwordx4 v[32:35], v28, s[40:43], s7 offen offset:0 sc1
buffer_store_dwordx4 v[36:39], v28, s[40:43], s7 offen offset:64 sc1
v_mfma_f32_16x16x32_bf16 v[172:175], a[136:139], a[88:91], v[172:175]
buffer_store_dwordx4 v[40:43], v28, s[40:43], s7 offen offset:128 sc1
buffer_store_dwordx4 v[44:47], v28, s[40:43], s7 offen offset:192 sc1
v_mfma_f32_16x16x32_bf16 v[172:175], a[140:143], a[92:95], v[172:175]
v_mfma_f32_16x16x32_bf16 v[176:179], a[136:139], a[96:99], v[176:179]
v_mfma_f32_16x16x32_bf16 v[176:179], a[140:143], a[100:103], v[176:179]
v_mfma_f32_16x16x32_bf16 v[180:183], a[136:139], a[104:107], v[180:183]
v_mfma_f32_16x16x32_bf16 v[180:183], a[140:143], a[108:111], v[180:183]
buffer_load_dword a255, v22, s[24:27], 0 offen
v_add_u32 v22, 524288, v22
v_mfma_f32_16x16x32_bf16 v[184:187], a[136:139], a[112:115], v[184:187]
buffer_load_dword a255, v23, s[20:23], 0 offen
v_add_u32 v23, 128, v23
v_mfma_f32_16x16x32_bf16 v[184:187], a[140:143], a[116:119], v[184:187]
s_cmp_lt_u32 s16, 8
s_cselect_b32 s46, s17, 0
s_cselect_b32 s6, 1408, 0
v_mfma_f32_16x16x32_bf16 v[188:191], a[136:139], a[120:123], v[188:191]
s_add_u32 s16, s16, 1
buffer_load_dword a255, v3, s[44:47], 0 offen
v_mfma_f32_16x16x32_bf16 v[188:191], a[140:143], a[124:127], v[188:191]
s_waitcnt lgkmcnt(0)
v_add_u32 v3, s6, v3
v_mfma_f32_16x16x32_bf16 v[192:195], a[128:131], a[64:67], v[192:195]
ds_read_b64_tr_b16 a[136:137], v19 offset:0
v_mfma_f32_16x16x32_bf16 v[192:195], a[132:135], a[68:71], v[192:195]
ds_read_b64_tr_b16 a[138:139], v19 offset:2048
v_mfma_f32_16x16x32_bf16 v[196:199], a[128:131], a[72:75], v[196:199]
ds_read_b64_tr_b16 a[140:141], v19 offset:16384
v_mfma_f32_16x16x32_bf16 v[196:199], a[132:135], a[76:79], v[196:199]
ds_read_b64_tr_b16 a[142:143], v19 offset:18432
v_mfma_f32_16x16x32_bf16 v[200:203], a[128:131], a[80:83], v[200:203]
v_add_u32 v19, s54, v19
v_mfma_f32_16x16x32_bf16 v[200:203], a[132:135], a[84:87], v[200:203]
v_mfma_f32_16x16x32_bf16 v[204:207], a[128:131], a[88:91], v[204:207]
v_mfma_f32_16x16x32_bf16 v[204:207], a[132:135], a[92:95], v[204:207]
v_mfma_f32_16x16x32_bf16 v[208:211], a[128:131], a[96:99], v[208:211]
v_mfma_f32_16x16x32_bf16 v[208:211], a[132:135], a[100:103], v[208:211]
v_mfma_f32_16x16x32_bf16 v[212:215], a[128:131], a[104:107], v[212:215]
v_mfma_f32_16x16x32_bf16 v[212:215], a[132:135], a[108:111], v[212:215]
s_cmp_eq_u32 s53, s69
s_cselect_b32 s54, s58, s59
v_mfma_f32_16x16x32_bf16 v[216:219], a[128:131], a[112:115], v[216:219]
s_add_u32 s53, s53, 32768
s_cmp_eq_u32 s53, s68
s_cselect_b32 s53, s69, s53
v_mfma_f32_16x16x32_bf16 v[216:219], a[132:135], a[116:119], v[216:219]
s_xor_b32 s52, s52, 0x38000
v_mfma_f32_16x16x32_bf16 v[220:223], a[128:131], a[120:123], v[220:223]
v_mfma_f32_16x16x32_bf16 v[220:223], a[132:135], a[124:127], v[220:223]
s_waitcnt vmcnt(26)
s_barrier
s_waitcnt lgkmcnt(0)
v_mfma_f32_16x16x32_bf16 v[224:227], a[136:139], a[64:67], v[224:227]
ds_read_b64_tr_b16 a[128:129], v12 offset:0
ds_read_b128 a[64:67], v20 offset:0
v_mfma_f32_16x16x32_bf16 v[224:227], a[140:143], a[68:71], v[224:227]
ds_read_b64_tr_b16 a[130:131], v12 offset:2048
ds_read_b128 a[68:71], v21 offset:0
v_mfma_f32_16x16x32_bf16 v[228:231], a[136:139], a[72:75], v[228:231]
ds_read_b64_tr_b16 a[132:133], v12 offset:16384
ds_read_b128 a[72:75], v20 offset:2048
v_mfma_f32_16x16x32_bf16 v[228:231], a[140:143], a[76:79], v[228:231]
ds_read_b64_tr_b16 a[134:135], v12 offset:18432
ds_read_b128 a[76:79], v21 offset:2048
v_mfma_f32_16x16x32_bf16 v[232:235], a[136:139], a[80:83], v[232:235]
v_add_u32 v12, s54, v12
ds_read_b128 a[80:83], v20 offset:4096
v_mfma_f32_16x16x32_bf16 v[232:235], a[140:143], a[84:87], v[232:235]
ds_read_b128 a[84:87], v21 offset:4096
v_mfma_f32_16x16x32_bf16 v[236:239], a[136:139], a[88:91], v[236:239]
ds_read_b128 a[88:91], v20 offset:6144
v_mfma_f32_16x16x32_bf16 v[236:239], a[140:143], a[92:95], v[236:239]
ds_read_b128 a[92:95], v21 offset:6144
v_mfma_f32_16x16x32_bf16 v[240:243], a[136:139], a[96:99], v[240:243]
ds_read_b128 a[96:99], v20 offset:8192
v_mfma_f32_16x16x32_bf16 v[240:243], a[140:143], a[100:103], v[240:243]
ds_read_b128 a[100:103], v21 offset:8192
v_mfma_f32_16x16x32_bf16 v[244:247], a[136:139], a[104:107], v[244:247]
ds_read_b128 a[104:107], v20 offset:10240
v_mfma_f32_16x16x32_bf16 v[244:247], a[140:143], a[108:111], v[244:247]
ds_read_b128 a[108:111], v21 offset:10240
v_mfma_f32_16x16x32_bf16 v[248:251], a[136:139], a[112:115], v[248:251]
ds_read_b128 a[112:115], v20 offset:12288
v_mfma_f32_16x16x32_bf16 v[248:251], a[140:143], a[116:119], v[248:251]
ds_read_b128 a[116:119], v21 offset:12288
v_mfma_f32_16x16x32_bf16 v[252:255], a[136:139], a[120:123], v[252:255]
ds_read_b128 a[120:123], v20 offset:14336
v_mfma_f32_16x16x32_bf16 v[252:255], a[140:143], a[124:127], v[252:255]
ds_read_b128 a[124:127], v21 offset:14336
v_xor_b32 v20, 0x38000, v20
v_xor_b32 v21, 0x38000, v21
s_waitcnt lgkmcnt(12)
v_mfma_f32_16x16x32_bf16 a[0:3], a[128:131], a[64:67], a[0:3]
ds_read_b64_tr_b16 a[136:137], v13 offset:0
v_mfma_f32_16x16x32_bf16 a[0:3], a[132:135], a[68:71], a[0:3]
ds_read_b64_tr_b16 a[138:139], v13 offset:2048
v_mfma_f32_16x16x32_bf16 a[4:7], a[128:131], a[72:75], a[4:7]
ds_read_b64_tr_b16 a[140:141], v13 offset:16384
v_mfma_f32_16x16x32_bf16 a[4:7], a[132:135], a[76:79], a[4:7]
s_waitcnt lgkmcnt(11)
ds_read_b64_tr_b16 a[142:143], v13 offset:18432
v_mfma_f32_16x16x32_bf16 a[8:11], a[128:131], a[80:83], a[8:11]
v_add_u32 v13, s54, v13
v_mfma_f32_16x16x32_bf16 a[8:11], a[132:135], a[84:87], a[8:11]
v_mfma_f32_16x16x32_bf16 a[12:15], a[128:131], a[88:91], a[12:15]
v_mfma_f32_16x16x32_bf16 a[12:15], a[132:135], a[92:95], a[12:15]
s_waitcnt lgkmcnt(8)
v_mfma_f32_16x16x32_bf16 a[16:19], a[128:131], a[96:99], a[16:19]
v_mfma_f32_16x16x32_bf16 a[16:19], a[132:135], a[100:103], a[16:19]
v_mfma_f32_16x16x32_bf16 a[20:23], a[128:131], a[104:107], a[20:23]
v_mfma_f32_16x16x32_bf16 a[20:23], a[132:135], a[108:111], a[20:23]
s_waitcnt lgkmcnt(4)
v_mfma_f32_16x16x32_bf16 a[24:27], a[128:131], a[112:115], a[24:27]
v_mfma_f32_16x16x32_bf16 a[24:27], a[132:135], a[116:119], a[24:27]
v_mfma_f32_16x16x32_bf16 a[28:31], a[128:131], a[120:123], a[28:31]
v_mfma_f32_16x16x32_bf16 a[28:31], a[132:135], a[124:127], a[28:31]
s_waitcnt lgkmcnt(0)
s_barrier
v_mfma_f32_16x16x32_bf16 a[32:35], a[136:139], a[64:67], a[32:35]
ds_read_b64_tr_b16 a[128:129], v14 offset:0
v_mfma_f32_16x16x32_bf16 a[32:35], a[140:143], a[68:71], a[32:35]
ds_read_b64_tr_b16 a[130:131], v14 offset:2048
v_mfma_f32_16x16x32_bf16 a[36:39], a[136:139], a[72:75], a[36:39]
ds_read_b64_tr_b16 a[132:133], v14 offset:16384
v_mfma_f32_16x16x32_bf16 a[36:39], a[140:143], a[76:79], a[36:39]
ds_read_b64_tr_b16 a[134:135], v14 offset:18432
v_mfma_f32_16x16x32_bf16 a[40:43], a[136:139], a[80:83], a[40:43]
v_add_u32 v14, s54, v14
s_mov_b32 m0, s52
v_mfma_f32_16x16x32_bf16 a[40:43], a[140:143], a[84:87], a[40:43]
buffer_load_dwordx4 v4, s[20:23], s48 offen offset:0 lds
v_mfma_f32_16x16x32_bf16 a[44:47], a[136:139], a[88:91], a[44:47]
v_mfma_f32_16x16x32_bf16 a[44:47], a[140:143], a[92:95], a[44:47]
v_mfma_f32_16x16x32_bf16 a[48:51], a[136:139], a[96:99], a[48:51]
v_mfma_f32_16x16x32_bf16 a[48:51], a[140:143], a[100:103], a[48:51]
buffer_load_dwordx4 v5, s[20:23], s48 offen offset:1024 lds
v_mfma_f32_16x16x32_bf16 a[52:55], a[136:139], a[104:107], a[52:55]
v_mfma_f32_16x16x32_bf16 a[52:55], a[140:143], a[108:111], a[52:55]
v_mfma_f32_16x16x32_bf16 a[56:59], a[136:139], a[112:115], a[56:59]
v_mfma_f32_16x16x32_bf16 a[56:59], a[140:143], a[116:119], a[56:59]
buffer_load_dwordx4 v6, s[20:23], s48 offen offset:2048 lds
v_mfma_f32_16x16x32_bf16 a[60:63], a[136:139], a[120:123], a[60:63]
v_mfma_f32_16x16x32_bf16 a[60:63], a[140:143], a[124:127], a[60:63]
s_waitcnt lgkmcnt(0)
v_mfma_f32_16x16x32_bf16 v[64:67], a[128:131], a[64:67], v[64:67]
ds_read_b64_tr_b16 a[136:137], v15 offset:0
v_mfma_f32_16x16x32_bf16 v[64:67], a[132:135], a[68:71], v[64:67]
ds_read_b64_tr_b16 a[138:139], v15 offset:2048
buffer_load_dwordx4 v7, s[20:23], s48 offen offset:3072 lds
v_mfma_f32_16x16x32_bf16 v[68:71], a[128:131], a[72:75], v[68:71]
ds_read_b64_tr_b16 a[140:141], v15 offset:16384
s_add_u32 s48, s48, 128
v_mfma_f32_16x16x32_bf16 v[68:71], a[132:135], a[76:79], v[68:71]
ds_read_b64_tr_b16 a[142:143], v15 offset:18432
v_mfma_f32_16x16x32_bf16 v[72:75], a[128:131], a[80:83], v[72:75]
v_add_u32 v15, s54, v15
s_add_u32 m0, s52, 4096
v_mfma_f32_16x16x32_bf16 v[72:75], a[132:135], a[84:87], v[72:75]
buffer_load_dwordx4 v4, s[20:23], s49 offen offset:0 lds
v_mfma_f32_16x16x32_bf16 v[76:79], a[128:131], a[88:91], v[76:79]
v_mfma_f32_16x16x32_bf16 v[76:79], a[132:135], a[92:95], v[76:79]
v_mfma_f32_16x16x32_bf16 v[80:83], a[128:131], a[96:99], v[80:83]
v_mfma_f32_16x16x32_bf16 v[80:83], a[132:135], a[100:103], v[80:83]
buffer_load_dwordx4 v5, s[20:23], s49 offen offset:1024 lds
v_mfma_f32_16x16x32_bf16 v[84:87], a[128:131], a[104:107], v[84:87]
v_mfma_f32_16x16x32_bf16 v[84:87], a[132:135], a[108:111], v[84:87]
v_mfma_f32_16x16x32_bf16 v[88:91], a[128:131], a[112:115], v[88:91]
v_mfma_f32_16x16x32_bf16 v[88:91], a[132:135], a[116:119], v[88:91]
buffer_load_dwordx4 v6, s[20:23], s49 offen offset:2048 lds
v_mfma_f32_16x16x32_bf16 v[92:95], a[128:131], a[120:123], v[92:95]
v_mfma_f32_16x16x32_bf16 v[92:95], a[132:135], a[124:127], v[92:95]
s_waitcnt lgkmcnt(0)
v_mfma_f32_16x16x32_bf16 v[96:99], a[136:139], a[64:67], v[96:99]
ds_read_b64_tr_b16 a[128:129], v16 offset:0
v_mfma_f32_16x16x32_bf16 v[96:99], a[140:143], a[68:71], v[96:99]
ds_read_b64_tr_b16 a[130:131], v16 offset:2048
buffer_load_dwordx4 v7, s[20:23], s49 offen offset:3072 lds
v_mfma_f32_16x16x32_bf16 v[100:103], a[136:139], a[72:75], v[100:103]
ds_read_b64_tr_b16 a[132:133], v16 offset:16384
s_add_u32 s49, s49, 128
v_mfma_f32_16x16x32_bf16 v[100:103], a[140:143], a[76:79], v[100:103]
ds_read_b64_tr_b16 a[134:135], v16 offset:18432
v_mfma_f32_16x16x32_bf16 v[104:107], a[136:139], a[80:83], v[104:107]
v_add_u32 v16, s54, v16
s_mov_b32 m0, s53
v_mfma_f32_16x16x32_bf16 v[104:107], a[140:143], a[84:87], v[104:107]
buffer_load_dwordx4 v8, s[24:27], s50 offen offset:0 lds
v_mfma_f32_16x16x32_bf16 v[108:111], a[136:139], a[88:91], v[108:111]
v_mfma_f32_16x16x32_bf16 v[108:111], a[140:143], a[92:95], v[108:111]
v_mfma_f32_16x16x32_bf16 v[112:115], a[136:139], a[96:99], v[112:115]
v_mfma_f32_16x16x32_bf16 v[112:115], a[140:143], a[100:103], v[112:115]
buffer_load_dwordx4 v9, s[24:27], s50 offen offset:1024 lds
v_mfma_f32_16x16x32_bf16 v[116:119], a[136:139], a[104:107], v[116:119]
v_mfma_f32_16x16x32_bf16 v[116:119], a[140:143], a[108:111], v[116:119]
v_mfma_f32_16x16x32_bf16 v[120:123], a[136:139], a[112:115], v[120:123]
v_mfma_f32_16x16x32_bf16 v[120:123], a[140:143], a[116:119], v[120:123]
buffer_load_dwordx4 v10, s[24:27], s50 offen offset:2048 lds
v_mfma_f32_16x16x32_bf16 v[124:127], a[136:139], a[120:123], v[124:127]
v_mfma_f32_16x16x32_bf16 v[124:127], a[140:143], a[124:127], v[124:127]
s_waitcnt lgkmcnt(0)
v_mfma_f32_16x16x32_bf16 v[128:131], a[128:131], a[64:67], v[128:131]
ds_read_b64_tr_b16 a[136:137], v17 offset:0
v_mfma_f32_16x16x32_bf16 v[128:131], a[132:135], a[68:71], v[128:131]
ds_read_b64_tr_b16 a[138:139], v17 offset:2048
buffer_load_dwordx4 v11, s[24:27], s50 offen offset:3072 lds
v_mfma_f32_16x16x32_bf16 v[132:135], a[128:131], a[72:75], v[132:135]
ds_read_b64_tr_b16 a[140:141], v17 offset:16384
s_add_u32 s50, s50, 524288
v_mfma_f32_16x16x32_bf16 v[132:135], a[132:135], a[76:79], v[132:135]
ds_read_b64_tr_b16 a[142:143], v17 offset:18432
v_mfma_f32_16x16x32_bf16 v[136:139], a[128:131], a[80:83], v[136:139]
v_add_u32 v17, s54, v17
s_add_u32 m0, s53, 8192
v_mfma_f32_16x16x32_bf16 v[136:139], a[132:135], a[84:87], v[136:139]
buffer_load_dwordx4 v8, s[24:27], s51 offen offset:0 lds
v_mfma_f32_16x16x32_bf16 v[140:143], a[128:131], a[88:91], v[140:143]
v_mfma_f32_16x16x32_bf16 v[140:143], a[132:135], a[92:95], v[140:143]
v_mfma_f32_16x16x32_bf16 v[144:147], a[128:131], a[96:99], v[144:147]
v_mfma_f32_16x16x32_bf16 v[144:147], a[132:135], a[100:103], v[144:147]
buffer_load_dwordx4 v9, s[24:27], s51 offen offset:1024 lds
v_mfma_f32_16x16x32_bf16 v[148:151], a[128:131], a[104:107], v[148:151]
v_mfma_f32_16x16x32_bf16 v[148:151], a[132:135], a[108:111], v[148:151]
v_mfma_f32_16x16x32_bf16 v[152:155], a[128:131], a[112:115], v[152:155]
v_mfma_f32_16x16x32_bf16 v[152:155], a[132:135], a[116:119], v[152:155]
buffer_load_dwordx4 v10, s[24:27], s51 offen offset:2048 lds
v_mfma_f32_16x16x32_bf16 v[156:159], a[128:131], a[120:123], v[156:159]
v_mfma_f32_16x16x32_bf16 v[156:159], a[132:135], a[124:127], v[156:159]
s_waitcnt lgkmcnt(0)
v_mfma_f32_16x16x32_bf16 v[160:163], a[136:139], a[64:67], v[160:163]
ds_read_b64_tr_b16 a[128:129], v18 offset:0
v_mfma_f32_16x16x32_bf16 v[160:163], a[140:143], a[68:71], v[160:163]
ds_read_b64_tr_b16 a[130:131], v18 offset:2048
buffer_load_dwordx4 v11, s[24:27], s51 offen offset:3072 lds
v_mfma_f32_16x16x32_bf16 v[164:167], a[136:139], a[72:75], v[164:167]
ds_read_b64_tr_b16 a[132:133], v18 offset:16384
s_add_u32 s51, s51, 524288
v_mfma_f32_16x16x32_bf16 v[164:167], a[140:143], a[76:79], v[164:167]
ds_read_b64_tr_b16 a[134:135], v18 offset:18432
v_mfma_f32_16x16x32_bf16 v[168:171], a[136:139], a[80:83], v[168:171]
v_add_u32 v18, s54, v18
v_mfma_f32_16x16x32_bf16 v[168:171], a[140:143], a[84:87], v[168:171]
v_mfma_f32_16x16x32_bf16 v[172:175], a[136:139], a[88:91], v[172:175]
v_mfma_f32_16x16x32_bf16 v[172:175], a[140:143], a[92:95], v[172:175]
v_mfma_f32_16x16x32_bf16 v[176:179], a[136:139], a[96:99], v[176:179]
v_mfma_f32_16x16x32_bf16 v[176:179], a[140:143], a[100:103], v[176:179]
v_mfma_f32_16x16x32_bf16 v[180:183], a[136:139], a[104:107], v[180:183]
v_mfma_f32_16x16x32_bf16 v[180:183], a[140:143], a[108:111], v[180:183]
buffer_load_dword a255, v22, s[24:27], 0 offen
v_add_u32 v22, 524288, v22
v_mfma_f32_16x16x32_bf16 v[184:187], a[136:139], a[112:115], v[184:187]
buffer_load_dword a255, v23, s[20:23], 0 offen
v_add_u32 v23, 128, v23
v_mfma_f32_16x16x32_bf16 v[184:187], a[140:143], a[116:119], v[184:187]
s_cmp_lt_u32 s16, 8
s_cselect_b32 s46, s17, 0
s_cselect_b32 s6, 1408, 0
v_mfma_f32_16x16x32_bf16 v[188:191], a[136:139], a[120:123], v[188:191]
s_add_u32 s16, s16, 1
buffer_load_dword a255, v3, s[44:47], 0 offen
v_mfma_f32_16x16x32_bf16 v[188:191], a[140:143], a[124:127], v[188:191]
s_waitcnt lgkmcnt(0)
v_add_u32 v3, s6, v3
v_mfma_f32_16x16x32_bf16 v[192:195], a[128:131], a[64:67], v[192:195]
ds_read_b64_tr_b16 a[136:137], v19 offset:0
v_mfma_f32_16x16x32_bf16 v[192:195], a[132:135], a[68:71], v[192:195]
ds_read_b64_tr_b16 a[138:139], v19 offset:2048
v_mfma_f32_16x16x32_bf16 v[196:199], a[128:131], a[72:75], v[196:199]
ds_read_b64_tr_b16 a[140:141], v19 offset:16384
v_mfma_f32_16x16x32_bf16 v[196:199], a[132:135], a[76:79], v[196:199]
ds_read_b64_tr_b16 a[142:143], v19 offset:18432
v_mfma_f32_16x16x32_bf16 v[200:203], a[128:131], a[80:83], v[200:203]
v_add_u32 v19, s54, v19
v_mfma_f32_16x16x32_bf16 v[200:203], a[132:135], a[84:87], v[200:203]
v_mfma_f32_16x16x32_bf16 v[204:207], a[128:131], a[88:91], v[204:207]
v_mfma_f32_16x16x32_bf16 v[204:207], a[132:135], a[92:95], v[204:207]
v_mfma_f32_16x16x32_bf16 v[208:211], a[128:131], a[96:99], v[208:211]
v_mfma_f32_16x16x32_bf16 v[208:211], a[132:135], a[100:103], v[208:211]
v_mfma_f32_16x16x32_bf16 v[212:215], a[128:131], a[104:107], v[212:215]
v_mfma_f32_16x16x32_bf16 v[212:215], a[132:135], a[108:111], v[212:215]
s_cmp_eq_u32 s53, s69
s_cselect_b32 s54, s58, s59
v_mfma_f32_16x16x32_bf16 v[216:219], a[128:131], a[112:115], v[216:219]
s_add_u32 s53, s53, 32768
s_cmp_eq_u32 s53, s68
s_cselect_b32 s53, s69, s53
v_mfma_f32_16x16x32_bf16 v[216:219], a[132:135], a[116:119], v[216:219]
s_xor_b32 s52, s52, 0x38000
v_mfma_f32_16x16x32_bf16 v[220:223], a[128:131], a[120:123], v[220:223]
v_mfma_f32_16x16x32_bf16 v[220:223], a[132:135], a[124:127], v[220:223]
s_waitcnt vmcnt(22)
s_barrier
s_waitcnt lgkmcnt(0)
v_mfma_f32_16x16x32_bf16 v[224:227], a[136:139], a[64:67], v[224:227]
ds_read_b64_tr_b16 a[128:129], v12 offset:0
ds_read_b128 a[64:67], v20 offset:0
v_mfma_f32_16x16x32_bf16 v[224:227], a[140:143], a[68:71], v[224:227]
ds_read_b64_tr_b16 a[130:131], v12 offset:2048
ds_read_b128 a[68:71], v21 offset:0
v_mfma_f32_16x16x32_bf16 v[228:231], a[136:139], a[72:75], v[228:231]
ds_read_b64_tr_b16 a[132:133], v12 offset:16384
ds_read_b128 a[72:75], v20 offset:2048
v_mfma_f32_16x16x32_bf16 v[228:231], a[140:143], a[76:79], v[228:231]
ds_read_b64_tr_b16 a[134:135], v12 offset:18432
ds_read_b128 a[76:79], v21 offset:2048
v_mfma_f32_16x16x32_bf16 v[232:235], a[136:139], a[80:83], v[232:235]
v_add_u32 v12, s54, v12
ds_read_b128 a[80:83], v20 offset:4096
v_mfma_f32_16x16x32_bf16 v[232:235], a[140:143], a[84:87], v[232:235]
ds_read_b128 a[84:87], v21 offset:4096
v_mfma_f32_16x16x32_bf16 v[236:239], a[136:139], a[88:91], v[236:239]
ds_read_b128 a[88:91], v20 offset:6144
v_mfma_f32_16x16x32_bf16 v[236:239], a[140:143], a[92:95], v[236:239]
ds_read_b128 a[92:95], v21 offset:6144
v_mfma_f32_16x16x32_bf16 v[240:243], a[136:139], a[96:99], v[240:243]
ds_read_b128 a[96:99], v20 offset:8192
v_mfma_f32_16x16x32_bf16 v[240:243], a[140:143], a[100:103], v[240:243]
ds_read_b128 a[100:103], v21 offset:8192
v_mfma_f32_16x16x32_bf16 v[244:247], a[136:139], a[104:107], v[244:247]
ds_read_b128 a[104:107], v20 offset:10240
v_mfma_f32_16x16x32_bf16 v[244:247], a[140:143], a[108:111], v[244:247]
ds_read_b128 a[108:111], v21 offset:10240
v_mfma_f32_16x16x32_bf16 v[248:251], a[136:139], a[112:115], v[248:251]
ds_read_b128 a[112:115], v20 offset:12288
v_mfma_f32_16x16x32_bf16 v[248:251], a[140:143], a[116:119], v[248:251]
ds_read_b128 a[116:119], v21 offset:12288
v_mfma_f32_16x16x32_bf16 v[252:255], a[136:139], a[120:123], v[252:255]
ds_read_b128 a[120:123], v20 offset:14336
v_mfma_f32_16x16x32_bf16 v[252:255], a[140:143], a[124:127], v[252:255]
ds_read_b128 a[124:127], v21 offset:14336
v_xor_b32 v20, 0x38000, v20
v_xor_b32 v21, 0x38000, v21
s_waitcnt lgkmcnt(12)
v_mfma_f32_16x16x32_bf16 a[0:3], a[128:131], a[64:67], a[0:3]
ds_read_b64_tr_b16 a[136:137], v13 offset:0
s_lshr_b32 s70, s57, 2
v_mfma_f32_16x16x32_bf16 a[0:3], a[132:135], a[68:71], a[0:3]
ds_read_b64_tr_b16 a[138:139], v13 offset:2048
s_and_b32 s71, s70, 7
v_mfma_f32_16x16x32_bf16 a[4:7], a[128:131], a[72:75], a[4:7]
ds_read_b64_tr_b16 a[140:141], v13 offset:16384
s_add_u32 s71, s71, 16
v_mfma_f32_16x16x32_bf16 a[4:7], a[132:135], a[76:79], a[4:7]
s_waitcnt lgkmcnt(11)
ds_read_b64_tr_b16 a[142:143], v13 offset:18432
v_mfma_f32_16x16x32_bf16 a[8:11], a[128:131], a[80:83], a[8:11]
v_add_u32 v13, s54, v13
s_lshl_b32 s71, 1, s71
v_mfma_f32_16x16x32_bf16 a[8:11], a[132:135], a[84:87], a[8:11]
s_lshr_b32 s70, s70, 3
s_lshl_b32 s70, s70, 7
v_mfma_f32_16x16x32_bf16 a[12:15], a[128:131], a[88:91], a[12:15]
s_add_u32 s70, s70, 36831232
v_cmp_eq_u32 vcc, 0, v0
v_mfma_f32_16x16x32_bf16 a[12:15], a[132:135], a[92:95], a[12:15]
s_waitcnt lgkmcnt(8)
v_mov_b32 v31, s71
v_mfma_f32_16x16x32_bf16 a[16:19], a[128:131], a[96:99], a[16:19]
v_lshlrev_b32 v30, 6, v29
v_cndmask_b32 v30, v30, 0, vcc
v_mfma_f32_16x16x32_bf16 a[16:19], a[132:135], a[100:103], a[16:19]
buffer_atomic_or v31, v30, s[12:15], s70 offen sc1
v_mfma_f32_16x16x32_bf16 a[20:23], a[128:131], a[104:107], a[20:23]
v_mfma_f32_16x16x32_bf16 a[20:23], a[132:135], a[108:111], a[20:23]
s_waitcnt lgkmcnt(4)
v_mfma_f32_16x16x32_bf16 a[24:27], a[128:131], a[112:115], a[24:27]
v_mfma_f32_16x16x32_bf16 a[24:27], a[132:135], a[116:119], a[24:27]
v_mfma_f32_16x16x32_bf16 a[28:31], a[128:131], a[120:123], a[28:31]
v_mfma_f32_16x16x32_bf16 a[28:31], a[132:135], a[124:127], a[28:31]
s_waitcnt lgkmcnt(0)
s_barrier
v_mfma_f32_16x16x32_bf16 a[32:35], a[136:139], a[64:67], a[32:35]
ds_read_b64_tr_b16 a[128:129], v14 offset:0
v_mfma_f32_16x16x32_bf16 a[32:35], a[140:143], a[68:71], a[32:35]
ds_read_b64_tr_b16 a[130:131], v14 offset:2048
v_mfma_f32_16x16x32_bf16 a[36:39], a[136:139], a[72:75], a[36:39]
ds_read_b64_tr_b16 a[132:133], v14 offset:16384
v_mfma_f32_16x16x32_bf16 a[36:39], a[140:143], a[76:79], a[36:39]
ds_read_b64_tr_b16 a[134:135], v14 offset:18432
v_mfma_f32_16x16x32_bf16 a[40:43], a[136:139], a[80:83], a[40:43]
v_add_u32 v14, s54, v14
s_mov_b32 m0, s52
v_mfma_f32_16x16x32_bf16 a[40:43], a[140:143], a[84:87], a[40:43]
buffer_load_dwordx4 v4, s[20:23], s48 offen offset:0 lds
v_mfma_f32_16x16x32_bf16 a[44:47], a[136:139], a[88:91], a[44:47]
v_mfma_f32_16x16x32_bf16 a[44:47], a[140:143], a[92:95], a[44:47]
v_mfma_f32_16x16x32_bf16 a[48:51], a[136:139], a[96:99], a[48:51]
v_mfma_f32_16x16x32_bf16 a[48:51], a[140:143], a[100:103], a[48:51]
buffer_load_dwordx4 v5, s[20:23], s48 offen offset:1024 lds
v_mfma_f32_16x16x32_bf16 a[52:55], a[136:139], a[104:107], a[52:55]
v_mfma_f32_16x16x32_bf16 a[52:55], a[140:143], a[108:111], a[52:55]
v_mfma_f32_16x16x32_bf16 a[56:59], a[136:139], a[112:115], a[56:59]
v_mfma_f32_16x16x32_bf16 a[56:59], a[140:143], a[116:119], a[56:59]
buffer_load_dwordx4 v6, s[20:23], s48 offen offset:2048 lds
v_mfma_f32_16x16x32_bf16 a[60:63], a[136:139], a[120:123], a[60:63]
v_mfma_f32_16x16x32_bf16 a[60:63], a[140:143], a[124:127], a[60:63]
s_waitcnt lgkmcnt(0)
v_mfma_f32_16x16x32_bf16 v[64:67], a[128:131], a[64:67], v[64:67]
ds_read_b64_tr_b16 a[136:137], v15 offset:0
v_mfma_f32_16x16x32_bf16 v[64:67], a[132:135], a[68:71], v[64:67]
ds_read_b64_tr_b16 a[138:139], v15 offset:2048
buffer_load_dwordx4 v7, s[20:23], s48 offen offset:3072 lds
v_mfma_f32_16x16x32_bf16 v[68:71], a[128:131], a[72:75], v[68:71]
ds_read_b64_tr_b16 a[140:141], v15 offset:16384
s_add_u32 s48, s48, 128
v_mfma_f32_16x16x32_bf16 v[68:71], a[132:135], a[76:79], v[68:71]
ds_read_b64_tr_b16 a[142:143], v15 offset:18432
v_mfma_f32_16x16x32_bf16 v[72:75], a[128:131], a[80:83], v[72:75]
v_add_u32 v15, s54, v15
s_add_u32 m0, s52, 4096
v_mfma_f32_16x16x32_bf16 v[72:75], a[132:135], a[84:87], v[72:75]
buffer_load_dwordx4 v4, s[20:23], s49 offen offset:0 lds
v_mfma_f32_16x16x32_bf16 v[76:79], a[128:131], a[88:91], v[76:79]
v_mfma_f32_16x16x32_bf16 v[76:79], a[132:135], a[92:95], v[76:79]
v_mfma_f32_16x16x32_bf16 v[80:83], a[128:131], a[96:99], v[80:83]
v_mfma_f32_16x16x32_bf16 v[80:83], a[132:135], a[100:103], v[80:83]
buffer_load_dwordx4 v5, s[20:23], s49 offen offset:1024 lds
v_mfma_f32_16x16x32_bf16 v[84:87], a[128:131], a[104:107], v[84:87]
v_mfma_f32_16x16x32_bf16 v[84:87], a[132:135], a[108:111], v[84:87]
v_mfma_f32_16x16x32_bf16 v[88:91], a[128:131], a[112:115], v[88:91]
v_mfma_f32_16x16x32_bf16 v[88:91], a[132:135], a[116:119], v[88:91]
buffer_load_dwordx4 v6, s[20:23], s49 offen offset:2048 lds
v_mfma_f32_16x16x32_bf16 v[92:95], a[128:131], a[120:123], v[92:95]
v_mfma_f32_16x16x32_bf16 v[92:95], a[132:135], a[124:127], v[92:95]
s_waitcnt lgkmcnt(0)
v_mfma_f32_16x16x32_bf16 v[96:99], a[136:139], a[64:67], v[96:99]
ds_read_b64_tr_b16 a[128:129], v16 offset:0
v_mfma_f32_16x16x32_bf16 v[96:99], a[140:143], a[68:71], v[96:99]
ds_read_b64_tr_b16 a[130:131], v16 offset:2048
buffer_load_dwordx4 v7, s[20:23], s49 offen offset:3072 lds
v_mfma_f32_16x16x32_bf16 v[100:103], a[136:139], a[72:75], v[100:103]
ds_read_b64_tr_b16 a[132:133], v16 offset:16384
s_add_u32 s49, s49, 128
v_mfma_f32_16x16x32_bf16 v[100:103], a[140:143], a[76:79], v[100:103]
ds_read_b64_tr_b16 a[134:135], v16 offset:18432
v_mfma_f32_16x16x32_bf16 v[104:107], a[136:139], a[80:83], v[104:107]
v_add_u32 v16, s54, v16
s_mov_b32 m0, s53
v_mfma_f32_16x16x32_bf16 v[104:107], a[140:143], a[84:87], v[104:107]
buffer_load_dwordx4 v8, s[24:27], s50 offen offset:0 lds
v_mfma_f32_16x16x32_bf16 v[108:111], a[136:139], a[88:91], v[108:111]
v_mfma_f32_16x16x32_bf16 v[108:111], a[140:143], a[92:95], v[108:111]
v_mfma_f32_16x16x32_bf16 v[112:115], a[136:139], a[96:99], v[112:115]
v_mfma_f32_16x16x32_bf16 v[112:115], a[140:143], a[100:103], v[112:115]
buffer_load_dwordx4 v9, s[24:27], s50 offen offset:1024 lds
v_mfma_f32_16x16x32_bf16 v[116:119], a[136:139], a[104:107], v[116:119]
v_mfma_f32_16x16x32_bf16 v[116:119], a[140:143], a[108:111], v[116:119]
v_mfma_f32_16x16x32_bf16 v[120:123], a[136:139], a[112:115], v[120:123]
v_mfma_f32_16x16x32_bf16 v[120:123], a[140:143], a[116:119], v[120:123]
buffer_load_dwordx4 v10, s[24:27], s50 offen offset:2048 lds
v_mfma_f32_16x16x32_bf16 v[124:127], a[136:139], a[120:123], v[124:127]
v_mfma_f32_16x16x32_bf16 v[124:127], a[140:143], a[124:127], v[124:127]
s_waitcnt lgkmcnt(0)
v_mfma_f32_16x16x32_bf16 v[128:131], a[128:131], a[64:67], v[128:131]
ds_read_b64_tr_b16 a[136:137], v17 offset:0
v_mfma_f32_16x16x32_bf16 v[128:131], a[132:135], a[68:71], v[128:131]
ds_read_b64_tr_b16 a[138:139], v17 offset:2048
buffer_load_dwordx4 v11, s[24:27], s50 offen offset:3072 lds
v_mfma_f32_16x16x32_bf16 v[132:135], a[128:131], a[72:75], v[132:135]
ds_read_b64_tr_b16 a[140:141], v17 offset:16384
s_add_u32 s50, s50, 524288
v_mfma_f32_16x16x32_bf16 v[132:135], a[132:135], a[76:79], v[132:135]
ds_read_b64_tr_b16 a[142:143], v17 offset:18432
v_mfma_f32_16x16x32_bf16 v[136:139], a[128:131], a[80:83], v[136:139]
v_add_u32 v17, s54, v17
s_add_u32 m0, s53, 8192
v_mfma_f32_16x16x32_bf16 v[136:139], a[132:135], a[84:87], v[136:139]
buffer_load_dwordx4 v8, s[24:27], s51 offen offset:0 lds
v_mfma_f32_16x16x32_bf16 v[140:143], a[128:131], a[88:91], v[140:143]
v_mfma_f32_16x16x32_bf16 v[140:143], a[132:135], a[92:95], v[140:143]
v_mfma_f32_16x16x32_bf16 v[144:147], a[128:131], a[96:99], v[144:147]
v_mfma_f32_16x16x32_bf16 v[144:147], a[132:135], a[100:103], v[144:147]
buffer_load_dwordx4 v9, s[24:27], s51 offen offset:1024 lds
v_mfma_f32_16x16x32_bf16 v[148:151], a[128:131], a[104:107], v[148:151]
v_mfma_f32_16x16x32_bf16 v[148:151], a[132:135], a[108:111], v[148:151]
v_mfma_f32_16x16x32_bf16 v[152:155], a[128:131], a[112:115], v[152:155]
v_mfma_f32_16x16x32_bf16 v[152:155], a[132:135], a[116:119], v[152:155]
buffer_load_dwordx4 v10, s[24:27], s51 offen offset:2048 lds
v_mfma_f32_16x16x32_bf16 v[156:159], a[128:131], a[120:123], v[156:159]
v_mfma_f32_16x16x32_bf16 v[156:159], a[132:135], a[124:127], v[156:159]
s_waitcnt lgkmcnt(0)
v_mfma_f32_16x16x32_bf16 v[160:163], a[136:139], a[64:67], v[160:163]
ds_read_b64_tr_b16 a[128:129], v18 offset:0
v_mfma_f32_16x16x32_bf16 v[160:163], a[140:143], a[68:71], v[160:163]
ds_read_b64_tr_b16 a[130:131], v18 offset:2048
buffer_load_dwordx4 v11, s[24:27], s51 offen offset:3072 lds
v_mfma_f32_16x16x32_bf16 v[164:167], a[136:139], a[72:75], v[164:167]
ds_read_b64_tr_b16 a[132:133], v18 offset:16384
s_add_u32 s51, s51, 524288
v_mfma_f32_16x16x32_bf16 v[164:167], a[140:143], a[76:79], v[164:167]
ds_read_b64_tr_b16 a[134:135], v18 offset:18432
v_mfma_f32_16x16x32_bf16 v[168:171], a[136:139], a[80:83], v[168:171]
v_add_u32 v18, s54, v18
v_mfma_f32_16x16x32_bf16 v[168:171], a[140:143], a[84:87], v[168:171]
v_mfma_f32_16x16x32_bf16 v[172:175], a[136:139], a[88:91], v[172:175]
v_mfma_f32_16x16x32_bf16 v[172:175], a[140:143], a[92:95], v[172:175]
v_mfma_f32_16x16x32_bf16 v[176:179], a[136:139], a[96:99], v[176:179]
v_mfma_f32_16x16x32_bf16 v[176:179], a[140:143], a[100:103], v[176:179]
v_mfma_f32_16x16x32_bf16 v[180:183], a[136:139], a[104:107], v[180:183]
v_mfma_f32_16x16x32_bf16 v[180:183], a[140:143], a[108:111], v[180:183]
buffer_load_dword a255, v22, s[24:27], 0 offen
v_add_u32 v22, 524288, v22
v_mfma_f32_16x16x32_bf16 v[184:187], a[136:139], a[112:115], v[184:187]
buffer_load_dword a255, v23, s[20:23], 0 offen
v_add_u32 v23, 128, v23
v_mfma_f32_16x16x32_bf16 v[184:187], a[140:143], a[116:119], v[184:187]
s_cmp_lt_u32 s16, 8
s_cselect_b32 s46, s17, 0
s_cselect_b32 s6, 1408, 0
v_mfma_f32_16x16x32_bf16 v[188:191], a[136:139], a[120:123], v[188:191]
s_add_u32 s16, s16, 1
buffer_load_dword a255, v3, s[44:47], 0 offen
v_mfma_f32_16x16x32_bf16 v[188:191], a[140:143], a[124:127], v[188:191]
s_waitcnt lgkmcnt(0)
v_add_u32 v3, s6, v3
v_mfma_f32_16x16x32_bf16 v[192:195], a[128:131], a[64:67], v[192:195]
ds_read_b64_tr_b16 a[136:137], v19 offset:0
v_mfma_f32_16x16x32_bf16 v[192:195], a[132:135], a[68:71], v[192:195]
ds_read_b64_tr_b16 a[138:139], v19 offset:2048
v_mfma_f32_16x16x32_bf16 v[196:199], a[128:131], a[72:75], v[196:199]
ds_read_b64_tr_b16 a[140:141], v19 offset:16384
v_mfma_f32_16x16x32_bf16 v[196:199], a[132:135], a[76:79], v[196:199]
ds_read_b64_tr_b16 a[142:143], v19 offset:18432
v_mfma_f32_16x16x32_bf16 v[200:203], a[128:131], a[80:83], v[200:203]
v_add_u32 v19, s54, v19
v_mfma_f32_16x16x32_bf16 v[200:203], a[132:135], a[84:87], v[200:203]
v_mfma_f32_16x16x32_bf16 v[204:207], a[128:131], a[88:91], v[204:207]
v_mfma_f32_16x16x32_bf16 v[204:207], a[132:135], a[92:95], v[204:207]
v_mfma_f32_16x16x32_bf16 v[208:211], a[128:131], a[96:99], v[208:211]
v_mfma_f32_16x16x32_bf16 v[208:211], a[132:135], a[100:103], v[208:211]
v_mfma_f32_16x16x32_bf16 v[212:215], a[128:131], a[104:107], v[212:215]
v_mfma_f32_16x16x32_bf16 v[212:215], a[132:135], a[108:111], v[212:215]
s_cmp_eq_u32 s53, s69
s_cselect_b32 s54, s58, s59
v_mfma_f32_16x16x32_bf16 v[216:219], a[128:131], a[112:115], v[216:219]
s_add_u32 s53, s53, 32768
s_cmp_eq_u32 s53, s68
s_cselect_b32 s53, s69, s53
v_mfma_f32_16x16x32_bf16 v[216:219], a[132:135], a[116:119], v[216:219]
s_xor_b32 s52, s52, 0x38000
v_mfma_f32_16x16x32_bf16 v[220:223], a[128:131], a[120:123], v[220:223]
v_mfma_f32_16x16x32_bf16 v[220:223], a[132:135], a[124:127], v[220:223]
s_waitcnt vmcnt(23)
s_barrier
s_waitcnt lgkmcnt(0)
v_mfma_f32_16x16x32_bf16 v[224:227], a[136:139], a[64:67], v[224:227]
ds_read_b64_tr_b16 a[128:129], v12 offset:0
ds_read_b128 a[64:67], v20 offset:0
v_mfma_f32_16x16x32_bf16 v[224:227], a[140:143], a[68:71], v[224:227]
ds_read_b64_tr_b16 a[130:131], v12 offset:2048
ds_read_b128 a[68:71], v21 offset:0
v_mfma_f32_16x16x32_bf16 v[228:231], a[136:139], a[72:75], v[228:231]
ds_read_b64_tr_b16 a[132:133], v12 offset:16384
ds_read_b128 a[72:75], v20 offset:2048
v_mfma_f32_16x16x32_bf16 v[228:231], a[140:143], a[76:79], v[228:231]
ds_read_b64_tr_b16 a[134:135], v12 offset:18432
ds_read_b128 a[76:79], v21 offset:2048
v_mfma_f32_16x16x32_bf16 v[232:235], a[136:139], a[80:83], v[232:235]
v_add_u32 v12, s54, v12
ds_read_b128 a[80:83], v20 offset:4096
v_mfma_f32_16x16x32_bf16 v[232:235], a[140:143], a[84:87], v[232:235]
ds_read_b128 a[84:87], v21 offset:4096
v_mfma_f32_16x16x32_bf16 v[236:239], a[136:139], a[88:91], v[236:239]
ds_read_b128 a[88:91], v20 offset:6144
v_mfma_f32_16x16x32_bf16 v[236:239], a[140:143], a[92:95], v[236:239]
ds_read_b128 a[92:95], v21 offset:6144
v_mfma_f32_16x16x32_bf16 v[240:243], a[136:139], a[96:99], v[240:243]
ds_read_b128 a[96:99], v20 offset:8192
v_mfma_f32_16x16x32_bf16 v[240:243], a[140:143], a[100:103], v[240:243]
ds_read_b128 a[100:103], v21 offset:8192
v_mfma_f32_16x16x32_bf16 v[244:247], a[136:139], a[104:107], v[244:247]
ds_read_b128 a[104:107], v20 offset:10240
v_mfma_f32_16x16x32_bf16 v[244:247], a[140:143], a[108:111], v[244:247]
ds_read_b128 a[108:111], v21 offset:10240
v_mfma_f32_16x16x32_bf16 v[248:251], a[136:139], a[112:115], v[248:251]
ds_read_b128 a[112:115], v20 offset:12288
v_mfma_f32_16x16x32_bf16 v[248:251], a[140:143], a[116:119], v[248:251]
ds_read_b128 a[116:119], v21 offset:12288
v_mfma_f32_16x16x32_bf16 v[252:255], a[136:139], a[120:123], v[252:255]
ds_read_b128 a[120:123], v20 offset:14336
v_mfma_f32_16x16x32_bf16 v[252:255], a[140:143], a[124:127], v[252:255]
ds_read_b128 a[124:127], v21 offset:14336
v_xor_b32 v20, 0x38000, v20
v_xor_b32 v21, 0x38000, v21
s_add_u32 s72, s60, 0
s_add_u32 s73, s60, 8192
s_add_u32 s74, s60, 131072
s_add_u32 s75, s60, 139264
s_add_u32 s76, s60, 262144
s_add_u32 s77, s60, 270336
s_add_u32 s78, s60, 393216
s_add_u32 s79, s60, 401408
s_waitcnt lgkmcnt(13)
s_waitcnt lgkmcnt(12)
v_mfma_f32_16x16x32_bf16 a[0:3], a[128:131], a[64:67], a[0:3]
ds_read_b64_tr_b16 a[136:137], v13 offset:0
s_mov_b32 s24, s55
s_and_b32 s25, s2, 7
v_mfma_f32_16x16x32_bf16 a[0:3], a[132:135], a[68:71], a[0:3]
ds_read_b64_tr_b16 a[138:139], v13 offset:2048
s_lshl_b32 s25, s25, 1
s_lshr_b32 s26, s2, 7
v_mfma_f32_16x16x32_bf16 a[4:7], a[128:131], a[72:75], a[4:7]
ds_read_b64_tr_b16 a[140:141], v13 offset:16384
s_add_u32 s25, s25, s26
s_bfe_u32 s26, s2, 0x40003
v_mfma_f32_16x16x32_bf16 a[4:7], a[132:135], a[76:79], a[4:7]
s_waitcnt lgkmcnt(11)
ds_read_b64_tr_b16 a[142:143], v13 offset:18432
s_sub_u32 s27, 21, s26
v_mfma_f32_16x16x32_bf16 a[8:11], a[128:131], a[80:83], a[8:11]
v_add_u32 v13, s54, v13
s_sub_u32 s60, s26, 6
s_sub_u32 s61, 15, s60
v_mfma_f32_16x16x32_bf16 a[8:11], a[132:135], a[84:87], a[8:11]
s_cmp_lt_u32 s26, 12
s_cselect_b32 s27, s60, s27
s_cselect_b32 s63, s60, 0
s_cselect_b32 s31, s61, -1
v_mfma_f32_16x16x32_bf16 a[12:15], a[128:131], a[88:91], a[12:15]
s_lshl_b32 s29, s27, 2
s_add_u32 s29, s29, 4
s_sub_u32 s60, 15, s26
v_mfma_f32_16x16x32_bf16 a[12:15], a[132:135], a[92:95], a[12:15]
s_waitcnt lgkmcnt(8)
v_mfma_f32_16x16x32_bf16 a[16:19], a[128:131], a[96:99], a[16:19]
s_cmp_lt_u32 s26, 6
s_cselect_b32 s27, s60, s27
s_cselect_b32 s30, 2, 0
s_cselect_b32 s31, -1, s31
s_cselect_b32 s63, s26, s63
v_mfma_f32_16x16x32_bf16 a[16:19], a[132:135], a[100:103], a[16:19]
s_cmp_eq_u32 s63, 5
s_cselect_b32 s3, 40, 40
v_mfma_f32_16x16x32_bf16 a[20:23], a[128:131], a[104:107], a[20:23]
s_bitcmp1_b32 s2, 0
s_cselect_b32 s60, 40, s3
s_min_u32 s3, s3, s60
v_mfma_f32_16x16x32_bf16 a[20:23], a[132:135], a[108:111], a[20:23]
s_waitcnt lgkmcnt(4)
s_cmp_eq_u32 s30, 2
s_cselect_b32 s29, s3, s29
v_mfma_f32_16x16x32_bf16 a[24:27], a[128:131], a[112:115], a[24:27]
s_mov_b32 s28, 0
s_lshl_b32 s67, s27, 7
s_add_u32 s67, s67, 36831232
v_mfma_f32_16x16x32_bf16 a[24:27], a[132:135], a[116:119], a[24:27]
s_lshl_b32 s68, s25, 7
s_add_u32 s69, s68, 36833280
s_add_u32 s68, s68, 36847616
v_mfma_f32_16x16x32_bf16 a[28:31], a[128:131], a[120:123], a[28:31]
v_cmp_eq_u32 vcc, 0, v1
v_mov_b32 v7, 0x1000000
s_nop 0
v_cndmask_b32 v7, v7, 0, vcc
v_mfma_f32_16x16x32_bf16 a[28:31], a[132:135], a[124:127], a[28:31]
s_waitcnt vmcnt(3)
s_barrier
s_waitcnt lgkmcnt(0)
v_mfma_f32_16x16x32_bf16 a[32:35], a[136:139], a[64:67], a[32:35]
ds_read_b64_tr_b16 a[128:129], v12 offset:0
s_lshr_b32 s60, s24, 1
s_lshl_b32 s60, s60, 5
v_mfma_f32_16x16x32_bf16 a[32:35], a[140:143], a[68:71], a[32:35]
ds_read_b64_tr_b16 a[130:131], v12 offset:2048
s_and_b32 s61, s24, 1
s_lshl_b32 s61, s61, 3
v_mfma_f32_16x16x32_bf16 a[36:39], a[136:139], a[72:75], a[36:39]
ds_read_b64_tr_b16 a[132:133], v12 offset:16384
s_add_u32 s60, s60, s61
s_lshl_b32 s37, s60, 9
v_mfma_f32_16x16x32_bf16 a[36:39], a[140:143], a[76:79], a[36:39]
ds_read_b64_tr_b16 a[134:135], v12 offset:18432
s_lshl_b32 s34, s60, 13
s_lshl_b32 s61, s25, 9
v_mfma_f32_16x16x32_bf16 a[40:43], a[136:139], a[80:83], a[40:43]
ds_read_b128 a[144:147], v20 offset:0
ds_read_b128 a[148:151], v21 offset:0
s_add_u32 s34, s34, s61
v_mfma_f32_16x16x32_bf16 a[40:43], a[140:143], a[84:87], a[40:43]
ds_read_b128 a[152:155], v20 offset:2048
ds_read_b128 a[156:159], v21 offset:2048
s_add_u32 s35, s34, 131072
v_mfma_f32_16x16x32_bf16 a[44:47], a[136:139], a[88:91], a[44:47]
ds_read_b128 a[160:163], v20 offset:4096
ds_read_b128 a[164:167], v21 offset:4096
s_mov_b32 s16, s18
v_mfma_f32_16x16x32_bf16 a[44:47], a[140:143], a[92:95], a[44:47]
ds_read_b128 a[168:171], v20 offset:6144
ds_read_b128 a[172:175], v21 offset:6144
s_mov_b32 s17, s19
v_mfma_f32_16x16x32_bf16 a[48:51], a[136:139], a[96:99], a[48:51]
ds_read_b128 a[176:179], v20 offset:8192
s_mov_b32 s18, 3670016
s_mov_b32 s19, 0x00020000
v_mfma_f32_16x16x32_bf16 a[48:51], a[140:143], a[100:103], a[48:51]
ds_read_b128 a[180:183], v21 offset:8192
s_lshl_b32 s60, s27, 3
s_lshl_b32 s61, s24, 1
v_mfma_f32_16x16x32_bf16 a[52:55], a[136:139], a[104:107], a[52:55]
ds_read_b128 a[184:187], v20 offset:10240
s_add_u32 s60, s60, s61
s_mul_i32 s43, s60, 14336
v_mfma_f32_16x16x32_bf16 a[52:55], a[140:143], a[108:111], a[52:55]
ds_read_b128 a[188:191], v21 offset:10240
s_add_u32 s43, s43, 33554432
s_add_u32 s44, s43, 14336
v_mfma_f32_16x16x32_bf16 a[56:59], a[136:139], a[112:115], a[56:59]
ds_read_b128 a[192:195], v20 offset:12288
v_and_b32 v4, 15, v1
v_lshlrev_b32 v4, 6, v4
v_mfma_f32_16x16x32_bf16 a[56:59], a[140:143], a[116:119], a[56:59]
ds_read_b128 a[196:199], v21 offset:12288
v_and_b32 v3, 48, v1
v_add_u32 v3, v3, v4
v_mfma_f32_16x16x32_bf16 a[60:63], a[136:139], a[120:123], a[60:63]
ds_read_b128 a[200:203], v20 offset:14336
s_cmp_eq_u32 s24, 0
s_cselect_b32 s62, 0, -1
v_mfma_f32_16x16x32_bf16 a[60:63], a[140:143], a[124:127], a[60:63]
ds_read_b128 a[204:207], v21 offset:14336
s_waitcnt lgkmcnt(15)
s_waitcnt lgkmcnt(12)
v_mfma_f32_16x16x32_bf16 a[0:3], a[128:131], a[144:147], a[0:3]
ds_read_b64_tr_b16 a[136:137], v13 offset:0
v_mfma_f32_16x16x32_bf16 a[0:3], a[132:135], a[148:151], a[0:3]
ds_read_b64_tr_b16 a[138:139], v13 offset:2048
v_mfma_f32_16x16x32_bf16 a[4:7], a[128:131], a[152:155], a[4:7]
ds_read_b64_tr_b16 a[140:141], v13 offset:16384
s_add_u32 m0, s37, 98304
v_mfma_f32_16x16x32_bf16 a[4:7], a[132:135], a[156:159], a[4:7]
s_waitcnt lgkmcnt(11)
ds_read_b64_tr_b16 a[142:143], v13 offset:18432
buffer_load_dwordx4 v8, s[16:19], s34 offen offset:0 lds
v_mfma_f32_16x16x32_bf16 a[8:11], a[128:131], a[160:163], a[8:11]
v_mfma_f32_16x16x32_bf16 a[8:11], a[132:135], a[164:167], a[8:11]
buffer_load_dwordx4 v9, s[16:19], s34 offen offset:1024 lds
v_mfma_f32_16x16x32_bf16 a[12:15], a[128:131], a[168:171], a[12:15]
v_mfma_f32_16x16x32_bf16 a[12:15], a[132:135], a[172:175], a[12:15]
s_waitcnt lgkmcnt(8)
buffer_load_dword v6, v7, s[8:11], 0 offen offset:4 sc1
buffer_load_dword v21, v7, s[8:11], 0 offen offset:132 sc1
buffer_load_dwordx4 v10, s[16:19], s34 offen offset:2048 lds
v_mfma_f32_16x16x32_bf16 a[16:19], a[128:131], a[176:179], a[16:19]
v_mfma_f32_16x16x32_bf16 a[16:19], a[132:135], a[180:183], a[16:19]
buffer_load_dwordx4 v11, s[16:19], s34 offen offset:3072 lds
s_add_u32 s34, s34, 524288
v_mfma_f32_16x16x32_bf16 a[20:23], a[128:131], a[184:187], a[20:23]
v_mfma_f32_16x16x32_bf16 a[20:23], a[132:135], a[188:191], a[20:23]
s_waitcnt lgkmcnt(4)
v_lshlrev_b32 v20, 6, v7
s_add_u32 m0, s37, 106496
v_mfma_f32_16x16x32_bf16 a[24:27], a[128:131], a[192:195], a[24:27]
buffer_load_dwordx4 v8, s[16:19], s35 offen offset:0 lds
v_mfma_f32_16x16x32_bf16 a[24:27], a[132:135], a[196:199], a[24:27]
s_and_b32 s39, s62, 0x40000000
v_or_b32 v20, s39, v20
v_mfma_f32_16x16x32_bf16 a[28:31], a[128:131], a[200:203], a[28:31]
buffer_load_dwordx4 v9, s[16:19], s35 offen offset:1024 lds
v_mfma_f32_16x16x32_bf16 a[28:31], a[132:135], a[204:207], a[28:31]
s_waitcnt lgkmcnt(0)
v_mfma_f32_16x16x32_bf16 a[32:35], a[136:139], a[144:147], a[32:35]
ds_read_b64_tr_b16 a[128:129], v14 offset:0
buffer_load_dwordx4 v10, s[16:19], s35 offen offset:2048 lds
v_mfma_f32_16x16x32_bf16 a[32:35], a[140:143], a[148:151], a[32:35]
ds_read_b64_tr_b16 a[130:131], v14 offset:2048
v_mfma_f32_16x16x32_bf16 a[36:39], a[136:139], a[152:155], a[36:39]
ds_read_b64_tr_b16 a[132:133], v14 offset:16384
buffer_load_dwordx4 v11, s[16:19], s35 offen offset:3072 lds
s_add_u32 s35, s35, 524288
v_mfma_f32_16x16x32_bf16 a[36:39], a[140:143], a[156:159], a[36:39]
ds_read_b64_tr_b16 a[134:135], v14 offset:18432
v_mfma_f32_16x16x32_bf16 a[40:43], a[136:139], a[160:163], a[40:43]
v_add_u32 v14, s54, v14
v_mfma_f32_16x16x32_bf16 a[40:43], a[140:143], a[164:167], a[40:43]
v_mfma_f32_16x16x32_bf16 a[44:47], a[136:139], a[168:171], a[44:47]
v_accvgpr_read_b32 v56, a0
v_accvgpr_read_b32 v57, a1
v_mfma_f32_16x16x32_bf16 a[44:47], a[140:143], a[172:175], a[44:47]
v_accvgpr_read_b32 v58, a2
v_accvgpr_read_b32 v59, a3
v_mfma_f32_16x16x32_bf16 a[48:51], a[136:139], a[176:179], a[48:51]
v_cvt_pk_bf16_f32 v24, v56, v57
v_cvt_pk_bf16_f32 v25, v58, v59
v_mfma_f32_16x16x32_bf16 a[48:51], a[140:143], a[180:183], a[48:51]
v_accvgpr_read_b32 v60, a32
v_accvgpr_read_b32 v61, a33
v_mfma_f32_16x16x32_bf16 a[52:55], a[136:139], a[184:187], a[52:55]
v_accvgpr_read_b32 v62, a34
v_accvgpr_read_b32 v63, a35
v_mfma_f32_16x16x32_bf16 a[52:55], a[140:143], a[188:191], a[52:55]
v_cvt_pk_bf16_f32 v26, v60, v61
v_cvt_pk_bf16_f32 v27, v62, v63
v_mfma_f32_16x16x32_bf16 a[56:59], a[136:139], a[192:195], a[56:59]
v_mfma_f32_16x16x32_bf16 a[56:59], a[140:143], a[196:199], a[56:59]
buffer_store_dwordx4 v[24:27], v2, s[12:15], s72 offen offset:0 sc1
v_accvgpr_read_b32 v56, a4
v_mfma_f32_16x16x32_bf16 a[60:63], a[136:139], a[200:203], a[60:63]
v_accvgpr_read_b32 v57, a5
v_accvgpr_read_b32 v58, a6
v_mfma_f32_16x16x32_bf16 a[60:63], a[140:143], a[204:207], a[60:63]
s_barrier
s_waitcnt lgkmcnt(0)
v_mfma_f32_16x16x32_bf16 v[64:67], a[128:131], a[64:67], v[64:67]
ds_read_b64_tr_b16 a[136:137], v15 offset:0
v_accvgpr_read_b32 v59, a7
v_mfma_f32_16x16x32_bf16 v[64:67], a[132:135], a[68:71], v[64:67]
ds_read_b64_tr_b16 a[138:139], v15 offset:2048
s_add_u32 m0, s37, 131072
s_add_u32 s45, s43, 4096
v_mfma_f32_16x16x32_bf16 v[68:71], a[128:131], a[72:75], v[68:71]
ds_read_b64_tr_b16 a[140:141], v15 offset:16384
buffer_load_dwordx4 v8, s[16:19], s34 offen offset:0 lds
s_add_u32 s46, s44, 4096
v_mfma_f32_16x16x32_bf16 v[68:71], a[132:135], a[76:79], v[68:71]
ds_read_b64_tr_b16 a[142:143], v15 offset:18432
s_add_u32 s47, s43, 8192
s_add_u32 s48, s44, 8192
v_mfma_f32_16x16x32_bf16 v[72:75], a[128:131], a[80:83], v[72:75]
v_add_u32 v15, s54, v15
buffer_load_dwordx4 v9, s[16:19], s34 offen offset:1024 lds
s_add_u32 s49, s43, 12288
v_mfma_f32_16x16x32_bf16 v[72:75], a[132:135], a[84:87], v[72:75]
s_add_u32 s50, s44, 12288
s_lshl_b32 s6, s24, 12
s_add_u32 s36, s6, 98304
v_mfma_f32_16x16x32_bf16 v[76:79], a[128:131], a[88:91], v[76:79]
buffer_load_dwordx4 v10, s[16:19], s34 offen offset:2048 lds
s_add_u32 s7, s6, 32768
s_mul_i32 s60, s25, 6
v_mfma_f32_16x16x32_bf16 v[76:79], a[132:135], a[92:95], v[76:79]
s_add_u32 s60, s60, s63
s_lshl_b32 s60, s60, 2
s_add_u32 s60, s60, s24
v_mfma_f32_16x16x32_bf16 v[80:83], a[128:131], a[96:99], v[80:83]
buffer_load_dwordx4 v11, s[16:19], s34 offen offset:3072 lds
s_add_u32 s34, s34, 524288
s_lshl_b32 s64, s60, 14
v_mfma_f32_16x16x32_bf16 v[80:83], a[132:135], a[100:103], v[80:83]
s_lshl_b32 s65, s60, 10
s_add_u32 s65, s65, 61865984
s_lshl_b32 s58, s25, 4
v_mfma_f32_16x16x32_bf16 v[84:87], a[128:131], a[104:107], v[84:87]
s_add_u32 m0, s37, 139264
s_add_u32 s58, s58, s63
s_lshl_b32 s58, s58, 2
v_mfma_f32_16x16x32_bf16 v[84:87], a[132:135], a[108:111], v[84:87]
buffer_load_dwordx4 v8, s[16:19], s35 offen offset:0 lds
s_add_u32 s58, s58, s24
s_lshl_b32 s58, s58, 7
v_mfma_f32_16x16x32_bf16 v[88:91], a[128:131], a[112:115], v[88:91]
s_add_u32 s58, s58, 36700160
s_add_u32 s59, s58, 4096
s_lshl_b32 s41, s25, 20
v_mfma_f32_16x16x32_bf16 v[88:91], a[132:135], a[116:119], v[88:91]
buffer_load_dwordx4 v9, s[16:19], s35 offen offset:1024 lds
s_add_u32 s41, s41, s6
s_add_u32 s32, s41, 16384
v_mfma_f32_16x16x32_bf16 v[92:95], a[128:131], a[120:123], v[92:95]
s_add_u32 s33, s41, 16777216
s_mov_b32 s20, s4
s_mov_b32 s21, s5
v_mfma_f32_16x16x32_bf16 v[92:95], a[132:135], a[124:127], v[92:95]
s_waitcnt lgkmcnt(0)
buffer_load_dwordx4 v10, s[16:19], s35 offen offset:2048 lds
s_and_b32 s60, s26, 7
v_mfma_f32_16x16x32_bf16 v[96:99], a[136:139], a[64:67], v[96:99]
ds_read_b64_tr_b16 a[128:129], v14 offset:0
s_cmp_eq_u32 s60, 0
s_cselect_b32 s22, 268435456, 0
v_mfma_f32_16x16x32_bf16 v[96:99], a[140:143], a[68:71], v[96:99]
ds_read_b64_tr_b16 a[130:131], v14 offset:2048
buffer_load_dwordx4 v11, s[16:19], s35 offen offset:3072 lds
s_add_u32 s35, s35, 524288
v_mfma_f32_16x16x32_bf16 v[100:103], a[136:139], a[72:75], v[100:103]
ds_read_b64_tr_b16 a[132:133], v14 offset:16384
s_mov_b32 s23, 0x00020000
s_lshl_b32 s70, 1, s26
v_mfma_f32_16x16x32_bf16 v[100:103], a[140:143], a[76:79], v[100:103]
ds_read_b64_tr_b16 a[134:135], v14 offset:18432
s_add_u32 m0, s37, 32768
v_mfma_f32_16x16x32_bf16 v[104:107], a[136:139], a[80:83], v[104:107]
buffer_load_dwordx4 v8, s[16:19], s34 offen offset:0 lds
v_cvt_pk_bf16_f32 v28, v56, v57
v_mfma_f32_16x16x32_bf16 v[104:107], a[140:143], a[84:87], v[104:107]
v_cvt_pk_bf16_f32 v29, v58, v59
v_accvgpr_read_b32 v60, a36
v_mfma_f32_16x16x32_bf16 v[108:111], a[136:139], a[88:91], v[108:111]
buffer_load_dwordx4 v9, s[16:19], s34 offen offset:1024 lds
v_accvgpr_read_b32 v61, a37
v_mfma_f32_16x16x32_bf16 v[108:111], a[140:143], a[92:95], v[108:111]
v_accvgpr_read_b32 v62, a38
v_accvgpr_read_b32 v63, a39
v_mfma_f32_16x16x32_bf16 v[112:115], a[136:139], a[96:99], v[112:115]
buffer_load_dwordx4 v10, s[16:19], s34 offen offset:2048 lds
v_cvt_pk_bf16_f32 v30, v60, v61
v_mfma_f32_16x16x32_bf16 v[112:115], a[140:143], a[100:103], v[112:115]
v_cvt_pk_bf16_f32 v31, v62, v63
buffer_store_dwordx4 v[28:31], v2, s[12:15], s73 offen offset:0 sc1
v_mfma_f32_16x16x32_bf16 v[116:119], a[136:139], a[104:107], v[116:119]
buffer_load_dwordx4 v11, s[16:19], s34 offen offset:3072 lds
s_add_u32 s34, s34, 524288
v_mfma_f32_16x16x32_bf16 v[116:119], a[140:143], a[108:111], v[116:119]
v_accvgpr_read_b32 v56, a8
v_accvgpr_read_b32 v57, a9
v_mfma_f32_16x16x32_bf16 v[120:123], a[136:139], a[112:115], v[120:123]
s_add_u32 m0, s37, 40960
v_accvgpr_read_b32 v58, a10
v_mfma_f32_16x16x32_bf16 v[120:123], a[140:143], a[116:119], v[120:123]
buffer_load_dwordx4 v8, s[16:19], s35 offen offset:0 lds
v_accvgpr_read_b32 v59, a11
v_mfma_f32_16x16x32_bf16 v[124:127], a[136:139], a[120:123], v[124:127]
v_cvt_pk_bf16_f32 v32, v56, v57
v_cvt_pk_bf16_f32 v33, v58, v59
v_mfma_f32_16x16x32_bf16 v[124:127], a[140:143], a[124:127], v[124:127]
s_waitcnt vmcnt(21)
v_readfirstlane_b32 s39, v6
v_readfirstlane_b32 s38, v21
s_nop 0
s_add_u32 s39, s39, s38
s_or_b32 s39, s39, s62
s_cmp_ge_u32 s39, 336
s_cbranch_scc0 at_m0
at_m0r:
s_waitcnt lgkmcnt(0)
buffer_load_dwordx4 v9, s[16:19], s35 offen offset:1024 lds
v_mfma_f32_16x16x32_bf16 v[64:67], a[128:131], a[144:147], v[64:67]
ds_read_b64_tr_b16 a[136:137], v15 offset:0
v_accvgpr_read_b32 v60, a40
v_mfma_f32_16x16x32_bf16 v[64:67], a[132:135], a[148:151], v[64:67]
ds_read_b64_tr_b16 a[138:139], v15 offset:2048
buffer_load_dwordx4 v10, s[16:19], s35 offen offset:2048 lds
v_mfma_f32_16x16x32_bf16 v[68:71], a[128:131], a[152:155], v[68:71]
ds_read_b64_tr_b16 a[140:141], v15 offset:16384
v_accvgpr_read_b32 v61, a41
v_mfma_f32_16x16x32_bf16 v[68:71], a[132:135], a[156:159], v[68:71]
ds_read_b64_tr_b16 a[142:143], v15 offset:18432
buffer_load_dwordx4 v11, s[16:19], s35 offen offset:3072 lds
s_add_u32 s35, s35, 524288
v_mfma_f32_16x16x32_bf16 v[72:75], a[128:131], a[160:163], v[72:75]
v_accvgpr_read_b32 v62, a42
v_accvgpr_read_b32 v63, a43
v_mfma_f32_16x16x32_bf16 v[72:75], a[132:135], a[164:167], v[72:75]
v_cvt_pk_bf16_f32 v34, v60, v61
v_cvt_pk_bf16_f32 v35, v62, v63
v_mfma_f32_16x16x32_bf16 v[76:79], a[128:131], a[168:171], v[76:79]
buffer_store_dwordx4 v[32:35], v2, s[12:15], s74 offen offset:0 sc1
v_accvgpr_read_b32 v56, a12
v_mfma_f32_16x16x32_bf16 v[76:79], a[132:135], a[172:175], v[76:79]
v_accvgpr_read_b32 v57, a13
v_accvgpr_read_b32 v58, a14
v_mfma_f32_16x16x32_bf16 v[80:83], a[128:131], a[176:179], v[80:83]
v_accvgpr_read_b32 v59, a15
v_cvt_pk_bf16_f32 v36, v56, v57
v_mfma_f32_16x16x32_bf16 v[80:83], a[132:135], a[180:183], v[80:83]
v_cvt_pk_bf16_f32 v37, v58, v59
v_accvgpr_read_b32 v60, a44
v_mfma_f32_16x16x32_bf16 v[84:87], a[128:131], a[184:187], v[84:87]
v_accvgpr_read_b32 v61, a45
v_accvgpr_read_b32 v62, a46
v_mfma_f32_16x16x32_bf16 v[84:87], a[132:135], a[188:191], v[84:87]
v_accvgpr_read_b32 v63, a47
v_cvt_pk_bf16_f32 v38, v60, v61
v_mfma_f32_16x16x32_bf16 v[88:91], a[128:131], a[192:195], v[88:91]
v_cvt_pk_bf16_f32 v39, v62, v63
buffer_store_dwordx4 v[36:39], v2, s[12:15], s75 offen offset:0 sc1
v_mfma_f32_16x16x32_bf16 v[88:91], a[132:135], a[196:199], v[88:91]
v_accvgpr_read_b32 v56, a16
v_accvgpr_read_b32 v57, a17
v_mfma_f32_16x16x32_bf16 v[92:95], a[128:131], a[200:203], v[92:95]
v_accvgpr_read_b32 v58, a18
v_accvgpr_read_b32 v59, a19
v_mfma_f32_16x16x32_bf16 v[92:95], a[132:135], a[204:207], v[92:95]
s_waitcnt lgkmcnt(0)
v_cvt_pk_bf16_f32 v24, v56, v57
v_mfma_f32_16x16x32_bf16 v[96:99], a[136:139], a[144:147], v[96:99]
ds_read_b64_tr_b16 a[128:129], v16 offset:0
v_cvt_pk_bf16_f32 v25, v58, v59
v_mfma_f32_16x16x32_bf16 v[96:99], a[140:143], a[148:151], v[96:99]
ds_read_b64_tr_b16 a[130:131], v16 offset:2048
v_accvgpr_read_b32 v60, a48
v_mfma_f32_16x16x32_bf16 v[100:103], a[136:139], a[152:155], v[100:103]
ds_read_b64_tr_b16 a[132:133], v16 offset:16384
v_accvgpr_read_b32 v61, a49
v_mfma_f32_16x16x32_bf16 v[100:103], a[140:143], a[156:159], v[100:103]
ds_read_b64_tr_b16 a[134:135], v16 offset:18432
v_accvgpr_read_b32 v62, a50
v_mfma_f32_16x16x32_bf16 v[104:107], a[136:139], a[160:163], v[104:107]
v_add_u32 v16, s54, v16
v_accvgpr_read_b32 v63, a51
v_mfma_f32_16x16x32_bf16 v[104:107], a[140:143], a[164:167], v[104:107]
v_cvt_pk_bf16_f32 v26, v60, v61
v_cvt_pk_bf16_f32 v27, v62, v63
v_mfma_f32_16x16x32_bf16 v[108:111], a[136:139], a[168:171], v[108:111]
buffer_store_dwordx4 v[24:27], v2, s[12:15], s76 offen offset:0 sc1
v_accvgpr_read_b32 v56, a20
v_mfma_f32_16x16x32_bf16 v[108:111], a[140:143], a[172:175], v[108:111]
v_mov_b32 v6, 0
buffer_atomic_or v6, v20, s[12:15], s67 offen sc0 sc1
v_mfma_f32_16x16x32_bf16 v[112:115], a[136:139], a[176:179], v[112:115]
v_accvgpr_read_b32 v57, a21
v_accvgpr_read_b32 v58, a22
v_mfma_f32_16x16x32_bf16 v[112:115], a[140:143], a[180:183], v[112:115]
v_accvgpr_read_b32 v59, a23
v_cvt_pk_bf16_f32 v28, v56, v57
v_mfma_f32_16x16x32_bf16 v[116:119], a[136:139], a[184:187], v[116:119]
v_cvt_pk_bf16_f32 v29, v58, v59
v_accvgpr_read_b32 v60, a52
v_mfma_f32_16x16x32_bf16 v[116:119], a[140:143], a[188:191], v[116:119]
v_accvgpr_read_b32 v61, a53
v_accvgpr_read_b32 v62, a54
v_mfma_f32_16x16x32_bf16 v[120:123], a[136:139], a[192:195], v[120:123]
v_accvgpr_read_b32 v63, a55
v_cvt_pk_bf16_f32 v30, v60, v61
v_mfma_f32_16x16x32_bf16 v[120:123], a[140:143], a[196:199], v[120:123]
v_cvt_pk_bf16_f32 v31, v62, v63
buffer_store_dwordx4 v[28:31], v2, s[12:15], s77 offen offset:0 sc1
v_mfma_f32_16x16x32_bf16 v[124:127], a[136:139], a[200:203], v[124:127]
v_accvgpr_read_b32 v56, a24
v_accvgpr_read_b32 v57, a25
v_mfma_f32_16x16x32_bf16 v[124:127], a[140:143], a[204:207], v[124:127]
s_waitcnt lgkmcnt(0)
v_accvgpr_read_b32 v58, a26
v_mfma_f32_16x16x32_bf16 v[128:131], a[128:131], a[64:67], v[128:131]
ds_read_b64_tr_b16 a[136:137], v17 offset:0
v_accvgpr_read_b32 v59, a27
v_mfma_f32_16x16x32_bf16 v[128:131], a[132:135], a[68:71], v[128:131]
ds_read_b64_tr_b16 a[138:139], v17 offset:2048
v_cvt_pk_bf16_f32 v32, v56, v57
v_mfma_f32_16x16x32_bf16 v[132:135], a[128:131], a[72:75], v[132:135]
ds_read_b64_tr_b16 a[140:141], v17 offset:16384
v_cvt_pk_bf16_f32 v33, v58, v59
v_mfma_f32_16x16x32_bf16 v[132:135], a[132:135], a[76:79], v[132:135]
ds_read_b64_tr_b16 a[142:143], v17 offset:18432
v_accvgpr_read_b32 v60, a56
v_mfma_f32_16x16x32_bf16 v[136:139], a[128:131], a[80:83], v[136:139]
v_add_u32 v17, s54, v17
v_accvgpr_read_b32 v61, a57
v_mfma_f32_16x16x32_bf16 v[136:139], a[132:135], a[84:87], v[136:139]
v_accvgpr_read_b32 v62, a58
v_accvgpr_read_b32 v63, a59
v_mfma_f32_16x16x32_bf16 v[140:143], a[128:131], a[88:91], v[140:143]
v_cvt_pk_bf16_f32 v34, v60, v61
v_cvt_pk_bf16_f32 v35, v62, v63
v_mfma_f32_16x16x32_bf16 v[140:143], a[132:135], a[92:95], v[140:143]
buffer_store_dwordx4 v[32:35], v2, s[12:15], s78 offen offset:0 sc1
v_accvgpr_read_b32 v56, a28
v_mfma_f32_16x16x32_bf16 v[144:147], a[128:131], a[96:99], v[144:147]
v_accvgpr_read_b32 v57, a29
v_accvgpr_read_b32 v58, a30
v_mfma_f32_16x16x32_bf16 v[144:147], a[132:135], a[100:103], v[144:147]
v_accvgpr_read_b32 v59, a31
v_cvt_pk_bf16_f32 v36, v56, v57
v_mfma_f32_16x16x32_bf16 v[148:151], a[128:131], a[104:107], v[148:151]
v_cvt_pk_bf16_f32 v37, v58, v59
v_accvgpr_read_b32 v60, a60
v_mfma_f32_16x16x32_bf16 v[148:151], a[132:135], a[108:111], v[148:151]
v_accvgpr_read_b32 v61, a61
v_accvgpr_read_b32 v62, a62
v_mfma_f32_16x16x32_bf16 v[152:155], a[128:131], a[112:115], v[152:155]
v_accvgpr_read_b32 v63, a63
v_cvt_pk_bf16_f32 v38, v60, v61
v_mfma_f32_16x16x32_bf16 v[152:155], a[132:135], a[116:119], v[152:155]
v_cvt_pk_bf16_f32 v39, v62, v63
v_lshrrev_b32 v22, 4, v1
v_mfma_f32_16x16x32_bf16 v[156:159], a[128:131], a[120:123], v[156:159]
v_bfe_u32 v23, v1, 2, 2
v_lshl_add_u32 v5, v22, 3, v23
v_mfma_f32_16x16x32_bf16 v[156:159], a[132:135], a[124:127], v[156:159]
s_waitcnt lgkmcnt(0)
v_lshlrev_b32 v5, 9, v5
v_mfma_f32_16x16x32_bf16 v[160:163], a[136:139], a[64:67], v[160:163]
ds_read_b64_tr_b16 a[128:129], v16 offset:0
v_and_b32 v22, 1, v22
v_mfma_f32_16x16x32_bf16 v[160:163], a[140:143], a[68:71], v[160:163]
ds_read_b64_tr_b16 a[130:131], v16 offset:2048
buffer_store_dwordx4 v[36:39], v2, s[12:15], s79 offen offset:0 sc1
v_mfma_f32_16x16x32_bf16 v[164:167], a[136:139], a[72:75], v[164:167]
ds_read_b64_tr_b16 a[132:133], v16 offset:16384
v_cvt_pk_bf16_f32 v24, v64, v65
v_mfma_f32_16x16x32_bf16 v[164:167], a[140:143], a[76:79], v[164:167]
ds_read_b64_tr_b16 a[134:135], v16 offset:18432
v_cvt_pk_bf16_f32 v25, v66, v67
v_mfma_f32_16x16x32_bf16 v[168:171], a[136:139], a[80:83], v[168:171]
v_cvt_pk_bf16_f32 v26, v96, v97
v_cvt_pk_bf16_f32 v27, v98, v99
v_mfma_f32_16x16x32_bf16 v[168:171], a[140:143], a[84:87], v[168:171]
buffer_store_dwordx4 v[24:27], v2, s[12:15], s72 offen offset:1024 sc1
v_cvt_pk_bf16_f32 v28, v68, v69
v_mfma_f32_16x16x32_bf16 v[172:175], a[136:139], a[88:91], v[172:175]
v_cvt_pk_bf16_f32 v29, v70, v71
v_cvt_pk_bf16_f32 v30, v100, v101
v_mfma_f32_16x16x32_bf16 v[172:175], a[140:143], a[92:95], v[172:175]
v_cvt_pk_bf16_f32 v31, v102, v103
buffer_store_dwordx4 v[28:31], v2, s[12:15], s73 offen offset:1024 sc1
v_mfma_f32_16x16x32_bf16 v[176:179], a[136:139], a[96:99], v[176:179]
v_cvt_pk_bf16_f32 v32, v72, v73
v_cvt_pk_bf16_f32 v33, v74, v75
v_mfma_f32_16x16x32_bf16 v[176:179], a[140:143], a[100:103], v[176:179]
v_cvt_pk_bf16_f32 v34, v104, v105
v_cvt_pk_bf16_f32 v35, v106, v107
v_mfma_f32_16x16x32_bf16 v[180:183], a[136:139], a[104:107], v[180:183]
v_accvgpr_write_b32 a8, v32
v_accvgpr_write_b32 a9, v33
v_mfma_f32_16x16x32_bf16 v[180:183], a[140:143], a[108:111], v[180:183]
v_accvgpr_write_b32 a10, v34
v_accvgpr_write_b32 a11, v35
v_mfma_f32_16x16x32_bf16 v[184:187], a[136:139], a[112:115], v[184:187]
v_cvt_pk_bf16_f32 v36, v76, v77
v_cvt_pk_bf16_f32 v37, v78, v79
v_mfma_f32_16x16x32_bf16 v[184:187], a[140:143], a[116:119], v[184:187]
v_cvt_pk_bf16_f32 v38, v108, v109
v_cvt_pk_bf16_f32 v39, v110, v111
v_mfma_f32_16x16x32_bf16 v[188:191], a[136:139], a[120:123], v[188:191]
v_accvgpr_write_b32 a12, v36
v_accvgpr_write_b32 a13, v37
v_mfma_f32_16x16x32_bf16 v[188:191], a[140:143], a[124:127], v[188:191]
s_waitcnt vmcnt(5)
v_readfirstlane_b32 s60, v6
s_nop 0
s_or_b32 s60, s60, s62
s_bfe_u32 s60, s60, 0x80010
s_cmp_eq_u32 s60, 0xff
s_cbranch_scc0 at_h0spin
at_h0spun:
s_barrier
s_waitcnt lgkmcnt(0)
v_mfma_f32_16x16x32_bf16 v[128:131], a[128:131], a[144:147], v[128:131]
ds_read_b64_tr_b16 a[136:137], v17 offset:0
v_accvgpr_write_b32 a14, v38
v_mfma_f32_16x16x32_bf16 v[128:131], a[132:135], a[148:151], v[128:131]
ds_read_b64_tr_b16 a[138:139], v17 offset:2048
v_accvgpr_write_b32 a15, v39
v_mfma_f32_16x16x32_bf16 v[132:135], a[128:131], a[152:155], v[132:135]
ds_read_b64_tr_b16 a[140:141], v17 offset:16384
v_cvt_pk_bf16_f32 v24, v80, v81
v_mfma_f32_16x16x32_bf16 v[132:135], a[132:135], a[156:159], v[132:135]
ds_read_b64_tr_b16 a[142:143], v17 offset:18432
v_cvt_pk_bf16_f32 v25, v82, v83
v_mfma_f32_16x16x32_bf16 v[136:139], a[128:131], a[160:163], v[136:139]
v_cvt_pk_bf16_f32 v26, v112, v113
v_cvt_pk_bf16_f32 v27, v114, v115
v_mfma_f32_16x16x32_bf16 v[136:139], a[132:135], a[164:167], v[136:139]
buffer_load_dwordx4 a[208:211], v3, s[12:15], s43 offen offset:0 sc1
v_accvgpr_write_b32 a16, v24
v_mfma_f32_16x16x32_bf16 v[140:143], a[128:131], a[168:171], v[140:143]
v_accvgpr_write_b32 a17, v25
v_accvgpr_write_b32 a18, v26
v_mfma_f32_16x16x32_bf16 v[140:143], a[132:135], a[172:175], v[140:143]
v_accvgpr_write_b32 a19, v27
v_cvt_pk_bf16_f32 v28, v84, v85
v_mfma_f32_16x16x32_bf16 v[144:147], a[128:131], a[176:179], v[144:147]
buffer_load_dwordx4 a[212:215], v3, s[12:15], s44 offen offset:0 sc1
v_cvt_pk_bf16_f32 v29, v86, v87
v_mfma_f32_16x16x32_bf16 v[144:147], a[132:135], a[180:183], v[144:147]
v_cvt_pk_bf16_f32 v30, v116, v117
v_cvt_pk_bf16_f32 v31, v118, v119
v_mfma_f32_16x16x32_bf16 v[148:151], a[128:131], a[184:187], v[148:151]
v_accvgpr_write_b32 a20, v28
v_accvgpr_write_b32 a21, v29
v_mfma_f32_16x16x32_bf16 v[148:151], a[132:135], a[188:191], v[148:151]
buffer_load_dwordx4 a[216:219], v3, s[12:15], s43 offen offset:1024 sc1
v_accvgpr_write_b32 a22, v30
v_mfma_f32_16x16x32_bf16 v[152:155], a[128:131], a[192:195], v[152:155]
v_accvgpr_write_b32 a23, v31
v_cvt_pk_bf16_f32 v32, v88, v89
v_mfma_f32_16x16x32_bf16 v[152:155], a[132:135], a[196:199], v[152:155]
v_cvt_pk_bf16_f32 v33, v90, v91
v_cvt_pk_bf16_f32 v34, v120, v121
v_mfma_f32_16x16x32_bf16 v[156:159], a[128:131], a[200:203], v[156:159]
buffer_load_dwordx4 a[220:223], v3, s[12:15], s44 offen offset:1024 sc1
v_cvt_pk_bf16_f32 v35, v122, v123
v_mfma_f32_16x16x32_bf16 v[156:159], a[132:135], a[204:207], v[156:159]
s_waitcnt lgkmcnt(0)
v_accvgpr_write_b32 a24, v32
v_mfma_f32_16x16x32_bf16 v[160:163], a[136:139], a[144:147], v[160:163]
ds_read_b64_tr_b16 a[128:129], v18 offset:0
v_accvgpr_write_b32 a25, v33
v_mfma_f32_16x16x32_bf16 v[160:163], a[140:143], a[148:151], v[160:163]
ds_read_b64_tr_b16 a[130:131], v18 offset:2048
buffer_load_dwordx4 a[224:227], v3, s[12:15], s43 offen offset:2048 sc1
v_mfma_f32_16x16x32_bf16 v[164:167], a[136:139], a[152:155], v[164:167]
ds_read_b64_tr_b16 a[132:133], v18 offset:16384
v_accvgpr_write_b32 a26, v34
v_mfma_f32_16x16x32_bf16 v[164:167], a[140:143], a[156:159], v[164:167]
ds_read_b64_tr_b16 a[134:135], v18 offset:18432
v_accvgpr_write_b32 a27, v35
v_mfma_f32_16x16x32_bf16 v[168:171], a[136:139], a[160:163], v[168:171]
v_add_u32 v18, s54, v18
buffer_load_dwordx4 a[228:231], v3, s[12:15], s44 offen offset:2048 sc1
v_mfma_f32_16x16x32_bf16 v[168:171], a[140:143], a[164:167], v[168:171]
v_cvt_pk_bf16_f32 v36, v92, v93
v_cvt_pk_bf16_f32 v37, v94, v95
v_mfma_f32_16x16x32_bf16 v[172:175], a[136:139], a[168:171], v[172:175]
v_cvt_pk_bf16_f32 v38, v124, v125
v_cvt_pk_bf16_f32 v39, v126, v127
v_mfma_f32_16x16x32_bf16 v[172:175], a[140:143], a[172:175], v[172:175]
buffer_load_dwordx4 a[232:235], v3, s[12:15], s43 offen offset:3072 sc1
v_accvgpr_write_b32 a28, v36
v_mfma_f32_16x16x32_bf16 v[176:179], a[136:139], a[176:179], v[176:179]
v_accvgpr_write_b32 a29, v37
v_accvgpr_write_b32 a30, v38
v_mfma_f32_16x16x32_bf16 v[176:179], a[140:143], a[180:183], v[176:179]
v_accvgpr_write_b32 a31, v39
v_lshl_or_b32 v22, v22, 2, v23
v_mfma_f32_16x16x32_bf16 v[180:183], a[136:139], a[184:187], v[180:183]
buffer_load_dwordx4 a[236:239], v3, s[12:15], s44 offen offset:3072 sc1
v_and_b32 v23, 3, v1
v_mfma_f32_16x16x32_bf16 v[180:183], a[140:143], a[188:191], v[180:183]
v_lshl_add_u32 v5, v23, 3, v5
v_add_u32 v5, 32768, v5
v_mfma_f32_16x16x32_bf16 v[184:187], a[136:139], a[192:195], v[184:187]
v_xor_b32 v23, 0, v22
v_lshl_add_u32 v40, v23, 5, v5
v_mfma_f32_16x16x32_bf16 v[184:187], a[140:143], a[196:199], v[184:187]
v_add_u32 v48, 0x10000, v40
v_xor_b32 v23, 1, v22
v_mfma_f32_16x16x32_bf16 v[188:191], a[136:139], a[200:203], v[188:191]
v_lshl_add_u32 v41, v23, 5, v5
v_add_u32 v49, 0x10000, v41
v_mfma_f32_16x16x32_bf16 v[188:191], a[140:143], a[204:207], v[188:191]
s_waitcnt lgkmcnt(0)
v_xor_b32 v23, 2, v22
v_mfma_f32_16x16x32_bf16 v[192:195], a[128:131], a[64:67], v[192:195]
ds_read_b64_tr_b16 a[136:137], v19 offset:0
v_lshl_add_u32 v42, v23, 5, v5
v_mfma_f32_16x16x32_bf16 v[192:195], a[132:135], a[68:71], v[192:195]
ds_read_b64_tr_b16 a[138:139], v19 offset:2048
v_add_u32 v50, 0x10000, v42
v_mfma_f32_16x16x32_bf16 v[196:199], a[128:131], a[72:75], v[196:199]
ds_read_b64_tr_b16 a[140:141], v19 offset:16384
v_xor_b32 v23, 3, v22
v_mfma_f32_16x16x32_bf16 v[196:199], a[132:135], a[76:79], v[196:199]
ds_read_b64_tr_b16 a[142:143], v19 offset:18432
v_lshl_add_u32 v43, v23, 5, v5
v_mfma_f32_16x16x32_bf16 v[200:203], a[128:131], a[80:83], v[200:203]
v_add_u32 v19, s54, v19
v_add_u32 v51, 0x10000, v43
v_mfma_f32_16x16x32_bf16 v[200:203], a[132:135], a[84:87], v[200:203]
v_xor_b32 v23, 4, v22
v_lshl_add_u32 v44, v23, 5, v5
v_mfma_f32_16x16x32_bf16 v[204:207], a[128:131], a[88:91], v[204:207]
v_add_u32 v52, 0x10000, v44
v_xor_b32 v23, 5, v22
v_mfma_f32_16x16x32_bf16 v[204:207], a[132:135], a[92:95], v[204:207]
v_lshl_add_u32 v45, v23, 5, v5
v_add_u32 v53, 0x10000, v45
v_mfma_f32_16x16x32_bf16 v[208:211], a[128:131], a[96:99], v[208:211]
v_xor_b32 v23, 6, v22
v_lshl_add_u32 v46, v23, 5, v5
v_mfma_f32_16x16x32_bf16 v[208:211], a[132:135], a[100:103], v[208:211]
v_add_u32 v54, 0x10000, v46
v_xor_b32 v23, 7, v22
v_mfma_f32_16x16x32_bf16 v[212:215], a[128:131], a[104:107], v[212:215]
v_lshl_add_u32 v47, v23, 5, v5
v_add_u32 v55, 0x10000, v47
v_mfma_f32_16x16x32_bf16 v[212:215], a[132:135], a[108:111], v[212:215]
v_cvt_pk_bf16_f32 v96, v128, v129
v_cvt_pk_bf16_f32 v97, v130, v131
v_mfma_f32_16x16x32_bf16 v[216:219], a[128:131], a[112:115], v[216:219]
v_cvt_pk_bf16_f32 v98, v160, v161
v_cvt_pk_bf16_f32 v99, v162, v163
v_mfma_f32_16x16x32_bf16 v[216:219], a[132:135], a[116:119], v[216:219]
s_add_u32 s61, s72, 2048
buffer_store_dwordx4 v[96:99], v2, s[12:15], s61 offen sc1
v_mfma_f32_16x16x32_bf16 v[220:223], a[128:131], a[120:123], v[220:223]
v_cvt_pk_bf16_f32 v100, v132, v133
v_cvt_pk_bf16_f32 v101, v134, v135
v_mfma_f32_16x16x32_bf16 v[220:223], a[132:135], a[124:127], v[220:223]
s_waitcnt lgkmcnt(0)
v_cvt_pk_bf16_f32 v102, v164, v165
v_mfma_f32_16x16x32_bf16 v[224:227], a[136:139], a[64:67], v[224:227]
ds_read_b64_tr_b16 a[128:129], v18 offset:0
v_cvt_pk_bf16_f32 v103, v166, v167
v_mfma_f32_16x16x32_bf16 v[224:227], a[140:143], a[68:71], v[224:227]
ds_read_b64_tr_b16 a[130:131], v18 offset:2048
v_mfma_f32_16x16x32_bf16 v[228:231], a[136:139], a[72:75], v[228:231]
ds_read_b64_tr_b16 a[132:133], v18 offset:16384
v_mfma_f32_16x16x32_bf16 v[228:231], a[140:143], a[76:79], v[228:231]
ds_read_b64_tr_b16 a[134:135], v18 offset:18432
v_mfma_f32_16x16x32_bf16 v[232:235], a[136:139], a[80:83], v[232:235]
s_add_u32 s61, s73, 2048
buffer_store_dwordx4 v[100:103], v2, s[12:15], s61 offen sc1
v_mfma_f32_16x16x32_bf16 v[232:235], a[140:143], a[84:87], v[232:235]
v_cvt_pk_bf16_f32 v104, v136, v137
v_cvt_pk_bf16_f32 v105, v138, v139
v_mfma_f32_16x16x32_bf16 v[236:239], a[136:139], a[88:91], v[236:239]
v_cvt_pk_bf16_f32 v106, v168, v169
v_cvt_pk_bf16_f32 v107, v170, v171
v_mfma_f32_16x16x32_bf16 v[236:239], a[140:143], a[92:95], v[236:239]
v_cvt_pk_bf16_f32 v108, v140, v141
v_cvt_pk_bf16_f32 v109, v142, v143
v_mfma_f32_16x16x32_bf16 v[240:243], a[136:139], a[96:99], v[240:243]
v_cvt_pk_bf16_f32 v110, v172, v173
v_cvt_pk_bf16_f32 v111, v174, v175
v_mfma_f32_16x16x32_bf16 v[240:243], a[140:143], a[100:103], v[240:243]
v_cvt_pk_bf16_f32 v112, v144, v145
v_cvt_pk_bf16_f32 v113, v146, v147
v_mfma_f32_16x16x32_bf16 v[244:247], a[136:139], a[104:107], v[244:247]
v_cvt_pk_bf16_f32 v114, v176, v177
v_cvt_pk_bf16_f32 v115, v178, v179
v_mfma_f32_16x16x32_bf16 v[244:247], a[140:143], a[108:111], v[244:247]
v_cvt_pk_bf16_f32 v116, v148, v149
v_cvt_pk_bf16_f32 v117, v150, v151
v_mfma_f32_16x16x32_bf16 v[248:251], a[136:139], a[112:115], v[248:251]
v_cvt_pk_bf16_f32 v118, v180, v181
v_cvt_pk_bf16_f32 v119, v182, v183
v_mfma_f32_16x16x32_bf16 v[248:251], a[140:143], a[116:119], v[248:251]
v_cvt_pk_bf16_f32 v120, v152, v153
v_cvt_pk_bf16_f32 v121, v154, v155
v_mfma_f32_16x16x32_bf16 v[252:255], a[136:139], a[120:123], v[252:255]
v_cvt_pk_bf16_f32 v122, v184, v185
v_cvt_pk_bf16_f32 v123, v186, v187
v_mfma_f32_16x16x32_bf16 v[252:255], a[140:143], a[124:127], v[252:255]
s_waitcnt lgkmcnt(0)
v_cvt_pk_bf16_f32 v124, v156, v157
v_mfma_f32_16x16x32_bf16 v[192:195], a[128:131], a[144:147], v[192:195]
ds_read_b64_tr_b16 a[136:137], v19 offset:0
v_cvt_pk_bf16_f32 v125, v158, v159
v_mfma_f32_16x16x32_bf16 v[192:195], a[132:135], a[148:151], v[192:195]
ds_read_b64_tr_b16 a[138:139], v19 offset:2048
v_cvt_pk_bf16_f32 v126, v188, v189
v_mfma_f32_16x16x32_bf16 v[196:199], a[128:131], a[152:155], v[196:199]
ds_read_b64_tr_b16 a[140:141], v19 offset:16384
v_cvt_pk_bf16_f32 v127, v190, v191
v_mfma_f32_16x16x32_bf16 v[196:199], a[132:135], a[156:159], v[196:199]
ds_read_b64_tr_b16 a[142:143], v19 offset:18432
v_mfma_f32_16x16x32_bf16 v[200:203], a[128:131], a[160:163], v[200:203]
v_mfma_f32_16x16x32_bf16 v[200:203], a[132:135], a[164:167], v[200:203]
v_mfma_f32_16x16x32_bf16 v[204:207], a[128:131], a[168:171], v[204:207]
v_mfma_f32_16x16x32_bf16 v[204:207], a[132:135], a[172:175], v[204:207]
v_mfma_f32_16x16x32_bf16 v[208:211], a[128:131], a[176:179], v[208:211]
v_mfma_f32_16x16x32_bf16 v[208:211], a[132:135], a[180:183], v[208:211]
v_mfma_f32_16x16x32_bf16 v[212:215], a[128:131], a[184:187], v[212:215]
v_mfma_f32_16x16x32_bf16 v[212:215], a[132:135], a[188:191], v[212:215]
v_mfma_f32_16x16x32_bf16 v[216:219], a[128:131], a[192:195], v[216:219]
v_mfma_f32_16x16x32_bf16 v[216:219], a[132:135], a[196:199], v[216:219]
v_mfma_f32_16x16x32_bf16 v[220:223], a[128:131], a[200:203], v[220:223]
v_mfma_f32_16x16x32_bf16 v[220:223], a[132:135], a[204:207], v[220:223]
s_barrier
s_waitcnt lgkmcnt(0)
v_mfma_f32_16x16x32_bf16 v[224:227], a[136:139], a[144:147], v[224:227]
v_mfma_f32_16x16x32_bf16 v[224:227], a[140:143], a[148:151], v[224:227]
v_mfma_f32_16x16x32_bf16 v[228:231], a[136:139], a[152:155], v[228:231]
ds_read_b64_tr_b16 a[64:65], v48 offset:0
v_mfma_f32_16x16x32_bf16 v[228:231], a[140:143], a[156:159], v[228:231]
ds_read_b64_tr_b16 a[66:67], v48 offset:2048
v_mfma_f32_16x16x32_bf16 v[232:235], a[136:139], a[160:163], v[232:235]
ds_read_b64_tr_b16 a[68:69], v48 offset:16384
v_mfma_f32_16x16x32_bf16 v[232:235], a[140:143], a[164:167], v[232:235]
ds_read_b64_tr_b16 a[70:71], v48 offset:18432
v_mfma_f32_16x16x32_bf16 v[236:239], a[136:139], a[168:171], v[236:239]
ds_read_b64_tr_b16 a[72:73], v49 offset:0
v_cvt_pk_bf16_f32 v64, v192, v193
v_mfma_f32_16x16x32_bf16 v[236:239], a[140:143], a[172:175], v[236:239]
ds_read_b64_tr_b16 a[74:75], v49 offset:2048
v_cvt_pk_bf16_f32 v65, v194, v195
v_mfma_f32_16x16x32_bf16 v[240:243], a[136:139], a[176:179], v[240:243]
ds_read_b64_tr_b16 a[76:77], v49 offset:16384
v_cvt_pk_bf16_f32 v66, v224, v225
v_mfma_f32_16x16x32_bf16 v[240:243], a[140:143], a[180:183], v[240:243]
ds_read_b64_tr_b16 a[78:79], v49 offset:18432
v_cvt_pk_bf16_f32 v67, v226, v227
v_mfma_f32_16x16x32_bf16 v[244:247], a[136:139], a[184:187], v[244:247]
ds_read_b64_tr_b16 a[80:81], v50 offset:0
v_cvt_pk_bf16_f32 v68, v196, v197
v_mfma_f32_16x16x32_bf16 v[244:247], a[140:143], a[188:191], v[244:247]
ds_read_b64_tr_b16 a[82:83], v50 offset:2048
v_cvt_pk_bf16_f32 v69, v198, v199
v_mfma_f32_16x16x32_bf16 v[248:251], a[136:139], a[192:195], v[248:251]
ds_read_b64_tr_b16 a[84:85], v50 offset:16384
v_cvt_pk_bf16_f32 v70, v228, v229
v_mfma_f32_16x16x32_bf16 v[248:251], a[140:143], a[196:199], v[248:251]
ds_read_b64_tr_b16 a[86:87], v50 offset:18432
v_cvt_pk_bf16_f32 v71, v230, v231
v_mfma_f32_16x16x32_bf16 v[252:255], a[136:139], a[200:203], v[252:255]
v_cvt_pk_bf16_f32 v72, v200, v201
v_cvt_pk_bf16_f32 v73, v202, v203
v_mfma_f32_16x16x32_bf16 v[252:255], a[140:143], a[204:207], v[252:255]
v_cvt_pk_bf16_f32 v74, v232, v233
v_cvt_pk_bf16_f32 v75, v234, v235
v_cvt_pk_bf16_f32 v76, v204, v205
v_cvt_pk_bf16_f32 v77, v206, v207
v_cvt_pk_bf16_f32 v78, v236, v237
v_cvt_pk_bf16_f32 v79, v238, v239
v_cvt_pk_bf16_f32 v80, v208, v209
v_cvt_pk_bf16_f32 v81, v210, v211
v_cvt_pk_bf16_f32 v82, v240, v241
v_cvt_pk_bf16_f32 v83, v242, v243
v_cvt_pk_bf16_f32 v84, v212, v213
v_cvt_pk_bf16_f32 v85, v214, v215
v_cvt_pk_bf16_f32 v86, v244, v245
v_cvt_pk_bf16_f32 v87, v246, v247
v_cvt_pk_bf16_f32 v88, v216, v217
v_cvt_pk_bf16_f32 v89, v218, v219
v_cvt_pk_bf16_f32 v90, v248, v249
v_cvt_pk_bf16_f32 v91, v250, v251
v_cvt_pk_bf16_f32 v92, v220, v221
v_cvt_pk_bf16_f32 v93, v222, v223
v_cvt_pk_bf16_f32 v94, v252, v253
v_cvt_pk_bf16_f32 v95, v254, v255
s_add_u32 s72, s72, 1024
s_add_u32 s73, s73, 1024
s_add_u32 s74, s74, 1024
s_add_u32 s75, s75, 1024
s_add_u32 s76, s76, 1024
s_add_u32 s77, s77, 1024
s_add_u32 s78, s78, 1024
s_add_u32 s79, s79, 1024
v_add_u32 v22, 1024, v2
v_add_u32 v23, 2048, v2
s_nop 0
s_branch kv_att
kv_v:
s_lshl_b32 s71, s71, 13
s_add_u32 s60, s60, s71
s_add_u32 s60, s60, 16777216
s_mov_b32 s40, s34
s_mov_b32 s41, s35
s_mov_b32 s32, s36
s_mov_b32 s33, s37
s_cmp_lt_u32 s57, 336
s_cselect_b32 s34, 2408448, 0
s_mov_b32 s35, 0x00020000
s_mov_b32 s36, s40
s_mov_b32 s37, s41
s_mov_b32 s38, 896
s_mov_b32 s39, 0x00020000
s_add_u32 s40, s28, 35651584
s_addc_u32 s41, s29, 0
s_mov_b32 s42, 21760
s_mov_b32 s43, 0x00020000
s_mov_b32 s4, s28
s_mov_b32 s5, s29
s_mov_b32 s12, s28
s_mov_b32 s13, s29
s_mov_b32 s14, 268435456
s_mov_b32 s15, 0x00020000
s_mov_b32 s8, s76
s_mov_b32 s9, s77
s_cmp_eq_u32 s55, 0
s_cselect_b32 s10, 256, 0
s_mov_b32 s11, 0x00020000
s_waitcnt vmcnt(0)
s_barrier
ds_read_b128 a[64:67], v20 offset:0
ds_read_b128 a[68:71], v21 offset:0
ds_read_b128 a[72:75], v20 offset:2048
ds_read_b128 a[76:79], v21 offset:2048
ds_read_b128 a[80:83], v20 offset:4096
ds_read_b128 a[84:87], v21 offset:4096
ds_read_b128 a[88:91], v20 offset:6144
ds_read_b128 a[92:95], v21 offset:6144
ds_read_b128 a[96:99], v20 offset:8192
ds_read_b128 a[100:103], v21 offset:8192
ds_read_b128 a[104:107], v20 offset:10240
ds_read_b128 a[108:111], v21 offset:10240
ds_read_b128 a[112:115], v20 offset:12288
ds_read_b128 a[116:119], v21 offset:12288
ds_read_b128 a[120:123], v20 offset:14336
ds_read_b128 a[124:127], v21 offset:14336
ds_read_b64_tr_b16 a[128:129], v12 offset:0
ds_read_b64_tr_b16 a[130:131], v12 offset:2048
ds_read_b64_tr_b16 a[132:133], v12 offset:16384
ds_read_b64_tr_b16 a[134:135], v12 offset:18432
v_add_u32 v12, s54, v12
v_xor_b32 v20, 0x38000, v20
v_xor_b32 v21, 0x38000, v21
s_waitcnt lgkmcnt(0)
v_mfma_f32_16x16x32_bf16 a[0:3], a[64:67], a[128:131], 0
ds_read_b64_tr_b16 a[136:137], v13 offset:0
v_mfma_f32_16x16x32_bf16 a[0:3], a[68:71], a[132:135], a[0:3]
ds_read_b64_tr_b16 a[138:139], v13 offset:2048
v_mfma_f32_16x16x32_bf16 a[4:7], a[72:75], a[128:131], 0
ds_read_b64_tr_b16 a[140:141], v13 offset:16384
v_mfma_f32_16x16x32_bf16 a[4:7], a[76:79], a[132:135], a[4:7]
ds_read_b64_tr_b16 a[142:143], v13 offset:18432
v_mfma_f32_16x16x32_bf16 a[8:11], a[80:83], a[128:131], 0
v_add_u32 v13, s54, v13
s_mov_b32 m0, s52
v_mfma_f32_16x16x32_bf16 a[8:11], a[84:87], a[132:135], a[8:11]
buffer_load_dwordx4 v4, s[20:23], s48 offen offset:0 lds
v_mfma_f32_16x16x32_bf16 a[12:15], a[88:91], a[128:131], 0
v_mfma_f32_16x16x32_bf16 a[12:15], a[92:95], a[132:135], a[12:15]
buffer_load_dwordx4 v5, s[20:23], s48 offen offset:1024 lds
v_mfma_f32_16x16x32_bf16 a[16:19], a[96:99], a[128:131], 0
v_mfma_f32_16x16x32_bf16 a[16:19], a[100:103], a[132:135], a[16:19]
buffer_load_dwordx4 v6, s[20:23], s48 offen offset:2048 lds
v_mfma_f32_16x16x32_bf16 a[20:23], a[104:107], a[128:131], 0
v_mfma_f32_16x16x32_bf16 a[20:23], a[108:111], a[132:135], a[20:23]
buffer_load_dwordx4 v7, s[20:23], s48 offen offset:3072 lds
s_add_u32 s48, s48, 128
v_mfma_f32_16x16x32_bf16 a[24:27], a[112:115], a[128:131], 0
s_mov_b32 m0, s53
v_mfma_f32_16x16x32_bf16 a[24:27], a[116:119], a[132:135], a[24:27]
buffer_load_dwordx4 v8, s[24:27], s50 offen offset:0 lds
v_mfma_f32_16x16x32_bf16 a[28:31], a[120:123], a[128:131], 0
v_mfma_f32_16x16x32_bf16 a[28:31], a[124:127], a[132:135], a[28:31]
s_waitcnt lgkmcnt(0)
s_barrier
buffer_load_dwordx4 v9, s[24:27], s50 offen offset:1024 lds
v_mfma_f32_16x16x32_bf16 a[32:35], a[64:67], a[136:139], 0
ds_read_b64_tr_b16 a[128:129], v14 offset:0
v_mfma_f32_16x16x32_bf16 a[32:35], a[68:71], a[140:143], a[32:35]
ds_read_b64_tr_b16 a[130:131], v14 offset:2048
buffer_load_dwordx4 v10, s[24:27], s50 offen offset:2048 lds
v_mfma_f32_16x16x32_bf16 a[36:39], a[72:75], a[136:139], 0
ds_read_b64_tr_b16 a[132:133], v14 offset:16384
v_mfma_f32_16x16x32_bf16 a[36:39], a[76:79], a[140:143], a[36:39]
ds_read_b64_tr_b16 a[134:135], v14 offset:18432
buffer_load_dwordx4 v11, s[24:27], s50 offen offset:3072 lds
s_add_u32 s50, s50, 524288
v_mfma_f32_16x16x32_bf16 a[40:43], a[80:83], a[136:139], 0
v_add_u32 v14, s54, v14
s_add_u32 m0, s52, 4096
v_mfma_f32_16x16x32_bf16 a[40:43], a[84:87], a[140:143], a[40:43]
buffer_load_dwordx4 v4, s[20:23], s49 offen offset:0 lds
v_mfma_f32_16x16x32_bf16 a[44:47], a[88:91], a[136:139], 0
v_mfma_f32_16x16x32_bf16 a[44:47], a[92:95], a[140:143], a[44:47]
buffer_load_dwordx4 v5, s[20:23], s49 offen offset:1024 lds
v_mfma_f32_16x16x32_bf16 a[48:51], a[96:99], a[136:139], 0
v_mfma_f32_16x16x32_bf16 a[48:51], a[100:103], a[140:143], a[48:51]
buffer_load_dwordx4 v6, s[20:23], s49 offen offset:2048 lds
v_mfma_f32_16x16x32_bf16 a[52:55], a[104:107], a[136:139], 0
v_mfma_f32_16x16x32_bf16 a[52:55], a[108:111], a[140:143], a[52:55]
buffer_load_dwordx4 v7, s[20:23], s49 offen offset:3072 lds
s_add_u32 s49, s49, 128
v_mfma_f32_16x16x32_bf16 a[56:59], a[112:115], a[136:139], 0
s_add_u32 m0, s53, 8192
v_mfma_f32_16x16x32_bf16 a[56:59], a[116:119], a[140:143], a[56:59]
buffer_load_dwordx4 v8, s[24:27], s51 offen offset:0 lds
v_mfma_f32_16x16x32_bf16 a[60:63], a[120:123], a[136:139], 0
v_mfma_f32_16x16x32_bf16 a[60:63], a[124:127], a[140:143], a[60:63]
s_waitcnt lgkmcnt(0)
buffer_load_dwordx4 v9, s[24:27], s51 offen offset:1024 lds
v_mfma_f32_16x16x32_bf16 v[64:67], a[64:67], a[128:131], 0
ds_read_b64_tr_b16 a[136:137], v15 offset:0
v_mfma_f32_16x16x32_bf16 v[64:67], a[68:71], a[132:135], v[64:67]
ds_read_b64_tr_b16 a[138:139], v15 offset:2048
buffer_load_dwordx4 v10, s[24:27], s51 offen offset:2048 lds
v_mfma_f32_16x16x32_bf16 v[68:71], a[72:75], a[128:131], 0
ds_read_b64_tr_b16 a[140:141], v15 offset:16384
v_mfma_f32_16x16x32_bf16 v[68:71], a[76:79], a[132:135], v[68:71]
ds_read_b64_tr_b16 a[142:143], v15 offset:18432
buffer_load_dwordx4 v11, s[24:27], s51 offen offset:3072 lds
s_add_u32 s51, s51, 524288
v_mfma_f32_16x16x32_bf16 v[72:75], a[80:83], a[128:131], 0
v_add_u32 v15, s54, v15
v_mfma_f32_16x16x32_bf16 v[72:75], a[84:87], a[132:135], v[72:75]
s_add_u32 s53, s53, 32768
s_xor_b32 s52, s52, 0x38000
v_mfma_f32_16x16x32_bf16 v[76:79], a[88:91], a[128:131], 0
v_mfma_f32_16x16x32_bf16 v[76:79], a[92:95], a[132:135], v[76:79]
v_mfma_f32_16x16x32_bf16 v[80:83], a[96:99], a[128:131], 0
s_mov_b32 m0, s52
v_mfma_f32_16x16x32_bf16 v[80:83], a[100:103], a[132:135], v[80:83]
buffer_load_dwordx4 v4, s[20:23], s48 offen offset:0 lds
v_mfma_f32_16x16x32_bf16 v[84:87], a[104:107], a[128:131], 0
v_mfma_f32_16x16x32_bf16 v[84:87], a[108:111], a[132:135], v[84:87]
v_mfma_f32_16x16x32_bf16 v[88:91], a[112:115], a[128:131], 0
buffer_load_dwordx4 v5, s[20:23], s48 offen offset:1024 lds
v_mfma_f32_16x16x32_bf16 v[88:91], a[116:119], a[132:135], v[88:91]
v_mfma_f32_16x16x32_bf16 v[92:95], a[120:123], a[128:131], 0
v_mfma_f32_16x16x32_bf16 v[92:95], a[124:127], a[132:135], v[92:95]
s_waitcnt lgkmcnt(0)
buffer_load_dwordx4 v6, s[20:23], s48 offen offset:2048 lds
v_mfma_f32_16x16x32_bf16 v[96:99], a[64:67], a[136:139], 0
ds_read_b64_tr_b16 a[128:129], v16 offset:0
v_mfma_f32_16x16x32_bf16 v[96:99], a[68:71], a[140:143], v[96:99]
ds_read_b64_tr_b16 a[130:131], v16 offset:2048
v_mfma_f32_16x16x32_bf16 v[100:103], a[72:75], a[136:139], 0
ds_read_b64_tr_b16 a[132:133], v16 offset:16384
buffer_load_dwordx4 v7, s[20:23], s48 offen offset:3072 lds
v_mfma_f32_16x16x32_bf16 v[100:103], a[76:79], a[140:143], v[100:103]
ds_read_b64_tr_b16 a[134:135], v16 offset:18432
s_add_u32 s48, s48, 128
v_mfma_f32_16x16x32_bf16 v[104:107], a[80:83], a[136:139], 0
v_add_u32 v16, s54, v16
s_add_u32 m0, s52, 4096
v_mfma_f32_16x16x32_bf16 v[104:107], a[84:87], a[140:143], v[104:107]
buffer_load_dwordx4 v4, s[20:23], s49 offen offset:0 lds
v_mfma_f32_16x16x32_bf16 v[108:111], a[88:91], a[136:139], 0
v_mfma_f32_16x16x32_bf16 v[108:111], a[92:95], a[140:143], v[108:111]
v_mfma_f32_16x16x32_bf16 v[112:115], a[96:99], a[136:139], 0
buffer_load_dwordx4 v5, s[20:23], s49 offen offset:1024 lds
v_mfma_f32_16x16x32_bf16 v[112:115], a[100:103], a[140:143], v[112:115]
v_mfma_f32_16x16x32_bf16 v[116:119], a[104:107], a[136:139], 0
v_mfma_f32_16x16x32_bf16 v[116:119], a[108:111], a[140:143], v[116:119]
buffer_load_dwordx4 v6, s[20:23], s49 offen offset:2048 lds
v_mfma_f32_16x16x32_bf16 v[120:123], a[112:115], a[136:139], 0
v_mfma_f32_16x16x32_bf16 v[120:123], a[116:119], a[140:143], v[120:123]
v_mfma_f32_16x16x32_bf16 v[124:127], a[120:123], a[136:139], 0
buffer_load_dwordx4 v7, s[20:23], s49 offen offset:3072 lds
v_mfma_f32_16x16x32_bf16 v[124:127], a[124:127], a[140:143], v[124:127]
s_waitcnt lgkmcnt(0)
s_add_u32 s49, s49, 128
v_mfma_f32_16x16x32_bf16 v[128:131], a[64:67], a[128:131], 0
ds_read_b64_tr_b16 a[136:137], v17 offset:0
s_mov_b32 m0, s53
v_mfma_f32_16x16x32_bf16 v[128:131], a[68:71], a[132:135], v[128:131]
ds_read_b64_tr_b16 a[138:139], v17 offset:2048
buffer_load_dwordx4 v8, s[24:27], s50 offen offset:0 lds
v_mfma_f32_16x16x32_bf16 v[132:135], a[72:75], a[128:131], 0
ds_read_b64_tr_b16 a[140:141], v17 offset:16384
v_mfma_f32_16x16x32_bf16 v[132:135], a[76:79], a[132:135], v[132:135]
ds_read_b64_tr_b16 a[142:143], v17 offset:18432
v_mfma_f32_16x16x32_bf16 v[136:139], a[80:83], a[128:131], 0
v_add_u32 v17, s54, v17
buffer_load_dwordx4 v9, s[24:27], s50 offen offset:1024 lds
v_mfma_f32_16x16x32_bf16 v[136:139], a[84:87], a[132:135], v[136:139]
v_mfma_f32_16x16x32_bf16 v[140:143], a[88:91], a[128:131], 0
v_mfma_f32_16x16x32_bf16 v[140:143], a[92:95], a[132:135], v[140:143]
buffer_load_dwordx4 v10, s[24:27], s50 offen offset:2048 lds
v_mfma_f32_16x16x32_bf16 v[144:147], a[96:99], a[128:131], 0
v_mfma_f32_16x16x32_bf16 v[144:147], a[100:103], a[132:135], v[144:147]
v_mfma_f32_16x16x32_bf16 v[148:151], a[104:107], a[128:131], 0
buffer_load_dwordx4 v11, s[24:27], s50 offen offset:3072 lds
v_mfma_f32_16x16x32_bf16 v[148:151], a[108:111], a[132:135], v[148:151]
s_add_u32 s50, s50, 524288
v_mfma_f32_16x16x32_bf16 v[152:155], a[112:115], a[128:131], 0
s_add_u32 m0, s53, 8192
v_mfma_f32_16x16x32_bf16 v[152:155], a[116:119], a[132:135], v[152:155]
buffer_load_dwordx4 v8, s[24:27], s51 offen offset:0 lds
v_mfma_f32_16x16x32_bf16 v[156:159], a[120:123], a[128:131], 0
v_mfma_f32_16x16x32_bf16 v[156:159], a[124:127], a[132:135], v[156:159]
s_waitcnt lgkmcnt(0)
v_mfma_f32_16x16x32_bf16 v[160:163], a[64:67], a[136:139], 0
ds_read_b64_tr_b16 a[128:129], v18 offset:0
buffer_load_dwordx4 v9, s[24:27], s51 offen offset:1024 lds
v_mfma_f32_16x16x32_bf16 v[160:163], a[68:71], a[140:143], v[160:163]
ds_read_b64_tr_b16 a[130:131], v18 offset:2048
v_mfma_f32_16x16x32_bf16 v[164:167], a[72:75], a[136:139], 0
ds_read_b64_tr_b16 a[132:133], v18 offset:16384
v_mfma_f32_16x16x32_bf16 v[164:167], a[76:79], a[140:143], v[164:167]
ds_read_b64_tr_b16 a[134:135], v18 offset:18432
buffer_load_dwordx4 v10, s[24:27], s51 offen offset:2048 lds
v_mfma_f32_16x16x32_bf16 v[168:171], a[80:83], a[136:139], 0
v_add_u32 v18, s54, v18
v_mfma_f32_16x16x32_bf16 v[168:171], a[84:87], a[140:143], v[168:171]
v_mfma_f32_16x16x32_bf16 v[172:175], a[88:91], a[136:139], 0
buffer_load_dwordx4 v11, s[24:27], s51 offen offset:3072 lds
v_mfma_f32_16x16x32_bf16 v[172:175], a[92:95], a[140:143], v[172:175]
s_add_u32 s51, s51, 524288
v_mfma_f32_16x16x32_bf16 v[176:179], a[96:99], a[136:139], 0
v_mfma_f32_16x16x32_bf16 v[176:179], a[100:103], a[140:143], v[176:179]
v_mfma_f32_16x16x32_bf16 v[180:183], a[104:107], a[136:139], 0
v_mfma_f32_16x16x32_bf16 v[180:183], a[108:111], a[140:143], v[180:183]
buffer_load_dword a255, v22, s[24:27], 0 offen
v_add_u32 v22, 524288, v22
v_mfma_f32_16x16x32_bf16 v[184:187], a[112:115], a[136:139], 0
buffer_load_dword a255, v23, s[20:23], 0 offen
v_add_u32 v23, 128, v23
v_mfma_f32_16x16x32_bf16 v[184:187], a[116:119], a[140:143], v[184:187]
s_cmp_lt_u32 s16, 8
s_cselect_b32 s46, s17, 0
s_cselect_b32 s6, 1408, 0
v_mfma_f32_16x16x32_bf16 v[188:191], a[120:123], a[136:139], 0
s_add_u32 s16, s16, 1
buffer_load_dword a255, v3, s[44:47], 0 offen
v_mfma_f32_16x16x32_bf16 v[188:191], a[124:127], a[140:143], v[188:191]
s_waitcnt lgkmcnt(0)
v_add_u32 v3, s6, v3
v_mfma_f32_16x16x32_bf16 v[192:195], a[64:67], a[128:131], 0
ds_read_b64_tr_b16 a[136:137], v19 offset:0
v_mfma_f32_16x16x32_bf16 v[192:195], a[68:71], a[132:135], v[192:195]
ds_read_b64_tr_b16 a[138:139], v19 offset:2048
v_mfma_f32_16x16x32_bf16 v[196:199], a[72:75], a[128:131], 0
ds_read_b64_tr_b16 a[140:141], v19 offset:16384
v_mfma_f32_16x16x32_bf16 v[196:199], a[76:79], a[132:135], v[196:199]
ds_read_b64_tr_b16 a[142:143], v19 offset:18432
v_mfma_f32_16x16x32_bf16 v[200:203], a[80:83], a[128:131], 0
v_add_u32 v19, s54, v19
v_mfma_f32_16x16x32_bf16 v[200:203], a[84:87], a[132:135], v[200:203]
v_mfma_f32_16x16x32_bf16 v[204:207], a[88:91], a[128:131], 0
v_mfma_f32_16x16x32_bf16 v[204:207], a[92:95], a[132:135], v[204:207]
v_mfma_f32_16x16x32_bf16 v[208:211], a[96:99], a[128:131], 0
v_mfma_f32_16x16x32_bf16 v[208:211], a[100:103], a[132:135], v[208:211]
v_mfma_f32_16x16x32_bf16 v[212:215], a[104:107], a[128:131], 0
v_mfma_f32_16x16x32_bf16 v[212:215], a[108:111], a[132:135], v[212:215]
s_cmp_eq_u32 s53, s69
s_cselect_b32 s54, s58, s59
v_mfma_f32_16x16x32_bf16 v[216:219], a[112:115], a[128:131], 0
s_add_u32 s53, s53, 32768
s_cmp_eq_u32 s53, s68
s_cselect_b32 s53, s69, s53
v_mfma_f32_16x16x32_bf16 v[216:219], a[116:119], a[132:135], v[216:219]
s_xor_b32 s52, s52, 0x38000
v_mfma_f32_16x16x32_bf16 v[220:223], a[120:123], a[128:131], 0
v_mfma_f32_16x16x32_bf16 v[220:223], a[124:127], a[132:135], v[220:223]
s_waitcnt vmcnt(19)
s_barrier
s_waitcnt lgkmcnt(0)
v_mfma_f32_16x16x32_bf16 v[224:227], a[64:67], a[136:139], 0
ds_read_b64_tr_b16 a[128:129], v12 offset:0
ds_read_b128 a[64:67], v20 offset:0
v_mfma_f32_16x16x32_bf16 v[224:227], a[68:71], a[140:143], v[224:227]
ds_read_b64_tr_b16 a[130:131], v12 offset:2048
ds_read_b128 a[68:71], v21 offset:0
v_mfma_f32_16x16x32_bf16 v[228:231], a[72:75], a[136:139], 0
ds_read_b64_tr_b16 a[132:133], v12 offset:16384
ds_read_b128 a[72:75], v20 offset:2048
v_mfma_f32_16x16x32_bf16 v[228:231], a[76:79], a[140:143], v[228:231]
ds_read_b64_tr_b16 a[134:135], v12 offset:18432
ds_read_b128 a[76:79], v21 offset:2048
v_mfma_f32_16x16x32_bf16 v[232:235], a[80:83], a[136:139], 0
v_add_u32 v12, s54, v12
ds_read_b128 a[80:83], v20 offset:4096
v_mfma_f32_16x16x32_bf16 v[232:235], a[84:87], a[140:143], v[232:235]
ds_read_b128 a[84:87], v21 offset:4096
v_mfma_f32_16x16x32_bf16 v[236:239], a[88:91], a[136:139], 0
ds_read_b128 a[88:91], v20 offset:6144
v_mfma_f32_16x16x32_bf16 v[236:239], a[92:95], a[140:143], v[236:239]
ds_read_b128 a[92:95], v21 offset:6144
v_mfma_f32_16x16x32_bf16 v[240:243], a[96:99], a[136:139], 0
ds_read_b128 a[96:99], v20 offset:8192
v_mfma_f32_16x16x32_bf16 v[240:243], a[100:103], a[140:143], v[240:243]
ds_read_b128 a[100:103], v21 offset:8192
v_mfma_f32_16x16x32_bf16 v[244:247], a[104:107], a[136:139], 0
ds_read_b128 a[104:107], v20 offset:10240
v_mfma_f32_16x16x32_bf16 v[244:247], a[108:111], a[140:143], v[244:247]
ds_read_b128 a[108:111], v21 offset:10240
v_mfma_f32_16x16x32_bf16 v[248:251], a[112:115], a[136:139], 0
ds_read_b128 a[112:115], v20 offset:12288
v_mfma_f32_16x16x32_bf16 v[248:251], a[116:119], a[140:143], v[248:251]
ds_read_b128 a[116:119], v21 offset:12288
v_mfma_f32_16x16x32_bf16 v[252:255], a[120:123], a[136:139], 0
ds_read_b128 a[120:123], v20 offset:14336
v_mfma_f32_16x16x32_bf16 v[252:255], a[124:127], a[140:143], v[252:255]
ds_read_b128 a[124:127], v21 offset:14336
v_xor_b32 v20, 0x38000, v20
v_xor_b32 v21, 0x38000, v21
s_waitcnt lgkmcnt(12)
v_mfma_f32_16x16x32_bf16 a[0:3], a[64:67], a[128:131], a[0:3]
ds_read_b64_tr_b16 a[136:137], v13 offset:0
s_lshl_b32 s70, s57, 4
v_mfma_f32_16x16x32_bf16 a[0:3], a[68:71], a[132:135], a[0:3]
ds_read_b64_tr_b16 a[138:139], v13 offset:2048
v_mul_u32_u24 v48, 5376, v1
v_mfma_f32_16x16x32_bf16 a[4:7], a[72:75], a[128:131], a[4:7]
ds_read_b64_tr_b16 a[140:141], v13 offset:16384
v_lshlrev_b32 v49, 1, v1
v_mfma_f32_16x16x32_bf16 a[4:7], a[76:79], a[132:135], a[4:7]
s_waitcnt lgkmcnt(11)
ds_read_b64_tr_b16 a[142:143], v13 offset:18432
v_mfma_f32_16x16x32_bf16 a[8:11], a[80:83], a[128:131], a[8:11]
v_add_u32 v13, s54, v13
v_mfma_f32_16x16x32_bf16 a[8:11], a[84:87], a[132:135], a[8:11]
v_mfma_f32_16x16x32_bf16 a[12:15], a[88:91], a[128:131], a[12:15]
v_mfma_f32_16x16x32_bf16 a[12:15], a[92:95], a[132:135], a[12:15]
s_waitcnt lgkmcnt(8)
v_mfma_f32_16x16x32_bf16 a[16:19], a[96:99], a[128:131], a[16:19]
v_mfma_f32_16x16x32_bf16 a[16:19], a[100:103], a[132:135], a[16:19]
v_mfma_f32_16x16x32_bf16 a[20:23], a[104:107], a[128:131], a[20:23]
v_mfma_f32_16x16x32_bf16 a[20:23], a[108:111], a[132:135], a[20:23]
s_waitcnt lgkmcnt(4)
v_mfma_f32_16x16x32_bf16 a[24:27], a[112:115], a[128:131], a[24:27]
v_mfma_f32_16x16x32_bf16 a[24:27], a[116:119], a[132:135], a[24:27]
v_mfma_f32_16x16x32_bf16 a[28:31], a[120:123], a[128:131], a[28:31]
v_mfma_f32_16x16x32_bf16 a[28:31], a[124:127], a[132:135], a[28:31]
s_waitcnt lgkmcnt(0)
s_barrier
v_mfma_f32_16x16x32_bf16 a[32:35], a[64:67], a[136:139], a[32:35]
ds_read_b64_tr_b16 a[128:129], v14 offset:0
v_mfma_f32_16x16x32_bf16 a[32:35], a[68:71], a[140:143], a[32:35]
ds_read_b64_tr_b16 a[130:131], v14 offset:2048
v_mfma_f32_16x16x32_bf16 a[36:39], a[72:75], a[136:139], a[36:39]
ds_read_b64_tr_b16 a[132:133], v14 offset:16384
v_mfma_f32_16x16x32_bf16 a[36:39], a[76:79], a[140:143], a[36:39]
ds_read_b64_tr_b16 a[134:135], v14 offset:18432
v_mfma_f32_16x16x32_bf16 a[40:43], a[80:83], a[136:139], a[40:43]
v_add_u32 v14, s54, v14
s_mov_b32 m0, s52
v_mfma_f32_16x16x32_bf16 a[40:43], a[84:87], a[140:143], a[40:43]
buffer_load_dwordx4 v4, s[20:23], s48 offen offset:0 lds
v_mfma_f32_16x16x32_bf16 a[44:47], a[88:91], a[136:139], a[44:47]
v_mfma_f32_16x16x32_bf16 a[44:47], a[92:95], a[140:143], a[44:47]
v_mfma_f32_16x16x32_bf16 a[48:51], a[96:99], a[136:139], a[48:51]
v_mfma_f32_16x16x32_bf16 a[48:51], a[100:103], a[140:143], a[48:51]
buffer_load_dwordx4 v5, s[20:23], s48 offen offset:1024 lds
v_mfma_f32_16x16x32_bf16 a[52:55], a[104:107], a[136:139], a[52:55]
v_mfma_f32_16x16x32_bf16 a[52:55], a[108:111], a[140:143], a[52:55]
v_mfma_f32_16x16x32_bf16 a[56:59], a[112:115], a[136:139], a[56:59]
v_mfma_f32_16x16x32_bf16 a[56:59], a[116:119], a[140:143], a[56:59]
buffer_load_dwordx4 v6, s[20:23], s48 offen offset:2048 lds
v_mfma_f32_16x16x32_bf16 a[60:63], a[120:123], a[136:139], a[60:63]
v_mfma_f32_16x16x32_bf16 a[60:63], a[124:127], a[140:143], a[60:63]
s_waitcnt lgkmcnt(0)
v_mfma_f32_16x16x32_bf16 v[64:67], a[64:67], a[128:131], v[64:67]
ds_read_b64_tr_b16 a[136:137], v15 offset:0
v_mfma_f32_16x16x32_bf16 v[64:67], a[68:71], a[132:135], v[64:67]
ds_read_b64_tr_b16 a[138:139], v15 offset:2048
buffer_load_dwordx4 v7, s[20:23], s48 offen offset:3072 lds
v_mfma_f32_16x16x32_bf16 v[68:71], a[72:75], a[128:131], v[68:71]
ds_read_b64_tr_b16 a[140:141], v15 offset:16384
s_add_u32 s48, s48, 128
v_mfma_f32_16x16x32_bf16 v[68:71], a[76:79], a[132:135], v[68:71]
ds_read_b64_tr_b16 a[142:143], v15 offset:18432
v_mfma_f32_16x16x32_bf16 v[72:75], a[80:83], a[128:131], v[72:75]
v_add_u32 v15, s54, v15
s_add_u32 m0, s52, 4096
v_mfma_f32_16x16x32_bf16 v[72:75], a[84:87], a[132:135], v[72:75]
buffer_load_dwordx4 v4, s[20:23], s49 offen offset:0 lds
v_mfma_f32_16x16x32_bf16 v[76:79], a[88:91], a[128:131], v[76:79]
v_mfma_f32_16x16x32_bf16 v[76:79], a[92:95], a[132:135], v[76:79]
v_mfma_f32_16x16x32_bf16 v[80:83], a[96:99], a[128:131], v[80:83]
v_mfma_f32_16x16x32_bf16 v[80:83], a[100:103], a[132:135], v[80:83]
buffer_load_dwordx4 v5, s[20:23], s49 offen offset:1024 lds
v_mfma_f32_16x16x32_bf16 v[84:87], a[104:107], a[128:131], v[84:87]
v_mfma_f32_16x16x32_bf16 v[84:87], a[108:111], a[132:135], v[84:87]
v_mfma_f32_16x16x32_bf16 v[88:91], a[112:115], a[128:131], v[88:91]
v_mfma_f32_16x16x32_bf16 v[88:91], a[116:119], a[132:135], v[88:91]
buffer_load_dwordx4 v6, s[20:23], s49 offen offset:2048 lds
v_mfma_f32_16x16x32_bf16 v[92:95], a[120:123], a[128:131], v[92:95]
v_mfma_f32_16x16x32_bf16 v[92:95], a[124:127], a[132:135], v[92:95]
s_waitcnt lgkmcnt(0)
v_mfma_f32_16x16x32_bf16 v[96:99], a[64:67], a[136:139], v[96:99]
ds_read_b64_tr_b16 a[128:129], v16 offset:0
v_mfma_f32_16x16x32_bf16 v[96:99], a[68:71], a[140:143], v[96:99]
ds_read_b64_tr_b16 a[130:131], v16 offset:2048
buffer_load_dwordx4 v7, s[20:23], s49 offen offset:3072 lds
v_mfma_f32_16x16x32_bf16 v[100:103], a[72:75], a[136:139], v[100:103]
ds_read_b64_tr_b16 a[132:133], v16 offset:16384
s_add_u32 s49, s49, 128
v_mfma_f32_16x16x32_bf16 v[100:103], a[76:79], a[140:143], v[100:103]
ds_read_b64_tr_b16 a[134:135], v16 offset:18432
v_mfma_f32_16x16x32_bf16 v[104:107], a[80:83], a[136:139], v[104:107]
v_add_u32 v16, s54, v16
s_mov_b32 m0, s53
v_mfma_f32_16x16x32_bf16 v[104:107], a[84:87], a[140:143], v[104:107]
buffer_load_dwordx4 v8, s[24:27], s50 offen offset:0 lds
v_mfma_f32_16x16x32_bf16 v[108:111], a[88:91], a[136:139], v[108:111]
v_mfma_f32_16x16x32_bf16 v[108:111], a[92:95], a[140:143], v[108:111]
v_mfma_f32_16x16x32_bf16 v[112:115], a[96:99], a[136:139], v[112:115]
v_mfma_f32_16x16x32_bf16 v[112:115], a[100:103], a[140:143], v[112:115]
buffer_load_dwordx4 v9, s[24:27], s50 offen offset:1024 lds
v_mfma_f32_16x16x32_bf16 v[116:119], a[104:107], a[136:139], v[116:119]
v_mfma_f32_16x16x32_bf16 v[116:119], a[108:111], a[140:143], v[116:119]
v_mfma_f32_16x16x32_bf16 v[120:123], a[112:115], a[136:139], v[120:123]
v_mfma_f32_16x16x32_bf16 v[120:123], a[116:119], a[140:143], v[120:123]
buffer_load_dwordx4 v10, s[24:27], s50 offen offset:2048 lds
v_mfma_f32_16x16x32_bf16 v[124:127], a[120:123], a[136:139], v[124:127]
v_mfma_f32_16x16x32_bf16 v[124:127], a[124:127], a[140:143], v[124:127]
s_waitcnt lgkmcnt(0)
v_mfma_f32_16x16x32_bf16 v[128:131], a[64:67], a[128:131], v[128:131]
ds_read_b64_tr_b16 a[136:137], v17 offset:0
v_mfma_f32_16x16x32_bf16 v[128:131], a[68:71], a[132:135], v[128:131]
ds_read_b64_tr_b16 a[138:139], v17 offset:2048
buffer_load_dwordx4 v11, s[24:27], s50 offen offset:3072 lds
v_mfma_f32_16x16x32_bf16 v[132:135], a[72:75], a[128:131], v[132:135]
ds_read_b64_tr_b16 a[140:141], v17 offset:16384
s_add_u32 s50, s50, 524288
v_mfma_f32_16x16x32_bf16 v[132:135], a[76:79], a[132:135], v[132:135]
ds_read_b64_tr_b16 a[142:143], v17 offset:18432
v_mfma_f32_16x16x32_bf16 v[136:139], a[80:83], a[128:131], v[136:139]
v_add_u32 v17, s54, v17
s_add_u32 m0, s53, 8192
v_mfma_f32_16x16x32_bf16 v[136:139], a[84:87], a[132:135], v[136:139]
buffer_load_dwordx4 v8, s[24:27], s51 offen offset:0 lds
v_mfma_f32_16x16x32_bf16 v[140:143], a[88:91], a[128:131], v[140:143]
v_mfma_f32_16x16x32_bf16 v[140:143], a[92:95], a[132:135], v[140:143]
v_mfma_f32_16x16x32_bf16 v[144:147], a[96:99], a[128:131], v[144:147]
v_mfma_f32_16x16x32_bf16 v[144:147], a[100:103], a[132:135], v[144:147]
buffer_load_dwordx4 v9, s[24:27], s51 offen offset:1024 lds
v_mfma_f32_16x16x32_bf16 v[148:151], a[104:107], a[128:131], v[148:151]
v_mfma_f32_16x16x32_bf16 v[148:151], a[108:111], a[132:135], v[148:151]
v_mfma_f32_16x16x32_bf16 v[152:155], a[112:115], a[128:131], v[152:155]
v_mfma_f32_16x16x32_bf16 v[152:155], a[116:119], a[132:135], v[152:155]
buffer_load_dwordx4 v10, s[24:27], s51 offen offset:2048 lds
v_mfma_f32_16x16x32_bf16 v[156:159], a[120:123], a[128:131], v[156:159]
v_mfma_f32_16x16x32_bf16 v[156:159], a[124:127], a[132:135], v[156:159]
s_waitcnt lgkmcnt(0)
v_mfma_f32_16x16x32_bf16 v[160:163], a[64:67], a[136:139], v[160:163]
ds_read_b64_tr_b16 a[128:129], v18 offset:0
v_mfma_f32_16x16x32_bf16 v[160:163], a[68:71], a[140:143], v[160:163]
ds_read_b64_tr_b16 a[130:131], v18 offset:2048
buffer_load_dwordx4 v11, s[24:27], s51 offen offset:3072 lds
v_mfma_f32_16x16x32_bf16 v[164:167], a[72:75], a[136:139], v[164:167]
ds_read_b64_tr_b16 a[132:133], v18 offset:16384
s_add_u32 s51, s51, 524288
v_mfma_f32_16x16x32_bf16 v[164:167], a[76:79], a[140:143], v[164:167]
ds_read_b64_tr_b16 a[134:135], v18 offset:18432
buffer_load_ushort v24, v49, s[36:39], 0 offen offset:0
v_mfma_f32_16x16x32_bf16 v[168:171], a[80:83], a[136:139], v[168:171]
v_add_u32 v18, s54, v18
buffer_load_ushort v25, v49, s[36:39], 0 offen offset:128
v_mfma_f32_16x16x32_bf16 v[168:171], a[84:87], a[140:143], v[168:171]
buffer_load_ushort v26, v49, s[36:39], 0 offen offset:256
buffer_load_ushort v27, v49, s[36:39], 0 offen offset:384
v_mfma_f32_16x16x32_bf16 v[172:175], a[88:91], a[136:139], v[172:175]
buffer_load_ushort v28, v49, s[36:39], 0 offen offset:512
buffer_load_ushort v29, v49, s[36:39], 0 offen offset:640
v_mfma_f32_16x16x32_bf16 v[172:175], a[92:95], a[140:143], v[172:175]
buffer_load_ushort v30, v49, s[36:39], 0 offen offset:768
buffer_load_dwordx4 a[208:211], v48, s[32:35], s70 offen
v_mfma_f32_16x16x32_bf16 v[176:179], a[96:99], a[136:139], v[176:179]
s_add_u32 s70, s70, 344064
buffer_load_dwordx4 a[212:215], v48, s[32:35], s70 offen
v_mfma_f32_16x16x32_bf16 v[176:179], a[100:103], a[140:143], v[176:179]
s_add_u32 s70, s70, 344064
buffer_load_dwordx4 a[216:219], v48, s[32:35], s70 offen
v_mfma_f32_16x16x32_bf16 v[180:183], a[104:107], a[136:139], v[180:183]
s_add_u32 s70, s70, 344064
v_mfma_f32_16x16x32_bf16 v[180:183], a[108:111], a[140:143], v[180:183]
buffer_load_dword a255, v22, s[24:27], 0 offen
v_add_u32 v22, 524288, v22
v_mfma_f32_16x16x32_bf16 v[184:187], a[112:115], a[136:139], v[184:187]
buffer_load_dword a255, v23, s[20:23], 0 offen
v_add_u32 v23, 128, v23
v_mfma_f32_16x16x32_bf16 v[184:187], a[116:119], a[140:143], v[184:187]
s_cmp_lt_u32 s16, 8
s_cselect_b32 s46, s17, 0
s_cselect_b32 s6, 1408, 0
v_mfma_f32_16x16x32_bf16 v[188:191], a[120:123], a[136:139], v[188:191]
s_add_u32 s16, s16, 1
buffer_load_dword a255, v3, s[44:47], 0 offen
v_mfma_f32_16x16x32_bf16 v[188:191], a[124:127], a[140:143], v[188:191]
s_waitcnt lgkmcnt(0)
v_add_u32 v3, s6, v3
v_mfma_f32_16x16x32_bf16 v[192:195], a[64:67], a[128:131], v[192:195]
ds_read_b64_tr_b16 a[136:137], v19 offset:0
v_mfma_f32_16x16x32_bf16 v[192:195], a[68:71], a[132:135], v[192:195]
ds_read_b64_tr_b16 a[138:139], v19 offset:2048
v_mfma_f32_16x16x32_bf16 v[196:199], a[72:75], a[128:131], v[196:199]
ds_read_b64_tr_b16 a[140:141], v19 offset:16384
v_mfma_f32_16x16x32_bf16 v[196:199], a[76:79], a[132:135], v[196:199]
ds_read_b64_tr_b16 a[142:143], v19 offset:18432
v_mfma_f32_16x16x32_bf16 v[200:203], a[80:83], a[128:131], v[200:203]
v_add_u32 v19, s54, v19
v_mfma_f32_16x16x32_bf16 v[200:203], a[84:87], a[132:135], v[200:203]
v_mfma_f32_16x16x32_bf16 v[204:207], a[88:91], a[128:131], v[204:207]
v_mfma_f32_16x16x32_bf16 v[204:207], a[92:95], a[132:135], v[204:207]
v_mfma_f32_16x16x32_bf16 v[208:211], a[96:99], a[128:131], v[208:211]
v_mfma_f32_16x16x32_bf16 v[208:211], a[100:103], a[132:135], v[208:211]
v_mfma_f32_16x16x32_bf16 v[212:215], a[104:107], a[128:131], v[212:215]
v_mfma_f32_16x16x32_bf16 v[212:215], a[108:111], a[132:135], v[212:215]
s_cmp_eq_u32 s53, s69
s_cselect_b32 s54, s58, s59
v_mfma_f32_16x16x32_bf16 v[216:219], a[112:115], a[128:131], v[216:219]
s_add_u32 s53, s53, 32768
s_cmp_eq_u32 s53, s68
s_cselect_b32 s53, s69, s53
v_mfma_f32_16x16x32_bf16 v[216:219], a[116:119], a[132:135], v[216:219]
s_xor_b32 s52, s52, 0x38000
v_mfma_f32_16x16x32_bf16 v[220:223], a[120:123], a[128:131], v[220:223]
v_mfma_f32_16x16x32_bf16 v[220:223], a[124:127], a[132:135], v[220:223]
s_waitcnt vmcnt(32)
s_barrier
s_waitcnt lgkmcnt(0)
v_mfma_f32_16x16x32_bf16 v[224:227], a[64:67], a[136:139], v[224:227]
ds_read_b64_tr_b16 a[128:129], v12 offset:0
ds_read_b128 a[64:67], v20 offset:0
v_mfma_f32_16x16x32_bf16 v[224:227], a[68:71], a[140:143], v[224:227]
ds_read_b64_tr_b16 a[130:131], v12 offset:2048
ds_read_b128 a[68:71], v21 offset:0
v_mfma_f32_16x16x32_bf16 v[228:231], a[72:75], a[136:139], v[228:231]
ds_read_b64_tr_b16 a[132:133], v12 offset:16384
ds_read_b128 a[72:75], v20 offset:2048
v_mfma_f32_16x16x32_bf16 v[228:231], a[76:79], a[140:143], v[228:231]
ds_read_b64_tr_b16 a[134:135], v12 offset:18432
ds_read_b128 a[76:79], v21 offset:2048
v_mfma_f32_16x16x32_bf16 v[232:235], a[80:83], a[136:139], v[232:235]
v_add_u32 v12, s54, v12
ds_read_b128 a[80:83], v20 offset:4096
v_mfma_f32_16x16x32_bf16 v[232:235], a[84:87], a[140:143], v[232:235]
ds_read_b128 a[84:87], v21 offset:4096
v_mfma_f32_16x16x32_bf16 v[236:239], a[88:91], a[136:139], v[236:239]
ds_read_b128 a[88:91], v20 offset:6144
v_mfma_f32_16x16x32_bf16 v[236:239], a[92:95], a[140:143], v[236:239]
ds_read_b128 a[92:95], v21 offset:6144
v_mfma_f32_16x16x32_bf16 v[240:243], a[96:99], a[136:139], v[240:243]
ds_read_b128 a[96:99], v20 offset:8192
v_mfma_f32_16x16x32_bf16 v[240:243], a[100:103], a[140:143], v[240:243]
ds_read_b128 a[100:103], v21 offset:8192
v_mfma_f32_16x16x32_bf16 v[244:247], a[104:107], a[136:139], v[244:247]
ds_read_b128 a[104:107], v20 offset:10240
v_mfma_f32_16x16x32_bf16 v[244:247], a[108:111], a[140:143], v[244:247]
ds_read_b128 a[108:111], v21 offset:10240
v_mfma_f32_16x16x32_bf16 v[248:251], a[112:115], a[136:139], v[248:251]
ds_read_b128 a[112:115], v20 offset:12288
v_mfma_f32_16x16x32_bf16 v[248:251], a[116:119], a[140:143], v[248:251]
ds_read_b128 a[116:119], v21 offset:12288
v_mfma_f32_16x16x32_bf16 v[252:255], a[120:123], a[136:139], v[252:255]
ds_read_b128 a[120:123], v20 offset:14336
v_mfma_f32_16x16x32_bf16 v[252:255], a[124:127], a[140:143], v[252:255]
ds_read_b128 a[124:127], v21 offset:14336
v_xor_b32 v20, 0x38000, v20
v_xor_b32 v21, 0x38000, v21
s_waitcnt lgkmcnt(12)
v_mfma_f32_16x16x32_bf16 a[0:3], a[64:67], a[128:131], a[0:3]
ds_read_b64_tr_b16 a[136:137], v13 offset:0
v_mfma_f32_16x16x32_bf16 a[0:3], a[68:71], a[132:135], a[0:3]
ds_read_b64_tr_b16 a[138:139], v13 offset:2048
v_mfma_f32_16x16x32_bf16 a[4:7], a[72:75], a[128:131], a[4:7]
ds_read_b64_tr_b16 a[140:141], v13 offset:16384
v_mfma_f32_16x16x32_bf16 a[4:7], a[76:79], a[132:135], a[4:7]
s_waitcnt lgkmcnt(11)
ds_read_b64_tr_b16 a[142:143], v13 offset:18432
v_mfma_f32_16x16x32_bf16 a[8:11], a[80:83], a[128:131], a[8:11]
v_add_u32 v13, s54, v13
v_mfma_f32_16x16x32_bf16 a[8:11], a[84:87], a[132:135], a[8:11]
v_mfma_f32_16x16x32_bf16 a[12:15], a[88:91], a[128:131], a[12:15]
v_mfma_f32_16x16x32_bf16 a[12:15], a[92:95], a[132:135], a[12:15]
s_waitcnt lgkmcnt(8)
v_mfma_f32_16x16x32_bf16 a[16:19], a[96:99], a[128:131], a[16:19]
v_mfma_f32_16x16x32_bf16 a[16:19], a[100:103], a[132:135], a[16:19]
v_mfma_f32_16x16x32_bf16 a[20:23], a[104:107], a[128:131], a[20:23]
v_mfma_f32_16x16x32_bf16 a[20:23], a[108:111], a[132:135], a[20:23]
s_waitcnt lgkmcnt(4)
v_mfma_f32_16x16x32_bf16 a[24:27], a[112:115], a[128:131], a[24:27]
v_mfma_f32_16x16x32_bf16 a[24:27], a[116:119], a[132:135], a[24:27]
v_mfma_f32_16x16x32_bf16 a[28:31], a[120:123], a[128:131], a[28:31]
v_mfma_f32_16x16x32_bf16 a[28:31], a[124:127], a[132:135], a[28:31]
s_waitcnt lgkmcnt(0)
s_barrier
v_mfma_f32_16x16x32_bf16 a[32:35], a[64:67], a[136:139], a[32:35]
ds_read_b64_tr_b16 a[128:129], v14 offset:0
v_mfma_f32_16x16x32_bf16 a[32:35], a[68:71], a[140:143], a[32:35]
ds_read_b64_tr_b16 a[130:131], v14 offset:2048
v_mfma_f32_16x16x32_bf16 a[36:39], a[72:75], a[136:139], a[36:39]
ds_read_b64_tr_b16 a[132:133], v14 offset:16384
v_mfma_f32_16x16x32_bf16 a[36:39], a[76:79], a[140:143], a[36:39]
ds_read_b64_tr_b16 a[134:135], v14 offset:18432
v_mfma_f32_16x16x32_bf16 a[40:43], a[80:83], a[136:139], a[40:43]
v_add_u32 v14, s54, v14
s_mov_b32 m0, s52
v_mfma_f32_16x16x32_bf16 a[40:43], a[84:87], a[140:143], a[40:43]
buffer_load_dwordx4 v4, s[20:23], s48 offen offset:0 lds
v_mfma_f32_16x16x32_bf16 a[44:47], a[88:91], a[136:139], a[44:47]
v_mfma_f32_16x16x32_bf16 a[44:47], a[92:95], a[140:143], a[44:47]
v_mfma_f32_16x16x32_bf16 a[48:51], a[96:99], a[136:139], a[48:51]
v_mfma_f32_16x16x32_bf16 a[48:51], a[100:103], a[140:143], a[48:51]
buffer_load_dwordx4 v5, s[20:23], s48 offen offset:1024 lds
v_mfma_f32_16x16x32_bf16 a[52:55], a[104:107], a[136:139], a[52:55]
v_mfma_f32_16x16x32_bf16 a[52:55], a[108:111], a[140:143], a[52:55]
v_mfma_f32_16x16x32_bf16 a[56:59], a[112:115], a[136:139], a[56:59]
v_mfma_f32_16x16x32_bf16 a[56:59], a[116:119], a[140:143], a[56:59]
buffer_load_dwordx4 v6, s[20:23], s48 offen offset:2048 lds
v_mfma_f32_16x16x32_bf16 a[60:63], a[120:123], a[136:139], a[60:63]
v_mfma_f32_16x16x32_bf16 a[60:63], a[124:127], a[140:143], a[60:63]
s_waitcnt lgkmcnt(0)
v_mfma_f32_16x16x32_bf16 v[64:67], a[64:67], a[128:131], v[64:67]
ds_read_b64_tr_b16 a[136:137], v15 offset:0
v_mfma_f32_16x16x32_bf16 v[64:67], a[68:71], a[132:135], v[64:67]
ds_read_b64_tr_b16 a[138:139], v15 offset:2048
buffer_load_dwordx4 v7, s[20:23], s48 offen offset:3072 lds
v_mfma_f32_16x16x32_bf16 v[68:71], a[72:75], a[128:131], v[68:71]
ds_read_b64_tr_b16 a[140:141], v15 offset:16384
s_add_u32 s48, s48, 128
v_mfma_f32_16x16x32_bf16 v[68:71], a[76:79], a[132:135], v[68:71]
ds_read_b64_tr_b16 a[142:143], v15 offset:18432
v_mfma_f32_16x16x32_bf16 v[72:75], a[80:83], a[128:131], v[72:75]
v_add_u32 v15, s54, v15
s_add_u32 m0, s52, 4096
v_mfma_f32_16x16x32_bf16 v[72:75], a[84:87], a[132:135], v[72:75]
buffer_load_dwordx4 v4, s[20:23], s49 offen offset:0 lds
v_mfma_f32_16x16x32_bf16 v[76:79], a[88:91], a[128:131], v[76:79]
v_mfma_f32_16x16x32_bf16 v[76:79], a[92:95], a[132:135], v[76:79]
v_mfma_f32_16x16x32_bf16 v[80:83], a[96:99], a[128:131], v[80:83]
v_mfma_f32_16x16x32_bf16 v[80:83], a[100:103], a[132:135], v[80:83]
buffer_load_dwordx4 v5, s[20:23], s49 offen offset:1024 lds
v_mfma_f32_16x16x32_bf16 v[84:87], a[104:107], a[128:131], v[84:87]
v_mfma_f32_16x16x32_bf16 v[84:87], a[108:111], a[132:135], v[84:87]
v_mfma_f32_16x16x32_bf16 v[88:91], a[112:115], a[128:131], v[88:91]
v_mfma_f32_16x16x32_bf16 v[88:91], a[116:119], a[132:135], v[88:91]
buffer_load_dwordx4 v6, s[20:23], s49 offen offset:2048 lds
v_mfma_f32_16x16x32_bf16 v[92:95], a[120:123], a[128:131], v[92:95]
v_mfma_f32_16x16x32_bf16 v[92:95], a[124:127], a[132:135], v[92:95]
s_waitcnt lgkmcnt(0)
v_mfma_f32_16x16x32_bf16 v[96:99], a[64:67], a[136:139], v[96:99]
ds_read_b64_tr_b16 a[128:129], v16 offset:0
v_mfma_f32_16x16x32_bf16 v[96:99], a[68:71], a[140:143], v[96:99]
ds_read_b64_tr_b16 a[130:131], v16 offset:2048
buffer_load_dwordx4 v7, s[20:23], s49 offen offset:3072 lds
v_mfma_f32_16x16x32_bf16 v[100:103], a[72:75], a[136:139], v[100:103]
ds_read_b64_tr_b16 a[132:133], v16 offset:16384
s_add_u32 s49, s49, 128
v_mfma_f32_16x16x32_bf16 v[100:103], a[76:79], a[140:143], v[100:103]
ds_read_b64_tr_b16 a[134:135], v16 offset:18432
v_mfma_f32_16x16x32_bf16 v[104:107], a[80:83], a[136:139], v[104:107]
v_add_u32 v16, s54, v16
s_mov_b32 m0, s53
v_mfma_f32_16x16x32_bf16 v[104:107], a[84:87], a[140:143], v[104:107]
buffer_load_dwordx4 v8, s[24:27], s50 offen offset:0 lds
v_mfma_f32_16x16x32_bf16 v[108:111], a[88:91], a[136:139], v[108:111]
v_mfma_f32_16x16x32_bf16 v[108:111], a[92:95], a[140:143], v[108:111]
v_mfma_f32_16x16x32_bf16 v[112:115], a[96:99], a[136:139], v[112:115]
v_mfma_f32_16x16x32_bf16 v[112:115], a[100:103], a[140:143], v[112:115]
buffer_load_dwordx4 v9, s[24:27], s50 offen offset:1024 lds
v_mfma_f32_16x16x32_bf16 v[116:119], a[104:107], a[136:139], v[116:119]
v_mfma_f32_16x16x32_bf16 v[116:119], a[108:111], a[140:143], v[116:119]
v_mfma_f32_16x16x32_bf16 v[120:123], a[112:115], a[136:139], v[120:123]
v_mfma_f32_16x16x32_bf16 v[120:123], a[116:119], a[140:143], v[120:123]
buffer_load_dwordx4 v10, s[24:27], s50 offen offset:2048 lds
v_mfma_f32_16x16x32_bf16 v[124:127], a[120:123], a[136:139], v[124:127]
v_mfma_f32_16x16x32_bf16 v[124:127], a[124:127], a[140:143], v[124:127]
s_waitcnt lgkmcnt(0)
v_mfma_f32_16x16x32_bf16 v[128:131], a[64:67], a[128:131], v[128:131]
ds_read_b64_tr_b16 a[136:137], v17 offset:0
v_mfma_f32_16x16x32_bf16 v[128:131], a[68:71], a[132:135], v[128:131]
ds_read_b64_tr_b16 a[138:139], v17 offset:2048
buffer_load_dwordx4 v11, s[24:27], s50 offen offset:3072 lds
v_mfma_f32_16x16x32_bf16 v[132:135], a[72:75], a[128:131], v[132:135]
ds_read_b64_tr_b16 a[140:141], v17 offset:16384
s_add_u32 s50, s50, 524288
v_mfma_f32_16x16x32_bf16 v[132:135], a[76:79], a[132:135], v[132:135]
ds_read_b64_tr_b16 a[142:143], v17 offset:18432
v_mfma_f32_16x16x32_bf16 v[136:139], a[80:83], a[128:131], v[136:139]
v_add_u32 v17, s54, v17
s_add_u32 m0, s53, 8192
v_mfma_f32_16x16x32_bf16 v[136:139], a[84:87], a[132:135], v[136:139]
buffer_load_dwordx4 v8, s[24:27], s51 offen offset:0 lds
v_mfma_f32_16x16x32_bf16 v[140:143], a[88:91], a[128:131], v[140:143]
v_mfma_f32_16x16x32_bf16 v[140:143], a[92:95], a[132:135], v[140:143]
v_mfma_f32_16x16x32_bf16 v[144:147], a[96:99], a[128:131], v[144:147]
v_mfma_f32_16x16x32_bf16 v[144:147], a[100:103], a[132:135], v[144:147]
buffer_load_dwordx4 v9, s[24:27], s51 offen offset:1024 lds
v_mfma_f32_16x16x32_bf16 v[148:151], a[104:107], a[128:131], v[148:151]
v_mfma_f32_16x16x32_bf16 v[148:151], a[108:111], a[132:135], v[148:151]
v_mfma_f32_16x16x32_bf16 v[152:155], a[112:115], a[128:131], v[152:155]
v_mfma_f32_16x16x32_bf16 v[152:155], a[116:119], a[132:135], v[152:155]
buffer_load_dwordx4 v10, s[24:27], s51 offen offset:2048 lds
v_mfma_f32_16x16x32_bf16 v[156:159], a[120:123], a[128:131], v[156:159]
v_mfma_f32_16x16x32_bf16 v[156:159], a[124:127], a[132:135], v[156:159]
s_waitcnt lgkmcnt(0)
v_mfma_f32_16x16x32_bf16 v[160:163], a[64:67], a[136:139], v[160:163]
ds_read_b64_tr_b16 a[128:129], v18 offset:0
v_mfma_f32_16x16x32_bf16 v[160:163], a[68:71], a[140:143], v[160:163]
ds_read_b64_tr_b16 a[130:131], v18 offset:2048
buffer_load_dwordx4 v11, s[24:27], s51 offen offset:3072 lds
v_mfma_f32_16x16x32_bf16 v[164:167], a[72:75], a[136:139], v[164:167]
ds_read_b64_tr_b16 a[132:133], v18 offset:16384
s_add_u32 s51, s51, 524288
v_mfma_f32_16x16x32_bf16 v[164:167], a[76:79], a[140:143], v[164:167]
ds_read_b64_tr_b16 a[134:135], v18 offset:18432
buffer_load_dwordx4 a[220:223], v48, s[32:35], s70 offen
v_mfma_f32_16x16x32_bf16 v[168:171], a[80:83], a[136:139], v[168:171]
v_add_u32 v18, s54, v18
s_add_u32 s70, s70, 344064
v_mfma_f32_16x16x32_bf16 v[168:171], a[84:87], a[140:143], v[168:171]
buffer_load_dwordx4 a[224:227], v48, s[32:35], s70 offen
s_add_u32 s70, s70, 344064
v_mfma_f32_16x16x32_bf16 v[172:175], a[88:91], a[136:139], v[172:175]
buffer_load_dwordx4 a[228:231], v48, s[32:35], s70 offen
s_add_u32 s70, s70, 344064
v_mfma_f32_16x16x32_bf16 v[172:175], a[92:95], a[140:143], v[172:175]
buffer_load_dwordx4 a[232:235], v48, s[32:35], s70 offen
v_mfma_f32_16x16x32_bf16 v[176:179], a[96:99], a[136:139], v[176:179]
v_mfma_f32_16x16x32_bf16 v[176:179], a[100:103], a[140:143], v[176:179]
v_mfma_f32_16x16x32_bf16 v[180:183], a[104:107], a[136:139], v[180:183]
v_mfma_f32_16x16x32_bf16 v[180:183], a[108:111], a[140:143], v[180:183]
buffer_load_dword a255, v22, s[24:27], 0 offen
v_add_u32 v22, 524288, v22
v_mfma_f32_16x16x32_bf16 v[184:187], a[112:115], a[136:139], v[184:187]
buffer_load_dword a255, v23, s[20:23], 0 offen
v_add_u32 v23, 128, v23
v_mfma_f32_16x16x32_bf16 v[184:187], a[116:119], a[140:143], v[184:187]
s_cmp_lt_u32 s16, 8
s_cselect_b32 s46, s17, 0
s_cselect_b32 s6, 1408, 0
v_mfma_f32_16x16x32_bf16 v[188:191], a[120:123], a[136:139], v[188:191]
s_add_u32 s16, s16, 1
buffer_load_dword a255, v3, s[44:47], 0 offen
v_mfma_f32_16x16x32_bf16 v[188:191], a[124:127], a[140:143], v[188:191]
s_waitcnt lgkmcnt(0)
v_add_u32 v3, s6, v3
v_mfma_f32_16x16x32_bf16 v[192:195], a[64:67], a[128:131], v[192:195]
ds_read_b64_tr_b16 a[136:137], v19 offset:0
v_mfma_f32_16x16x32_bf16 v[192:195], a[68:71], a[132:135], v[192:195]
ds_read_b64_tr_b16 a[138:139], v19 offset:2048
v_mfma_f32_16x16x32_bf16 v[196:199], a[72:75], a[128:131], v[196:199]
ds_read_b64_tr_b16 a[140:141], v19 offset:16384
v_mfma_f32_16x16x32_bf16 v[196:199], a[76:79], a[132:135], v[196:199]
ds_read_b64_tr_b16 a[142:143], v19 offset:18432
v_mfma_f32_16x16x32_bf16 v[200:203], a[80:83], a[128:131], v[200:203]
v_add_u32 v19, s54, v19
v_mfma_f32_16x16x32_bf16 v[200:203], a[84:87], a[132:135], v[200:203]
v_mfma_f32_16x16x32_bf16 v[204:207], a[88:91], a[128:131], v[204:207]
v_mfma_f32_16x16x32_bf16 v[204:207], a[92:95], a[132:135], v[204:207]
v_mfma_f32_16x16x32_bf16 v[208:211], a[96:99], a[128:131], v[208:211]
v_mfma_f32_16x16x32_bf16 v[208:211], a[100:103], a[132:135], v[208:211]
v_mfma_f32_16x16x32_bf16 v[212:215], a[104:107], a[128:131], v[212:215]
v_mfma_f32_16x16x32_bf16 v[212:215], a[108:111], a[132:135], v[212:215]
s_cmp_eq_u32 s53, s69
s_cselect_b32 s54, s58, s59
v_mfma_f32_16x16x32_bf16 v[216:219], a[112:115], a[128:131], v[216:219]
s_add_u32 s53, s53, 32768
s_cmp_eq_u32 s53, s68
s_cselect_b32 s53, s69, s53
v_mfma_f32_16x16x32_bf16 v[216:219], a[116:119], a[132:135], v[216:219]
s_xor_b32 s52, s52, 0x38000
v_mfma_f32_16x16x32_bf16 v[220:223], a[120:123], a[128:131], v[220:223]
v_mfma_f32_16x16x32_bf16 v[220:223], a[124:127], a[132:135], v[220:223]
s_waitcnt vmcnt(36)
s_barrier
s_waitcnt lgkmcnt(0)
v_mfma_f32_16x16x32_bf16 v[224:227], a[64:67], a[136:139], v[224:227]
ds_read_b64_tr_b16 a[128:129], v12 offset:0
ds_read_b128 a[64:67], v20 offset:0
v_mfma_f32_16x16x32_bf16 v[224:227], a[68:71], a[140:143], v[224:227]
ds_read_b64_tr_b16 a[130:131], v12 offset:2048
ds_read_b128 a[68:71], v21 offset:0
v_mfma_f32_16x16x32_bf16 v[228:231], a[72:75], a[136:139], v[228:231]
ds_read_b64_tr_b16 a[132:133], v12 offset:16384
ds_read_b128 a[72:75], v20 offset:2048
v_mfma_f32_16x16x32_bf16 v[228:231], a[76:79], a[140:143], v[228:231]
ds_read_b64_tr_b16 a[134:135], v12 offset:18432
ds_read_b128 a[76:79], v21 offset:2048
v_mfma_f32_16x16x32_bf16 v[232:235], a[80:83], a[136:139], v[232:235]
v_add_u32 v12, s54, v12
ds_read_b128 a[80:83], v20 offset:4096
v_mfma_f32_16x16x32_bf16 v[232:235], a[84:87], a[140:143], v[232:235]
ds_read_b128 a[84:87], v21 offset:4096
v_mfma_f32_16x16x32_bf16 v[236:239], a[88:91], a[136:139], v[236:239]
ds_read_b128 a[88:91], v20 offset:6144
v_mfma_f32_16x16x32_bf16 v[236:239], a[92:95], a[140:143], v[236:239]
ds_read_b128 a[92:95], v21 offset:6144
v_mfma_f32_16x16x32_bf16 v[240:243], a[96:99], a[136:139], v[240:243]
ds_read_b128 a[96:99], v20 offset:8192
v_mfma_f32_16x16x32_bf16 v[240:243], a[100:103], a[140:143], v[240:243]
ds_read_b128 a[100:103], v21 offset:8192
v_mfma_f32_16x16x32_bf16 v[244:247], a[104:107], a[136:139], v[244:247]
ds_read_b128 a[104:107], v20 offset:10240
v_mfma_f32_16x16x32_bf16 v[244:247], a[108:111], a[140:143], v[244:247]
ds_read_b128 a[108:111], v21 offset:10240
v_mfma_f32_16x16x32_bf16 v[248:251], a[112:115], a[136:139], v[248:251]
ds_read_b128 a[112:115], v20 offset:12288
v_mfma_f32_16x16x32_bf16 v[248:251], a[116:119], a[140:143], v[248:251]
ds_read_b128 a[116:119], v21 offset:12288
v_mfma_f32_16x16x32_bf16 v[252:255], a[120:123], a[136:139], v[252:255]
ds_read_b128 a[120:123], v20 offset:14336
v_mfma_f32_16x16x32_bf16 v[252:255], a[124:127], a[140:143], v[252:255]
ds_read_b128 a[124:127], v21 offset:14336
v_xor_b32 v20, 0x38000, v20
v_xor_b32 v21, 0x38000, v21
s_waitcnt lgkmcnt(12)
v_mfma_f32_16x16x32_bf16 a[0:3], a[64:67], a[128:131], a[0:3]
ds_read_b64_tr_b16 a[136:137], v13 offset:0
v_mfma_f32_16x16x32_bf16 a[0:3], a[68:71], a[132:135], a[0:3]
ds_read_b64_tr_b16 a[138:139], v13 offset:2048
v_mfma_f32_16x16x32_bf16 a[4:7], a[72:75], a[128:131], a[4:7]
ds_read_b64_tr_b16 a[140:141], v13 offset:16384
v_mfma_f32_16x16x32_bf16 a[4:7], a[76:79], a[132:135], a[4:7]
s_waitcnt lgkmcnt(11)
ds_read_b64_tr_b16 a[142:143], v13 offset:18432
v_mfma_f32_16x16x32_bf16 a[8:11], a[80:83], a[128:131], a[8:11]
v_add_u32 v13, s54, v13
v_mfma_f32_16x16x32_bf16 a[8:11], a[84:87], a[132:135], a[8:11]
v_mfma_f32_16x16x32_bf16 a[12:15], a[88:91], a[128:131], a[12:15]
v_mfma_f32_16x16x32_bf16 a[12:15], a[92:95], a[132:135], a[12:15]
s_waitcnt lgkmcnt(8)
v_mfma_f32_16x16x32_bf16 a[16:19], a[96:99], a[128:131], a[16:19]
v_mfma_f32_16x16x32_bf16 a[16:19], a[100:103], a[132:135], a[16:19]
v_mfma_f32_16x16x32_bf16 a[20:23], a[104:107], a[128:131], a[20:23]
v_mfma_f32_16x16x32_bf16 a[20:23], a[108:111], a[132:135], a[20:23]
s_waitcnt lgkmcnt(4)
v_mfma_f32_16x16x32_bf16 a[24:27], a[112:115], a[128:131], a[24:27]
v_mfma_f32_16x16x32_bf16 a[24:27], a[116:119], a[132:135], a[24:27]
v_mfma_f32_16x16x32_bf16 a[28:31], a[120:123], a[128:131], a[28:31]
v_mfma_f32_16x16x32_bf16 a[28:31], a[124:127], a[132:135], a[28:31]
s_waitcnt lgkmcnt(0)
s_barrier
v_mfma_f32_16x16x32_bf16 a[32:35], a[64:67], a[136:139], a[32:35]
ds_read_b64_tr_b16 a[128:129], v14 offset:0
v_mfma_f32_16x16x32_bf16 a[32:35], a[68:71], a[140:143], a[32:35]
ds_read_b64_tr_b16 a[130:131], v14 offset:2048
v_mfma_f32_16x16x32_bf16 a[36:39], a[72:75], a[136:139], a[36:39]
ds_read_b64_tr_b16 a[132:133], v14 offset:16384
v_mfma_f32_16x16x32_bf16 a[36:39], a[76:79], a[140:143], a[36:39]
ds_read_b64_tr_b16 a[134:135], v14 offset:18432
v_mfma_f32_16x16x32_bf16 a[40:43], a[80:83], a[136:139], a[40:43]
v_add_u32 v14, s54, v14
s_mov_b32 m0, s52
v_mfma_f32_16x16x32_bf16 a[40:43], a[84:87], a[140:143], a[40:43]
buffer_load_dwordx4 v4, s[20:23], s48 offen offset:0 lds
v_mfma_f32_16x16x32_bf16 a[44:47], a[88:91], a[136:139], a[44:47]
v_mfma_f32_16x16x32_bf16 a[44:47], a[92:95], a[140:143], a[44:47]
v_mfma_f32_16x16x32_bf16 a[48:51], a[96:99], a[136:139], a[48:51]
v_mfma_f32_16x16x32_bf16 a[48:51], a[100:103], a[140:143], a[48:51]
buffer_load_dwordx4 v5, s[20:23], s48 offen offset:1024 lds
v_mfma_f32_16x16x32_bf16 a[52:55], a[104:107], a[136:139], a[52:55]
v_mfma_f32_16x16x32_bf16 a[52:55], a[108:111], a[140:143], a[52:55]
v_mfma_f32_16x16x32_bf16 a[56:59], a[112:115], a[136:139], a[56:59]
v_mfma_f32_16x16x32_bf16 a[56:59], a[116:119], a[140:143], a[56:59]
buffer_load_dwordx4 v6, s[20:23], s48 offen offset:2048 lds
v_mfma_f32_16x16x32_bf16 a[60:63], a[120:123], a[136:139], a[60:63]
v_mfma_f32_16x16x32_bf16 a[60:63], a[124:127], a[140:143], a[60:63]
s_waitcnt lgkmcnt(0)
v_mfma_f32_16x16x32_bf16 v[64:67], a[64:67], a[128:131], v[64:67]
ds_read_b64_tr_b16 a[136:137], v15 offset:0
v_mfma_f32_16x16x32_bf16 v[64:67], a[68:71], a[132:135], v[64:67]
ds_read_b64_tr_b16 a[138:139], v15 offset:2048
buffer_load_dwordx4 v7, s[20:23], s48 offen offset:3072 lds
v_mfma_f32_16x16x32_bf16 v[68:71], a[72:75], a[128:131], v[68:71]
ds_read_b64_tr_b16 a[140:141], v15 offset:16384
s_add_u32 s48, s48, 128
v_mfma_f32_16x16x32_bf16 v[68:71], a[76:79], a[132:135], v[68:71]
ds_read_b64_tr_b16 a[142:143], v15 offset:18432
v_mfma_f32_16x16x32_bf16 v[72:75], a[80:83], a[128:131], v[72:75]
v_add_u32 v15, s54, v15
s_add_u32 m0, s52, 4096
v_mfma_f32_16x16x32_bf16 v[72:75], a[84:87], a[132:135], v[72:75]
buffer_load_dwordx4 v4, s[20:23], s49 offen offset:0 lds
v_mfma_f32_16x16x32_bf16 v[76:79], a[88:91], a[128:131], v[76:79]
v_mfma_f32_16x16x32_bf16 v[76:79], a[92:95], a[132:135], v[76:79]
v_mfma_f32_16x16x32_bf16 v[80:83], a[96:99], a[128:131], v[80:83]
v_mfma_f32_16x16x32_bf16 v[80:83], a[100:103], a[132:135], v[80:83]
buffer_load_dwordx4 v5, s[20:23], s49 offen offset:1024 lds
v_mfma_f32_16x16x32_bf16 v[84:87], a[104:107], a[128:131], v[84:87]
v_mfma_f32_16x16x32_bf16 v[84:87], a[108:111], a[132:135], v[84:87]
v_mfma_f32_16x16x32_bf16 v[88:91], a[112:115], a[128:131], v[88:91]
v_mfma_f32_16x16x32_bf16 v[88:91], a[116:119], a[132:135], v[88:91]
buffer_load_dwordx4 v6, s[20:23], s49 offen offset:2048 lds
v_mfma_f32_16x16x32_bf16 v[92:95], a[120:123], a[128:131], v[92:95]
v_mfma_f32_16x16x32_bf16 v[92:95], a[124:127], a[132:135], v[92:95]
s_waitcnt lgkmcnt(0)
v_mfma_f32_16x16x32_bf16 v[96:99], a[64:67], a[136:139], v[96:99]
ds_read_b64_tr_b16 a[128:129], v16 offset:0
v_mfma_f32_16x16x32_bf16 v[96:99], a[68:71], a[140:143], v[96:99]
ds_read_b64_tr_b16 a[130:131], v16 offset:2048
buffer_load_dwordx4 v7, s[20:23], s49 offen offset:3072 lds
v_mfma_f32_16x16x32_bf16 v[100:103], a[72:75], a[136:139], v[100:103]
ds_read_b64_tr_b16 a[132:133], v16 offset:16384
s_add_u32 s49, s49, 128
v_mfma_f32_16x16x32_bf16 v[100:103], a[76:79], a[140:143], v[100:103]
ds_read_b64_tr_b16 a[134:135], v16 offset:18432
v_mfma_f32_16x16x32_bf16 v[104:107], a[80:83], a[136:139], v[104:107]
v_add_u32 v16, s54, v16
s_mov_b32 m0, s53
v_mfma_f32_16x16x32_bf16 v[104:107], a[84:87], a[140:143], v[104:107]
buffer_load_dwordx4 v8, s[24:27], s50 offen offset:0 lds
v_mfma_f32_16x16x32_bf16 v[108:111], a[88:91], a[136:139], v[108:111]
v_mfma_f32_16x16x32_bf16 v[108:111], a[92:95], a[140:143], v[108:111]
v_mfma_f32_16x16x32_bf16 v[112:115], a[96:99], a[136:139], v[112:115]
v_mfma_f32_16x16x32_bf16 v[112:115], a[100:103], a[140:143], v[112:115]
buffer_load_dwordx4 v9, s[24:27], s50 offen offset:1024 lds
v_mfma_f32_16x16x32_bf16 v[116:119], a[104:107], a[136:139], v[116:119]
v_mfma_f32_16x16x32_bf16 v[116:119], a[108:111], a[140:143], v[116:119]
s_waitcnt vmcnt(39)
v_lshlrev_b32 v24, 16, v24
v_mfma_f32_16x16x32_bf16 v[120:123], a[112:115], a[136:139], v[120:123]
v_lshlrev_b32 v25, 16, v25
v_lshlrev_b32 v26, 16, v26
v_mfma_f32_16x16x32_bf16 v[120:123], a[116:119], a[140:143], v[120:123]
buffer_load_dwordx4 v10, s[24:27], s50 offen offset:2048 lds
v_lshlrev_b32 v27, 16, v27
v_mfma_f32_16x16x32_bf16 v[124:127], a[120:123], a[136:139], v[124:127]
v_lshlrev_b32 v28, 16, v28
v_lshlrev_b32 v29, 16, v29
v_mfma_f32_16x16x32_bf16 v[124:127], a[124:127], a[140:143], v[124:127]
s_waitcnt lgkmcnt(0)
v_lshlrev_b32 v30, 16, v30
v_mfma_f32_16x16x32_bf16 v[128:131], a[64:67], a[128:131], v[128:131]
ds_read_b64_tr_b16 a[136:137], v17 offset:0
v_mul_f32 v40, 0xbfb8aa3b, v24
v_mfma_f32_16x16x32_bf16 v[128:131], a[68:71], a[132:135], v[128:131]
ds_read_b64_tr_b16 a[138:139], v17 offset:2048
buffer_load_dwordx4 v11, s[24:27], s50 offen offset:3072 lds
v_mfma_f32_16x16x32_bf16 v[132:135], a[72:75], a[128:131], v[132:135]
ds_read_b64_tr_b16 a[140:141], v17 offset:16384
s_add_u32 s50, s50, 524288
v_mfma_f32_16x16x32_bf16 v[132:135], a[76:79], a[132:135], v[132:135]
ds_read_b64_tr_b16 a[142:143], v17 offset:18432
v_mul_f32 v41, 0xbfb8aa3b, v25
v_mfma_f32_16x16x32_bf16 v[136:139], a[80:83], a[128:131], v[136:139]
v_add_u32 v17, s54, v17
s_add_u32 m0, s53, 8192
v_mfma_f32_16x16x32_bf16 v[136:139], a[84:87], a[132:135], v[136:139]
buffer_load_dwordx4 v8, s[24:27], s51 offen offset:0 lds
v_mul_f32 v42, 0xbfb8aa3b, v26
v_mfma_f32_16x16x32_bf16 v[140:143], a[88:91], a[128:131], v[140:143]
v_mul_f32 v43, 0xbfb8aa3b, v27
v_mul_f32 v44, 0xbfb8aa3b, v28
v_mfma_f32_16x16x32_bf16 v[140:143], a[92:95], a[132:135], v[140:143]
v_mul_f32 v45, 0xbfb8aa3b, v29
v_mul_f32 v46, 0xbfb8aa3b, v30
v_mfma_f32_16x16x32_bf16 v[144:147], a[96:99], a[128:131], v[144:147]
v_exp_f32 v40, v40
v_mfma_f32_16x16x32_bf16 v[144:147], a[100:103], a[132:135], v[144:147]
buffer_load_dwordx4 v9, s[24:27], s51 offen offset:1024 lds
v_mfma_f32_16x16x32_bf16 v[148:151], a[104:107], a[128:131], v[148:151]
v_exp_f32 v41, v41
v_mfma_f32_16x16x32_bf16 v[148:151], a[108:111], a[132:135], v[148:151]
v_exp_f32 v42, v42
v_mfma_f32_16x16x32_bf16 v[152:155], a[112:115], a[128:131], v[152:155]
v_exp_f32 v43, v43
v_mfma_f32_16x16x32_bf16 v[152:155], a[116:119], a[132:135], v[152:155]
buffer_load_dwordx4 v10, s[24:27], s51 offen offset:2048 lds
v_mfma_f32_16x16x32_bf16 v[156:159], a[120:123], a[128:131], v[156:159]
v_exp_f32 v44, v44
v_mfma_f32_16x16x32_bf16 v[156:159], a[124:127], a[132:135], v[156:159]
s_waitcnt lgkmcnt(0)
v_mfma_f32_16x16x32_bf16 v[160:163], a[64:67], a[136:139], v[160:163]
ds_read_b64_tr_b16 a[128:129], v18 offset:0
v_mfma_f32_16x16x32_bf16 v[160:163], a[68:71], a[140:143], v[160:163]
ds_read_b64_tr_b16 a[130:131], v18 offset:2048
buffer_load_dwordx4 v11, s[24:27], s51 offen offset:3072 lds
v_mfma_f32_16x16x32_bf16 v[164:167], a[72:75], a[136:139], v[164:167]
ds_read_b64_tr_b16 a[132:133], v18 offset:16384
s_add_u32 s51, s51, 524288
v_mfma_f32_16x16x32_bf16 v[164:167], a[76:79], a[140:143], v[164:167]
ds_read_b64_tr_b16 a[134:135], v18 offset:18432
v_mfma_f32_16x16x32_bf16 v[168:171], a[80:83], a[136:139], v[168:171]
v_add_u32 v18, s54, v18
v_mfma_f32_16x16x32_bf16 v[168:171], a[84:87], a[140:143], v[168:171]
v_exp_f32 v45, v45
v_mfma_f32_16x16x32_bf16 v[172:175], a[88:91], a[136:139], v[172:175]
v_exp_f32 v46, v46
v_mfma_f32_16x16x32_bf16 v[172:175], a[92:95], a[140:143], v[172:175]
v_add_f32 v40, 1.0, v40
v_add_f32 v41, 1.0, v41
v_mfma_f32_16x16x32_bf16 v[176:179], a[96:99], a[136:139], v[176:179]
v_add_f32 v42, 1.0, v42
v_add_f32 v43, 1.0, v43
v_mfma_f32_16x16x32_bf16 v[176:179], a[100:103], a[140:143], v[176:179]
v_add_f32 v44, 1.0, v44
v_add_f32 v45, 1.0, v45
v_mfma_f32_16x16x32_bf16 v[180:183], a[104:107], a[136:139], v[180:183]
v_add_f32 v46, 1.0, v46
v_mfma_f32_16x16x32_bf16 v[180:183], a[108:111], a[140:143], v[180:183]
buffer_load_dword a255, v22, s[24:27], 0 offen
v_add_u32 v22, 524288, v22
v_mfma_f32_16x16x32_bf16 v[184:187], a[112:115], a[136:139], v[184:187]
buffer_load_dword a255, v23, s[20:23], 0 offen
v_add_u32 v23, 128, v23
v_mfma_f32_16x16x32_bf16 v[184:187], a[116:119], a[140:143], v[184:187]
s_cmp_lt_u32 s16, 8
s_cselect_b32 s46, s17, 0
s_cselect_b32 s6, 1408, 0
v_mfma_f32_16x16x32_bf16 v[188:191], a[120:123], a[136:139], v[188:191]
s_add_u32 s16, s16, 1
buffer_load_dword a255, v3, s[44:47], 0 offen
v_mfma_f32_16x16x32_bf16 v[188:191], a[124:127], a[140:143], v[188:191]
s_waitcnt lgkmcnt(0)
v_add_u32 v3, s6, v3
v_mfma_f32_16x16x32_bf16 v[192:195], a[64:67], a[128:131], v[192:195]
ds_read_b64_tr_b16 a[136:137], v19 offset:0
v_mfma_f32_16x16x32_bf16 v[192:195], a[68:71], a[132:135], v[192:195]
ds_read_b64_tr_b16 a[138:139], v19 offset:2048
v_mfma_f32_16x16x32_bf16 v[196:199], a[72:75], a[128:131], v[196:199]
ds_read_b64_tr_b16 a[140:141], v19 offset:16384
v_mfma_f32_16x16x32_bf16 v[196:199], a[76:79], a[132:135], v[196:199]
ds_read_b64_tr_b16 a[142:143], v19 offset:18432
v_mfma_f32_16x16x32_bf16 v[200:203], a[80:83], a[128:131], v[200:203]
v_add_u32 v19, s54, v19
v_mfma_f32_16x16x32_bf16 v[200:203], a[84:87], a[132:135], v[200:203]
v_rcp_f32 v40, v40
v_mfma_f32_16x16x32_bf16 v[204:207], a[88:91], a[128:131], v[204:207]
v_rcp_f32 v41, v41
v_mfma_f32_16x16x32_bf16 v[204:207], a[92:95], a[132:135], v[204:207]
v_rcp_f32 v42, v42
v_mfma_f32_16x16x32_bf16 v[208:211], a[96:99], a[128:131], v[208:211]
v_rcp_f32 v43, v43
v_mfma_f32_16x16x32_bf16 v[208:211], a[100:103], a[132:135], v[208:211]
v_mfma_f32_16x16x32_bf16 v[212:215], a[104:107], a[128:131], v[212:215]
v_mfma_f32_16x16x32_bf16 v[212:215], a[108:111], a[132:135], v[212:215]
s_cmp_eq_u32 s53, s69
s_cselect_b32 s54, s58, s59
v_mfma_f32_16x16x32_bf16 v[216:219], a[112:115], a[128:131], v[216:219]
s_add_u32 s53, s53, 32768
s_cmp_eq_u32 s53, s68
s_cselect_b32 s53, s69, s53
v_mfma_f32_16x16x32_bf16 v[216:219], a[116:119], a[132:135], v[216:219]
s_xor_b32 s52, s52, 0x38000
v_mfma_f32_16x16x32_bf16 v[220:223], a[120:123], a[128:131], v[220:223]
v_mfma_f32_16x16x32_bf16 v[220:223], a[124:127], a[132:135], v[220:223]
s_waitcnt vmcnt(26)
s_barrier
s_waitcnt lgkmcnt(0)
v_mfma_f32_16x16x32_bf16 v[224:227], a[64:67], a[136:139], v[224:227]
ds_read_b64_tr_b16 a[128:129], v12 offset:0
ds_read_b128 a[64:67], v20 offset:0
v_mfma_f32_16x16x32_bf16 v[224:227], a[68:71], a[140:143], v[224:227]
ds_read_b64_tr_b16 a[130:131], v12 offset:2048
ds_read_b128 a[68:71], v21 offset:0
v_mfma_f32_16x16x32_bf16 v[228:231], a[72:75], a[136:139], v[228:231]
ds_read_b64_tr_b16 a[132:133], v12 offset:16384
ds_read_b128 a[72:75], v20 offset:2048
v_mfma_f32_16x16x32_bf16 v[228:231], a[76:79], a[140:143], v[228:231]
ds_read_b64_tr_b16 a[134:135], v12 offset:18432
ds_read_b128 a[76:79], v21 offset:2048
v_mfma_f32_16x16x32_bf16 v[232:235], a[80:83], a[136:139], v[232:235]
v_add_u32 v12, s54, v12
ds_read_b128 a[80:83], v20 offset:4096
v_mfma_f32_16x16x32_bf16 v[232:235], a[84:87], a[140:143], v[232:235]
ds_read_b128 a[84:87], v21 offset:4096
v_mfma_f32_16x16x32_bf16 v[236:239], a[88:91], a[136:139], v[236:239]
ds_read_b128 a[88:91], v20 offset:6144
v_mfma_f32_16x16x32_bf16 v[236:239], a[92:95], a[140:143], v[236:239]
ds_read_b128 a[92:95], v21 offset:6144
v_mfma_f32_16x16x32_bf16 v[240:243], a[96:99], a[136:139], v[240:243]
ds_read_b128 a[96:99], v20 offset:8192
v_mfma_f32_16x16x32_bf16 v[240:243], a[100:103], a[140:143], v[240:243]
ds_read_b128 a[100:103], v21 offset:8192
v_mfma_f32_16x16x32_bf16 v[244:247], a[104:107], a[136:139], v[244:247]
ds_read_b128 a[104:107], v20 offset:10240
v_mfma_f32_16x16x32_bf16 v[244:247], a[108:111], a[140:143], v[244:247]
ds_read_b128 a[108:111], v21 offset:10240
v_mfma_f32_16x16x32_bf16 v[248:251], a[112:115], a[136:139], v[248:251]
ds_read_b128 a[112:115], v20 offset:12288
v_mfma_f32_16x16x32_bf16 v[248:251], a[116:119], a[140:143], v[248:251]
ds_read_b128 a[116:119], v21 offset:12288
v_mfma_f32_16x16x32_bf16 v[252:255], a[120:123], a[136:139], v[252:255]
ds_read_b128 a[120:123], v20 offset:14336
v_mfma_f32_16x16x32_bf16 v[252:255], a[124:127], a[140:143], v[252:255]
ds_read_b128 a[124:127], v21 offset:14336
v_xor_b32 v20, 0x38000, v20
v_xor_b32 v21, 0x38000, v21
s_waitcnt lgkmcnt(12)
v_mfma_f32_16x16x32_bf16 a[0:3], a[64:67], a[128:131], a[0:3]
ds_read_b64_tr_b16 a[136:137], v13 offset:0
v_mfma_f32_16x16x32_bf16 a[0:3], a[68:71], a[132:135], a[0:3]
ds_read_b64_tr_b16 a[138:139], v13 offset:2048
v_mfma_f32_16x16x32_bf16 a[4:7], a[72:75], a[128:131], a[4:7]
ds_read_b64_tr_b16 a[140:141], v13 offset:16384
v_mfma_f32_16x16x32_bf16 a[4:7], a[76:79], a[132:135], a[4:7]
s_waitcnt lgkmcnt(11)
ds_read_b64_tr_b16 a[142:143], v13 offset:18432
v_mfma_f32_16x16x32_bf16 a[8:11], a[80:83], a[128:131], a[8:11]
v_add_u32 v13, s54, v13
v_mfma_f32_16x16x32_bf16 a[8:11], a[84:87], a[132:135], a[8:11]
v_rcp_f32 v44, v44
v_mfma_f32_16x16x32_bf16 a[12:15], a[88:91], a[128:131], a[12:15]
v_rcp_f32 v45, v45
v_mfma_f32_16x16x32_bf16 a[12:15], a[92:95], a[132:135], a[12:15]
s_waitcnt lgkmcnt(8)
v_mfma_f32_16x16x32_bf16 a[16:19], a[96:99], a[128:131], a[16:19]
v_rcp_f32 v46, v46
v_mfma_f32_16x16x32_bf16 a[16:19], a[100:103], a[132:135], a[16:19]
v_mul_f32 v24, v24, v40
v_mul_f32 v25, v25, v41
v_mfma_f32_16x16x32_bf16 a[20:23], a[104:107], a[128:131], a[20:23]
v_mul_f32 v26, v26, v42
v_mul_f32 v27, v27, v43
v_mfma_f32_16x16x32_bf16 a[20:23], a[108:111], a[132:135], a[20:23]
s_waitcnt lgkmcnt(4)
v_mul_f32 v28, v28, v44
v_mfma_f32_16x16x32_bf16 a[24:27], a[112:115], a[128:131], a[24:27]
v_mul_f32 v29, v29, v45
v_mul_f32 v30, v30, v46
v_mfma_f32_16x16x32_bf16 a[24:27], a[116:119], a[132:135], a[24:27]
v_cvt_pk_bf16_f32 v24, v24, v24
v_and_b32 v24, 0xffff0000, v24
v_mfma_f32_16x16x32_bf16 a[28:31], a[120:123], a[128:131], a[28:31]
v_cvt_pk_bf16_f32 v25, v25, v25
v_and_b32 v25, 0xffff0000, v25
v_mfma_f32_16x16x32_bf16 a[28:31], a[124:127], a[132:135], a[28:31]
s_waitcnt lgkmcnt(0)
s_barrier
v_mfma_f32_16x16x32_bf16 a[32:35], a[64:67], a[136:139], a[32:35]
ds_read_b64_tr_b16 a[128:129], v14 offset:0
v_cvt_pk_bf16_f32 v26, v26, v26
v_mfma_f32_16x16x32_bf16 a[32:35], a[68:71], a[140:143], a[32:35]
ds_read_b64_tr_b16 a[130:131], v14 offset:2048
v_and_b32 v26, 0xffff0000, v26
v_mfma_f32_16x16x32_bf16 a[36:39], a[72:75], a[136:139], a[36:39]
ds_read_b64_tr_b16 a[132:133], v14 offset:16384
v_cvt_pk_bf16_f32 v27, v27, v27
v_mfma_f32_16x16x32_bf16 a[36:39], a[76:79], a[140:143], a[36:39]
ds_read_b64_tr_b16 a[134:135], v14 offset:18432
v_and_b32 v27, 0xffff0000, v27
v_mfma_f32_16x16x32_bf16 a[40:43], a[80:83], a[136:139], a[40:43]
v_add_u32 v14, s54, v14
s_mov_b32 m0, s52
v_mfma_f32_16x16x32_bf16 a[40:43], a[84:87], a[140:143], a[40:43]
buffer_load_dwordx4 v4, s[20:23], s48 offen offset:0 lds
v_cvt_pk_bf16_f32 v28, v28, v28
v_mfma_f32_16x16x32_bf16 a[44:47], a[88:91], a[136:139], a[44:47]
v_and_b32 v28, 0xffff0000, v28
v_cvt_pk_bf16_f32 v29, v29, v29
v_mfma_f32_16x16x32_bf16 a[44:47], a[92:95], a[140:143], a[44:47]
v_and_b32 v29, 0xffff0000, v29
v_cvt_pk_bf16_f32 v30, v30, v30
v_mfma_f32_16x16x32_bf16 a[48:51], a[96:99], a[136:139], a[48:51]
v_and_b32 v30, 0xffff0000, v30
s_waitcnt vmcnt(23)
v_mfma_f32_16x16x32_bf16 a[48:51], a[100:103], a[140:143], a[48:51]
buffer_load_dwordx4 v5, s[20:23], s48 offen offset:1024 lds
v_accvgpr_read_b32 v42, a208
v_mfma_f32_16x16x32_bf16 a[52:55], a[104:107], a[136:139], a[52:55]
v_lshlrev_b32 v40, 16, v42
v_and_b32 v41, 0xffff0000, v42
v_mfma_f32_16x16x32_bf16 a[52:55], a[108:111], a[140:143], a[52:55]
v_mul_f32 v32, v40, v24
v_mul_f32 v33, v41, v24
v_mfma_f32_16x16x32_bf16 a[56:59], a[112:115], a[136:139], a[56:59]
v_accvgpr_read_b32 v42, a209
v_lshlrev_b32 v40, 16, v42
v_mfma_f32_16x16x32_bf16 a[56:59], a[116:119], a[140:143], a[56:59]
buffer_load_dwordx4 v6, s[20:23], s48 offen offset:2048 lds
v_and_b32 v41, 0xffff0000, v42
v_mfma_f32_16x16x32_bf16 a[60:63], a[120:123], a[136:139], a[60:63]
v_mul_f32 v34, v40, v24
v_mul_f32 v35, v41, v24
v_mfma_f32_16x16x32_bf16 a[60:63], a[124:127], a[140:143], a[60:63]
s_waitcnt lgkmcnt(0)
v_accvgpr_read_b32 v42, a210
v_mfma_f32_16x16x32_bf16 v[64:67], a[64:67], a[128:131], v[64:67]
ds_read_b64_tr_b16 a[136:137], v15 offset:0
v_lshlrev_b32 v40, 16, v42
v_mfma_f32_16x16x32_bf16 v[64:67], a[68:71], a[132:135], v[64:67]
ds_read_b64_tr_b16 a[138:139], v15 offset:2048
buffer_load_dwordx4 v7, s[20:23], s48 offen offset:3072 lds
v_mfma_f32_16x16x32_bf16 v[68:71], a[72:75], a[128:131], v[68:71]
ds_read_b64_tr_b16 a[140:141], v15 offset:16384
s_add_u32 s48, s48, 128
v_mfma_f32_16x16x32_bf16 v[68:71], a[76:79], a[132:135], v[68:71]
ds_read_b64_tr_b16 a[142:143], v15 offset:18432
v_and_b32 v41, 0xffff0000, v42
v_mfma_f32_16x16x32_bf16 v[72:75], a[80:83], a[128:131], v[72:75]
v_add_u32 v15, s54, v15
s_add_u32 m0, s52, 4096
v_mfma_f32_16x16x32_bf16 v[72:75], a[84:87], a[132:135], v[72:75]
buffer_load_dwordx4 v4, s[20:23], s49 offen offset:0 lds
v_mul_f32 v36, v40, v24
v_mfma_f32_16x16x32_bf16 v[76:79], a[88:91], a[128:131], v[76:79]
v_mul_f32 v37, v41, v24
v_accvgpr_read_b32 v42, a211
v_mfma_f32_16x16x32_bf16 v[76:79], a[92:95], a[132:135], v[76:79]
v_lshlrev_b32 v40, 16, v42
v_and_b32 v41, 0xffff0000, v42
v_mfma_f32_16x16x32_bf16 v[80:83], a[96:99], a[128:131], v[80:83]
v_mul_f32 v38, v40, v24
v_mul_f32 v39, v41, v24
v_mfma_f32_16x16x32_bf16 v[80:83], a[100:103], a[132:135], v[80:83]
buffer_load_dwordx4 v5, s[20:23], s49 offen offset:1024 lds
v_accvgpr_read_b32 v42, a212
v_mfma_f32_16x16x32_bf16 v[84:87], a[104:107], a[128:131], v[84:87]
v_lshlrev_b32 v40, 16, v42
v_and_b32 v41, 0xffff0000, v42
v_mfma_f32_16x16x32_bf16 v[84:87], a[108:111], a[132:135], v[84:87]
v_fmac_f32 v32, v40, v25
v_fmac_f32 v33, v41, v25
v_mfma_f32_16x16x32_bf16 v[88:91], a[112:115], a[128:131], v[88:91]
v_accvgpr_read_b32 v42, a213
v_lshlrev_b32 v40, 16, v42
v_mfma_f32_16x16x32_bf16 v[88:91], a[116:119], a[132:135], v[88:91]
buffer_load_dwordx4 v6, s[20:23], s49 offen offset:2048 lds
v_and_b32 v41, 0xffff0000, v42
v_mfma_f32_16x16x32_bf16 v[92:95], a[120:123], a[128:131], v[92:95]
v_fmac_f32 v34, v40, v25
v_fmac_f32 v35, v41, v25
v_mfma_f32_16x16x32_bf16 v[92:95], a[124:127], a[132:135], v[92:95]
s_waitcnt lgkmcnt(0)
v_accvgpr_read_b32 v42, a214
v_mfma_f32_16x16x32_bf16 v[96:99], a[64:67], a[136:139], v[96:99]
ds_read_b64_tr_b16 a[128:129], v16 offset:0
v_lshlrev_b32 v40, 16, v42
v_mfma_f32_16x16x32_bf16 v[96:99], a[68:71], a[140:143], v[96:99]
ds_read_b64_tr_b16 a[130:131], v16 offset:2048
buffer_load_dwordx4 v7, s[20:23], s49 offen offset:3072 lds
v_mfma_f32_16x16x32_bf16 v[100:103], a[72:75], a[136:139], v[100:103]
ds_read_b64_tr_b16 a[132:133], v16 offset:16384
s_add_u32 s49, s49, 128
v_mfma_f32_16x16x32_bf16 v[100:103], a[76:79], a[140:143], v[100:103]
ds_read_b64_tr_b16 a[134:135], v16 offset:18432
v_and_b32 v41, 0xffff0000, v42
v_mfma_f32_16x16x32_bf16 v[104:107], a[80:83], a[136:139], v[104:107]
v_add_u32 v16, s54, v16
s_mov_b32 m0, s53
v_mfma_f32_16x16x32_bf16 v[104:107], a[84:87], a[140:143], v[104:107]
buffer_load_dwordx4 v8, s[24:27], s50 offen offset:0 lds
v_fmac_f32 v36, v40, v25
v_mfma_f32_16x16x32_bf16 v[108:111], a[88:91], a[136:139], v[108:111]
v_fmac_f32 v37, v41, v25
v_accvgpr_read_b32 v42, a215
v_mfma_f32_16x16x32_bf16 v[108:111], a[92:95], a[140:143], v[108:111]
v_lshlrev_b32 v40, 16, v42
v_and_b32 v41, 0xffff0000, v42
v_mfma_f32_16x16x32_bf16 v[112:115], a[96:99], a[136:139], v[112:115]
v_fmac_f32 v38, v40, v25
v_fmac_f32 v39, v41, v25
v_mfma_f32_16x16x32_bf16 v[112:115], a[100:103], a[140:143], v[112:115]
buffer_load_dwordx4 v9, s[24:27], s50 offen offset:1024 lds
v_accvgpr_read_b32 v42, a216
v_mfma_f32_16x16x32_bf16 v[116:119], a[104:107], a[136:139], v[116:119]
v_lshlrev_b32 v40, 16, v42
v_and_b32 v41, 0xffff0000, v42
v_mfma_f32_16x16x32_bf16 v[116:119], a[108:111], a[140:143], v[116:119]
v_fmac_f32 v32, v40, v26
v_fmac_f32 v33, v41, v26
v_mfma_f32_16x16x32_bf16 v[120:123], a[112:115], a[136:139], v[120:123]
v_accvgpr_read_b32 v42, a217
v_lshlrev_b32 v40, 16, v42
v_mfma_f32_16x16x32_bf16 v[120:123], a[116:119], a[140:143], v[120:123]
buffer_load_dwordx4 v10, s[24:27], s50 offen offset:2048 lds
v_and_b32 v41, 0xffff0000, v42
v_mfma_f32_16x16x32_bf16 v[124:127], a[120:123], a[136:139], v[124:127]
v_fmac_f32 v34, v40, v26
v_fmac_f32 v35, v41, v26
v_mfma_f32_16x16x32_bf16 v[124:127], a[124:127], a[140:143], v[124:127]
s_waitcnt lgkmcnt(0)
v_accvgpr_read_b32 v42, a218
v_mfma_f32_16x16x32_bf16 v[128:131], a[64:67], a[128:131], v[128:131]
ds_read_b64_tr_b16 a[136:137], v17 offset:0
v_lshlrev_b32 v40, 16, v42
v_mfma_f32_16x16x32_bf16 v[128:131], a[68:71], a[132:135], v[128:131]
ds_read_b64_tr_b16 a[138:139], v17 offset:2048
buffer_load_dwordx4 v11, s[24:27], s50 offen offset:3072 lds
v_mfma_f32_16x16x32_bf16 v[132:135], a[72:75], a[128:131], v[132:135]
ds_read_b64_tr_b16 a[140:141], v17 offset:16384
s_add_u32 s50, s50, 524288
v_mfma_f32_16x16x32_bf16 v[132:135], a[76:79], a[132:135], v[132:135]
ds_read_b64_tr_b16 a[142:143], v17 offset:18432
v_and_b32 v41, 0xffff0000, v42
v_mfma_f32_16x16x32_bf16 v[136:139], a[80:83], a[128:131], v[136:139]
v_add_u32 v17, s54, v17
s_add_u32 m0, s53, 8192
v_mfma_f32_16x16x32_bf16 v[136:139], a[84:87], a[132:135], v[136:139]
buffer_load_dwordx4 v8, s[24:27], s51 offen offset:0 lds
v_fmac_f32 v36, v40, v26
v_mfma_f32_16x16x32_bf16 v[140:143], a[88:91], a[128:131], v[140:143]
v_fmac_f32 v37, v41, v26
v_accvgpr_read_b32 v42, a219
v_mfma_f32_16x16x32_bf16 v[140:143], a[92:95], a[132:135], v[140:143]
v_lshlrev_b32 v40, 16, v42
v_and_b32 v41, 0xffff0000, v42
v_mfma_f32_16x16x32_bf16 v[144:147], a[96:99], a[128:131], v[144:147]
v_fmac_f32 v38, v40, v26
v_fmac_f32 v39, v41, v26
v_mfma_f32_16x16x32_bf16 v[144:147], a[100:103], a[132:135], v[144:147]
buffer_load_dwordx4 v9, s[24:27], s51 offen offset:1024 lds
v_accvgpr_read_b32 v42, a220
v_mfma_f32_16x16x32_bf16 v[148:151], a[104:107], a[128:131], v[148:151]
v_lshlrev_b32 v40, 16, v42
v_and_b32 v41, 0xffff0000, v42
v_mfma_f32_16x16x32_bf16 v[148:151], a[108:111], a[132:135], v[148:151]
v_fmac_f32 v32, v40, v27
v_fmac_f32 v33, v41, v27
v_mfma_f32_16x16x32_bf16 v[152:155], a[112:115], a[128:131], v[152:155]
v_accvgpr_read_b32 v42, a221
v_lshlrev_b32 v40, 16, v42
v_mfma_f32_16x16x32_bf16 v[152:155], a[116:119], a[132:135], v[152:155]
buffer_load_dwordx4 v10, s[24:27], s51 offen offset:2048 lds
v_and_b32 v41, 0xffff0000, v42
v_mfma_f32_16x16x32_bf16 v[156:159], a[120:123], a[128:131], v[156:159]
v_fmac_f32 v34, v40, v27
v_fmac_f32 v35, v41, v27
v_mfma_f32_16x16x32_bf16 v[156:159], a[124:127], a[132:135], v[156:159]
s_waitcnt lgkmcnt(0)
v_accvgpr_read_b32 v42, a222
v_mfma_f32_16x16x32_bf16 v[160:163], a[64:67], a[136:139], v[160:163]
ds_read_b64_tr_b16 a[128:129], v18 offset:0
v_lshlrev_b32 v40, 16, v42
v_mfma_f32_16x16x32_bf16 v[160:163], a[68:71], a[140:143], v[160:163]
ds_read_b64_tr_b16 a[130:131], v18 offset:2048
buffer_load_dwordx4 v11, s[24:27], s51 offen offset:3072 lds
v_mfma_f32_16x16x32_bf16 v[164:167], a[72:75], a[136:139], v[164:167]
ds_read_b64_tr_b16 a[132:133], v18 offset:16384
s_add_u32 s51, s51, 524288
v_mfma_f32_16x16x32_bf16 v[164:167], a[76:79], a[140:143], v[164:167]
ds_read_b64_tr_b16 a[134:135], v18 offset:18432
v_and_b32 v41, 0xffff0000, v42
v_mfma_f32_16x16x32_bf16 v[168:171], a[80:83], a[136:139], v[168:171]
v_add_u32 v18, s54, v18
v_fmac_f32 v36, v40, v27
v_mfma_f32_16x16x32_bf16 v[168:171], a[84:87], a[140:143], v[168:171]
v_fmac_f32 v37, v41, v27
v_accvgpr_read_b32 v42, a223
v_mfma_f32_16x16x32_bf16 v[172:175], a[88:91], a[136:139], v[172:175]
v_lshlrev_b32 v40, 16, v42
v_and_b32 v41, 0xffff0000, v42
v_mfma_f32_16x16x32_bf16 v[172:175], a[92:95], a[140:143], v[172:175]
v_fmac_f32 v38, v40, v27
v_fmac_f32 v39, v41, v27
v_mfma_f32_16x16x32_bf16 v[176:179], a[96:99], a[136:139], v[176:179]
v_accvgpr_read_b32 v42, a224
v_lshlrev_b32 v40, 16, v42
v_mfma_f32_16x16x32_bf16 v[176:179], a[100:103], a[140:143], v[176:179]
v_and_b32 v41, 0xffff0000, v42
v_fmac_f32 v32, v40, v28
v_mfma_f32_16x16x32_bf16 v[180:183], a[104:107], a[136:139], v[180:183]
v_fmac_f32 v33, v41, v28
v_accvgpr_read_b32 v42, a225
v_mfma_f32_16x16x32_bf16 v[180:183], a[108:111], a[140:143], v[180:183]
buffer_load_dword a255, v22, s[24:27], 0 offen
v_add_u32 v22, 524288, v22
v_mfma_f32_16x16x32_bf16 v[184:187], a[112:115], a[136:139], v[184:187]
buffer_load_dword a255, v23, s[20:23], 0 offen
v_add_u32 v23, 128, v23
v_mfma_f32_16x16x32_bf16 v[184:187], a[116:119], a[140:143], v[184:187]
s_cmp_lt_u32 s16, 8
s_cselect_b32 s46, s17, 0
s_cselect_b32 s6, 1408, 0
v_mfma_f32_16x16x32_bf16 v[188:191], a[120:123], a[136:139], v[188:191]
s_add_u32 s16, s16, 1
buffer_load_dword a255, v3, s[44:47], 0 offen
v_mfma_f32_16x16x32_bf16 v[188:191], a[124:127], a[140:143], v[188:191]
s_waitcnt lgkmcnt(0)
v_add_u32 v3, s6, v3
v_mfma_f32_16x16x32_bf16 v[192:195], a[64:67], a[128:131], v[192:195]
ds_read_b64_tr_b16 a[136:137], v19 offset:0
v_lshlrev_b32 v40, 16, v42
v_mfma_f32_16x16x32_bf16 v[192:195], a[68:71], a[132:135], v[192:195]
ds_read_b64_tr_b16 a[138:139], v19 offset:2048
v_and_b32 v41, 0xffff0000, v42
v_mfma_f32_16x16x32_bf16 v[196:199], a[72:75], a[128:131], v[196:199]
ds_read_b64_tr_b16 a[140:141], v19 offset:16384
v_fmac_f32 v34, v40, v28
v_mfma_f32_16x16x32_bf16 v[196:199], a[76:79], a[132:135], v[196:199]
ds_read_b64_tr_b16 a[142:143], v19 offset:18432
v_fmac_f32 v35, v41, v28
v_mfma_f32_16x16x32_bf16 v[200:203], a[80:83], a[128:131], v[200:203]
v_add_u32 v19, s54, v19
v_accvgpr_read_b32 v42, a226
v_mfma_f32_16x16x32_bf16 v[200:203], a[84:87], a[132:135], v[200:203]
v_lshlrev_b32 v40, 16, v42
v_and_b32 v41, 0xffff0000, v42
v_mfma_f32_16x16x32_bf16 v[204:207], a[88:91], a[128:131], v[204:207]
v_fmac_f32 v36, v40, v28
v_fmac_f32 v37, v41, v28
v_mfma_f32_16x16x32_bf16 v[204:207], a[92:95], a[132:135], v[204:207]
v_accvgpr_read_b32 v42, a227
v_lshlrev_b32 v40, 16, v42
v_mfma_f32_16x16x32_bf16 v[208:211], a[96:99], a[128:131], v[208:211]
v_and_b32 v41, 0xffff0000, v42
v_fmac_f32 v38, v40, v28
v_mfma_f32_16x16x32_bf16 v[208:211], a[100:103], a[132:135], v[208:211]
v_mfma_f32_16x16x32_bf16 v[212:215], a[104:107], a[128:131], v[212:215]
v_mfma_f32_16x16x32_bf16 v[212:215], a[108:111], a[132:135], v[212:215]
s_cmp_eq_u32 s53, s69
s_cselect_b32 s54, s58, s59
v_mfma_f32_16x16x32_bf16 v[216:219], a[112:115], a[128:131], v[216:219]
s_add_u32 s53, s53, 32768
s_cmp_eq_u32 s53, s68
s_cselect_b32 s53, s69, s53
v_mfma_f32_16x16x32_bf16 v[216:219], a[116:119], a[132:135], v[216:219]
s_xor_b32 s52, s52, 0x38000
v_mfma_f32_16x16x32_bf16 v[220:223], a[120:123], a[128:131], v[220:223]
v_mfma_f32_16x16x32_bf16 v[220:223], a[124:127], a[132:135], v[220:223]
s_waitcnt vmcnt(22)
s_barrier
s_waitcnt lgkmcnt(0)
v_mfma_f32_16x16x32_bf16 v[224:227], a[64:67], a[136:139], v[224:227]
ds_read_b64_tr_b16 a[128:129], v12 offset:0
ds_read_b128 a[64:67], v20 offset:0
v_mfma_f32_16x16x32_bf16 v[224:227], a[68:71], a[140:143], v[224:227]
ds_read_b64_tr_b16 a[130:131], v12 offset:2048
ds_read_b128 a[68:71], v21 offset:0
v_mfma_f32_16x16x32_bf16 v[228:231], a[72:75], a[136:139], v[228:231]
ds_read_b64_tr_b16 a[132:133], v12 offset:16384
ds_read_b128 a[72:75], v20 offset:2048
v_mfma_f32_16x16x32_bf16 v[228:231], a[76:79], a[140:143], v[228:231]
ds_read_b64_tr_b16 a[134:135], v12 offset:18432
ds_read_b128 a[76:79], v21 offset:2048
v_mfma_f32_16x16x32_bf16 v[232:235], a[80:83], a[136:139], v[232:235]
v_add_u32 v12, s54, v12
ds_read_b128 a[80:83], v20 offset:4096
v_mfma_f32_16x16x32_bf16 v[232:235], a[84:87], a[140:143], v[232:235]
ds_read_b128 a[84:87], v21 offset:4096
v_mfma_f32_16x16x32_bf16 v[236:239], a[88:91], a[136:139], v[236:239]
ds_read_b128 a[88:91], v20 offset:6144
v_mfma_f32_16x16x32_bf16 v[236:239], a[92:95], a[140:143], v[236:239]
ds_read_b128 a[92:95], v21 offset:6144
v_mfma_f32_16x16x32_bf16 v[240:243], a[96:99], a[136:139], v[240:243]
ds_read_b128 a[96:99], v20 offset:8192
v_mfma_f32_16x16x32_bf16 v[240:243], a[100:103], a[140:143], v[240:243]
ds_read_b128 a[100:103], v21 offset:8192
v_mfma_f32_16x16x32_bf16 v[244:247], a[104:107], a[136:139], v[244:247]
ds_read_b128 a[104:107], v20 offset:10240
v_mfma_f32_16x16x32_bf16 v[244:247], a[108:111], a[140:143], v[244:247]
ds_read_b128 a[108:111], v21 offset:10240
v_mfma_f32_16x16x32_bf16 v[248:251], a[112:115], a[136:139], v[248:251]
ds_read_b128 a[112:115], v20 offset:12288
v_mfma_f32_16x16x32_bf16 v[248:251], a[116:119], a[140:143], v[248:251]
ds_read_b128 a[116:119], v21 offset:12288
v_mfma_f32_16x16x32_bf16 v[252:255], a[120:123], a[136:139], v[252:255]
ds_read_b128 a[120:123], v20 offset:14336
v_mfma_f32_16x16x32_bf16 v[252:255], a[124:127], a[140:143], v[252:255]
ds_read_b128 a[124:127], v21 offset:14336
v_xor_b32 v20, 0x38000, v20
v_xor_b32 v21, 0x38000, v21
s_waitcnt lgkmcnt(12)
v_mfma_f32_16x16x32_bf16 a[0:3], a[64:67], a[128:131], a[0:3]
ds_read_b64_tr_b16 a[136:137], v13 offset:0
v_fmac_f32 v39, v41, v28
v_mfma_f32_16x16x32_bf16 a[0:3], a[68:71], a[132:135], a[0:3]
ds_read_b64_tr_b16 a[138:139], v13 offset:2048
v_accvgpr_read_b32 v42, a228
v_mfma_f32_16x16x32_bf16 a[4:7], a[72:75], a[128:131], a[4:7]
ds_read_b64_tr_b16 a[140:141], v13 offset:16384
v_lshlrev_b32 v40, 16, v42
v_mfma_f32_16x16x32_bf16 a[4:7], a[76:79], a[132:135], a[4:7]
s_waitcnt lgkmcnt(11)
ds_read_b64_tr_b16 a[142:143], v13 offset:18432
v_mfma_f32_16x16x32_bf16 a[8:11], a[80:83], a[128:131], a[8:11]
v_add_u32 v13, s54, v13
v_and_b32 v41, 0xffff0000, v42
v_mfma_f32_16x16x32_bf16 a[8:11], a[84:87], a[132:135], a[8:11]
v_fmac_f32 v32, v40, v29
v_fmac_f32 v33, v41, v29
v_mfma_f32_16x16x32_bf16 a[12:15], a[88:91], a[128:131], a[12:15]
v_accvgpr_read_b32 v42, a229
v_lshlrev_b32 v40, 16, v42
v_mfma_f32_16x16x32_bf16 a[12:15], a[92:95], a[132:135], a[12:15]
s_waitcnt lgkmcnt(8)
v_and_b32 v41, 0xffff0000, v42
v_mfma_f32_16x16x32_bf16 a[16:19], a[96:99], a[128:131], a[16:19]
v_fmac_f32 v34, v40, v29
v_fmac_f32 v35, v41, v29
v_mfma_f32_16x16x32_bf16 a[16:19], a[100:103], a[132:135], a[16:19]
v_accvgpr_read_b32 v42, a230
v_lshlrev_b32 v40, 16, v42
v_mfma_f32_16x16x32_bf16 a[20:23], a[104:107], a[128:131], a[20:23]
v_and_b32 v41, 0xffff0000, v42
v_fmac_f32 v36, v40, v29
v_mfma_f32_16x16x32_bf16 a[20:23], a[108:111], a[132:135], a[20:23]
s_waitcnt lgkmcnt(4)
v_fmac_f32 v37, v41, v29
v_mfma_f32_16x16x32_bf16 a[24:27], a[112:115], a[128:131], a[24:27]
v_accvgpr_read_b32 v42, a231
v_lshlrev_b32 v40, 16, v42
v_mfma_f32_16x16x32_bf16 a[24:27], a[116:119], a[132:135], a[24:27]
v_and_b32 v41, 0xffff0000, v42
v_fmac_f32 v38, v40, v29
v_mfma_f32_16x16x32_bf16 a[28:31], a[120:123], a[128:131], a[28:31]
v_fmac_f32 v39, v41, v29
v_accvgpr_read_b32 v42, a232
v_mfma_f32_16x16x32_bf16 a[28:31], a[124:127], a[132:135], a[28:31]
s_waitcnt lgkmcnt(0)
s_barrier
v_mfma_f32_16x16x32_bf16 a[32:35], a[64:67], a[136:139], a[32:35]
ds_read_b64_tr_b16 a[128:129], v14 offset:0
v_lshlrev_b32 v40, 16, v42
v_mfma_f32_16x16x32_bf16 a[32:35], a[68:71], a[140:143], a[32:35]
ds_read_b64_tr_b16 a[130:131], v14 offset:2048
v_and_b32 v41, 0xffff0000, v42
v_mfma_f32_16x16x32_bf16 a[36:39], a[72:75], a[136:139], a[36:39]
ds_read_b64_tr_b16 a[132:133], v14 offset:16384
v_fmac_f32 v32, v40, v30
v_mfma_f32_16x16x32_bf16 a[36:39], a[76:79], a[140:143], a[36:39]
ds_read_b64_tr_b16 a[134:135], v14 offset:18432
v_fmac_f32 v33, v41, v30
v_mfma_f32_16x16x32_bf16 a[40:43], a[80:83], a[136:139], a[40:43]
v_add_u32 v14, s54, v14
s_mov_b32 m0, s52
v_mfma_f32_16x16x32_bf16 a[40:43], a[84:87], a[140:143], a[40:43]
buffer_load_dwordx4 v4, s[20:23], s48 offen offset:0 lds
v_accvgpr_read_b32 v42, a233
v_mfma_f32_16x16x32_bf16 a[44:47], a[88:91], a[136:139], a[44:47]
v_lshlrev_b32 v40, 16, v42
v_and_b32 v41, 0xffff0000, v42
v_mfma_f32_16x16x32_bf16 a[44:47], a[92:95], a[140:143], a[44:47]
v_fmac_f32 v34, v40, v30
v_fmac_f32 v35, v41, v30
v_mfma_f32_16x16x32_bf16 a[48:51], a[96:99], a[136:139], a[48:51]
v_accvgpr_read_b32 v42, a234
v_lshlrev_b32 v40, 16, v42
v_mfma_f32_16x16x32_bf16 a[48:51], a[100:103], a[140:143], a[48:51]
buffer_load_dwordx4 v5, s[20:23], s48 offen offset:1024 lds
v_and_b32 v41, 0xffff0000, v42
v_mfma_f32_16x16x32_bf16 a[52:55], a[104:107], a[136:139], a[52:55]
v_fmac_f32 v36, v40, v30
v_fmac_f32 v37, v41, v30
v_mfma_f32_16x16x32_bf16 a[52:55], a[108:111], a[140:143], a[52:55]
v_accvgpr_read_b32 v42, a235
v_lshlrev_b32 v40, 16, v42
v_mfma_f32_16x16x32_bf16 a[56:59], a[112:115], a[136:139], a[56:59]
v_and_b32 v41, 0xffff0000, v42
v_fmac_f32 v38, v40, v30
v_mfma_f32_16x16x32_bf16 a[56:59], a[116:119], a[140:143], a[56:59]
buffer_load_dwordx4 v6, s[20:23], s48 offen offset:2048 lds
v_fmac_f32 v39, v41, v30
v_mfma_f32_16x16x32_bf16 a[60:63], a[120:123], a[136:139], a[60:63]
v_add_f32_dpp v32, v32, v32 quad_perm:[1,0,3,2] row_mask:0xf bank_mask:0xf
v_add_f32_dpp v33, v33, v33 quad_perm:[1,0,3,2] row_mask:0xf bank_mask:0xf
v_mfma_f32_16x16x32_bf16 a[60:63], a[124:127], a[140:143], a[60:63]
s_waitcnt lgkmcnt(0)
v_add_f32_dpp v34, v34, v34 quad_perm:[1,0,3,2] row_mask:0xf bank_mask:0xf
v_mfma_f32_16x16x32_bf16 v[64:67], a[64:67], a[128:131], v[64:67]
ds_read_b64_tr_b16 a[136:137], v15 offset:0
v_add_f32_dpp v35, v35, v35 quad_perm:[1,0,3,2] row_mask:0xf bank_mask:0xf
v_mfma_f32_16x16x32_bf16 v[64:67], a[68:71], a[132:135], v[64:67]
ds_read_b64_tr_b16 a[138:139], v15 offset:2048
buffer_load_dwordx4 v7, s[20:23], s48 offen offset:3072 lds
v_mfma_f32_16x16x32_bf16 v[68:71], a[72:75], a[128:131], v[68:71]
ds_read_b64_tr_b16 a[140:141], v15 offset:16384
s_add_u32 s48, s48, 128
v_mfma_f32_16x16x32_bf16 v[68:71], a[76:79], a[132:135], v[68:71]
ds_read_b64_tr_b16 a[142:143], v15 offset:18432
v_add_f32_dpp v36, v36, v36 quad_perm:[1,0,3,2] row_mask:0xf bank_mask:0xf
v_mfma_f32_16x16x32_bf16 v[72:75], a[80:83], a[128:131], v[72:75]
v_add_u32 v15, s54, v15
s_add_u32 m0, s52, 4096
v_mfma_f32_16x16x32_bf16 v[72:75], a[84:87], a[132:135], v[72:75]
buffer_load_dwordx4 v4, s[20:23], s49 offen offset:0 lds
v_add_f32_dpp v37, v37, v37 quad_perm:[1,0,3,2] row_mask:0xf bank_mask:0xf
v_mfma_f32_16x16x32_bf16 v[76:79], a[88:91], a[128:131], v[76:79]
v_add_f32_dpp v38, v38, v38 quad_perm:[1,0,3,2] row_mask:0xf bank_mask:0xf
v_add_f32_dpp v39, v39, v39 quad_perm:[1,0,3,2] row_mask:0xf bank_mask:0xf
v_mfma_f32_16x16x32_bf16 v[76:79], a[92:95], a[132:135], v[76:79]
v_add_f32_dpp v32, v32, v32 quad_perm:[2,3,0,1] row_mask:0xf bank_mask:0xf
v_add_f32_dpp v33, v33, v33 quad_perm:[2,3,0,1] row_mask:0xf bank_mask:0xf
v_mfma_f32_16x16x32_bf16 v[80:83], a[96:99], a[128:131], v[80:83]
v_add_f32_dpp v34, v34, v34 quad_perm:[2,3,0,1] row_mask:0xf bank_mask:0xf
v_add_f32_dpp v35, v35, v35 quad_perm:[2,3,0,1] row_mask:0xf bank_mask:0xf
v_mfma_f32_16x16x32_bf16 v[80:83], a[100:103], a[132:135], v[80:83]
buffer_load_dwordx4 v5, s[20:23], s49 offen offset:1024 lds
v_add_f32_dpp v36, v36, v36 quad_perm:[2,3,0,1] row_mask:0xf bank_mask:0xf
v_mfma_f32_16x16x32_bf16 v[84:87], a[104:107], a[128:131], v[84:87]
v_add_f32_dpp v37, v37, v37 quad_perm:[2,3,0,1] row_mask:0xf bank_mask:0xf
v_add_f32_dpp v38, v38, v38 quad_perm:[2,3,0,1] row_mask:0xf bank_mask:0xf
v_mfma_f32_16x16x32_bf16 v[84:87], a[108:111], a[132:135], v[84:87]
v_add_f32_dpp v39, v39, v39 quad_perm:[2,3,0,1] row_mask:0xf bank_mask:0xf
v_add_f32_dpp v32, v32, v32 row_half_mirror row_mask:0xf bank_mask:0xf
v_mfma_f32_16x16x32_bf16 v[88:91], a[112:115], a[128:131], v[88:91]
v_add_f32_dpp v33, v33, v33 row_half_mirror row_mask:0xf bank_mask:0xf
v_add_f32_dpp v34, v34, v34 row_half_mirror row_mask:0xf bank_mask:0xf
v_mfma_f32_16x16x32_bf16 v[88:91], a[116:119], a[132:135], v[88:91]
buffer_load_dwordx4 v6, s[20:23], s49 offen offset:2048 lds
v_add_f32_dpp v35, v35, v35 row_half_mirror row_mask:0xf bank_mask:0xf
v_mfma_f32_16x16x32_bf16 v[92:95], a[120:123], a[128:131], v[92:95]
v_add_f32_dpp v36, v36, v36 row_half_mirror row_mask:0xf bank_mask:0xf
v_add_f32_dpp v37, v37, v37 row_half_mirror row_mask:0xf bank_mask:0xf
v_mfma_f32_16x16x32_bf16 v[92:95], a[124:127], a[132:135], v[92:95]
s_waitcnt lgkmcnt(0)
v_add_f32_dpp v38, v38, v38 row_half_mirror row_mask:0xf bank_mask:0xf
v_mfma_f32_16x16x32_bf16 v[96:99], a[64:67], a[136:139], v[96:99]
ds_read_b64_tr_b16 a[128:129], v16 offset:0
v_add_f32_dpp v39, v39, v39 row_half_mirror row_mask:0xf bank_mask:0xf
v_mfma_f32_16x16x32_bf16 v[96:99], a[68:71], a[140:143], v[96:99]
ds_read_b64_tr_b16 a[130:131], v16 offset:2048
buffer_load_dwordx4 v7, s[20:23], s49 offen offset:3072 lds
v_mfma_f32_16x16x32_bf16 v[100:103], a[72:75], a[136:139], v[100:103]
ds_read_b64_tr_b16 a[132:133], v16 offset:16384
s_add_u32 s49, s49, 128
v_mfma_f32_16x16x32_bf16 v[100:103], a[76:79], a[140:143], v[100:103]
ds_read_b64_tr_b16 a[134:135], v16 offset:18432
v_add_f32_dpp v32, v32, v32 row_mirror row_mask:0xf bank_mask:0xf
v_mfma_f32_16x16x32_bf16 v[104:107], a[80:83], a[136:139], v[104:107]
v_add_u32 v16, s54, v16
s_mov_b32 m0, s53
v_mfma_f32_16x16x32_bf16 v[104:107], a[84:87], a[140:143], v[104:107]
buffer_load_dwordx4 v8, s[24:27], s50 offen offset:0 lds
v_add_f32_dpp v33, v33, v33 row_mirror row_mask:0xf bank_mask:0xf
v_mfma_f32_16x16x32_bf16 v[108:111], a[88:91], a[136:139], v[108:111]
v_add_f32_dpp v34, v34, v34 row_mirror row_mask:0xf bank_mask:0xf
v_add_f32_dpp v35, v35, v35 row_mirror row_mask:0xf bank_mask:0xf
v_mfma_f32_16x16x32_bf16 v[108:111], a[92:95], a[140:143], v[108:111]
v_add_f32_dpp v36, v36, v36 row_mirror row_mask:0xf bank_mask:0xf
v_add_f32_dpp v37, v37, v37 row_mirror row_mask:0xf bank_mask:0xf
v_mfma_f32_16x16x32_bf16 v[112:115], a[96:99], a[136:139], v[112:115]
v_add_f32_dpp v38, v38, v38 row_mirror row_mask:0xf bank_mask:0xf
v_add_f32_dpp v39, v39, v39 row_mirror row_mask:0xf bank_mask:0xf
v_mfma_f32_16x16x32_bf16 v[112:115], a[100:103], a[140:143], v[112:115]
buffer_load_dwordx4 v9, s[24:27], s50 offen offset:1024 lds
v_add_f32_dpp v32, v32, v32 row_bcast:15 row_mask:0xa bank_mask:0xf
v_mfma_f32_16x16x32_bf16 v[116:119], a[104:107], a[136:139], v[116:119]
v_add_f32_dpp v33, v33, v33 row_bcast:15 row_mask:0xa bank_mask:0xf
v_add_f32_dpp v34, v34, v34 row_bcast:15 row_mask:0xa bank_mask:0xf
v_mfma_f32_16x16x32_bf16 v[116:119], a[108:111], a[140:143], v[116:119]
v_add_f32_dpp v35, v35, v35 row_bcast:15 row_mask:0xa bank_mask:0xf
v_add_f32_dpp v36, v36, v36 row_bcast:15 row_mask:0xa bank_mask:0xf
v_mfma_f32_16x16x32_bf16 v[120:123], a[112:115], a[136:139], v[120:123]
v_add_f32_dpp v37, v37, v37 row_bcast:15 row_mask:0xa bank_mask:0xf
v_add_f32_dpp v38, v38, v38 row_bcast:15 row_mask:0xa bank_mask:0xf
v_mfma_f32_16x16x32_bf16 v[120:123], a[116:119], a[140:143], v[120:123]
buffer_load_dwordx4 v10, s[24:27], s50 offen offset:2048 lds
v_add_f32_dpp v39, v39, v39 row_bcast:15 row_mask:0xa bank_mask:0xf
v_mfma_f32_16x16x32_bf16 v[124:127], a[120:123], a[136:139], v[124:127]
v_add_f32_dpp v32, v32, v32 row_bcast:31 row_mask:0xc bank_mask:0xf
v_add_f32_dpp v33, v33, v33 row_bcast:31 row_mask:0xc bank_mask:0xf
v_mfma_f32_16x16x32_bf16 v[124:127], a[124:127], a[140:143], v[124:127]
s_waitcnt lgkmcnt(0)
v_add_f32_dpp v34, v34, v34 row_bcast:31 row_mask:0xc bank_mask:0xf
v_mfma_f32_16x16x32_bf16 v[128:131], a[64:67], a[128:131], v[128:131]
ds_read_b64_tr_b16 a[136:137], v17 offset:0
v_add_f32_dpp v35, v35, v35 row_bcast:31 row_mask:0xc bank_mask:0xf
v_mfma_f32_16x16x32_bf16 v[128:131], a[68:71], a[132:135], v[128:131]
ds_read_b64_tr_b16 a[138:139], v17 offset:2048
buffer_load_dwordx4 v11, s[24:27], s50 offen offset:3072 lds
v_mfma_f32_16x16x32_bf16 v[132:135], a[72:75], a[128:131], v[132:135]
ds_read_b64_tr_b16 a[140:141], v17 offset:16384
s_add_u32 s50, s50, 524288
v_mfma_f32_16x16x32_bf16 v[132:135], a[76:79], a[132:135], v[132:135]
ds_read_b64_tr_b16 a[142:143], v17 offset:18432
v_add_f32_dpp v36, v36, v36 row_bcast:31 row_mask:0xc bank_mask:0xf
v_mfma_f32_16x16x32_bf16 v[136:139], a[80:83], a[128:131], v[136:139]
v_add_u32 v17, s54, v17
s_add_u32 m0, s53, 8192
v_mfma_f32_16x16x32_bf16 v[136:139], a[84:87], a[132:135], v[136:139]
buffer_load_dwordx4 v8, s[24:27], s51 offen offset:0 lds
v_add_f32_dpp v37, v37, v37 row_bcast:31 row_mask:0xc bank_mask:0xf
v_mfma_f32_16x16x32_bf16 v[140:143], a[88:91], a[128:131], v[140:143]
v_add_f32_dpp v38, v38, v38 row_bcast:31 row_mask:0xc bank_mask:0xf
v_add_f32_dpp v39, v39, v39 row_bcast:31 row_mask:0xc bank_mask:0xf
v_mfma_f32_16x16x32_bf16 v[140:143], a[92:95], a[132:135], v[140:143]
s_mul_i32 s70, s57, 1171
s_lshr_b32 s70, s70, 16
v_mfma_f32_16x16x32_bf16 v[144:147], a[96:99], a[128:131], v[144:147]
s_mov_b32 s71, 0
v_mfma_f32_16x16x32_bf16 v[144:147], a[100:103], a[132:135], v[144:147]
buffer_load_dwordx4 v9, s[24:27], s51 offen offset:1024 lds
v_mfma_f32_16x16x32_bf16 v[148:151], a[104:107], a[128:131], v[148:151]
s_cmp_eq_u32 s70, 1
s_cselect_b32 s71, 1.0, s71
v_mfma_f32_16x16x32_bf16 v[148:151], a[108:111], a[132:135], v[148:151]
s_cmp_eq_u32 s70, 4
s_cselect_b32 s71, 1.0, s71
v_mfma_f32_16x16x32_bf16 v[152:155], a[112:115], a[128:131], v[152:155]
s_cmp_lt_u32 s70, 2
s_cselect_b32 s72, 0x3db8aa3b, 1.0
v_mfma_f32_16x16x32_bf16 v[152:155], a[116:119], a[132:135], v[152:155]
buffer_load_dwordx4 v10, s[24:27], s51 offen offset:2048 lds
v_cvt_pk_bf16_f32 v32, v32, v32
v_mfma_f32_16x16x32_bf16 v[156:159], a[120:123], a[128:131], v[156:159]
v_and_b32 v32, 0xffff0000, v32
v_cvt_pk_bf16_f32 v33, v33, v33
v_mfma_f32_16x16x32_bf16 v[156:159], a[124:127], a[132:135], v[156:159]
s_waitcnt lgkmcnt(0)
v_and_b32 v33, 0xffff0000, v33
v_mfma_f32_16x16x32_bf16 v[160:163], a[64:67], a[136:139], v[160:163]
ds_read_b64_tr_b16 a[128:129], v18 offset:0
v_cvt_pk_bf16_f32 v34, v34, v34
v_mfma_f32_16x16x32_bf16 v[160:163], a[68:71], a[140:143], v[160:163]
ds_read_b64_tr_b16 a[130:131], v18 offset:2048
buffer_load_dwordx4 v11, s[24:27], s51 offen offset:3072 lds
v_mfma_f32_16x16x32_bf16 v[164:167], a[72:75], a[136:139], v[164:167]
ds_read_b64_tr_b16 a[132:133], v18 offset:16384
s_add_u32 s51, s51, 524288
v_mfma_f32_16x16x32_bf16 v[164:167], a[76:79], a[140:143], v[164:167]
ds_read_b64_tr_b16 a[134:135], v18 offset:18432
v_and_b32 v34, 0xffff0000, v34
v_mfma_f32_16x16x32_bf16 v[168:171], a[80:83], a[136:139], v[168:171]
v_add_u32 v18, s54, v18
v_cvt_pk_bf16_f32 v35, v35, v35
v_mfma_f32_16x16x32_bf16 v[168:171], a[84:87], a[140:143], v[168:171]
v_and_b32 v35, 0xffff0000, v35
v_cvt_pk_bf16_f32 v36, v36, v36
v_mfma_f32_16x16x32_bf16 v[172:175], a[88:91], a[136:139], v[172:175]
v_and_b32 v36, 0xffff0000, v36
v_cvt_pk_bf16_f32 v37, v37, v37
v_mfma_f32_16x16x32_bf16 v[172:175], a[92:95], a[140:143], v[172:175]
v_and_b32 v37, 0xffff0000, v37
v_cvt_pk_bf16_f32 v38, v38, v38
v_mfma_f32_16x16x32_bf16 v[176:179], a[96:99], a[136:139], v[176:179]
v_and_b32 v38, 0xffff0000, v38
v_cvt_pk_bf16_f32 v39, v39, v39
v_mfma_f32_16x16x32_bf16 v[176:179], a[100:103], a[140:143], v[176:179]
v_and_b32 v39, 0xffff0000, v39
v_add_f32 v32, s71, v32
v_mfma_f32_16x16x32_bf16 v[180:183], a[104:107], a[136:139], v[180:183]
v_add_f32 v33, s71, v33
v_add_f32 v34, s71, v34
v_mfma_f32_16x16x32_bf16 v[180:183], a[108:111], a[140:143], v[180:183]
buffer_load_dword a255, v22, s[24:27], 0 offen
v_add_u32 v22, 524288, v22
v_mfma_f32_16x16x32_bf16 v[184:187], a[112:115], a[136:139], v[184:187]
buffer_load_dword a255, v23, s[20:23], 0 offen
v_add_u32 v23, 128, v23
v_mfma_f32_16x16x32_bf16 v[184:187], a[116:119], a[140:143], v[184:187]
s_cmp_lt_u32 s16, 8
s_cselect_b32 s46, s17, 0
s_cselect_b32 s6, 1408, 0
v_mfma_f32_16x16x32_bf16 v[188:191], a[120:123], a[136:139], v[188:191]
s_add_u32 s16, s16, 1
buffer_load_dword a255, v3, s[44:47], 0 offen
v_mfma_f32_16x16x32_bf16 v[188:191], a[124:127], a[140:143], v[188:191]
s_waitcnt lgkmcnt(0)
v_add_u32 v3, s6, v3
v_mfma_f32_16x16x32_bf16 v[192:195], a[64:67], a[128:131], v[192:195]
ds_read_b64_tr_b16 a[136:137], v19 offset:0
v_add_f32 v35, s71, v35
v_mfma_f32_16x16x32_bf16 v[192:195], a[68:71], a[132:135], v[192:195]
ds_read_b64_tr_b16 a[138:139], v19 offset:2048
v_add_f32 v36, s71, v36
v_mfma_f32_16x16x32_bf16 v[196:199], a[72:75], a[128:131], v[196:199]
ds_read_b64_tr_b16 a[140:141], v19 offset:16384
v_add_f32 v37, s71, v37
v_mfma_f32_16x16x32_bf16 v[196:199], a[76:79], a[132:135], v[196:199]
ds_read_b64_tr_b16 a[142:143], v19 offset:18432
v_add_f32 v38, s71, v38
v_mfma_f32_16x16x32_bf16 v[200:203], a[80:83], a[128:131], v[200:203]
v_add_u32 v19, s54, v19
v_add_f32 v39, s71, v39
v_mfma_f32_16x16x32_bf16 v[200:203], a[84:87], a[132:135], v[200:203]
v_cvt_pk_bf16_f32 v32, v32, v32
v_and_b32 v32, 0xffff0000, v32
v_mfma_f32_16x16x32_bf16 v[204:207], a[88:91], a[128:131], v[204:207]
v_cvt_pk_bf16_f32 v33, v33, v33
v_and_b32 v33, 0xffff0000, v33
v_mfma_f32_16x16x32_bf16 v[204:207], a[92:95], a[132:135], v[204:207]
v_cvt_pk_bf16_f32 v34, v34, v34
v_and_b32 v34, 0xffff0000, v34
v_mfma_f32_16x16x32_bf16 v[208:211], a[96:99], a[128:131], v[208:211]
v_cvt_pk_bf16_f32 v35, v35, v35
v_and_b32 v35, 0xffff0000, v35
v_mfma_f32_16x16x32_bf16 v[208:211], a[100:103], a[132:135], v[208:211]
v_mfma_f32_16x16x32_bf16 v[212:215], a[104:107], a[128:131], v[212:215]
v_mfma_f32_16x16x32_bf16 v[212:215], a[108:111], a[132:135], v[212:215]
s_cmp_eq_u32 s53, s69
s_cselect_b32 s54, s58, s59
v_mfma_f32_16x16x32_bf16 v[216:219], a[112:115], a[128:131], v[216:219]
s_add_u32 s53, s53, 32768
s_cmp_eq_u32 s53, s68
s_cselect_b32 s53, s69, s53
v_mfma_f32_16x16x32_bf16 v[216:219], a[116:119], a[132:135], v[216:219]
s_xor_b32 s52, s52, 0x38000
v_mfma_f32_16x16x32_bf16 v[220:223], a[120:123], a[128:131], v[220:223]
v_mfma_f32_16x16x32_bf16 v[220:223], a[124:127], a[132:135], v[220:223]
s_waitcnt vmcnt(22)
s_barrier
s_waitcnt lgkmcnt(0)
v_mfma_f32_16x16x32_bf16 v[224:227], a[64:67], a[136:139], v[224:227]
ds_read_b64_tr_b16 a[128:129], v12 offset:0
ds_read_b128 a[64:67], v20 offset:0
v_mfma_f32_16x16x32_bf16 v[224:227], a[68:71], a[140:143], v[224:227]
ds_read_b64_tr_b16 a[130:131], v12 offset:2048
ds_read_b128 a[68:71], v21 offset:0
v_mfma_f32_16x16x32_bf16 v[228:231], a[72:75], a[136:139], v[228:231]
ds_read_b64_tr_b16 a[132:133], v12 offset:16384
ds_read_b128 a[72:75], v20 offset:2048
v_mfma_f32_16x16x32_bf16 v[228:231], a[76:79], a[140:143], v[228:231]
ds_read_b64_tr_b16 a[134:135], v12 offset:18432
ds_read_b128 a[76:79], v21 offset:2048
v_mfma_f32_16x16x32_bf16 v[232:235], a[80:83], a[136:139], v[232:235]
v_add_u32 v12, s54, v12
ds_read_b128 a[80:83], v20 offset:4096
v_mfma_f32_16x16x32_bf16 v[232:235], a[84:87], a[140:143], v[232:235]
ds_read_b128 a[84:87], v21 offset:4096
v_mfma_f32_16x16x32_bf16 v[236:239], a[88:91], a[136:139], v[236:239]
ds_read_b128 a[88:91], v20 offset:6144
v_mfma_f32_16x16x32_bf16 v[236:239], a[92:95], a[140:143], v[236:239]
ds_read_b128 a[92:95], v21 offset:6144
v_mfma_f32_16x16x32_bf16 v[240:243], a[96:99], a[136:139], v[240:243]
ds_read_b128 a[96:99], v20 offset:8192
v_mfma_f32_16x16x32_bf16 v[240:243], a[100:103], a[140:143], v[240:243]
ds_read_b128 a[100:103], v21 offset:8192
v_mfma_f32_16x16x32_bf16 v[244:247], a[104:107], a[136:139], v[244:247]
ds_read_b128 a[104:107], v20 offset:10240
v_mfma_f32_16x16x32_bf16 v[244:247], a[108:111], a[140:143], v[244:247]
ds_read_b128 a[108:111], v21 offset:10240
v_mfma_f32_16x16x32_bf16 v[248:251], a[112:115], a[136:139], v[248:251]
ds_read_b128 a[112:115], v20 offset:12288
v_mfma_f32_16x16x32_bf16 v[248:251], a[116:119], a[140:143], v[248:251]
ds_read_b128 a[116:119], v21 offset:12288
v_mfma_f32_16x16x32_bf16 v[252:255], a[120:123], a[136:139], v[252:255]
ds_read_b128 a[120:123], v20 offset:14336
v_mfma_f32_16x16x32_bf16 v[252:255], a[124:127], a[140:143], v[252:255]
ds_read_b128 a[124:127], v21 offset:14336
v_xor_b32 v20, 0x38000, v20
v_xor_b32 v21, 0x38000, v21
s_waitcnt lgkmcnt(12)
v_mfma_f32_16x16x32_bf16 a[0:3], a[64:67], a[128:131], a[0:3]
ds_read_b64_tr_b16 a[136:137], v13 offset:0
v_cvt_pk_bf16_f32 v36, v36, v36
v_mfma_f32_16x16x32_bf16 a[0:3], a[68:71], a[132:135], a[0:3]
ds_read_b64_tr_b16 a[138:139], v13 offset:2048
v_and_b32 v36, 0xffff0000, v36
v_mfma_f32_16x16x32_bf16 a[4:7], a[72:75], a[128:131], a[4:7]
ds_read_b64_tr_b16 a[140:141], v13 offset:16384
v_cvt_pk_bf16_f32 v37, v37, v37
v_mfma_f32_16x16x32_bf16 a[4:7], a[76:79], a[132:135], a[4:7]
s_waitcnt lgkmcnt(11)
ds_read_b64_tr_b16 a[142:143], v13 offset:18432
v_mfma_f32_16x16x32_bf16 a[8:11], a[80:83], a[128:131], a[8:11]
v_add_u32 v13, s54, v13
v_and_b32 v37, 0xffff0000, v37
v_mfma_f32_16x16x32_bf16 a[8:11], a[84:87], a[132:135], a[8:11]
v_cvt_pk_bf16_f32 v38, v38, v38
v_and_b32 v38, 0xffff0000, v38
v_mfma_f32_16x16x32_bf16 a[12:15], a[88:91], a[128:131], a[12:15]
v_cvt_pk_bf16_f32 v39, v39, v39
v_and_b32 v39, 0xffff0000, v39
v_mfma_f32_16x16x32_bf16 a[12:15], a[92:95], a[132:135], a[12:15]
s_waitcnt lgkmcnt(8)
v_cvt_pk_bf16_f32 v24, v32, v33
v_mfma_f32_16x16x32_bf16 a[16:19], a[96:99], a[128:131], a[16:19]
v_cvt_pk_bf16_f32 v25, v34, v35
v_cvt_pk_bf16_f32 v26, v36, v37
v_mfma_f32_16x16x32_bf16 a[16:19], a[100:103], a[132:135], a[16:19]
v_cvt_pk_bf16_f32 v27, v38, v39
v_mul_f32 v32, s72, v32
v_mfma_f32_16x16x32_bf16 a[20:23], a[104:107], a[128:131], a[20:23]
v_mul_f32 v33, s72, v33
v_mul_f32 v34, s72, v34
v_mfma_f32_16x16x32_bf16 a[20:23], a[108:111], a[132:135], a[20:23]
s_waitcnt lgkmcnt(4)
v_mul_f32 v35, s72, v35
v_mfma_f32_16x16x32_bf16 a[24:27], a[112:115], a[128:131], a[24:27]
v_mul_f32 v36, s72, v36
v_mul_f32 v37, s72, v37
v_mfma_f32_16x16x32_bf16 a[24:27], a[116:119], a[132:135], a[24:27]
v_mul_f32 v38, s72, v38
v_mul_f32 v39, s72, v39
v_mfma_f32_16x16x32_bf16 a[28:31], a[120:123], a[128:131], a[28:31]
s_lshl_b32 s70, s57, 5
v_cmp_eq_u32 s[74:75], 63, v1
v_mfma_f32_16x16x32_bf16 a[28:31], a[124:127], a[132:135], a[28:31]
s_waitcnt lgkmcnt(0)
s_barrier
v_mfma_f32_16x16x32_bf16 a[32:35], a[64:67], a[136:139], a[32:35]
ds_read_b64_tr_b16 a[128:129], v14 offset:0
v_mov_b32 v40, 0x1000000
v_mfma_f32_16x16x32_bf16 a[32:35], a[68:71], a[140:143], a[32:35]
ds_read_b64_tr_b16 a[130:131], v14 offset:2048
v_mov_b32 v41, s70
v_mfma_f32_16x16x32_bf16 a[36:39], a[72:75], a[136:139], a[36:39]
ds_read_b64_tr_b16 a[132:133], v14 offset:16384
v_cndmask_b32 v40, v40, v41, s[74:75]
v_mfma_f32_16x16x32_bf16 a[36:39], a[76:79], a[140:143], a[36:39]
ds_read_b64_tr_b16 a[134:135], v14 offset:18432
buffer_store_dwordx4 v[32:35], v40, s[40:43], 0 offen sc1
v_mfma_f32_16x16x32_bf16 a[40:43], a[80:83], a[136:139], a[40:43]
v_add_u32 v14, s54, v14
s_mov_b32 m0, s52
v_mfma_f32_16x16x32_bf16 a[40:43], a[84:87], a[140:143], a[40:43]
buffer_load_dwordx4 v4, s[20:23], s48 offen offset:0 lds
buffer_store_dwordx4 v[36:39], v40, s[40:43], 0 offen offset:16 sc1
v_mfma_f32_16x16x32_bf16 a[44:47], a[88:91], a[136:139], a[44:47]
v_lshrrev_b32 v40, 1, v40
v_add_u32 v40, 16384, v40
v_mfma_f32_16x16x32_bf16 a[44:47], a[92:95], a[140:143], a[44:47]
buffer_store_dwordx4 v[24:27], v40, s[40:43], 0 offen sc1
v_mfma_f32_16x16x32_bf16 a[48:51], a[96:99], a[136:139], a[48:51]
v_mfma_f32_16x16x32_bf16 a[48:51], a[100:103], a[140:143], a[48:51]
buffer_load_dwordx4 v5, s[20:23], s48 offen offset:1024 lds
v_mfma_f32_16x16x32_bf16 a[52:55], a[104:107], a[136:139], a[52:55]
v_mfma_f32_16x16x32_bf16 a[52:55], a[108:111], a[140:143], a[52:55]
v_mfma_f32_16x16x32_bf16 a[56:59], a[112:115], a[136:139], a[56:59]
v_mfma_f32_16x16x32_bf16 a[56:59], a[116:119], a[140:143], a[56:59]
buffer_load_dwordx4 v6, s[20:23], s48 offen offset:2048 lds
v_mfma_f32_16x16x32_bf16 a[60:63], a[120:123], a[136:139], a[60:63]
v_mfma_f32_16x16x32_bf16 a[60:63], a[124:127], a[140:143], a[60:63]
s_waitcnt lgkmcnt(0)
v_mfma_f32_16x16x32_bf16 v[64:67], a[64:67], a[128:131], v[64:67]
ds_read_b64_tr_b16 a[136:137], v15 offset:0
v_mfma_f32_16x16x32_bf16 v[64:67], a[68:71], a[132:135], v[64:67]
ds_read_b64_tr_b16 a[138:139], v15 offset:2048
buffer_load_dwordx4 v7, s[20:23], s48 offen offset:3072 lds
v_mfma_f32_16x16x32_bf16 v[68:71], a[72:75], a[128:131], v[68:71]
ds_read_b64_tr_b16 a[140:141], v15 offset:16384
s_add_u32 s48, s48, 128
v_mfma_f32_16x16x32_bf16 v[68:71], a[76:79], a[132:135], v[68:71]
ds_read_b64_tr_b16 a[142:143], v15 offset:18432
v_mfma_f32_16x16x32_bf16 v[72:75], a[80:83], a[128:131], v[72:75]
v_add_u32 v15, s54, v15
s_add_u32 m0, s52, 4096
v_mfma_f32_16x16x32_bf16 v[72:75], a[84:87], a[132:135], v[72:75]
buffer_load_dwordx4 v4, s[20:23], s49 offen offset:0 lds
v_mfma_f32_16x16x32_bf16 v[76:79], a[88:91], a[128:131], v[76:79]
v_mfma_f32_16x16x32_bf16 v[76:79], a[92:95], a[132:135], v[76:79]
v_mfma_f32_16x16x32_bf16 v[80:83], a[96:99], a[128:131], v[80:83]
v_mfma_f32_16x16x32_bf16 v[80:83], a[100:103], a[132:135], v[80:83]
buffer_load_dwordx4 v5, s[20:23], s49 offen offset:1024 lds
v_mfma_f32_16x16x32_bf16 v[84:87], a[104:107], a[128:131], v[84:87]
v_mfma_f32_16x16x32_bf16 v[84:87], a[108:111], a[132:135], v[84:87]
v_mfma_f32_16x16x32_bf16 v[88:91], a[112:115], a[128:131], v[88:91]
v_mfma_f32_16x16x32_bf16 v[88:91], a[116:119], a[132:135], v[88:91]
buffer_load_dwordx4 v6, s[20:23], s49 offen offset:2048 lds
v_mfma_f32_16x16x32_bf16 v[92:95], a[120:123], a[128:131], v[92:95]
v_mfma_f32_16x16x32_bf16 v[92:95], a[124:127], a[132:135], v[92:95]
s_waitcnt lgkmcnt(0)
v_mfma_f32_16x16x32_bf16 v[96:99], a[64:67], a[136:139], v[96:99]
ds_read_b64_tr_b16 a[128:129], v16 offset:0
v_mfma_f32_16x16x32_bf16 v[96:99], a[68:71], a[140:143], v[96:99]
ds_read_b64_tr_b16 a[130:131], v16 offset:2048
buffer_load_dwordx4 v7, s[20:23], s49 offen offset:3072 lds
v_mfma_f32_16x16x32_bf16 v[100:103], a[72:75], a[136:139], v[100:103]
ds_read_b64_tr_b16 a[132:133], v16 offset:16384
s_add_u32 s49, s49, 128
v_mfma_f32_16x16x32_bf16 v[100:103], a[76:79], a[140:143], v[100:103]
ds_read_b64_tr_b16 a[134:135], v16 offset:18432
v_mfma_f32_16x16x32_bf16 v[104:107], a[80:83], a[136:139], v[104:107]
v_add_u32 v16, s54, v16
s_mov_b32 m0, s53
v_mfma_f32_16x16x32_bf16 v[104:107], a[84:87], a[140:143], v[104:107]
buffer_load_dwordx4 v8, s[24:27], s50 offen offset:0 lds
v_mfma_f32_16x16x32_bf16 v[108:111], a[88:91], a[136:139], v[108:111]
v_mfma_f32_16x16x32_bf16 v[108:111], a[92:95], a[140:143], v[108:111]
v_mfma_f32_16x16x32_bf16 v[112:115], a[96:99], a[136:139], v[112:115]
v_mfma_f32_16x16x32_bf16 v[112:115], a[100:103], a[140:143], v[112:115]
buffer_load_dwordx4 v9, s[24:27], s50 offen offset:1024 lds
v_mfma_f32_16x16x32_bf16 v[116:119], a[104:107], a[136:139], v[116:119]
v_mfma_f32_16x16x32_bf16 v[116:119], a[108:111], a[140:143], v[116:119]
s_mov_b32 s36, s76
s_mov_b32 s37, s77
v_mfma_f32_16x16x32_bf16 v[120:123], a[112:115], a[136:139], v[120:123]
s_cmp_lt_u32 s57, 336
s_cselect_b32 s38, 256, 0
v_mfma_f32_16x16x32_bf16 v[120:123], a[116:119], a[140:143], v[120:123]
buffer_load_dwordx4 v10, s[24:27], s50 offen offset:2048 lds
v_mfma_f32_16x16x32_bf16 v[124:127], a[120:123], a[136:139], v[124:127]
s_cmp_lt_u32 s57, 112
s_cselect_b32 s70, 0, 128
v_mfma_f32_16x16x32_bf16 v[124:127], a[124:127], a[140:143], v[124:127]
s_waitcnt lgkmcnt(0)
v_mov_b32 v41, 0x1000000
v_mfma_f32_16x16x32_bf16 v[128:131], a[64:67], a[128:131], v[128:131]
ds_read_b64_tr_b16 a[136:137], v17 offset:0
v_cndmask_b32 v41, v41, 0, s[74:75]
v_mfma_f32_16x16x32_bf16 v[128:131], a[68:71], a[132:135], v[128:131]
ds_read_b64_tr_b16 a[138:139], v17 offset:2048
buffer_load_dwordx4 v11, s[24:27], s50 offen offset:3072 lds
v_mfma_f32_16x16x32_bf16 v[132:135], a[72:75], a[128:131], v[132:135]
ds_read_b64_tr_b16 a[140:141], v17 offset:16384
s_add_u32 s50, s50, 524288
v_mfma_f32_16x16x32_bf16 v[132:135], a[76:79], a[132:135], v[132:135]
ds_read_b64_tr_b16 a[142:143], v17 offset:18432
v_mov_b32 v42, 1
v_mfma_f32_16x16x32_bf16 v[136:139], a[80:83], a[128:131], v[136:139]
v_add_u32 v17, s54, v17
s_add_u32 m0, s53, 8192
v_mfma_f32_16x16x32_bf16 v[136:139], a[84:87], a[132:135], v[136:139]
buffer_load_dwordx4 v8, s[24:27], s51 offen offset:0 lds
v_mfma_f32_16x16x32_bf16 v[140:143], a[88:91], a[128:131], v[140:143]
s_waitcnt vmcnt(12)
buffer_atomic_add v42, v41, s[36:39], s70 offen offset:4 sc1
v_mfma_f32_16x16x32_bf16 v[140:143], a[92:95], a[132:135], v[140:143]
v_mfma_f32_16x16x32_bf16 v[144:147], a[96:99], a[128:131], v[144:147]
v_mfma_f32_16x16x32_bf16 v[144:147], a[100:103], a[132:135], v[144:147]
buffer_load_dwordx4 v9, s[24:27], s51 offen offset:1024 lds
v_mfma_f32_16x16x32_bf16 v[148:151], a[104:107], a[128:131], v[148:151]
v_mfma_f32_16x16x32_bf16 v[148:151], a[108:111], a[132:135], v[148:151]
v_mfma_f32_16x16x32_bf16 v[152:155], a[112:115], a[128:131], v[152:155]
v_mfma_f32_16x16x32_bf16 v[152:155], a[116:119], a[132:135], v[152:155]
buffer_load_dwordx4 v10, s[24:27], s51 offen offset:2048 lds
v_mfma_f32_16x16x32_bf16 v[156:159], a[120:123], a[128:131], v[156:159]
v_mfma_f32_16x16x32_bf16 v[156:159], a[124:127], a[132:135], v[156:159]
s_waitcnt lgkmcnt(0)
v_mfma_f32_16x16x32_bf16 v[160:163], a[64:67], a[136:139], v[160:163]
ds_read_b64_tr_b16 a[128:129], v18 offset:0
v_mfma_f32_16x16x32_bf16 v[160:163], a[68:71], a[140:143], v[160:163]
ds_read_b64_tr_b16 a[130:131], v18 offset:2048
buffer_load_dwordx4 v11, s[24:27], s51 offen offset:3072 lds
v_mfma_f32_16x16x32_bf16 v[164:167], a[72:75], a[136:139], v[164:167]
ds_read_b64_tr_b16 a[132:133], v18 offset:16384
s_add_u32 s51, s51, 524288
v_mfma_f32_16x16x32_bf16 v[164:167], a[76:79], a[140:143], v[164:167]
ds_read_b64_tr_b16 a[134:135], v18 offset:18432
v_mfma_f32_16x16x32_bf16 v[168:171], a[80:83], a[136:139], v[168:171]
v_add_u32 v18, s54, v18
v_mfma_f32_16x16x32_bf16 v[168:171], a[84:87], a[140:143], v[168:171]
v_mfma_f32_16x16x32_bf16 v[172:175], a[88:91], a[136:139], v[172:175]
v_mfma_f32_16x16x32_bf16 v[172:175], a[92:95], a[140:143], v[172:175]
v_mfma_f32_16x16x32_bf16 v[176:179], a[96:99], a[136:139], v[176:179]
v_mfma_f32_16x16x32_bf16 v[176:179], a[100:103], a[140:143], v[176:179]
v_mfma_f32_16x16x32_bf16 v[180:183], a[104:107], a[136:139], v[180:183]
v_mfma_f32_16x16x32_bf16 v[180:183], a[108:111], a[140:143], v[180:183]
buffer_load_dword a255, v22, s[24:27], 0 offen
v_add_u32 v22, 524288, v22
v_mfma_f32_16x16x32_bf16 v[184:187], a[112:115], a[136:139], v[184:187]
buffer_load_dword a255, v23, s[20:23], 0 offen
v_add_u32 v23, 128, v23
v_mfma_f32_16x16x32_bf16 v[184:187], a[116:119], a[140:143], v[184:187]
s_cmp_lt_u32 s16, 8
s_cselect_b32 s46, s17, 0
s_cselect_b32 s6, 1408, 0
v_mfma_f32_16x16x32_bf16 v[188:191], a[120:123], a[136:139], v[188:191]
s_add_u32 s16, s16, 1
buffer_load_dword a255, v3, s[44:47], 0 offen
v_mfma_f32_16x16x32_bf16 v[188:191], a[124:127], a[140:143], v[188:191]
s_waitcnt lgkmcnt(0)
v_add_u32 v3, s6, v3
v_mfma_f32_16x16x32_bf16 v[192:195], a[64:67], a[128:131], v[192:195]
ds_read_b64_tr_b16 a[136:137], v19 offset:0
v_mfma_f32_16x16x32_bf16 v[192:195], a[68:71], a[132:135], v[192:195]
ds_read_b64_tr_b16 a[138:139], v19 offset:2048
v_mfma_f32_16x16x32_bf16 v[196:199], a[72:75], a[128:131], v[196:199]
ds_read_b64_tr_b16 a[140:141], v19 offset:16384
v_mfma_f32_16x16x32_bf16 v[196:199], a[76:79], a[132:135], v[196:199]
ds_read_b64_tr_b16 a[142:143], v19 offset:18432
v_mfma_f32_16x16x32_bf16 v[200:203], a[80:83], a[128:131], v[200:203]
v_add_u32 v19, s54, v19
v_mfma_f32_16x16x32_bf16 v[200:203], a[84:87], a[132:135], v[200:203]
v_mfma_f32_16x16x32_bf16 v[204:207], a[88:91], a[128:131], v[204:207]
v_mfma_f32_16x16x32_bf16 v[204:207], a[92:95], a[132:135], v[204:207]
v_mfma_f32_16x16x32_bf16 v[208:211], a[96:99], a[128:131], v[208:211]
v_mfma_f32_16x16x32_bf16 v[208:211], a[100:103], a[132:135], v[208:211]
v_mfma_f32_16x16x32_bf16 v[212:215], a[104:107], a[128:131], v[212:215]
v_mfma_f32_16x16x32_bf16 v[212:215], a[108:111], a[132:135], v[212:215]
s_cmp_eq_u32 s53, s69
s_cselect_b32 s54, s58, s59
v_mfma_f32_16x16x32_bf16 v[216:219], a[112:115], a[128:131], v[216:219]
s_add_u32 s53, s53, 32768
s_cmp_eq_u32 s53, s68
s_cselect_b32 s53, s69, s53
v_mfma_f32_16x16x32_bf16 v[216:219], a[116:119], a[132:135], v[216:219]
s_xor_b32 s52, s52, 0x38000
v_mfma_f32_16x16x32_bf16 v[220:223], a[120:123], a[128:131], v[220:223]
v_mfma_f32_16x16x32_bf16 v[220:223], a[124:127], a[132:135], v[220:223]
s_barrier
s_waitcnt lgkmcnt(0)
v_mfma_f32_16x16x32_bf16 v[224:227], a[64:67], a[136:139], v[224:227]
ds_read_b64_tr_b16 a[128:129], v12 offset:0
ds_read_b128 a[64:67], v20 offset:0
v_mfma_f32_16x16x32_bf16 v[224:227], a[68:71], a[140:143], v[224:227]
ds_read_b64_tr_b16 a[130:131], v12 offset:2048
ds_read_b128 a[68:71], v21 offset:0
v_mfma_f32_16x16x32_bf16 v[228:231], a[72:75], a[136:139], v[228:231]
ds_read_b64_tr_b16 a[132:133], v12 offset:16384
ds_read_b128 a[72:75], v20 offset:2048
v_mfma_f32_16x16x32_bf16 v[228:231], a[76:79], a[140:143], v[228:231]
ds_read_b64_tr_b16 a[134:135], v12 offset:18432
ds_read_b128 a[76:79], v21 offset:2048
v_mfma_f32_16x16x32_bf16 v[232:235], a[80:83], a[136:139], v[232:235]
v_add_u32 v12, s54, v12
ds_read_b128 a[80:83], v20 offset:4096
v_mfma_f32_16x16x32_bf16 v[232:235], a[84:87], a[140:143], v[232:235]
ds_read_b128 a[84:87], v21 offset:4096
v_mfma_f32_16x16x32_bf16 v[236:239], a[88:91], a[136:139], v[236:239]
ds_read_b128 a[88:91], v20 offset:6144
v_mfma_f32_16x16x32_bf16 v[236:239], a[92:95], a[140:143], v[236:239]
ds_read_b128 a[92:95], v21 offset:6144
v_mfma_f32_16x16x32_bf16 v[240:243], a[96:99], a[136:139], v[240:243]
ds_read_b128 a[96:99], v20 offset:8192
v_mfma_f32_16x16x32_bf16 v[240:243], a[100:103], a[140:143], v[240:243]
ds_read_b128 a[100:103], v21 offset:8192
v_mfma_f32_16x16x32_bf16 v[244:247], a[104:107], a[136:139], v[244:247]
ds_read_b128 a[104:107], v20 offset:10240
v_mfma_f32_16x16x32_bf16 v[244:247], a[108:111], a[140:143], v[244:247]
ds_read_b128 a[108:111], v21 offset:10240
v_mfma_f32_16x16x32_bf16 v[248:251], a[112:115], a[136:139], v[248:251]
ds_read_b128 a[112:115], v20 offset:12288
v_mfma_f32_16x16x32_bf16 v[248:251], a[116:119], a[140:143], v[248:251]
ds_read_b128 a[116:119], v21 offset:12288
v_mfma_f32_16x16x32_bf16 v[252:255], a[120:123], a[136:139], v[252:255]
ds_read_b128 a[120:123], v20 offset:14336
v_mfma_f32_16x16x32_bf16 v[252:255], a[124:127], a[140:143], v[252:255]
ds_read_b128 a[124:127], v21 offset:14336
v_xor_b32 v20, 0x38000, v20
v_xor_b32 v21, 0x38000, v21
s_mov_b32 s56, 7
kv_loop1:
s_waitcnt lgkmcnt(12)
v_mfma_f32_16x16x32_bf16 a[0:3], a[64:67], a[128:131], a[0:3]
ds_read_b64_tr_b16 a[136:137], v13 offset:0
v_mfma_f32_16x16x32_bf16 a[0:3], a[68:71], a[132:135], a[0:3]
ds_read_b64_tr_b16 a[138:139], v13 offset:2048
v_mfma_f32_16x16x32_bf16 a[4:7], a[72:75], a[128:131], a[4:7]
ds_read_b64_tr_b16 a[140:141], v13 offset:16384
v_mfma_f32_16x16x32_bf16 a[4:7], a[76:79], a[132:135], a[4:7]
s_waitcnt lgkmcnt(11)
ds_read_b64_tr_b16 a[142:143], v13 offset:18432
v_mfma_f32_16x16x32_bf16 a[8:11], a[80:83], a[128:131], a[8:11]
v_add_u32 v13, s54, v13
v_mfma_f32_16x16x32_bf16 a[8:11], a[84:87], a[132:135], a[8:11]
v_mfma_f32_16x16x32_bf16 a[12:15], a[88:91], a[128:131], a[12:15]
v_mfma_f32_16x16x32_bf16 a[12:15], a[92:95], a[132:135], a[12:15]
s_waitcnt lgkmcnt(8)
v_mfma_f32_16x16x32_bf16 a[16:19], a[96:99], a[128:131], a[16:19]
v_mfma_f32_16x16x32_bf16 a[16:19], a[100:103], a[132:135], a[16:19]
v_mfma_f32_16x16x32_bf16 a[20:23], a[104:107], a[128:131], a[20:23]
v_mfma_f32_16x16x32_bf16 a[20:23], a[108:111], a[132:135], a[20:23]
s_waitcnt lgkmcnt(4)
v_mfma_f32_16x16x32_bf16 a[24:27], a[112:115], a[128:131], a[24:27]
v_mfma_f32_16x16x32_bf16 a[24:27], a[116:119], a[132:135], a[24:27]
v_mfma_f32_16x16x32_bf16 a[28:31], a[120:123], a[128:131], a[28:31]
v_mfma_f32_16x16x32_bf16 a[28:31], a[124:127], a[132:135], a[28:31]
s_waitcnt lgkmcnt(0)
s_barrier
v_mfma_f32_16x16x32_bf16 a[32:35], a[64:67], a[136:139], a[32:35]
ds_read_b64_tr_b16 a[128:129], v14 offset:0
v_mfma_f32_16x16x32_bf16 a[32:35], a[68:71], a[140:143], a[32:35]
ds_read_b64_tr_b16 a[130:131], v14 offset:2048
v_mfma_f32_16x16x32_bf16 a[36:39], a[72:75], a[136:139], a[36:39]
ds_read_b64_tr_b16 a[132:133], v14 offset:16384
v_mfma_f32_16x16x32_bf16 a[36:39], a[76:79], a[140:143], a[36:39]
ds_read_b64_tr_b16 a[134:135], v14 offset:18432
v_mfma_f32_16x16x32_bf16 a[40:43], a[80:83], a[136:139], a[40:43]
v_add_u32 v14, s54, v14
s_mov_b32 m0, s52
v_mfma_f32_16x16x32_bf16 a[40:43], a[84:87], a[140:143], a[40:43]
buffer_load_dwordx4 v4, s[20:23], s48 offen offset:0 lds
v_mfma_f32_16x16x32_bf16 a[44:47], a[88:91], a[136:139], a[44:47]
v_mfma_f32_16x16x32_bf16 a[44:47], a[92:95], a[140:143], a[44:47]
v_mfma_f32_16x16x32_bf16 a[48:51], a[96:99], a[136:139], a[48:51]
v_mfma_f32_16x16x32_bf16 a[48:51], a[100:103], a[140:143], a[48:51]
buffer_load_dwordx4 v5, s[20:23], s48 offen offset:1024 lds
v_mfma_f32_16x16x32_bf16 a[52:55], a[104:107], a[136:139], a[52:55]
v_mfma_f32_16x16x32_bf16 a[52:55], a[108:111], a[140:143], a[52:55]
v_mfma_f32_16x16x32_bf16 a[56:59], a[112:115], a[136:139], a[56:59]
v_mfma_f32_16x16x32_bf16 a[56:59], a[116:119], a[140:143], a[56:59]
buffer_load_dwordx4 v6, s[20:23], s48 offen offset:2048 lds
v_mfma_f32_16x16x32_bf16 a[60:63], a[120:123], a[136:139], a[60:63]
v_mfma_f32_16x16x32_bf16 a[60:63], a[124:127], a[140:143], a[60:63]
s_waitcnt lgkmcnt(0)
v_mfma_f32_16x16x32_bf16 v[64:67], a[64:67], a[128:131], v[64:67]
ds_read_b64_tr_b16 a[136:137], v15 offset:0
v_mfma_f32_16x16x32_bf16 v[64:67], a[68:71], a[132:135], v[64:67]
ds_read_b64_tr_b16 a[138:139], v15 offset:2048
buffer_load_dwordx4 v7, s[20:23], s48 offen offset:3072 lds
v_mfma_f32_16x16x32_bf16 v[68:71], a[72:75], a[128:131], v[68:71]
ds_read_b64_tr_b16 a[140:141], v15 offset:16384
s_add_u32 s48, s48, 128
v_mfma_f32_16x16x32_bf16 v[68:71], a[76:79], a[132:135], v[68:71]
ds_read_b64_tr_b16 a[142:143], v15 offset:18432
v_mfma_f32_16x16x32_bf16 v[72:75], a[80:83], a[128:131], v[72:75]
v_add_u32 v15, s54, v15
s_add_u32 m0, s52, 4096
v_mfma_f32_16x16x32_bf16 v[72:75], a[84:87], a[132:135], v[72:75]
buffer_load_dwordx4 v4, s[20:23], s49 offen offset:0 lds
v_mfma_f32_16x16x32_bf16 v[76:79], a[88:91], a[128:131], v[76:79]
v_mfma_f32_16x16x32_bf16 v[76:79], a[92:95], a[132:135], v[76:79]
v_mfma_f32_16x16x32_bf16 v[80:83], a[96:99], a[128:131], v[80:83]
v_mfma_f32_16x16x32_bf16 v[80:83], a[100:103], a[132:135], v[80:83]
buffer_load_dwordx4 v5, s[20:23], s49 offen offset:1024 lds
v_mfma_f32_16x16x32_bf16 v[84:87], a[104:107], a[128:131], v[84:87]
v_mfma_f32_16x16x32_bf16 v[84:87], a[108:111], a[132:135], v[84:87]
v_mfma_f32_16x16x32_bf16 v[88:91], a[112:115], a[128:131], v[88:91]
v_mfma_f32_16x16x32_bf16 v[88:91], a[116:119], a[132:135], v[88:91]
buffer_load_dwordx4 v6, s[20:23], s49 offen offset:2048 lds
v_mfma_f32_16x16x32_bf16 v[92:95], a[120:123], a[128:131], v[92:95]
v_mfma_f32_16x16x32_bf16 v[92:95], a[124:127], a[132:135], v[92:95]
s_waitcnt lgkmcnt(0)
v_mfma_f32_16x16x32_bf16 v[96:99], a[64:67], a[136:139], v[96:99]
ds_read_b64_tr_b16 a[128:129], v16 offset:0
v_mfma_f32_16x16x32_bf16 v[96:99], a[68:71], a[140:143], v[96:99]
ds_read_b64_tr_b16 a[130:131], v16 offset:2048
buffer_load_dwordx4 v7, s[20:23], s49 offen offset:3072 lds
v_mfma_f32_16x16x32_bf16 v[100:103], a[72:75], a[136:139], v[100:103]
ds_read_b64_tr_b16 a[132:133], v16 offset:16384
s_add_u32 s49, s49, 128
v_mfma_f32_16x16x32_bf16 v[100:103], a[76:79], a[140:143], v[100:103]
ds_read_b64_tr_b16 a[134:135], v16 offset:18432
v_mfma_f32_16x16x32_bf16 v[104:107], a[80:83], a[136:139], v[104:107]
v_add_u32 v16, s54, v16
s_mov_b32 m0, s53
v_mfma_f32_16x16x32_bf16 v[104:107], a[84:87], a[140:143], v[104:107]
buffer_load_dwordx4 v8, s[24:27], s50 offen offset:0 lds
v_mfma_f32_16x16x32_bf16 v[108:111], a[88:91], a[136:139], v[108:111]
v_mfma_f32_16x16x32_bf16 v[108:111], a[92:95], a[140:143], v[108:111]
v_mfma_f32_16x16x32_bf16 v[112:115], a[96:99], a[136:139], v[112:115]
v_mfma_f32_16x16x32_bf16 v[112:115], a[100:103], a[140:143], v[112:115]
buffer_load_dwordx4 v9, s[24:27], s50 offen offset:1024 lds
v_mfma_f32_16x16x32_bf16 v[116:119], a[104:107], a[136:139], v[116:119]
v_mfma_f32_16x16x32_bf16 v[116:119], a[108:111], a[140:143], v[116:119]
v_mfma_f32_16x16x32_bf16 v[120:123], a[112:115], a[136:139], v[120:123]
v_mfma_f32_16x16x32_bf16 v[120:123], a[116:119], a[140:143], v[120:123]
buffer_load_dwordx4 v10, s[24:27], s50 offen offset:2048 lds
v_mfma_f32_16x16x32_bf16 v[124:127], a[120:123], a[136:139], v[124:127]
v_mfma_f32_16x16x32_bf16 v[124:127], a[124:127], a[140:143], v[124:127]
s_waitcnt lgkmcnt(0)
v_mfma_f32_16x16x32_bf16 v[128:131], a[64:67], a[128:131], v[128:131]
ds_read_b64_tr_b16 a[136:137], v17 offset:0
v_mfma_f32_16x16x32_bf16 v[128:131], a[68:71], a[132:135], v[128:131]
ds_read_b64_tr_b16 a[138:139], v17 offset:2048
buffer_load_dwordx4 v11, s[24:27], s50 offen offset:3072 lds
v_mfma_f32_16x16x32_bf16 v[132:135], a[72:75], a[128:131], v[132:135]
ds_read_b64_tr_b16 a[140:141], v17 offset:16384
s_add_u32 s50, s50, 524288
v_mfma_f32_16x16x32_bf16 v[132:135], a[76:79], a[132:135], v[132:135]
ds_read_b64_tr_b16 a[142:143], v17 offset:18432
v_mfma_f32_16x16x32_bf16 v[136:139], a[80:83], a[128:131], v[136:139]
v_add_u32 v17, s54, v17
s_add_u32 m0, s53, 8192
v_mfma_f32_16x16x32_bf16 v[136:139], a[84:87], a[132:135], v[136:139]
buffer_load_dwordx4 v8, s[24:27], s51 offen offset:0 lds
v_mfma_f32_16x16x32_bf16 v[140:143], a[88:91], a[128:131], v[140:143]
v_mfma_f32_16x16x32_bf16 v[140:143], a[92:95], a[132:135], v[140:143]
v_mfma_f32_16x16x32_bf16 v[144:147], a[96:99], a[128:131], v[144:147]
v_mfma_f32_16x16x32_bf16 v[144:147], a[100:103], a[132:135], v[144:147]
buffer_load_dwordx4 v9, s[24:27], s51 offen offset:1024 lds
v_mfma_f32_16x16x32_bf16 v[148:151], a[104:107], a[128:131], v[148:151]
v_mfma_f32_16x16x32_bf16 v[148:151], a[108:111], a[132:135], v[148:151]
v_mfma_f32_16x16x32_bf16 v[152:155], a[112:115], a[128:131], v[152:155]
v_mfma_f32_16x16x32_bf16 v[152:155], a[116:119], a[132:135], v[152:155]
buffer_load_dwordx4 v10, s[24:27], s51 offen offset:2048 lds
v_mfma_f32_16x16x32_bf16 v[156:159], a[120:123], a[128:131], v[156:159]
v_mfma_f32_16x16x32_bf16 v[156:159], a[124:127], a[132:135], v[156:159]
s_waitcnt lgkmcnt(0)
v_mfma_f32_16x16x32_bf16 v[160:163], a[64:67], a[136:139], v[160:163]
ds_read_b64_tr_b16 a[128:129], v18 offset:0
v_mfma_f32_16x16x32_bf16 v[160:163], a[68:71], a[140:143], v[160:163]
ds_read_b64_tr_b16 a[130:131], v18 offset:2048
buffer_load_dwordx4 v11, s[24:27], s51 offen offset:3072 lds
v_mfma_f32_16x16x32_bf16 v[164:167], a[72:75], a[136:139], v[164:167]
ds_read_b64_tr_b16 a[132:133], v18 offset:16384
s_add_u32 s51, s51, 524288
v_mfma_f32_16x16x32_bf16 v[164:167], a[76:79], a[140:143], v[164:167]
ds_read_b64_tr_b16 a[134:135], v18 offset:18432
v_mfma_f32_16x16x32_bf16 v[168:171], a[80:83], a[136:139], v[168:171]
v_add_u32 v18, s54, v18
v_mfma_f32_16x16x32_bf16 v[168:171], a[84:87], a[140:143], v[168:171]
v_mfma_f32_16x16x32_bf16 v[172:175], a[88:91], a[136:139], v[172:175]
v_mfma_f32_16x16x32_bf16 v[172:175], a[92:95], a[140:143], v[172:175]
v_mfma_f32_16x16x32_bf16 v[176:179], a[96:99], a[136:139], v[176:179]
v_mfma_f32_16x16x32_bf16 v[176:179], a[100:103], a[140:143], v[176:179]
v_mfma_f32_16x16x32_bf16 v[180:183], a[104:107], a[136:139], v[180:183]
v_mfma_f32_16x16x32_bf16 v[180:183], a[108:111], a[140:143], v[180:183]
buffer_load_dword a255, v22, s[24:27], 0 offen
v_add_u32 v22, 524288, v22
v_mfma_f32_16x16x32_bf16 v[184:187], a[112:115], a[136:139], v[184:187]
buffer_load_dword a255, v23, s[20:23], 0 offen
v_add_u32 v23, 128, v23
v_mfma_f32_16x16x32_bf16 v[184:187], a[116:119], a[140:143], v[184:187]
s_cmp_lt_u32 s16, 8
s_cselect_b32 s46, s17, 0
s_cselect_b32 s6, 1408, 0
v_mfma_f32_16x16x32_bf16 v[188:191], a[120:123], a[136:139], v[188:191]
s_add_u32 s16, s16, 1
buffer_load_dword a255, v3, s[44:47], 0 offen
v_mfma_f32_16x16x32_bf16 v[188:191], a[124:127], a[140:143], v[188:191]
s_waitcnt lgkmcnt(0)
v_add_u32 v3, s6, v3
v_mfma_f32_16x16x32_bf16 v[192:195], a[64:67], a[128:131], v[192:195]
ds_read_b64_tr_b16 a[136:137], v19 offset:0
v_mfma_f32_16x16x32_bf16 v[192:195], a[68:71], a[132:135], v[192:195]
ds_read_b64_tr_b16 a[138:139], v19 offset:2048
v_mfma_f32_16x16x32_bf16 v[196:199], a[72:75], a[128:131], v[196:199]
ds_read_b64_tr_b16 a[140:141], v19 offset:16384
v_mfma_f32_16x16x32_bf16 v[196:199], a[76:79], a[132:135], v[196:199]
ds_read_b64_tr_b16 a[142:143], v19 offset:18432
v_mfma_f32_16x16x32_bf16 v[200:203], a[80:83], a[128:131], v[200:203]
v_add_u32 v19, s54, v19
v_mfma_f32_16x16x32_bf16 v[200:203], a[84:87], a[132:135], v[200:203]
v_mfma_f32_16x16x32_bf16 v[204:207], a[88:91], a[128:131], v[204:207]
v_mfma_f32_16x16x32_bf16 v[204:207], a[92:95], a[132:135], v[204:207]
v_mfma_f32_16x16x32_bf16 v[208:211], a[96:99], a[128:131], v[208:211]
v_mfma_f32_16x16x32_bf16 v[208:211], a[100:103], a[132:135], v[208:211]
v_mfma_f32_16x16x32_bf16 v[212:215], a[104:107], a[128:131], v[212:215]
v_mfma_f32_16x16x32_bf16 v[212:215], a[108:111], a[132:135], v[212:215]
s_cmp_eq_u32 s53, s69
s_cselect_b32 s54, s58, s59
v_mfma_f32_16x16x32_bf16 v[216:219], a[112:115], a[128:131], v[216:219]
s_add_u32 s53, s53, 32768
s_cmp_eq_u32 s53, s68
s_cselect_b32 s53, s69, s53
v_mfma_f32_16x16x32_bf16 v[216:219], a[116:119], a[132:135], v[216:219]
s_xor_b32 s52, s52, 0x38000
v_mfma_f32_16x16x32_bf16 v[220:223], a[120:123], a[128:131], v[220:223]
v_mfma_f32_16x16x32_bf16 v[220:223], a[124:127], a[132:135], v[220:223]
s_waitcnt vmcnt(22)
s_barrier
s_waitcnt lgkmcnt(0)
v_mfma_f32_16x16x32_bf16 v[224:227], a[64:67], a[136:139], v[224:227]
ds_read_b64_tr_b16 a[128:129], v12 offset:0
ds_read_b128 a[64:67], v20 offset:0
v_mfma_f32_16x16x32_bf16 v[224:227], a[68:71], a[140:143], v[224:227]
ds_read_b64_tr_b16 a[130:131], v12 offset:2048
ds_read_b128 a[68:71], v21 offset:0
v_mfma_f32_16x16x32_bf16 v[228:231], a[72:75], a[136:139], v[228:231]
ds_read_b64_tr_b16 a[132:133], v12 offset:16384
ds_read_b128 a[72:75], v20 offset:2048
v_mfma_f32_16x16x32_bf16 v[228:231], a[76:79], a[140:143], v[228:231]
ds_read_b64_tr_b16 a[134:135], v12 offset:18432
ds_read_b128 a[76:79], v21 offset:2048
v_mfma_f32_16x16x32_bf16 v[232:235], a[80:83], a[136:139], v[232:235]
v_add_u32 v12, s54, v12
ds_read_b128 a[80:83], v20 offset:4096
v_mfma_f32_16x16x32_bf16 v[232:235], a[84:87], a[140:143], v[232:235]
ds_read_b128 a[84:87], v21 offset:4096
v_mfma_f32_16x16x32_bf16 v[236:239], a[88:91], a[136:139], v[236:239]
ds_read_b128 a[88:91], v20 offset:6144
v_mfma_f32_16x16x32_bf16 v[236:239], a[92:95], a[140:143], v[236:239]
ds_read_b128 a[92:95], v21 offset:6144
v_mfma_f32_16x16x32_bf16 v[240:243], a[96:99], a[136:139], v[240:243]
ds_read_b128 a[96:99], v20 offset:8192
v_mfma_f32_16x16x32_bf16 v[240:243], a[100:103], a[140:143], v[240:243]
ds_read_b128 a[100:103], v21 offset:8192
v_mfma_f32_16x16x32_bf16 v[244:247], a[104:107], a[136:139], v[244:247]
ds_read_b128 a[104:107], v20 offset:10240
v_mfma_f32_16x16x32_bf16 v[244:247], a[108:111], a[140:143], v[244:247]
ds_read_b128 a[108:111], v21 offset:10240
v_mfma_f32_16x16x32_bf16 v[248:251], a[112:115], a[136:139], v[248:251]
ds_read_b128 a[112:115], v20 offset:12288
v_mfma_f32_16x16x32_bf16 v[248:251], a[116:119], a[140:143], v[248:251]
ds_read_b128 a[116:119], v21 offset:12288
v_mfma_f32_16x16x32_bf16 v[252:255], a[120:123], a[136:139], v[252:255]
ds_read_b128 a[120:123], v20 offset:14336
v_mfma_f32_16x16x32_bf16 v[252:255], a[124:127], a[140:143], v[252:255]
ds_read_b128 a[124:127], v21 offset:14336
v_xor_b32 v20, 0x38000, v20
v_xor_b32 v21, 0x38000, v21
s_sub_u32 s56, s56, 1
s_cmp_lg_u32 s56, 0
s_cbranch_scc1 kv_loop1
s_add_u32 s72, s60, 0
s_add_u32 s73, s60, 1024
s_add_u32 s74, s60, 131072
s_add_u32 s75, s60, 132096
s_add_u32 s76, s60, 262144
s_add_u32 s77, s60, 263168
s_add_u32 s78, s60, 393216
s_add_u32 s79, s60, 394240
s_waitcnt lgkmcnt(13)
s_waitcnt lgkmcnt(12)
v_mfma_f32_16x16x32_bf16 a[0:3], a[64:67], a[128:131], a[0:3]
ds_read_b64_tr_b16 a[136:137], v13 offset:0
s_mov_b32 s24, s55
s_and_b32 s25, s2, 7
v_mfma_f32_16x16x32_bf16 a[0:3], a[68:71], a[132:135], a[0:3]
ds_read_b64_tr_b16 a[138:139], v13 offset:2048
s_lshl_b32 s25, s25, 1
s_lshr_b32 s26, s2, 7
v_mfma_f32_16x16x32_bf16 a[4:7], a[72:75], a[128:131], a[4:7]
ds_read_b64_tr_b16 a[140:141], v13 offset:16384
s_add_u32 s25, s25, s26
s_bfe_u32 s26, s2, 0x40003
v_mfma_f32_16x16x32_bf16 a[4:7], a[76:79], a[132:135], a[4:7]
s_waitcnt lgkmcnt(11)
ds_read_b64_tr_b16 a[142:143], v13 offset:18432
s_sub_u32 s27, 21, s26
v_mfma_f32_16x16x32_bf16 a[8:11], a[80:83], a[128:131], a[8:11]
v_add_u32 v13, s54, v13
s_sub_u32 s60, s26, 6
s_sub_u32 s61, 15, s60
v_mfma_f32_16x16x32_bf16 a[8:11], a[84:87], a[132:135], a[8:11]
s_cmp_lt_u32 s26, 12
s_cselect_b32 s27, s60, s27
s_cselect_b32 s63, s60, 0
s_cselect_b32 s31, s61, -1
v_mfma_f32_16x16x32_bf16 a[12:15], a[88:91], a[128:131], a[12:15]
s_lshl_b32 s29, s27, 2
s_add_u32 s29, s29, 4
s_sub_u32 s60, 15, s26
v_mfma_f32_16x16x32_bf16 a[12:15], a[92:95], a[132:135], a[12:15]
s_waitcnt lgkmcnt(8)
v_mfma_f32_16x16x32_bf16 a[16:19], a[96:99], a[128:131], a[16:19]
s_cmp_lt_u32 s26, 6
s_cselect_b32 s27, s60, s27
s_cselect_b32 s30, 2, 0
s_cselect_b32 s31, -1, s31
s_cselect_b32 s63, s26, s63
v_mfma_f32_16x16x32_bf16 a[16:19], a[100:103], a[132:135], a[16:19]
s_cmp_eq_u32 s63, 5
s_cselect_b32 s3, 40, 40
v_mfma_f32_16x16x32_bf16 a[20:23], a[104:107], a[128:131], a[20:23]
s_bitcmp1_b32 s2, 0
s_cselect_b32 s60, 40, s3
s_min_u32 s3, s3, s60
v_mfma_f32_16x16x32_bf16 a[20:23], a[108:111], a[132:135], a[20:23]
s_waitcnt lgkmcnt(4)
s_cmp_eq_u32 s30, 2
s_cselect_b32 s29, s3, s29
v_mfma_f32_16x16x32_bf16 a[24:27], a[112:115], a[128:131], a[24:27]
s_mov_b32 s28, 0
s_lshl_b32 s67, s27, 7
s_add_u32 s67, s67, 36831232
v_mfma_f32_16x16x32_bf16 a[24:27], a[116:119], a[132:135], a[24:27]
s_lshl_b32 s68, s25, 7
s_add_u32 s69, s68, 36833280
s_add_u32 s68, s68, 36847616
v_mfma_f32_16x16x32_bf16 a[28:31], a[120:123], a[128:131], a[28:31]
v_cmp_eq_u32 vcc, 0, v1
v_mov_b32 v7, 0x1000000
s_nop 0
v_cndmask_b32 v7, v7, 0, vcc
v_mfma_f32_16x16x32_bf16 a[28:31], a[124:127], a[132:135], a[28:31]
s_waitcnt vmcnt(3)
s_barrier
s_waitcnt lgkmcnt(0)
v_mfma_f32_16x16x32_bf16 a[32:35], a[64:67], a[136:139], a[32:35]
ds_read_b64_tr_b16 a[128:129], v12 offset:0
s_lshr_b32 s60, s24, 1
s_lshl_b32 s60, s60, 5
v_mfma_f32_16x16x32_bf16 a[32:35], a[68:71], a[140:143], a[32:35]
ds_read_b64_tr_b16 a[130:131], v12 offset:2048
s_and_b32 s61, s24, 1
s_lshl_b32 s61, s61, 3
v_mfma_f32_16x16x32_bf16 a[36:39], a[72:75], a[136:139], a[36:39]
ds_read_b64_tr_b16 a[132:133], v12 offset:16384
s_add_u32 s60, s60, s61
s_lshl_b32 s37, s60, 9
v_mfma_f32_16x16x32_bf16 a[36:39], a[76:79], a[140:143], a[36:39]
ds_read_b64_tr_b16 a[134:135], v12 offset:18432
s_lshl_b32 s34, s60, 13
s_lshl_b32 s61, s25, 9
v_mfma_f32_16x16x32_bf16 a[40:43], a[80:83], a[136:139], a[40:43]
ds_read_b128 a[144:147], v20 offset:0
ds_read_b128 a[148:151], v21 offset:0
s_add_u32 s34, s34, s61
v_mfma_f32_16x16x32_bf16 a[40:43], a[84:87], a[140:143], a[40:43]
ds_read_b128 a[152:155], v20 offset:2048
ds_read_b128 a[156:159], v21 offset:2048
s_add_u32 s35, s34, 131072
v_mfma_f32_16x16x32_bf16 a[44:47], a[88:91], a[136:139], a[44:47]
ds_read_b128 a[160:163], v20 offset:4096
ds_read_b128 a[164:167], v21 offset:4096
s_mov_b32 s16, s18
v_mfma_f32_16x16x32_bf16 a[44:47], a[92:95], a[140:143], a[44:47]
ds_read_b128 a[168:171], v20 offset:6144
ds_read_b128 a[172:175], v21 offset:6144
s_mov_b32 s17, s19
v_mfma_f32_16x16x32_bf16 a[48:51], a[96:99], a[136:139], a[48:51]
ds_read_b128 a[176:179], v20 offset:8192
s_mov_b32 s18, 3670016
s_mov_b32 s19, 0x00020000
v_mfma_f32_16x16x32_bf16 a[48:51], a[100:103], a[140:143], a[48:51]
ds_read_b128 a[180:183], v21 offset:8192
s_lshl_b32 s60, s27, 3
s_lshl_b32 s61, s24, 1
v_mfma_f32_16x16x32_bf16 a[52:55], a[104:107], a[136:139], a[52:55]
ds_read_b128 a[184:187], v20 offset:10240
s_add_u32 s60, s60, s61
s_mul_i32 s43, s60, 14336
v_mfma_f32_16x16x32_bf16 a[52:55], a[108:111], a[140:143], a[52:55]
ds_read_b128 a[188:191], v21 offset:10240
s_add_u32 s43, s43, 33554432
s_add_u32 s44, s43, 14336
v_mfma_f32_16x16x32_bf16 a[56:59], a[112:115], a[136:139], a[56:59]
ds_read_b128 a[192:195], v20 offset:12288
v_and_b32 v4, 15, v1
v_lshlrev_b32 v4, 6, v4
v_mfma_f32_16x16x32_bf16 a[56:59], a[116:119], a[140:143], a[56:59]
ds_read_b128 a[196:199], v21 offset:12288
v_and_b32 v3, 48, v1
v_add_u32 v3, v3, v4
v_mfma_f32_16x16x32_bf16 a[60:63], a[120:123], a[136:139], a[60:63]
ds_read_b128 a[200:203], v20 offset:14336
s_cmp_eq_u32 s24, 0
s_cselect_b32 s62, 0, -1
v_mfma_f32_16x16x32_bf16 a[60:63], a[124:127], a[140:143], a[60:63]
ds_read_b128 a[204:207], v21 offset:14336
s_waitcnt lgkmcnt(15)
s_waitcnt lgkmcnt(12)
v_mfma_f32_16x16x32_bf16 a[0:3], a[144:147], a[128:131], a[0:3]
ds_read_b64_tr_b16 a[136:137], v13 offset:0
v_mfma_f32_16x16x32_bf16 a[0:3], a[148:151], a[132:135], a[0:3]
ds_read_b64_tr_b16 a[138:139], v13 offset:2048
v_mfma_f32_16x16x32_bf16 a[4:7], a[152:155], a[128:131], a[4:7]
ds_read_b64_tr_b16 a[140:141], v13 offset:16384
s_add_u32 m0, s37, 98304
v_mfma_f32_16x16x32_bf16 a[4:7], a[156:159], a[132:135], a[4:7]
s_waitcnt lgkmcnt(11)
ds_read_b64_tr_b16 a[142:143], v13 offset:18432
buffer_load_dwordx4 v8, s[16:19], s34 offen offset:0 lds
v_mfma_f32_16x16x32_bf16 a[8:11], a[160:163], a[128:131], a[8:11]
v_mfma_f32_16x16x32_bf16 a[8:11], a[164:167], a[132:135], a[8:11]
buffer_load_dwordx4 v9, s[16:19], s34 offen offset:1024 lds
v_mfma_f32_16x16x32_bf16 a[12:15], a[168:171], a[128:131], a[12:15]
v_mfma_f32_16x16x32_bf16 a[12:15], a[172:175], a[132:135], a[12:15]
s_waitcnt lgkmcnt(8)
buffer_load_dword v6, v7, s[8:11], 0 offen offset:4 sc1
buffer_load_dword v21, v7, s[8:11], 0 offen offset:132 sc1
buffer_load_dwordx4 v10, s[16:19], s34 offen offset:2048 lds
v_mfma_f32_16x16x32_bf16 a[16:19], a[176:179], a[128:131], a[16:19]
v_accvgpr_read_b32 v56, a0
v_accvgpr_read_b32 v57, a1
v_mfma_f32_16x16x32_bf16 a[16:19], a[180:183], a[132:135], a[16:19]
buffer_load_dwordx4 v11, s[16:19], s34 offen offset:3072 lds
s_add_u32 s34, s34, 524288
v_mfma_f32_16x16x32_bf16 a[20:23], a[184:187], a[128:131], a[20:23]
v_accvgpr_read_b32 v58, a2
v_accvgpr_read_b32 v59, a3
v_mfma_f32_16x16x32_bf16 a[20:23], a[188:191], a[132:135], a[20:23]
s_waitcnt lgkmcnt(4)
v_lshlrev_b32 v20, 6, v7
s_add_u32 m0, s37, 106496
v_mfma_f32_16x16x32_bf16 a[24:27], a[192:195], a[128:131], a[24:27]
buffer_load_dwordx4 v8, s[16:19], s35 offen offset:0 lds
v_cvt_pk_bf16_f32 v24, v56, v57
v_mfma_f32_16x16x32_bf16 a[24:27], a[196:199], a[132:135], a[24:27]
s_and_b32 s39, s62, 0x40000000
v_or_b32 v20, s39, v20
v_mfma_f32_16x16x32_bf16 a[28:31], a[200:203], a[128:131], a[28:31]
buffer_load_dwordx4 v9, s[16:19], s35 offen offset:1024 lds
v_cvt_pk_bf16_f32 v25, v58, v59
v_mfma_f32_16x16x32_bf16 a[28:31], a[204:207], a[132:135], a[28:31]
s_waitcnt lgkmcnt(0)
v_accvgpr_read_b32 v60, a4
v_mfma_f32_16x16x32_bf16 a[32:35], a[144:147], a[136:139], a[32:35]
ds_read_b64_tr_b16 a[128:129], v14 offset:0
buffer_load_dwordx4 v10, s[16:19], s35 offen offset:2048 lds
v_mfma_f32_16x16x32_bf16 a[32:35], a[148:151], a[140:143], a[32:35]
ds_read_b64_tr_b16 a[130:131], v14 offset:2048
v_accvgpr_read_b32 v61, a5
v_mfma_f32_16x16x32_bf16 a[36:39], a[152:155], a[136:139], a[36:39]
ds_read_b64_tr_b16 a[132:133], v14 offset:16384
buffer_load_dwordx4 v11, s[16:19], s35 offen offset:3072 lds
s_add_u32 s35, s35, 524288
v_mfma_f32_16x16x32_bf16 a[36:39], a[156:159], a[140:143], a[36:39]
ds_read_b64_tr_b16 a[134:135], v14 offset:18432
v_accvgpr_read_b32 v62, a6
v_mfma_f32_16x16x32_bf16 a[40:43], a[160:163], a[136:139], a[40:43]
v_add_u32 v14, s54, v14
v_accvgpr_read_b32 v63, a7
v_mfma_f32_16x16x32_bf16 a[40:43], a[164:167], a[140:143], a[40:43]
v_cvt_pk_bf16_f32 v26, v60, v61
v_cvt_pk_bf16_f32 v27, v62, v63
v_mfma_f32_16x16x32_bf16 a[44:47], a[168:171], a[136:139], a[44:47]
v_mfma_f32_16x16x32_bf16 a[44:47], a[172:175], a[140:143], a[44:47]
v_mfma_f32_16x16x32_bf16 a[48:51], a[176:179], a[136:139], a[48:51]
v_mfma_f32_16x16x32_bf16 a[48:51], a[180:183], a[140:143], a[48:51]
v_mfma_f32_16x16x32_bf16 a[52:55], a[184:187], a[136:139], a[52:55]
v_mfma_f32_16x16x32_bf16 a[52:55], a[188:191], a[140:143], a[52:55]
v_mfma_f32_16x16x32_bf16 a[56:59], a[192:195], a[136:139], a[56:59]
v_mfma_f32_16x16x32_bf16 a[56:59], a[196:199], a[140:143], a[56:59]
buffer_store_dwordx4 v[24:27], v2, s[12:15], s72 offen offset:0 sc1
v_accvgpr_read_b32 v56, a8
v_mfma_f32_16x16x32_bf16 a[60:63], a[200:203], a[136:139], a[60:63]
v_accvgpr_read_b32 v57, a9
v_accvgpr_read_b32 v58, a10
v_mfma_f32_16x16x32_bf16 a[60:63], a[204:207], a[140:143], a[60:63]
s_barrier
s_waitcnt lgkmcnt(0)
v_mfma_f32_16x16x32_bf16 v[64:67], a[64:67], a[128:131], v[64:67]
ds_read_b64_tr_b16 a[136:137], v15 offset:0
v_accvgpr_read_b32 v59, a11
v_mfma_f32_16x16x32_bf16 v[64:67], a[68:71], a[132:135], v[64:67]
ds_read_b64_tr_b16 a[138:139], v15 offset:2048
s_add_u32 m0, s37, 131072
s_add_u32 s45, s43, 4096
v_mfma_f32_16x16x32_bf16 v[68:71], a[72:75], a[128:131], v[68:71]
ds_read_b64_tr_b16 a[140:141], v15 offset:16384
buffer_load_dwordx4 v8, s[16:19], s34 offen offset:0 lds
s_add_u32 s46, s44, 4096
v_mfma_f32_16x16x32_bf16 v[68:71], a[76:79], a[132:135], v[68:71]
ds_read_b64_tr_b16 a[142:143], v15 offset:18432
s_add_u32 s47, s43, 8192
s_add_u32 s48, s44, 8192
v_mfma_f32_16x16x32_bf16 v[72:75], a[80:83], a[128:131], v[72:75]
v_add_u32 v15, s54, v15
buffer_load_dwordx4 v9, s[16:19], s34 offen offset:1024 lds
s_add_u32 s49, s43, 12288
v_mfma_f32_16x16x32_bf16 v[72:75], a[84:87], a[132:135], v[72:75]
s_add_u32 s50, s44, 12288
s_lshl_b32 s6, s24, 12
s_add_u32 s36, s6, 98304
v_mfma_f32_16x16x32_bf16 v[76:79], a[88:91], a[128:131], v[76:79]
buffer_load_dwordx4 v10, s[16:19], s34 offen offset:2048 lds
s_add_u32 s7, s6, 32768
s_mul_i32 s60, s25, 6
v_mfma_f32_16x16x32_bf16 v[76:79], a[92:95], a[132:135], v[76:79]
s_add_u32 s60, s60, s63
s_lshl_b32 s60, s60, 2
s_add_u32 s60, s60, s24
v_mfma_f32_16x16x32_bf16 v[80:83], a[96:99], a[128:131], v[80:83]
buffer_load_dwordx4 v11, s[16:19], s34 offen offset:3072 lds
s_add_u32 s34, s34, 524288
s_lshl_b32 s64, s60, 14
v_mfma_f32_16x16x32_bf16 v[80:83], a[100:103], a[132:135], v[80:83]
s_lshl_b32 s65, s60, 10
s_add_u32 s65, s65, 61865984
s_lshl_b32 s58, s25, 4
v_mfma_f32_16x16x32_bf16 v[84:87], a[104:107], a[128:131], v[84:87]
s_add_u32 m0, s37, 139264
s_add_u32 s58, s58, s63
s_lshl_b32 s58, s58, 2
v_mfma_f32_16x16x32_bf16 v[84:87], a[108:111], a[132:135], v[84:87]
buffer_load_dwordx4 v8, s[16:19], s35 offen offset:0 lds
s_add_u32 s58, s58, s24
s_lshl_b32 s58, s58, 7
v_mfma_f32_16x16x32_bf16 v[88:91], a[112:115], a[128:131], v[88:91]
s_add_u32 s58, s58, 36700160
s_add_u32 s59, s58, 4096
s_lshl_b32 s41, s25, 20
v_mfma_f32_16x16x32_bf16 v[88:91], a[116:119], a[132:135], v[88:91]
buffer_load_dwordx4 v9, s[16:19], s35 offen offset:1024 lds
s_add_u32 s41, s41, s6
s_add_u32 s32, s41, 16384
v_mfma_f32_16x16x32_bf16 v[92:95], a[120:123], a[128:131], v[92:95]
s_add_u32 s33, s41, 16777216
s_mov_b32 s20, s4
s_mov_b32 s21, s5
v_mfma_f32_16x16x32_bf16 v[92:95], a[124:127], a[132:135], v[92:95]
s_waitcnt lgkmcnt(0)
buffer_load_dwordx4 v10, s[16:19], s35 offen offset:2048 lds
s_and_b32 s60, s26, 7
v_mfma_f32_16x16x32_bf16 v[96:99], a[64:67], a[136:139], v[96:99]
ds_read_b64_tr_b16 a[128:129], v14 offset:0
s_cmp_eq_u32 s60, 0
s_cselect_b32 s22, 268435456, 0
v_mfma_f32_16x16x32_bf16 v[96:99], a[68:71], a[140:143], v[96:99]
ds_read_b64_tr_b16 a[130:131], v14 offset:2048
buffer_load_dwordx4 v11, s[16:19], s35 offen offset:3072 lds
s_add_u32 s35, s35, 524288
v_mfma_f32_16x16x32_bf16 v[100:103], a[72:75], a[136:139], v[100:103]
ds_read_b64_tr_b16 a[132:133], v14 offset:16384
s_mov_b32 s23, 0x00020000
s_lshl_b32 s70, 1, s26
v_mfma_f32_16x16x32_bf16 v[100:103], a[76:79], a[140:143], v[100:103]
ds_read_b64_tr_b16 a[134:135], v14 offset:18432
s_add_u32 m0, s37, 32768
v_mfma_f32_16x16x32_bf16 v[104:107], a[80:83], a[136:139], v[104:107]
buffer_load_dwordx4 v8, s[16:19], s34 offen offset:0 lds
v_cvt_pk_bf16_f32 v28, v56, v57
v_mfma_f32_16x16x32_bf16 v[104:107], a[84:87], a[140:143], v[104:107]
v_cvt_pk_bf16_f32 v29, v58, v59
v_accvgpr_read_b32 v60, a12
v_mfma_f32_16x16x32_bf16 v[108:111], a[88:91], a[136:139], v[108:111]
buffer_load_dwordx4 v9, s[16:19], s34 offen offset:1024 lds
v_accvgpr_read_b32 v61, a13
v_mfma_f32_16x16x32_bf16 v[108:111], a[92:95], a[140:143], v[108:111]
v_accvgpr_read_b32 v62, a14
v_accvgpr_read_b32 v63, a15
v_mfma_f32_16x16x32_bf16 v[112:115], a[96:99], a[136:139], v[112:115]
buffer_load_dwordx4 v10, s[16:19], s34 offen offset:2048 lds
v_cvt_pk_bf16_f32 v30, v60, v61
v_mfma_f32_16x16x32_bf16 v[112:115], a[100:103], a[140:143], v[112:115]
v_cvt_pk_bf16_f32 v31, v62, v63
buffer_store_dwordx4 v[28:31], v2, s[12:15], s74 offen offset:0 sc1
v_mfma_f32_16x16x32_bf16 v[116:119], a[104:107], a[136:139], v[116:119]
buffer_load_dwordx4 v11, s[16:19], s34 offen offset:3072 lds
s_add_u32 s34, s34, 524288
v_mfma_f32_16x16x32_bf16 v[116:119], a[108:111], a[140:143], v[116:119]
v_accvgpr_read_b32 v56, a16
v_accvgpr_read_b32 v57, a17
v_mfma_f32_16x16x32_bf16 v[120:123], a[112:115], a[136:139], v[120:123]
s_add_u32 m0, s37, 40960
v_accvgpr_read_b32 v58, a18
v_mfma_f32_16x16x32_bf16 v[120:123], a[116:119], a[140:143], v[120:123]
buffer_load_dwordx4 v8, s[16:19], s35 offen offset:0 lds
v_accvgpr_read_b32 v59, a19
v_mfma_f32_16x16x32_bf16 v[124:127], a[120:123], a[136:139], v[124:127]
v_cvt_pk_bf16_f32 v32, v56, v57
v_cvt_pk_bf16_f32 v33, v58, v59
v_mfma_f32_16x16x32_bf16 v[124:127], a[124:127], a[140:143], v[124:127]
s_waitcnt vmcnt(21)
v_readfirstlane_b32 s39, v6
v_readfirstlane_b32 s38, v21
s_nop 0
s_add_u32 s39, s39, s38
s_or_b32 s39, s39, s62
s_cmp_ge_u32 s39, 336
s_cbranch_scc0 at_m1
at_m1r:
s_waitcnt lgkmcnt(0)
buffer_load_dwordx4 v9, s[16:19], s35 offen offset:1024 lds
v_mfma_f32_16x16x32_bf16 v[64:67], a[144:147], a[128:131], v[64:67]
ds_read_b64_tr_b16 a[136:137], v15 offset:0
v_accvgpr_read_b32 v60, a20
v_mfma_f32_16x16x32_bf16 v[64:67], a[148:151], a[132:135], v[64:67]
ds_read_b64_tr_b16 a[138:139], v15 offset:2048
buffer_load_dwordx4 v10, s[16:19], s35 offen offset:2048 lds
v_mfma_f32_16x16x32_bf16 v[68:71], a[152:155], a[128:131], v[68:71]
ds_read_b64_tr_b16 a[140:141], v15 offset:16384
v_accvgpr_read_b32 v61, a21
v_mfma_f32_16x16x32_bf16 v[68:71], a[156:159], a[132:135], v[68:71]
ds_read_b64_tr_b16 a[142:143], v15 offset:18432
buffer_load_dwordx4 v11, s[16:19], s35 offen offset:3072 lds
s_add_u32 s35, s35, 524288
v_mfma_f32_16x16x32_bf16 v[72:75], a[160:163], a[128:131], v[72:75]
v_accvgpr_read_b32 v62, a22
v_accvgpr_read_b32 v63, a23
v_mfma_f32_16x16x32_bf16 v[72:75], a[164:167], a[132:135], v[72:75]
v_cvt_pk_bf16_f32 v34, v60, v61
v_cvt_pk_bf16_f32 v35, v62, v63
v_mfma_f32_16x16x32_bf16 v[76:79], a[168:171], a[128:131], v[76:79]
buffer_store_dwordx4 v[32:35], v2, s[12:15], s76 offen offset:0 sc1
v_accvgpr_read_b32 v56, a24
v_mfma_f32_16x16x32_bf16 v[76:79], a[172:175], a[132:135], v[76:79]
v_accvgpr_read_b32 v57, a25
v_accvgpr_read_b32 v58, a26
v_mfma_f32_16x16x32_bf16 v[80:83], a[176:179], a[128:131], v[80:83]
v_accvgpr_read_b32 v59, a27
v_cvt_pk_bf16_f32 v36, v56, v57
v_mfma_f32_16x16x32_bf16 v[80:83], a[180:183], a[132:135], v[80:83]
v_cvt_pk_bf16_f32 v37, v58, v59
v_accvgpr_read_b32 v60, a28
v_mfma_f32_16x16x32_bf16 v[84:87], a[184:187], a[128:131], v[84:87]
v_accvgpr_read_b32 v61, a29
v_accvgpr_read_b32 v62, a30
v_mfma_f32_16x16x32_bf16 v[84:87], a[188:191], a[132:135], v[84:87]
v_accvgpr_read_b32 v63, a31
v_cvt_pk_bf16_f32 v38, v60, v61
v_mfma_f32_16x16x32_bf16 v[88:91], a[192:195], a[128:131], v[88:91]
v_cvt_pk_bf16_f32 v39, v62, v63
buffer_store_dwordx4 v[36:39], v2, s[12:15], s78 offen offset:0 sc1
v_mfma_f32_16x16x32_bf16 v[88:91], a[196:199], a[132:135], v[88:91]
v_accvgpr_read_b32 v56, a32
v_accvgpr_read_b32 v57, a33
v_mfma_f32_16x16x32_bf16 v[92:95], a[200:203], a[128:131], v[92:95]
v_accvgpr_read_b32 v58, a34
v_accvgpr_read_b32 v59, a35
v_mfma_f32_16x16x32_bf16 v[92:95], a[204:207], a[132:135], v[92:95]
s_waitcnt lgkmcnt(0)
v_cvt_pk_bf16_f32 v24, v56, v57
v_mfma_f32_16x16x32_bf16 v[96:99], a[144:147], a[136:139], v[96:99]
ds_read_b64_tr_b16 a[128:129], v16 offset:0
v_cvt_pk_bf16_f32 v25, v58, v59
v_mfma_f32_16x16x32_bf16 v[96:99], a[148:151], a[140:143], v[96:99]
ds_read_b64_tr_b16 a[130:131], v16 offset:2048
v_accvgpr_read_b32 v60, a36
v_mfma_f32_16x16x32_bf16 v[100:103], a[152:155], a[136:139], v[100:103]
ds_read_b64_tr_b16 a[132:133], v16 offset:16384
v_accvgpr_read_b32 v61, a37
v_mfma_f32_16x16x32_bf16 v[100:103], a[156:159], a[140:143], v[100:103]
ds_read_b64_tr_b16 a[134:135], v16 offset:18432
v_accvgpr_read_b32 v62, a38
v_mfma_f32_16x16x32_bf16 v[104:107], a[160:163], a[136:139], v[104:107]
v_add_u32 v16, s54, v16
v_accvgpr_read_b32 v63, a39
v_mfma_f32_16x16x32_bf16 v[104:107], a[164:167], a[140:143], v[104:107]
v_cvt_pk_bf16_f32 v26, v60, v61
v_cvt_pk_bf16_f32 v27, v62, v63
v_mfma_f32_16x16x32_bf16 v[108:111], a[168:171], a[136:139], v[108:111]
buffer_store_dwordx4 v[24:27], v2, s[12:15], s73 offen offset:0 sc1
v_accvgpr_read_b32 v56, a40
v_mfma_f32_16x16x32_bf16 v[108:111], a[172:175], a[140:143], v[108:111]
v_mov_b32 v6, 0
buffer_atomic_or v6, v20, s[12:15], s67 offen sc0 sc1
v_mfma_f32_16x16x32_bf16 v[112:115], a[176:179], a[136:139], v[112:115]
v_accvgpr_read_b32 v57, a41
v_accvgpr_read_b32 v58, a42
v_mfma_f32_16x16x32_bf16 v[112:115], a[180:183], a[140:143], v[112:115]
v_accvgpr_read_b32 v59, a43
v_cvt_pk_bf16_f32 v28, v56, v57
v_mfma_f32_16x16x32_bf16 v[116:119], a[184:187], a[136:139], v[116:119]
v_cvt_pk_bf16_f32 v29, v58, v59
v_accvgpr_read_b32 v60, a44
v_mfma_f32_16x16x32_bf16 v[116:119], a[188:191], a[140:143], v[116:119]
v_accvgpr_read_b32 v61, a45
v_accvgpr_read_b32 v62, a46
v_mfma_f32_16x16x32_bf16 v[120:123], a[192:195], a[136:139], v[120:123]
v_accvgpr_read_b32 v63, a47
v_cvt_pk_bf16_f32 v30, v60, v61
v_mfma_f32_16x16x32_bf16 v[120:123], a[196:199], a[140:143], v[120:123]
v_cvt_pk_bf16_f32 v31, v62, v63
buffer_store_dwordx4 v[28:31], v2, s[12:15], s75 offen offset:0 sc1
v_mfma_f32_16x16x32_bf16 v[124:127], a[200:203], a[136:139], v[124:127]
v_accvgpr_read_b32 v56, a48
v_accvgpr_read_b32 v57, a49
v_mfma_f32_16x16x32_bf16 v[124:127], a[204:207], a[140:143], v[124:127]
s_waitcnt lgkmcnt(0)
v_accvgpr_read_b32 v58, a50
v_mfma_f32_16x16x32_bf16 v[128:131], a[64:67], a[128:131], v[128:131]
ds_read_b64_tr_b16 a[136:137], v17 offset:0
v_accvgpr_read_b32 v59, a51
v_mfma_f32_16x16x32_bf16 v[128:131], a[68:71], a[132:135], v[128:131]
ds_read_b64_tr_b16 a[138:139], v17 offset:2048
v_cvt_pk_bf16_f32 v32, v56, v57
v_mfma_f32_16x16x32_bf16 v[132:135], a[72:75], a[128:131], v[132:135]
ds_read_b64_tr_b16 a[140:141], v17 offset:16384
v_cvt_pk_bf16_f32 v33, v58, v59
v_mfma_f32_16x16x32_bf16 v[132:135], a[76:79], a[132:135], v[132:135]
ds_read_b64_tr_b16 a[142:143], v17 offset:18432
v_accvgpr_read_b32 v60, a52
v_mfma_f32_16x16x32_bf16 v[136:139], a[80:83], a[128:131], v[136:139]
v_add_u32 v17, s54, v17
v_accvgpr_read_b32 v61, a53
v_mfma_f32_16x16x32_bf16 v[136:139], a[84:87], a[132:135], v[136:139]
v_accvgpr_read_b32 v62, a54
v_accvgpr_read_b32 v63, a55
v_mfma_f32_16x16x32_bf16 v[140:143], a[88:91], a[128:131], v[140:143]
v_cvt_pk_bf16_f32 v34, v60, v61
v_cvt_pk_bf16_f32 v35, v62, v63
v_mfma_f32_16x16x32_bf16 v[140:143], a[92:95], a[132:135], v[140:143]
buffer_store_dwordx4 v[32:35], v2, s[12:15], s77 offen offset:0 sc1
v_accvgpr_read_b32 v56, a56
v_mfma_f32_16x16x32_bf16 v[144:147], a[96:99], a[128:131], v[144:147]
v_accvgpr_read_b32 v57, a57
v_accvgpr_read_b32 v58, a58
v_mfma_f32_16x16x32_bf16 v[144:147], a[100:103], a[132:135], v[144:147]
v_accvgpr_read_b32 v59, a59
v_cvt_pk_bf16_f32 v36, v56, v57
v_mfma_f32_16x16x32_bf16 v[148:151], a[104:107], a[128:131], v[148:151]
v_cvt_pk_bf16_f32 v37, v58, v59
v_accvgpr_read_b32 v60, a60
v_mfma_f32_16x16x32_bf16 v[148:151], a[108:111], a[132:135], v[148:151]
v_accvgpr_read_b32 v61, a61
v_accvgpr_read_b32 v62, a62
v_mfma_f32_16x16x32_bf16 v[152:155], a[112:115], a[128:131], v[152:155]
v_accvgpr_read_b32 v63, a63
v_cvt_pk_bf16_f32 v38, v60, v61
v_mfma_f32_16x16x32_bf16 v[152:155], a[116:119], a[132:135], v[152:155]
v_cvt_pk_bf16_f32 v39, v62, v63
v_lshrrev_b32 v22, 4, v1
v_mfma_f32_16x16x32_bf16 v[156:159], a[120:123], a[128:131], v[156:159]
v_bfe_u32 v23, v1, 2, 2
v_lshl_add_u32 v5, v22, 3, v23
v_mfma_f32_16x16x32_bf16 v[156:159], a[124:127], a[132:135], v[156:159]
s_waitcnt lgkmcnt(0)
v_lshlrev_b32 v5, 9, v5
v_mfma_f32_16x16x32_bf16 v[160:163], a[64:67], a[136:139], v[160:163]
ds_read_b64_tr_b16 a[128:129], v16 offset:0
v_and_b32 v22, 1, v22
v_mfma_f32_16x16x32_bf16 v[160:163], a[68:71], a[140:143], v[160:163]
ds_read_b64_tr_b16 a[130:131], v16 offset:2048
buffer_store_dwordx4 v[36:39], v2, s[12:15], s79 offen offset:0 sc1
v_mfma_f32_16x16x32_bf16 v[164:167], a[72:75], a[136:139], v[164:167]
ds_read_b64_tr_b16 a[132:133], v16 offset:16384
v_cvt_pk_bf16_f32 v24, v64, v65
v_mfma_f32_16x16x32_bf16 v[164:167], a[76:79], a[140:143], v[164:167]
ds_read_b64_tr_b16 a[134:135], v16 offset:18432
v_cvt_pk_bf16_f32 v25, v66, v67
v_mfma_f32_16x16x32_bf16 v[168:171], a[80:83], a[136:139], v[168:171]
v_cvt_pk_bf16_f32 v26, v68, v69
v_cvt_pk_bf16_f32 v27, v70, v71
v_mfma_f32_16x16x32_bf16 v[168:171], a[84:87], a[140:143], v[168:171]
buffer_store_dwordx4 v[24:27], v2, s[12:15], s72 offen offset:2048 sc1
v_cvt_pk_bf16_f32 v28, v72, v73
v_mfma_f32_16x16x32_bf16 v[172:175], a[88:91], a[136:139], v[172:175]
v_cvt_pk_bf16_f32 v29, v74, v75
v_cvt_pk_bf16_f32 v30, v76, v77
v_mfma_f32_16x16x32_bf16 v[172:175], a[92:95], a[140:143], v[172:175]
v_cvt_pk_bf16_f32 v31, v78, v79
v_accvgpr_write_b32 a8, v28
v_mfma_f32_16x16x32_bf16 v[176:179], a[96:99], a[136:139], v[176:179]
v_accvgpr_write_b32 a9, v29
v_accvgpr_write_b32 a10, v30
v_mfma_f32_16x16x32_bf16 v[176:179], a[100:103], a[140:143], v[176:179]
v_accvgpr_write_b32 a11, v31
v_cvt_pk_bf16_f32 v32, v80, v81
v_mfma_f32_16x16x32_bf16 v[180:183], a[104:107], a[136:139], v[180:183]
v_cvt_pk_bf16_f32 v33, v82, v83
v_cvt_pk_bf16_f32 v34, v84, v85
v_mfma_f32_16x16x32_bf16 v[180:183], a[108:111], a[140:143], v[180:183]
v_cvt_pk_bf16_f32 v35, v86, v87
v_accvgpr_write_b32 a16, v32
v_mfma_f32_16x16x32_bf16 v[184:187], a[112:115], a[136:139], v[184:187]
v_accvgpr_write_b32 a17, v33
v_accvgpr_write_b32 a18, v34
v_mfma_f32_16x16x32_bf16 v[184:187], a[116:119], a[140:143], v[184:187]
v_accvgpr_write_b32 a19, v35
v_cvt_pk_bf16_f32 v36, v88, v89
v_mfma_f32_16x16x32_bf16 v[188:191], a[120:123], a[136:139], v[188:191]
v_cvt_pk_bf16_f32 v37, v90, v91
v_cvt_pk_bf16_f32 v38, v92, v93
v_mfma_f32_16x16x32_bf16 v[188:191], a[124:127], a[140:143], v[188:191]
s_waitcnt vmcnt(4)
v_readfirstlane_b32 s60, v6
s_nop 0
s_or_b32 s60, s60, s62
s_bfe_u32 s60, s60, 0x80010
s_cmp_eq_u32 s60, 0xff
s_cbranch_scc0 at_h1spin
at_h1spun:
s_barrier
s_waitcnt lgkmcnt(0)
v_mfma_f32_16x16x32_bf16 v[128:131], a[144:147], a[128:131], v[128:131]
ds_read_b64_tr_b16 a[136:137], v17 offset:0
v_cvt_pk_bf16_f32 v39, v94, v95
v_mfma_f32_16x16x32_bf16 v[128:131], a[148:151], a[132:135], v[128:131]
ds_read_b64_tr_b16 a[138:139], v17 offset:2048
v_accvgpr_write_b32 a24, v36
v_mfma_f32_16x16x32_bf16 v[132:135], a[152:155], a[128:131], v[132:135]
ds_read_b64_tr_b16 a[140:141], v17 offset:16384
v_accvgpr_write_b32 a25, v37
v_mfma_f32_16x16x32_bf16 v[132:135], a[156:159], a[132:135], v[132:135]
ds_read_b64_tr_b16 a[142:143], v17 offset:18432
v_accvgpr_write_b32 a26, v38
v_mfma_f32_16x16x32_bf16 v[136:139], a[160:163], a[128:131], v[136:139]
v_accvgpr_write_b32 a27, v39
v_cvt_pk_bf16_f32 v24, v96, v97
v_mfma_f32_16x16x32_bf16 v[136:139], a[164:167], a[132:135], v[136:139]
buffer_load_dwordx4 a[208:211], v3, s[12:15], s43 offen offset:0 sc1
v_cvt_pk_bf16_f32 v25, v98, v99
v_mfma_f32_16x16x32_bf16 v[140:143], a[168:171], a[128:131], v[140:143]
v_cvt_pk_bf16_f32 v26, v100, v101
v_cvt_pk_bf16_f32 v27, v102, v103
v_mfma_f32_16x16x32_bf16 v[140:143], a[172:175], a[132:135], v[140:143]
buffer_store_dwordx4 v[24:27], v2, s[12:15], s73 offen offset:2048 sc1
v_cvt_pk_bf16_f32 v28, v104, v105
v_mfma_f32_16x16x32_bf16 v[144:147], a[176:179], a[128:131], v[144:147]
buffer_load_dwordx4 a[212:215], v3, s[12:15], s44 offen offset:0 sc1
v_cvt_pk_bf16_f32 v29, v106, v107
v_mfma_f32_16x16x32_bf16 v[144:147], a[180:183], a[132:135], v[144:147]
v_cvt_pk_bf16_f32 v30, v108, v109
v_cvt_pk_bf16_f32 v31, v110, v111
v_mfma_f32_16x16x32_bf16 v[148:151], a[184:187], a[128:131], v[148:151]
v_accvgpr_write_b32 a12, v28
v_accvgpr_write_b32 a13, v29
v_mfma_f32_16x16x32_bf16 v[148:151], a[188:191], a[132:135], v[148:151]
buffer_load_dwordx4 a[216:219], v3, s[12:15], s43 offen offset:1024 sc1
v_accvgpr_write_b32 a14, v30
v_mfma_f32_16x16x32_bf16 v[152:155], a[192:195], a[128:131], v[152:155]
v_accvgpr_write_b32 a15, v31
v_cvt_pk_bf16_f32 v32, v112, v113
v_mfma_f32_16x16x32_bf16 v[152:155], a[196:199], a[132:135], v[152:155]
v_cvt_pk_bf16_f32 v33, v114, v115
v_cvt_pk_bf16_f32 v34, v116, v117
v_mfma_f32_16x16x32_bf16 v[156:159], a[200:203], a[128:131], v[156:159]
buffer_load_dwordx4 a[220:223], v3, s[12:15], s44 offen offset:1024 sc1
v_cvt_pk_bf16_f32 v35, v118, v119
v_mfma_f32_16x16x32_bf16 v[156:159], a[204:207], a[132:135], v[156:159]
s_waitcnt lgkmcnt(0)
v_accvgpr_write_b32 a20, v32
v_mfma_f32_16x16x32_bf16 v[160:163], a[144:147], a[136:139], v[160:163]
ds_read_b64_tr_b16 a[128:129], v18 offset:0
v_accvgpr_write_b32 a21, v33
v_mfma_f32_16x16x32_bf16 v[160:163], a[148:151], a[140:143], v[160:163]
ds_read_b64_tr_b16 a[130:131], v18 offset:2048
buffer_load_dwordx4 a[224:227], v3, s[12:15], s43 offen offset:2048 sc1
v_mfma_f32_16x16x32_bf16 v[164:167], a[152:155], a[136:139], v[164:167]
ds_read_b64_tr_b16 a[132:133], v18 offset:16384
v_accvgpr_write_b32 a22, v34
v_mfma_f32_16x16x32_bf16 v[164:167], a[156:159], a[140:143], v[164:167]
ds_read_b64_tr_b16 a[134:135], v18 offset:18432
v_accvgpr_write_b32 a23, v35
v_mfma_f32_16x16x32_bf16 v[168:171], a[160:163], a[136:139], v[168:171]
v_add_u32 v18, s54, v18
buffer_load_dwordx4 a[228:231], v3, s[12:15], s44 offen offset:2048 sc1
v_mfma_f32_16x16x32_bf16 v[168:171], a[164:167], a[140:143], v[168:171]
v_cvt_pk_bf16_f32 v36, v120, v121
v_cvt_pk_bf16_f32 v37, v122, v123
v_mfma_f32_16x16x32_bf16 v[172:175], a[168:171], a[136:139], v[172:175]
v_cvt_pk_bf16_f32 v38, v124, v125
v_cvt_pk_bf16_f32 v39, v126, v127
v_mfma_f32_16x16x32_bf16 v[172:175], a[172:175], a[140:143], v[172:175]
buffer_load_dwordx4 a[232:235], v3, s[12:15], s43 offen offset:3072 sc1
v_accvgpr_write_b32 a28, v36
v_mfma_f32_16x16x32_bf16 v[176:179], a[176:179], a[136:139], v[176:179]
v_accvgpr_write_b32 a29, v37
v_accvgpr_write_b32 a30, v38
v_mfma_f32_16x16x32_bf16 v[176:179], a[180:183], a[140:143], v[176:179]
v_accvgpr_write_b32 a31, v39
v_lshl_or_b32 v22, v22, 2, v23
v_mfma_f32_16x16x32_bf16 v[180:183], a[184:187], a[136:139], v[180:183]
buffer_load_dwordx4 a[236:239], v3, s[12:15], s44 offen offset:3072 sc1
v_and_b32 v23, 3, v1
v_mfma_f32_16x16x32_bf16 v[180:183], a[188:191], a[140:143], v[180:183]
v_lshl_add_u32 v5, v23, 3, v5
v_add_u32 v5, 32768, v5
v_mfma_f32_16x16x32_bf16 v[184:187], a[192:195], a[136:139], v[184:187]
v_xor_b32 v23, 0, v22
v_lshl_add_u32 v40, v23, 5, v5
v_mfma_f32_16x16x32_bf16 v[184:187], a[196:199], a[140:143], v[184:187]
v_add_u32 v48, 0x10000, v40
v_xor_b32 v23, 1, v22
v_mfma_f32_16x16x32_bf16 v[188:191], a[200:203], a[136:139], v[188:191]
v_lshl_add_u32 v41, v23, 5, v5
v_add_u32 v49, 0x10000, v41
v_mfma_f32_16x16x32_bf16 v[188:191], a[204:207], a[140:143], v[188:191]
s_waitcnt lgkmcnt(0)
v_xor_b32 v23, 2, v22
v_mfma_f32_16x16x32_bf16 v[192:195], a[64:67], a[128:131], v[192:195]
ds_read_b64_tr_b16 a[136:137], v19 offset:0
v_lshl_add_u32 v42, v23, 5, v5
v_mfma_f32_16x16x32_bf16 v[192:195], a[68:71], a[132:135], v[192:195]
ds_read_b64_tr_b16 a[138:139], v19 offset:2048
v_add_u32 v50, 0x10000, v42
v_mfma_f32_16x16x32_bf16 v[196:199], a[72:75], a[128:131], v[196:199]
ds_read_b64_tr_b16 a[140:141], v19 offset:16384
v_xor_b32 v23, 3, v22
v_mfma_f32_16x16x32_bf16 v[196:199], a[76:79], a[132:135], v[196:199]
ds_read_b64_tr_b16 a[142:143], v19 offset:18432
v_lshl_add_u32 v43, v23, 5, v5
v_mfma_f32_16x16x32_bf16 v[200:203], a[80:83], a[128:131], v[200:203]
v_add_u32 v19, s54, v19
v_add_u32 v51, 0x10000, v43
v_mfma_f32_16x16x32_bf16 v[200:203], a[84:87], a[132:135], v[200:203]
v_xor_b32 v23, 4, v22
v_lshl_add_u32 v44, v23, 5, v5
v_mfma_f32_16x16x32_bf16 v[204:207], a[88:91], a[128:131], v[204:207]
v_add_u32 v52, 0x10000, v44
v_xor_b32 v23, 5, v22
v_mfma_f32_16x16x32_bf16 v[204:207], a[92:95], a[132:135], v[204:207]
v_lshl_add_u32 v45, v23, 5, v5
v_add_u32 v53, 0x10000, v45
v_mfma_f32_16x16x32_bf16 v[208:211], a[96:99], a[128:131], v[208:211]
v_xor_b32 v23, 6, v22
v_lshl_add_u32 v46, v23, 5, v5
v_mfma_f32_16x16x32_bf16 v[208:211], a[100:103], a[132:135], v[208:211]
v_add_u32 v54, 0x10000, v46
v_xor_b32 v23, 7, v22
v_mfma_f32_16x16x32_bf16 v[212:215], a[104:107], a[128:131], v[212:215]
v_lshl_add_u32 v47, v23, 5, v5
v_add_u32 v55, 0x10000, v47
v_mfma_f32_16x16x32_bf16 v[212:215], a[108:111], a[132:135], v[212:215]
v_cvt_pk_bf16_f32 v96, v128, v129
v_cvt_pk_bf16_f32 v97, v130, v131
v_mfma_f32_16x16x32_bf16 v[216:219], a[112:115], a[128:131], v[216:219]
v_cvt_pk_bf16_f32 v98, v132, v133
v_cvt_pk_bf16_f32 v99, v134, v135
v_mfma_f32_16x16x32_bf16 v[216:219], a[116:119], a[132:135], v[216:219]
s_add_u32 s61, s72, 4096
buffer_store_dwordx4 v[96:99], v2, s[12:15], s61 offen sc1
v_mfma_f32_16x16x32_bf16 v[220:223], a[120:123], a[128:131], v[220:223]
v_cvt_pk_bf16_f32 v104, v136, v137
v_cvt_pk_bf16_f32 v105, v138, v139
v_mfma_f32_16x16x32_bf16 v[220:223], a[124:127], a[132:135], v[220:223]
s_waitcnt lgkmcnt(0)
v_cvt_pk_bf16_f32 v106, v140, v141
v_mfma_f32_16x16x32_bf16 v[224:227], a[64:67], a[136:139], v[224:227]
ds_read_b64_tr_b16 a[128:129], v18 offset:0
v_cvt_pk_bf16_f32 v107, v142, v143
v_mfma_f32_16x16x32_bf16 v[224:227], a[68:71], a[140:143], v[224:227]
ds_read_b64_tr_b16 a[130:131], v18 offset:2048
v_cvt_pk_bf16_f32 v112, v144, v145
v_mfma_f32_16x16x32_bf16 v[228:231], a[72:75], a[136:139], v[228:231]
ds_read_b64_tr_b16 a[132:133], v18 offset:16384
v_cvt_pk_bf16_f32 v113, v146, v147
v_mfma_f32_16x16x32_bf16 v[228:231], a[76:79], a[140:143], v[228:231]
ds_read_b64_tr_b16 a[134:135], v18 offset:18432
v_cvt_pk_bf16_f32 v114, v148, v149
v_mfma_f32_16x16x32_bf16 v[232:235], a[80:83], a[136:139], v[232:235]
v_cvt_pk_bf16_f32 v115, v150, v151
v_cvt_pk_bf16_f32 v120, v152, v153
v_mfma_f32_16x16x32_bf16 v[232:235], a[84:87], a[140:143], v[232:235]
v_cvt_pk_bf16_f32 v121, v154, v155
v_cvt_pk_bf16_f32 v122, v156, v157
v_mfma_f32_16x16x32_bf16 v[236:239], a[88:91], a[136:139], v[236:239]
v_cvt_pk_bf16_f32 v123, v158, v159
v_cvt_pk_bf16_f32 v100, v160, v161
v_mfma_f32_16x16x32_bf16 v[236:239], a[92:95], a[140:143], v[236:239]
v_cvt_pk_bf16_f32 v101, v162, v163
v_cvt_pk_bf16_f32 v102, v164, v165
v_mfma_f32_16x16x32_bf16 v[240:243], a[96:99], a[136:139], v[240:243]
v_cvt_pk_bf16_f32 v103, v166, v167
v_mfma_f32_16x16x32_bf16 v[240:243], a[100:103], a[140:143], v[240:243]
s_add_u32 s61, s73, 4096
buffer_store_dwordx4 v[100:103], v2, s[12:15], s61 offen sc1
v_mfma_f32_16x16x32_bf16 v[244:247], a[104:107], a[136:139], v[244:247]
v_cvt_pk_bf16_f32 v108, v168, v169
v_cvt_pk_bf16_f32 v109, v170, v171
v_mfma_f32_16x16x32_bf16 v[244:247], a[108:111], a[140:143], v[244:247]
v_cvt_pk_bf16_f32 v110, v172, v173
v_cvt_pk_bf16_f32 v111, v174, v175
v_mfma_f32_16x16x32_bf16 v[248:251], a[112:115], a[136:139], v[248:251]
v_cvt_pk_bf16_f32 v116, v176, v177
v_cvt_pk_bf16_f32 v117, v178, v179
v_mfma_f32_16x16x32_bf16 v[248:251], a[116:119], a[140:143], v[248:251]
v_cvt_pk_bf16_f32 v118, v180, v181
v_cvt_pk_bf16_f32 v119, v182, v183
v_mfma_f32_16x16x32_bf16 v[252:255], a[120:123], a[136:139], v[252:255]
v_cvt_pk_bf16_f32 v124, v184, v185
v_cvt_pk_bf16_f32 v125, v186, v187
v_mfma_f32_16x16x32_bf16 v[252:255], a[124:127], a[140:143], v[252:255]
s_waitcnt lgkmcnt(0)
v_cvt_pk_bf16_f32 v126, v188, v189
v_mfma_f32_16x16x32_bf16 v[192:195], a[144:147], a[128:131], v[192:195]
ds_read_b64_tr_b16 a[136:137], v19 offset:0
v_cvt_pk_bf16_f32 v127, v190, v191
v_mfma_f32_16x16x32_bf16 v[192:195], a[148:151], a[132:135], v[192:195]
ds_read_b64_tr_b16 a[138:139], v19 offset:2048
v_mfma_f32_16x16x32_bf16 v[196:199], a[152:155], a[128:131], v[196:199]
ds_read_b64_tr_b16 a[140:141], v19 offset:16384
v_mfma_f32_16x16x32_bf16 v[196:199], a[156:159], a[132:135], v[196:199]
ds_read_b64_tr_b16 a[142:143], v19 offset:18432
v_mfma_f32_16x16x32_bf16 v[200:203], a[160:163], a[128:131], v[200:203]
v_mfma_f32_16x16x32_bf16 v[200:203], a[164:167], a[132:135], v[200:203]
v_mfma_f32_16x16x32_bf16 v[204:207], a[168:171], a[128:131], v[204:207]
v_mfma_f32_16x16x32_bf16 v[204:207], a[172:175], a[132:135], v[204:207]
v_mfma_f32_16x16x32_bf16 v[208:211], a[176:179], a[128:131], v[208:211]
v_cvt_pk_bf16_f32 v64, v192, v193
v_cvt_pk_bf16_f32 v65, v194, v195
v_mfma_f32_16x16x32_bf16 v[208:211], a[180:183], a[132:135], v[208:211]
v_cvt_pk_bf16_f32 v66, v196, v197
v_cvt_pk_bf16_f32 v67, v198, v199
v_mfma_f32_16x16x32_bf16 v[212:215], a[184:187], a[128:131], v[212:215]
v_mfma_f32_16x16x32_bf16 v[212:215], a[188:191], a[132:135], v[212:215]
v_mfma_f32_16x16x32_bf16 v[216:219], a[192:195], a[128:131], v[216:219]
v_cvt_pk_bf16_f32 v72, v200, v201
v_cvt_pk_bf16_f32 v73, v202, v203
v_mfma_f32_16x16x32_bf16 v[216:219], a[196:199], a[132:135], v[216:219]
v_cvt_pk_bf16_f32 v74, v204, v205
v_cvt_pk_bf16_f32 v75, v206, v207
v_mfma_f32_16x16x32_bf16 v[220:223], a[200:203], a[128:131], v[220:223]
v_mfma_f32_16x16x32_bf16 v[220:223], a[204:207], a[132:135], v[220:223]
s_barrier
s_waitcnt lgkmcnt(0)
v_mfma_f32_16x16x32_bf16 v[224:227], a[144:147], a[136:139], v[224:227]
v_cvt_pk_bf16_f32 v80, v208, v209
v_cvt_pk_bf16_f32 v81, v210, v211
v_mfma_f32_16x16x32_bf16 v[224:227], a[148:151], a[140:143], v[224:227]
v_cvt_pk_bf16_f32 v82, v212, v213
v_cvt_pk_bf16_f32 v83, v214, v215
v_mfma_f32_16x16x32_bf16 v[228:231], a[152:155], a[136:139], v[228:231]
ds_read_b64_tr_b16 a[64:65], v48 offset:0
v_mfma_f32_16x16x32_bf16 v[228:231], a[156:159], a[140:143], v[228:231]
ds_read_b64_tr_b16 a[66:67], v48 offset:2048
v_mfma_f32_16x16x32_bf16 v[232:235], a[160:163], a[136:139], v[232:235]
ds_read_b64_tr_b16 a[68:69], v48 offset:16384
v_cvt_pk_bf16_f32 v88, v216, v217
v_mfma_f32_16x16x32_bf16 v[232:235], a[164:167], a[140:143], v[232:235]
ds_read_b64_tr_b16 a[70:71], v48 offset:18432
v_cvt_pk_bf16_f32 v89, v218, v219
v_mfma_f32_16x16x32_bf16 v[236:239], a[168:171], a[136:139], v[236:239]
ds_read_b64_tr_b16 a[72:73], v49 offset:0
v_cvt_pk_bf16_f32 v90, v220, v221
v_mfma_f32_16x16x32_bf16 v[236:239], a[172:175], a[140:143], v[236:239]
ds_read_b64_tr_b16 a[74:75], v49 offset:2048
v_cvt_pk_bf16_f32 v91, v222, v223
v_mfma_f32_16x16x32_bf16 v[240:243], a[176:179], a[136:139], v[240:243]
ds_read_b64_tr_b16 a[76:77], v49 offset:16384
v_cvt_pk_bf16_f32 v68, v224, v225
v_mfma_f32_16x16x32_bf16 v[240:243], a[180:183], a[140:143], v[240:243]
ds_read_b64_tr_b16 a[78:79], v49 offset:18432
v_cvt_pk_bf16_f32 v69, v226, v227
v_mfma_f32_16x16x32_bf16 v[244:247], a[184:187], a[136:139], v[244:247]
ds_read_b64_tr_b16 a[80:81], v50 offset:0
v_cvt_pk_bf16_f32 v70, v228, v229
v_mfma_f32_16x16x32_bf16 v[244:247], a[188:191], a[140:143], v[244:247]
ds_read_b64_tr_b16 a[82:83], v50 offset:2048
v_cvt_pk_bf16_f32 v71, v230, v231
v_mfma_f32_16x16x32_bf16 v[248:251], a[192:195], a[136:139], v[248:251]
ds_read_b64_tr_b16 a[84:85], v50 offset:16384
v_cvt_pk_bf16_f32 v76, v232, v233
v_mfma_f32_16x16x32_bf16 v[248:251], a[196:199], a[140:143], v[248:251]
ds_read_b64_tr_b16 a[86:87], v50 offset:18432
v_cvt_pk_bf16_f32 v77, v234, v235
v_mfma_f32_16x16x32_bf16 v[252:255], a[200:203], a[136:139], v[252:255]
v_cvt_pk_bf16_f32 v78, v236, v237
v_cvt_pk_bf16_f32 v79, v238, v239
v_mfma_f32_16x16x32_bf16 v[252:255], a[204:207], a[140:143], v[252:255]
v_cvt_pk_bf16_f32 v84, v240, v241
v_cvt_pk_bf16_f32 v85, v242, v243
v_cvt_pk_bf16_f32 v86, v244, v245
v_cvt_pk_bf16_f32 v87, v246, v247
v_cvt_pk_bf16_f32 v92, v248, v249
v_cvt_pk_bf16_f32 v93, v250, v251
s_nop 1
v_cvt_pk_bf16_f32 v94, v252, v253
v_cvt_pk_bf16_f32 v95, v254, v255
s_add_u32 s72, s72, 2048
s_add_u32 s73, s73, 2048
s_add_u32 s74, s74, 2048
s_add_u32 s75, s75, 2048
s_add_u32 s76, s76, 2048
s_add_u32 s77, s77, 2048
s_add_u32 s78, s78, 2048
s_add_u32 s79, s79, 2048
v_add_u32 v22, 2048, v2
v_add_u32 v23, 4096, v2
s_nop 0
kv_att:
s_barrier
s_waitcnt lgkmcnt(8)
ds_read_b64_tr_b16 a[88:89], v51 offset:0
s_waitcnt vmcnt(6)
v_mfma_f32_16x16x32_bf16 v[128:131], a[64:67], a[208:211], 0
ds_read_b64_tr_b16 a[90:91], v51 offset:2048
buffer_store_dwordx4 v[64:67], v23, s[12:15], s72 offen sc1
v_mfma_f32_16x16x32_bf16 v[128:131], a[68:71], a[216:219], v[128:131]
ds_read_b64_tr_b16 a[92:93], v51 offset:16384
s_add_u32 m0, s37, 65536
buffer_store_dwordx4 v[68:71], v23, s[12:15], s73 offen sc1
v_mfma_f32_16x16x32_bf16 v[132:135], a[64:67], a[212:215], 0
ds_read_b64_tr_b16 a[94:95], v51 offset:18432
buffer_load_dwordx4 v8, s[16:19], s34 offen offset:0 lds
v_mfma_f32_16x16x32_bf16 v[132:135], a[68:71], a[220:223], v[132:135]
s_waitcnt lgkmcnt(8)
ds_read_b64_tr_b16 a[96:97], v52 offset:0
v_mov_b32 v14, s70
v_mfma_f32_16x16x32_bf16 v[136:139], a[72:75], a[208:211], 0
ds_read_b64_tr_b16 a[98:99], v52 offset:2048
v_mfma_f32_16x16x32_bf16 v[136:139], a[76:79], a[216:219], v[136:139]
ds_read_b64_tr_b16 a[100:101], v52 offset:16384
buffer_load_dwordx4 v9, s[16:19], s34 offen offset:1024 lds
v_mfma_f32_16x16x32_bf16 v[140:143], a[72:75], a[212:215], 0
ds_read_b64_tr_b16 a[102:103], v52 offset:18432
v_mfma_f32_16x16x32_bf16 v[140:143], a[76:79], a[220:223], v[140:143]
s_waitcnt lgkmcnt(8)
ds_read_b64_tr_b16 a[104:105], v53 offset:0
v_mfma_f32_16x16x32_bf16 v[144:147], a[80:83], a[208:211], 0
ds_read_b64_tr_b16 a[106:107], v53 offset:2048
buffer_load_dwordx4 v10, s[16:19], s34 offen offset:2048 lds
v_mfma_f32_16x16x32_bf16 v[144:147], a[84:87], a[216:219], v[144:147]
ds_read_b64_tr_b16 a[108:109], v53 offset:16384
v_mfma_f32_16x16x32_bf16 v[148:151], a[80:83], a[212:215], 0
ds_read_b64_tr_b16 a[110:111], v53 offset:18432
v_mfma_f32_16x16x32_bf16 v[148:151], a[84:87], a[220:223], v[148:151]
s_waitcnt lgkmcnt(8)
ds_read_b64_tr_b16 a[112:113], v54 offset:0
buffer_load_dwordx4 v11, s[16:19], s34 offen offset:3072 lds
s_add_u32 s34, s34, 524288
v_mfma_f32_16x16x32_bf16 v[152:155], a[88:91], a[208:211], 0
ds_read_b64_tr_b16 a[114:115], v54 offset:2048
v_mfma_f32_16x16x32_bf16 v[152:155], a[92:95], a[216:219], v[152:155]
ds_read_b64_tr_b16 a[116:117], v54 offset:16384
v_mfma_f32_16x16x32_bf16 v[156:159], a[88:91], a[212:215], 0
ds_read_b64_tr_b16 a[118:119], v54 offset:18432
s_add_u32 m0, s37, 73728
v_mfma_f32_16x16x32_bf16 v[156:159], a[92:95], a[220:223], v[156:159]
s_waitcnt lgkmcnt(8)
ds_read_b64_tr_b16 a[120:121], v55 offset:0
buffer_load_dwordx4 v8, s[16:19], s35 offen offset:0 lds
v_mfma_f32_16x16x32_bf16 v[160:163], a[96:99], a[208:211], 0
ds_read_b64_tr_b16 a[122:123], v55 offset:2048
buffer_store_dwordx4 v[104:107], v22, s[12:15], s74 offen sc1
v_mfma_f32_16x16x32_bf16 v[160:163], a[100:103], a[216:219], v[160:163]
ds_read_b64_tr_b16 a[124:125], v55 offset:16384
v_mfma_f32_16x16x32_bf16 v[164:167], a[96:99], a[212:215], 0
ds_read_b64_tr_b16 a[126:127], v55 offset:18432
buffer_load_dwordx4 v9, s[16:19], s35 offen offset:1024 lds
v_mfma_f32_16x16x32_bf16 v[164:167], a[100:103], a[220:223], v[164:167]
s_waitcnt lgkmcnt(8)
ds_read_b64_tr_b16 a[64:65], v48 offset:256
v_mfma_f32_16x16x32_bf16 v[168:171], a[104:107], a[208:211], 0
ds_read_b64_tr_b16 a[66:67], v48 offset:2304
v_mfma_f32_16x16x32_bf16 v[168:171], a[108:111], a[216:219], v[168:171]
ds_read_b64_tr_b16 a[68:69], v48 offset:16640
buffer_load_dwordx4 v10, s[16:19], s35 offen offset:2048 lds
v_mfma_f32_16x16x32_bf16 v[172:175], a[104:107], a[212:215], 0
ds_read_b64_tr_b16 a[70:71], v48 offset:18688
v_mfma_f32_16x16x32_bf16 v[172:175], a[108:111], a[220:223], v[172:175]
s_waitcnt lgkmcnt(8)
ds_read_b64_tr_b16 a[72:73], v49 offset:256
v_mfma_f32_16x16x32_bf16 v[176:179], a[112:115], a[208:211], 0
ds_read_b64_tr_b16 a[74:75], v49 offset:2304
buffer_load_dwordx4 v11, s[16:19], s35 offen offset:3072 lds
s_add_u32 s35, s35, 524288
v_mfma_f32_16x16x32_bf16 v[176:179], a[116:119], a[216:219], v[176:179]
ds_read_b64_tr_b16 a[76:77], v49 offset:16640
v_mfma_f32_16x16x32_bf16 v[180:183], a[112:115], a[212:215], 0
ds_read_b64_tr_b16 a[78:79], v49 offset:18688
v_mfma_f32_16x16x32_bf16 v[180:183], a[116:119], a[220:223], v[180:183]
s_waitcnt lgkmcnt(8)
ds_read_b64_tr_b16 a[80:81], v50 offset:256
v_mfma_f32_16x16x32_bf16 v[184:187], a[120:123], a[208:211], 0
ds_read_b64_tr_b16 a[82:83], v50 offset:2304
buffer_load_dwordx4 a[144:147], v3, s[12:15], s45 offen offset:0 sc1
v_mfma_f32_16x16x32_bf16 v[184:187], a[124:127], a[216:219], v[184:187]
ds_read_b64_tr_b16 a[84:85], v50 offset:16640
buffer_load_dwordx4 a[148:151], v3, s[12:15], s46 offen offset:0 sc1
v_mfma_f32_16x16x32_bf16 v[188:191], a[120:123], a[212:215], 0
ds_read_b64_tr_b16 a[86:87], v50 offset:18688
buffer_load_dwordx4 a[152:155], v3, s[12:15], s45 offen offset:1024 sc1
v_mfma_f32_16x16x32_bf16 v[188:191], a[124:127], a[220:223], v[188:191]
s_waitcnt lgkmcnt(8)
ds_read_b64_tr_b16 a[88:89], v51 offset:256
v_mfma_f32_16x16x32_bf16 v[192:195], a[64:67], a[208:211], 0
ds_read_b64_tr_b16 a[90:91], v51 offset:2304
buffer_load_dwordx4 a[156:159], v3, s[12:15], s46 offen offset:1024 sc1
buffer_store_dwordx4 v[108:111], v22, s[12:15], s75 offen sc1
v_mfma_f32_16x16x32_bf16 v[192:195], a[68:71], a[216:219], v[192:195]
ds_read_b64_tr_b16 a[92:93], v51 offset:16640
v_mfma_f32_16x16x32_bf16 v[196:199], a[64:67], a[212:215], 0
ds_read_b64_tr_b16 a[94:95], v51 offset:18688
v_mfma_f32_16x16x32_bf16 v[196:199], a[68:71], a[220:223], v[196:199]
s_waitcnt lgkmcnt(8)
ds_read_b64_tr_b16 a[96:97], v52 offset:256
v_mfma_f32_16x16x32_bf16 v[200:203], a[72:75], a[208:211], 0
ds_read_b64_tr_b16 a[98:99], v52 offset:2304
v_mfma_f32_16x16x32_bf16 v[200:203], a[76:79], a[216:219], v[200:203]
ds_read_b64_tr_b16 a[100:101], v52 offset:16640
v_mfma_f32_16x16x32_bf16 v[204:207], a[72:75], a[212:215], 0
ds_read_b64_tr_b16 a[102:103], v52 offset:18688
v_mfma_f32_16x16x32_bf16 v[204:207], a[76:79], a[220:223], v[204:207]
s_waitcnt lgkmcnt(8)
ds_read_b64_tr_b16 a[104:105], v53 offset:256
v_mfma_f32_16x16x32_bf16 v[208:211], a[80:83], a[208:211], 0
ds_read_b64_tr_b16 a[106:107], v53 offset:2304
v_mfma_f32_16x16x32_bf16 v[208:211], a[84:87], a[216:219], v[208:211]
ds_read_b64_tr_b16 a[108:109], v53 offset:16640
v_mfma_f32_16x16x32_bf16 v[212:215], a[80:83], a[212:215], 0
ds_read_b64_tr_b16 a[110:111], v53 offset:18688
v_mfma_f32_16x16x32_bf16 v[212:215], a[84:87], a[220:223], v[212:215]
s_waitcnt lgkmcnt(8)
ds_read_b64_tr_b16 a[112:113], v54 offset:256
v_mfma_f32_16x16x32_bf16 v[216:219], a[88:91], a[208:211], 0
ds_read_b64_tr_b16 a[114:115], v54 offset:2304
v_mfma_f32_16x16x32_bf16 v[216:219], a[92:95], a[216:219], v[216:219]
ds_read_b64_tr_b16 a[116:117], v54 offset:16640
v_mfma_f32_16x16x32_bf16 v[220:223], a[88:91], a[212:215], 0
ds_read_b64_tr_b16 a[118:119], v54 offset:18688
v_mfma_f32_16x16x32_bf16 v[220:223], a[92:95], a[220:223], v[220:223]
s_waitcnt lgkmcnt(8)
ds_read_b64_tr_b16 a[120:121], v55 offset:256
v_mfma_f32_16x16x32_bf16 v[224:227], a[96:99], a[208:211], 0
ds_read_b64_tr_b16 a[122:123], v55 offset:2304
buffer_store_dwordx4 v[112:115], v22, s[12:15], s76 offen sc1
v_mfma_f32_16x16x32_bf16 v[224:227], a[100:103], a[216:219], v[224:227]
ds_read_b64_tr_b16 a[124:125], v55 offset:16640
v_mfma_f32_16x16x32_bf16 v[228:231], a[96:99], a[212:215], 0
ds_read_b64_tr_b16 a[126:127], v55 offset:18688
v_mfma_f32_16x16x32_bf16 v[228:231], a[100:103], a[220:223], v[228:231]
s_waitcnt lgkmcnt(8)
ds_read_b64_tr_b16 a[64:65], v48 offset:32768
v_mfma_f32_16x16x32_bf16 v[232:235], a[104:107], a[208:211], 0
ds_read_b64_tr_b16 a[66:67], v48 offset:34816
v_mfma_f32_16x16x32_bf16 v[232:235], a[108:111], a[216:219], v[232:235]
ds_read_b64_tr_b16 a[68:69], v48 offset:49152
v_mfma_f32_16x16x32_bf16 v[236:239], a[104:107], a[212:215], 0
ds_read_b64_tr_b16 a[70:71], v48 offset:51200
v_mfma_f32_16x16x32_bf16 v[236:239], a[108:111], a[220:223], v[236:239]
s_waitcnt lgkmcnt(8)
ds_read_b64_tr_b16 a[72:73], v49 offset:32768
v_mfma_f32_16x16x32_bf16 v[240:243], a[112:115], a[208:211], 0
ds_read_b64_tr_b16 a[74:75], v49 offset:34816
v_mfma_f32_16x16x32_bf16 v[240:243], a[116:119], a[216:219], v[240:243]
ds_read_b64_tr_b16 a[76:77], v49 offset:49152
v_mfma_f32_16x16x32_bf16 v[244:247], a[112:115], a[212:215], 0
ds_read_b64_tr_b16 a[78:79], v49 offset:51200
v_mfma_f32_16x16x32_bf16 v[244:247], a[116:119], a[220:223], v[244:247]
s_waitcnt lgkmcnt(8)
ds_read_b64_tr_b16 a[80:81], v50 offset:32768
v_mfma_f32_16x16x32_bf16 v[248:251], a[120:123], a[208:211], 0
ds_read_b64_tr_b16 a[82:83], v50 offset:34816
v_mfma_f32_16x16x32_bf16 v[248:251], a[124:127], a[216:219], v[248:251]
ds_read_b64_tr_b16 a[84:85], v50 offset:49152
v_mfma_f32_16x16x32_bf16 v[252:255], a[120:123], a[212:215], 0
ds_read_b64_tr_b16 a[86:87], v50 offset:51200
v_mfma_f32_16x16x32_bf16 v[252:255], a[124:127], a[220:223], v[252:255]
s_waitcnt vmcnt(15)
s_barrier
s_waitcnt lgkmcnt(8)
ds_read_b64_tr_b16 a[88:89], v51 offset:32768
v_mfma_f32_16x16x32_bf16 v[128:131], a[64:67], a[224:227], v[128:131]
ds_read_b64_tr_b16 a[90:91], v51 offset:34816
v_mfma_f32_16x16x32_bf16 v[128:131], a[68:71], a[232:235], v[128:131]
ds_read_b64_tr_b16 a[92:93], v51 offset:49152
s_add_u32 m0, s37, 98304
buffer_atomic_or v14, v20, s[12:15], s69 offen sc1
v_mfma_f32_16x16x32_bf16 v[132:135], a[64:67], a[228:231], v[132:135]
ds_read_b64_tr_b16 a[94:95], v51 offset:51200
buffer_load_dwordx4 v8, s[16:19], s34 offen offset:0 lds
v_mfma_f32_16x16x32_bf16 v[132:135], a[68:71], a[236:239], v[132:135]
s_waitcnt lgkmcnt(8)
ds_read_b64_tr_b16 a[96:97], v52 offset:32768
v_mfma_f32_16x16x32_bf16 v[136:139], a[72:75], a[224:227], v[136:139]
ds_read_b64_tr_b16 a[98:99], v52 offset:34816
v_mfma_f32_16x16x32_bf16 v[136:139], a[76:79], a[232:235], v[136:139]
ds_read_b64_tr_b16 a[100:101], v52 offset:49152
buffer_load_dwordx4 v9, s[16:19], s34 offen offset:1024 lds
v_mfma_f32_16x16x32_bf16 v[140:143], a[72:75], a[228:231], v[140:143]
ds_read_b64_tr_b16 a[102:103], v52 offset:51200
v_mfma_f32_16x16x32_bf16 v[140:143], a[76:79], a[236:239], v[140:143]
s_waitcnt lgkmcnt(8)
ds_read_b64_tr_b16 a[104:105], v53 offset:32768
v_mfma_f32_16x16x32_bf16 v[144:147], a[80:83], a[224:227], v[144:147]
ds_read_b64_tr_b16 a[106:107], v53 offset:34816
buffer_load_dwordx4 v10, s[16:19], s34 offen offset:2048 lds
v_mfma_f32_16x16x32_bf16 v[144:147], a[84:87], a[232:235], v[144:147]
ds_read_b64_tr_b16 a[108:109], v53 offset:49152
v_mfma_f32_16x16x32_bf16 v[148:151], a[80:83], a[228:231], v[148:151]
ds_read_b64_tr_b16 a[110:111], v53 offset:51200
v_mfma_f32_16x16x32_bf16 v[148:151], a[84:87], a[236:239], v[148:151]
s_waitcnt lgkmcnt(8)
ds_read_b64_tr_b16 a[112:113], v54 offset:32768
buffer_load_dwordx4 v11, s[16:19], s34 offen offset:3072 lds
s_add_u32 s34, s34, 524288
v_mfma_f32_16x16x32_bf16 v[152:155], a[88:91], a[224:227], v[152:155]
ds_read_b64_tr_b16 a[114:115], v54 offset:34816
v_mfma_f32_16x16x32_bf16 v[152:155], a[92:95], a[232:235], v[152:155]
ds_read_b64_tr_b16 a[116:117], v54 offset:49152
v_mfma_f32_16x16x32_bf16 v[156:159], a[88:91], a[228:231], v[156:159]
ds_read_b64_tr_b16 a[118:119], v54 offset:51200
s_add_u32 m0, s37, 106496
v_mfma_f32_16x16x32_bf16 v[156:159], a[92:95], a[236:239], v[156:159]
s_waitcnt lgkmcnt(8)
ds_read_b64_tr_b16 a[120:121], v55 offset:32768
buffer_load_dwordx4 v8, s[16:19], s35 offen offset:0 lds
v_mfma_f32_16x16x32_bf16 v[160:163], a[96:99], a[224:227], v[160:163]
ds_read_b64_tr_b16 a[122:123], v55 offset:34816
buffer_store_dwordx4 v[116:119], v22, s[12:15], s77 offen sc1
v_mfma_f32_16x16x32_bf16 v[160:163], a[100:103], a[232:235], v[160:163]
ds_read_b64_tr_b16 a[124:125], v55 offset:49152
v_mfma_f32_16x16x32_bf16 v[164:167], a[96:99], a[228:231], v[164:167]
ds_read_b64_tr_b16 a[126:127], v55 offset:51200
buffer_load_dwordx4 v9, s[16:19], s35 offen offset:1024 lds
v_mfma_f32_16x16x32_bf16 v[164:167], a[100:103], a[236:239], v[164:167]
s_waitcnt lgkmcnt(8)
ds_read_b64_tr_b16 a[64:65], v48 offset:33024
v_mfma_f32_16x16x32_bf16 v[168:171], a[104:107], a[224:227], v[168:171]
ds_read_b64_tr_b16 a[66:67], v48 offset:35072
v_mfma_f32_16x16x32_bf16 v[168:171], a[108:111], a[232:235], v[168:171]
ds_read_b64_tr_b16 a[68:69], v48 offset:49408
buffer_load_dwordx4 v10, s[16:19], s35 offen offset:2048 lds
v_mfma_f32_16x16x32_bf16 v[172:175], a[104:107], a[228:231], v[172:175]
ds_read_b64_tr_b16 a[70:71], v48 offset:51456
v_mfma_f32_16x16x32_bf16 v[172:175], a[108:111], a[236:239], v[172:175]
s_waitcnt lgkmcnt(8)
ds_read_b64_tr_b16 a[72:73], v49 offset:33024
v_mfma_f32_16x16x32_bf16 v[176:179], a[112:115], a[224:227], v[176:179]
ds_read_b64_tr_b16 a[74:75], v49 offset:35072
buffer_load_dwordx4 v11, s[16:19], s35 offen offset:3072 lds
s_add_u32 s35, s35, 524288
v_mfma_f32_16x16x32_bf16 v[176:179], a[116:119], a[232:235], v[176:179]
ds_read_b64_tr_b16 a[76:77], v49 offset:49408
v_mfma_f32_16x16x32_bf16 v[180:183], a[112:115], a[228:231], v[180:183]
ds_read_b64_tr_b16 a[78:79], v49 offset:51456
v_mfma_f32_16x16x32_bf16 v[180:183], a[116:119], a[236:239], v[180:183]
s_waitcnt lgkmcnt(8)
ds_read_b64_tr_b16 a[80:81], v50 offset:33024
v_mfma_f32_16x16x32_bf16 v[184:187], a[120:123], a[224:227], v[184:187]
ds_read_b64_tr_b16 a[82:83], v50 offset:35072
buffer_load_dwordx4 a[160:163], v3, s[12:15], s45 offen offset:2048 sc1
v_mfma_f32_16x16x32_bf16 v[184:187], a[124:127], a[232:235], v[184:187]
ds_read_b64_tr_b16 a[84:85], v50 offset:49408
buffer_load_dwordx4 a[164:167], v3, s[12:15], s46 offen offset:2048 sc1
v_mfma_f32_16x16x32_bf16 v[188:191], a[120:123], a[228:231], v[188:191]
ds_read_b64_tr_b16 a[86:87], v50 offset:51456
buffer_load_dwordx4 a[168:171], v3, s[12:15], s45 offen offset:3072 sc1
v_mfma_f32_16x16x32_bf16 v[188:191], a[124:127], a[236:239], v[188:191]
s_waitcnt lgkmcnt(8)
ds_read_b64_tr_b16 a[88:89], v51 offset:33024
v_mfma_f32_16x16x32_bf16 v[192:195], a[64:67], a[224:227], v[192:195]
ds_read_b64_tr_b16 a[90:91], v51 offset:35072
buffer_load_dwordx4 a[172:175], v3, s[12:15], s46 offen offset:3072 sc1
buffer_store_dwordx4 v[120:123], v22, s[12:15], s78 offen sc1
v_mfma_f32_16x16x32_bf16 v[192:195], a[68:71], a[232:235], v[192:195]
ds_read_b64_tr_b16 a[92:93], v51 offset:49408
v_mfma_f32_16x16x32_bf16 v[196:199], a[64:67], a[228:231], v[196:199]
ds_read_b64_tr_b16 a[94:95], v51 offset:51456
v_mfma_f32_16x16x32_bf16 v[196:199], a[68:71], a[236:239], v[196:199]
s_waitcnt lgkmcnt(8)
ds_read_b64_tr_b16 a[96:97], v52 offset:33024
v_mfma_f32_16x16x32_bf16 v[200:203], a[72:75], a[224:227], v[200:203]
ds_read_b64_tr_b16 a[98:99], v52 offset:35072
v_mfma_f32_16x16x32_bf16 v[200:203], a[76:79], a[232:235], v[200:203]
ds_read_b64_tr_b16 a[100:101], v52 offset:49408
v_mfma_f32_16x16x32_bf16 v[204:207], a[72:75], a[228:231], v[204:207]
ds_read_b64_tr_b16 a[102:103], v52 offset:51456
v_mfma_f32_16x16x32_bf16 v[204:207], a[76:79], a[236:239], v[204:207]
s_waitcnt lgkmcnt(8)
ds_read_b64_tr_b16 a[104:105], v53 offset:33024
v_mfma_f32_16x16x32_bf16 v[208:211], a[80:83], a[224:227], v[208:211]
ds_read_b64_tr_b16 a[106:107], v53 offset:35072
v_mfma_f32_16x16x32_bf16 v[208:211], a[84:87], a[232:235], v[208:211]
ds_read_b64_tr_b16 a[108:109], v53 offset:49408
v_mfma_f32_16x16x32_bf16 v[212:215], a[80:83], a[228:231], v[212:215]
ds_read_b64_tr_b16 a[110:111], v53 offset:51456
v_mfma_f32_16x16x32_bf16 v[212:215], a[84:87], a[236:239], v[212:215]
s_waitcnt lgkmcnt(8)
ds_read_b64_tr_b16 a[112:113], v54 offset:33024
v_mfma_f32_16x16x32_bf16 v[216:219], a[88:91], a[224:227], v[216:219]
ds_read_b64_tr_b16 a[114:115], v54 offset:35072
v_mfma_f32_16x16x32_bf16 v[216:219], a[92:95], a[232:235], v[216:219]
ds_read_b64_tr_b16 a[116:117], v54 offset:49408
v_mfma_f32_16x16x32_bf16 v[220:223], a[88:91], a[228:231], v[220:223]
ds_read_b64_tr_b16 a[118:119], v54 offset:51456
v_mfma_f32_16x16x32_bf16 v[220:223], a[92:95], a[236:239], v[220:223]
s_waitcnt lgkmcnt(8)
ds_read_b64_tr_b16 a[120:121], v55 offset:33024
v_mfma_f32_16x16x32_bf16 v[224:227], a[96:99], a[224:227], v[224:227]
ds_read_b64_tr_b16 a[122:123], v55 offset:35072
buffer_store_dwordx4 v[124:127], v22, s[12:15], s79 offen sc1
v_mfma_f32_16x16x32_bf16 v[224:227], a[100:103], a[232:235], v[224:227]
ds_read_b64_tr_b16 a[124:125], v55 offset:49408
v_mfma_f32_16x16x32_bf16 v[228:231], a[96:99], a[228:231], v[228:231]
ds_read_b64_tr_b16 a[126:127], v55 offset:51456
v_mfma_f32_16x16x32_bf16 v[228:231], a[100:103], a[236:239], v[228:231]
s_waitcnt lgkmcnt(8)
ds_read_b64_tr_b16 a[64:65], v40 offset:0
v_mfma_f32_16x16x32_bf16 v[232:235], a[104:107], a[224:227], v[232:235]
ds_read_b64_tr_b16 a[66:67], v40 offset:2048
v_mfma_f32_16x16x32_bf16 v[232:235], a[108:111], a[232:235], v[232:235]
ds_read_b64_tr_b16 a[68:69], v40 offset:16384
v_mfma_f32_16x16x32_bf16 v[236:239], a[104:107], a[228:231], v[236:239]
ds_read_b64_tr_b16 a[70:71], v40 offset:18432
v_mfma_f32_16x16x32_bf16 v[236:239], a[108:111], a[236:239], v[236:239]
s_waitcnt lgkmcnt(8)
ds_read_b64_tr_b16 a[72:73], v41 offset:0
v_mfma_f32_16x16x32_bf16 v[240:243], a[112:115], a[224:227], v[240:243]
ds_read_b64_tr_b16 a[74:75], v41 offset:2048
v_mfma_f32_16x16x32_bf16 v[240:243], a[116:119], a[232:235], v[240:243]
ds_read_b64_tr_b16 a[76:77], v41 offset:16384
v_mfma_f32_16x16x32_bf16 v[244:247], a[112:115], a[228:231], v[244:247]
ds_read_b64_tr_b16 a[78:79], v41 offset:18432
v_mfma_f32_16x16x32_bf16 v[244:247], a[116:119], a[236:239], v[244:247]
s_waitcnt lgkmcnt(8)
ds_read_b64_tr_b16 a[80:81], v42 offset:0
v_mfma_f32_16x16x32_bf16 v[248:251], a[120:123], a[224:227], v[248:251]
ds_read_b64_tr_b16 a[82:83], v42 offset:2048
v_mfma_f32_16x16x32_bf16 v[248:251], a[124:127], a[232:235], v[248:251]
ds_read_b64_tr_b16 a[84:85], v42 offset:16384
v_mfma_f32_16x16x32_bf16 v[252:255], a[120:123], a[228:231], v[252:255]
ds_read_b64_tr_b16 a[86:87], v42 offset:18432
v_mfma_f32_16x16x32_bf16 v[252:255], a[124:127], a[236:239], v[252:255]
s_waitcnt vmcnt(22)
s_barrier
s_waitcnt lgkmcnt(8)
ds_read_b64_tr_b16 a[88:89], v43 offset:0
s_waitcnt vmcnt(18)
v_mfma_f32_16x16x32_bf16 v[128:131], a[64:67], a[144:147], v[128:131]
ds_read_b64_tr_b16 a[90:91], v43 offset:2048
v_lshrrev_b32 v28, 3, v1
v_mfma_f32_16x16x32_bf16 v[128:131], a[68:71], a[152:155], v[128:131]
ds_read_b64_tr_b16 a[92:93], v43 offset:16384
s_add_u32 m0, s37, 131072
v_mfma_f32_16x16x32_bf16 v[132:135], a[64:67], a[148:151], v[132:135]
ds_read_b64_tr_b16 a[94:95], v43 offset:18432
buffer_load_dwordx4 v8, s[16:19], s34 offen offset:0 lds
v_mfma_f32_16x16x32_bf16 v[132:135], a[68:71], a[156:159], v[132:135]
s_waitcnt lgkmcnt(8)
ds_read_b64_tr_b16 a[96:97], v44 offset:0
v_mfma_f32_16x16x32_bf16 v[136:139], a[72:75], a[144:147], v[136:139]
ds_read_b64_tr_b16 a[98:99], v44 offset:2048
v_bfe_u32 v29, v1, 1, 2
v_mfma_f32_16x16x32_bf16 v[136:139], a[76:79], a[152:155], v[136:139]
ds_read_b64_tr_b16 a[100:101], v44 offset:16384
buffer_load_dwordx4 v9, s[16:19], s34 offen offset:1024 lds
v_mfma_f32_16x16x32_bf16 v[140:143], a[72:75], a[148:151], v[140:143]
ds_read_b64_tr_b16 a[102:103], v44 offset:18432
v_bfe_u32 v30, v1, 4, 2
v_mfma_f32_16x16x32_bf16 v[140:143], a[76:79], a[156:159], v[140:143]
s_waitcnt lgkmcnt(8)
ds_read_b64_tr_b16 a[104:105], v45 offset:0
v_mfma_f32_16x16x32_bf16 v[144:147], a[80:83], a[144:147], v[144:147]
ds_read_b64_tr_b16 a[106:107], v45 offset:2048
buffer_load_dwordx4 v10, s[16:19], s34 offen offset:2048 lds
v_mfma_f32_16x16x32_bf16 v[144:147], a[84:87], a[152:155], v[144:147]
ds_read_b64_tr_b16 a[108:109], v45 offset:16384
v_xor_b32 v29, v29, v30
v_mfma_f32_16x16x32_bf16 v[148:151], a[80:83], a[148:151], v[148:151]
ds_read_b64_tr_b16 a[110:111], v45 offset:18432
v_and_b32 v30, 1, v1
v_mfma_f32_16x16x32_bf16 v[148:151], a[84:87], a[156:159], v[148:151]
s_waitcnt lgkmcnt(8)
ds_read_b64_tr_b16 a[112:113], v46 offset:0
buffer_load_dwordx4 v11, s[16:19], s34 offen offset:3072 lds
s_add_u32 s34, s34, 524288
v_mfma_f32_16x16x32_bf16 v[152:155], a[88:91], a[144:147], v[152:155]
ds_read_b64_tr_b16 a[114:115], v46 offset:2048
v_lshlrev_b32 v30, 4, v30
v_mfma_f32_16x16x32_bf16 v[152:155], a[92:95], a[152:155], v[152:155]
ds_read_b64_tr_b16 a[116:117], v46 offset:16384
v_lshl_add_u32 v29, v29, 5, v30
v_mfma_f32_16x16x32_bf16 v[156:159], a[88:91], a[148:151], v[156:159]
ds_read_b64_tr_b16 a[118:119], v46 offset:18432
s_add_u32 m0, s37, 139264
v_mfma_f32_16x16x32_bf16 v[156:159], a[92:95], a[156:159], v[156:159]
s_waitcnt lgkmcnt(8)
ds_read_b64_tr_b16 a[120:121], v47 offset:0
buffer_load_dwordx4 v8, s[16:19], s35 offen offset:0 lds
v_mfma_f32_16x16x32_bf16 v[160:163], a[96:99], a[144:147], v[160:163]
ds_read_b64_tr_b16 a[122:123], v47 offset:2048
buffer_store_dwordx4 a[8:11], v2, s[12:15], s74 offen sc1
v_mfma_f32_16x16x32_bf16 v[160:163], a[100:103], a[152:155], v[160:163]
ds_read_b64_tr_b16 a[124:125], v47 offset:16384
v_mul_u32_u24 v28, 896, v28
v_mfma_f32_16x16x32_bf16 v[164:167], a[96:99], a[148:151], v[164:167]
ds_read_b64_tr_b16 a[126:127], v47 offset:18432
buffer_load_dwordx4 v9, s[16:19], s35 offen offset:1024 lds
v_mfma_f32_16x16x32_bf16 v[164:167], a[100:103], a[156:159], v[164:167]
s_waitcnt lgkmcnt(8)
ds_read_b64_tr_b16 a[64:65], v40 offset:256
v_mfma_f32_16x16x32_bf16 v[168:171], a[104:107], a[144:147], v[168:171]
ds_read_b64_tr_b16 a[66:67], v40 offset:2304
v_add_u32 v16, v28, v29
v_mfma_f32_16x16x32_bf16 v[168:171], a[108:111], a[152:155], v[168:171]
ds_read_b64_tr_b16 a[68:69], v40 offset:16640
buffer_load_dwordx4 v10, s[16:19], s35 offen offset:2048 lds
v_mfma_f32_16x16x32_bf16 v[172:175], a[104:107], a[148:151], v[172:175]
ds_read_b64_tr_b16 a[70:71], v40 offset:18688
v_add_u32 v17, 6144, v16
v_mfma_f32_16x16x32_bf16 v[172:175], a[108:111], a[156:159], v[172:175]
s_waitcnt lgkmcnt(8)
ds_read_b64_tr_b16 a[72:73], v41 offset:256
v_mfma_f32_16x16x32_bf16 v[176:179], a[112:115], a[144:147], v[176:179]
ds_read_b64_tr_b16 a[74:75], v41 offset:2304
buffer_load_dwordx4 v11, s[16:19], s35 offen offset:3072 lds
s_add_u32 s35, s35, 524288
v_mfma_f32_16x16x32_bf16 v[176:179], a[116:119], a[152:155], v[176:179]
ds_read_b64_tr_b16 a[76:77], v41 offset:16640
v_add_u32 v18, 12288, v16
v_mfma_f32_16x16x32_bf16 v[180:183], a[112:115], a[148:151], v[180:183]
ds_read_b64_tr_b16 a[78:79], v41 offset:18688
v_add_u32 v19, 18432, v16
v_mfma_f32_16x16x32_bf16 v[180:183], a[116:119], a[156:159], v[180:183]
s_waitcnt lgkmcnt(8)
ds_read_b64_tr_b16 a[80:81], v42 offset:256
v_mfma_f32_16x16x32_bf16 v[184:187], a[120:123], a[144:147], v[184:187]
ds_read_b64_tr_b16 a[82:83], v42 offset:2304
buffer_load_dwordx4 a[208:211], v3, s[12:15], s47 offen offset:0 sc1
v_mfma_f32_16x16x32_bf16 v[184:187], a[124:127], a[152:155], v[184:187]
ds_read_b64_tr_b16 a[84:85], v42 offset:16640
buffer_load_dwordx4 a[212:215], v3, s[12:15], s48 offen offset:0 sc1
v_mfma_f32_16x16x32_bf16 v[188:191], a[120:123], a[148:151], v[188:191]
ds_read_b64_tr_b16 a[86:87], v42 offset:18688
buffer_load_dwordx4 a[216:219], v3, s[12:15], s47 offen offset:1024 sc1
v_mfma_f32_16x16x32_bf16 v[188:191], a[124:127], a[156:159], v[188:191]
s_waitcnt lgkmcnt(8)
ds_read_b64_tr_b16 a[88:89], v43 offset:256
v_mfma_f32_16x16x32_bf16 v[192:195], a[64:67], a[144:147], v[192:195]
ds_read_b64_tr_b16 a[90:91], v43 offset:2304
buffer_load_dwordx4 a[220:223], v3, s[12:15], s48 offen offset:1024 sc1
buffer_store_dwordx4 a[12:15], v2, s[12:15], s75 offen sc1
v_mfma_f32_16x16x32_bf16 v[192:195], a[68:71], a[152:155], v[192:195]
ds_read_b64_tr_b16 a[92:93], v43 offset:16640
v_lshrrev_b32 v28, 2, v1
v_mfma_f32_16x16x32_bf16 v[196:199], a[64:67], a[148:151], v[196:199]
ds_read_b64_tr_b16 a[94:95], v43 offset:18688
v_bfe_u32 v29, v1, 3, 2
v_mfma_f32_16x16x32_bf16 v[196:199], a[68:71], a[156:159], v[196:199]
s_waitcnt lgkmcnt(8)
ds_read_b64_tr_b16 a[96:97], v44 offset:256
v_mfma_f32_16x16x32_bf16 v[200:203], a[72:75], a[144:147], v[200:203]
ds_read_b64_tr_b16 a[98:99], v44 offset:2304
v_and_b32 v30, 3, v1
v_mfma_f32_16x16x32_bf16 v[200:203], a[76:79], a[152:155], v[200:203]
ds_read_b64_tr_b16 a[100:101], v44 offset:16640
v_lshlrev_b32 v30, 3, v30
v_mfma_f32_16x16x32_bf16 v[204:207], a[72:75], a[148:151], v[204:207]
ds_read_b64_tr_b16 a[102:103], v44 offset:18688
v_lshl_add_u32 v28, v28, 7, v30
v_mfma_f32_16x16x32_bf16 v[204:207], a[76:79], a[156:159], v[204:207]
s_waitcnt lgkmcnt(8)
ds_read_b64_tr_b16 a[104:105], v45 offset:256
v_mfma_f32_16x16x32_bf16 v[208:211], a[80:83], a[144:147], v[208:211]
ds_read_b64_tr_b16 a[106:107], v45 offset:2304
v_lshl_add_u32 v21, v29, 5, v28
v_mfma_f32_16x16x32_bf16 v[208:211], a[84:87], a[152:155], v[208:211]
ds_read_b64_tr_b16 a[108:109], v45 offset:16640
v_mfma_f32_16x16x32_bf16 v[212:215], a[80:83], a[148:151], v[212:215]
ds_read_b64_tr_b16 a[110:111], v45 offset:18688
v_mfma_f32_16x16x32_bf16 v[212:215], a[84:87], a[156:159], v[212:215]
s_waitcnt lgkmcnt(8)
ds_read_b64_tr_b16 a[112:113], v46 offset:256
v_mfma_f32_16x16x32_bf16 v[216:219], a[88:91], a[144:147], v[216:219]
ds_read_b64_tr_b16 a[114:115], v46 offset:2304
v_mfma_f32_16x16x32_bf16 v[216:219], a[92:95], a[152:155], v[216:219]
ds_read_b64_tr_b16 a[116:117], v46 offset:16640
v_mfma_f32_16x16x32_bf16 v[220:223], a[88:91], a[148:151], v[220:223]
ds_read_b64_tr_b16 a[118:119], v46 offset:18688
v_mfma_f32_16x16x32_bf16 v[220:223], a[92:95], a[156:159], v[220:223]
s_waitcnt lgkmcnt(8)
ds_read_b64_tr_b16 a[120:121], v47 offset:256
v_mfma_f32_16x16x32_bf16 v[224:227], a[96:99], a[144:147], v[224:227]
ds_read_b64_tr_b16 a[122:123], v47 offset:2304
buffer_store_dwordx4 a[16:19], v2, s[12:15], s76 offen sc1
v_mfma_f32_16x16x32_bf16 v[224:227], a[100:103], a[152:155], v[224:227]
ds_read_b64_tr_b16 a[124:125], v47 offset:16640
v_mfma_f32_16x16x32_bf16 v[228:231], a[96:99], a[148:151], v[228:231]
ds_read_b64_tr_b16 a[126:127], v47 offset:18688
v_mfma_f32_16x16x32_bf16 v[228:231], a[100:103], a[156:159], v[228:231]
s_waitcnt lgkmcnt(8)
ds_read_b64_tr_b16 a[64:65], v40 offset:32768
v_mfma_f32_16x16x32_bf16 v[232:235], a[104:107], a[144:147], v[232:235]
ds_read_b64_tr_b16 a[66:67], v40 offset:34816
v_mfma_f32_16x16x32_bf16 v[232:235], a[108:111], a[152:155], v[232:235]
ds_read_b64_tr_b16 a[68:69], v40 offset:49152
v_mfma_f32_16x16x32_bf16 v[236:239], a[104:107], a[148:151], v[236:239]
ds_read_b64_tr_b16 a[70:71], v40 offset:51200
v_mfma_f32_16x16x32_bf16 v[236:239], a[108:111], a[156:159], v[236:239]
s_waitcnt lgkmcnt(8)
ds_read_b64_tr_b16 a[72:73], v41 offset:32768
v_mfma_f32_16x16x32_bf16 v[240:243], a[112:115], a[144:147], v[240:243]
ds_read_b64_tr_b16 a[74:75], v41 offset:34816
v_mfma_f32_16x16x32_bf16 v[240:243], a[116:119], a[152:155], v[240:243]
ds_read_b64_tr_b16 a[76:77], v41 offset:49152
v_mfma_f32_16x16x32_bf16 v[244:247], a[112:115], a[148:151], v[244:247]
ds_read_b64_tr_b16 a[78:79], v41 offset:51200
v_mfma_f32_16x16x32_bf16 v[244:247], a[116:119], a[156:159], v[244:247]
s_waitcnt lgkmcnt(8)
ds_read_b64_tr_b16 a[80:81], v42 offset:32768
v_mfma_f32_16x16x32_bf16 v[248:251], a[120:123], a[144:147], v[248:251]
ds_read_b64_tr_b16 a[82:83], v42 offset:34816
v_mfma_f32_16x16x32_bf16 v[248:251], a[124:127], a[152:155], v[248:251]
ds_read_b64_tr_b16 a[84:85], v42 offset:49152
v_mfma_f32_16x16x32_bf16 v[252:255], a[120:123], a[148:151], v[252:255]
ds_read_b64_tr_b16 a[86:87], v42 offset:51200
v_mfma_f32_16x16x32_bf16 v[252:255], a[124:127], a[156:159], v[252:255]
s_waitcnt vmcnt(21)
s_barrier
s_waitcnt lgkmcnt(8)
ds_read_b64_tr_b16 a[88:89], v43 offset:32768
s_waitcnt vmcnt(17)
v_mfma_f32_16x16x32_bf16 v[128:131], a[64:67], a[160:163], v[128:131]
ds_read_b64_tr_b16 a[90:91], v43 offset:34816
v_mfma_f32_16x16x32_bf16 v[128:131], a[68:71], a[168:171], v[128:131]
ds_read_b64_tr_b16 a[92:93], v43 offset:49152
s_add_u32 m0, s37, 32768
v_mfma_f32_16x16x32_bf16 v[132:135], a[64:67], a[164:167], v[132:135]
ds_read_b64_tr_b16 a[94:95], v43 offset:51200
buffer_load_dwordx4 v8, s[16:19], s34 offen offset:0 lds
v_mfma_f32_16x16x32_bf16 v[132:135], a[68:71], a[172:175], v[132:135]
s_waitcnt lgkmcnt(8)
ds_read_b64_tr_b16 a[96:97], v44 offset:32768
v_mfma_f32_16x16x32_bf16 v[136:139], a[72:75], a[160:163], v[136:139]
ds_read_b64_tr_b16 a[98:99], v44 offset:34816
v_mfma_f32_16x16x32_bf16 v[136:139], a[76:79], a[168:171], v[136:139]
ds_read_b64_tr_b16 a[100:101], v44 offset:49152
buffer_load_dwordx4 v9, s[16:19], s34 offen offset:1024 lds
v_mfma_f32_16x16x32_bf16 v[140:143], a[72:75], a[164:167], v[140:143]
ds_read_b64_tr_b16 a[102:103], v44 offset:51200
v_mfma_f32_16x16x32_bf16 v[140:143], a[76:79], a[172:175], v[140:143]
s_waitcnt lgkmcnt(8)
ds_read_b64_tr_b16 a[104:105], v45 offset:32768
v_mov_b32 v6, 0
buffer_atomic_or v6, v20, s[12:15], s69 offen sc0 sc1
v_mfma_f32_16x16x32_bf16 v[144:147], a[80:83], a[160:163], v[144:147]
ds_read_b64_tr_b16 a[106:107], v45 offset:34816
buffer_load_dwordx4 v10, s[16:19], s34 offen offset:2048 lds
v_mfma_f32_16x16x32_bf16 v[144:147], a[84:87], a[168:171], v[144:147]
ds_read_b64_tr_b16 a[108:109], v45 offset:49152
v_mfma_f32_16x16x32_bf16 v[148:151], a[80:83], a[164:167], v[148:151]
ds_read_b64_tr_b16 a[110:111], v45 offset:51200
v_mfma_f32_16x16x32_bf16 v[148:151], a[84:87], a[172:175], v[148:151]
s_waitcnt lgkmcnt(8)
ds_read_b64_tr_b16 a[112:113], v46 offset:32768
buffer_load_dwordx4 v11, s[16:19], s34 offen offset:3072 lds
s_add_u32 s34, s34, 524288
v_mfma_f32_16x16x32_bf16 v[152:155], a[88:91], a[160:163], v[152:155]
ds_read_b64_tr_b16 a[114:115], v46 offset:34816
v_mfma_f32_16x16x32_bf16 v[152:155], a[92:95], a[168:171], v[152:155]
ds_read_b64_tr_b16 a[116:117], v46 offset:49152
v_mfma_f32_16x16x32_bf16 v[156:159], a[88:91], a[164:167], v[156:159]
ds_read_b64_tr_b16 a[118:119], v46 offset:51200
s_add_u32 m0, s37, 40960
v_mfma_f32_16x16x32_bf16 v[156:159], a[92:95], a[172:175], v[156:159]
s_waitcnt lgkmcnt(8)
ds_read_b64_tr_b16 a[120:121], v47 offset:32768
buffer_load_dwordx4 v8, s[16:19], s35 offen offset:0 lds
v_mfma_f32_16x16x32_bf16 v[160:163], a[96:99], a[160:163], v[160:163]
ds_read_b64_tr_b16 a[122:123], v47 offset:34816
buffer_store_dwordx4 a[20:23], v2, s[12:15], s77 offen sc1
v_mfma_f32_16x16x32_bf16 v[160:163], a[100:103], a[168:171], v[160:163]
ds_read_b64_tr_b16 a[124:125], v47 offset:49152
v_mfma_f32_16x16x32_bf16 v[164:167], a[96:99], a[164:167], v[164:167]
ds_read_b64_tr_b16 a[126:127], v47 offset:51200
buffer_load_dwordx4 v9, s[16:19], s35 offen offset:1024 lds
v_mfma_f32_16x16x32_bf16 v[164:167], a[100:103], a[172:175], v[164:167]
s_waitcnt lgkmcnt(8)
ds_read_b64_tr_b16 a[64:65], v40 offset:33024
v_mfma_f32_16x16x32_bf16 v[168:171], a[104:107], a[160:163], v[168:171]
ds_read_b64_tr_b16 a[66:67], v40 offset:35072
v_mfma_f32_16x16x32_bf16 v[168:171], a[108:111], a[168:171], v[168:171]
ds_read_b64_tr_b16 a[68:69], v40 offset:49408
buffer_load_dwordx4 v10, s[16:19], s35 offen offset:2048 lds
v_mfma_f32_16x16x32_bf16 v[172:175], a[104:107], a[164:167], v[172:175]
ds_read_b64_tr_b16 a[70:71], v40 offset:51456
v_mfma_f32_16x16x32_bf16 v[172:175], a[108:111], a[172:175], v[172:175]
s_waitcnt lgkmcnt(8)
ds_read_b64_tr_b16 a[72:73], v41 offset:33024
v_mfma_f32_16x16x32_bf16 v[176:179], a[112:115], a[160:163], v[176:179]
ds_read_b64_tr_b16 a[74:75], v41 offset:35072
buffer_load_dwordx4 v11, s[16:19], s35 offen offset:3072 lds
s_add_u32 s35, s35, 524288
v_mfma_f32_16x16x32_bf16 v[176:179], a[116:119], a[168:171], v[176:179]
ds_read_b64_tr_b16 a[76:77], v41 offset:49408
v_mfma_f32_16x16x32_bf16 v[180:183], a[112:115], a[164:167], v[180:183]
ds_read_b64_tr_b16 a[78:79], v41 offset:51456
v_mfma_f32_16x16x32_bf16 v[180:183], a[116:119], a[172:175], v[180:183]
s_waitcnt lgkmcnt(8)
ds_read_b64_tr_b16 a[80:81], v42 offset:33024
v_mfma_f32_16x16x32_bf16 v[184:187], a[120:123], a[160:163], v[184:187]
ds_read_b64_tr_b16 a[82:83], v42 offset:35072
buffer_load_dwordx4 a[224:227], v3, s[12:15], s47 offen offset:2048 sc1
v_mfma_f32_16x16x32_bf16 v[184:187], a[124:127], a[168:171], v[184:187]
ds_read_b64_tr_b16 a[84:85], v42 offset:49408
buffer_load_dwordx4 a[228:231], v3, s[12:15], s48 offen offset:2048 sc1
v_mfma_f32_16x16x32_bf16 v[188:191], a[120:123], a[164:167], v[188:191]
ds_read_b64_tr_b16 a[86:87], v42 offset:51456
buffer_load_dwordx4 a[232:235], v3, s[12:15], s47 offen offset:3072 sc1
v_mfma_f32_16x16x32_bf16 v[188:191], a[124:127], a[172:175], v[188:191]
s_waitcnt lgkmcnt(8)
ds_read_b64_tr_b16 a[88:89], v43 offset:33024
v_mfma_f32_16x16x32_bf16 v[192:195], a[64:67], a[160:163], v[192:195]
ds_read_b64_tr_b16 a[90:91], v43 offset:35072
buffer_load_dwordx4 a[236:239], v3, s[12:15], s48 offen offset:3072 sc1
buffer_store_dwordx4 a[24:27], v2, s[12:15], s78 offen sc1
v_mfma_f32_16x16x32_bf16 v[192:195], a[68:71], a[168:171], v[192:195]
ds_read_b64_tr_b16 a[92:93], v43 offset:49408
v_mfma_f32_16x16x32_bf16 v[196:199], a[64:67], a[164:167], v[196:199]
ds_read_b64_tr_b16 a[94:95], v43 offset:51456
v_mfma_f32_16x16x32_bf16 v[196:199], a[68:71], a[172:175], v[196:199]
s_waitcnt lgkmcnt(8)
ds_read_b64_tr_b16 a[96:97], v44 offset:33024
v_mfma_f32_16x16x32_bf16 v[200:203], a[72:75], a[160:163], v[200:203]
ds_read_b64_tr_b16 a[98:99], v44 offset:35072
v_mfma_f32_16x16x32_bf16 v[200:203], a[76:79], a[168:171], v[200:203]
ds_read_b64_tr_b16 a[100:101], v44 offset:49408
v_mfma_f32_16x16x32_bf16 v[204:207], a[72:75], a[164:167], v[204:207]
ds_read_b64_tr_b16 a[102:103], v44 offset:51456
v_mfma_f32_16x16x32_bf16 v[204:207], a[76:79], a[172:175], v[204:207]
s_waitcnt lgkmcnt(8)
ds_read_b64_tr_b16 a[104:105], v45 offset:33024
v_mfma_f32_16x16x32_bf16 v[208:211], a[80:83], a[160:163], v[208:211]
ds_read_b64_tr_b16 a[106:107], v45 offset:35072
v_mfma_f32_16x16x32_bf16 v[208:211], a[84:87], a[168:171], v[208:211]
ds_read_b64_tr_b16 a[108:109], v45 offset:49408
v_mfma_f32_16x16x32_bf16 v[212:215], a[80:83], a[164:167], v[212:215]
ds_read_b64_tr_b16 a[110:111], v45 offset:51456
v_mfma_f32_16x16x32_bf16 v[212:215], a[84:87], a[172:175], v[212:215]
s_waitcnt lgkmcnt(8)
ds_read_b64_tr_b16 a[112:113], v46 offset:33024
v_mfma_f32_16x16x32_bf16 v[216:219], a[88:91], a[160:163], v[216:219]
ds_read_b64_tr_b16 a[114:115], v46 offset:35072
v_mfma_f32_16x16x32_bf16 v[216:219], a[92:95], a[168:171], v[216:219]
ds_read_b64_tr_b16 a[116:117], v46 offset:49408
v_mfma_f32_16x16x32_bf16 v[220:223], a[88:91], a[164:167], v[220:223]
ds_read_b64_tr_b16 a[118:119], v46 offset:51456
v_mfma_f32_16x16x32_bf16 v[220:223], a[92:95], a[172:175], v[220:223]
s_waitcnt lgkmcnt(8)
ds_read_b64_tr_b16 a[120:121], v47 offset:33024
v_mfma_f32_16x16x32_bf16 v[224:227], a[96:99], a[160:163], v[224:227]
ds_read_b64_tr_b16 a[122:123], v47 offset:35072
buffer_store_dwordx4 a[28:31], v2, s[12:15], s79 offen sc1
v_mfma_f32_16x16x32_bf16 v[224:227], a[100:103], a[168:171], v[224:227]
ds_read_b64_tr_b16 a[124:125], v47 offset:49408
v_mfma_f32_16x16x32_bf16 v[228:231], a[96:99], a[164:167], v[228:231]
ds_read_b64_tr_b16 a[126:127], v47 offset:51456
v_mfma_f32_16x16x32_bf16 v[228:231], a[100:103], a[172:175], v[228:231]
s_waitcnt lgkmcnt(8)
ds_read_b64_tr_b16 a[64:65], v48 offset:0
v_mfma_f32_16x16x32_bf16 v[232:235], a[104:107], a[160:163], v[232:235]
ds_read_b64_tr_b16 a[66:67], v48 offset:2048
v_mfma_f32_16x16x32_bf16 v[232:235], a[108:111], a[168:171], v[232:235]
ds_read_b64_tr_b16 a[68:69], v48 offset:16384
v_mfma_f32_16x16x32_bf16 v[236:239], a[104:107], a[164:167], v[236:239]
ds_read_b64_tr_b16 a[70:71], v48 offset:18432
v_mfma_f32_16x16x32_bf16 v[236:239], a[108:111], a[172:175], v[236:239]
s_waitcnt lgkmcnt(8)
ds_read_b64_tr_b16 a[72:73], v49 offset:0
v_mfma_f32_16x16x32_bf16 v[240:243], a[112:115], a[160:163], v[240:243]
ds_read_b64_tr_b16 a[74:75], v49 offset:2048
v_mfma_f32_16x16x32_bf16 v[240:243], a[116:119], a[168:171], v[240:243]
ds_read_b64_tr_b16 a[76:77], v49 offset:16384
v_mfma_f32_16x16x32_bf16 v[244:247], a[112:115], a[164:167], v[244:247]
ds_read_b64_tr_b16 a[78:79], v49 offset:18432
v_mfma_f32_16x16x32_bf16 v[244:247], a[116:119], a[172:175], v[244:247]
s_waitcnt lgkmcnt(8)
ds_read_b64_tr_b16 a[80:81], v50 offset:0
v_mfma_f32_16x16x32_bf16 v[248:251], a[120:123], a[160:163], v[248:251]
ds_read_b64_tr_b16 a[82:83], v50 offset:2048
v_mfma_f32_16x16x32_bf16 v[248:251], a[124:127], a[168:171], v[248:251]
ds_read_b64_tr_b16 a[84:85], v50 offset:16384
v_mfma_f32_16x16x32_bf16 v[252:255], a[120:123], a[164:167], v[252:255]
ds_read_b64_tr_b16 a[86:87], v50 offset:18432
v_mfma_f32_16x16x32_bf16 v[252:255], a[124:127], a[172:175], v[252:255]
s_waitcnt vmcnt(13)
v_readfirstlane_b32 s60, v6
s_nop 0
s_or_b32 s60, s60, s62
s_and_b32 s61, s60, 0xffff
s_cmp_eq_u32 s61, 0xffff
s_cbranch_scc0 at_kspin
at_kspun:
s_add_u32 s71, s62, 1
s_barrier
s_waitcnt lgkmcnt(8)
ds_read_b64_tr_b16 a[88:89], v51 offset:0
v_mfma_f32_16x16x32_bf16 v[128:131], a[64:67], a[208:211], v[128:131]
ds_read_b64_tr_b16 a[90:91], v51 offset:2048
v_add_u32 v4, 32768, v2
v_mfma_f32_16x16x32_bf16 v[128:131], a[68:71], a[216:219], v[128:131]
ds_read_b64_tr_b16 a[92:93], v51 offset:16384
s_add_u32 m0, s7, 32768
v_mfma_f32_16x16x32_bf16 v[132:135], a[64:67], a[212:215], v[132:135]
ds_read_b64_tr_b16 a[94:95], v51 offset:18432
buffer_load_dwordx4 v2, s[12:15], s32 offen offset:0 sc1 lds
v_mfma_f32_16x16x32_bf16 v[132:135], a[68:71], a[220:223], v[132:135]
s_waitcnt lgkmcnt(8)
ds_read_b64_tr_b16 a[96:97], v52 offset:0
v_mfma_f32_16x16x32_bf16 v[136:139], a[72:75], a[208:211], v[136:139]
ds_read_b64_tr_b16 a[98:99], v52 offset:2048
v_add_u32 v5, 98304, v2
v_mfma_f32_16x16x32_bf16 v[136:139], a[76:79], a[216:219], v[136:139]
ds_read_b64_tr_b16 a[100:101], v52 offset:16384
buffer_load_dwordx4 v2, s[12:15], s32 offen offset:1024 sc1 lds
v_mfma_f32_16x16x32_bf16 v[140:143], a[72:75], a[212:215], v[140:143]
ds_read_b64_tr_b16 a[102:103], v52 offset:18432
v_and_b32 v28, 15, v1
v_mfma_f32_16x16x32_bf16 v[140:143], a[76:79], a[220:223], v[140:143]
s_waitcnt lgkmcnt(8)
ds_read_b64_tr_b16 a[104:105], v53 offset:0
v_mfma_f32_16x16x32_bf16 v[144:147], a[80:83], a[208:211], v[144:147]
ds_read_b64_tr_b16 a[106:107], v53 offset:2048
buffer_load_dwordx4 v2, s[12:15], s32 offen offset:2048 sc1 lds
v_mfma_f32_16x16x32_bf16 v[144:147], a[84:87], a[216:219], v[144:147]
ds_read_b64_tr_b16 a[108:109], v53 offset:16384
v_lshrrev_b32 v29, 4, v1
v_mfma_f32_16x16x32_bf16 v[148:151], a[80:83], a[212:215], v[148:151]
ds_read_b64_tr_b16 a[110:111], v53 offset:18432
v_lshlrev_b32 v29, 2, v29
v_mfma_f32_16x16x32_bf16 v[148:151], a[84:87], a[220:223], v[148:151]
s_waitcnt lgkmcnt(8)
ds_read_b64_tr_b16 a[112:113], v54 offset:0
buffer_load_dwordx4 v2, s[12:15], s32 offen offset:3072 sc1 lds
s_add_u32 s32, s32, 16384
v_mfma_f32_16x16x32_bf16 v[152:155], a[88:91], a[208:211], v[152:155]
ds_read_b64_tr_b16 a[114:115], v54 offset:2048
v_sub_u32 v25, v28, v29
v_mfma_f32_16x16x32_bf16 v[152:155], a[92:95], a[216:219], v[152:155]
ds_read_b64_tr_b16 a[116:117], v54 offset:16384
s_lshl_b32 s60, s24, 5
v_mfma_f32_16x16x32_bf16 v[156:159], a[88:91], a[212:215], v[156:159]
ds_read_b64_tr_b16 a[118:119], v54 offset:18432
s_add_u32 m0, s7, 49152
v_mfma_f32_16x16x32_bf16 v[156:159], a[92:95], a[220:223], v[156:159]
s_waitcnt lgkmcnt(8)
ds_read_b64_tr_b16 a[120:121], v55 offset:0
buffer_load_dwordx4 v2, s[12:15], s41 offen offset:0 sc1 lds
v_mfma_f32_16x16x32_bf16 v[160:163], a[96:99], a[208:211], v[160:163]
ds_read_b64_tr_b16 a[122:123], v55 offset:2048
buffer_store_dwordx4 v[72:75], v23, s[12:15], s74 offen sc1
v_mfma_f32_16x16x32_bf16 v[160:163], a[100:103], a[216:219], v[160:163]
ds_read_b64_tr_b16 a[124:125], v55 offset:16384
v_add_u32 v25, s60, v25
v_mfma_f32_16x16x32_bf16 v[164:167], a[96:99], a[212:215], v[164:167]
ds_read_b64_tr_b16 a[126:127], v55 offset:18432
buffer_load_dwordx4 v2, s[12:15], s41 offen offset:1024 sc1 lds
v_mfma_f32_16x16x32_bf16 v[164:167], a[100:103], a[220:223], v[164:167]
s_waitcnt lgkmcnt(8)
ds_read_b64_tr_b16 a[64:65], v48 offset:256
v_mfma_f32_16x16x32_bf16 v[168:171], a[104:107], a[208:211], v[168:171]
ds_read_b64_tr_b16 a[66:67], v48 offset:2304
v_mov_b32 v27, 0xff800000
v_mfma_f32_16x16x32_bf16 v[168:171], a[108:111], a[216:219], v[168:171]
ds_read_b64_tr_b16 a[68:69], v48 offset:16640
buffer_load_dwordx4 v2, s[12:15], s41 offen offset:2048 sc1 lds
v_mfma_f32_16x16x32_bf16 v[172:175], a[104:107], a[212:215], v[172:175]
ds_read_b64_tr_b16 a[70:71], v48 offset:18688
s_mov_b32 s42, 0x4b800000
v_mfma_f32_16x16x32_bf16 v[172:175], a[108:111], a[220:223], v[172:175]
s_waitcnt lgkmcnt(8)
ds_read_b64_tr_b16 a[72:73], v49 offset:256
v_mfma_f32_16x16x32_bf16 v[176:179], a[112:115], a[208:211], v[176:179]
ds_read_b64_tr_b16 a[74:75], v49 offset:2304
buffer_load_dwordx4 v2, s[12:15], s41 offen offset:3072 sc1 lds
v_mfma_f32_16x16x32_bf16 v[176:179], a[116:119], a[216:219], v[176:179]
ds_read_b64_tr_b16 a[76:77], v49 offset:16640
v_lshlrev_b32 v109, 6, v7
v_mfma_f32_16x16x32_bf16 v[180:183], a[112:115], a[212:215], v[180:183]
ds_read_b64_tr_b16 a[78:79], v49 offset:18688
v_lshrrev_b32 v28, 4, v1
v_mfma_f32_16x16x32_bf16 v[180:183], a[116:119], a[220:223], v[180:183]
s_waitcnt lgkmcnt(8)
ds_read_b64_tr_b16 a[80:81], v50 offset:256
v_mfma_f32_16x16x32_bf16 v[184:187], a[120:123], a[208:211], v[184:187]
ds_read_b64_tr_b16 a[82:83], v50 offset:2304
buffer_load_dwordx4 a[144:147], v3, s[12:15], s49 offen offset:0 sc1
v_mfma_f32_16x16x32_bf16 v[184:187], a[124:127], a[216:219], v[184:187]
ds_read_b64_tr_b16 a[84:85], v50 offset:16640
buffer_load_dwordx4 a[148:151], v3, s[12:15], s50 offen offset:0 sc1
v_mfma_f32_16x16x32_bf16 v[188:191], a[120:123], a[212:215], v[188:191]
ds_read_b64_tr_b16 a[86:87], v50 offset:18688
buffer_load_dwordx4 a[152:155], v3, s[12:15], s49 offen offset:1024 sc1
v_mfma_f32_16x16x32_bf16 v[188:191], a[124:127], a[220:223], v[188:191]
s_waitcnt lgkmcnt(8)
ds_read_b64_tr_b16 a[88:89], v51 offset:256
v_mfma_f32_16x16x32_bf16 v[192:195], a[64:67], a[208:211], v[192:195]
ds_read_b64_tr_b16 a[90:91], v51 offset:2304
buffer_load_dwordx4 a[156:159], v3, s[12:15], s50 offen offset:1024 sc1
buffer_store_dwordx4 v[76:79], v23, s[12:15], s75 offen sc1
v_mfma_f32_16x16x32_bf16 v[192:195], a[68:71], a[216:219], v[192:195]
ds_read_b64_tr_b16 a[92:93], v51 offset:16640
v_bfe_u32 v29, v1, 2, 2
v_mfma_f32_16x16x32_bf16 v[196:199], a[64:67], a[212:215], v[196:199]
ds_read_b64_tr_b16 a[94:95], v51 offset:18688
v_and_b32 v30, 1, v1
v_mfma_f32_16x16x32_bf16 v[196:199], a[68:71], a[220:223], v[196:199]
s_waitcnt lgkmcnt(8)
ds_read_b64_tr_b16 a[96:97], v52 offset:256
v_mfma_f32_16x16x32_bf16 v[200:203], a[72:75], a[208:211], v[200:203]
ds_read_b64_tr_b16 a[98:99], v52 offset:2304
v_lshlrev_b32 v30, 4, v30
v_mfma_f32_16x16x32_bf16 v[200:203], a[76:79], a[216:219], v[200:203]
ds_read_b64_tr_b16 a[100:101], v52 offset:16640
v_mov_b32 v31, 0x3f80
v_mfma_f32_16x16x32_bf16 v[204:207], a[72:75], a[212:215], v[204:207]
ds_read_b64_tr_b16 a[102:103], v52 offset:18688
v_lshlrev_b32 v30, v30, v31
v_mfma_f32_16x16x32_bf16 v[204:207], a[76:79], a[220:223], v[204:207]
s_waitcnt lgkmcnt(8)
ds_read_b64_tr_b16 a[104:105], v53 offset:256
v_mfma_f32_16x16x32_bf16 v[208:211], a[80:83], a[208:211], v[208:211]
ds_read_b64_tr_b16 a[106:107], v53 offset:2304
v_cmp_eq_u32 vcc, v28, v29
v_mfma_f32_16x16x32_bf16 v[208:211], a[84:87], a[216:219], v[208:211]
ds_read_b64_tr_b16 a[108:109], v53 offset:16640
v_mov_b32 v116, 0
v_mfma_f32_16x16x32_bf16 v[212:215], a[80:83], a[212:215], v[212:215]
ds_read_b64_tr_b16 a[110:111], v53 offset:18688
v_mov_b32 v117, 0
v_mfma_f32_16x16x32_bf16 v[212:215], a[84:87], a[220:223], v[212:215]
s_waitcnt lgkmcnt(8)
ds_read_b64_tr_b16 a[112:113], v54 offset:256
v_mfma_f32_16x16x32_bf16 v[216:219], a[88:91], a[208:211], v[216:219]
ds_read_b64_tr_b16 a[114:115], v54 offset:2304
v_cndmask_b32 v30, 0, v30, vcc
v_mfma_f32_16x16x32_bf16 v[216:219], a[92:95], a[216:219], v[216:219]
ds_read_b64_tr_b16 a[116:117], v54 offset:16640
v_and_b32 v31, 2, v1
v_mfma_f32_16x16x32_bf16 v[220:223], a[88:91], a[212:215], v[220:223]
ds_read_b64_tr_b16 a[118:119], v54 offset:18688
v_cmp_eq_u32 vcc, 0, v31
v_mfma_f32_16x16x32_bf16 v[220:223], a[92:95], a[220:223], v[220:223]
s_waitcnt lgkmcnt(8)
ds_read_b64_tr_b16 a[120:121], v55 offset:256
v_mfma_f32_16x16x32_bf16 v[224:227], a[96:99], a[208:211], v[224:227]
ds_read_b64_tr_b16 a[122:123], v55 offset:2304
buffer_store_dwordx4 v[80:83], v23, s[12:15], s76 offen sc1
v_mfma_f32_16x16x32_bf16 v[224:227], a[100:103], a[216:219], v[224:227]
ds_read_b64_tr_b16 a[124:125], v55 offset:16640
v_mov_b32 v120, 0
v_mfma_f32_16x16x32_bf16 v[228:231], a[96:99], a[212:215], v[228:231]
ds_read_b64_tr_b16 a[126:127], v55 offset:18688
v_mov_b32 v121, 0
v_mfma_f32_16x16x32_bf16 v[228:231], a[100:103], a[220:223], v[228:231]
s_waitcnt lgkmcnt(8)
ds_read_b64_tr_b16 a[64:65], v48 offset:32768
v_mfma_f32_16x16x32_bf16 v[232:235], a[104:107], a[208:211], v[232:235]
ds_read_b64_tr_b16 a[66:67], v48 offset:34816
v_cndmask_b32 v118, 0, v30, vcc
v_mfma_f32_16x16x32_bf16 v[232:235], a[108:111], a[216:219], v[232:235]
ds_read_b64_tr_b16 a[68:69], v48 offset:49152
v_sub_u32 v119, v30, v118
v_mfma_f32_16x16x32_bf16 v[236:239], a[104:107], a[212:215], v[236:239]
ds_read_b64_tr_b16 a[70:71], v48 offset:51200
v_mfma_f32_16x16x32_bf16 v[236:239], a[108:111], a[220:223], v[236:239]
s_waitcnt lgkmcnt(8)
ds_read_b64_tr_b16 a[72:73], v49 offset:32768
v_mfma_f32_16x16x32_bf16 v[240:243], a[112:115], a[208:211], v[240:243]
ds_read_b64_tr_b16 a[74:75], v49 offset:34816
v_mfma_f32_16x16x32_bf16 v[240:243], a[116:119], a[216:219], v[240:243]
ds_read_b64_tr_b16 a[76:77], v49 offset:49152
v_mfma_f32_16x16x32_bf16 v[244:247], a[112:115], a[212:215], v[244:247]
ds_read_b64_tr_b16 a[78:79], v49 offset:51200
v_mfma_f32_16x16x32_bf16 v[244:247], a[116:119], a[220:223], v[244:247]
s_waitcnt lgkmcnt(8)
ds_read_b64_tr_b16 a[80:81], v50 offset:32768
v_mfma_f32_16x16x32_bf16 v[248:251], a[120:123], a[208:211], v[248:251]
ds_read_b64_tr_b16 a[82:83], v50 offset:34816
v_mfma_f32_16x16x32_bf16 v[248:251], a[124:127], a[216:219], v[248:251]
ds_read_b64_tr_b16 a[84:85], v50 offset:49152
v_mfma_f32_16x16x32_bf16 v[252:255], a[120:123], a[212:215], v[252:255]
ds_read_b64_tr_b16 a[86:87], v50 offset:51200
v_mfma_f32_16x16x32_bf16 v[252:255], a[124:127], a[220:223], v[252:255]
s_waitcnt vmcnt(21)
s_barrier
s_waitcnt lgkmcnt(8)
ds_read_b64_tr_b16 a[88:89], v51 offset:32768
s_waitcnt vmcnt(17)
v_mfma_f32_16x16x32_bf16 v[128:131], a[64:67], a[224:227], v[128:131]
ds_read_b64_tr_b16 a[90:91], v51 offset:34816
v_mfma_f32_16x16x32_bf16 v[128:131], a[68:71], a[232:235], v[128:131]
ds_read_b64_tr_b16 a[92:93], v51 offset:49152
s_add_u32 m0, s36, 0
v_mfma_f32_16x16x32_bf16 v[132:135], a[64:67], a[228:231], v[132:135]
ds_read_b64_tr_b16 a[94:95], v51 offset:51200
buffer_load_dwordx4 v2, s[12:15], s32 offen offset:0 sc1 lds
v_mfma_f32_16x16x32_bf16 v[132:135], a[68:71], a[236:239], v[132:135]
s_waitcnt lgkmcnt(8)
ds_read_b64_tr_b16 a[96:97], v52 offset:32768
v_mfma_f32_16x16x32_bf16 v[136:139], a[72:75], a[224:227], v[136:139]
ds_read_b64_tr_b16 a[98:99], v52 offset:34816
v_mfma_f32_16x16x32_bf16 v[136:139], a[76:79], a[232:235], v[136:139]
ds_read_b64_tr_b16 a[100:101], v52 offset:49152
buffer_load_dwordx4 v2, s[12:15], s32 offen offset:1024 sc1 lds
v_mfma_f32_16x16x32_bf16 v[140:143], a[72:75], a[228:231], v[140:143]
ds_read_b64_tr_b16 a[102:103], v52 offset:51200
v_mfma_f32_16x16x32_bf16 v[140:143], a[76:79], a[236:239], v[140:143]
s_waitcnt lgkmcnt(8)
ds_read_b64_tr_b16 a[104:105], v53 offset:32768
v_mfma_f32_16x16x32_bf16 v[144:147], a[80:83], a[224:227], v[144:147]
ds_read_b64_tr_b16 a[106:107], v53 offset:34816
buffer_load_dwordx4 v2, s[12:15], s32 offen offset:2048 sc1 lds
v_mfma_f32_16x16x32_bf16 v[144:147], a[84:87], a[232:235], v[144:147]
ds_read_b64_tr_b16 a[108:109], v53 offset:49152
v_mfma_f32_16x16x32_bf16 v[148:151], a[80:83], a[228:231], v[148:151]
ds_read_b64_tr_b16 a[110:111], v53 offset:51200
v_mfma_f32_16x16x32_bf16 v[148:151], a[84:87], a[236:239], v[148:151]
s_waitcnt lgkmcnt(8)
ds_read_b64_tr_b16 a[112:113], v54 offset:32768
buffer_load_dwordx4 v2, s[12:15], s32 offen offset:3072 sc1 lds
s_add_u32 s32, s32, 16384
v_mfma_f32_16x16x32_bf16 v[152:155], a[88:91], a[224:227], v[152:155]
ds_read_b64_tr_b16 a[114:115], v54 offset:34816
v_mfma_f32_16x16x32_bf16 v[152:155], a[92:95], a[232:235], v[152:155]
ds_read_b64_tr_b16 a[116:117], v54 offset:49152
v_mfma_f32_16x16x32_bf16 v[156:159], a[88:91], a[228:231], v[156:159]
ds_read_b64_tr_b16 a[118:119], v54 offset:51200
s_add_u32 m0, s36, 16384
v_mfma_f32_16x16x32_bf16 v[156:159], a[92:95], a[236:239], v[156:159]
s_waitcnt lgkmcnt(8)
ds_read_b64_tr_b16 a[120:121], v55 offset:32768
buffer_load_dwordx4 v2, s[12:15], s33 offen offset:0 sc1 lds
v_mfma_f32_16x16x32_bf16 v[160:163], a[96:99], a[224:227], v[160:163]
ds_read_b64_tr_b16 a[122:123], v55 offset:34816
buffer_store_dwordx4 v[84:87], v23, s[12:15], s77 offen sc1
v_mfma_f32_16x16x32_bf16 v[160:163], a[100:103], a[232:235], v[160:163]
ds_read_b64_tr_b16 a[124:125], v55 offset:49152
v_mfma_f32_16x16x32_bf16 v[164:167], a[96:99], a[228:231], v[164:167]
ds_read_b64_tr_b16 a[126:127], v55 offset:51200
buffer_load_dwordx4 v2, s[12:15], s33 offen offset:1024 sc1 lds
v_mfma_f32_16x16x32_bf16 v[164:167], a[100:103], a[236:239], v[164:167]
s_waitcnt lgkmcnt(8)
ds_read_b64_tr_b16 a[64:65], v48 offset:33024
v_mfma_f32_16x16x32_bf16 v[168:171], a[104:107], a[224:227], v[168:171]
ds_read_b64_tr_b16 a[66:67], v48 offset:35072
v_mfma_f32_16x16x32_bf16 v[168:171], a[108:111], a[232:235], v[168:171]
ds_read_b64_tr_b16 a[68:69], v48 offset:49408
buffer_load_dwordx4 v2, s[12:15], s33 offen offset:2048 sc1 lds
v_mfma_f32_16x16x32_bf16 v[172:175], a[104:107], a[228:231], v[172:175]
ds_read_b64_tr_b16 a[70:71], v48 offset:51456
v_mfma_f32_16x16x32_bf16 v[172:175], a[108:111], a[236:239], v[172:175]
s_waitcnt lgkmcnt(8)
ds_read_b64_tr_b16 a[72:73], v49 offset:33024
v_mfma_f32_16x16x32_bf16 v[176:179], a[112:115], a[224:227], v[176:179]
ds_read_b64_tr_b16 a[74:75], v49 offset:35072
buffer_load_dwordx4 v2, s[12:15], s33 offen offset:3072 sc1 lds
s_add_u32 s33, s33, 16384
v_mfma_f32_16x16x32_bf16 v[176:179], a[116:119], a[232:235], v[176:179]
ds_read_b64_tr_b16 a[76:77], v49 offset:49408
v_mfma_f32_16x16x32_bf16 v[180:183], a[112:115], a[228:231], v[180:183]
ds_read_b64_tr_b16 a[78:79], v49 offset:51456
v_mfma_f32_16x16x32_bf16 v[180:183], a[116:119], a[236:239], v[180:183]
s_waitcnt lgkmcnt(8)
ds_read_b64_tr_b16 a[80:81], v50 offset:33024
v_mfma_f32_16x16x32_bf16 v[184:187], a[120:123], a[224:227], v[184:187]
ds_read_b64_tr_b16 a[82:83], v50 offset:35072
v_mfma_f32_16x16x32_bf16 v[184:187], a[124:127], a[232:235], v[184:187]
ds_read_b64_tr_b16 a[84:85], v50 offset:49408
v_mfma_f32_16x16x32_bf16 v[188:191], a[120:123], a[228:231], v[188:191]
ds_read_b64_tr_b16 a[86:87], v50 offset:51456
v_mfma_f32_16x16x32_bf16 v[188:191], a[124:127], a[236:239], v[188:191]
s_waitcnt lgkmcnt(8)
ds_read_b64_tr_b16 a[88:89], v51 offset:33024
v_mfma_f32_16x16x32_bf16 v[192:195], a[64:67], a[224:227], v[192:195]
ds_read_b64_tr_b16 a[90:91], v51 offset:35072
buffer_store_dwordx4 v[88:91], v23, s[12:15], s78 offen sc1
v_mfma_f32_16x16x32_bf16 v[192:195], a[68:71], a[232:235], v[192:195]
ds_read_b64_tr_b16 a[92:93], v51 offset:49408
v_mfma_f32_16x16x32_bf16 v[196:199], a[64:67], a[228:231], v[196:199]
ds_read_b64_tr_b16 a[94:95], v51 offset:51456
v_mfma_f32_16x16x32_bf16 v[196:199], a[68:71], a[236:239], v[196:199]
s_waitcnt lgkmcnt(8)
ds_read_b64_tr_b16 a[96:97], v52 offset:33024
v_mfma_f32_16x16x32_bf16 v[200:203], a[72:75], a[224:227], v[200:203]
ds_read_b64_tr_b16 a[98:99], v52 offset:35072
v_mfma_f32_16x16x32_bf16 v[200:203], a[76:79], a[232:235], v[200:203]
ds_read_b64_tr_b16 a[100:101], v52 offset:49408
v_mfma_f32_16x16x32_bf16 v[204:207], a[72:75], a[228:231], v[204:207]
ds_read_b64_tr_b16 a[102:103], v52 offset:51456
v_mfma_f32_16x16x32_bf16 v[204:207], a[76:79], a[236:239], v[204:207]
s_waitcnt lgkmcnt(8)
ds_read_b64_tr_b16 a[104:105], v53 offset:33024
v_mfma_f32_16x16x32_bf16 v[208:211], a[80:83], a[224:227], v[208:211]
ds_read_b64_tr_b16 a[106:107], v53 offset:35072
v_mfma_f32_16x16x32_bf16 v[208:211], a[84:87], a[232:235], v[208:211]
ds_read_b64_tr_b16 a[108:109], v53 offset:49408
v_mfma_f32_16x16x32_bf16 v[212:215], a[80:83], a[228:231], v[212:215]
ds_read_b64_tr_b16 a[110:111], v53 offset:51456
v_mfma_f32_16x16x32_bf16 v[212:215], a[84:87], a[236:239], v[212:215]
s_waitcnt lgkmcnt(8)
ds_read_b64_tr_b16 a[112:113], v54 offset:33024
v_mfma_f32_16x16x32_bf16 v[216:219], a[88:91], a[224:227], v[216:219]
ds_read_b64_tr_b16 a[114:115], v54 offset:35072
v_mfma_f32_16x16x32_bf16 v[216:219], a[92:95], a[232:235], v[216:219]
ds_read_b64_tr_b16 a[116:117], v54 offset:49408
v_mfma_f32_16x16x32_bf16 v[220:223], a[88:91], a[228:231], v[220:223]
ds_read_b64_tr_b16 a[118:119], v54 offset:51456
v_mfma_f32_16x16x32_bf16 v[220:223], a[92:95], a[236:239], v[220:223]
s_waitcnt lgkmcnt(8)
ds_read_b64_tr_b16 a[120:121], v55 offset:33024
v_mfma_f32_16x16x32_bf16 v[224:227], a[96:99], a[224:227], v[224:227]
ds_read_b64_tr_b16 a[122:123], v55 offset:35072
buffer_store_dwordx4 v[92:95], v23, s[12:15], s79 offen sc1
v_mfma_f32_16x16x32_bf16 v[224:227], a[100:103], a[232:235], v[224:227]
ds_read_b64_tr_b16 a[124:125], v55 offset:49408
v_mfma_f32_16x16x32_bf16 v[228:231], a[96:99], a[228:231], v[228:231]
ds_read_b64_tr_b16 a[126:127], v55 offset:51456
v_mfma_f32_16x16x32_bf16 v[228:231], a[100:103], a[236:239], v[228:231]
s_waitcnt lgkmcnt(8)
ds_read_b64_tr_b16 a[64:65], v40 offset:0
v_mfma_f32_16x16x32_bf16 v[232:235], a[104:107], a[224:227], v[232:235]
ds_read_b64_tr_b16 a[66:67], v40 offset:2048
v_mfma_f32_16x16x32_bf16 v[232:235], a[108:111], a[232:235], v[232:235]
ds_read_b64_tr_b16 a[68:69], v40 offset:16384
v_mfma_f32_16x16x32_bf16 v[236:239], a[104:107], a[228:231], v[236:239]
ds_read_b64_tr_b16 a[70:71], v40 offset:18432
v_mfma_f32_16x16x32_bf16 v[236:239], a[108:111], a[236:239], v[236:239]
s_waitcnt lgkmcnt(8)
ds_read_b64_tr_b16 a[72:73], v41 offset:0
v_mfma_f32_16x16x32_bf16 v[240:243], a[112:115], a[224:227], v[240:243]
ds_read_b64_tr_b16 a[74:75], v41 offset:2048
v_mfma_f32_16x16x32_bf16 v[240:243], a[116:119], a[232:235], v[240:243]
ds_read_b64_tr_b16 a[76:77], v41 offset:16384
v_mfma_f32_16x16x32_bf16 v[244:247], a[112:115], a[228:231], v[244:247]
ds_read_b64_tr_b16 a[78:79], v41 offset:18432
v_mfma_f32_16x16x32_bf16 v[244:247], a[116:119], a[236:239], v[244:247]
s_waitcnt lgkmcnt(8)
ds_read_b64_tr_b16 a[80:81], v42 offset:0
v_mfma_f32_16x16x32_bf16 v[248:251], a[120:123], a[224:227], v[248:251]
ds_read_b64_tr_b16 a[82:83], v42 offset:2048
v_mfma_f32_16x16x32_bf16 v[248:251], a[124:127], a[232:235], v[248:251]
ds_read_b64_tr_b16 a[84:85], v42 offset:16384
v_mfma_f32_16x16x32_bf16 v[252:255], a[120:123], a[228:231], v[252:255]
ds_read_b64_tr_b16 a[86:87], v42 offset:18432
v_mfma_f32_16x16x32_bf16 v[252:255], a[124:127], a[236:239], v[252:255]
s_cmp_ge_u32 s26, 6
s_cselect_b32 s56, 6, 0
s_cselect_b32 s57, 0, 8
s_sub_u32 s56, s26, s56
s_min_u32 s56, s56, 6
s_cmp_eq_u32 s26, 12
s_cselect_b32 s57, 8, s57
s_lshl_b32 s57, s57, 1
s_add_u32 s57, s57, s25
s_lshl_b32 s57, s57, 2
s_add_u32 s57, s57, s24
s_mul_i32 s57, s57, 14336
s_lshl_b32 s61, s56, 7
s_add_u32 s57, s57, s61
v_and_b32 v12, 15, v1
v_mul_u32_u24 v12, 896, v12
v_and_b32 v13, 48, v1
v_add_u32 v12, v12, v13
v_lshlrev_b32 v13, 1, v13
s_lshl_b32 s56, s56, 8
s_add_u32 s56, s56, 35655168
s_barrier
s_waitcnt lgkmcnt(8)
ds_read_b64_tr_b16 a[88:89], v43 offset:0
s_waitcnt vmcnt(13)
v_mfma_f32_16x16x32_bf16 v[128:131], a[64:67], a[144:147], v[128:131]
ds_read_b64_tr_b16 a[90:91], v43 offset:2048
v_mfma_f32_16x16x32_bf16 v[128:131], a[68:71], a[152:155], v[128:131]
ds_read_b64_tr_b16 a[92:93], v43 offset:16384
s_add_u32 m0, s36, 32768
v_mfma_f32_16x16x32_bf16 v[132:135], a[64:67], a[148:151], v[132:135]
ds_read_b64_tr_b16 a[94:95], v43 offset:18432
buffer_load_dwordx4 v2, s[12:15], s32 offen offset:0 sc1 lds
v_mfma_f32_16x16x32_bf16 v[132:135], a[68:71], a[156:159], v[132:135]
s_waitcnt lgkmcnt(8)
ds_read_b64_tr_b16 a[96:97], v44 offset:0
v_mfma_f32_16x16x32_bf16 v[136:139], a[72:75], a[144:147], v[136:139]
ds_read_b64_tr_b16 a[98:99], v44 offset:2048
v_mfma_f32_16x16x32_bf16 v[136:139], a[76:79], a[152:155], v[136:139]
ds_read_b64_tr_b16 a[100:101], v44 offset:16384
buffer_load_dwordx4 v2, s[12:15], s32 offen offset:1024 sc1 lds
v_mfma_f32_16x16x32_bf16 v[140:143], a[72:75], a[148:151], v[140:143]
ds_read_b64_tr_b16 a[102:103], v44 offset:18432
v_mfma_f32_16x16x32_bf16 v[140:143], a[76:79], a[156:159], v[140:143]
s_waitcnt lgkmcnt(8)
ds_read_b64_tr_b16 a[104:105], v45 offset:0
v_mfma_f32_16x16x32_bf16 v[144:147], a[80:83], a[144:147], v[144:147]
ds_read_b64_tr_b16 a[106:107], v45 offset:2048
buffer_load_dwordx4 v2, s[12:15], s32 offen offset:2048 sc1 lds
v_mfma_f32_16x16x32_bf16 v[144:147], a[84:87], a[152:155], v[144:147]
ds_read_b64_tr_b16 a[108:109], v45 offset:16384
v_mfma_f32_16x16x32_bf16 v[148:151], a[80:83], a[148:151], v[148:151]
ds_read_b64_tr_b16 a[110:111], v45 offset:18432
v_mfma_f32_16x16x32_bf16 v[148:151], a[84:87], a[156:159], v[148:151]
s_waitcnt lgkmcnt(8)
ds_read_b64_tr_b16 a[112:113], v46 offset:0
buffer_load_dwordx4 v2, s[12:15], s32 offen offset:3072 sc1 lds
s_add_u32 s32, s32, 16384
v_mfma_f32_16x16x32_bf16 v[152:155], a[88:91], a[144:147], v[152:155]
ds_read_b64_tr_b16 a[114:115], v46 offset:2048
v_cvt_pk_bf16_f32 v28, v128, v129
v_mfma_f32_16x16x32_bf16 v[152:155], a[92:95], a[152:155], v[152:155]
ds_read_b64_tr_b16 a[116:117], v46 offset:16384
v_accvgpr_write_b32 a0, v28
v_mfma_f32_16x16x32_bf16 v[156:159], a[88:91], a[148:151], v[156:159]
ds_read_b64_tr_b16 a[118:119], v46 offset:18432
s_add_u32 m0, s36, 49152
v_mfma_f32_16x16x32_bf16 v[156:159], a[92:95], a[156:159], v[156:159]
s_waitcnt lgkmcnt(8)
ds_read_b64_tr_b16 a[120:121], v47 offset:0
buffer_load_dwordx4 v2, s[12:15], s33 offen offset:0 sc1 lds
v_mfma_f32_16x16x32_bf16 v[160:163], a[96:99], a[144:147], v[160:163]
ds_read_b64_tr_b16 a[122:123], v47 offset:2048
v_cvt_pk_bf16_f32 v29, v130, v131
v_mfma_f32_16x16x32_bf16 v[160:163], a[100:103], a[152:155], v[160:163]
ds_read_b64_tr_b16 a[124:125], v47 offset:16384
v_accvgpr_write_b32 a1, v29
v_mfma_f32_16x16x32_bf16 v[164:167], a[96:99], a[148:151], v[164:167]
ds_read_b64_tr_b16 a[126:127], v47 offset:18432
buffer_load_dwordx4 v2, s[12:15], s33 offen offset:1024 sc1 lds
v_mfma_f32_16x16x32_bf16 v[164:167], a[100:103], a[156:159], v[164:167]
s_waitcnt lgkmcnt(8)
ds_read_b64_tr_b16 a[64:65], v40 offset:256
v_mfma_f32_16x16x32_bf16 v[168:171], a[104:107], a[144:147], v[168:171]
ds_read_b64_tr_b16 a[66:67], v40 offset:2304
v_mov_b64 v[128:129], 0
v_mfma_f32_16x16x32_bf16 v[168:171], a[108:111], a[152:155], v[168:171]
ds_read_b64_tr_b16 a[68:69], v40 offset:16640
buffer_load_dwordx4 v2, s[12:15], s33 offen offset:2048 sc1 lds
v_mfma_f32_16x16x32_bf16 v[172:175], a[104:107], a[148:151], v[172:175]
ds_read_b64_tr_b16 a[70:71], v40 offset:18688
v_mov_b64 v[130:131], 0
v_mfma_f32_16x16x32_bf16 v[172:175], a[108:111], a[156:159], v[172:175]
s_waitcnt lgkmcnt(8)
ds_read_b64_tr_b16 a[72:73], v41 offset:256
v_mfma_f32_16x16x32_bf16 v[176:179], a[112:115], a[144:147], v[176:179]
ds_read_b64_tr_b16 a[74:75], v41 offset:2304
buffer_load_dwordx4 v2, s[12:15], s33 offen offset:3072 sc1 lds
s_add_u32 s33, s33, 16384
v_mfma_f32_16x16x32_bf16 v[176:179], a[116:119], a[152:155], v[176:179]
ds_read_b64_tr_b16 a[76:77], v41 offset:16640
v_cvt_pk_bf16_f32 v30, v136, v137
v_mfma_f32_16x16x32_bf16 v[180:183], a[112:115], a[148:151], v[180:183]
ds_read_b64_tr_b16 a[78:79], v41 offset:18688
v_accvgpr_write_b32 a2, v30
v_mfma_f32_16x16x32_bf16 v[180:183], a[116:119], a[156:159], v[180:183]
s_waitcnt lgkmcnt(8)
ds_read_b64_tr_b16 a[80:81], v42 offset:256
s_mov_b32 s72, s80
s_mov_b32 s73, s81
s_mov_b32 s74, 3670016
s_mov_b32 s75, 0x00020000
s_lshl_b32 s76, s25, 3
s_add_u32 s76, s76, s24
s_mul_i32 s76, s76, 28672
s_add_u32 s76, s76, 256
s_add_u32 m0, s6, 0
v_mfma_f32_16x16x32_bf16 v[184:187], a[120:123], a[144:147], v[184:187]
ds_read_b64_tr_b16 a[82:83], v42 offset:2304
buffer_load_dwordx4 v16, s[72:75], s76 offen offset:0 lds
v_mfma_f32_16x16x32_bf16 v[184:187], a[124:127], a[152:155], v[184:187]
ds_read_b64_tr_b16 a[84:85], v42 offset:16640
v_cvt_pk_bf16_f32 v31, v138, v139
v_mfma_f32_16x16x32_bf16 v[188:191], a[120:123], a[148:151], v[188:191]
ds_read_b64_tr_b16 a[86:87], v42 offset:18688
v_accvgpr_write_b32 a3, v31
v_mfma_f32_16x16x32_bf16 v[188:191], a[124:127], a[156:159], v[188:191]
s_waitcnt lgkmcnt(8)
ds_read_b64_tr_b16 a[88:89], v43 offset:256
buffer_load_dwordx4 v17, s[72:75], s76 offen offset:1024 lds
v_mfma_f32_16x16x32_bf16 v[192:195], a[64:67], a[144:147], v[192:195]
ds_read_b64_tr_b16 a[90:91], v43 offset:2304
v_mov_b64 v[136:137], 0
v_mfma_f32_16x16x32_bf16 v[192:195], a[68:71], a[152:155], v[192:195]
ds_read_b64_tr_b16 a[92:93], v43 offset:16640
v_mov_b64 v[138:139], 0
v_mfma_f32_16x16x32_bf16 v[196:199], a[64:67], a[148:151], v[196:199]
ds_read_b64_tr_b16 a[94:95], v43 offset:18688
buffer_load_dwordx4 v18, s[72:75], s76 offen offset:2048 lds
v_mfma_f32_16x16x32_bf16 v[196:199], a[68:71], a[156:159], v[196:199]
s_waitcnt lgkmcnt(8)
ds_read_b64_tr_b16 a[96:97], v44 offset:256
v_mfma_f32_16x16x32_bf16 v[200:203], a[72:75], a[144:147], v[200:203]
ds_read_b64_tr_b16 a[98:99], v44 offset:2304
v_cvt_pk_bf16_f32 v28, v132, v133
v_mfma_f32_16x16x32_bf16 v[200:203], a[76:79], a[152:155], v[200:203]
ds_read_b64_tr_b16 a[100:101], v44 offset:16640
buffer_load_dwordx4 v19, s[72:75], s76 offen offset:3072 lds
v_mfma_f32_16x16x32_bf16 v[204:207], a[72:75], a[148:151], v[204:207]
ds_read_b64_tr_b16 a[102:103], v44 offset:18688
v_accvgpr_write_b32 a32, v28
v_mfma_f32_16x16x32_bf16 v[204:207], a[76:79], a[156:159], v[204:207]
s_waitcnt lgkmcnt(8)
ds_read_b64_tr_b16 a[104:105], v45 offset:256
v_mfma_f32_16x16x32_bf16 v[208:211], a[80:83], a[144:147], v[208:211]
ds_read_b64_tr_b16 a[106:107], v45 offset:2304
s_mov_b32 s72, s80
s_mov_b32 s73, s81
s_mov_b32 s74, 3670016
s_mov_b32 s75, 0x00020000
s_lshl_b32 s76, s25, 3
s_add_u32 s76, s76, s24
s_mul_i32 s76, s76, 28672
s_add_u32 s76, s76, 114944
s_add_u32 m0, s6, 16384
v_mfma_f32_16x16x32_bf16 v[208:211], a[84:87], a[152:155], v[208:211]
ds_read_b64_tr_b16 a[108:109], v45 offset:16640
buffer_load_dwordx4 v16, s[72:75], s76 offen offset:0 lds
v_mfma_f32_16x16x32_bf16 v[212:215], a[80:83], a[148:151], v[212:215]
ds_read_b64_tr_b16 a[110:111], v45 offset:18688
v_cvt_pk_bf16_f32 v29, v134, v135
v_mfma_f32_16x16x32_bf16 v[212:215], a[84:87], a[156:159], v[212:215]
s_waitcnt lgkmcnt(8)
ds_read_b64_tr_b16 a[112:113], v46 offset:256
v_mfma_f32_16x16x32_bf16 v[216:219], a[88:91], a[144:147], v[216:219]
ds_read_b64_tr_b16 a[114:115], v46 offset:2304
buffer_load_dwordx4 v17, s[72:75], s76 offen offset:1024 lds
v_mfma_f32_16x16x32_bf16 v[216:219], a[92:95], a[152:155], v[216:219]
ds_read_b64_tr_b16 a[116:117], v46 offset:16640
v_accvgpr_write_b32 a33, v29
v_mfma_f32_16x16x32_bf16 v[220:223], a[88:91], a[148:151], v[220:223]
ds_read_b64_tr_b16 a[118:119], v46 offset:18688
v_mov_b64 v[132:133], 0
v_mfma_f32_16x16x32_bf16 v[220:223], a[92:95], a[156:159], v[220:223]
s_waitcnt lgkmcnt(8)
ds_read_b64_tr_b16 a[120:121], v47 offset:256
buffer_load_dwordx4 v18, s[72:75], s76 offen offset:2048 lds
v_mfma_f32_16x16x32_bf16 v[224:227], a[96:99], a[144:147], v[224:227]
ds_read_b64_tr_b16 a[122:123], v47 offset:2304
v_mov_b64 v[134:135], 0
v_mfma_f32_16x16x32_bf16 v[224:227], a[100:103], a[152:155], v[224:227]
ds_read_b64_tr_b16 a[124:125], v47 offset:16640
v_cvt_pk_bf16_f32 v30, v140, v141
v_mfma_f32_16x16x32_bf16 v[228:231], a[96:99], a[148:151], v[228:231]
ds_read_b64_tr_b16 a[126:127], v47 offset:18688
buffer_load_dwordx4 v19, s[72:75], s76 offen offset:3072 lds
v_mfma_f32_16x16x32_bf16 v[228:231], a[100:103], a[156:159], v[228:231]
s_waitcnt lgkmcnt(8)
v_accvgpr_write_b32 a34, v30
v_mfma_f32_16x16x32_bf16 v[232:235], a[104:107], a[144:147], v[232:235]
v_cvt_pk_bf16_f32 v31, v142, v143
v_accvgpr_write_b32 a35, v31
v_mfma_f32_16x16x32_bf16 v[232:235], a[108:111], a[152:155], v[232:235]
s_mov_b32 s52, s82
s_mov_b32 s53, s83
s_mov_b32 s54, 1835008
s_mov_b32 s55, 0x00020000
buffer_load_dwordx4 a[200:203], v12, s[52:55], s57 offen
v_mfma_f32_16x16x32_bf16 v[236:239], a[104:107], a[148:151], v[236:239]
buffer_load_dwordx4 a[204:207], v12, s[52:55], s57 offen offset:64
v_mov_b64 v[140:141], 0
v_mfma_f32_16x16x32_bf16 v[236:239], a[108:111], a[156:159], v[236:239]
s_waitcnt lgkmcnt(4)
buffer_load_dwordx4 a[208:211], v13, s[12:15], s56 offen offset:0 sc1
v_mfma_f32_16x16x32_bf16 v[240:243], a[112:115], a[144:147], v[240:243]
buffer_load_dwordx4 a[212:215], v13, s[12:15], s56 offen offset:16 sc1
v_mov_b64 v[142:143], 0
v_mfma_f32_16x16x32_bf16 v[240:243], a[116:119], a[152:155], v[240:243]
buffer_load_dwordx4 a[216:219], v13, s[12:15], s56 offen offset:128 sc1
v_cvt_pk_bf16_f32 v28, v144, v145
v_mfma_f32_16x16x32_bf16 v[244:247], a[112:115], a[148:151], v[244:247]
buffer_load_dwordx4 a[220:223], v13, s[12:15], s56 offen offset:144 sc1
v_accvgpr_write_b32 a4, v28
v_mfma_f32_16x16x32_bf16 v[244:247], a[116:119], a[156:159], v[244:247]
s_waitcnt lgkmcnt(0)
buffer_load_dwordx4 a[224:227], v13, s[12:15], s56 offen offset:3584 sc1
v_mfma_f32_16x16x32_bf16 v[248:251], a[120:123], a[144:147], v[248:251]
buffer_load_dwordx4 a[228:231], v13, s[12:15], s56 offen offset:3600 sc1
v_cvt_pk_bf16_f32 v29, v146, v147
v_mfma_f32_16x16x32_bf16 v[248:251], a[124:127], a[152:155], v[248:251]
buffer_load_dwordx4 a[232:235], v13, s[12:15], s56 offen offset:3712 sc1
v_accvgpr_write_b32 a5, v29
v_mfma_f32_16x16x32_bf16 v[252:255], a[120:123], a[148:151], v[252:255]
buffer_load_dwordx4 a[236:239], v13, s[12:15], s56 offen offset:3728 sc1
v_mov_b64 v[144:145], 0
v_mfma_f32_16x16x32_bf16 v[252:255], a[124:127], a[156:159], v[252:255]
v_mov_b64 v[146:147], 0
v_cvt_pk_bf16_f32 v30, v152, v153
v_accvgpr_write_b32 a6, v30
v_cvt_pk_bf16_f32 v31, v154, v155
v_accvgpr_write_b32 a7, v31
v_mov_b64 v[152:153], 0
v_mov_b64 v[154:155], 0
v_cvt_pk_bf16_f32 v28, v148, v149
v_accvgpr_write_b32 a36, v28
v_cvt_pk_bf16_f32 v29, v150, v151
v_accvgpr_write_b32 a37, v29
v_mov_b64 v[148:149], 0
v_mov_b64 v[150:151], 0
v_cvt_pk_bf16_f32 v30, v156, v157
v_accvgpr_write_b32 a38, v30
v_cvt_pk_bf16_f32 v31, v158, v159
v_accvgpr_write_b32 a39, v31
v_mov_b64 v[156:157], 0
v_mov_b64 v[158:159], 0
v_cvt_pk_bf16_f32 v28, v160, v161
v_accvgpr_write_b32 a8, v28
v_cvt_pk_bf16_f32 v29, v162, v163
v_accvgpr_write_b32 a9, v29
v_mov_b64 v[160:161], 0
v_mov_b64 v[162:163], 0
v_cvt_pk_bf16_f32 v30, v168, v169
v_accvgpr_write_b32 a10, v30
v_cvt_pk_bf16_f32 v31, v170, v171
v_accvgpr_write_b32 a11, v31
v_mov_b64 v[168:169], 0
v_mov_b64 v[170:171], 0
v_cvt_pk_bf16_f32 v28, v164, v165
v_accvgpr_write_b32 a40, v28
v_cvt_pk_bf16_f32 v29, v166, v167
v_accvgpr_write_b32 a41, v29
v_mov_b64 v[164:165], 0
v_mov_b64 v[166:167], 0
v_cvt_pk_bf16_f32 v30, v172, v173
v_accvgpr_write_b32 a42, v30
v_cvt_pk_bf16_f32 v31, v174, v175
v_accvgpr_write_b32 a43, v31
v_mov_b64 v[172:173], 0
v_mov_b64 v[174:175], 0
v_cvt_pk_bf16_f32 v28, v176, v177
v_accvgpr_write_b32 a12, v28
v_cvt_pk_bf16_f32 v29, v178, v179
v_accvgpr_write_b32 a13, v29
v_mov_b64 v[176:177], 0
v_mov_b64 v[178:179], 0
v_cvt_pk_bf16_f32 v30, v184, v185
v_accvgpr_write_b32 a14, v30
v_cvt_pk_bf16_f32 v31, v186, v187
v_accvgpr_write_b32 a15, v31
v_mov_b64 v[184:185], 0
v_mov_b64 v[186:187], 0
v_cvt_pk_bf16_f32 v28, v180, v181
v_accvgpr_write_b32 a44, v28
v_cvt_pk_bf16_f32 v29, v182, v183
v_accvgpr_write_b32 a45, v29
v_mov_b64 v[180:181], 0
v_mov_b64 v[182:183], 0
v_cvt_pk_bf16_f32 v30, v188, v189
v_accvgpr_write_b32 a46, v30
v_cvt_pk_bf16_f32 v31, v190, v191
v_accvgpr_write_b32 a47, v31
v_mov_b64 v[188:189], 0
v_mov_b64 v[190:191], 0
v_cvt_pk_bf16_f32 v28, v192, v193
v_accvgpr_write_b32 a16, v28
v_cvt_pk_bf16_f32 v29, v194, v195
v_accvgpr_write_b32 a17, v29
v_mov_b64 v[192:193], 0
v_mov_b64 v[194:195], 0
v_cvt_pk_bf16_f32 v30, v200, v201
v_accvgpr_write_b32 a18, v30
v_cvt_pk_bf16_f32 v31, v202, v203
v_accvgpr_write_b32 a19, v31
v_mov_b64 v[200:201], 0
v_mov_b64 v[202:203], 0
v_cvt_pk_bf16_f32 v28, v196, v197
v_accvgpr_write_b32 a48, v28
v_cvt_pk_bf16_f32 v29, v198, v199
v_accvgpr_write_b32 a49, v29
v_mov_b64 v[196:197], 0
v_mov_b64 v[198:199], 0
v_cvt_pk_bf16_f32 v30, v204, v205
v_accvgpr_write_b32 a50, v30
v_cvt_pk_bf16_f32 v31, v206, v207
v_accvgpr_write_b32 a51, v31
v_mov_b64 v[204:205], 0
v_mov_b64 v[206:207], 0
v_cvt_pk_bf16_f32 v28, v208, v209
v_accvgpr_write_b32 a20, v28
v_cvt_pk_bf16_f32 v29, v210, v211
v_accvgpr_write_b32 a21, v29
v_mov_b64 v[208:209], 0
v_mov_b64 v[210:211], 0
v_cvt_pk_bf16_f32 v30, v216, v217
v_accvgpr_write_b32 a22, v30
v_cvt_pk_bf16_f32 v31, v218, v219
v_accvgpr_write_b32 a23, v31
v_mov_b64 v[216:217], 0
v_mov_b64 v[218:219], 0
v_cvt_pk_bf16_f32 v28, v212, v213
v_accvgpr_write_b32 a52, v28
v_cvt_pk_bf16_f32 v29, v214, v215
v_accvgpr_write_b32 a53, v29
v_mov_b64 v[212:213], 0
v_mov_b64 v[214:215], 0
v_cvt_pk_bf16_f32 v30, v220, v221
v_accvgpr_write_b32 a54, v30
v_cvt_pk_bf16_f32 v31, v222, v223
v_accvgpr_write_b32 a55, v31
v_mov_b64 v[220:221], 0
v_mov_b64 v[222:223], 0
v_cvt_pk_bf16_f32 v28, v224, v225
v_accvgpr_write_b32 a24, v28
v_cvt_pk_bf16_f32 v29, v226, v227
v_accvgpr_write_b32 a25, v29
v_mov_b64 v[224:225], 0
v_mov_b64 v[226:227], 0
v_cvt_pk_bf16_f32 v30, v232, v233
v_accvgpr_write_b32 a26, v30
v_cvt_pk_bf16_f32 v31, v234, v235
v_accvgpr_write_b32 a27, v31
v_mov_b64 v[232:233], 0
v_mov_b64 v[234:235], 0
v_cvt_pk_bf16_f32 v28, v228, v229
v_accvgpr_write_b32 a56, v28
v_cvt_pk_bf16_f32 v29, v230, v231
v_accvgpr_write_b32 a57, v29
v_mov_b64 v[228:229], 0
v_mov_b64 v[230:231], 0
v_cvt_pk_bf16_f32 v30, v236, v237
v_accvgpr_write_b32 a58, v30
v_cvt_pk_bf16_f32 v31, v238, v239
v_accvgpr_write_b32 a59, v31
v_mov_b64 v[236:237], 0
v_mov_b64 v[238:239], 0
v_cvt_pk_bf16_f32 v28, v240, v241
v_accvgpr_write_b32 a28, v28
v_cvt_pk_bf16_f32 v29, v242, v243
v_accvgpr_write_b32 a29, v29
v_mov_b64 v[240:241], 0
v_mov_b64 v[242:243], 0
v_cvt_pk_bf16_f32 v30, v248, v249
v_accvgpr_write_b32 a30, v30
v_cvt_pk_bf16_f32 v31, v250, v251
v_accvgpr_write_b32 a31, v31
v_mov_b64 v[248:249], 0
v_mov_b64 v[250:251], 0
v_cvt_pk_bf16_f32 v28, v244, v245
v_accvgpr_write_b32 a60, v28
v_cvt_pk_bf16_f32 v29, v246, v247
v_accvgpr_write_b32 a61, v29
v_mov_b64 v[244:245], 0
v_mov_b64 v[246:247], 0
v_cvt_pk_bf16_f32 v30, v252, v253
v_accvgpr_write_b32 a62, v30
v_cvt_pk_bf16_f32 v31, v254, v255
v_accvgpr_write_b32 a63, v31
v_mov_b64 v[252:253], 0
v_mov_b64 v[254:255], 0
s_cmp_eq_u32 s30, 2
s_cselect_b32 s22, 268435456, 0
s_cselect_b32 s66, 2, 0
s_or_b32 s66, s66, s71
s_mov_b32 s16, s4
s_mov_b32 s17, s5
s_add_u32 s43, s64, 92274688
s_add_u32 s70, s65, 524288
s_waitcnt vmcnt(26)
s_barrier
buffer_atomic_or v14, v20, s[12:15], s68 offen sc1
ds_read_b128 a[64:67], v4 offset:49152
ds_read_b128 a[68:71], v4 offset:50176
ds_read_b128 a[72:75], v4 offset:51200
ds_read_b128 a[76:79], v4 offset:52224
ds_read_b128 a[80:83], v4 offset:53248
ds_read_b128 a[84:87], v4 offset:54272
ds_read_b128 a[88:91], v4 offset:55296
ds_read_b128 a[92:95], v4 offset:56320
at_att:
s_waitcnt lgkmcnt(4)
v_mfma_f32_16x16x32_bf16 v[32:35], a[64:67], a[0:3], 0
ds_read_b128 a[96:99], v4 offset:57344
buffer_store_dwordx4 a[0:3], v2, s[20:23], s43 offen offset:0 sc1
v_mfma_f32_16x16x32_bf16 v[32:35], a[68:71], a[4:7], v[32:35]
ds_read_b128 a[100:103], v4 offset:58368
buffer_store_dwordx4 a[4:7], v2, s[20:23], s43 offen offset:1024 sc1
v_mfma_f32_16x16x32_bf16 v[36:39], a[64:67], a[32:35], 0
buffer_store_dwordx4 a[8:11], v2, s[20:23], s43 offen offset:2048 sc1
v_mov_b32 v72, 0
v_mfma_f32_16x16x32_bf16 v[36:39], a[68:71], a[36:39], v[36:39]
ds_read_b128 a[104:107], v4 offset:59392
v_mov_b32 v73, 0
v_mfma_f32_16x16x32_bf16 v[32:35], a[72:75], a[8:11], v[32:35]
buffer_store_dwordx4 a[12:15], v2, s[20:23], s43 offen offset:3072 sc1
v_mov_b32 v74, 0
v_mfma_f32_16x16x32_bf16 v[32:35], a[76:79], a[12:15], v[32:35]
ds_read_b128 a[108:111], v4 offset:60416
s_add_u32 s43, s43, 4096
v_mfma_f32_16x16x32_bf16 v[36:39], a[72:75], a[40:43], v[36:39]
buffer_store_dwordx4 a[16:19], v2, s[20:23], s43 offen offset:0 sc1
v_mov_b32 v75, 0
v_mfma_f32_16x16x32_bf16 v[36:39], a[76:79], a[44:47], v[36:39]
s_waitcnt lgkmcnt(4)
v_mov_b32 v76, 0
v_mfma_f32_16x16x32_bf16 v[32:35], a[80:83], a[16:19], v[32:35]
ds_read_b128 a[112:115], v4 offset:61440
buffer_store_dwordx4 a[20:23], v2, s[20:23], s43 offen offset:1024 sc1
v_mfma_f32_16x16x32_bf16 v[32:35], a[84:87], a[20:23], v[32:35]
ds_read_b128 a[116:119], v4 offset:62464
buffer_store_dwordx4 a[24:27], v2, s[20:23], s43 offen offset:2048 sc1
v_mfma_f32_16x16x32_bf16 v[36:39], a[80:83], a[48:51], v[36:39]
buffer_store_dwordx4 a[28:31], v2, s[20:23], s43 offen offset:3072 sc1
v_mov_b32 v77, 0
v_mfma_f32_16x16x32_bf16 v[36:39], a[84:87], a[52:55], v[36:39]
ds_read_b128 a[120:123], v4 offset:63488
v_mov_b32 v78, 0
v_mfma_f32_16x16x32_bf16 v[32:35], a[88:91], a[24:27], v[32:35]
s_add_u32 s43, s43, 4096
v_mov_b32 v79, 0
v_mfma_f32_16x16x32_bf16 v[32:35], a[92:95], a[28:31], v[32:35]
ds_read_b128 a[124:127], v4 offset:64512
buffer_store_dwordx4 a[32:35], v2, s[20:23], s43 offen offset:0 sc1
v_mfma_f32_16x16x32_bf16 v[36:39], a[88:91], a[56:59], v[36:39]
v_mov_b32 v28, 0
v_mov_b32 v29, 0
v_mfma_f32_16x16x32_bf16 v[36:39], a[92:95], a[60:63], v[36:39]
s_waitcnt lgkmcnt(4)
buffer_store_dwordx4 a[36:39], v2, s[20:23], s43 offen offset:1024 sc1
v_mfma_f32_16x16x32_bf16 v[40:43], a[96:99], a[0:3], 0
ds_read_b128 a[64:67], v4 offset:32768
buffer_store_dwordx4 a[40:43], v2, s[20:23], s43 offen offset:2048 sc1
v_mfma_f32_16x16x32_bf16 v[40:43], a[100:103], a[4:7], v[40:43]
ds_read_b128 a[68:71], v4 offset:33792
buffer_store_dwordx4 a[44:47], v2, s[20:23], s43 offen offset:3072 sc1
v_mfma_f32_16x16x32_bf16 v[44:47], a[96:99], a[32:35], 0
v_mov_b32 v30, 0
v_mov_b32 v31, 0
v_mfma_f32_16x16x32_bf16 v[44:47], a[100:103], a[36:39], v[44:47]
ds_read_b128 a[72:75], v4 offset:34816
s_add_u32 s43, s43, 4096
v_mfma_f32_16x16x32_bf16 v[40:43], a[104:107], a[8:11], v[40:43]
buffer_store_dwordx4 a[48:51], v2, s[20:23], s43 offen offset:0 sc1
s_lshl_b32 s40, s27, 7
v_mfma_f32_16x16x32_bf16 v[40:43], a[108:111], a[12:15], v[40:43]
ds_read_b128 a[76:79], v4 offset:35840
buffer_store_dwordx4 a[52:55], v2, s[20:23], s43 offen offset:1024 sc1
v_mfma_f32_16x16x32_bf16 v[44:47], a[104:107], a[40:43], v[44:47]
s_lshl_b32 s60, s28, 5
s_sub_u32 s40, s40, s60
v_mfma_f32_16x16x32_bf16 v[44:47], a[108:111], a[44:47], v[44:47]
s_waitcnt lgkmcnt(4)
buffer_store_dwordx4 a[56:59], v2, s[20:23], s43 offen offset:2048 sc1
v_mfma_f32_16x16x32_bf16 v[40:43], a[112:115], a[16:19], v[40:43]
ds_read_b128 a[80:83], v4 offset:36864
buffer_store_dwordx4 a[60:63], v2, s[20:23], s43 offen offset:3072 sc1
v_mfma_f32_16x16x32_bf16 v[40:43], a[116:119], a[20:23], v[40:43]
ds_read_b128 a[84:87], v4 offset:37888
v_add_u32 v26, s40, v25
v_mfma_f32_16x16x32_bf16 v[44:47], a[112:115], a[48:51], v[44:47]
s_lshl_b32 s40, s24, 5
s_sub_u32 s38, s29, 2
v_mfma_f32_16x16x32_bf16 v[44:47], a[116:119], a[52:55], v[44:47]
ds_read_b128 a[88:91], v4 offset:38912
s_lshr_b32 s38, s38, 2
v_mfma_f32_16x16x32_bf16 v[40:43], a[120:123], a[24:27], v[40:43]
s_bfe_u32 s49, s29, 0x10001
v_mfma_f32_16x16x32_bf16 v[40:43], a[124:127], a[28:31], v[40:43]
ds_read_b128 a[92:95], v4 offset:39936
v_mfma_f32_16x16x32_bf16 v[44:47], a[120:123], a[56:59], v[44:47]
v_mfma_f32_16x16x32_bf16 v[44:47], a[124:127], a[60:63], v[44:47]
s_cmp_eq_u32 s30, 1
s_cbranch_scc1 at_given
v_cmp_gt_i32 s[50:51], 0, v26
v_cmp_gt_i32 s[52:53], 1, v26
v_cmp_gt_i32 s[54:55], 2, v26
v_cmp_gt_i32 s[56:57], 3, v26
v_cndmask_b32 v32, v32, v27, s[50:51]
s_nop 0
v_cndmask_b32 v44, v44, v27, s[50:51]
v_cndmask_b32 v33, v33, v27, s[52:53]
v_cndmask_b32 v45, v45, v27, s[52:53]
v_cndmask_b32 v34, v34, v27, s[54:55]
v_cndmask_b32 v46, v46, v27, s[54:55]
v_cndmask_b32 v35, v35, v27, s[56:57]
v_cndmask_b32 v47, v47, v27, s[56:57]
v_cmp_gt_i32 s[50:51], -16, v26
v_cmp_gt_i32 s[52:53], -15, v26
v_cmp_gt_i32 s[54:55], -14, v26
v_cmp_gt_i32 s[56:57], -13, v26
v_cndmask_b32 v36, v36, v27, s[50:51]
v_cndmask_b32 v37, v37, v27, s[52:53]
v_cndmask_b32 v38, v38, v27, s[54:55]
v_cndmask_b32 v39, v39, v27, s[56:57]
v_cmp_gt_i32 s[50:51], 16, v26
v_cmp_gt_i32 s[52:53], 17, v26
v_cmp_gt_i32 s[54:55], 18, v26
v_cmp_gt_i32 s[56:57], 19, v26
v_cndmask_b32 v40, v40, v27, s[50:51]
v_cndmask_b32 v41, v41, v27, s[52:53]
v_cndmask_b32 v42, v42, v27, s[54:55]
v_cndmask_b32 v43, v43, v27, s[56:57]
v_max3_f32 v96, v32, v33, v34
v_max3_f32 v96, v96, v35, v40
v_max3_f32 v96, v96, v41, v42
v_max_f32 v96, v96, v43
v_max3_f32 v97, v36, v37, v38
v_max3_f32 v97, v97, v39, v44
v_max3_f32 v97, v97, v45, v46
v_max_f32 v97, v97, v47
v_mov_b32 v98, v96
v_mov_b32 v99, v97
s_nop 0
v_permlane16_swap_b32 v96, v98
v_permlane16_swap_b32 v97, v99
v_max_f32 v96, v96, v98
v_max_f32 v97, v97, v99
v_mov_b32 v98, v96
v_mov_b32 v99, v97
s_nop 0
v_permlane32_swap_b32 v96, v98
v_permlane32_swap_b32 v97, v99
v_max_f32 v96, v96, v98
v_max_f32 v97, v97, v99
v_sub_f32 v104, 0, v96
v_sub_f32 v105, 0, v97
buffer_store_dwordx4 v[104:107], v2, s[20:23], s70 offen sc1
at_given:
v_mov_b32 v80, v104
v_mov_b32 v81, v104
v_mov_b32 v82, v104
v_mov_b32 v83, v104
v_add_f32 v32, v32, v104
v_add_f32 v33, v33, v104
v_add_f32 v34, v34, v104
v_add_f32 v35, v35, v104
v_add_f32 v40, v40, v104
v_add_f32 v41, v41, v104
v_add_f32 v42, v42, v104
v_add_f32 v43, v43, v104
v_mov_b32 v84, v105
v_mov_b32 v85, v105
v_mov_b32 v86, v105
v_mov_b32 v87, v105
v_add_f32 v36, v36, v105
v_add_f32 v37, v37, v105
v_add_f32 v38, v38, v105
v_add_f32 v39, v39, v105
v_add_f32 v44, v44, v105
v_add_f32 v45, v45, v105
v_add_f32 v46, v46, v105
v_add_f32 v47, v47, v105
s_cmp_eq_u32 s38, 0
s_cbranch_scc1 at_tail
at_loop:
s_waitcnt lgkmcnt(4)
v_mfma_f32_16x16x32_bf16 v[48:51], a[64:67], a[0:3], v[80:83]
ds_read_b128 a[96:99], v4 offset:40960
v_add_f32 v28, v28, v30
v_mfma_f32_16x16x32_bf16 v[48:51], a[68:71], a[4:7], v[48:51]
ds_read_b128 a[100:103], v4 offset:41984
v_add_f32 v29, v29, v31
v_mfma_f32_16x16x32_bf16 v[52:55], a[64:67], a[32:35], v[84:87]
s_waitcnt vmcnt(8)
v_mfma_f32_16x16x32_bf16 v[52:55], a[68:71], a[36:39], v[52:55]
ds_read_b128 a[104:107], v4 offset:43008
v_mfma_f32_16x16x32_bf16 v[48:51], a[72:75], a[8:11], v[48:51]
s_barrier
v_mfma_f32_16x16x32_bf16 v[48:51], a[76:79], a[12:15], v[48:51]
ds_read_b128 a[108:111], v4 offset:44032
v_mfma_f32_16x16x32_bf16 v[52:55], a[72:75], a[40:43], v[52:55]
s_add_u32 m0, s7, 0
v_mfma_f32_16x16x32_bf16 v[52:55], a[76:79], a[44:47], v[52:55]
s_waitcnt lgkmcnt(4)
buffer_load_dwordx4 v2, s[12:15], s32 offen offset:0 sc1 lds
v_mfma_f32_16x16x32_bf16 v[48:51], a[80:83], a[16:19], v[48:51]
ds_read_b128 a[112:115], v4 offset:45056
v_mfma_f32_16x16x32_bf16 v[48:51], a[84:87], a[20:23], v[48:51]
ds_read_b128 a[116:119], v4 offset:46080
v_mfma_f32_16x16x32_bf16 v[52:55], a[80:83], a[48:51], v[52:55]
v_exp_f32 v88, v32
v_mfma_f32_16x16x32_bf16 v[52:55], a[84:87], a[52:55], v[52:55]
ds_read_b128 a[120:123], v4 offset:47104
buffer_load_dwordx4 v2, s[12:15], s32 offen offset:1024 sc1 lds
v_mfma_f32_16x16x32_bf16 v[48:51], a[88:91], a[24:27], v[48:51]
v_exp_f32 v89, v33
v_mfma_f32_16x16x32_bf16 v[48:51], a[92:95], a[28:31], v[48:51]
ds_read_b128 a[124:127], v4 offset:48128
v_add_f32 v30, v88, v89
v_mfma_f32_16x16x32_bf16 v[52:55], a[88:91], a[56:59], v[52:55]
v_exp_f32 v90, v34
v_mfma_f32_16x16x32_bf16 v[52:55], a[92:95], a[60:63], v[52:55]
s_waitcnt lgkmcnt(4)
buffer_load_dwordx4 v2, s[12:15], s32 offen offset:2048 sc1 lds
v_mfma_f32_16x16x32_bf16 v[56:59], a[96:99], a[0:3], v[80:83]
ds_read_b128 a[64:67], v4 offset:49152
v_cvt_pk_bf16_f32 v64, v88, v89
v_mfma_f32_16x16x32_bf16 v[56:59], a[100:103], a[4:7], v[56:59]
ds_read_b128 a[68:71], v4 offset:50176
v_mfma_f32_16x16x32_bf16 v[60:63], a[96:99], a[32:35], v[84:87]
v_exp_f32 v91, v35
v_mfma_f32_16x16x32_bf16 v[60:63], a[100:103], a[36:39], v[60:63]
ds_read_b128 a[72:75], v4 offset:51200
buffer_load_dwordx4 v2, s[12:15], s32 offen offset:3072 sc1 lds
s_add_u32 s32, s32, 16384
v_mfma_f32_16x16x32_bf16 v[56:59], a[104:107], a[8:11], v[56:59]
v_exp_f32 v92, v36
v_mfma_f32_16x16x32_bf16 v[56:59], a[108:111], a[12:15], v[56:59]
ds_read_b128 a[76:79], v4 offset:52224
v_add_f32 v30, v30, v90
v_mfma_f32_16x16x32_bf16 v[60:63], a[104:107], a[40:43], v[60:63]
v_exp_f32 v93, v37
v_mfma_f32_16x16x32_bf16 v[60:63], a[108:111], a[44:47], v[60:63]
s_waitcnt lgkmcnt(4)
s_add_u32 m0, s7, 16384
v_mfma_f32_16x16x32_bf16 v[56:59], a[112:115], a[16:19], v[56:59]
ds_read_b128 a[80:83], v4 offset:53248
buffer_load_dwordx4 v2, s[12:15], s33 offen offset:0 sc1 lds
v_mfma_f32_16x16x32_bf16 v[56:59], a[116:119], a[20:23], v[56:59]
ds_read_b128 a[84:87], v4 offset:54272
v_add_f32 v30, v30, v91
v_mfma_f32_16x16x32_bf16 v[60:63], a[112:115], a[48:51], v[60:63]
v_exp_f32 v94, v38
v_mfma_f32_16x16x32_bf16 v[60:63], a[116:119], a[52:55], v[60:63]
ds_read_b128 a[88:91], v4 offset:55296
v_cvt_pk_bf16_f32 v65, v90, v91
v_mfma_f32_16x16x32_bf16 v[56:59], a[120:123], a[24:27], v[56:59]
buffer_load_dwordx4 v2, s[12:15], s33 offen offset:1024 sc1 lds
v_add_f32 v31, v92, v93
v_mfma_f32_16x16x32_bf16 v[56:59], a[124:127], a[28:31], v[56:59]
ds_read_b128 a[92:95], v4 offset:56320
v_cvt_pk_bf16_f32 v68, v92, v93
v_mfma_f32_16x16x32_bf16 v[60:63], a[120:123], a[56:59], v[60:63]
v_exp_f32 v95, v39
v_mfma_f32_16x16x32_bf16 v[60:63], a[124:127], a[60:63], v[60:63]
s_waitcnt lgkmcnt(4)
v_add_f32 v31, v31, v94
v_mfma_f32_16x16x32_bf16 v[128:131], a[64:67], v[72:75], v[128:131]
ds_read_b128 a[96:99], v4 offset:57344
buffer_load_dwordx4 v2, s[12:15], s33 offen offset:2048 sc1 lds
v_mfma_f32_16x16x32_bf16 v[132:135], a[64:67], v[76:79], v[132:135]
ds_read_b128 a[100:103], v4 offset:58368
v_add_f32 v31, v31, v95
v_mfma_f32_16x16x32_bf16 v[136:139], a[68:71], v[72:75], v[136:139]
v_exp_f32 v88, v40
v_mfma_f32_16x16x32_bf16 v[140:143], a[68:71], v[76:79], v[140:143]
ds_read_b128 a[104:107], v4 offset:59392
v_cvt_pk_bf16_f32 v69, v94, v95
v_mfma_f32_16x16x32_bf16 v[144:147], a[72:75], v[72:75], v[144:147]
buffer_load_dwordx4 v2, s[12:15], s33 offen offset:3072 sc1 lds
s_add_u32 s33, s33, 16384
v_mfma_f32_16x16x32_bf16 v[148:151], a[72:75], v[76:79], v[148:151]
ds_read_b128 a[108:111], v4 offset:60416
v_mfma_f32_16x16x32_bf16 v[152:155], a[76:79], v[72:75], v[152:155]
v_exp_f32 v89, v41
v_mfma_f32_16x16x32_bf16 v[156:159], a[76:79], v[76:79], v[156:159]
s_waitcnt lgkmcnt(4)
v_add_f32 v30, v30, v88
v_mfma_f32_16x16x32_bf16 v[160:163], a[80:83], v[72:75], v[160:163]
ds_read_b128 a[112:115], v4 offset:61440
v_add_f32 v30, v30, v89
v_mfma_f32_16x16x32_bf16 v[164:167], a[80:83], v[76:79], v[164:167]
ds_read_b128 a[116:119], v4 offset:62464
v_cvt_pk_bf16_f32 v66, v88, v89
v_mfma_f32_16x16x32_bf16 v[168:171], a[84:87], v[72:75], v[168:171]
v_exp_f32 v90, v42
v_mfma_f32_16x16x32_bf16 v[172:175], a[84:87], v[76:79], v[172:175]
ds_read_b128 a[120:123], v4 offset:63488
v_mfma_f32_16x16x32_bf16 v[176:179], a[88:91], v[72:75], v[176:179]
v_exp_f32 v91, v43
v_mfma_f32_16x16x32_bf16 v[180:183], a[88:91], v[76:79], v[180:183]
ds_read_b128 a[124:127], v4 offset:64512
v_add_f32 v30, v30, v90
v_mfma_f32_16x16x32_bf16 v[184:187], a[92:95], v[72:75], v[184:187]
v_exp_f32 v92, v44
v_mfma_f32_16x16x32_bf16 v[188:191], a[92:95], v[76:79], v[188:191]
s_waitcnt lgkmcnt(4)
v_add_f32 v30, v30, v91
v_mfma_f32_16x16x32_bf16 v[192:195], a[96:99], v[72:75], v[192:195]
ds_read_b128 a[64:67], v5 offset:0
v_cvt_pk_bf16_f32 v67, v90, v91
v_mfma_f32_16x16x32_bf16 v[196:199], a[96:99], v[76:79], v[196:199]
ds_read_b128 a[68:71], v5 offset:1024
v_mfma_f32_16x16x32_bf16 v[200:203], a[100:103], v[72:75], v[200:203]
v_exp_f32 v93, v45
v_mfma_f32_16x16x32_bf16 v[204:207], a[100:103], v[76:79], v[204:207]
ds_read_b128 a[72:75], v5 offset:2048
v_add_f32 v31, v31, v92
v_mfma_f32_16x16x32_bf16 v[208:211], a[104:107], v[72:75], v[208:211]
v_exp_f32 v94, v46
v_mfma_f32_16x16x32_bf16 v[212:215], a[104:107], v[76:79], v[212:215]
ds_read_b128 a[76:79], v5 offset:3072
v_add_f32 v31, v31, v93
v_mfma_f32_16x16x32_bf16 v[216:219], a[108:111], v[72:75], v[216:219]
v_exp_f32 v95, v47
v_mfma_f32_16x16x32_bf16 v[220:223], a[108:111], v[76:79], v[220:223]
s_waitcnt lgkmcnt(4)
v_cvt_pk_bf16_f32 v70, v92, v93
v_mfma_f32_16x16x32_bf16 v[224:227], a[112:115], v[72:75], v[224:227]
ds_read_b128 a[80:83], v5 offset:4096
v_add_f32 v31, v31, v94
v_mfma_f32_16x16x32_bf16 v[228:231], a[112:115], v[76:79], v[228:231]
ds_read_b128 a[84:87], v5 offset:5120
v_add_f32 v31, v31, v95
v_mfma_f32_16x16x32_bf16 v[232:235], a[116:119], v[72:75], v[232:235]
v_cvt_pk_bf16_f32 v71, v94, v95
v_add_f32 v96, v30, v31
v_mfma_f32_16x16x32_bf16 v[236:239], a[116:119], v[76:79], v[236:239]
ds_read_b128 a[88:91], v5 offset:6144
v_cmp_lt_f32 vcc, s42, v96
v_mfma_f32_16x16x32_bf16 v[240:243], a[120:123], v[72:75], v[240:243]
v_mfma_f32_16x16x32_bf16 v[244:247], a[120:123], v[76:79], v[244:247]
ds_read_b128 a[92:95], v5 offset:7168
v_mfma_f32_16x16x32_bf16 v[248:251], a[124:127], v[72:75], v[248:251]
v_mfma_f32_16x16x32_bf16 v[252:255], a[124:127], v[76:79], v[252:255]
s_cbranch_vccnz at_stub0
at_ret0:
s_waitcnt lgkmcnt(4)
v_mfma_f32_16x16x32_bf16 v[32:35], a[64:67], a[0:3], v[80:83]
ds_read_b128 a[96:99], v5 offset:8192
v_add_f32 v28, v28, v30
v_mfma_f32_16x16x32_bf16 v[32:35], a[68:71], a[4:7], v[32:35]
ds_read_b128 a[100:103], v5 offset:9216
v_add_f32 v29, v29, v31
v_mfma_f32_16x16x32_bf16 v[36:39], a[64:67], a[32:35], v[84:87]
s_waitcnt vmcnt(8)
s_cmp_eq_u32 s66, 0
s_cbranch_scc0 at_qflag
at_qret:
v_mfma_f32_16x16x32_bf16 v[36:39], a[68:71], a[36:39], v[36:39]
ds_read_b128 a[104:107], v5 offset:10240
v_mfma_f32_16x16x32_bf16 v[32:35], a[72:75], a[8:11], v[32:35]
s_barrier
v_mfma_f32_16x16x32_bf16 v[32:35], a[76:79], a[12:15], v[32:35]
ds_read_b128 a[108:111], v5 offset:11264
v_mfma_f32_16x16x32_bf16 v[36:39], a[72:75], a[40:43], v[36:39]
s_add_u32 m0, s7, 32768
v_mfma_f32_16x16x32_bf16 v[36:39], a[76:79], a[44:47], v[36:39]
s_waitcnt lgkmcnt(4)
buffer_load_dwordx4 v2, s[12:15], s32 offen offset:0 sc1 lds
v_mfma_f32_16x16x32_bf16 v[32:35], a[80:83], a[16:19], v[32:35]
ds_read_b128 a[112:115], v5 offset:12288
v_mfma_f32_16x16x32_bf16 v[32:35], a[84:87], a[20:23], v[32:35]
ds_read_b128 a[116:119], v5 offset:13312
v_mfma_f32_16x16x32_bf16 v[36:39], a[80:83], a[48:51], v[36:39]
v_exp_f32 v88, v48
v_mfma_f32_16x16x32_bf16 v[36:39], a[84:87], a[52:55], v[36:39]
ds_read_b128 a[120:123], v5 offset:14336
buffer_load_dwordx4 v2, s[12:15], s32 offen offset:1024 sc1 lds
v_mfma_f32_16x16x32_bf16 v[32:35], a[88:91], a[24:27], v[32:35]
v_exp_f32 v89, v49
v_mfma_f32_16x16x32_bf16 v[32:35], a[92:95], a[28:31], v[32:35]
ds_read_b128 a[124:127], v5 offset:15360
v_add_f32 v30, v88, v89
v_mfma_f32_16x16x32_bf16 v[36:39], a[88:91], a[56:59], v[36:39]
v_exp_f32 v90, v50
v_mfma_f32_16x16x32_bf16 v[36:39], a[92:95], a[60:63], v[36:39]
s_waitcnt lgkmcnt(4)
buffer_load_dwordx4 v2, s[12:15], s32 offen offset:2048 sc1 lds
v_mfma_f32_16x16x32_bf16 v[40:43], a[96:99], a[0:3], v[80:83]
ds_read_b128 a[64:67], v5 offset:16384
v_cvt_pk_bf16_f32 v72, v88, v89
v_mfma_f32_16x16x32_bf16 v[40:43], a[100:103], a[4:7], v[40:43]
ds_read_b128 a[68:71], v5 offset:17408
v_mfma_f32_16x16x32_bf16 v[44:47], a[96:99], a[32:35], v[84:87]
v_exp_f32 v91, v51
v_mfma_f32_16x16x32_bf16 v[44:47], a[100:103], a[36:39], v[44:47]
ds_read_b128 a[72:75], v5 offset:18432
buffer_load_dwordx4 v2, s[12:15], s32 offen offset:3072 sc1 lds
s_add_u32 s32, s32, 16384
v_mfma_f32_16x16x32_bf16 v[40:43], a[104:107], a[8:11], v[40:43]
v_exp_f32 v92, v52
v_mfma_f32_16x16x32_bf16 v[40:43], a[108:111], a[12:15], v[40:43]
ds_read_b128 a[76:79], v5 offset:19456
v_add_f32 v30, v30, v90
v_mfma_f32_16x16x32_bf16 v[44:47], a[104:107], a[40:43], v[44:47]
v_exp_f32 v93, v53
v_mfma_f32_16x16x32_bf16 v[44:47], a[108:111], a[44:47], v[44:47]
s_waitcnt lgkmcnt(4)
s_add_u32 m0, s7, 49152
v_mfma_f32_16x16x32_bf16 v[40:43], a[112:115], a[16:19], v[40:43]
ds_read_b128 a[80:83], v5 offset:20480
buffer_load_dwordx4 v2, s[12:15], s33 offen offset:0 sc1 lds
v_mfma_f32_16x16x32_bf16 v[40:43], a[116:119], a[20:23], v[40:43]
ds_read_b128 a[84:87], v5 offset:21504
v_add_f32 v30, v30, v91
v_mfma_f32_16x16x32_bf16 v[44:47], a[112:115], a[48:51], v[44:47]
v_exp_f32 v94, v54
v_mfma_f32_16x16x32_bf16 v[44:47], a[116:119], a[52:55], v[44:47]
ds_read_b128 a[88:91], v5 offset:22528
v_cvt_pk_bf16_f32 v73, v90, v91
v_mfma_f32_16x16x32_bf16 v[40:43], a[120:123], a[24:27], v[40:43]
buffer_load_dwordx4 v2, s[12:15], s33 offen offset:1024 sc1 lds
v_add_f32 v31, v92, v93
v_mfma_f32_16x16x32_bf16 v[40:43], a[124:127], a[28:31], v[40:43]
ds_read_b128 a[92:95], v5 offset:23552
v_cvt_pk_bf16_f32 v76, v92, v93
v_mfma_f32_16x16x32_bf16 v[44:47], a[120:123], a[56:59], v[44:47]
v_exp_f32 v95, v55
v_mfma_f32_16x16x32_bf16 v[44:47], a[124:127], a[60:63], v[44:47]
s_waitcnt lgkmcnt(4)
v_add_f32 v31, v31, v94
v_mfma_f32_16x16x32_bf16 v[128:131], a[64:67], v[64:67], v[128:131]
ds_read_b128 a[96:99], v5 offset:24576
buffer_load_dwordx4 v2, s[12:15], s33 offen offset:2048 sc1 lds
v_mfma_f32_16x16x32_bf16 v[132:135], a[64:67], v[68:71], v[132:135]
ds_read_b128 a[100:103], v5 offset:25600
v_add_f32 v31, v31, v95
v_mfma_f32_16x16x32_bf16 v[136:139], a[68:71], v[64:67], v[136:139]
v_exp_f32 v88, v56
v_mfma_f32_16x16x32_bf16 v[140:143], a[68:71], v[68:71], v[140:143]
ds_read_b128 a[104:107], v5 offset:26624
v_cvt_pk_bf16_f32 v77, v94, v95
v_mfma_f32_16x16x32_bf16 v[144:147], a[72:75], v[64:67], v[144:147]
buffer_load_dwordx4 v2, s[12:15], s33 offen offset:3072 sc1 lds
s_add_u32 s33, s33, 16384
v_mfma_f32_16x16x32_bf16 v[148:151], a[72:75], v[68:71], v[148:151]
ds_read_b128 a[108:111], v5 offset:27648
v_mfma_f32_16x16x32_bf16 v[152:155], a[76:79], v[64:67], v[152:155]
v_exp_f32 v89, v57
v_mfma_f32_16x16x32_bf16 v[156:159], a[76:79], v[68:71], v[156:159]
s_waitcnt lgkmcnt(4)
v_add_f32 v30, v30, v88
v_mfma_f32_16x16x32_bf16 v[160:163], a[80:83], v[64:67], v[160:163]
ds_read_b128 a[112:115], v5 offset:28672
v_add_f32 v30, v30, v89
v_mfma_f32_16x16x32_bf16 v[164:167], a[80:83], v[68:71], v[164:167]
ds_read_b128 a[116:119], v5 offset:29696
v_cvt_pk_bf16_f32 v74, v88, v89
v_mfma_f32_16x16x32_bf16 v[168:171], a[84:87], v[64:67], v[168:171]
v_exp_f32 v90, v58
v_mfma_f32_16x16x32_bf16 v[172:175], a[84:87], v[68:71], v[172:175]
ds_read_b128 a[120:123], v5 offset:30720
v_mfma_f32_16x16x32_bf16 v[176:179], a[88:91], v[64:67], v[176:179]
v_exp_f32 v91, v59
v_mfma_f32_16x16x32_bf16 v[180:183], a[88:91], v[68:71], v[180:183]
ds_read_b128 a[124:127], v5 offset:31744
v_add_f32 v30, v30, v90
v_mfma_f32_16x16x32_bf16 v[184:187], a[92:95], v[64:67], v[184:187]
v_exp_f32 v92, v60
v_mfma_f32_16x16x32_bf16 v[188:191], a[92:95], v[68:71], v[188:191]
s_waitcnt lgkmcnt(4)
v_add_f32 v30, v30, v91
v_mfma_f32_16x16x32_bf16 v[192:195], a[96:99], v[64:67], v[192:195]
ds_read_b128 a[64:67], v5 offset:32768
v_cvt_pk_bf16_f32 v75, v90, v91
v_mfma_f32_16x16x32_bf16 v[196:199], a[96:99], v[68:71], v[196:199]
ds_read_b128 a[68:71], v5 offset:33792
v_mfma_f32_16x16x32_bf16 v[200:203], a[100:103], v[64:67], v[200:203]
v_exp_f32 v93, v61
v_mfma_f32_16x16x32_bf16 v[204:207], a[100:103], v[68:71], v[204:207]
ds_read_b128 a[72:75], v5 offset:34816
v_add_f32 v31, v31, v92
v_mfma_f32_16x16x32_bf16 v[208:211], a[104:107], v[64:67], v[208:211]
v_exp_f32 v94, v62
v_mfma_f32_16x16x32_bf16 v[212:215], a[104:107], v[68:71], v[212:215]
ds_read_b128 a[76:79], v5 offset:35840
v_add_f32 v31, v31, v93
v_mfma_f32_16x16x32_bf16 v[216:219], a[108:111], v[64:67], v[216:219]
v_exp_f32 v95, v63
v_mfma_f32_16x16x32_bf16 v[220:223], a[108:111], v[68:71], v[220:223]
s_waitcnt lgkmcnt(4)
v_cvt_pk_bf16_f32 v78, v92, v93
v_mfma_f32_16x16x32_bf16 v[224:227], a[112:115], v[64:67], v[224:227]
ds_read_b128 a[80:83], v5 offset:36864
v_add_f32 v31, v31, v94
v_mfma_f32_16x16x32_bf16 v[228:231], a[112:115], v[68:71], v[228:231]
ds_read_b128 a[84:87], v5 offset:37888
v_add_f32 v31, v31, v95
v_mfma_f32_16x16x32_bf16 v[232:235], a[116:119], v[64:67], v[232:235]
v_cvt_pk_bf16_f32 v79, v94, v95
v_add_f32 v96, v30, v31
v_mfma_f32_16x16x32_bf16 v[236:239], a[116:119], v[68:71], v[236:239]
ds_read_b128 a[88:91], v5 offset:38912
v_cmp_lt_f32 vcc, s42, v96
v_mfma_f32_16x16x32_bf16 v[240:243], a[120:123], v[64:67], v[240:243]
v_mfma_f32_16x16x32_bf16 v[244:247], a[120:123], v[68:71], v[244:247]
ds_read_b128 a[92:95], v5 offset:39936
v_mfma_f32_16x16x32_bf16 v[248:251], a[124:127], v[64:67], v[248:251]
v_mfma_f32_16x16x32_bf16 v[252:255], a[124:127], v[68:71], v[252:255]
s_cbranch_vccnz at_stub1
at_ret1:
s_cmp_eq_u32 s38, s49
s_cbranch_scc1 at_half
s_waitcnt lgkmcnt(4)
v_mfma_f32_16x16x32_bf16 v[48:51], a[64:67], a[0:3], v[80:83]
ds_read_b128 a[96:99], v5 offset:40960
v_add_f32 v28, v28, v30
v_mfma_f32_16x16x32_bf16 v[48:51], a[68:71], a[4:7], v[48:51]
ds_read_b128 a[100:103], v5 offset:41984
v_add_f32 v29, v29, v31
v_mfma_f32_16x16x32_bf16 v[52:55], a[64:67], a[32:35], v[84:87]
s_waitcnt vmcnt(8)
v_mfma_f32_16x16x32_bf16 v[52:55], a[68:71], a[36:39], v[52:55]
ds_read_b128 a[104:107], v5 offset:43008
v_mfma_f32_16x16x32_bf16 v[48:51], a[72:75], a[8:11], v[48:51]
s_barrier
v_mfma_f32_16x16x32_bf16 v[48:51], a[76:79], a[12:15], v[48:51]
ds_read_b128 a[108:111], v5 offset:44032
v_mfma_f32_16x16x32_bf16 v[52:55], a[72:75], a[40:43], v[52:55]
s_add_u32 m0, s36, 0
v_mfma_f32_16x16x32_bf16 v[52:55], a[76:79], a[44:47], v[52:55]
s_waitcnt lgkmcnt(4)
buffer_load_dwordx4 v2, s[12:15], s32 offen offset:0 sc1 lds
v_mfma_f32_16x16x32_bf16 v[48:51], a[80:83], a[16:19], v[48:51]
ds_read_b128 a[112:115], v5 offset:45056
v_mfma_f32_16x16x32_bf16 v[48:51], a[84:87], a[20:23], v[48:51]
ds_read_b128 a[116:119], v5 offset:46080
v_mfma_f32_16x16x32_bf16 v[52:55], a[80:83], a[48:51], v[52:55]
v_exp_f32 v88, v32
v_mfma_f32_16x16x32_bf16 v[52:55], a[84:87], a[52:55], v[52:55]
ds_read_b128 a[120:123], v5 offset:47104
buffer_load_dwordx4 v2, s[12:15], s32 offen offset:1024 sc1 lds
v_mfma_f32_16x16x32_bf16 v[48:51], a[88:91], a[24:27], v[48:51]
v_exp_f32 v89, v33
v_mfma_f32_16x16x32_bf16 v[48:51], a[92:95], a[28:31], v[48:51]
ds_read_b128 a[124:127], v5 offset:48128
v_add_f32 v30, v88, v89
v_mfma_f32_16x16x32_bf16 v[52:55], a[88:91], a[56:59], v[52:55]
v_exp_f32 v90, v34
v_mfma_f32_16x16x32_bf16 v[52:55], a[92:95], a[60:63], v[52:55]
s_waitcnt lgkmcnt(4)
buffer_load_dwordx4 v2, s[12:15], s32 offen offset:2048 sc1 lds
v_mfma_f32_16x16x32_bf16 v[56:59], a[96:99], a[0:3], v[80:83]
ds_read_b128 a[64:67], v5 offset:49152
v_cvt_pk_bf16_f32 v64, v88, v89
v_mfma_f32_16x16x32_bf16 v[56:59], a[100:103], a[4:7], v[56:59]
ds_read_b128 a[68:71], v5 offset:50176
v_mfma_f32_16x16x32_bf16 v[60:63], a[96:99], a[32:35], v[84:87]
v_exp_f32 v91, v35
v_mfma_f32_16x16x32_bf16 v[60:63], a[100:103], a[36:39], v[60:63]
ds_read_b128 a[72:75], v5 offset:51200
buffer_load_dwordx4 v2, s[12:15], s32 offen offset:3072 sc1 lds
s_add_u32 s32, s32, 16384
v_mfma_f32_16x16x32_bf16 v[56:59], a[104:107], a[8:11], v[56:59]
v_exp_f32 v92, v36
v_mfma_f32_16x16x32_bf16 v[56:59], a[108:111], a[12:15], v[56:59]
ds_read_b128 a[76:79], v5 offset:52224
v_add_f32 v30, v30, v90
v_mfma_f32_16x16x32_bf16 v[60:63], a[104:107], a[40:43], v[60:63]
v_exp_f32 v93, v37
v_mfma_f32_16x16x32_bf16 v[60:63], a[108:111], a[44:47], v[60:63]
s_waitcnt lgkmcnt(4)
s_add_u32 m0, s36, 16384
v_mfma_f32_16x16x32_bf16 v[56:59], a[112:115], a[16:19], v[56:59]
ds_read_b128 a[80:83], v5 offset:53248
buffer_load_dwordx4 v2, s[12:15], s33 offen offset:0 sc1 lds
v_mfma_f32_16x16x32_bf16 v[56:59], a[116:119], a[20:23], v[56:59]
ds_read_b128 a[84:87], v5 offset:54272
v_add_f32 v30, v30, v91
v_mfma_f32_16x16x32_bf16 v[60:63], a[112:115], a[48:51], v[60:63]
v_exp_f32 v94, v38
v_mfma_f32_16x16x32_bf16 v[60:63], a[116:119], a[52:55], v[60:63]
ds_read_b128 a[88:91], v5 offset:55296
v_cvt_pk_bf16_f32 v65, v90, v91
v_mfma_f32_16x16x32_bf16 v[56:59], a[120:123], a[24:27], v[56:59]
buffer_load_dwordx4 v2, s[12:15], s33 offen offset:1024 sc1 lds
v_add_f32 v31, v92, v93
v_mfma_f32_16x16x32_bf16 v[56:59], a[124:127], a[28:31], v[56:59]
ds_read_b128 a[92:95], v5 offset:56320
v_cvt_pk_bf16_f32 v68, v92, v93
v_mfma_f32_16x16x32_bf16 v[60:63], a[120:123], a[56:59], v[60:63]
v_exp_f32 v95, v39
v_mfma_f32_16x16x32_bf16 v[60:63], a[124:127], a[60:63], v[60:63]
s_waitcnt lgkmcnt(4)
v_add_f32 v31, v31, v94
v_mfma_f32_16x16x32_bf16 v[128:131], a[64:67], v[72:75], v[128:131]
ds_read_b128 a[96:99], v5 offset:57344
buffer_load_dwordx4 v2, s[12:15], s33 offen offset:2048 sc1 lds
v_mfma_f32_16x16x32_bf16 v[132:135], a[64:67], v[76:79], v[132:135]
ds_read_b128 a[100:103], v5 offset:58368
v_add_f32 v31, v31, v95
v_mfma_f32_16x16x32_bf16 v[136:139], a[68:71], v[72:75], v[136:139]
v_exp_f32 v88, v40
v_mfma_f32_16x16x32_bf16 v[140:143], a[68:71], v[76:79], v[140:143]
ds_read_b128 a[104:107], v5 offset:59392
v_cvt_pk_bf16_f32 v69, v94, v95
v_mfma_f32_16x16x32_bf16 v[144:147], a[72:75], v[72:75], v[144:147]
buffer_load_dwordx4 v2, s[12:15], s33 offen offset:3072 sc1 lds
s_add_u32 s33, s33, 16384
v_mfma_f32_16x16x32_bf16 v[148:151], a[72:75], v[76:79], v[148:151]
ds_read_b128 a[108:111], v5 offset:60416
v_mfma_f32_16x16x32_bf16 v[152:155], a[76:79], v[72:75], v[152:155]
v_exp_f32 v89, v41
v_mfma_f32_16x16x32_bf16 v[156:159], a[76:79], v[76:79], v[156:159]
s_waitcnt lgkmcnt(4)
v_add_f32 v30, v30, v88
v_mfma_f32_16x16x32_bf16 v[160:163], a[80:83], v[72:75], v[160:163]
ds_read_b128 a[112:115], v5 offset:61440
v_add_f32 v30, v30, v89
v_mfma_f32_16x16x32_bf16 v[164:167], a[80:83], v[76:79], v[164:167]
ds_read_b128 a[116:119], v5 offset:62464
v_cvt_pk_bf16_f32 v66, v88, v89
v_mfma_f32_16x16x32_bf16 v[168:171], a[84:87], v[72:75], v[168:171]
v_exp_f32 v90, v42
v_mfma_f32_16x16x32_bf16 v[172:175], a[84:87], v[76:79], v[172:175]
ds_read_b128 a[120:123], v5 offset:63488
v_mfma_f32_16x16x32_bf16 v[176:179], a[88:91], v[72:75], v[176:179]
v_exp_f32 v91, v43
v_mfma_f32_16x16x32_bf16 v[180:183], a[88:91], v[76:79], v[180:183]
ds_read_b128 a[124:127], v5 offset:64512
v_add_f32 v30, v30, v90
v_mfma_f32_16x16x32_bf16 v[184:187], a[92:95], v[72:75], v[184:187]
v_exp_f32 v92, v44
v_mfma_f32_16x16x32_bf16 v[188:191], a[92:95], v[76:79], v[188:191]
s_waitcnt lgkmcnt(4)
v_add_f32 v30, v30, v91
v_mfma_f32_16x16x32_bf16 v[192:195], a[96:99], v[72:75], v[192:195]
ds_read_b128 a[64:67], v4 offset:0
v_cvt_pk_bf16_f32 v67, v90, v91
v_mfma_f32_16x16x32_bf16 v[196:199], a[96:99], v[76:79], v[196:199]
ds_read_b128 a[68:71], v4 offset:1024
v_mfma_f32_16x16x32_bf16 v[200:203], a[100:103], v[72:75], v[200:203]
v_exp_f32 v93, v45
v_mfma_f32_16x16x32_bf16 v[204:207], a[100:103], v[76:79], v[204:207]
ds_read_b128 a[72:75], v4 offset:2048
v_add_f32 v31, v31, v92
v_mfma_f32_16x16x32_bf16 v[208:211], a[104:107], v[72:75], v[208:211]
v_exp_f32 v94, v46
v_mfma_f32_16x16x32_bf16 v[212:215], a[104:107], v[76:79], v[212:215]
ds_read_b128 a[76:79], v4 offset:3072
v_add_f32 v31, v31, v93
v_mfma_f32_16x16x32_bf16 v[216:219], a[108:111], v[72:75], v[216:219]
v_exp_f32 v95, v47
v_mfma_f32_16x16x32_bf16 v[220:223], a[108:111], v[76:79], v[220:223]
s_waitcnt lgkmcnt(4)
v_cvt_pk_bf16_f32 v70, v92, v93
v_mfma_f32_16x16x32_bf16 v[224:227], a[112:115], v[72:75], v[224:227]
ds_read_b128 a[80:83], v4 offset:4096
v_add_f32 v31, v31, v94
v_mfma_f32_16x16x32_bf16 v[228:231], a[112:115], v[76:79], v[228:231]
ds_read_b128 a[84:87], v4 offset:5120
v_add_f32 v31, v31, v95
v_mfma_f32_16x16x32_bf16 v[232:235], a[116:119], v[72:75], v[232:235]
v_cvt_pk_bf16_f32 v71, v94, v95
v_add_f32 v96, v30, v31
v_mfma_f32_16x16x32_bf16 v[236:239], a[116:119], v[76:79], v[236:239]
ds_read_b128 a[88:91], v4 offset:6144
v_cmp_lt_f32 vcc, s42, v96
v_mfma_f32_16x16x32_bf16 v[240:243], a[120:123], v[72:75], v[240:243]
v_mfma_f32_16x16x32_bf16 v[244:247], a[120:123], v[76:79], v[244:247]
ds_read_b128 a[92:95], v4 offset:7168
v_mfma_f32_16x16x32_bf16 v[248:251], a[124:127], v[72:75], v[248:251]
v_mfma_f32_16x16x32_bf16 v[252:255], a[124:127], v[76:79], v[252:255]
s_cbranch_vccnz at_stub2
at_ret2:
s_waitcnt lgkmcnt(4)
v_mfma_f32_16x16x32_bf16 v[32:35], a[64:67], a[0:3], v[80:83]
ds_read_b128 a[96:99], v4 offset:8192
v_add_f32 v28, v28, v30
v_mfma_f32_16x16x32_bf16 v[32:35], a[68:71], a[4:7], v[32:35]
ds_read_b128 a[100:103], v4 offset:9216
v_add_f32 v29, v29, v31
v_mfma_f32_16x16x32_bf16 v[36:39], a[64:67], a[32:35], v[84:87]
s_waitcnt vmcnt(8)
s_cmp_eq_u32 s71, 0
s_cbranch_scc0 at_f
at_fspun:
v_mfma_f32_16x16x32_bf16 v[36:39], a[68:71], a[36:39], v[36:39]
ds_read_b128 a[104:107], v4 offset:10240
v_mfma_f32_16x16x32_bf16 v[32:35], a[72:75], a[8:11], v[32:35]
s_barrier
v_mfma_f32_16x16x32_bf16 v[32:35], a[76:79], a[12:15], v[32:35]
ds_read_b128 a[108:111], v4 offset:11264
v_mfma_f32_16x16x32_bf16 v[36:39], a[72:75], a[40:43], v[36:39]
s_add_u32 m0, s36, 32768
v_mfma_f32_16x16x32_bf16 v[36:39], a[76:79], a[44:47], v[36:39]
s_waitcnt lgkmcnt(4)
buffer_load_dwordx4 v2, s[12:15], s32 offen offset:0 sc1 lds
v_mfma_f32_16x16x32_bf16 v[32:35], a[80:83], a[16:19], v[32:35]
ds_read_b128 a[112:115], v4 offset:12288
v_mfma_f32_16x16x32_bf16 v[32:35], a[84:87], a[20:23], v[32:35]
ds_read_b128 a[116:119], v4 offset:13312
v_mfma_f32_16x16x32_bf16 v[36:39], a[80:83], a[48:51], v[36:39]
v_exp_f32 v88, v48
v_mfma_f32_16x16x32_bf16 v[36:39], a[84:87], a[52:55], v[36:39]
ds_read_b128 a[120:123], v4 offset:14336
buffer_load_dwordx4 v2, s[12:15], s32 offen offset:1024 sc1 lds
v_mfma_f32_16x16x32_bf16 v[32:35], a[88:91], a[24:27], v[32:35]
v_exp_f32 v89, v49
v_mfma_f32_16x16x32_bf16 v[32:35], a[92:95], a[28:31], v[32:35]
ds_read_b128 a[124:127], v4 offset:15360
v_add_f32 v30, v88, v89
v_mfma_f32_16x16x32_bf16 v[36:39], a[88:91], a[56:59], v[36:39]
v_exp_f32 v90, v50
v_mfma_f32_16x16x32_bf16 v[36:39], a[92:95], a[60:63], v[36:39]
s_waitcnt lgkmcnt(4)
buffer_load_dwordx4 v2, s[12:15], s32 offen offset:2048 sc1 lds
v_mfma_f32_16x16x32_bf16 v[40:43], a[96:99], a[0:3], v[80:83]
ds_read_b128 a[64:67], v4 offset:16384
v_cvt_pk_bf16_f32 v72, v88, v89
v_mfma_f32_16x16x32_bf16 v[40:43], a[100:103], a[4:7], v[40:43]
ds_read_b128 a[68:71], v4 offset:17408
v_mfma_f32_16x16x32_bf16 v[44:47], a[96:99], a[32:35], v[84:87]
v_exp_f32 v91, v51
v_mfma_f32_16x16x32_bf16 v[44:47], a[100:103], a[36:39], v[44:47]
ds_read_b128 a[72:75], v4 offset:18432
buffer_load_dwordx4 v2, s[12:15], s32 offen offset:3072 sc1 lds
s_add_u32 s32, s32, 16384
v_mfma_f32_16x16x32_bf16 v[40:43], a[104:107], a[8:11], v[40:43]
v_exp_f32 v92, v52
v_mfma_f32_16x16x32_bf16 v[40:43], a[108:111], a[12:15], v[40:43]
ds_read_b128 a[76:79], v4 offset:19456
v_add_f32 v30, v30, v90
v_mfma_f32_16x16x32_bf16 v[44:47], a[104:107], a[40:43], v[44:47]
v_exp_f32 v93, v53
v_mfma_f32_16x16x32_bf16 v[44:47], a[108:111], a[44:47], v[44:47]
s_waitcnt lgkmcnt(4)
s_add_u32 m0, s36, 49152
v_mfma_f32_16x16x32_bf16 v[40:43], a[112:115], a[16:19], v[40:43]
ds_read_b128 a[80:83], v4 offset:20480
buffer_load_dwordx4 v2, s[12:15], s33 offen offset:0 sc1 lds
v_mfma_f32_16x16x32_bf16 v[40:43], a[116:119], a[20:23], v[40:43]
ds_read_b128 a[84:87], v4 offset:21504
v_add_f32 v30, v30, v91
v_mfma_f32_16x16x32_bf16 v[44:47], a[112:115], a[48:51], v[44:47]
v_exp_f32 v94, v54
v_mfma_f32_16x16x32_bf16 v[44:47], a[116:119], a[52:55], v[44:47]
ds_read_b128 a[88:91], v4 offset:22528
v_cvt_pk_bf16_f32 v73, v90, v91
v_mfma_f32_16x16x32_bf16 v[40:43], a[120:123], a[24:27], v[40:43]
buffer_load_dwordx4 v2, s[12:15], s33 offen offset:1024 sc1 lds
v_add_f32 v31, v92, v93
v_mfma_f32_16x16x32_bf16 v[40:43], a[124:127], a[28:31], v[40:43]
ds_read_b128 a[92:95], v4 offset:23552
v_cvt_pk_bf16_f32 v76, v92, v93
v_mfma_f32_16x16x32_bf16 v[44:47], a[120:123], a[56:59], v[44:47]
v_exp_f32 v95, v55
v_mfma_f32_16x16x32_bf16 v[44:47], a[124:127], a[60:63], v[44:47]
s_waitcnt lgkmcnt(4)
v_add_f32 v31, v31, v94
v_mfma_f32_16x16x32_bf16 v[128:131], a[64:67], v[64:67], v[128:131]
ds_read_b128 a[96:99], v4 offset:24576
buffer_load_dwordx4 v2, s[12:15], s33 offen offset:2048 sc1 lds
v_mfma_f32_16x16x32_bf16 v[132:135], a[64:67], v[68:71], v[132:135]
ds_read_b128 a[100:103], v4 offset:25600
v_add_f32 v31, v31, v95
v_mfma_f32_16x16x32_bf16 v[136:139], a[68:71], v[64:67], v[136:139]
v_exp_f32 v88, v56
v_mfma_f32_16x16x32_bf16 v[140:143], a[68:71], v[68:71], v[140:143]
ds_read_b128 a[104:107], v4 offset:26624
v_cvt_pk_bf16_f32 v77, v94, v95
v_mfma_f32_16x16x32_bf16 v[144:147], a[72:75], v[64:67], v[144:147]
buffer_load_dwordx4 v2, s[12:15], s33 offen offset:3072 sc1 lds
s_add_u32 s33, s33, 16384
v_mfma_f32_16x16x32_bf16 v[148:151], a[72:75], v[68:71], v[148:151]
ds_read_b128 a[108:111], v4 offset:27648
v_mfma_f32_16x16x32_bf16 v[152:155], a[76:79], v[64:67], v[152:155]
v_exp_f32 v89, v57
v_mfma_f32_16x16x32_bf16 v[156:159], a[76:79], v[68:71], v[156:159]
s_waitcnt lgkmcnt(4)
v_add_f32 v30, v30, v88
v_mfma_f32_16x16x32_bf16 v[160:163], a[80:83], v[64:67], v[160:163]
ds_read_b128 a[112:115], v4 offset:28672
v_add_f32 v30, v30, v89
v_mfma_f32_16x16x32_bf16 v[164:167], a[80:83], v[68:71], v[164:167]
ds_read_b128 a[116:119], v4 offset:29696
v_cvt_pk_bf16_f32 v74, v88, v89
v_mfma_f32_16x16x32_bf16 v[168:171], a[84:87], v[64:67], v[168:171]
v_exp_f32 v90, v58
v_mfma_f32_16x16x32_bf16 v[172:175], a[84:87], v[68:71], v[172:175]
ds_read_b128 a[120:123], v4 offset:30720
v_mfma_f32_16x16x32_bf16 v[176:179], a[88:91], v[64:67], v[176:179]
v_exp_f32 v91, v59
v_mfma_f32_16x16x32_bf16 v[180:183], a[88:91], v[68:71], v[180:183]
ds_read_b128 a[124:127], v4 offset:31744
v_add_f32 v30, v30, v90
v_mfma_f32_16x16x32_bf16 v[184:187], a[92:95], v[64:67], v[184:187]
v_exp_f32 v92, v60
v_mfma_f32_16x16x32_bf16 v[188:191], a[92:95], v[68:71], v[188:191]
s_waitcnt lgkmcnt(4)
v_add_f32 v30, v30, v91
v_mfma_f32_16x16x32_bf16 v[192:195], a[96:99], v[64:67], v[192:195]
ds_read_b128 a[64:67], v4 offset:32768
v_cvt_pk_bf16_f32 v75, v90, v91
v_mfma_f32_16x16x32_bf16 v[196:199], a[96:99], v[68:71], v[196:199]
ds_read_b128 a[68:71], v4 offset:33792
v_mfma_f32_16x16x32_bf16 v[200:203], a[100:103], v[64:67], v[200:203]
v_exp_f32 v93, v61
v_mfma_f32_16x16x32_bf16 v[204:207], a[100:103], v[68:71], v[204:207]
ds_read_b128 a[72:75], v4 offset:34816
v_add_f32 v31, v31, v92
v_mfma_f32_16x16x32_bf16 v[208:211], a[104:107], v[64:67], v[208:211]
v_exp_f32 v94, v62
v_mfma_f32_16x16x32_bf16 v[212:215], a[104:107], v[68:71], v[212:215]
ds_read_b128 a[76:79], v4 offset:35840
v_add_f32 v31, v31, v93
v_mfma_f32_16x16x32_bf16 v[216:219], a[108:111], v[64:67], v[216:219]
v_exp_f32 v95, v63
v_mfma_f32_16x16x32_bf16 v[220:223], a[108:111], v[68:71], v[220:223]
s_waitcnt lgkmcnt(4)
v_cvt_pk_bf16_f32 v78, v92, v93
v_mfma_f32_16x16x32_bf16 v[224:227], a[112:115], v[64:67], v[224:227]
ds_read_b128 a[80:83], v4 offset:36864
v_add_f32 v31, v31, v94
v_mfma_f32_16x16x32_bf16 v[228:231], a[112:115], v[68:71], v[228:231]
ds_read_b128 a[84:87], v4 offset:37888
v_add_f32 v31, v31, v95
v_mfma_f32_16x16x32_bf16 v[232:235], a[116:119], v[64:67], v[232:235]
v_cvt_pk_bf16_f32 v79, v94, v95
v_add_f32 v96, v30, v31
v_mfma_f32_16x16x32_bf16 v[236:239], a[116:119], v[68:71], v[236:239]
ds_read_b128 a[88:91], v4 offset:38912
v_cmp_lt_f32 vcc, s42, v96
v_mfma_f32_16x16x32_bf16 v[240:243], a[120:123], v[64:67], v[240:243]
v_mfma_f32_16x16x32_bf16 v[244:247], a[120:123], v[68:71], v[244:247]
ds_read_b128 a[92:95], v4 offset:39936
v_mfma_f32_16x16x32_bf16 v[248:251], a[124:127], v[64:67], v[248:251]
v_mfma_f32_16x16x32_bf16 v[252:255], a[124:127], v[68:71], v[252:255]
s_cbranch_vccnz at_stub3
at_ret3:
s_sub_u32 s38, s38, 1
s_cmp_lg_u32 s38, 0
s_cbranch_scc1 at_loop
at_tail:
s_cmp_eq_u32 s71, 0
s_cbranch_scc0 at_g
at_gspun:
s_cmp_eq_u32 s30, 2
s_cbranch_scc1 at_tf
s_cmp_eq_u32 s24, 0
s_cbranch_scc0 at_t1
s_waitcnt lgkmcnt(0)
ds_read_b128 a[64:67], v4 offset:49152
ds_read_b128 a[68:71], v4 offset:50176
ds_read_b128 a[72:75], v4 offset:51200
ds_read_b128 a[76:79], v4 offset:52224
ds_read_b128 a[80:83], v4 offset:53248
ds_read_b128 a[84:87], v4 offset:54272
ds_read_b128 a[88:91], v4 offset:55296
ds_read_b128 a[92:95], v4 offset:56320
s_waitcnt vmcnt(8)
s_barrier
s_waitcnt lgkmcnt(4)
v_mfma_f32_16x16x32_bf16 v[128:131], a[64:67], v[72:75], v[128:131]
ds_read_b128 a[96:99], v4 offset:57344
v_add_f32 v28, v28, v30
v_add_f32 v29, v29, v31
s_lshl_b32 s41, s25, 20
s_add_u32 s41, s41, s6
v_mfma_f32_16x16x32_bf16 v[132:135], a[64:67], v[76:79], v[132:135]
ds_read_b128 a[100:103], v4 offset:58368
s_lshl_b32 s67, s3, 14
s_add_u32 s41, s41, s67
s_add_u32 s67, s41, 16384
s_add_u32 s34, s41, 32768
v_mfma_f32_16x16x32_bf16 v[136:139], a[68:71], v[72:75], v[136:139]
s_add_u32 m0, s7, 16384
s_add_u32 s35, s41, 16777216
s_lshl_b32 s44, s25, 3
s_add_u32 s44, s44, s24
s_mul_i32 s44, s44, 28672
v_mfma_f32_16x16x32_bf16 v[140:143], a[68:71], v[76:79], v[140:143]
ds_read_b128 a[104:107], v4 offset:59392
buffer_load_dwordx4 v2, s[12:15], s33 offen offset:0 sc1 lds
s_add_u32 s45, s44, 114688
s_mov_b32 s77, s44
v_mfma_f32_16x16x32_bf16 v[144:147], a[72:75], v[72:75], v[144:147]
s_cmp_eq_u32 s31, -1
s_cselect_b32 s22, 0, 268435456
s_cselect_b32 s16, s80, s4
s_cselect_b32 s17, s81, s5
s_cselect_b32 s18, 3670016, s14
s_cselect_b32 s34, s44, s34
s_cselect_b32 s35, s45, s35
s_cselect_b64 s[46:47], -1, 0
v_mfma_f32_16x16x32_bf16 v[148:151], a[72:75], v[76:79], v[148:151]
ds_read_b128 a[108:111], v4 offset:60416
buffer_load_dwordx4 v2, s[12:15], s33 offen offset:1024 sc1 lds
s_mov_b32 s37, 16384
s_cmp_eq_u32 s31, -1
s_cselect_b32 s37, 128, s37
v_mfma_f32_16x16x32_bf16 v[152:155], a[76:79], v[72:75], v[152:155]
s_add_u32 s43, s64, 92274688
s_add_u32 s48, s64, 83886080
v_mfma_f32_16x16x32_bf16 v[156:159], a[76:79], v[76:79], v[156:159]
s_waitcnt lgkmcnt(4)
buffer_load_dwordx4 v2, s[12:15], s33 offen offset:2048 sc1 lds
v_mfma_f32_16x16x32_bf16 v[160:163], a[80:83], v[72:75], v[160:163]
ds_read_b128 a[112:115], v4 offset:61440
v_mfma_f32_16x16x32_bf16 v[164:167], a[80:83], v[76:79], v[164:167]
ds_read_b128 a[116:119], v4 offset:62464
buffer_load_dwordx4 v2, s[12:15], s33 offen offset:3072 sc1 lds
s_add_u32 s33, s33, 16384
v_mfma_f32_16x16x32_bf16 v[168:171], a[84:87], v[72:75], v[168:171]
s_cmp_eq_u32 s30, 2
s_cselect_b32 s22, 268435456, s22
s_cselect_b32 s69, s58, s59
s_cselect_b32 s43, s48, s43
s_cselect_b32 s70, s65, s70
v_mfma_f32_16x16x32_bf16 v[172:175], a[84:87], v[76:79], v[172:175]
ds_read_b128 a[120:123], v4 offset:63488
v_subrev_u32 v26, s40, v25
v_cmp_gt_i32 s[50:51], 0, v26
v_cmp_gt_i32 s[52:53], 1, v26
v_cmp_gt_i32 s[54:55], 2, v26
v_mfma_f32_16x16x32_bf16 v[176:179], a[88:91], v[72:75], v[176:179]
v_cmp_gt_i32 s[56:57], 3, v26
v_mov_b32 v40, v27
v_mov_b32 v41, v27
v_mov_b32 v42, v27
v_mov_b32 v43, v27
v_mfma_f32_16x16x32_bf16 v[180:183], a[88:91], v[76:79], v[180:183]
ds_read_b128 a[124:127], v4 offset:64512
v_cndmask_b32 v32, v32, v27, s[50:51]
v_cndmask_b32 v33, v33, v27, s[52:53]
v_cndmask_b32 v34, v34, v27, s[54:55]
v_cndmask_b32 v35, v35, v27, s[56:57]
v_mfma_f32_16x16x32_bf16 v[184:187], a[92:95], v[72:75], v[184:187]
v_cndmask_b32 v44, v44, v27, s[50:51]
v_cndmask_b32 v45, v45, v27, s[52:53]
v_cndmask_b32 v46, v46, v27, s[54:55]
v_cndmask_b32 v47, v47, v27, s[56:57]
v_mfma_f32_16x16x32_bf16 v[188:191], a[92:95], v[76:79], v[188:191]
s_waitcnt lgkmcnt(4)
v_exp_f32 v88, v32
v_exp_f32 v89, v33
v_mfma_f32_16x16x32_bf16 v[192:195], a[96:99], v[72:75], v[192:195]
ds_read_b128 a[64:67], v5 offset:16384
v_exp_f32 v90, v34
v_exp_f32 v91, v35
v_mfma_f32_16x16x32_bf16 v[196:199], a[96:99], v[76:79], v[196:199]
ds_read_b128 a[68:71], v5 offset:17408
v_exp_f32 v92, v36
v_exp_f32 v93, v37
v_mfma_f32_16x16x32_bf16 v[200:203], a[100:103], v[72:75], v[200:203]
v_exp_f32 v94, v38
v_exp_f32 v95, v39
v_add_f32 v30, v88, v89
v_mfma_f32_16x16x32_bf16 v[204:207], a[100:103], v[76:79], v[204:207]
ds_read_b128 a[72:75], v5 offset:18432
v_cvt_pk_bf16_f32 v64, v88, v89
v_exp_f32 v88, v40
v_add_f32 v30, v30, v90
v_mfma_f32_16x16x32_bf16 v[208:211], a[104:107], v[72:75], v[208:211]
v_exp_f32 v89, v41
v_add_f32 v30, v30, v91
v_cvt_pk_bf16_f32 v65, v90, v91
v_add_f32 v31, v92, v93
v_mfma_f32_16x16x32_bf16 v[212:215], a[104:107], v[76:79], v[212:215]
ds_read_b128 a[76:79], v5 offset:19456
v_exp_f32 v90, v42
v_exp_f32 v91, v43
v_mfma_f32_16x16x32_bf16 v[216:219], a[108:111], v[72:75], v[216:219]
v_cvt_pk_bf16_f32 v68, v92, v93
v_exp_f32 v92, v44
v_exp_f32 v93, v45
v_mfma_f32_16x16x32_bf16 v[220:223], a[108:111], v[76:79], v[220:223]
s_waitcnt lgkmcnt(4)
v_add_f32 v31, v31, v94
v_add_f32 v31, v31, v95
v_cvt_pk_bf16_f32 v69, v94, v95
v_add_f32 v30, v30, v88
v_mfma_f32_16x16x32_bf16 v[224:227], a[112:115], v[72:75], v[224:227]
ds_read_b128 a[80:83], v5 offset:20480
v_exp_f32 v94, v46
v_exp_f32 v95, v47
v_mfma_f32_16x16x32_bf16 v[228:231], a[112:115], v[76:79], v[228:231]
ds_read_b128 a[84:87], v5 offset:21504
v_add_f32 v30, v30, v89
v_cvt_pk_bf16_f32 v66, v88, v89
v_add_f32 v30, v30, v90
v_add_f32 v30, v30, v91
v_mfma_f32_16x16x32_bf16 v[232:235], a[116:119], v[72:75], v[232:235]
v_cvt_pk_bf16_f32 v67, v90, v91
v_add_f32 v31, v31, v92
v_add_f32 v31, v31, v93
v_cvt_pk_bf16_f32 v70, v92, v93
v_add_f32 v31, v31, v94
v_mfma_f32_16x16x32_bf16 v[236:239], a[116:119], v[76:79], v[236:239]
ds_read_b128 a[88:91], v5 offset:22528
v_add_f32 v31, v31, v95
v_cvt_pk_bf16_f32 v71, v94, v95
v_add_f32 v96, v30, v31
v_cmp_lt_f32 vcc, s42, v96
v_mfma_f32_16x16x32_bf16 v[240:243], a[120:123], v[72:75], v[240:243]
v_mfma_f32_16x16x32_bf16 v[244:247], a[120:123], v[76:79], v[244:247]
ds_read_b128 a[92:95], v5 offset:23552
v_mfma_f32_16x16x32_bf16 v[248:251], a[124:127], v[72:75], v[248:251]
v_mfma_f32_16x16x32_bf16 v[252:255], a[124:127], v[76:79], v[252:255]
s_cbranch_vccnz at_stub4
at_ret4:
s_waitcnt vmcnt(4)
s_barrier
s_waitcnt lgkmcnt(4)
v_mfma_f32_16x16x32_bf16 v[128:131], a[64:67], v[64:67], v[128:131]
ds_read_b128 a[96:99], v5 offset:24576
v_add_f32 v28, v28, v30
v_mfma_f32_16x16x32_bf16 v[132:135], a[64:67], v[68:71], v[132:135]
ds_read_b128 a[100:103], v5 offset:25600
v_add_f32 v29, v29, v31
v_mfma_f32_16x16x32_bf16 v[136:139], a[68:71], v[64:67], v[136:139]
s_add_u32 m0, s7, 49152
v_cndmask_b32 v12, v2, v16, s[46:47]
v_mfma_f32_16x16x32_bf16 v[140:143], a[68:71], v[68:71], v[140:143]
ds_read_b128 a[104:107], v5 offset:26624
buffer_load_dwordx4 v2, s[12:15], s33 offen offset:0 sc1 lds
v_mfma_f32_16x16x32_bf16 v[144:147], a[72:75], v[64:67], v[144:147]
v_cndmask_b32 v13, v2, v17, s[46:47]
v_cndmask_b32 v14, v2, v18, s[46:47]
v_mfma_f32_16x16x32_bf16 v[148:151], a[72:75], v[68:71], v[148:151]
ds_read_b128 a[108:111], v5 offset:27648
buffer_load_dwordx4 v2, s[12:15], s33 offen offset:1024 sc1 lds
v_mfma_f32_16x16x32_bf16 v[152:155], a[76:79], v[64:67], v[152:155]
v_cndmask_b32 v15, v2, v19, s[46:47]
v_mfma_f32_16x16x32_bf16 v[156:159], a[76:79], v[68:71], v[156:159]
s_waitcnt lgkmcnt(4)
buffer_load_dwordx4 v2, s[12:15], s33 offen offset:2048 sc1 lds
v_mfma_f32_16x16x32_bf16 v[160:163], a[80:83], v[64:67], v[160:163]
ds_read_b128 a[112:115], v5 offset:28672
v_mfma_f32_16x16x32_bf16 v[164:167], a[80:83], v[68:71], v[164:167]
ds_read_b128 a[116:119], v5 offset:29696
buffer_load_dwordx4 v2, s[12:15], s33 offen offset:3072 sc1 lds
s_add_u32 s33, s33, 16384
v_mfma_f32_16x16x32_bf16 v[168:171], a[84:87], v[64:67], v[168:171]
v_mfma_f32_16x16x32_bf16 v[172:175], a[84:87], v[68:71], v[172:175]
ds_read_b128 a[120:123], v5 offset:30720
v_mfma_f32_16x16x32_bf16 v[176:179], a[88:91], v[64:67], v[176:179]
v_mfma_f32_16x16x32_bf16 v[180:183], a[88:91], v[68:71], v[180:183]
ds_read_b128 a[124:127], v5 offset:31744
v_mfma_f32_16x16x32_bf16 v[184:187], a[92:95], v[64:67], v[184:187]
v_mfma_f32_16x16x32_bf16 v[188:191], a[92:95], v[68:71], v[188:191]
s_waitcnt lgkmcnt(4)
v_mfma_f32_16x16x32_bf16 v[192:195], a[96:99], v[64:67], v[192:195]
v_mfma_f32_16x16x32_bf16 v[196:199], a[96:99], v[68:71], v[196:199]
v_mfma_f32_16x16x32_bf16 v[200:203], a[100:103], v[64:67], v[200:203]
v_mfma_f32_16x16x32_bf16 v[204:207], a[100:103], v[68:71], v[204:207]
v_mfma_f32_16x16x32_bf16 v[208:211], a[104:107], v[64:67], v[208:211]
v_mfma_f32_16x16x32_bf16 v[212:215], a[104:107], v[68:71], v[212:215]
v_mfma_f32_16x16x32_bf16 v[216:219], a[108:111], v[64:67], v[216:219]
v_mfma_f32_16x16x32_bf16 v[220:223], a[108:111], v[68:71], v[220:223]
s_waitcnt lgkmcnt(0)
v_mfma_f32_16x16x32_bf16 v[224:227], a[112:115], v[64:67], v[224:227]
v_mfma_f32_16x16x32_bf16 v[228:231], a[112:115], v[68:71], v[228:231]
v_mfma_f32_16x16x32_bf16 v[232:235], a[116:119], v[64:67], v[232:235]
v_mfma_f32_16x16x32_bf16 v[236:239], a[116:119], v[68:71], v[236:239]
v_mfma_f32_16x16x32_bf16 v[240:243], a[120:123], v[64:67], v[240:243]
v_mfma_f32_16x16x32_bf16 v[244:247], a[120:123], v[68:71], v[244:247]
v_mfma_f32_16x16x32_bf16 v[248:251], a[124:127], v[64:67], v[248:251]
v_mfma_f32_16x16x32_bf16 v[252:255], a[124:127], v[68:71], v[252:255]
s_waitcnt vmcnt(4)
s_barrier
v_mov_b32 v108, 0
buffer_atomic_or v108, v109, s[20:23], s69 offen sc0 sc1
s_add_u32 m0, s36, 0
s_nop 0
buffer_load_dwordx4 v12, s[16:19], s34 offen offset:0 sc1 lds
buffer_load_dwordx4 v13, s[16:19], s34 offen offset:1024 sc1 lds
buffer_load_dwordx4 v14, s[16:19], s34 offen offset:2048 sc1 lds
buffer_load_dwordx4 v15, s[16:19], s34 offen offset:3072 sc1 lds
s_add_u32 s34, s34, s37
s_add_u32 m0, s36, 16384
s_nop 0
buffer_load_dwordx4 v12, s[16:19], s35 offen offset:0 sc1 lds
buffer_load_dwordx4 v13, s[16:19], s35 offen offset:1024 sc1 lds
buffer_load_dwordx4 v14, s[16:19], s35 offen offset:2048 sc1 lds
buffer_load_dwordx4 v15, s[16:19], s35 offen offset:3072 sc1 lds
s_add_u32 s35, s35, s37
s_waitcnt vmcnt(8)
v_readfirstlane_b32 s60, v108
s_cmp_eq_u32 s22, 0
s_cselect_b32 s60, 1, s60
s_cmp_eq_u32 s60, 1
s_cbranch_scc0 at_w0spin
at_w0spun:
s_barrier
buffer_load_dwordx4 v[104:107], v2, s[20:23], s70 offen sc1
buffer_load_dwordx4 a[0:3], v2, s[20:23], s43 offen offset:0 sc1
buffer_load_dwordx4 a[4:7], v2, s[20:23], s43 offen offset:1024 sc1
buffer_load_dwordx4 a[8:11], v2, s[20:23], s43 offen offset:2048 sc1
buffer_load_dwordx4 a[12:15], v2, s[20:23], s43 offen offset:3072 sc1
s_add_u32 s43, s43, 4096
buffer_load_dwordx4 a[16:19], v2, s[20:23], s43 offen offset:0 sc1
buffer_load_dwordx4 a[20:23], v2, s[20:23], s43 offen offset:1024 sc1
buffer_load_dwordx4 a[24:27], v2, s[20:23], s43 offen offset:2048 sc1
buffer_load_dwordx4 a[28:31], v2, s[20:23], s43 offen offset:3072 sc1
s_add_u32 s43, s43, 4096
buffer_load_dwordx4 a[32:35], v2, s[20:23], s43 offen offset:0 sc1
buffer_load_dwordx4 a[36:39], v2, s[20:23], s43 offen offset:1024 sc1
buffer_load_dwordx4 a[40:43], v2, s[20:23], s43 offen offset:2048 sc1
buffer_load_dwordx4 a[44:47], v2, s[20:23], s43 offen offset:3072 sc1
s_add_u32 s43, s43, 4096
buffer_load_dwordx4 a[48:51], v2, s[20:23], s43 offen offset:0 sc1
buffer_load_dwordx4 a[52:55], v2, s[20:23], s43 offen offset:1024 sc1
buffer_load_dwordx4 a[56:59], v2, s[20:23], s43 offen offset:2048 sc1
buffer_load_dwordx4 a[60:63], v2, s[20:23], s43 offen offset:3072 sc1
s_nop 0
s_barrier
s_add_u32 m0, s36, 32768
s_nop 0
buffer_load_dwordx4 v12, s[16:19], s34 offen offset:0 sc1 lds
buffer_load_dwordx4 v13, s[16:19], s34 offen offset:1024 sc1 lds
buffer_load_dwordx4 v14, s[16:19], s34 offen offset:2048 sc1 lds
buffer_load_dwordx4 v15, s[16:19], s34 offen offset:3072 sc1 lds
s_add_u32 s34, s34, s37
s_add_u32 m0, s36, 49152
s_nop 0
buffer_load_dwordx4 v12, s[16:19], s35 offen offset:0 sc1 lds
buffer_load_dwordx4 v13, s[16:19], s35 offen offset:1024 sc1 lds
buffer_load_dwordx4 v14, s[16:19], s35 offen offset:2048 sc1 lds
buffer_load_dwordx4 v15, s[16:19], s35 offen offset:3072 sc1 lds
s_add_u32 s35, s35, s37
v_mov_b32 v96, v28
v_mov_b32 v97, v29
s_nop 0
v_permlane16_swap_b32 v28, v96
v_permlane16_swap_b32 v29, v97
v_add_f32 v28, v28, v96
v_add_f32 v29, v29, v97
v_mov_b32 v96, v28
v_mov_b32 v97, v29
s_nop 0
v_permlane32_swap_b32 v28, v96
v_permlane32_swap_b32 v29, v97
v_add_f32 v28, v28, v96
v_add_f32 v29, v29, v97
s_mov_b32 s44, s48
s_add_u32 s45, s48, 8192
s_add_u32 s46, s44, 4096
s_add_u32 s47, s45, 4096
s_branch at_tj
at_t1:
s_cmp_eq_u32 s24, 1
s_cbranch_scc0 at_t2
s_waitcnt vmcnt(8)
s_barrier
s_waitcnt lgkmcnt(4)
v_mfma_f32_16x16x32_bf16 v[48:51], a[64:67], a[0:3], v[80:83]
ds_read_b128 a[96:99], v4 offset:40960
v_add_f32 v28, v28, v30
v_add_f32 v29, v29, v31
v_mfma_f32_16x16x32_bf16 v[48:51], a[68:71], a[4:7], v[48:51]
ds_read_b128 a[100:103], v4 offset:41984
s_lshl_b32 s41, s25, 20
s_add_u32 s41, s41, s6
v_mfma_f32_16x16x32_bf16 v[52:55], a[64:67], a[32:35], v[84:87]
s_add_u32 m0, s7, 16384
s_lshl_b32 s67, s3, 14
s_add_u32 s41, s41, s67
v_mfma_f32_16x16x32_bf16 v[52:55], a[68:71], a[36:39], v[52:55]
ds_read_b128 a[104:107], v4 offset:43008
buffer_load_dwordx4 v2, s[12:15], s33 offen offset:0 sc1 lds
s_add_u32 s67, s41, 16384
v_mfma_f32_16x16x32_bf16 v[48:51], a[72:75], a[8:11], v[48:51]
s_add_u32 s34, s41, 32768
s_add_u32 s35, s41, 16777216
s_lshl_b32 s44, s25, 3
v_mfma_f32_16x16x32_bf16 v[48:51], a[76:79], a[12:15], v[48:51]
ds_read_b128 a[108:111], v4 offset:44032
s_add_u32 s44, s44, s24
s_mul_i32 s44, s44, 28672
v_mfma_f32_16x16x32_bf16 v[52:55], a[72:75], a[40:43], v[52:55]
s_add_u32 s45, s44, 114688
s_mov_b32 s77, s44
v_mfma_f32_16x16x32_bf16 v[52:55], a[76:79], a[44:47], v[52:55]
s_waitcnt lgkmcnt(4)
buffer_load_dwordx4 v2, s[12:15], s33 offen offset:1024 sc1 lds
v_mfma_f32_16x16x32_bf16 v[48:51], a[80:83], a[16:19], v[48:51]
ds_read_b128 a[112:115], v4 offset:45056
v_mfma_f32_16x16x32_bf16 v[48:51], a[84:87], a[20:23], v[48:51]
ds_read_b128 a[116:119], v4 offset:46080
v_mfma_f32_16x16x32_bf16 v[52:55], a[80:83], a[48:51], v[52:55]
s_cmp_eq_u32 s31, -1
s_cselect_b32 s22, 0, 268435456
s_cselect_b32 s16, s80, s4
s_cselect_b32 s17, s81, s5
s_cselect_b32 s18, 3670016, s14
s_cselect_b32 s34, s44, s34
s_cselect_b32 s35, s45, s35
s_cselect_b64 s[46:47], -1, 0
v_mfma_f32_16x16x32_bf16 v[52:55], a[84:87], a[52:55], v[52:55]
ds_read_b128 a[120:123], v4 offset:47104
buffer_load_dwordx4 v2, s[12:15], s33 offen offset:2048 sc1 lds
s_mov_b32 s37, 16384
v_mfma_f32_16x16x32_bf16 v[48:51], a[88:91], a[24:27], v[48:51]
s_cmp_eq_u32 s31, -1
s_cselect_b32 s37, 128, s37
s_add_u32 s43, s64, 92274688
v_mfma_f32_16x16x32_bf16 v[48:51], a[92:95], a[28:31], v[48:51]
ds_read_b128 a[124:127], v4 offset:48128
s_add_u32 s48, s64, 83886080
v_mfma_f32_16x16x32_bf16 v[52:55], a[88:91], a[56:59], v[52:55]
s_cmp_eq_u32 s30, 2
s_cselect_b32 s22, 268435456, s22
s_cselect_b32 s69, s58, s59
s_cselect_b32 s43, s48, s43
s_cselect_b32 s70, s65, s70
v_mfma_f32_16x16x32_bf16 v[52:55], a[92:95], a[60:63], v[52:55]
s_waitcnt lgkmcnt(4)
buffer_load_dwordx4 v2, s[12:15], s33 offen offset:3072 sc1 lds
s_add_u32 s33, s33, 16384
v_mfma_f32_16x16x32_bf16 v[56:59], a[96:99], a[0:3], v[80:83]
ds_read_b128 a[64:67], v4 offset:49152
v_exp_f32 v88, v32
v_mfma_f32_16x16x32_bf16 v[56:59], a[100:103], a[4:7], v[56:59]
ds_read_b128 a[68:71], v4 offset:50176
v_exp_f32 v89, v33
v_mfma_f32_16x16x32_bf16 v[60:63], a[96:99], a[32:35], v[84:87]
v_exp_f32 v90, v34
v_add_f32 v30, v88, v89
v_mfma_f32_16x16x32_bf16 v[60:63], a[100:103], a[36:39], v[60:63]
ds_read_b128 a[72:75], v4 offset:51200
v_exp_f32 v91, v35
v_mfma_f32_16x16x32_bf16 v[56:59], a[104:107], a[8:11], v[56:59]
v_exp_f32 v92, v36
v_cvt_pk_bf16_f32 v64, v88, v89
v_mfma_f32_16x16x32_bf16 v[56:59], a[108:111], a[12:15], v[56:59]
ds_read_b128 a[76:79], v4 offset:52224
v_exp_f32 v93, v37
v_mfma_f32_16x16x32_bf16 v[60:63], a[104:107], a[40:43], v[60:63]
v_exp_f32 v94, v38
v_add_f32 v30, v30, v90
v_mfma_f32_16x16x32_bf16 v[60:63], a[108:111], a[44:47], v[60:63]
s_waitcnt lgkmcnt(4)
v_exp_f32 v95, v39
v_mfma_f32_16x16x32_bf16 v[56:59], a[112:115], a[16:19], v[56:59]
ds_read_b128 a[80:83], v4 offset:53248
v_exp_f32 v88, v40
v_mfma_f32_16x16x32_bf16 v[56:59], a[116:119], a[20:23], v[56:59]
ds_read_b128 a[84:87], v4 offset:54272
v_exp_f32 v89, v41
v_mfma_f32_16x16x32_bf16 v[60:63], a[112:115], a[48:51], v[60:63]
v_add_f32 v30, v30, v91
v_cvt_pk_bf16_f32 v65, v90, v91
v_add_f32 v31, v92, v93
v_mfma_f32_16x16x32_bf16 v[60:63], a[116:119], a[52:55], v[60:63]
ds_read_b128 a[88:91], v4 offset:55296
v_exp_f32 v90, v42
v_mfma_f32_16x16x32_bf16 v[56:59], a[120:123], a[24:27], v[56:59]
v_exp_f32 v91, v43
v_cvt_pk_bf16_f32 v68, v92, v93
v_mfma_f32_16x16x32_bf16 v[56:59], a[124:127], a[28:31], v[56:59]
ds_read_b128 a[92:95], v4 offset:56320
v_exp_f32 v92, v44
v_mfma_f32_16x16x32_bf16 v[60:63], a[120:123], a[56:59], v[60:63]
v_exp_f32 v93, v45
v_add_f32 v31, v31, v94
v_mfma_f32_16x16x32_bf16 v[60:63], a[124:127], a[60:63], v[60:63]
s_waitcnt lgkmcnt(4)
v_add_f32 v31, v31, v95
v_cvt_pk_bf16_f32 v69, v94, v95
v_mfma_f32_16x16x32_bf16 v[128:131], a[64:67], v[72:75], v[128:131]
ds_read_b128 a[96:99], v4 offset:57344
v_exp_f32 v94, v46
v_mfma_f32_16x16x32_bf16 v[132:135], a[64:67], v[76:79], v[132:135]
ds_read_b128 a[100:103], v4 offset:58368
v_exp_f32 v95, v47
v_mfma_f32_16x16x32_bf16 v[136:139], a[68:71], v[72:75], v[136:139]
v_add_f32 v30, v30, v88
v_add_f32 v30, v30, v89
v_cvt_pk_bf16_f32 v66, v88, v89
v_mfma_f32_16x16x32_bf16 v[140:143], a[68:71], v[76:79], v[140:143]
ds_read_b128 a[104:107], v4 offset:59392
v_add_f32 v30, v30, v90
v_add_f32 v30, v30, v91
v_mfma_f32_16x16x32_bf16 v[144:147], a[72:75], v[72:75], v[144:147]
v_cvt_pk_bf16_f32 v67, v90, v91
v_add_f32 v31, v31, v92
v_add_f32 v31, v31, v93
v_mfma_f32_16x16x32_bf16 v[148:151], a[72:75], v[76:79], v[148:151]
ds_read_b128 a[108:111], v4 offset:60416
v_cvt_pk_bf16_f32 v70, v92, v93
v_add_f32 v31, v31, v94
v_mfma_f32_16x16x32_bf16 v[152:155], a[76:79], v[72:75], v[152:155]
v_add_f32 v31, v31, v95
v_cvt_pk_bf16_f32 v71, v94, v95
v_add_f32 v96, v30, v31
v_mfma_f32_16x16x32_bf16 v[156:159], a[76:79], v[76:79], v[156:159]
s_waitcnt lgkmcnt(4)
v_cmp_lt_f32 vcc, s42, v96
v_mfma_f32_16x16x32_bf16 v[160:163], a[80:83], v[72:75], v[160:163]
ds_read_b128 a[112:115], v4 offset:61440
v_mfma_f32_16x16x32_bf16 v[164:167], a[80:83], v[76:79], v[164:167]
ds_read_b128 a[116:119], v4 offset:62464
v_mfma_f32_16x16x32_bf16 v[168:171], a[84:87], v[72:75], v[168:171]
v_mfma_f32_16x16x32_bf16 v[172:175], a[84:87], v[76:79], v[172:175]
ds_read_b128 a[120:123], v4 offset:63488
v_mfma_f32_16x16x32_bf16 v[176:179], a[88:91], v[72:75], v[176:179]
v_mfma_f32_16x16x32_bf16 v[180:183], a[88:91], v[76:79], v[180:183]
ds_read_b128 a[124:127], v4 offset:64512
v_mfma_f32_16x16x32_bf16 v[184:187], a[92:95], v[72:75], v[184:187]
v_mfma_f32_16x16x32_bf16 v[188:191], a[92:95], v[76:79], v[188:191]
s_waitcnt lgkmcnt(4)
v_mfma_f32_16x16x32_bf16 v[192:195], a[96:99], v[72:75], v[192:195]
ds_read_b128 a[64:67], v5 offset:16384
v_mfma_f32_16x16x32_bf16 v[196:199], a[96:99], v[76:79], v[196:199]
ds_read_b128 a[68:71], v5 offset:17408
v_mfma_f32_16x16x32_bf16 v[200:203], a[100:103], v[72:75], v[200:203]
v_mfma_f32_16x16x32_bf16 v[204:207], a[100:103], v[76:79], v[204:207]
ds_read_b128 a[72:75], v5 offset:18432
v_mfma_f32_16x16x32_bf16 v[208:211], a[104:107], v[72:75], v[208:211]
v_mfma_f32_16x16x32_bf16 v[212:215], a[104:107], v[76:79], v[212:215]
ds_read_b128 a[76:79], v5 offset:19456
v_mfma_f32_16x16x32_bf16 v[216:219], a[108:111], v[72:75], v[216:219]
v_mfma_f32_16x16x32_bf16 v[220:223], a[108:111], v[76:79], v[220:223]
s_waitcnt lgkmcnt(4)
v_mfma_f32_16x16x32_bf16 v[224:227], a[112:115], v[72:75], v[224:227]
ds_read_b128 a[80:83], v5 offset:20480
v_mfma_f32_16x16x32_bf16 v[228:231], a[112:115], v[76:79], v[228:231]
ds_read_b128 a[84:87], v5 offset:21504
v_mfma_f32_16x16x32_bf16 v[232:235], a[116:119], v[72:75], v[232:235]
v_mfma_f32_16x16x32_bf16 v[236:239], a[116:119], v[76:79], v[236:239]
ds_read_b128 a[88:91], v5 offset:22528
v_mfma_f32_16x16x32_bf16 v[240:243], a[120:123], v[72:75], v[240:243]
v_mfma_f32_16x16x32_bf16 v[244:247], a[120:123], v[76:79], v[244:247]
ds_read_b128 a[92:95], v5 offset:23552
v_mfma_f32_16x16x32_bf16 v[248:251], a[124:127], v[72:75], v[248:251]
v_mfma_f32_16x16x32_bf16 v[252:255], a[124:127], v[76:79], v[252:255]
s_cbranch_vccnz at_stub5
at_ret5:
s_waitcnt vmcnt(4)
s_barrier
s_waitcnt lgkmcnt(4)
v_mfma_f32_16x16x32_bf16 v[128:131], a[64:67], v[64:67], v[128:131]
ds_read_b128 a[96:99], v5 offset:24576
v_add_f32 v28, v28, v30
v_add_f32 v29, v29, v31
v_cndmask_b32 v12, v2, v16, s[46:47]
v_mfma_f32_16x16x32_bf16 v[132:135], a[64:67], v[68:71], v[132:135]
ds_read_b128 a[100:103], v5 offset:25600
v_cndmask_b32 v13, v2, v17, s[46:47]
v_cndmask_b32 v14, v2, v18, s[46:47]
v_cndmask_b32 v15, v2, v19, s[46:47]
v_mfma_f32_16x16x32_bf16 v[136:139], a[68:71], v[64:67], v[136:139]
s_add_u32 m0, s7, 49152
v_subrev_u32 v26, s40, v25
v_cmp_gt_i32 s[50:51], 0, v26
v_cmp_gt_i32 s[52:53], 1, v26
v_mfma_f32_16x16x32_bf16 v[140:143], a[68:71], v[68:71], v[140:143]
ds_read_b128 a[104:107], v5 offset:26624
buffer_load_dwordx4 v2, s[12:15], s33 offen offset:0 sc1 lds
v_cmp_gt_i32 s[54:55], 2, v26
v_cmp_gt_i32 s[56:57], 3, v26
v_mfma_f32_16x16x32_bf16 v[144:147], a[72:75], v[64:67], v[144:147]
v_mov_b32 v56, v27
v_mov_b32 v57, v27
v_mov_b32 v58, v27
v_mov_b32 v59, v27
v_mfma_f32_16x16x32_bf16 v[148:151], a[72:75], v[68:71], v[148:151]
ds_read_b128 a[108:111], v5 offset:27648
buffer_load_dwordx4 v2, s[12:15], s33 offen offset:1024 sc1 lds
v_cndmask_b32 v48, v48, v27, s[50:51]
v_cndmask_b32 v49, v49, v27, s[52:53]
v_mfma_f32_16x16x32_bf16 v[152:155], a[76:79], v[64:67], v[152:155]
v_cndmask_b32 v50, v50, v27, s[54:55]
v_cndmask_b32 v51, v51, v27, s[56:57]
v_cndmask_b32 v60, v60, v27, s[50:51]
v_cndmask_b32 v61, v61, v27, s[52:53]
v_mfma_f32_16x16x32_bf16 v[156:159], a[76:79], v[68:71], v[156:159]
s_waitcnt lgkmcnt(4)
buffer_load_dwordx4 v2, s[12:15], s33 offen offset:2048 sc1 lds
v_cndmask_b32 v62, v62, v27, s[54:55]
v_cndmask_b32 v63, v63, v27, s[56:57]
v_mfma_f32_16x16x32_bf16 v[160:163], a[80:83], v[64:67], v[160:163]
ds_read_b128 a[112:115], v5 offset:28672
v_exp_f32 v88, v48
v_mfma_f32_16x16x32_bf16 v[164:167], a[80:83], v[68:71], v[164:167]
ds_read_b128 a[116:119], v5 offset:29696
buffer_load_dwordx4 v2, s[12:15], s33 offen offset:3072 sc1 lds
s_add_u32 s33, s33, 16384
v_mfma_f32_16x16x32_bf16 v[168:171], a[84:87], v[64:67], v[168:171]
v_exp_f32 v89, v49
v_exp_f32 v90, v50
v_mfma_f32_16x16x32_bf16 v[172:175], a[84:87], v[68:71], v[172:175]
ds_read_b128 a[120:123], v5 offset:30720
v_exp_f32 v91, v51
v_add_f32 v30, v88, v89
v_mfma_f32_16x16x32_bf16 v[176:179], a[88:91], v[64:67], v[176:179]
v_exp_f32 v92, v52
v_exp_f32 v93, v53
v_mfma_f32_16x16x32_bf16 v[180:183], a[88:91], v[68:71], v[180:183]
ds_read_b128 a[124:127], v5 offset:31744
v_exp_f32 v94, v54
v_cvt_pk_bf16_f32 v72, v88, v89
v_mfma_f32_16x16x32_bf16 v[184:187], a[92:95], v[64:67], v[184:187]
v_exp_f32 v95, v55
v_exp_f32 v88, v56
v_mfma_f32_16x16x32_bf16 v[188:191], a[92:95], v[68:71], v[188:191]
s_waitcnt lgkmcnt(4)
v_exp_f32 v89, v57
v_add_f32 v30, v30, v90
v_mfma_f32_16x16x32_bf16 v[192:195], a[96:99], v[64:67], v[192:195]
ds_read_b128 a[64:67], v5 offset:49152
v_add_f32 v30, v30, v91
v_cvt_pk_bf16_f32 v73, v90, v91
v_add_f32 v31, v92, v93
v_mfma_f32_16x16x32_bf16 v[196:199], a[96:99], v[68:71], v[196:199]
ds_read_b128 a[68:71], v5 offset:50176
v_exp_f32 v90, v58
v_cvt_pk_bf16_f32 v76, v92, v93
v_mfma_f32_16x16x32_bf16 v[200:203], a[100:103], v[64:67], v[200:203]
v_exp_f32 v91, v59
v_exp_f32 v92, v60
v_mfma_f32_16x16x32_bf16 v[204:207], a[100:103], v[68:71], v[204:207]
ds_read_b128 a[72:75], v5 offset:51200
v_exp_f32 v93, v61
v_add_f32 v31, v31, v94
v_mfma_f32_16x16x32_bf16 v[208:211], a[104:107], v[64:67], v[208:211]
v_add_f32 v31, v31, v95
v_cvt_pk_bf16_f32 v77, v94, v95
v_exp_f32 v94, v62
v_mfma_f32_16x16x32_bf16 v[212:215], a[104:107], v[68:71], v[212:215]
ds_read_b128 a[76:79], v5 offset:52224
v_exp_f32 v95, v63
v_add_f32 v30, v30, v88
v_mfma_f32_16x16x32_bf16 v[216:219], a[108:111], v[64:67], v[216:219]
v_add_f32 v30, v30, v89
v_cvt_pk_bf16_f32 v74, v88, v89
v_add_f32 v30, v30, v90
v_add_f32 v30, v30, v91
v_mfma_f32_16x16x32_bf16 v[220:223], a[108:111], v[68:71], v[220:223]
s_waitcnt lgkmcnt(4)
v_cvt_pk_bf16_f32 v75, v90, v91
v_add_f32 v31, v31, v92
v_add_f32 v31, v31, v93
v_mfma_f32_16x16x32_bf16 v[224:227], a[112:115], v[64:67], v[224:227]
ds_read_b128 a[80:83], v5 offset:53248
v_cvt_pk_bf16_f32 v78, v92, v93
v_add_f32 v31, v31, v94
v_add_f32 v31, v31, v95
v_mfma_f32_16x16x32_bf16 v[228:231], a[112:115], v[68:71], v[228:231]
ds_read_b128 a[84:87], v5 offset:54272
v_cvt_pk_bf16_f32 v79, v94, v95
v_add_f32 v96, v30, v31
v_cmp_lt_f32 vcc, s42, v96
v_mfma_f32_16x16x32_bf16 v[232:235], a[116:119], v[64:67], v[232:235]
v_mfma_f32_16x16x32_bf16 v[236:239], a[116:119], v[68:71], v[236:239]
ds_read_b128 a[88:91], v5 offset:55296
v_mfma_f32_16x16x32_bf16 v[240:243], a[120:123], v[64:67], v[240:243]
v_mfma_f32_16x16x32_bf16 v[244:247], a[120:123], v[68:71], v[244:247]
ds_read_b128 a[92:95], v5 offset:56320
v_mfma_f32_16x16x32_bf16 v[248:251], a[124:127], v[64:67], v[248:251]
v_mfma_f32_16x16x32_bf16 v[252:255], a[124:127], v[68:71], v[252:255]
s_cbranch_vccnz at_stub6
at_ret6:
s_waitcnt vmcnt(4)
s_barrier
s_waitcnt lgkmcnt(4)
v_mfma_f32_16x16x32_bf16 v[128:131], a[64:67], v[72:75], v[128:131]
ds_read_b128 a[96:99], v5 offset:57344
v_mov_b32 v108, 0
buffer_atomic_or v108, v109, s[20:23], s69 offen sc0 sc1
v_mfma_f32_16x16x32_bf16 v[132:135], a[64:67], v[76:79], v[132:135]
ds_read_b128 a[100:103], v5 offset:58368
v_add_f32 v28, v28, v30
v_mfma_f32_16x16x32_bf16 v[136:139], a[68:71], v[72:75], v[136:139]
s_add_u32 m0, s36, 0
v_add_f32 v29, v29, v31
v_mfma_f32_16x16x32_bf16 v[140:143], a[68:71], v[76:79], v[140:143]
ds_read_b128 a[104:107], v5 offset:59392
buffer_load_dwordx4 v12, s[16:19], s34 offen offset:0 sc1 lds
v_mfma_f32_16x16x32_bf16 v[144:147], a[72:75], v[72:75], v[144:147]
v_mfma_f32_16x16x32_bf16 v[148:151], a[72:75], v[76:79], v[148:151]
ds_read_b128 a[108:111], v5 offset:60416
buffer_load_dwordx4 v13, s[16:19], s34 offen offset:1024 sc1 lds
v_mfma_f32_16x16x32_bf16 v[152:155], a[76:79], v[72:75], v[152:155]
v_mfma_f32_16x16x32_bf16 v[156:159], a[76:79], v[76:79], v[156:159]
s_waitcnt lgkmcnt(4)
buffer_load_dwordx4 v14, s[16:19], s34 offen offset:2048 sc1 lds
v_mfma_f32_16x16x32_bf16 v[160:163], a[80:83], v[72:75], v[160:163]
ds_read_b128 a[112:115], v5 offset:61440
v_mfma_f32_16x16x32_bf16 v[164:167], a[80:83], v[76:79], v[164:167]
ds_read_b128 a[116:119], v5 offset:62464
buffer_load_dwordx4 v15, s[16:19], s34 offen offset:3072 sc1 lds
s_add_u32 s34, s34, s37
v_mfma_f32_16x16x32_bf16 v[168:171], a[84:87], v[72:75], v[168:171]
v_mfma_f32_16x16x32_bf16 v[172:175], a[84:87], v[76:79], v[172:175]
ds_read_b128 a[120:123], v5 offset:63488
s_add_u32 m0, s36, 16384
v_mfma_f32_16x16x32_bf16 v[176:179], a[88:91], v[72:75], v[176:179]
buffer_load_dwordx4 v12, s[16:19], s35 offen offset:0 sc1 lds
v_mfma_f32_16x16x32_bf16 v[180:183], a[88:91], v[76:79], v[180:183]
ds_read_b128 a[124:127], v5 offset:64512
v_mfma_f32_16x16x32_bf16 v[184:187], a[92:95], v[72:75], v[184:187]
buffer_load_dwordx4 v13, s[16:19], s35 offen offset:1024 sc1 lds
v_mfma_f32_16x16x32_bf16 v[188:191], a[92:95], v[76:79], v[188:191]
s_waitcnt lgkmcnt(4)
v_mfma_f32_16x16x32_bf16 v[192:195], a[96:99], v[72:75], v[192:195]
buffer_load_dwordx4 v14, s[16:19], s35 offen offset:2048 sc1 lds
v_mfma_f32_16x16x32_bf16 v[196:199], a[96:99], v[76:79], v[196:199]
v_mfma_f32_16x16x32_bf16 v[200:203], a[100:103], v[72:75], v[200:203]
buffer_load_dwordx4 v15, s[16:19], s35 offen offset:3072 sc1 lds
s_add_u32 s35, s35, s37
v_mfma_f32_16x16x32_bf16 v[204:207], a[100:103], v[76:79], v[204:207]
v_mfma_f32_16x16x32_bf16 v[208:211], a[104:107], v[72:75], v[208:211]
v_mfma_f32_16x16x32_bf16 v[212:215], a[104:107], v[76:79], v[212:215]
v_mfma_f32_16x16x32_bf16 v[216:219], a[108:111], v[72:75], v[216:219]
v_mfma_f32_16x16x32_bf16 v[220:223], a[108:111], v[76:79], v[220:223]
s_waitcnt lgkmcnt(0)
v_mfma_f32_16x16x32_bf16 v[224:227], a[112:115], v[72:75], v[224:227]
v_mfma_f32_16x16x32_bf16 v[228:231], a[112:115], v[76:79], v[228:231]
v_mfma_f32_16x16x32_bf16 v[232:235], a[116:119], v[72:75], v[232:235]
v_mfma_f32_16x16x32_bf16 v[236:239], a[116:119], v[76:79], v[236:239]
v_mfma_f32_16x16x32_bf16 v[240:243], a[120:123], v[72:75], v[240:243]
v_mfma_f32_16x16x32_bf16 v[244:247], a[120:123], v[76:79], v[244:247]
v_mfma_f32_16x16x32_bf16 v[248:251], a[124:127], v[72:75], v[248:251]
v_mfma_f32_16x16x32_bf16 v[252:255], a[124:127], v[76:79], v[252:255]
s_waitcnt vmcnt(8)
v_readfirstlane_b32 s60, v108
s_cmp_eq_u32 s22, 0
s_cselect_b32 s60, 1, s60
s_cmp_eq_u32 s60, 1
s_cbranch_scc0 at_w1spin
at_w1spun:
s_barrier
buffer_load_dwordx4 v[104:107], v2, s[20:23], s70 offen sc1
buffer_load_dwordx4 a[0:3], v2, s[20:23], s43 offen offset:0 sc1
buffer_load_dwordx4 a[4:7], v2, s[20:23], s43 offen offset:1024 sc1
buffer_load_dwordx4 a[8:11], v2, s[20:23], s43 offen offset:2048 sc1
buffer_load_dwordx4 a[12:15], v2, s[20:23], s43 offen offset:3072 sc1
s_add_u32 s43, s43, 4096
buffer_load_dwordx4 a[16:19], v2, s[20:23], s43 offen offset:0 sc1
buffer_load_dwordx4 a[20:23], v2, s[20:23], s43 offen offset:1024 sc1
buffer_load_dwordx4 a[24:27], v2, s[20:23], s43 offen offset:2048 sc1
buffer_load_dwordx4 a[28:31], v2, s[20:23], s43 offen offset:3072 sc1
s_add_u32 s43, s43, 4096
buffer_load_dwordx4 a[32:35], v2, s[20:23], s43 offen offset:0 sc1
buffer_load_dwordx4 a[36:39], v2, s[20:23], s43 offen offset:1024 sc1
buffer_load_dwordx4 a[40:43], v2, s[20:23], s43 offen offset:2048 sc1
buffer_load_dwordx4 a[44:47], v2, s[20:23], s43 offen offset:3072 sc1
s_add_u32 s43, s43, 4096
buffer_load_dwordx4 a[48:51], v2, s[20:23], s43 offen offset:0 sc1
buffer_load_dwordx4 a[52:55], v2, s[20:23], s43 offen offset:1024 sc1
buffer_load_dwordx4 a[56:59], v2, s[20:23], s43 offen offset:2048 sc1
buffer_load_dwordx4 a[60:63], v2, s[20:23], s43 offen offset:3072 sc1
s_nop 0
s_barrier
s_add_u32 m0, s36, 32768
s_nop 0
buffer_load_dwordx4 v12, s[16:19], s34 offen offset:0 sc1 lds
buffer_load_dwordx4 v13, s[16:19], s34 offen offset:1024 sc1 lds
buffer_load_dwordx4 v14, s[16:19], s34 offen offset:2048 sc1 lds
buffer_load_dwordx4 v15, s[16:19], s34 offen offset:3072 sc1 lds
s_add_u32 s34, s34, s37
s_add_u32 m0, s36, 49152
s_nop 0
buffer_load_dwordx4 v12, s[16:19], s35 offen offset:0 sc1 lds
buffer_load_dwordx4 v13, s[16:19], s35 offen offset:1024 sc1 lds
buffer_load_dwordx4 v14, s[16:19], s35 offen offset:2048 sc1 lds
buffer_load_dwordx4 v15, s[16:19], s35 offen offset:3072 sc1 lds
s_add_u32 s35, s35, s37
v_mov_b32 v96, v28
v_mov_b32 v97, v29
s_nop 0
v_permlane16_swap_b32 v28, v96
v_permlane16_swap_b32 v29, v97
v_add_f32 v28, v28, v96
v_add_f32 v29, v29, v97
v_mov_b32 v96, v28
v_mov_b32 v97, v29
s_nop 0
v_permlane32_swap_b32 v28, v96
v_permlane32_swap_b32 v29, v97
v_add_f32 v28, v28, v96
v_add_f32 v29, v29, v97
s_mov_b32 s44, s48
s_add_u32 s45, s48, 8192
s_add_u32 s46, s44, 4096
s_add_u32 s47, s45, 4096
s_branch at_tj
at_t2:
s_cmp_eq_u32 s24, 2
s_cbranch_scc0 at_t3
s_waitcnt vmcnt(8)
s_barrier
s_waitcnt lgkmcnt(4)
v_mfma_f32_16x16x32_bf16 v[48:51], a[64:67], a[0:3], v[80:83]
ds_read_b128 a[96:99], v4 offset:40960
v_add_f32 v28, v28, v30
v_add_f32 v29, v29, v31
v_mfma_f32_16x16x32_bf16 v[48:51], a[68:71], a[4:7], v[48:51]
ds_read_b128 a[100:103], v4 offset:41984
s_lshl_b32 s41, s25, 20
s_add_u32 s41, s41, s6
v_mfma_f32_16x16x32_bf16 v[52:55], a[64:67], a[32:35], v[84:87]
s_add_u32 m0, s7, 16384
s_lshl_b32 s67, s3, 14
s_add_u32 s41, s41, s67
v_mfma_f32_16x16x32_bf16 v[52:55], a[68:71], a[36:39], v[52:55]
ds_read_b128 a[104:107], v4 offset:43008
buffer_load_dwordx4 v2, s[12:15], s33 offen offset:0 sc1 lds
s_add_u32 s67, s41, 16384
v_mfma_f32_16x16x32_bf16 v[48:51], a[72:75], a[8:11], v[48:51]
s_add_u32 s34, s41, 32768
s_add_u32 s35, s41, 16777216
s_lshl_b32 s44, s25, 3
v_mfma_f32_16x16x32_bf16 v[48:51], a[76:79], a[12:15], v[48:51]
ds_read_b128 a[108:111], v4 offset:44032
s_add_u32 s44, s44, s24
s_mul_i32 s44, s44, 28672
v_mfma_f32_16x16x32_bf16 v[52:55], a[72:75], a[40:43], v[52:55]
s_add_u32 s45, s44, 114688
s_mov_b32 s77, s44
v_mfma_f32_16x16x32_bf16 v[52:55], a[76:79], a[44:47], v[52:55]
s_waitcnt lgkmcnt(4)
buffer_load_dwordx4 v2, s[12:15], s33 offen offset:1024 sc1 lds
v_mfma_f32_16x16x32_bf16 v[48:51], a[80:83], a[16:19], v[48:51]
ds_read_b128 a[112:115], v4 offset:45056
v_mfma_f32_16x16x32_bf16 v[48:51], a[84:87], a[20:23], v[48:51]
ds_read_b128 a[116:119], v4 offset:46080
v_mfma_f32_16x16x32_bf16 v[52:55], a[80:83], a[48:51], v[52:55]
s_cmp_eq_u32 s31, -1
s_cselect_b32 s22, 0, 268435456
s_cselect_b32 s16, s80, s4
s_cselect_b32 s17, s81, s5
s_cselect_b32 s18, 3670016, s14
s_cselect_b32 s34, s44, s34
s_cselect_b32 s35, s45, s35
s_cselect_b64 s[46:47], -1, 0
v_mfma_f32_16x16x32_bf16 v[52:55], a[84:87], a[52:55], v[52:55]
ds_read_b128 a[120:123], v4 offset:47104
buffer_load_dwordx4 v2, s[12:15], s33 offen offset:2048 sc1 lds
s_mov_b32 s37, 16384
v_mfma_f32_16x16x32_bf16 v[48:51], a[88:91], a[24:27], v[48:51]
s_cmp_eq_u32 s31, -1
s_cselect_b32 s37, 128, s37
s_add_u32 s43, s64, 92274688
v_mfma_f32_16x16x32_bf16 v[48:51], a[92:95], a[28:31], v[48:51]
ds_read_b128 a[124:127], v4 offset:48128
s_add_u32 s48, s64, 83886080
v_mfma_f32_16x16x32_bf16 v[52:55], a[88:91], a[56:59], v[52:55]
s_cmp_eq_u32 s30, 2
s_cselect_b32 s22, 268435456, s22
s_cselect_b32 s69, s58, s59
s_cselect_b32 s43, s48, s43
s_cselect_b32 s70, s65, s70
v_mfma_f32_16x16x32_bf16 v[52:55], a[92:95], a[60:63], v[52:55]
s_waitcnt lgkmcnt(4)
buffer_load_dwordx4 v2, s[12:15], s33 offen offset:3072 sc1 lds
s_add_u32 s33, s33, 16384
v_mfma_f32_16x16x32_bf16 v[56:59], a[96:99], a[0:3], v[80:83]
ds_read_b128 a[64:67], v4 offset:49152
v_exp_f32 v88, v32
v_mfma_f32_16x16x32_bf16 v[56:59], a[100:103], a[4:7], v[56:59]
ds_read_b128 a[68:71], v4 offset:50176
v_exp_f32 v89, v33
v_mfma_f32_16x16x32_bf16 v[60:63], a[96:99], a[32:35], v[84:87]
v_exp_f32 v90, v34
v_add_f32 v30, v88, v89
v_mfma_f32_16x16x32_bf16 v[60:63], a[100:103], a[36:39], v[60:63]
ds_read_b128 a[72:75], v4 offset:51200
v_exp_f32 v91, v35
v_mfma_f32_16x16x32_bf16 v[56:59], a[104:107], a[8:11], v[56:59]
v_exp_f32 v92, v36
v_cvt_pk_bf16_f32 v64, v88, v89
v_mfma_f32_16x16x32_bf16 v[56:59], a[108:111], a[12:15], v[56:59]
ds_read_b128 a[76:79], v4 offset:52224
v_exp_f32 v93, v37
v_mfma_f32_16x16x32_bf16 v[60:63], a[104:107], a[40:43], v[60:63]
v_exp_f32 v94, v38
v_add_f32 v30, v30, v90
v_mfma_f32_16x16x32_bf16 v[60:63], a[108:111], a[44:47], v[60:63]
s_waitcnt lgkmcnt(4)
v_exp_f32 v95, v39
v_mfma_f32_16x16x32_bf16 v[56:59], a[112:115], a[16:19], v[56:59]
ds_read_b128 a[80:83], v4 offset:53248
v_exp_f32 v88, v40
v_mfma_f32_16x16x32_bf16 v[56:59], a[116:119], a[20:23], v[56:59]
ds_read_b128 a[84:87], v4 offset:54272
v_exp_f32 v89, v41
v_mfma_f32_16x16x32_bf16 v[60:63], a[112:115], a[48:51], v[60:63]
v_add_f32 v30, v30, v91
v_cvt_pk_bf16_f32 v65, v90, v91
v_add_f32 v31, v92, v93
v_mfma_f32_16x16x32_bf16 v[60:63], a[116:119], a[52:55], v[60:63]
ds_read_b128 a[88:91], v4 offset:55296
v_exp_f32 v90, v42
v_mfma_f32_16x16x32_bf16 v[56:59], a[120:123], a[24:27], v[56:59]
v_exp_f32 v91, v43
v_cvt_pk_bf16_f32 v68, v92, v93
v_mfma_f32_16x16x32_bf16 v[56:59], a[124:127], a[28:31], v[56:59]
ds_read_b128 a[92:95], v4 offset:56320
v_exp_f32 v92, v44
v_mfma_f32_16x16x32_bf16 v[60:63], a[120:123], a[56:59], v[60:63]
v_exp_f32 v93, v45
v_add_f32 v31, v31, v94
v_mfma_f32_16x16x32_bf16 v[60:63], a[124:127], a[60:63], v[60:63]
s_waitcnt lgkmcnt(4)
v_add_f32 v31, v31, v95
v_cvt_pk_bf16_f32 v69, v94, v95
v_mfma_f32_16x16x32_bf16 v[128:131], a[64:67], v[72:75], v[128:131]
ds_read_b128 a[96:99], v4 offset:57344
v_exp_f32 v94, v46
v_mfma_f32_16x16x32_bf16 v[132:135], a[64:67], v[76:79], v[132:135]
ds_read_b128 a[100:103], v4 offset:58368
v_exp_f32 v95, v47
v_mfma_f32_16x16x32_bf16 v[136:139], a[68:71], v[72:75], v[136:139]
v_add_f32 v30, v30, v88
v_add_f32 v30, v30, v89
v_cvt_pk_bf16_f32 v66, v88, v89
v_mfma_f32_16x16x32_bf16 v[140:143], a[68:71], v[76:79], v[140:143]
ds_read_b128 a[104:107], v4 offset:59392
v_add_f32 v30, v30, v90
v_add_f32 v30, v30, v91
v_mfma_f32_16x16x32_bf16 v[144:147], a[72:75], v[72:75], v[144:147]
v_cvt_pk_bf16_f32 v67, v90, v91
v_add_f32 v31, v31, v92
v_add_f32 v31, v31, v93
v_mfma_f32_16x16x32_bf16 v[148:151], a[72:75], v[76:79], v[148:151]
ds_read_b128 a[108:111], v4 offset:60416
v_cvt_pk_bf16_f32 v70, v92, v93
v_add_f32 v31, v31, v94
v_mfma_f32_16x16x32_bf16 v[152:155], a[76:79], v[72:75], v[152:155]
v_add_f32 v31, v31, v95
v_cvt_pk_bf16_f32 v71, v94, v95
v_add_f32 v96, v30, v31
v_mfma_f32_16x16x32_bf16 v[156:159], a[76:79], v[76:79], v[156:159]
s_waitcnt lgkmcnt(4)
v_cmp_lt_f32 vcc, s42, v96
v_mfma_f32_16x16x32_bf16 v[160:163], a[80:83], v[72:75], v[160:163]
ds_read_b128 a[112:115], v4 offset:61440
v_mfma_f32_16x16x32_bf16 v[164:167], a[80:83], v[76:79], v[164:167]
ds_read_b128 a[116:119], v4 offset:62464
v_mfma_f32_16x16x32_bf16 v[168:171], a[84:87], v[72:75], v[168:171]
v_mfma_f32_16x16x32_bf16 v[172:175], a[84:87], v[76:79], v[172:175]
ds_read_b128 a[120:123], v4 offset:63488
v_mfma_f32_16x16x32_bf16 v[176:179], a[88:91], v[72:75], v[176:179]
v_mfma_f32_16x16x32_bf16 v[180:183], a[88:91], v[76:79], v[180:183]
ds_read_b128 a[124:127], v4 offset:64512
v_mfma_f32_16x16x32_bf16 v[184:187], a[92:95], v[72:75], v[184:187]
v_mfma_f32_16x16x32_bf16 v[188:191], a[92:95], v[76:79], v[188:191]
s_waitcnt lgkmcnt(4)
v_mfma_f32_16x16x32_bf16 v[192:195], a[96:99], v[72:75], v[192:195]
ds_read_b128 a[64:67], v5 offset:0
v_mfma_f32_16x16x32_bf16 v[196:199], a[96:99], v[76:79], v[196:199]
ds_read_b128 a[68:71], v5 offset:1024
v_mfma_f32_16x16x32_bf16 v[200:203], a[100:103], v[72:75], v[200:203]
v_mfma_f32_16x16x32_bf16 v[204:207], a[100:103], v[76:79], v[204:207]
ds_read_b128 a[72:75], v5 offset:2048
v_mfma_f32_16x16x32_bf16 v[208:211], a[104:107], v[72:75], v[208:211]
v_mfma_f32_16x16x32_bf16 v[212:215], a[104:107], v[76:79], v[212:215]
ds_read_b128 a[76:79], v5 offset:3072
v_mfma_f32_16x16x32_bf16 v[216:219], a[108:111], v[72:75], v[216:219]
v_mfma_f32_16x16x32_bf16 v[220:223], a[108:111], v[76:79], v[220:223]
s_waitcnt lgkmcnt(4)
v_mfma_f32_16x16x32_bf16 v[224:227], a[112:115], v[72:75], v[224:227]
ds_read_b128 a[80:83], v5 offset:4096
v_mfma_f32_16x16x32_bf16 v[228:231], a[112:115], v[76:79], v[228:231]
ds_read_b128 a[84:87], v5 offset:5120
v_mfma_f32_16x16x32_bf16 v[232:235], a[116:119], v[72:75], v[232:235]
v_mfma_f32_16x16x32_bf16 v[236:239], a[116:119], v[76:79], v[236:239]
ds_read_b128 a[88:91], v5 offset:6144
v_mfma_f32_16x16x32_bf16 v[240:243], a[120:123], v[72:75], v[240:243]
v_mfma_f32_16x16x32_bf16 v[244:247], a[120:123], v[76:79], v[244:247]
ds_read_b128 a[92:95], v5 offset:7168
v_mfma_f32_16x16x32_bf16 v[248:251], a[124:127], v[72:75], v[248:251]
v_mfma_f32_16x16x32_bf16 v[252:255], a[124:127], v[76:79], v[252:255]
s_cbranch_vccnz at_stub7
at_ret7:
s_waitcnt vmcnt(4)
s_barrier
s_waitcnt lgkmcnt(4)
v_mfma_f32_16x16x32_bf16 v[32:35], a[64:67], a[0:3], v[80:83]
ds_read_b128 a[96:99], v5 offset:8192
v_add_f32 v28, v28, v30
v_mfma_f32_16x16x32_bf16 v[32:35], a[68:71], a[4:7], v[32:35]
ds_read_b128 a[100:103], v5 offset:9216
v_add_f32 v29, v29, v31
v_mfma_f32_16x16x32_bf16 v[36:39], a[64:67], a[32:35], v[84:87]
s_add_u32 m0, s7, 49152
v_cndmask_b32 v12, v2, v16, s[46:47]
v_mfma_f32_16x16x32_bf16 v[36:39], a[68:71], a[36:39], v[36:39]
ds_read_b128 a[104:107], v5 offset:10240
buffer_load_dwordx4 v2, s[12:15], s33 offen offset:0 sc1 lds
v_mfma_f32_16x16x32_bf16 v[32:35], a[72:75], a[8:11], v[32:35]
v_cndmask_b32 v13, v2, v17, s[46:47]
v_cndmask_b32 v14, v2, v18, s[46:47]
v_mfma_f32_16x16x32_bf16 v[32:35], a[76:79], a[12:15], v[32:35]
ds_read_b128 a[108:111], v5 offset:11264
v_cndmask_b32 v15, v2, v19, s[46:47]
v_mfma_f32_16x16x32_bf16 v[36:39], a[72:75], a[40:43], v[36:39]
v_exp_f32 v88, v48
v_mfma_f32_16x16x32_bf16 v[36:39], a[76:79], a[44:47], v[36:39]
s_waitcnt lgkmcnt(4)
buffer_load_dwordx4 v2, s[12:15], s33 offen offset:1024 sc1 lds
v_mfma_f32_16x16x32_bf16 v[32:35], a[80:83], a[16:19], v[32:35]
ds_read_b128 a[112:115], v5 offset:12288
v_mfma_f32_16x16x32_bf16 v[32:35], a[84:87], a[20:23], v[32:35]
ds_read_b128 a[116:119], v5 offset:13312
v_mfma_f32_16x16x32_bf16 v[36:39], a[80:83], a[48:51], v[36:39]
v_exp_f32 v89, v49
v_mfma_f32_16x16x32_bf16 v[36:39], a[84:87], a[52:55], v[36:39]
ds_read_b128 a[120:123], v5 offset:14336
buffer_load_dwordx4 v2, s[12:15], s33 offen offset:2048 sc1 lds
v_mfma_f32_16x16x32_bf16 v[32:35], a[88:91], a[24:27], v[32:35]
v_exp_f32 v90, v50
v_mfma_f32_16x16x32_bf16 v[32:35], a[92:95], a[28:31], v[32:35]
ds_read_b128 a[124:127], v5 offset:15360
v_add_f32 v30, v88, v89
v_mfma_f32_16x16x32_bf16 v[36:39], a[88:91], a[56:59], v[36:39]
v_exp_f32 v91, v51
v_mfma_f32_16x16x32_bf16 v[36:39], a[92:95], a[60:63], v[36:39]
s_waitcnt lgkmcnt(4)
buffer_load_dwordx4 v2, s[12:15], s33 offen offset:3072 sc1 lds
s_add_u32 s33, s33, 16384
v_mfma_f32_16x16x32_bf16 v[40:43], a[96:99], a[0:3], v[80:83]
ds_read_b128 a[64:67], v5 offset:16384
v_cvt_pk_bf16_f32 v72, v88, v89
v_mfma_f32_16x16x32_bf16 v[40:43], a[100:103], a[4:7], v[40:43]
ds_read_b128 a[68:71], v5 offset:17408
v_add_f32 v30, v30, v90
v_mfma_f32_16x16x32_bf16 v[44:47], a[96:99], a[32:35], v[84:87]
v_exp_f32 v92, v52
v_mfma_f32_16x16x32_bf16 v[44:47], a[100:103], a[36:39], v[44:47]
ds_read_b128 a[72:75], v5 offset:18432
v_add_f32 v30, v30, v91
v_mfma_f32_16x16x32_bf16 v[40:43], a[104:107], a[8:11], v[40:43]
v_exp_f32 v93, v53
v_mfma_f32_16x16x32_bf16 v[40:43], a[108:111], a[12:15], v[40:43]
ds_read_b128 a[76:79], v5 offset:19456
v_cvt_pk_bf16_f32 v73, v90, v91
v_mfma_f32_16x16x32_bf16 v[44:47], a[104:107], a[40:43], v[44:47]
v_exp_f32 v94, v54
v_mfma_f32_16x16x32_bf16 v[44:47], a[108:111], a[44:47], v[44:47]
s_waitcnt lgkmcnt(4)
v_add_f32 v31, v92, v93
v_mfma_f32_16x16x32_bf16 v[40:43], a[112:115], a[16:19], v[40:43]
ds_read_b128 a[80:83], v5 offset:20480
v_cvt_pk_bf16_f32 v76, v92, v93
v_mfma_f32_16x16x32_bf16 v[40:43], a[116:119], a[20:23], v[40:43]
ds_read_b128 a[84:87], v5 offset:21504
v_mfma_f32_16x16x32_bf16 v[44:47], a[112:115], a[48:51], v[44:47]
v_exp_f32 v95, v55
v_mfma_f32_16x16x32_bf16 v[44:47], a[116:119], a[52:55], v[44:47]
ds_read_b128 a[88:91], v5 offset:22528
v_add_f32 v31, v31, v94
v_mfma_f32_16x16x32_bf16 v[40:43], a[120:123], a[24:27], v[40:43]
v_exp_f32 v88, v56
v_mfma_f32_16x16x32_bf16 v[40:43], a[124:127], a[28:31], v[40:43]
ds_read_b128 a[92:95], v5 offset:23552
v_add_f32 v31, v31, v95
v_mfma_f32_16x16x32_bf16 v[44:47], a[120:123], a[56:59], v[44:47]
v_exp_f32 v89, v57
v_mfma_f32_16x16x32_bf16 v[44:47], a[124:127], a[60:63], v[44:47]
s_waitcnt lgkmcnt(4)
v_cvt_pk_bf16_f32 v77, v94, v95
v_mfma_f32_16x16x32_bf16 v[128:131], a[64:67], v[64:67], v[128:131]
ds_read_b128 a[96:99], v5 offset:24576
v_add_f32 v30, v30, v88
v_mfma_f32_16x16x32_bf16 v[132:135], a[64:67], v[68:71], v[132:135]
ds_read_b128 a[100:103], v5 offset:25600
v_add_f32 v30, v30, v89
v_mfma_f32_16x16x32_bf16 v[136:139], a[68:71], v[64:67], v[136:139]
v_exp_f32 v90, v58
v_mfma_f32_16x16x32_bf16 v[140:143], a[68:71], v[68:71], v[140:143]
ds_read_b128 a[104:107], v5 offset:26624
v_cvt_pk_bf16_f32 v74, v88, v89
v_mfma_f32_16x16x32_bf16 v[144:147], a[72:75], v[64:67], v[144:147]
v_exp_f32 v91, v59
v_mfma_f32_16x16x32_bf16 v[148:151], a[72:75], v[68:71], v[148:151]
ds_read_b128 a[108:111], v5 offset:27648
v_add_f32 v30, v30, v90
v_mfma_f32_16x16x32_bf16 v[152:155], a[76:79], v[64:67], v[152:155]
v_exp_f32 v92, v60
v_mfma_f32_16x16x32_bf16 v[156:159], a[76:79], v[68:71], v[156:159]
s_waitcnt lgkmcnt(4)
v_add_f32 v30, v30, v91
v_mfma_f32_16x16x32_bf16 v[160:163], a[80:83], v[64:67], v[160:163]
ds_read_b128 a[112:115], v5 offset:28672
v_cvt_pk_bf16_f32 v75, v90, v91
v_mfma_f32_16x16x32_bf16 v[164:167], a[80:83], v[68:71], v[164:167]
ds_read_b128 a[116:119], v5 offset:29696
v_mfma_f32_16x16x32_bf16 v[168:171], a[84:87], v[64:67], v[168:171]
v_exp_f32 v93, v61
v_mfma_f32_16x16x32_bf16 v[172:175], a[84:87], v[68:71], v[172:175]
ds_read_b128 a[120:123], v5 offset:30720
v_add_f32 v31, v31, v92
v_mfma_f32_16x16x32_bf16 v[176:179], a[88:91], v[64:67], v[176:179]
v_exp_f32 v94, v62
v_mfma_f32_16x16x32_bf16 v[180:183], a[88:91], v[68:71], v[180:183]
ds_read_b128 a[124:127], v5 offset:31744
v_add_f32 v31, v31, v93
v_mfma_f32_16x16x32_bf16 v[184:187], a[92:95], v[64:67], v[184:187]
v_exp_f32 v95, v63
v_mfma_f32_16x16x32_bf16 v[188:191], a[92:95], v[68:71], v[188:191]
s_waitcnt lgkmcnt(4)
v_cvt_pk_bf16_f32 v78, v92, v93
v_mfma_f32_16x16x32_bf16 v[192:195], a[96:99], v[64:67], v[192:195]
ds_read_b128 a[64:67], v5 offset:49152
v_add_f32 v31, v31, v94
v_mfma_f32_16x16x32_bf16 v[196:199], a[96:99], v[68:71], v[196:199]
ds_read_b128 a[68:71], v5 offset:50176
v_add_f32 v31, v31, v95
v_mfma_f32_16x16x32_bf16 v[200:203], a[100:103], v[64:67], v[200:203]
v_cvt_pk_bf16_f32 v79, v94, v95
v_add_f32 v96, v30, v31
v_mfma_f32_16x16x32_bf16 v[204:207], a[100:103], v[68:71], v[204:207]
ds_read_b128 a[72:75], v5 offset:51200
v_cmp_lt_f32 vcc, s42, v96
v_mfma_f32_16x16x32_bf16 v[208:211], a[104:107], v[64:67], v[208:211]
v_mfma_f32_16x16x32_bf16 v[212:215], a[104:107], v[68:71], v[212:215]
ds_read_b128 a[76:79], v5 offset:52224
v_mfma_f32_16x16x32_bf16 v[216:219], a[108:111], v[64:67], v[216:219]
v_mfma_f32_16x16x32_bf16 v[220:223], a[108:111], v[68:71], v[220:223]
s_waitcnt lgkmcnt(4)
v_mfma_f32_16x16x32_bf16 v[224:227], a[112:115], v[64:67], v[224:227]
ds_read_b128 a[80:83], v5 offset:53248
v_mfma_f32_16x16x32_bf16 v[228:231], a[112:115], v[68:71], v[228:231]
ds_read_b128 a[84:87], v5 offset:54272
v_mfma_f32_16x16x32_bf16 v[232:235], a[116:119], v[64:67], v[232:235]
v_mfma_f32_16x16x32_bf16 v[236:239], a[116:119], v[68:71], v[236:239]
ds_read_b128 a[88:91], v5 offset:55296
v_mfma_f32_16x16x32_bf16 v[240:243], a[120:123], v[64:67], v[240:243]
v_mfma_f32_16x16x32_bf16 v[244:247], a[120:123], v[68:71], v[244:247]
ds_read_b128 a[92:95], v5 offset:56320
v_mfma_f32_16x16x32_bf16 v[248:251], a[124:127], v[64:67], v[248:251]
v_mfma_f32_16x16x32_bf16 v[252:255], a[124:127], v[68:71], v[252:255]
s_cbranch_vccnz at_stub8
at_ret8:
s_waitcnt vmcnt(4)
s_barrier
s_waitcnt lgkmcnt(4)
v_mfma_f32_16x16x32_bf16 v[128:131], a[64:67], v[72:75], v[128:131]
ds_read_b128 a[96:99], v5 offset:57344
v_mov_b32 v108, 0
buffer_atomic_or v108, v109, s[20:23], s69 offen sc0 sc1
v_add_f32 v28, v28, v30
v_mfma_f32_16x16x32_bf16 v[132:135], a[64:67], v[76:79], v[132:135]
ds_read_b128 a[100:103], v5 offset:58368
v_add_f32 v29, v29, v31
v_subrev_u32 v26, s40, v25
v_cmp_gt_i32 s[50:51], 0, v26
v_mfma_f32_16x16x32_bf16 v[136:139], a[68:71], v[72:75], v[136:139]
s_add_u32 m0, s36, 0
v_cmp_gt_i32 s[52:53], 1, v26
v_cmp_gt_i32 s[54:55], 2, v26
v_cmp_gt_i32 s[56:57], 3, v26
v_mfma_f32_16x16x32_bf16 v[140:143], a[68:71], v[76:79], v[140:143]
ds_read_b128 a[104:107], v5 offset:59392
buffer_load_dwordx4 v12, s[16:19], s34 offen offset:0 sc1 lds
v_mov_b32 v40, v27
v_mov_b32 v41, v27
v_mfma_f32_16x16x32_bf16 v[144:147], a[72:75], v[72:75], v[144:147]
v_mov_b32 v42, v27
v_mov_b32 v43, v27
v_cndmask_b32 v32, v32, v27, s[50:51]
v_cndmask_b32 v33, v33, v27, s[52:53]
v_mfma_f32_16x16x32_bf16 v[148:151], a[72:75], v[76:79], v[148:151]
ds_read_b128 a[108:111], v5 offset:60416
buffer_load_dwordx4 v13, s[16:19], s34 offen offset:1024 sc1 lds
v_cndmask_b32 v34, v34, v27, s[54:55]
v_cndmask_b32 v35, v35, v27, s[56:57]
v_mfma_f32_16x16x32_bf16 v[152:155], a[76:79], v[72:75], v[152:155]
v_cndmask_b32 v44, v44, v27, s[50:51]
v_cndmask_b32 v45, v45, v27, s[52:53]
v_cndmask_b32 v46, v46, v27, s[54:55]
v_cndmask_b32 v47, v47, v27, s[56:57]
v_mfma_f32_16x16x32_bf16 v[156:159], a[76:79], v[76:79], v[156:159]
s_waitcnt lgkmcnt(4)
buffer_load_dwordx4 v14, s[16:19], s34 offen offset:2048 sc1 lds
v_exp_f32 v88, v32
v_mfma_f32_16x16x32_bf16 v[160:163], a[80:83], v[72:75], v[160:163]
ds_read_b128 a[112:115], v5 offset:61440
v_exp_f32 v89, v33
v_mfma_f32_16x16x32_bf16 v[164:167], a[80:83], v[76:79], v[164:167]
ds_read_b128 a[116:119], v5 offset:62464
buffer_load_dwordx4 v15, s[16:19], s34 offen offset:3072 sc1 lds
s_add_u32 s34, s34, s37
v_add_f32 v30, v88, v89
v_mfma_f32_16x16x32_bf16 v[168:171], a[84:87], v[72:75], v[168:171]
v_exp_f32 v90, v34
v_exp_f32 v91, v35
v_mfma_f32_16x16x32_bf16 v[172:175], a[84:87], v[76:79], v[172:175]
ds_read_b128 a[120:123], v5 offset:63488
s_add_u32 m0, s36, 16384
v_exp_f32 v92, v36
v_mfma_f32_16x16x32_bf16 v[176:179], a[88:91], v[72:75], v[176:179]
buffer_load_dwordx4 v12, s[16:19], s35 offen offset:0 sc1 lds
v_exp_f32 v93, v37
v_cvt_pk_bf16_f32 v64, v88, v89
v_mfma_f32_16x16x32_bf16 v[180:183], a[88:91], v[76:79], v[180:183]
ds_read_b128 a[124:127], v5 offset:64512
v_exp_f32 v94, v38
v_add_f32 v30, v30, v90
v_mfma_f32_16x16x32_bf16 v[184:187], a[92:95], v[72:75], v[184:187]
buffer_load_dwordx4 v13, s[16:19], s35 offen offset:1024 sc1 lds
v_exp_f32 v95, v39
v_add_f32 v30, v30, v91
v_mfma_f32_16x16x32_bf16 v[188:191], a[92:95], v[76:79], v[188:191]
s_waitcnt lgkmcnt(4)
v_exp_f32 v88, v40
v_cvt_pk_bf16_f32 v65, v90, v91
v_mfma_f32_16x16x32_bf16 v[192:195], a[96:99], v[72:75], v[192:195]
ds_read_b128 a[64:67], v4 offset:16384
buffer_load_dwordx4 v14, s[16:19], s35 offen offset:2048 sc1 lds
v_exp_f32 v89, v41
v_mfma_f32_16x16x32_bf16 v[196:199], a[96:99], v[76:79], v[196:199]
ds_read_b128 a[68:71], v4 offset:17408
v_exp_f32 v90, v42
v_add_f32 v31, v92, v93
v_mfma_f32_16x16x32_bf16 v[200:203], a[100:103], v[72:75], v[200:203]
buffer_load_dwordx4 v15, s[16:19], s35 offen offset:3072 sc1 lds
s_add_u32 s35, s35, s37
v_exp_f32 v91, v43
v_mfma_f32_16x16x32_bf16 v[204:207], a[100:103], v[76:79], v[204:207]
ds_read_b128 a[72:75], v4 offset:18432
v_cvt_pk_bf16_f32 v68, v92, v93
v_exp_f32 v92, v44
v_mfma_f32_16x16x32_bf16 v[208:211], a[104:107], v[72:75], v[208:211]
v_exp_f32 v93, v45
v_add_f32 v31, v31, v94
v_add_f32 v31, v31, v95
v_mfma_f32_16x16x32_bf16 v[212:215], a[104:107], v[76:79], v[212:215]
ds_read_b128 a[76:79], v4 offset:19456
v_cvt_pk_bf16_f32 v69, v94, v95
v_exp_f32 v94, v46
v_mfma_f32_16x16x32_bf16 v[216:219], a[108:111], v[72:75], v[216:219]
v_exp_f32 v95, v47
v_add_f32 v30, v30, v88
v_add_f32 v30, v30, v89
v_mfma_f32_16x16x32_bf16 v[220:223], a[108:111], v[76:79], v[220:223]
s_waitcnt lgkmcnt(4)
v_cvt_pk_bf16_f32 v66, v88, v89
v_add_f32 v30, v30, v90
v_add_f32 v30, v30, v91
v_mfma_f32_16x16x32_bf16 v[224:227], a[112:115], v[72:75], v[224:227]
ds_read_b128 a[80:83], v4 offset:20480
v_cvt_pk_bf16_f32 v67, v90, v91
v_add_f32 v31, v31, v92
v_add_f32 v31, v31, v93
v_mfma_f32_16x16x32_bf16 v[228:231], a[112:115], v[76:79], v[228:231]
ds_read_b128 a[84:87], v4 offset:21504
v_cvt_pk_bf16_f32 v70, v92, v93
v_add_f32 v31, v31, v94
v_add_f32 v31, v31, v95
v_mfma_f32_16x16x32_bf16 v[232:235], a[116:119], v[72:75], v[232:235]
v_cvt_pk_bf16_f32 v71, v94, v95
v_add_f32 v96, v30, v31
v_cmp_lt_f32 vcc, s42, v96
v_mfma_f32_16x16x32_bf16 v[236:239], a[116:119], v[76:79], v[236:239]
ds_read_b128 a[88:91], v4 offset:22528
v_mfma_f32_16x16x32_bf16 v[240:243], a[120:123], v[72:75], v[240:243]
v_mfma_f32_16x16x32_bf16 v[244:247], a[120:123], v[76:79], v[244:247]
ds_read_b128 a[92:95], v4 offset:23552
v_mfma_f32_16x16x32_bf16 v[248:251], a[124:127], v[72:75], v[248:251]
v_mfma_f32_16x16x32_bf16 v[252:255], a[124:127], v[76:79], v[252:255]
s_cbranch_vccnz at_stub9
at_ret9:
s_waitcnt vmcnt(8)
v_readfirstlane_b32 s60, v108
s_cmp_eq_u32 s22, 0
s_cselect_b32 s60, 1, s60
s_cmp_eq_u32 s60, 1
s_cbranch_scc0 at_w2spin
at_w2spun:
s_barrier
s_waitcnt lgkmcnt(4)
v_mfma_f32_16x16x32_bf16 v[128:131], a[64:67], v[64:67], v[128:131]
ds_read_b128 a[96:99], v4 offset:24576
buffer_load_dwordx4 v[104:107], v2, s[20:23], s70 offen sc1
v_mfma_f32_16x16x32_bf16 v[132:135], a[64:67], v[68:71], v[132:135]
ds_read_b128 a[100:103], v4 offset:25600
buffer_load_dwordx4 a[0:3], v2, s[20:23], s43 offen offset:0 sc1
v_mfma_f32_16x16x32_bf16 v[136:139], a[68:71], v[64:67], v[136:139]
buffer_load_dwordx4 a[4:7], v2, s[20:23], s43 offen offset:1024 sc1
v_add_f32 v28, v28, v30
v_mfma_f32_16x16x32_bf16 v[140:143], a[68:71], v[68:71], v[140:143]
ds_read_b128 a[104:107], v4 offset:26624
buffer_load_dwordx4 a[8:11], v2, s[20:23], s43 offen offset:2048 sc1
v_mfma_f32_16x16x32_bf16 v[144:147], a[72:75], v[64:67], v[144:147]
v_add_f32 v29, v29, v31
v_mfma_f32_16x16x32_bf16 v[148:151], a[72:75], v[68:71], v[148:151]
ds_read_b128 a[108:111], v4 offset:27648
buffer_load_dwordx4 a[12:15], v2, s[20:23], s43 offen offset:3072 sc1
v_mfma_f32_16x16x32_bf16 v[152:155], a[76:79], v[64:67], v[152:155]
s_add_u32 s43, s43, 4096
v_mfma_f32_16x16x32_bf16 v[156:159], a[76:79], v[68:71], v[156:159]
s_waitcnt lgkmcnt(4)
buffer_load_dwordx4 a[16:19], v2, s[20:23], s43 offen offset:0 sc1
v_mfma_f32_16x16x32_bf16 v[160:163], a[80:83], v[64:67], v[160:163]
ds_read_b128 a[112:115], v4 offset:28672
v_mfma_f32_16x16x32_bf16 v[164:167], a[80:83], v[68:71], v[164:167]
ds_read_b128 a[116:119], v4 offset:29696
buffer_load_dwordx4 a[20:23], v2, s[20:23], s43 offen offset:1024 sc1
v_mfma_f32_16x16x32_bf16 v[168:171], a[84:87], v[64:67], v[168:171]
buffer_load_dwordx4 a[24:27], v2, s[20:23], s43 offen offset:2048 sc1
v_mfma_f32_16x16x32_bf16 v[172:175], a[84:87], v[68:71], v[172:175]
ds_read_b128 a[120:123], v4 offset:30720
buffer_load_dwordx4 a[28:31], v2, s[20:23], s43 offen offset:3072 sc1
v_mfma_f32_16x16x32_bf16 v[176:179], a[88:91], v[64:67], v[176:179]
v_mfma_f32_16x16x32_bf16 v[180:183], a[88:91], v[68:71], v[180:183]
ds_read_b128 a[124:127], v4 offset:31744
s_add_u32 s43, s43, 4096
v_mfma_f32_16x16x32_bf16 v[184:187], a[92:95], v[64:67], v[184:187]
buffer_load_dwordx4 a[32:35], v2, s[20:23], s43 offen offset:0 sc1
v_mfma_f32_16x16x32_bf16 v[188:191], a[92:95], v[68:71], v[188:191]
s_waitcnt lgkmcnt(4)
buffer_load_dwordx4 a[36:39], v2, s[20:23], s43 offen offset:1024 sc1
v_mfma_f32_16x16x32_bf16 v[192:195], a[96:99], v[64:67], v[192:195]
buffer_load_dwordx4 a[40:43], v2, s[20:23], s43 offen offset:2048 sc1
v_mfma_f32_16x16x32_bf16 v[196:199], a[96:99], v[68:71], v[196:199]
v_mfma_f32_16x16x32_bf16 v[200:203], a[100:103], v[64:67], v[200:203]
buffer_load_dwordx4 a[44:47], v2, s[20:23], s43 offen offset:3072 sc1
v_mfma_f32_16x16x32_bf16 v[204:207], a[100:103], v[68:71], v[204:207]
s_add_u32 s43, s43, 4096
v_mfma_f32_16x16x32_bf16 v[208:211], a[104:107], v[64:67], v[208:211]
buffer_load_dwordx4 a[48:51], v2, s[20:23], s43 offen offset:0 sc1
v_mfma_f32_16x16x32_bf16 v[212:215], a[104:107], v[68:71], v[212:215]
v_mfma_f32_16x16x32_bf16 v[216:219], a[108:111], v[64:67], v[216:219]
buffer_load_dwordx4 a[52:55], v2, s[20:23], s43 offen offset:1024 sc1
v_mfma_f32_16x16x32_bf16 v[220:223], a[108:111], v[68:71], v[220:223]
s_waitcnt lgkmcnt(0)
buffer_load_dwordx4 a[56:59], v2, s[20:23], s43 offen offset:2048 sc1
v_mfma_f32_16x16x32_bf16 v[224:227], a[112:115], v[64:67], v[224:227]
buffer_load_dwordx4 a[60:63], v2, s[20:23], s43 offen offset:3072 sc1
v_mfma_f32_16x16x32_bf16 v[228:231], a[112:115], v[68:71], v[228:231]
v_mfma_f32_16x16x32_bf16 v[232:235], a[116:119], v[64:67], v[232:235]
v_mfma_f32_16x16x32_bf16 v[236:239], a[116:119], v[68:71], v[236:239]
v_mfma_f32_16x16x32_bf16 v[240:243], a[120:123], v[64:67], v[240:243]
v_mfma_f32_16x16x32_bf16 v[244:247], a[120:123], v[68:71], v[244:247]
v_mfma_f32_16x16x32_bf16 v[248:251], a[124:127], v[64:67], v[248:251]
v_mfma_f32_16x16x32_bf16 v[252:255], a[124:127], v[68:71], v[252:255]
s_nop 0
s_barrier
s_add_u32 m0, s36, 32768
s_nop 0
buffer_load_dwordx4 v12, s[16:19], s34 offen offset:0 sc1 lds
buffer_load_dwordx4 v13, s[16:19], s34 offen offset:1024 sc1 lds
buffer_load_dwordx4 v14, s[16:19], s34 offen offset:2048 sc1 lds
buffer_load_dwordx4 v15, s[16:19], s34 offen offset:3072 sc1 lds
s_add_u32 s34, s34, s37
s_add_u32 m0, s36, 49152
s_nop 0
buffer_load_dwordx4 v12, s[16:19], s35 offen offset:0 sc1 lds
buffer_load_dwordx4 v13, s[16:19], s35 offen offset:1024 sc1 lds
buffer_load_dwordx4 v14, s[16:19], s35 offen offset:2048 sc1 lds
buffer_load_dwordx4 v15, s[16:19], s35 offen offset:3072 sc1 lds
s_add_u32 s35, s35, s37
v_mov_b32 v96, v28
v_mov_b32 v97, v29
s_nop 0
v_permlane16_swap_b32 v28, v96
v_permlane16_swap_b32 v29, v97
v_add_f32 v28, v28, v96
v_add_f32 v29, v29, v97
v_mov_b32 v96, v28
v_mov_b32 v97, v29
s_nop 0
v_permlane32_swap_b32 v28, v96
v_permlane32_swap_b32 v29, v97
v_add_f32 v28, v28, v96
v_add_f32 v29, v29, v97
s_mov_b32 s44, s48
s_add_u32 s45, s48, 8192
s_add_u32 s46, s44, 4096
s_add_u32 s47, s45, 4096
s_branch at_tj
at_t3:
s_waitcnt vmcnt(8)
s_barrier
s_waitcnt lgkmcnt(4)
v_mfma_f32_16x16x32_bf16 v[48:51], a[64:67], a[0:3], v[80:83]
ds_read_b128 a[96:99], v4 offset:40960
v_add_f32 v28, v28, v30
v_add_f32 v29, v29, v31
v_mfma_f32_16x16x32_bf16 v[48:51], a[68:71], a[4:7], v[48:51]
ds_read_b128 a[100:103], v4 offset:41984
s_lshl_b32 s41, s25, 20
s_add_u32 s41, s41, s6
v_mfma_f32_16x16x32_bf16 v[52:55], a[64:67], a[32:35], v[84:87]
s_add_u32 m0, s7, 16384
s_lshl_b32 s67, s3, 14
s_add_u32 s41, s41, s67
v_mfma_f32_16x16x32_bf16 v[52:55], a[68:71], a[36:39], v[52:55]
ds_read_b128 a[104:107], v4 offset:43008
buffer_load_dwordx4 v2, s[12:15], s33 offen offset:0 sc1 lds
s_add_u32 s67, s41, 16384
v_mfma_f32_16x16x32_bf16 v[48:51], a[72:75], a[8:11], v[48:51]
s_add_u32 s34, s41, 32768
s_add_u32 s35, s41, 16777216
s_lshl_b32 s44, s25, 3
v_mfma_f32_16x16x32_bf16 v[48:51], a[76:79], a[12:15], v[48:51]
ds_read_b128 a[108:111], v4 offset:44032
s_add_u32 s44, s44, s24
s_mul_i32 s44, s44, 28672
v_mfma_f32_16x16x32_bf16 v[52:55], a[72:75], a[40:43], v[52:55]
s_add_u32 s45, s44, 114688
s_mov_b32 s77, s44
v_mfma_f32_16x16x32_bf16 v[52:55], a[76:79], a[44:47], v[52:55]
s_waitcnt lgkmcnt(4)
buffer_load_dwordx4 v2, s[12:15], s33 offen offset:1024 sc1 lds
v_mfma_f32_16x16x32_bf16 v[48:51], a[80:83], a[16:19], v[48:51]
ds_read_b128 a[112:115], v4 offset:45056
v_mfma_f32_16x16x32_bf16 v[48:51], a[84:87], a[20:23], v[48:51]
ds_read_b128 a[116:119], v4 offset:46080
v_mfma_f32_16x16x32_bf16 v[52:55], a[80:83], a[48:51], v[52:55]
s_cmp_eq_u32 s31, -1
s_cselect_b32 s22, 0, 268435456
s_cselect_b32 s16, s80, s4
s_cselect_b32 s17, s81, s5
s_cselect_b32 s18, 3670016, s14
s_cselect_b32 s34, s44, s34
s_cselect_b32 s35, s45, s35
s_cselect_b64 s[46:47], -1, 0
v_mfma_f32_16x16x32_bf16 v[52:55], a[84:87], a[52:55], v[52:55]
ds_read_b128 a[120:123], v4 offset:47104
buffer_load_dwordx4 v2, s[12:15], s33 offen offset:2048 sc1 lds
s_mov_b32 s37, 16384
v_mfma_f32_16x16x32_bf16 v[48:51], a[88:91], a[24:27], v[48:51]
s_cmp_eq_u32 s31, -1
s_cselect_b32 s37, 128, s37
s_add_u32 s43, s64, 92274688
v_mfma_f32_16x16x32_bf16 v[48:51], a[92:95], a[28:31], v[48:51]
ds_read_b128 a[124:127], v4 offset:48128
s_add_u32 s48, s64, 83886080
v_mfma_f32_16x16x32_bf16 v[52:55], a[88:91], a[56:59], v[52:55]
s_cmp_eq_u32 s30, 2
s_cselect_b32 s22, 268435456, s22
s_cselect_b32 s69, s58, s59
s_cselect_b32 s43, s48, s43
s_cselect_b32 s70, s65, s70
v_mfma_f32_16x16x32_bf16 v[52:55], a[92:95], a[60:63], v[52:55]
s_waitcnt lgkmcnt(4)
buffer_load_dwordx4 v2, s[12:15], s33 offen offset:3072 sc1 lds
s_add_u32 s33, s33, 16384
v_mfma_f32_16x16x32_bf16 v[56:59], a[96:99], a[0:3], v[80:83]
ds_read_b128 a[64:67], v4 offset:49152
v_exp_f32 v88, v32
v_mfma_f32_16x16x32_bf16 v[56:59], a[100:103], a[4:7], v[56:59]
ds_read_b128 a[68:71], v4 offset:50176
v_exp_f32 v89, v33
v_mfma_f32_16x16x32_bf16 v[60:63], a[96:99], a[32:35], v[84:87]
v_exp_f32 v90, v34
v_add_f32 v30, v88, v89
v_mfma_f32_16x16x32_bf16 v[60:63], a[100:103], a[36:39], v[60:63]
ds_read_b128 a[72:75], v4 offset:51200
v_exp_f32 v91, v35
v_mfma_f32_16x16x32_bf16 v[56:59], a[104:107], a[8:11], v[56:59]
v_exp_f32 v92, v36
v_cvt_pk_bf16_f32 v64, v88, v89
v_mfma_f32_16x16x32_bf16 v[56:59], a[108:111], a[12:15], v[56:59]
ds_read_b128 a[76:79], v4 offset:52224
v_exp_f32 v93, v37
v_mfma_f32_16x16x32_bf16 v[60:63], a[104:107], a[40:43], v[60:63]
v_exp_f32 v94, v38
v_add_f32 v30, v30, v90
v_mfma_f32_16x16x32_bf16 v[60:63], a[108:111], a[44:47], v[60:63]
s_waitcnt lgkmcnt(4)
v_exp_f32 v95, v39
v_mfma_f32_16x16x32_bf16 v[56:59], a[112:115], a[16:19], v[56:59]
ds_read_b128 a[80:83], v4 offset:53248
v_exp_f32 v88, v40
v_mfma_f32_16x16x32_bf16 v[56:59], a[116:119], a[20:23], v[56:59]
ds_read_b128 a[84:87], v4 offset:54272
v_exp_f32 v89, v41
v_mfma_f32_16x16x32_bf16 v[60:63], a[112:115], a[48:51], v[60:63]
v_add_f32 v30, v30, v91
v_cvt_pk_bf16_f32 v65, v90, v91
v_add_f32 v31, v92, v93
v_mfma_f32_16x16x32_bf16 v[60:63], a[116:119], a[52:55], v[60:63]
ds_read_b128 a[88:91], v4 offset:55296
v_exp_f32 v90, v42
v_mfma_f32_16x16x32_bf16 v[56:59], a[120:123], a[24:27], v[56:59]
v_exp_f32 v91, v43
v_cvt_pk_bf16_f32 v68, v92, v93
v_mfma_f32_16x16x32_bf16 v[56:59], a[124:127], a[28:31], v[56:59]
ds_read_b128 a[92:95], v4 offset:56320
v_exp_f32 v92, v44
v_mfma_f32_16x16x32_bf16 v[60:63], a[120:123], a[56:59], v[60:63]
v_exp_f32 v93, v45
v_add_f32 v31, v31, v94
v_mfma_f32_16x16x32_bf16 v[60:63], a[124:127], a[60:63], v[60:63]
s_waitcnt lgkmcnt(4)
v_add_f32 v31, v31, v95
v_cvt_pk_bf16_f32 v69, v94, v95
v_mfma_f32_16x16x32_bf16 v[128:131], a[64:67], v[72:75], v[128:131]
ds_read_b128 a[96:99], v4 offset:57344
v_exp_f32 v94, v46
v_mfma_f32_16x16x32_bf16 v[132:135], a[64:67], v[76:79], v[132:135]
ds_read_b128 a[100:103], v4 offset:58368
v_exp_f32 v95, v47
v_mfma_f32_16x16x32_bf16 v[136:139], a[68:71], v[72:75], v[136:139]
v_add_f32 v30, v30, v88
v_add_f32 v30, v30, v89
v_cvt_pk_bf16_f32 v66, v88, v89
v_mfma_f32_16x16x32_bf16 v[140:143], a[68:71], v[76:79], v[140:143]
ds_read_b128 a[104:107], v4 offset:59392
v_add_f32 v30, v30, v90
v_add_f32 v30, v30, v91
v_mfma_f32_16x16x32_bf16 v[144:147], a[72:75], v[72:75], v[144:147]
v_cvt_pk_bf16_f32 v67, v90, v91
v_add_f32 v31, v31, v92
v_add_f32 v31, v31, v93
v_mfma_f32_16x16x32_bf16 v[148:151], a[72:75], v[76:79], v[148:151]
ds_read_b128 a[108:111], v4 offset:60416
v_cvt_pk_bf16_f32 v70, v92, v93
v_add_f32 v31, v31, v94
v_mfma_f32_16x16x32_bf16 v[152:155], a[76:79], v[72:75], v[152:155]
v_add_f32 v31, v31, v95
v_cvt_pk_bf16_f32 v71, v94, v95
v_add_f32 v96, v30, v31
v_mfma_f32_16x16x32_bf16 v[156:159], a[76:79], v[76:79], v[156:159]
s_waitcnt lgkmcnt(4)
v_cmp_lt_f32 vcc, s42, v96
v_mfma_f32_16x16x32_bf16 v[160:163], a[80:83], v[72:75], v[160:163]
ds_read_b128 a[112:115], v4 offset:61440
v_mfma_f32_16x16x32_bf16 v[164:167], a[80:83], v[76:79], v[164:167]
ds_read_b128 a[116:119], v4 offset:62464
v_mfma_f32_16x16x32_bf16 v[168:171], a[84:87], v[72:75], v[168:171]
v_mfma_f32_16x16x32_bf16 v[172:175], a[84:87], v[76:79], v[172:175]
ds_read_b128 a[120:123], v4 offset:63488
v_mfma_f32_16x16x32_bf16 v[176:179], a[88:91], v[72:75], v[176:179]
v_mfma_f32_16x16x32_bf16 v[180:183], a[88:91], v[76:79], v[180:183]
ds_read_b128 a[124:127], v4 offset:64512
v_mfma_f32_16x16x32_bf16 v[184:187], a[92:95], v[72:75], v[184:187]
v_mfma_f32_16x16x32_bf16 v[188:191], a[92:95], v[76:79], v[188:191]
s_waitcnt lgkmcnt(4)
v_mfma_f32_16x16x32_bf16 v[192:195], a[96:99], v[72:75], v[192:195]
ds_read_b128 a[64:67], v5 offset:0
v_mfma_f32_16x16x32_bf16 v[196:199], a[96:99], v[76:79], v[196:199]
ds_read_b128 a[68:71], v5 offset:1024
v_mfma_f32_16x16x32_bf16 v[200:203], a[100:103], v[72:75], v[200:203]
v_mfma_f32_16x16x32_bf16 v[204:207], a[100:103], v[76:79], v[204:207]
ds_read_b128 a[72:75], v5 offset:2048
v_mfma_f32_16x16x32_bf16 v[208:211], a[104:107], v[72:75], v[208:211]
v_mfma_f32_16x16x32_bf16 v[212:215], a[104:107], v[76:79], v[212:215]
ds_read_b128 a[76:79], v5 offset:3072
v_mfma_f32_16x16x32_bf16 v[216:219], a[108:111], v[72:75], v[216:219]
v_mfma_f32_16x16x32_bf16 v[220:223], a[108:111], v[76:79], v[220:223]
s_waitcnt lgkmcnt(4)
v_mfma_f32_16x16x32_bf16 v[224:227], a[112:115], v[72:75], v[224:227]
ds_read_b128 a[80:83], v5 offset:4096
v_mfma_f32_16x16x32_bf16 v[228:231], a[112:115], v[76:79], v[228:231]
ds_read_b128 a[84:87], v5 offset:5120
v_mfma_f32_16x16x32_bf16 v[232:235], a[116:119], v[72:75], v[232:235]
v_mfma_f32_16x16x32_bf16 v[236:239], a[116:119], v[76:79], v[236:239]
ds_read_b128 a[88:91], v5 offset:6144
v_mfma_f32_16x16x32_bf16 v[240:243], a[120:123], v[72:75], v[240:243]
v_mfma_f32_16x16x32_bf16 v[244:247], a[120:123], v[76:79], v[244:247]
ds_read_b128 a[92:95], v5 offset:7168
v_mfma_f32_16x16x32_bf16 v[248:251], a[124:127], v[72:75], v[248:251]
v_mfma_f32_16x16x32_bf16 v[252:255], a[124:127], v[76:79], v[252:255]
s_cbranch_vccnz at_stub10
at_ret10:
s_waitcnt vmcnt(4)
s_barrier
s_waitcnt lgkmcnt(4)
v_mfma_f32_16x16x32_bf16 v[32:35], a[64:67], a[0:3], v[80:83]
ds_read_b128 a[96:99], v5 offset:8192
v_add_f32 v28, v28, v30
v_mfma_f32_16x16x32_bf16 v[32:35], a[68:71], a[4:7], v[32:35]
ds_read_b128 a[100:103], v5 offset:9216
v_add_f32 v29, v29, v31
v_mfma_f32_16x16x32_bf16 v[36:39], a[64:67], a[32:35], v[84:87]
s_add_u32 m0, s7, 49152
v_cndmask_b32 v12, v2, v16, s[46:47]
v_mfma_f32_16x16x32_bf16 v[36:39], a[68:71], a[36:39], v[36:39]
ds_read_b128 a[104:107], v5 offset:10240
buffer_load_dwordx4 v2, s[12:15], s33 offen offset:0 sc1 lds
v_mfma_f32_16x16x32_bf16 v[32:35], a[72:75], a[8:11], v[32:35]
v_cndmask_b32 v13, v2, v17, s[46:47]
v_cndmask_b32 v14, v2, v18, s[46:47]
v_mfma_f32_16x16x32_bf16 v[32:35], a[76:79], a[12:15], v[32:35]
ds_read_b128 a[108:111], v5 offset:11264
v_cndmask_b32 v15, v2, v19, s[46:47]
v_mfma_f32_16x16x32_bf16 v[36:39], a[72:75], a[40:43], v[36:39]
v_exp_f32 v88, v48
v_mfma_f32_16x16x32_bf16 v[36:39], a[76:79], a[44:47], v[36:39]
s_waitcnt lgkmcnt(4)
buffer_load_dwordx4 v2, s[12:15], s33 offen offset:1024 sc1 lds
v_mfma_f32_16x16x32_bf16 v[32:35], a[80:83], a[16:19], v[32:35]
ds_read_b128 a[112:115], v5 offset:12288
v_mfma_f32_16x16x32_bf16 v[32:35], a[84:87], a[20:23], v[32:35]
ds_read_b128 a[116:119], v5 offset:13312
v_mfma_f32_16x16x32_bf16 v[36:39], a[80:83], a[48:51], v[36:39]
v_exp_f32 v89, v49
v_mfma_f32_16x16x32_bf16 v[36:39], a[84:87], a[52:55], v[36:39]
ds_read_b128 a[120:123], v5 offset:14336
buffer_load_dwordx4 v2, s[12:15], s33 offen offset:2048 sc1 lds
v_mfma_f32_16x16x32_bf16 v[32:35], a[88:91], a[24:27], v[32:35]
v_exp_f32 v90, v50
v_mfma_f32_16x16x32_bf16 v[32:35], a[92:95], a[28:31], v[32:35]
ds_read_b128 a[124:127], v5 offset:15360
v_add_f32 v30, v88, v89
v_mfma_f32_16x16x32_bf16 v[36:39], a[88:91], a[56:59], v[36:39]
v_exp_f32 v91, v51
v_mfma_f32_16x16x32_bf16 v[36:39], a[92:95], a[60:63], v[36:39]
s_waitcnt lgkmcnt(4)
buffer_load_dwordx4 v2, s[12:15], s33 offen offset:3072 sc1 lds
s_add_u32 s33, s33, 16384
v_mfma_f32_16x16x32_bf16 v[40:43], a[96:99], a[0:3], v[80:83]
ds_read_b128 a[64:67], v5 offset:16384
v_cvt_pk_bf16_f32 v72, v88, v89
v_mfma_f32_16x16x32_bf16 v[40:43], a[100:103], a[4:7], v[40:43]
ds_read_b128 a[68:71], v5 offset:17408
v_add_f32 v30, v30, v90
v_mfma_f32_16x16x32_bf16 v[44:47], a[96:99], a[32:35], v[84:87]
v_exp_f32 v92, v52
v_mfma_f32_16x16x32_bf16 v[44:47], a[100:103], a[36:39], v[44:47]
ds_read_b128 a[72:75], v5 offset:18432
v_add_f32 v30, v30, v91
v_mfma_f32_16x16x32_bf16 v[40:43], a[104:107], a[8:11], v[40:43]
v_exp_f32 v93, v53
v_mfma_f32_16x16x32_bf16 v[40:43], a[108:111], a[12:15], v[40:43]
ds_read_b128 a[76:79], v5 offset:19456
v_cvt_pk_bf16_f32 v73, v90, v91
v_mfma_f32_16x16x32_bf16 v[44:47], a[104:107], a[40:43], v[44:47]
v_exp_f32 v94, v54
v_mfma_f32_16x16x32_bf16 v[44:47], a[108:111], a[44:47], v[44:47]
s_waitcnt lgkmcnt(4)
v_add_f32 v31, v92, v93
v_mfma_f32_16x16x32_bf16 v[40:43], a[112:115], a[16:19], v[40:43]
ds_read_b128 a[80:83], v5 offset:20480
v_cvt_pk_bf16_f32 v76, v92, v93
v_mfma_f32_16x16x32_bf16 v[40:43], a[116:119], a[20:23], v[40:43]
ds_read_b128 a[84:87], v5 offset:21504
v_mfma_f32_16x16x32_bf16 v[44:47], a[112:115], a[48:51], v[44:47]
v_exp_f32 v95, v55
v_mfma_f32_16x16x32_bf16 v[44:47], a[116:119], a[52:55], v[44:47]
ds_read_b128 a[88:91], v5 offset:22528
v_add_f32 v31, v31, v94
v_mfma_f32_16x16x32_bf16 v[40:43], a[120:123], a[24:27], v[40:43]
v_exp_f32 v88, v56
v_mfma_f32_16x16x32_bf16 v[40:43], a[124:127], a[28:31], v[40:43]
ds_read_b128 a[92:95], v5 offset:23552
v_add_f32 v31, v31, v95
v_mfma_f32_16x16x32_bf16 v[44:47], a[120:123], a[56:59], v[44:47]
v_exp_f32 v89, v57
v_mfma_f32_16x16x32_bf16 v[44:47], a[124:127], a[60:63], v[44:47]
s_waitcnt lgkmcnt(4)
v_cvt_pk_bf16_f32 v77, v94, v95
v_mfma_f32_16x16x32_bf16 v[128:131], a[64:67], v[64:67], v[128:131]
ds_read_b128 a[96:99], v5 offset:24576
v_add_f32 v30, v30, v88
v_mfma_f32_16x16x32_bf16 v[132:135], a[64:67], v[68:71], v[132:135]
ds_read_b128 a[100:103], v5 offset:25600
v_add_f32 v30, v30, v89
v_mfma_f32_16x16x32_bf16 v[136:139], a[68:71], v[64:67], v[136:139]
v_exp_f32 v90, v58
v_mfma_f32_16x16x32_bf16 v[140:143], a[68:71], v[68:71], v[140:143]
ds_read_b128 a[104:107], v5 offset:26624
v_cvt_pk_bf16_f32 v74, v88, v89
v_mfma_f32_16x16x32_bf16 v[144:147], a[72:75], v[64:67], v[144:147]
v_exp_f32 v91, v59
v_mfma_f32_16x16x32_bf16 v[148:151], a[72:75], v[68:71], v[148:151]
ds_read_b128 a[108:111], v5 offset:27648
v_add_f32 v30, v30, v90
v_mfma_f32_16x16x32_bf16 v[152:155], a[76:79], v[64:67], v[152:155]
v_exp_f32 v92, v60
v_mfma_f32_16x16x32_bf16 v[156:159], a[76:79], v[68:71], v[156:159]
s_waitcnt lgkmcnt(4)
v_add_f32 v30, v30, v91
v_mfma_f32_16x16x32_bf16 v[160:163], a[80:83], v[64:67], v[160:163]
ds_read_b128 a[112:115], v5 offset:28672
v_cvt_pk_bf16_f32 v75, v90, v91
v_mfma_f32_16x16x32_bf16 v[164:167], a[80:83], v[68:71], v[164:167]
ds_read_b128 a[116:119], v5 offset:29696
v_mfma_f32_16x16x32_bf16 v[168:171], a[84:87], v[64:67], v[168:171]
v_exp_f32 v93, v61
v_mfma_f32_16x16x32_bf16 v[172:175], a[84:87], v[68:71], v[172:175]
ds_read_b128 a[120:123], v5 offset:30720
v_add_f32 v31, v31, v92
v_mfma_f32_16x16x32_bf16 v[176:179], a[88:91], v[64:67], v[176:179]
v_exp_f32 v94, v62
v_mfma_f32_16x16x32_bf16 v[180:183], a[88:91], v[68:71], v[180:183]
ds_read_b128 a[124:127], v5 offset:31744
v_add_f32 v31, v31, v93
v_mfma_f32_16x16x32_bf16 v[184:187], a[92:95], v[64:67], v[184:187]
v_exp_f32 v95, v63
v_mfma_f32_16x16x32_bf16 v[188:191], a[92:95], v[68:71], v[188:191]
s_waitcnt lgkmcnt(4)
v_cvt_pk_bf16_f32 v78, v92, v93
v_mfma_f32_16x16x32_bf16 v[192:195], a[96:99], v[64:67], v[192:195]
ds_read_b128 a[64:67], v5 offset:32768
v_add_f32 v31, v31, v94
v_mfma_f32_16x16x32_bf16 v[196:199], a[96:99], v[68:71], v[196:199]
ds_read_b128 a[68:71], v5 offset:33792
v_add_f32 v31, v31, v95
v_mfma_f32_16x16x32_bf16 v[200:203], a[100:103], v[64:67], v[200:203]
v_cvt_pk_bf16_f32 v79, v94, v95
v_add_f32 v96, v30, v31
v_mfma_f32_16x16x32_bf16 v[204:207], a[100:103], v[68:71], v[204:207]
ds_read_b128 a[72:75], v5 offset:34816
v_cmp_lt_f32 vcc, s42, v96
v_mfma_f32_16x16x32_bf16 v[208:211], a[104:107], v[64:67], v[208:211]
v_mfma_f32_16x16x32_bf16 v[212:215], a[104:107], v[68:71], v[212:215]
ds_read_b128 a[76:79], v5 offset:35840
v_mfma_f32_16x16x32_bf16 v[216:219], a[108:111], v[64:67], v[216:219]
v_mfma_f32_16x16x32_bf16 v[220:223], a[108:111], v[68:71], v[220:223]
s_waitcnt lgkmcnt(4)
v_mfma_f32_16x16x32_bf16 v[224:227], a[112:115], v[64:67], v[224:227]
ds_read_b128 a[80:83], v5 offset:36864
v_mfma_f32_16x16x32_bf16 v[228:231], a[112:115], v[68:71], v[228:231]
ds_read_b128 a[84:87], v5 offset:37888
v_mfma_f32_16x16x32_bf16 v[232:235], a[116:119], v[64:67], v[232:235]
v_mfma_f32_16x16x32_bf16 v[236:239], a[116:119], v[68:71], v[236:239]
ds_read_b128 a[88:91], v5 offset:38912
v_mfma_f32_16x16x32_bf16 v[240:243], a[120:123], v[64:67], v[240:243]
v_mfma_f32_16x16x32_bf16 v[244:247], a[120:123], v[68:71], v[244:247]
ds_read_b128 a[92:95], v5 offset:39936
v_mfma_f32_16x16x32_bf16 v[248:251], a[124:127], v[64:67], v[248:251]
v_mfma_f32_16x16x32_bf16 v[252:255], a[124:127], v[68:71], v[252:255]
s_cbranch_vccnz at_stub11
at_ret11:
s_waitcnt vmcnt(4)
s_barrier
s_waitcnt lgkmcnt(4)
v_mfma_f32_16x16x32_bf16 v[48:51], a[64:67], a[0:3], v[80:83]
ds_read_b128 a[96:99], v5 offset:40960
v_mov_b32 v108, 0
buffer_atomic_or v108, v109, s[20:23], s69 offen sc0 sc1
v_mfma_f32_16x16x32_bf16 v[48:51], a[68:71], a[4:7], v[48:51]
ds_read_b128 a[100:103], v5 offset:41984
v_add_f32 v28, v28, v30
v_mfma_f32_16x16x32_bf16 v[52:55], a[64:67], a[32:35], v[84:87]
s_add_u32 m0, s36, 0
v_add_f32 v29, v29, v31
v_mfma_f32_16x16x32_bf16 v[52:55], a[68:71], a[36:39], v[52:55]
ds_read_b128 a[104:107], v5 offset:43008
buffer_load_dwordx4 v12, s[16:19], s34 offen offset:0 sc1 lds
v_mfma_f32_16x16x32_bf16 v[48:51], a[72:75], a[8:11], v[48:51]
v_exp_f32 v88, v32
v_mfma_f32_16x16x32_bf16 v[48:51], a[76:79], a[12:15], v[48:51]
ds_read_b128 a[108:111], v5 offset:44032
v_mfma_f32_16x16x32_bf16 v[52:55], a[72:75], a[40:43], v[52:55]
v_exp_f32 v89, v33
v_mfma_f32_16x16x32_bf16 v[52:55], a[76:79], a[44:47], v[52:55]
s_waitcnt lgkmcnt(4)
buffer_load_dwordx4 v13, s[16:19], s34 offen offset:1024 sc1 lds
v_mfma_f32_16x16x32_bf16 v[48:51], a[80:83], a[16:19], v[48:51]
ds_read_b128 a[112:115], v5 offset:45056
v_add_f32 v30, v88, v89
v_mfma_f32_16x16x32_bf16 v[48:51], a[84:87], a[20:23], v[48:51]
ds_read_b128 a[116:119], v5 offset:46080
v_cvt_pk_bf16_f32 v64, v88, v89
v_mfma_f32_16x16x32_bf16 v[52:55], a[80:83], a[48:51], v[52:55]
v_exp_f32 v90, v34
v_mfma_f32_16x16x32_bf16 v[52:55], a[84:87], a[52:55], v[52:55]
ds_read_b128 a[120:123], v5 offset:47104
buffer_load_dwordx4 v14, s[16:19], s34 offen offset:2048 sc1 lds
v_mfma_f32_16x16x32_bf16 v[48:51], a[88:91], a[24:27], v[48:51]
v_exp_f32 v91, v35
v_mfma_f32_16x16x32_bf16 v[48:51], a[92:95], a[28:31], v[48:51]
ds_read_b128 a[124:127], v5 offset:48128
v_add_f32 v30, v30, v90
v_mfma_f32_16x16x32_bf16 v[52:55], a[88:91], a[56:59], v[52:55]
v_exp_f32 v92, v36
v_mfma_f32_16x16x32_bf16 v[52:55], a[92:95], a[60:63], v[52:55]
s_waitcnt lgkmcnt(4)
buffer_load_dwordx4 v15, s[16:19], s34 offen offset:3072 sc1 lds
s_add_u32 s34, s34, s37
v_mfma_f32_16x16x32_bf16 v[56:59], a[96:99], a[0:3], v[80:83]
ds_read_b128 a[64:67], v5 offset:49152
v_add_f32 v30, v30, v91
v_mfma_f32_16x16x32_bf16 v[56:59], a[100:103], a[4:7], v[56:59]
ds_read_b128 a[68:71], v5 offset:50176
v_cvt_pk_bf16_f32 v65, v90, v91
v_mfma_f32_16x16x32_bf16 v[60:63], a[96:99], a[32:35], v[84:87]
v_exp_f32 v93, v37
v_mfma_f32_16x16x32_bf16 v[60:63], a[100:103], a[36:39], v[60:63]
ds_read_b128 a[72:75], v5 offset:51200
s_add_u32 m0, s36, 16384
v_mfma_f32_16x16x32_bf16 v[56:59], a[104:107], a[8:11], v[56:59]
buffer_load_dwordx4 v12, s[16:19], s35 offen offset:0 sc1 lds
v_add_f32 v31, v92, v93
v_mfma_f32_16x16x32_bf16 v[56:59], a[108:111], a[12:15], v[56:59]
ds_read_b128 a[76:79], v5 offset:52224
v_cvt_pk_bf16_f32 v68, v92, v93
v_mfma_f32_16x16x32_bf16 v[60:63], a[104:107], a[40:43], v[60:63]
v_exp_f32 v94, v38
v_mfma_f32_16x16x32_bf16 v[60:63], a[108:111], a[44:47], v[60:63]
s_waitcnt lgkmcnt(4)
v_mfma_f32_16x16x32_bf16 v[56:59], a[112:115], a[16:19], v[56:59]
ds_read_b128 a[80:83], v5 offset:53248
buffer_load_dwordx4 v13, s[16:19], s35 offen offset:1024 sc1 lds
v_mfma_f32_16x16x32_bf16 v[56:59], a[116:119], a[20:23], v[56:59]
ds_read_b128 a[84:87], v5 offset:54272
v_mfma_f32_16x16x32_bf16 v[60:63], a[112:115], a[48:51], v[60:63]
v_exp_f32 v95, v39
v_mfma_f32_16x16x32_bf16 v[60:63], a[116:119], a[52:55], v[60:63]
ds_read_b128 a[88:91], v5 offset:55296
v_add_f32 v31, v31, v94
v_mfma_f32_16x16x32_bf16 v[56:59], a[120:123], a[24:27], v[56:59]
buffer_load_dwordx4 v14, s[16:19], s35 offen offset:2048 sc1 lds
v_add_f32 v31, v31, v95
v_mfma_f32_16x16x32_bf16 v[56:59], a[124:127], a[28:31], v[56:59]
ds_read_b128 a[92:95], v5 offset:56320
v_cvt_pk_bf16_f32 v69, v94, v95
v_mfma_f32_16x16x32_bf16 v[60:63], a[120:123], a[56:59], v[60:63]
v_exp_f32 v88, v40
v_mfma_f32_16x16x32_bf16 v[60:63], a[124:127], a[60:63], v[60:63]
s_waitcnt lgkmcnt(4)
v_mfma_f32_16x16x32_bf16 v[128:131], a[64:67], v[72:75], v[128:131]
ds_read_b128 a[96:99], v5 offset:57344
buffer_load_dwordx4 v15, s[16:19], s35 offen offset:3072 sc1 lds
s_add_u32 s35, s35, s37
v_mfma_f32_16x16x32_bf16 v[132:135], a[64:67], v[76:79], v[132:135]
ds_read_b128 a[100:103], v5 offset:58368
v_mfma_f32_16x16x32_bf16 v[136:139], a[68:71], v[72:75], v[136:139]
v_exp_f32 v89, v41
v_mfma_f32_16x16x32_bf16 v[140:143], a[68:71], v[76:79], v[140:143]
ds_read_b128 a[104:107], v5 offset:59392
v_add_f32 v30, v30, v88
v_mfma_f32_16x16x32_bf16 v[144:147], a[72:75], v[72:75], v[144:147]
v_exp_f32 v90, v42
v_mfma_f32_16x16x32_bf16 v[148:151], a[72:75], v[76:79], v[148:151]
ds_read_b128 a[108:111], v5 offset:60416
v_add_f32 v30, v30, v89
v_mfma_f32_16x16x32_bf16 v[152:155], a[76:79], v[72:75], v[152:155]
v_exp_f32 v91, v43
v_mfma_f32_16x16x32_bf16 v[156:159], a[76:79], v[76:79], v[156:159]
s_waitcnt lgkmcnt(4)
v_cvt_pk_bf16_f32 v66, v88, v89
v_mfma_f32_16x16x32_bf16 v[160:163], a[80:83], v[72:75], v[160:163]
ds_read_b128 a[112:115], v5 offset:61440
v_add_f32 v30, v30, v90
v_mfma_f32_16x16x32_bf16 v[164:167], a[80:83], v[76:79], v[164:167]
ds_read_b128 a[116:119], v5 offset:62464
v_add_f32 v30, v30, v91
v_mfma_f32_16x16x32_bf16 v[168:171], a[84:87], v[72:75], v[168:171]
v_exp_f32 v92, v44
v_mfma_f32_16x16x32_bf16 v[172:175], a[84:87], v[76:79], v[172:175]
ds_read_b128 a[120:123], v5 offset:63488
v_cvt_pk_bf16_f32 v67, v90, v91
v_mfma_f32_16x16x32_bf16 v[176:179], a[88:91], v[72:75], v[176:179]
v_exp_f32 v93, v45
v_mfma_f32_16x16x32_bf16 v[180:183], a[88:91], v[76:79], v[180:183]
ds_read_b128 a[124:127], v5 offset:64512
v_add_f32 v31, v31, v92
v_mfma_f32_16x16x32_bf16 v[184:187], a[92:95], v[72:75], v[184:187]
v_exp_f32 v94, v46
v_mfma_f32_16x16x32_bf16 v[188:191], a[92:95], v[76:79], v[188:191]
s_waitcnt lgkmcnt(4)
v_add_f32 v31, v31, v93
v_mfma_f32_16x16x32_bf16 v[192:195], a[96:99], v[72:75], v[192:195]
ds_read_b128 a[64:67], v4 offset:16384
v_cvt_pk_bf16_f32 v70, v92, v93
v_mfma_f32_16x16x32_bf16 v[196:199], a[96:99], v[76:79], v[196:199]
ds_read_b128 a[68:71], v4 offset:17408
v_mfma_f32_16x16x32_bf16 v[200:203], a[100:103], v[72:75], v[200:203]
v_exp_f32 v95, v47
v_mfma_f32_16x16x32_bf16 v[204:207], a[100:103], v[76:79], v[204:207]
ds_read_b128 a[72:75], v4 offset:18432
v_add_f32 v31, v31, v94
v_mfma_f32_16x16x32_bf16 v[208:211], a[104:107], v[72:75], v[208:211]
v_add_f32 v31, v31, v95
v_cvt_pk_bf16_f32 v71, v94, v95
v_mfma_f32_16x16x32_bf16 v[212:215], a[104:107], v[76:79], v[212:215]
ds_read_b128 a[76:79], v4 offset:19456
v_add_f32 v96, v30, v31
v_mfma_f32_16x16x32_bf16 v[216:219], a[108:111], v[72:75], v[216:219]
v_cmp_lt_f32 vcc, s42, v96
v_mfma_f32_16x16x32_bf16 v[220:223], a[108:111], v[76:79], v[220:223]
s_waitcnt lgkmcnt(4)
v_mfma_f32_16x16x32_bf16 v[224:227], a[112:115], v[72:75], v[224:227]
ds_read_b128 a[80:83], v4 offset:20480
v_mfma_f32_16x16x32_bf16 v[228:231], a[112:115], v[76:79], v[228:231]
ds_read_b128 a[84:87], v4 offset:21504
v_mfma_f32_16x16x32_bf16 v[232:235], a[116:119], v[72:75], v[232:235]
v_mfma_f32_16x16x32_bf16 v[236:239], a[116:119], v[76:79], v[236:239]
ds_read_b128 a[88:91], v4 offset:22528
v_mfma_f32_16x16x32_bf16 v[240:243], a[120:123], v[72:75], v[240:243]
v_mfma_f32_16x16x32_bf16 v[244:247], a[120:123], v[76:79], v[244:247]
ds_read_b128 a[92:95], v4 offset:23552
v_mfma_f32_16x16x32_bf16 v[248:251], a[124:127], v[72:75], v[248:251]
v_mfma_f32_16x16x32_bf16 v[252:255], a[124:127], v[76:79], v[252:255]
s_cbranch_vccnz at_stub12
at_ret12:
s_waitcnt vmcnt(8)
v_readfirstlane_b32 s60, v108
s_cmp_eq_u32 s22, 0
s_cselect_b32 s60, 1, s60
s_cmp_eq_u32 s60, 1
s_cbranch_scc0 at_w3spin
at_w3spun:
s_barrier
s_waitcnt lgkmcnt(4)
v_mfma_f32_16x16x32_bf16 v[128:131], a[64:67], v[64:67], v[128:131]
ds_read_b128 a[96:99], v4 offset:24576
buffer_load_dwordx4 v[104:107], v2, s[20:23], s70 offen sc1
v_add_f32 v28, v28, v30
v_add_f32 v29, v29, v31
v_mfma_f32_16x16x32_bf16 v[132:135], a[64:67], v[68:71], v[132:135]
ds_read_b128 a[100:103], v4 offset:25600
buffer_load_dwordx4 a[0:3], v2, s[20:23], s43 offen offset:0 sc1
v_subrev_u32 v26, s40, v25
v_cmp_gt_i32 s[50:51], 0, v26
v_mfma_f32_16x16x32_bf16 v[136:139], a[68:71], v[64:67], v[136:139]
buffer_load_dwordx4 a[4:7], v2, s[20:23], s43 offen offset:1024 sc1
v_cmp_gt_i32 s[52:53], 1, v26
v_cmp_gt_i32 s[54:55], 2, v26
v_cmp_gt_i32 s[56:57], 3, v26
v_mfma_f32_16x16x32_bf16 v[140:143], a[68:71], v[68:71], v[140:143]
ds_read_b128 a[104:107], v4 offset:26624
buffer_load_dwordx4 a[8:11], v2, s[20:23], s43 offen offset:2048 sc1
v_mov_b32 v56, v27
v_mov_b32 v57, v27
v_mfma_f32_16x16x32_bf16 v[144:147], a[72:75], v[64:67], v[144:147]
v_mov_b32 v58, v27
v_mov_b32 v59, v27
v_cndmask_b32 v48, v48, v27, s[50:51]
v_cndmask_b32 v49, v49, v27, s[52:53]
v_mfma_f32_16x16x32_bf16 v[148:151], a[72:75], v[68:71], v[148:151]
ds_read_b128 a[108:111], v4 offset:27648
buffer_load_dwordx4 a[12:15], v2, s[20:23], s43 offen offset:3072 sc1
v_cndmask_b32 v50, v50, v27, s[54:55]
v_cndmask_b32 v51, v51, v27, s[56:57]
v_mfma_f32_16x16x32_bf16 v[152:155], a[76:79], v[64:67], v[152:155]
s_add_u32 s43, s43, 4096
v_cndmask_b32 v60, v60, v27, s[50:51]
v_cndmask_b32 v61, v61, v27, s[52:53]
v_cndmask_b32 v62, v62, v27, s[54:55]
v_mfma_f32_16x16x32_bf16 v[156:159], a[76:79], v[68:71], v[156:159]
s_waitcnt lgkmcnt(4)
buffer_load_dwordx4 a[16:19], v2, s[20:23], s43 offen offset:0 sc1
v_cndmask_b32 v63, v63, v27, s[56:57]
v_mfma_f32_16x16x32_bf16 v[160:163], a[80:83], v[64:67], v[160:163]
ds_read_b128 a[112:115], v4 offset:28672
v_exp_f32 v88, v48
v_mfma_f32_16x16x32_bf16 v[164:167], a[80:83], v[68:71], v[164:167]
ds_read_b128 a[116:119], v4 offset:29696
buffer_load_dwordx4 a[20:23], v2, s[20:23], s43 offen offset:1024 sc1
v_exp_f32 v89, v49
v_mfma_f32_16x16x32_bf16 v[168:171], a[84:87], v[64:67], v[168:171]
buffer_load_dwordx4 a[24:27], v2, s[20:23], s43 offen offset:2048 sc1
v_exp_f32 v90, v50
v_add_f32 v30, v88, v89
v_mfma_f32_16x16x32_bf16 v[172:175], a[84:87], v[68:71], v[172:175]
ds_read_b128 a[120:123], v4 offset:30720
buffer_load_dwordx4 a[28:31], v2, s[20:23], s43 offen offset:3072 sc1
v_exp_f32 v91, v51
v_mfma_f32_16x16x32_bf16 v[176:179], a[88:91], v[64:67], v[176:179]
v_exp_f32 v92, v52
v_exp_f32 v93, v53
v_mfma_f32_16x16x32_bf16 v[180:183], a[88:91], v[68:71], v[180:183]
ds_read_b128 a[124:127], v4 offset:31744
s_add_u32 s43, s43, 4096
v_exp_f32 v94, v54
v_mfma_f32_16x16x32_bf16 v[184:187], a[92:95], v[64:67], v[184:187]
buffer_load_dwordx4 a[32:35], v2, s[20:23], s43 offen offset:0 sc1
v_exp_f32 v95, v55
v_cvt_pk_bf16_f32 v72, v88, v89
v_mfma_f32_16x16x32_bf16 v[188:191], a[92:95], v[68:71], v[188:191]
s_waitcnt lgkmcnt(4)
buffer_load_dwordx4 a[36:39], v2, s[20:23], s43 offen offset:1024 sc1
v_exp_f32 v88, v56
v_mfma_f32_16x16x32_bf16 v[192:195], a[96:99], v[64:67], v[192:195]
ds_read_b128 a[64:67], v4 offset:49152
buffer_load_dwordx4 a[40:43], v2, s[20:23], s43 offen offset:2048 sc1
v_exp_f32 v89, v57
v_mfma_f32_16x16x32_bf16 v[196:199], a[96:99], v[68:71], v[196:199]
ds_read_b128 a[68:71], v4 offset:50176
v_add_f32 v30, v30, v90
v_add_f32 v30, v30, v91
v_cvt_pk_bf16_f32 v73, v90, v91
v_mfma_f32_16x16x32_bf16 v[200:203], a[100:103], v[64:67], v[200:203]
buffer_load_dwordx4 a[44:47], v2, s[20:23], s43 offen offset:3072 sc1
v_exp_f32 v90, v58
v_add_f32 v31, v92, v93
v_mfma_f32_16x16x32_bf16 v[204:207], a[100:103], v[68:71], v[204:207]
ds_read_b128 a[72:75], v4 offset:51200
s_add_u32 s43, s43, 4096
v_exp_f32 v91, v59
v_mfma_f32_16x16x32_bf16 v[208:211], a[104:107], v[64:67], v[208:211]
buffer_load_dwordx4 a[48:51], v2, s[20:23], s43 offen offset:0 sc1
v_cvt_pk_bf16_f32 v76, v92, v93
v_exp_f32 v92, v60
v_mfma_f32_16x16x32_bf16 v[212:215], a[104:107], v[68:71], v[212:215]
ds_read_b128 a[76:79], v4 offset:52224
v_exp_f32 v93, v61
v_add_f32 v31, v31, v94
v_mfma_f32_16x16x32_bf16 v[216:219], a[108:111], v[64:67], v[216:219]
buffer_load_dwordx4 a[52:55], v2, s[20:23], s43 offen offset:1024 sc1
v_add_f32 v31, v31, v95
v_cvt_pk_bf16_f32 v77, v94, v95
v_add_f32 v30, v30, v88
v_mfma_f32_16x16x32_bf16 v[220:223], a[108:111], v[68:71], v[220:223]
s_waitcnt lgkmcnt(4)
buffer_load_dwordx4 a[56:59], v2, s[20:23], s43 offen offset:2048 sc1
v_exp_f32 v94, v62
v_mfma_f32_16x16x32_bf16 v[224:227], a[112:115], v[64:67], v[224:227]
ds_read_b128 a[80:83], v4 offset:53248
buffer_load_dwordx4 a[60:63], v2, s[20:23], s43 offen offset:3072 sc1
v_exp_f32 v95, v63
v_mfma_f32_16x16x32_bf16 v[228:231], a[112:115], v[68:71], v[228:231]
ds_read_b128 a[84:87], v4 offset:54272
v_add_f32 v30, v30, v89
v_cvt_pk_bf16_f32 v74, v88, v89
v_add_f32 v30, v30, v90
v_mfma_f32_16x16x32_bf16 v[232:235], a[116:119], v[64:67], v[232:235]
v_add_f32 v30, v30, v91
v_cvt_pk_bf16_f32 v75, v90, v91
v_add_f32 v31, v31, v92
v_add_f32 v31, v31, v93
v_mfma_f32_16x16x32_bf16 v[236:239], a[116:119], v[68:71], v[236:239]
ds_read_b128 a[88:91], v4 offset:55296
v_cvt_pk_bf16_f32 v78, v92, v93
v_add_f32 v31, v31, v94
v_add_f32 v31, v31, v95
v_mfma_f32_16x16x32_bf16 v[240:243], a[120:123], v[64:67], v[240:243]
v_cvt_pk_bf16_f32 v79, v94, v95
v_add_f32 v96, v30, v31
v_cmp_lt_f32 vcc, s42, v96
v_mfma_f32_16x16x32_bf16 v[244:247], a[120:123], v[68:71], v[244:247]
ds_read_b128 a[92:95], v4 offset:56320
v_mfma_f32_16x16x32_bf16 v[248:251], a[124:127], v[64:67], v[248:251]
v_mfma_f32_16x16x32_bf16 v[252:255], a[124:127], v[68:71], v[252:255]
s_cbranch_vccnz at_stub13
at_ret13:
s_nop 0
s_barrier
s_waitcnt lgkmcnt(4)
v_mfma_f32_16x16x32_bf16 v[128:131], a[64:67], v[72:75], v[128:131]
ds_read_b128 a[96:99], v4 offset:57344
v_add_f32 v28, v28, v30
v_mfma_f32_16x16x32_bf16 v[132:135], a[64:67], v[76:79], v[132:135]
ds_read_b128 a[100:103], v4 offset:58368
v_add_f32 v29, v29, v31
v_mfma_f32_16x16x32_bf16 v[136:139], a[68:71], v[72:75], v[136:139]
s_add_u32 m0, s36, 32768
v_mov_b32 v96, v28
v_mfma_f32_16x16x32_bf16 v[140:143], a[68:71], v[76:79], v[140:143]
ds_read_b128 a[104:107], v4 offset:59392
buffer_load_dwordx4 v12, s[16:19], s34 offen offset:0 sc1 lds
v_mfma_f32_16x16x32_bf16 v[144:147], a[72:75], v[72:75], v[144:147]
v_mov_b32 v97, v29
v_permlane16_swap_b32 v28, v96
v_mfma_f32_16x16x32_bf16 v[148:151], a[72:75], v[76:79], v[148:151]
ds_read_b128 a[108:111], v4 offset:60416
buffer_load_dwordx4 v13, s[16:19], s34 offen offset:1024 sc1 lds
v_mfma_f32_16x16x32_bf16 v[152:155], a[76:79], v[72:75], v[152:155]
v_permlane16_swap_b32 v29, v97
v_add_f32 v28, v28, v96
v_mfma_f32_16x16x32_bf16 v[156:159], a[76:79], v[76:79], v[156:159]
s_waitcnt lgkmcnt(4)
buffer_load_dwordx4 v14, s[16:19], s34 offen offset:2048 sc1 lds
v_mfma_f32_16x16x32_bf16 v[160:163], a[80:83], v[72:75], v[160:163]
ds_read_b128 a[112:115], v4 offset:61440
v_add_f32 v29, v29, v97
v_mfma_f32_16x16x32_bf16 v[164:167], a[80:83], v[76:79], v[164:167]
ds_read_b128 a[116:119], v4 offset:62464
buffer_load_dwordx4 v15, s[16:19], s34 offen offset:3072 sc1 lds
s_add_u32 s34, s34, s37
v_mfma_f32_16x16x32_bf16 v[168:171], a[84:87], v[72:75], v[168:171]
v_mov_b32 v96, v28
v_mov_b32 v97, v29
v_mfma_f32_16x16x32_bf16 v[172:175], a[84:87], v[76:79], v[172:175]
ds_read_b128 a[120:123], v4 offset:63488
s_add_u32 m0, s36, 49152
v_mfma_f32_16x16x32_bf16 v[176:179], a[88:91], v[72:75], v[176:179]
buffer_load_dwordx4 v12, s[16:19], s35 offen offset:0 sc1 lds
v_permlane32_swap_b32 v28, v96
v_mfma_f32_16x16x32_bf16 v[180:183], a[88:91], v[76:79], v[180:183]
ds_read_b128 a[124:127], v4 offset:64512
v_permlane32_swap_b32 v29, v97
v_mfma_f32_16x16x32_bf16 v[184:187], a[92:95], v[72:75], v[184:187]
buffer_load_dwordx4 v13, s[16:19], s35 offen offset:1024 sc1 lds
v_add_f32 v28, v28, v96
v_mfma_f32_16x16x32_bf16 v[188:191], a[92:95], v[76:79], v[188:191]
s_waitcnt lgkmcnt(4)
v_add_f32 v29, v29, v97
v_mfma_f32_16x16x32_bf16 v[192:195], a[96:99], v[72:75], v[192:195]
buffer_load_dwordx4 v14, s[16:19], s35 offen offset:2048 sc1 lds
s_mov_b32 s44, s48
v_mfma_f32_16x16x32_bf16 v[196:199], a[96:99], v[76:79], v[196:199]
s_add_u32 s45, s48, 8192
s_add_u32 s46, s44, 4096
v_mfma_f32_16x16x32_bf16 v[200:203], a[100:103], v[72:75], v[200:203]
buffer_load_dwordx4 v15, s[16:19], s35 offen offset:3072 sc1 lds
s_add_u32 s35, s35, s37
v_mfma_f32_16x16x32_bf16 v[204:207], a[100:103], v[76:79], v[204:207]
s_add_u32 s47, s45, 4096
v_mfma_f32_16x16x32_bf16 v[208:211], a[104:107], v[72:75], v[208:211]
v_mfma_f32_16x16x32_bf16 v[212:215], a[104:107], v[76:79], v[212:215]
v_mfma_f32_16x16x32_bf16 v[216:219], a[108:111], v[72:75], v[216:219]
v_mfma_f32_16x16x32_bf16 v[220:223], a[108:111], v[76:79], v[220:223]
s_waitcnt lgkmcnt(0)
v_mfma_f32_16x16x32_bf16 v[224:227], a[112:115], v[72:75], v[224:227]
v_mfma_f32_16x16x32_bf16 v[228:231], a[112:115], v[76:79], v[228:231]
v_mfma_f32_16x16x32_bf16 v[232:235], a[116:119], v[72:75], v[232:235]
v_mfma_f32_16x16x32_bf16 v[236:239], a[116:119], v[76:79], v[236:239]
v_mfma_f32_16x16x32_bf16 v[240:243], a[120:123], v[72:75], v[240:243]
v_mfma_f32_16x16x32_bf16 v[244:247], a[120:123], v[76:79], v[244:247]
v_mfma_f32_16x16x32_bf16 v[248:251], a[124:127], v[72:75], v[248:251]
v_mfma_f32_16x16x32_bf16 v[252:255], a[124:127], v[76:79], v[252:255]
s_branch at_tj
at_tf:
s_waitcnt vmcnt(8)
s_barrier
s_waitcnt lgkmcnt(4)
v_mfma_f32_16x16x32_bf16 v[48:51], a[64:67], a[0:3], v[80:83]
ds_read_b128 a[96:99], v4 offset:40960
v_add_f32 v28, v28, v30
v_add_f32 v29, v29, v31
v_mfma_f32_16x16x32_bf16 v[48:51], a[68:71], a[4:7], v[48:51]
ds_read_b128 a[100:103], v4 offset:41984
s_lshl_b32 s41, s25, 20
s_add_u32 s41, s41, s6
v_mfma_f32_16x16x32_bf16 v[52:55], a[64:67], a[32:35], v[84:87]
s_add_u32 m0, s7, 16384
s_lshl_b32 s67, s3, 14
s_add_u32 s41, s41, s67
v_mfma_f32_16x16x32_bf16 v[52:55], a[68:71], a[36:39], v[52:55]
ds_read_b128 a[104:107], v4 offset:43008
buffer_load_dwordx4 v2, s[12:15], s33 offen offset:0 sc1 lds
s_add_u32 s67, s41, 16384
v_mfma_f32_16x16x32_bf16 v[48:51], a[72:75], a[8:11], v[48:51]
s_add_u32 s34, s41, 32768
s_add_u32 s35, s41, 16777216
s_lshl_b32 s44, s25, 3
v_mfma_f32_16x16x32_bf16 v[48:51], a[76:79], a[12:15], v[48:51]
ds_read_b128 a[108:111], v4 offset:44032
s_add_u32 s44, s44, s24
s_mul_i32 s44, s44, 28672
v_mfma_f32_16x16x32_bf16 v[52:55], a[72:75], a[40:43], v[52:55]
s_add_u32 s45, s44, 114688
s_mov_b32 s77, s44
v_mfma_f32_16x16x32_bf16 v[52:55], a[76:79], a[44:47], v[52:55]
s_waitcnt lgkmcnt(4)
buffer_load_dwordx4 v2, s[12:15], s33 offen offset:1024 sc1 lds
v_mfma_f32_16x16x32_bf16 v[48:51], a[80:83], a[16:19], v[48:51]
ds_read_b128 a[112:115], v4 offset:45056
v_mfma_f32_16x16x32_bf16 v[48:51], a[84:87], a[20:23], v[48:51]
ds_read_b128 a[116:119], v4 offset:46080
v_mfma_f32_16x16x32_bf16 v[52:55], a[80:83], a[48:51], v[52:55]
s_cmp_eq_u32 s31, -1
s_cselect_b32 s22, 0, 268435456
s_cselect_b32 s16, s80, s4
s_cselect_b32 s17, s81, s5
s_cselect_b32 s18, 3670016, s14
s_cselect_b32 s34, s44, s34
s_cselect_b32 s35, s45, s35
s_cselect_b64 s[46:47], -1, 0
v_mfma_f32_16x16x32_bf16 v[52:55], a[84:87], a[52:55], v[52:55]
ds_read_b128 a[120:123], v4 offset:47104
buffer_load_dwordx4 v2, s[12:15], s33 offen offset:2048 sc1 lds
s_mov_b32 s37, 16384
v_mfma_f32_16x16x32_bf16 v[48:51], a[88:91], a[24:27], v[48:51]
s_cmp_eq_u32 s31, -1
s_cselect_b32 s37, 128, s37
s_add_u32 s43, s64, 92274688
v_mfma_f32_16x16x32_bf16 v[48:51], a[92:95], a[28:31], v[48:51]
ds_read_b128 a[124:127], v4 offset:48128
s_add_u32 s48, s64, 83886080
v_mfma_f32_16x16x32_bf16 v[52:55], a[88:91], a[56:59], v[52:55]
s_cmp_eq_u32 s30, 2
s_cselect_b32 s22, 268435456, s22
s_cselect_b32 s69, s58, s59
s_cselect_b32 s43, s48, s43
s_cselect_b32 s70, s65, s70
v_mfma_f32_16x16x32_bf16 v[52:55], a[92:95], a[60:63], v[52:55]
s_waitcnt lgkmcnt(4)
buffer_load_dwordx4 v2, s[12:15], s33 offen offset:3072 sc1 lds
s_add_u32 s33, s33, 16384
v_mfma_f32_16x16x32_bf16 v[56:59], a[96:99], a[0:3], v[80:83]
ds_read_b128 a[64:67], v4 offset:49152
v_exp_f32 v88, v32
v_mfma_f32_16x16x32_bf16 v[56:59], a[100:103], a[4:7], v[56:59]
ds_read_b128 a[68:71], v4 offset:50176
v_exp_f32 v89, v33
v_mfma_f32_16x16x32_bf16 v[60:63], a[96:99], a[32:35], v[84:87]
v_exp_f32 v90, v34
v_add_f32 v30, v88, v89
v_mfma_f32_16x16x32_bf16 v[60:63], a[100:103], a[36:39], v[60:63]
ds_read_b128 a[72:75], v4 offset:51200
v_exp_f32 v91, v35
v_mfma_f32_16x16x32_bf16 v[56:59], a[104:107], a[8:11], v[56:59]
v_exp_f32 v92, v36
v_cvt_pk_bf16_f32 v64, v88, v89
v_mfma_f32_16x16x32_bf16 v[56:59], a[108:111], a[12:15], v[56:59]
ds_read_b128 a[76:79], v4 offset:52224
v_exp_f32 v93, v37
v_mfma_f32_16x16x32_bf16 v[60:63], a[104:107], a[40:43], v[60:63]
v_exp_f32 v94, v38
v_add_f32 v30, v30, v90
v_mfma_f32_16x16x32_bf16 v[60:63], a[108:111], a[44:47], v[60:63]
s_waitcnt lgkmcnt(4)
v_exp_f32 v95, v39
v_mfma_f32_16x16x32_bf16 v[56:59], a[112:115], a[16:19], v[56:59]
ds_read_b128 a[80:83], v4 offset:53248
v_exp_f32 v88, v40
v_mfma_f32_16x16x32_bf16 v[56:59], a[116:119], a[20:23], v[56:59]
ds_read_b128 a[84:87], v4 offset:54272
v_exp_f32 v89, v41
v_mfma_f32_16x16x32_bf16 v[60:63], a[112:115], a[48:51], v[60:63]
v_add_f32 v30, v30, v91
v_cvt_pk_bf16_f32 v65, v90, v91
v_add_f32 v31, v92, v93
v_mfma_f32_16x16x32_bf16 v[60:63], a[116:119], a[52:55], v[60:63]
ds_read_b128 a[88:91], v4 offset:55296
v_exp_f32 v90, v42
v_mfma_f32_16x16x32_bf16 v[56:59], a[120:123], a[24:27], v[56:59]
v_exp_f32 v91, v43
v_cvt_pk_bf16_f32 v68, v92, v93
v_mfma_f32_16x16x32_bf16 v[56:59], a[124:127], a[28:31], v[56:59]
ds_read_b128 a[92:95], v4 offset:56320
v_exp_f32 v92, v44
v_mfma_f32_16x16x32_bf16 v[60:63], a[120:123], a[56:59], v[60:63]
v_exp_f32 v93, v45
v_add_f32 v31, v31, v94
v_mfma_f32_16x16x32_bf16 v[60:63], a[124:127], a[60:63], v[60:63]
s_waitcnt lgkmcnt(4)
v_add_f32 v31, v31, v95
v_cvt_pk_bf16_f32 v69, v94, v95
v_mfma_f32_16x16x32_bf16 v[128:131], a[64:67], v[72:75], v[128:131]
ds_read_b128 a[96:99], v4 offset:57344
v_exp_f32 v94, v46
v_mfma_f32_16x16x32_bf16 v[132:135], a[64:67], v[76:79], v[132:135]
ds_read_b128 a[100:103], v4 offset:58368
v_exp_f32 v95, v47
v_mfma_f32_16x16x32_bf16 v[136:139], a[68:71], v[72:75], v[136:139]
v_add_f32 v30, v30, v88
v_add_f32 v30, v30, v89
v_cvt_pk_bf16_f32 v66, v88, v89
v_mfma_f32_16x16x32_bf16 v[140:143], a[68:71], v[76:79], v[140:143]
ds_read_b128 a[104:107], v4 offset:59392
v_add_f32 v30, v30, v90
v_add_f32 v30, v30, v91
v_mfma_f32_16x16x32_bf16 v[144:147], a[72:75], v[72:75], v[144:147]
v_cvt_pk_bf16_f32 v67, v90, v91
v_add_f32 v31, v31, v92
v_add_f32 v31, v31, v93
v_mfma_f32_16x16x32_bf16 v[148:151], a[72:75], v[76:79], v[148:151]
ds_read_b128 a[108:111], v4 offset:60416
v_cvt_pk_bf16_f32 v70, v92, v93
v_add_f32 v31, v31, v94
v_mfma_f32_16x16x32_bf16 v[152:155], a[76:79], v[72:75], v[152:155]
v_add_f32 v31, v31, v95
v_cvt_pk_bf16_f32 v71, v94, v95
v_add_f32 v96, v30, v31
v_mfma_f32_16x16x32_bf16 v[156:159], a[76:79], v[76:79], v[156:159]
s_waitcnt lgkmcnt(4)
v_cmp_lt_f32 vcc, s42, v96
v_mfma_f32_16x16x32_bf16 v[160:163], a[80:83], v[72:75], v[160:163]
ds_read_b128 a[112:115], v4 offset:61440
v_mfma_f32_16x16x32_bf16 v[164:167], a[80:83], v[76:79], v[164:167]
ds_read_b128 a[116:119], v4 offset:62464
v_mfma_f32_16x16x32_bf16 v[168:171], a[84:87], v[72:75], v[168:171]
v_mfma_f32_16x16x32_bf16 v[172:175], a[84:87], v[76:79], v[172:175]
ds_read_b128 a[120:123], v4 offset:63488
v_mfma_f32_16x16x32_bf16 v[176:179], a[88:91], v[72:75], v[176:179]
v_mfma_f32_16x16x32_bf16 v[180:183], a[88:91], v[76:79], v[180:183]
ds_read_b128 a[124:127], v4 offset:64512
v_mfma_f32_16x16x32_bf16 v[184:187], a[92:95], v[72:75], v[184:187]
v_mfma_f32_16x16x32_bf16 v[188:191], a[92:95], v[76:79], v[188:191]
s_waitcnt lgkmcnt(4)
v_mfma_f32_16x16x32_bf16 v[192:195], a[96:99], v[72:75], v[192:195]
ds_read_b128 a[64:67], v5 offset:0
v_mfma_f32_16x16x32_bf16 v[196:199], a[96:99], v[76:79], v[196:199]
ds_read_b128 a[68:71], v5 offset:1024
v_mfma_f32_16x16x32_bf16 v[200:203], a[100:103], v[72:75], v[200:203]
v_mfma_f32_16x16x32_bf16 v[204:207], a[100:103], v[76:79], v[204:207]
ds_read_b128 a[72:75], v5 offset:2048
v_mfma_f32_16x16x32_bf16 v[208:211], a[104:107], v[72:75], v[208:211]
v_mfma_f32_16x16x32_bf16 v[212:215], a[104:107], v[76:79], v[212:215]
ds_read_b128 a[76:79], v5 offset:3072
v_mfma_f32_16x16x32_bf16 v[216:219], a[108:111], v[72:75], v[216:219]
v_mfma_f32_16x16x32_bf16 v[220:223], a[108:111], v[76:79], v[220:223]
s_waitcnt lgkmcnt(4)
v_mfma_f32_16x16x32_bf16 v[224:227], a[112:115], v[72:75], v[224:227]
ds_read_b128 a[80:83], v5 offset:4096
v_mfma_f32_16x16x32_bf16 v[228:231], a[112:115], v[76:79], v[228:231]
ds_read_b128 a[84:87], v5 offset:5120
v_mfma_f32_16x16x32_bf16 v[232:235], a[116:119], v[72:75], v[232:235]
v_mfma_f32_16x16x32_bf16 v[236:239], a[116:119], v[76:79], v[236:239]
ds_read_b128 a[88:91], v5 offset:6144
v_mfma_f32_16x16x32_bf16 v[240:243], a[120:123], v[72:75], v[240:243]
v_mfma_f32_16x16x32_bf16 v[244:247], a[120:123], v[76:79], v[244:247]
ds_read_b128 a[92:95], v5 offset:7168
v_mfma_f32_16x16x32_bf16 v[248:251], a[124:127], v[72:75], v[248:251]
v_mfma_f32_16x16x32_bf16 v[252:255], a[124:127], v[76:79], v[252:255]
s_cbranch_vccnz at_stub14
at_ret14:
s_waitcnt vmcnt(4)
s_barrier
s_waitcnt lgkmcnt(4)
v_mfma_f32_16x16x32_bf16 v[32:35], a[64:67], a[0:3], v[80:83]
ds_read_b128 a[96:99], v5 offset:8192
v_add_f32 v28, v28, v30
v_mfma_f32_16x16x32_bf16 v[32:35], a[68:71], a[4:7], v[32:35]
ds_read_b128 a[100:103], v5 offset:9216
v_add_f32 v29, v29, v31
v_mfma_f32_16x16x32_bf16 v[36:39], a[64:67], a[32:35], v[84:87]
s_add_u32 m0, s7, 49152
v_cndmask_b32 v12, v2, v16, s[46:47]
v_mfma_f32_16x16x32_bf16 v[36:39], a[68:71], a[36:39], v[36:39]
ds_read_b128 a[104:107], v5 offset:10240
buffer_load_dwordx4 v2, s[12:15], s33 offen offset:0 sc1 lds
v_mfma_f32_16x16x32_bf16 v[32:35], a[72:75], a[8:11], v[32:35]
v_cndmask_b32 v13, v2, v17, s[46:47]
v_cndmask_b32 v14, v2, v18, s[46:47]
v_mfma_f32_16x16x32_bf16 v[32:35], a[76:79], a[12:15], v[32:35]
ds_read_b128 a[108:111], v5 offset:11264
v_cndmask_b32 v15, v2, v19, s[46:47]
v_mfma_f32_16x16x32_bf16 v[36:39], a[72:75], a[40:43], v[36:39]
v_exp_f32 v88, v48
v_mfma_f32_16x16x32_bf16 v[36:39], a[76:79], a[44:47], v[36:39]
s_waitcnt lgkmcnt(4)
buffer_load_dwordx4 v2, s[12:15], s33 offen offset:1024 sc1 lds
v_mfma_f32_16x16x32_bf16 v[32:35], a[80:83], a[16:19], v[32:35]
ds_read_b128 a[112:115], v5 offset:12288
v_mfma_f32_16x16x32_bf16 v[32:35], a[84:87], a[20:23], v[32:35]
ds_read_b128 a[116:119], v5 offset:13312
v_mfma_f32_16x16x32_bf16 v[36:39], a[80:83], a[48:51], v[36:39]
v_exp_f32 v89, v49
v_mfma_f32_16x16x32_bf16 v[36:39], a[84:87], a[52:55], v[36:39]
ds_read_b128 a[120:123], v5 offset:14336
buffer_load_dwordx4 v2, s[12:15], s33 offen offset:2048 sc1 lds
v_mfma_f32_16x16x32_bf16 v[32:35], a[88:91], a[24:27], v[32:35]
v_exp_f32 v90, v50
v_mfma_f32_16x16x32_bf16 v[32:35], a[92:95], a[28:31], v[32:35]
ds_read_b128 a[124:127], v5 offset:15360
v_add_f32 v30, v88, v89
v_mfma_f32_16x16x32_bf16 v[36:39], a[88:91], a[56:59], v[36:39]
v_exp_f32 v91, v51
v_mfma_f32_16x16x32_bf16 v[36:39], a[92:95], a[60:63], v[36:39]
s_waitcnt lgkmcnt(4)
buffer_load_dwordx4 v2, s[12:15], s33 offen offset:3072 sc1 lds
s_add_u32 s33, s33, 16384
v_mfma_f32_16x16x32_bf16 v[40:43], a[96:99], a[0:3], v[80:83]
ds_read_b128 a[64:67], v5 offset:16384
v_cvt_pk_bf16_f32 v72, v88, v89
v_mfma_f32_16x16x32_bf16 v[40:43], a[100:103], a[4:7], v[40:43]
ds_read_b128 a[68:71], v5 offset:17408
v_add_f32 v30, v30, v90
v_mfma_f32_16x16x32_bf16 v[44:47], a[96:99], a[32:35], v[84:87]
v_exp_f32 v92, v52
v_mfma_f32_16x16x32_bf16 v[44:47], a[100:103], a[36:39], v[44:47]
ds_read_b128 a[72:75], v5 offset:18432
v_add_f32 v30, v30, v91
v_mfma_f32_16x16x32_bf16 v[40:43], a[104:107], a[8:11], v[40:43]
v_exp_f32 v93, v53
v_mfma_f32_16x16x32_bf16 v[40:43], a[108:111], a[12:15], v[40:43]
ds_read_b128 a[76:79], v5 offset:19456
v_cvt_pk_bf16_f32 v73, v90, v91
v_mfma_f32_16x16x32_bf16 v[44:47], a[104:107], a[40:43], v[44:47]
v_exp_f32 v94, v54
v_mfma_f32_16x16x32_bf16 v[44:47], a[108:111], a[44:47], v[44:47]
s_waitcnt lgkmcnt(4)
v_add_f32 v31, v92, v93
v_mfma_f32_16x16x32_bf16 v[40:43], a[112:115], a[16:19], v[40:43]
ds_read_b128 a[80:83], v5 offset:20480
v_cvt_pk_bf16_f32 v76, v92, v93
v_mfma_f32_16x16x32_bf16 v[40:43], a[116:119], a[20:23], v[40:43]
ds_read_b128 a[84:87], v5 offset:21504
v_mfma_f32_16x16x32_bf16 v[44:47], a[112:115], a[48:51], v[44:47]
v_exp_f32 v95, v55
v_mfma_f32_16x16x32_bf16 v[44:47], a[116:119], a[52:55], v[44:47]
ds_read_b128 a[88:91], v5 offset:22528
v_add_f32 v31, v31, v94
v_mfma_f32_16x16x32_bf16 v[40:43], a[120:123], a[24:27], v[40:43]
v_exp_f32 v88, v56
v_mfma_f32_16x16x32_bf16 v[40:43], a[124:127], a[28:31], v[40:43]
ds_read_b128 a[92:95], v5 offset:23552
v_add_f32 v31, v31, v95
v_mfma_f32_16x16x32_bf16 v[44:47], a[120:123], a[56:59], v[44:47]
v_exp_f32 v89, v57
v_mfma_f32_16x16x32_bf16 v[44:47], a[124:127], a[60:63], v[44:47]
s_waitcnt lgkmcnt(4)
v_cvt_pk_bf16_f32 v77, v94, v95
v_mfma_f32_16x16x32_bf16 v[128:131], a[64:67], v[64:67], v[128:131]
ds_read_b128 a[96:99], v5 offset:24576
v_add_f32 v30, v30, v88
v_mfma_f32_16x16x32_bf16 v[132:135], a[64:67], v[68:71], v[132:135]
ds_read_b128 a[100:103], v5 offset:25600
v_add_f32 v30, v30, v89
v_mfma_f32_16x16x32_bf16 v[136:139], a[68:71], v[64:67], v[136:139]
v_exp_f32 v90, v58
v_mfma_f32_16x16x32_bf16 v[140:143], a[68:71], v[68:71], v[140:143]
ds_read_b128 a[104:107], v5 offset:26624
v_cvt_pk_bf16_f32 v74, v88, v89
v_mfma_f32_16x16x32_bf16 v[144:147], a[72:75], v[64:67], v[144:147]
v_exp_f32 v91, v59
v_mfma_f32_16x16x32_bf16 v[148:151], a[72:75], v[68:71], v[148:151]
ds_read_b128 a[108:111], v5 offset:27648
v_add_f32 v30, v30, v90
v_mfma_f32_16x16x32_bf16 v[152:155], a[76:79], v[64:67], v[152:155]
v_exp_f32 v92, v60
v_mfma_f32_16x16x32_bf16 v[156:159], a[76:79], v[68:71], v[156:159]
s_waitcnt lgkmcnt(4)
v_add_f32 v30, v30, v91
v_mfma_f32_16x16x32_bf16 v[160:163], a[80:83], v[64:67], v[160:163]
ds_read_b128 a[112:115], v5 offset:28672
v_cvt_pk_bf16_f32 v75, v90, v91
v_mfma_f32_16x16x32_bf16 v[164:167], a[80:83], v[68:71], v[164:167]
ds_read_b128 a[116:119], v5 offset:29696
v_mfma_f32_16x16x32_bf16 v[168:171], a[84:87], v[64:67], v[168:171]
v_exp_f32 v93, v61
v_mfma_f32_16x16x32_bf16 v[172:175], a[84:87], v[68:71], v[172:175]
ds_read_b128 a[120:123], v5 offset:30720
v_add_f32 v31, v31, v92
v_mfma_f32_16x16x32_bf16 v[176:179], a[88:91], v[64:67], v[176:179]
v_exp_f32 v94, v62
v_mfma_f32_16x16x32_bf16 v[180:183], a[88:91], v[68:71], v[180:183]
ds_read_b128 a[124:127], v5 offset:31744
v_add_f32 v31, v31, v93
v_mfma_f32_16x16x32_bf16 v[184:187], a[92:95], v[64:67], v[184:187]
v_exp_f32 v95, v63
v_mfma_f32_16x16x32_bf16 v[188:191], a[92:95], v[68:71], v[188:191]
s_waitcnt lgkmcnt(4)
v_cvt_pk_bf16_f32 v78, v92, v93
v_mfma_f32_16x16x32_bf16 v[192:195], a[96:99], v[64:67], v[192:195]
ds_read_b128 a[64:67], v5 offset:32768
v_add_f32 v31, v31, v94
v_mfma_f32_16x16x32_bf16 v[196:199], a[96:99], v[68:71], v[196:199]
ds_read_b128 a[68:71], v5 offset:33792
v_add_f32 v31, v31, v95
v_mfma_f32_16x16x32_bf16 v[200:203], a[100:103], v[64:67], v[200:203]
v_cvt_pk_bf16_f32 v79, v94, v95
v_add_f32 v96, v30, v31
v_mfma_f32_16x16x32_bf16 v[204:207], a[100:103], v[68:71], v[204:207]
ds_read_b128 a[72:75], v5 offset:34816
v_cmp_lt_f32 vcc, s42, v96
v_mfma_f32_16x16x32_bf16 v[208:211], a[104:107], v[64:67], v[208:211]
v_mfma_f32_16x16x32_bf16 v[212:215], a[104:107], v[68:71], v[212:215]
ds_read_b128 a[76:79], v5 offset:35840
v_mfma_f32_16x16x32_bf16 v[216:219], a[108:111], v[64:67], v[216:219]
v_mfma_f32_16x16x32_bf16 v[220:223], a[108:111], v[68:71], v[220:223]
s_waitcnt lgkmcnt(4)
v_mfma_f32_16x16x32_bf16 v[224:227], a[112:115], v[64:67], v[224:227]
ds_read_b128 a[80:83], v5 offset:36864
v_mfma_f32_16x16x32_bf16 v[228:231], a[112:115], v[68:71], v[228:231]
ds_read_b128 a[84:87], v5 offset:37888
v_mfma_f32_16x16x32_bf16 v[232:235], a[116:119], v[64:67], v[232:235]
v_mfma_f32_16x16x32_bf16 v[236:239], a[116:119], v[68:71], v[236:239]
ds_read_b128 a[88:91], v5 offset:38912
v_mfma_f32_16x16x32_bf16 v[240:243], a[120:123], v[64:67], v[240:243]
v_mfma_f32_16x16x32_bf16 v[244:247], a[120:123], v[68:71], v[244:247]
ds_read_b128 a[92:95], v5 offset:39936
v_mfma_f32_16x16x32_bf16 v[248:251], a[124:127], v[64:67], v[248:251]
v_mfma_f32_16x16x32_bf16 v[252:255], a[124:127], v[68:71], v[252:255]
s_cbranch_vccnz at_stub15
at_ret15:
s_waitcnt vmcnt(4)
s_barrier
s_waitcnt lgkmcnt(4)
v_mfma_f32_16x16x32_bf16 v[48:51], a[64:67], a[0:3], v[80:83]
ds_read_b128 a[96:99], v5 offset:40960
v_mov_b32 v108, 0
buffer_atomic_or v108, v109, s[20:23], s69 offen sc0 sc1
v_mfma_f32_16x16x32_bf16 v[48:51], a[68:71], a[4:7], v[48:51]
ds_read_b128 a[100:103], v5 offset:41984
v_add_f32 v28, v28, v30
v_mfma_f32_16x16x32_bf16 v[52:55], a[64:67], a[32:35], v[84:87]
s_add_u32 m0, s36, 0
v_add_f32 v29, v29, v31
v_mfma_f32_16x16x32_bf16 v[52:55], a[68:71], a[36:39], v[52:55]
ds_read_b128 a[104:107], v5 offset:43008
buffer_load_dwordx4 v12, s[16:19], s34 offen offset:0 sc1 lds
v_mfma_f32_16x16x32_bf16 v[48:51], a[72:75], a[8:11], v[48:51]
v_exp_f32 v88, v32
v_mfma_f32_16x16x32_bf16 v[48:51], a[76:79], a[12:15], v[48:51]
ds_read_b128 a[108:111], v5 offset:44032
v_mfma_f32_16x16x32_bf16 v[52:55], a[72:75], a[40:43], v[52:55]
v_exp_f32 v89, v33
v_mfma_f32_16x16x32_bf16 v[52:55], a[76:79], a[44:47], v[52:55]
s_waitcnt lgkmcnt(4)
buffer_load_dwordx4 v13, s[16:19], s34 offen offset:1024 sc1 lds
v_mfma_f32_16x16x32_bf16 v[48:51], a[80:83], a[16:19], v[48:51]
ds_read_b128 a[112:115], v5 offset:45056
v_add_f32 v30, v88, v89
v_mfma_f32_16x16x32_bf16 v[48:51], a[84:87], a[20:23], v[48:51]
ds_read_b128 a[116:119], v5 offset:46080
v_cvt_pk_bf16_f32 v64, v88, v89
v_mfma_f32_16x16x32_bf16 v[52:55], a[80:83], a[48:51], v[52:55]
v_exp_f32 v90, v34
v_mfma_f32_16x16x32_bf16 v[52:55], a[84:87], a[52:55], v[52:55]
ds_read_b128 a[120:123], v5 offset:47104
buffer_load_dwordx4 v14, s[16:19], s34 offen offset:2048 sc1 lds
v_mfma_f32_16x16x32_bf16 v[48:51], a[88:91], a[24:27], v[48:51]
v_exp_f32 v91, v35
v_mfma_f32_16x16x32_bf16 v[48:51], a[92:95], a[28:31], v[48:51]
ds_read_b128 a[124:127], v5 offset:48128
v_add_f32 v30, v30, v90
v_mfma_f32_16x16x32_bf16 v[52:55], a[88:91], a[56:59], v[52:55]
v_exp_f32 v92, v36
v_mfma_f32_16x16x32_bf16 v[52:55], a[92:95], a[60:63], v[52:55]
s_waitcnt lgkmcnt(4)
buffer_load_dwordx4 v15, s[16:19], s34 offen offset:3072 sc1 lds
s_add_u32 s34, s34, s37
v_mfma_f32_16x16x32_bf16 v[56:59], a[96:99], a[0:3], v[80:83]
ds_read_b128 a[64:67], v5 offset:49152
v_add_f32 v30, v30, v91
v_mfma_f32_16x16x32_bf16 v[56:59], a[100:103], a[4:7], v[56:59]
ds_read_b128 a[68:71], v5 offset:50176
v_cvt_pk_bf16_f32 v65, v90, v91
v_mfma_f32_16x16x32_bf16 v[60:63], a[96:99], a[32:35], v[84:87]
v_exp_f32 v93, v37
v_mfma_f32_16x16x32_bf16 v[60:63], a[100:103], a[36:39], v[60:63]
ds_read_b128 a[72:75], v5 offset:51200
s_add_u32 m0, s36, 16384
v_mfma_f32_16x16x32_bf16 v[56:59], a[104:107], a[8:11], v[56:59]
buffer_load_dwordx4 v12, s[16:19], s35 offen offset:0 sc1 lds
v_add_f32 v31, v92, v93
v_mfma_f32_16x16x32_bf16 v[56:59], a[108:111], a[12:15], v[56:59]
ds_read_b128 a[76:79], v5 offset:52224
v_cvt_pk_bf16_f32 v68, v92, v93
v_mfma_f32_16x16x32_bf16 v[60:63], a[104:107], a[40:43], v[60:63]
v_exp_f32 v94, v38
v_mfma_f32_16x16x32_bf16 v[60:63], a[108:111], a[44:47], v[60:63]
s_waitcnt lgkmcnt(4)
v_mfma_f32_16x16x32_bf16 v[56:59], a[112:115], a[16:19], v[56:59]
ds_read_b128 a[80:83], v5 offset:53248
buffer_load_dwordx4 v13, s[16:19], s35 offen offset:1024 sc1 lds
v_mfma_f32_16x16x32_bf16 v[56:59], a[116:119], a[20:23], v[56:59]
ds_read_b128 a[84:87], v5 offset:54272
v_mfma_f32_16x16x32_bf16 v[60:63], a[112:115], a[48:51], v[60:63]
v_exp_f32 v95, v39
v_mfma_f32_16x16x32_bf16 v[60:63], a[116:119], a[52:55], v[60:63]
ds_read_b128 a[88:91], v5 offset:55296
v_add_f32 v31, v31, v94
v_mfma_f32_16x16x32_bf16 v[56:59], a[120:123], a[24:27], v[56:59]
buffer_load_dwordx4 v14, s[16:19], s35 offen offset:2048 sc1 lds
v_add_f32 v31, v31, v95
v_mfma_f32_16x16x32_bf16 v[56:59], a[124:127], a[28:31], v[56:59]
ds_read_b128 a[92:95], v5 offset:56320
v_cvt_pk_bf16_f32 v69, v94, v95
v_mfma_f32_16x16x32_bf16 v[60:63], a[120:123], a[56:59], v[60:63]
v_exp_f32 v88, v40
v_mfma_f32_16x16x32_bf16 v[60:63], a[124:127], a[60:63], v[60:63]
s_waitcnt lgkmcnt(4)
v_mfma_f32_16x16x32_bf16 v[128:131], a[64:67], v[72:75], v[128:131]
ds_read_b128 a[96:99], v5 offset:57344
buffer_load_dwordx4 v15, s[16:19], s35 offen offset:3072 sc1 lds
s_add_u32 s35, s35, s37
v_mfma_f32_16x16x32_bf16 v[132:135], a[64:67], v[76:79], v[132:135]
ds_read_b128 a[100:103], v5 offset:58368
v_mfma_f32_16x16x32_bf16 v[136:139], a[68:71], v[72:75], v[136:139]
v_exp_f32 v89, v41
v_mfma_f32_16x16x32_bf16 v[140:143], a[68:71], v[76:79], v[140:143]
ds_read_b128 a[104:107], v5 offset:59392
v_add_f32 v30, v30, v88
v_mfma_f32_16x16x32_bf16 v[144:147], a[72:75], v[72:75], v[144:147]
v_exp_f32 v90, v42
v_mfma_f32_16x16x32_bf16 v[148:151], a[72:75], v[76:79], v[148:151]
ds_read_b128 a[108:111], v5 offset:60416
v_add_f32 v30, v30, v89
v_mfma_f32_16x16x32_bf16 v[152:155], a[76:79], v[72:75], v[152:155]
v_exp_f32 v91, v43
v_mfma_f32_16x16x32_bf16 v[156:159], a[76:79], v[76:79], v[156:159]
s_waitcnt lgkmcnt(4)
v_cvt_pk_bf16_f32 v66, v88, v89
v_mfma_f32_16x16x32_bf16 v[160:163], a[80:83], v[72:75], v[160:163]
ds_read_b128 a[112:115], v5 offset:61440
v_add_f32 v30, v30, v90
v_mfma_f32_16x16x32_bf16 v[164:167], a[80:83], v[76:79], v[164:167]
ds_read_b128 a[116:119], v5 offset:62464
v_add_f32 v30, v30, v91
v_mfma_f32_16x16x32_bf16 v[168:171], a[84:87], v[72:75], v[168:171]
v_exp_f32 v92, v44
v_mfma_f32_16x16x32_bf16 v[172:175], a[84:87], v[76:79], v[172:175]
ds_read_b128 a[120:123], v5 offset:63488
v_cvt_pk_bf16_f32 v67, v90, v91
v_mfma_f32_16x16x32_bf16 v[176:179], a[88:91], v[72:75], v[176:179]
v_exp_f32 v93, v45
v_mfma_f32_16x16x32_bf16 v[180:183], a[88:91], v[76:79], v[180:183]
ds_read_b128 a[124:127], v5 offset:64512
v_add_f32 v31, v31, v92
v_mfma_f32_16x16x32_bf16 v[184:187], a[92:95], v[72:75], v[184:187]
v_exp_f32 v94, v46
v_mfma_f32_16x16x32_bf16 v[188:191], a[92:95], v[76:79], v[188:191]
s_waitcnt lgkmcnt(4)
v_add_f32 v31, v31, v93
v_mfma_f32_16x16x32_bf16 v[192:195], a[96:99], v[72:75], v[192:195]
ds_read_b128 a[64:67], v4 offset:16384
v_cvt_pk_bf16_f32 v70, v92, v93
v_mfma_f32_16x16x32_bf16 v[196:199], a[96:99], v[76:79], v[196:199]
ds_read_b128 a[68:71], v4 offset:17408
v_mfma_f32_16x16x32_bf16 v[200:203], a[100:103], v[72:75], v[200:203]
v_exp_f32 v95, v47
v_mfma_f32_16x16x32_bf16 v[204:207], a[100:103], v[76:79], v[204:207]
ds_read_b128 a[72:75], v4 offset:18432
v_add_f32 v31, v31, v94
v_mfma_f32_16x16x32_bf16 v[208:211], a[104:107], v[72:75], v[208:211]
v_add_f32 v31, v31, v95
v_cvt_pk_bf16_f32 v71, v94, v95
v_mfma_f32_16x16x32_bf16 v[212:215], a[104:107], v[76:79], v[212:215]
ds_read_b128 a[76:79], v4 offset:19456
v_add_f32 v96, v30, v31
v_mfma_f32_16x16x32_bf16 v[216:219], a[108:111], v[72:75], v[216:219]
v_cmp_lt_f32 vcc, s42, v96
v_mfma_f32_16x16x32_bf16 v[220:223], a[108:111], v[76:79], v[220:223]
s_waitcnt lgkmcnt(4)
v_mfma_f32_16x16x32_bf16 v[224:227], a[112:115], v[72:75], v[224:227]
ds_read_b128 a[80:83], v4 offset:20480
v_mfma_f32_16x16x32_bf16 v[228:231], a[112:115], v[76:79], v[228:231]
ds_read_b128 a[84:87], v4 offset:21504
v_mfma_f32_16x16x32_bf16 v[232:235], a[116:119], v[72:75], v[232:235]
v_mfma_f32_16x16x32_bf16 v[236:239], a[116:119], v[76:79], v[236:239]
ds_read_b128 a[88:91], v4 offset:22528
v_mfma_f32_16x16x32_bf16 v[240:243], a[120:123], v[72:75], v[240:243]
v_mfma_f32_16x16x32_bf16 v[244:247], a[120:123], v[76:79], v[244:247]
ds_read_b128 a[92:95], v4 offset:23552
v_mfma_f32_16x16x32_bf16 v[248:251], a[124:127], v[72:75], v[248:251]
v_mfma_f32_16x16x32_bf16 v[252:255], a[124:127], v[76:79], v[252:255]
s_cbranch_vccnz at_stub16
at_ret16:
s_waitcnt vmcnt(8)
v_readfirstlane_b32 s60, v108
s_cmp_eq_u32 s22, 0
s_cselect_b32 s60, 1, s60
s_cmp_eq_u32 s60, 1
s_cbranch_scc0 at_wfspin
at_wfspun:
s_barrier
s_waitcnt lgkmcnt(4)
v_mfma_f32_16x16x32_bf16 v[128:131], a[64:67], v[64:67], v[128:131]
ds_read_b128 a[96:99], v4 offset:24576
buffer_load_dwordx4 v[104:107], v2, s[20:23], s70 offen sc1
v_add_f32 v28, v28, v30
v_add_f32 v29, v29, v31
v_mfma_f32_16x16x32_bf16 v[132:135], a[64:67], v[68:71], v[132:135]
ds_read_b128 a[100:103], v4 offset:25600
buffer_load_dwordx4 a[0:3], v2, s[20:23], s43 offen offset:0 sc1
v_exp_f32 v88, v48
v_mfma_f32_16x16x32_bf16 v[136:139], a[68:71], v[64:67], v[136:139]
buffer_load_dwordx4 a[4:7], v2, s[20:23], s43 offen offset:1024 sc1
v_exp_f32 v89, v49
v_mfma_f32_16x16x32_bf16 v[140:143], a[68:71], v[68:71], v[140:143]
ds_read_b128 a[104:107], v4 offset:26624
buffer_load_dwordx4 a[8:11], v2, s[20:23], s43 offen offset:2048 sc1
v_exp_f32 v90, v50
v_mfma_f32_16x16x32_bf16 v[144:147], a[72:75], v[64:67], v[144:147]
v_exp_f32 v91, v51
v_exp_f32 v92, v52
v_mfma_f32_16x16x32_bf16 v[148:151], a[72:75], v[68:71], v[148:151]
ds_read_b128 a[108:111], v4 offset:27648
buffer_load_dwordx4 a[12:15], v2, s[20:23], s43 offen offset:3072 sc1
v_exp_f32 v93, v53
v_mfma_f32_16x16x32_bf16 v[152:155], a[76:79], v[64:67], v[152:155]
s_add_u32 s43, s43, 4096
v_exp_f32 v94, v54
v_add_f32 v30, v88, v89
v_mfma_f32_16x16x32_bf16 v[156:159], a[76:79], v[68:71], v[156:159]
s_waitcnt lgkmcnt(4)
buffer_load_dwordx4 a[16:19], v2, s[20:23], s43 offen offset:0 sc1
v_exp_f32 v95, v55
v_mfma_f32_16x16x32_bf16 v[160:163], a[80:83], v[64:67], v[160:163]
ds_read_b128 a[112:115], v4 offset:28672
v_cvt_pk_bf16_f32 v72, v88, v89
v_exp_f32 v88, v56
v_mfma_f32_16x16x32_bf16 v[164:167], a[80:83], v[68:71], v[164:167]
ds_read_b128 a[116:119], v4 offset:29696
buffer_load_dwordx4 a[20:23], v2, s[20:23], s43 offen offset:1024 sc1
v_exp_f32 v89, v57
v_mfma_f32_16x16x32_bf16 v[168:171], a[84:87], v[64:67], v[168:171]
buffer_load_dwordx4 a[24:27], v2, s[20:23], s43 offen offset:2048 sc1
v_add_f32 v30, v30, v90
v_add_f32 v30, v30, v91
v_cvt_pk_bf16_f32 v73, v90, v91
v_mfma_f32_16x16x32_bf16 v[172:175], a[84:87], v[68:71], v[172:175]
ds_read_b128 a[120:123], v4 offset:30720
buffer_load_dwordx4 a[28:31], v2, s[20:23], s43 offen offset:3072 sc1
v_exp_f32 v90, v58
v_mfma_f32_16x16x32_bf16 v[176:179], a[88:91], v[64:67], v[176:179]
v_exp_f32 v91, v59
v_add_f32 v31, v92, v93
v_cvt_pk_bf16_f32 v76, v92, v93
v_mfma_f32_16x16x32_bf16 v[180:183], a[88:91], v[68:71], v[180:183]
ds_read_b128 a[124:127], v4 offset:31744
s_add_u32 s43, s43, 4096
v_exp_f32 v92, v60
v_mfma_f32_16x16x32_bf16 v[184:187], a[92:95], v[64:67], v[184:187]
buffer_load_dwordx4 a[32:35], v2, s[20:23], s43 offen offset:0 sc1
v_exp_f32 v93, v61
v_add_f32 v31, v31, v94
v_mfma_f32_16x16x32_bf16 v[188:191], a[92:95], v[68:71], v[188:191]
s_waitcnt lgkmcnt(4)
buffer_load_dwordx4 a[36:39], v2, s[20:23], s43 offen offset:1024 sc1
v_add_f32 v31, v31, v95
v_cvt_pk_bf16_f32 v77, v94, v95
v_mfma_f32_16x16x32_bf16 v[192:195], a[96:99], v[64:67], v[192:195]
ds_read_b128 a[64:67], v4 offset:49152
buffer_load_dwordx4 a[40:43], v2, s[20:23], s43 offen offset:2048 sc1
v_exp_f32 v94, v62
v_mfma_f32_16x16x32_bf16 v[196:199], a[96:99], v[68:71], v[196:199]
ds_read_b128 a[68:71], v4 offset:50176
v_exp_f32 v95, v63
v_add_f32 v30, v30, v88
v_mfma_f32_16x16x32_bf16 v[200:203], a[100:103], v[64:67], v[200:203]
buffer_load_dwordx4 a[44:47], v2, s[20:23], s43 offen offset:3072 sc1
v_add_f32 v30, v30, v89
v_cvt_pk_bf16_f32 v74, v88, v89
v_add_f32 v30, v30, v90
v_mfma_f32_16x16x32_bf16 v[204:207], a[100:103], v[68:71], v[204:207]
ds_read_b128 a[72:75], v4 offset:51200
s_add_u32 s43, s43, 4096
v_add_f32 v30, v30, v91
v_cvt_pk_bf16_f32 v75, v90, v91
v_mfma_f32_16x16x32_bf16 v[208:211], a[104:107], v[64:67], v[208:211]
buffer_load_dwordx4 a[48:51], v2, s[20:23], s43 offen offset:0 sc1
v_add_f32 v31, v31, v92
v_add_f32 v31, v31, v93
v_cvt_pk_bf16_f32 v78, v92, v93
v_mfma_f32_16x16x32_bf16 v[212:215], a[104:107], v[68:71], v[212:215]
ds_read_b128 a[76:79], v4 offset:52224
v_add_f32 v31, v31, v94
v_add_f32 v31, v31, v95
v_cvt_pk_bf16_f32 v79, v94, v95
v_mfma_f32_16x16x32_bf16 v[216:219], a[108:111], v[64:67], v[216:219]
buffer_load_dwordx4 a[52:55], v2, s[20:23], s43 offen offset:1024 sc1
v_add_f32 v96, v30, v31
v_cmp_lt_f32 vcc, s42, v96
v_mfma_f32_16x16x32_bf16 v[220:223], a[108:111], v[68:71], v[220:223]
s_waitcnt lgkmcnt(4)
buffer_load_dwordx4 a[56:59], v2, s[20:23], s43 offen offset:2048 sc1
v_mfma_f32_16x16x32_bf16 v[224:227], a[112:115], v[64:67], v[224:227]
ds_read_b128 a[80:83], v4 offset:53248
buffer_load_dwordx4 a[60:63], v2, s[20:23], s43 offen offset:3072 sc1
v_mfma_f32_16x16x32_bf16 v[228:231], a[112:115], v[68:71], v[228:231]
ds_read_b128 a[84:87], v4 offset:54272
v_mfma_f32_16x16x32_bf16 v[232:235], a[116:119], v[64:67], v[232:235]
v_mfma_f32_16x16x32_bf16 v[236:239], a[116:119], v[68:71], v[236:239]
ds_read_b128 a[88:91], v4 offset:55296
v_mfma_f32_16x16x32_bf16 v[240:243], a[120:123], v[64:67], v[240:243]
v_mfma_f32_16x16x32_bf16 v[244:247], a[120:123], v[68:71], v[244:247]
ds_read_b128 a[92:95], v4 offset:56320
v_mfma_f32_16x16x32_bf16 v[248:251], a[124:127], v[64:67], v[248:251]
v_mfma_f32_16x16x32_bf16 v[252:255], a[124:127], v[68:71], v[252:255]
s_cbranch_vccnz at_stub17
at_ret17:
s_nop 0
s_barrier
s_waitcnt lgkmcnt(4)
v_mfma_f32_16x16x32_bf16 v[128:131], a[64:67], v[72:75], v[128:131]
ds_read_b128 a[96:99], v4 offset:57344
v_add_f32 v28, v28, v30
v_mfma_f32_16x16x32_bf16 v[132:135], a[64:67], v[76:79], v[132:135]
ds_read_b128 a[100:103], v4 offset:58368
v_add_f32 v29, v29, v31
v_mfma_f32_16x16x32_bf16 v[136:139], a[68:71], v[72:75], v[136:139]
s_add_u32 m0, s36, 32768
v_mov_b32 v96, v28
v_mfma_f32_16x16x32_bf16 v[140:143], a[68:71], v[76:79], v[140:143]
ds_read_b128 a[104:107], v4 offset:59392
buffer_load_dwordx4 v12, s[16:19], s34 offen offset:0 sc1 lds
v_mfma_f32_16x16x32_bf16 v[144:147], a[72:75], v[72:75], v[144:147]
v_mov_b32 v97, v29
v_permlane16_swap_b32 v28, v96
v_mfma_f32_16x16x32_bf16 v[148:151], a[72:75], v[76:79], v[148:151]
ds_read_b128 a[108:111], v4 offset:60416
buffer_load_dwordx4 v13, s[16:19], s34 offen offset:1024 sc1 lds
v_mfma_f32_16x16x32_bf16 v[152:155], a[76:79], v[72:75], v[152:155]
v_permlane16_swap_b32 v29, v97
v_add_f32 v28, v28, v96
v_mfma_f32_16x16x32_bf16 v[156:159], a[76:79], v[76:79], v[156:159]
s_waitcnt lgkmcnt(4)
buffer_load_dwordx4 v14, s[16:19], s34 offen offset:2048 sc1 lds
v_mfma_f32_16x16x32_bf16 v[160:163], a[80:83], v[72:75], v[160:163]
ds_read_b128 a[112:115], v4 offset:61440
v_add_f32 v29, v29, v97
v_mfma_f32_16x16x32_bf16 v[164:167], a[80:83], v[76:79], v[164:167]
ds_read_b128 a[116:119], v4 offset:62464
buffer_load_dwordx4 v15, s[16:19], s34 offen offset:3072 sc1 lds
s_add_u32 s34, s34, s37
v_mfma_f32_16x16x32_bf16 v[168:171], a[84:87], v[72:75], v[168:171]
v_mov_b32 v96, v28
v_mov_b32 v97, v29
v_mfma_f32_16x16x32_bf16 v[172:175], a[84:87], v[76:79], v[172:175]
ds_read_b128 a[120:123], v4 offset:63488
s_add_u32 m0, s36, 49152
v_mfma_f32_16x16x32_bf16 v[176:179], a[88:91], v[72:75], v[176:179]
buffer_load_dwordx4 v12, s[16:19], s35 offen offset:0 sc1 lds
v_permlane32_swap_b32 v28, v96
v_mfma_f32_16x16x32_bf16 v[180:183], a[88:91], v[76:79], v[180:183]
ds_read_b128 a[124:127], v4 offset:64512
v_permlane32_swap_b32 v29, v97
v_mfma_f32_16x16x32_bf16 v[184:187], a[92:95], v[72:75], v[184:187]
buffer_load_dwordx4 v13, s[16:19], s35 offen offset:1024 sc1 lds
v_add_f32 v28, v28, v96
v_mfma_f32_16x16x32_bf16 v[188:191], a[92:95], v[76:79], v[188:191]
s_waitcnt lgkmcnt(4)
v_add_f32 v29, v29, v97
v_mfma_f32_16x16x32_bf16 v[192:195], a[96:99], v[72:75], v[192:195]
buffer_load_dwordx4 v14, s[16:19], s35 offen offset:2048 sc1 lds
s_mov_b32 s44, s48
v_mfma_f32_16x16x32_bf16 v[196:199], a[96:99], v[76:79], v[196:199]
s_add_u32 s45, s48, 8192
s_add_u32 s46, s44, 4096
v_mfma_f32_16x16x32_bf16 v[200:203], a[100:103], v[72:75], v[200:203]
buffer_load_dwordx4 v15, s[16:19], s35 offen offset:3072 sc1 lds
s_add_u32 s35, s35, s37
v_mfma_f32_16x16x32_bf16 v[204:207], a[100:103], v[76:79], v[204:207]
s_add_u32 s47, s45, 4096
v_mfma_f32_16x16x32_bf16 v[208:211], a[104:107], v[72:75], v[208:211]
v_mfma_f32_16x16x32_bf16 v[212:215], a[104:107], v[76:79], v[212:215]
v_mfma_f32_16x16x32_bf16 v[216:219], a[108:111], v[72:75], v[216:219]
v_mfma_f32_16x16x32_bf16 v[220:223], a[108:111], v[76:79], v[220:223]
s_waitcnt lgkmcnt(0)
v_mfma_f32_16x16x32_bf16 v[224:227], a[112:115], v[72:75], v[224:227]
v_mfma_f32_16x16x32_bf16 v[228:231], a[112:115], v[76:79], v[228:231]
v_mfma_f32_16x16x32_bf16 v[232:235], a[116:119], v[72:75], v[232:235]
v_mfma_f32_16x16x32_bf16 v[236:239], a[116:119], v[76:79], v[236:239]
v_mfma_f32_16x16x32_bf16 v[240:243], a[120:123], v[72:75], v[240:243]
v_mfma_f32_16x16x32_bf16 v[244:247], a[120:123], v[76:79], v[244:247]
v_mfma_f32_16x16x32_bf16 v[248:251], a[124:127], v[72:75], v[248:251]
v_mfma_f32_16x16x32_bf16 v[252:255], a[124:127], v[76:79], v[252:255]
at_tj:
s_cmp_eq_u32 s31, -1
s_cbranch_scc0 at_nx
s_waitcnt vmcnt(25)
s_barrier
v_xor_b32 v8, 0, v21
v_xor_b32 v9, 32, v21
v_xor_b32 v10, 64, v21
v_xor_b32 v11, 96, v21
s_sub_u32 s78, s7, s6
s_sub_u32 s79, s36, s6
v_add_u32 v20, s78, v8
v_add_u32 v8, s79, v8
v_add_u32 v21, s78, v9
v_add_u32 v9, s79, v9
v_add_u32 v22, s78, v10
v_add_u32 v10, s79, v10
v_add_u32 v23, s78, v11
v_add_u32 v11, s79, v11
ds_read_b64_tr_b16 a[64:65], v8 offset:0
ds_read_b64_tr_b16 a[66:67], v8 offset:2048
ds_read_b64_tr_b16 a[68:69], v8 offset:4096
ds_read_b64_tr_b16 a[70:71], v8 offset:6144
ds_read_b64_tr_b16 a[72:73], v8 offset:8192
ds_read_b64_tr_b16 a[74:75], v8 offset:10240
ds_read_b64_tr_b16 a[76:77], v8 offset:12288
ds_read_b64_tr_b16 a[78:79], v8 offset:14336
ds_read_b64_tr_b16 a[80:81], v8 offset:16384
ds_read_b64_tr_b16 a[82:83], v8 offset:18432
ds_read_b64_tr_b16 a[84:85], v8 offset:20480
ds_read_b64_tr_b16 a[86:87], v8 offset:22528
s_add_u32 s34, s34, 128
s_add_u32 s35, s35, 128
s_add_u32 m0, s7, 0
s_nop 0
buffer_load_dwordx4 v12, s[16:19], s34 offen offset:0 sc1 lds
buffer_load_dwordx4 v13, s[16:19], s34 offen offset:1024 sc1 lds
buffer_load_dwordx4 v14, s[16:19], s34 offen offset:2048 sc1 lds
buffer_load_dwordx4 v15, s[16:19], s34 offen offset:3072 sc1 lds
s_add_u32 s34, s34, s37
s_add_u32 m0, s7, 16384
s_nop 0
buffer_load_dwordx4 v12, s[16:19], s35 offen offset:0 sc1 lds
buffer_load_dwordx4 v13, s[16:19], s35 offen offset:1024 sc1 lds
buffer_load_dwordx4 v14, s[16:19], s35 offen offset:2048 sc1 lds
buffer_load_dwordx4 v15, s[16:19], s35 offen offset:3072 sc1 lds
s_add_u32 s35, s35, s37
s_branch at_ep
at_nx:
s_barrier
s_add_u32 m0, s7, 32768
s_nop 0
buffer_load_dwordx4 v2, s[12:15], s67 offen offset:0 sc1 lds
buffer_load_dwordx4 v2, s[12:15], s67 offen offset:1024 sc1 lds
buffer_load_dwordx4 v2, s[12:15], s67 offen offset:2048 sc1 lds
buffer_load_dwordx4 v2, s[12:15], s67 offen offset:3072 sc1 lds
s_add_u32 m0, s7, 49152
s_nop 0
buffer_load_dwordx4 v2, s[12:15], s41 offen offset:0 sc1 lds
buffer_load_dwordx4 v2, s[12:15], s41 offen offset:1024 sc1 lds
buffer_load_dwordx4 v2, s[12:15], s41 offen offset:2048 sc1 lds
buffer_load_dwordx4 v2, s[12:15], s41 offen offset:3072 sc1 lds
at_ep:
s_cmp_eq_u32 s30, 1
s_cbranch_scc1 at_part
s_cmp_eq_u32 s30, 2
s_cbranch_scc0 at_norm
s_waitcnt vmcnt(32)
v_cmp_neq_f32 vcc, v80, v104
v_cmp_neq_f32 s[50:51], v84, v105
s_nop 0
s_or_b64 vcc, vcc, s[50:51]
s_cbranch_vccnz at_slow
v_add_f32 v28, v28, v106
v_add_f32 v29, v29, v107
s_waitcnt vmcnt(30)
v_mfma_f32_16x16x32_bf16 v[128:131], v[118:121], a[0:3], v[128:131]
v_mfma_f32_16x16x32_bf16 v[136:139], v[116:119], a[0:3], v[136:139]
v_mfma_f32_16x16x32_bf16 v[144:147], v[118:121], a[4:7], v[144:147]
v_mfma_f32_16x16x32_bf16 v[152:155], v[116:119], a[4:7], v[152:155]
s_waitcnt vmcnt(28)
v_mfma_f32_16x16x32_bf16 v[160:163], v[118:121], a[8:11], v[160:163]
v_mfma_f32_16x16x32_bf16 v[168:171], v[116:119], a[8:11], v[168:171]
v_mfma_f32_16x16x32_bf16 v[176:179], v[118:121], a[12:15], v[176:179]
v_mfma_f32_16x16x32_bf16 v[184:187], v[116:119], a[12:15], v[184:187]
s_waitcnt vmcnt(26)
v_mfma_f32_16x16x32_bf16 v[192:195], v[118:121], a[16:19], v[192:195]
v_mfma_f32_16x16x32_bf16 v[200:203], v[116:119], a[16:19], v[200:203]
v_mfma_f32_16x16x32_bf16 v[208:211], v[118:121], a[20:23], v[208:211]
v_mfma_f32_16x16x32_bf16 v[216:219], v[116:119], a[20:23], v[216:219]
s_waitcnt vmcnt(24)
v_mfma_f32_16x16x32_bf16 v[224:227], v[118:121], a[24:27], v[224:227]
v_mfma_f32_16x16x32_bf16 v[232:235], v[116:119], a[24:27], v[232:235]
v_mfma_f32_16x16x32_bf16 v[240:243], v[118:121], a[28:31], v[240:243]
v_mfma_f32_16x16x32_bf16 v[248:251], v[116:119], a[28:31], v[248:251]
s_waitcnt vmcnt(22)
v_mfma_f32_16x16x32_bf16 v[132:135], v[118:121], a[32:35], v[132:135]
v_mfma_f32_16x16x32_bf16 v[140:143], v[116:119], a[32:35], v[140:143]
v_mfma_f32_16x16x32_bf16 v[148:151], v[118:121], a[36:39], v[148:151]
v_mfma_f32_16x16x32_bf16 v[156:159], v[116:119], a[36:39], v[156:159]
s_waitcnt vmcnt(20)
v_mfma_f32_16x16x32_bf16 v[164:167], v[118:121], a[40:43], v[164:167]
v_mfma_f32_16x16x32_bf16 v[172:175], v[116:119], a[40:43], v[172:175]
v_mfma_f32_16x16x32_bf16 v[180:183], v[118:121], a[44:47], v[180:183]
v_mfma_f32_16x16x32_bf16 v[188:191], v[116:119], a[44:47], v[188:191]
s_waitcnt vmcnt(18)
v_mfma_f32_16x16x32_bf16 v[196:199], v[118:121], a[48:51], v[196:199]
v_mfma_f32_16x16x32_bf16 v[204:207], v[116:119], a[48:51], v[204:207]
v_mfma_f32_16x16x32_bf16 v[212:215], v[118:121], a[52:55], v[212:215]
v_mfma_f32_16x16x32_bf16 v[220:223], v[116:119], a[52:55], v[220:223]
s_waitcnt vmcnt(16)
v_mfma_f32_16x16x32_bf16 v[228:231], v[118:121], a[56:59], v[228:231]
v_mfma_f32_16x16x32_bf16 v[236:239], v[116:119], a[56:59], v[236:239]
v_mfma_f32_16x16x32_bf16 v[244:247], v[118:121], a[60:63], v[244:247]
v_mfma_f32_16x16x32_bf16 v[252:255], v[116:119], a[60:63], v[252:255]
at_norm:
v_rcp_f32 v30, v28
v_rcp_f32 v31, v29
v_cvt_pk_bf16_f32 v128, v128, v129
v_cvt_pk_bf16_f32 v129, v130, v131
v_cvt_pk_bf16_f32 v130, v136, v137
v_cvt_pk_bf16_f32 v131, v138, v139
v_cvt_pk_bf16_f32 v132, v132, v133
v_cvt_pk_bf16_f32 v133, v134, v135
v_cvt_pk_bf16_f32 v134, v140, v141
v_cvt_pk_bf16_f32 v135, v142, v143
v_cvt_pk_bf16_f32 v144, v144, v145
v_cvt_pk_bf16_f32 v145, v146, v147
v_cvt_pk_bf16_f32 v146, v152, v153
v_cvt_pk_bf16_f32 v147, v154, v155
v_cvt_pk_bf16_f32 v148, v148, v149
v_cvt_pk_bf16_f32 v149, v150, v151
v_cvt_pk_bf16_f32 v150, v156, v157
v_cvt_pk_bf16_f32 v151, v158, v159
v_cvt_pk_bf16_f32 v160, v160, v161
v_cvt_pk_bf16_f32 v161, v162, v163
v_cvt_pk_bf16_f32 v162, v168, v169
v_cvt_pk_bf16_f32 v163, v170, v171
v_cvt_pk_bf16_f32 v164, v164, v165
v_cvt_pk_bf16_f32 v165, v166, v167
v_cvt_pk_bf16_f32 v166, v172, v173
v_cvt_pk_bf16_f32 v167, v174, v175
v_cvt_pk_bf16_f32 v176, v176, v177
v_cvt_pk_bf16_f32 v177, v178, v179
v_cvt_pk_bf16_f32 v178, v184, v185
v_cvt_pk_bf16_f32 v179, v186, v187
v_cvt_pk_bf16_f32 v180, v180, v181
v_cvt_pk_bf16_f32 v181, v182, v183
v_cvt_pk_bf16_f32 v182, v188, v189
v_cvt_pk_bf16_f32 v183, v190, v191
v_cvt_pk_bf16_f32 v192, v192, v193
v_cvt_pk_bf16_f32 v193, v194, v195
v_cvt_pk_bf16_f32 v194, v200, v201
v_cvt_pk_bf16_f32 v195, v202, v203
v_cvt_pk_bf16_f32 v196, v196, v197
v_cvt_pk_bf16_f32 v197, v198, v199
v_cvt_pk_bf16_f32 v198, v204, v205
v_cvt_pk_bf16_f32 v199, v206, v207
v_cvt_pk_bf16_f32 v208, v208, v209
v_cvt_pk_bf16_f32 v209, v210, v211
v_cvt_pk_bf16_f32 v210, v216, v217
v_cvt_pk_bf16_f32 v211, v218, v219
v_cvt_pk_bf16_f32 v212, v212, v213
v_cvt_pk_bf16_f32 v213, v214, v215
v_cvt_pk_bf16_f32 v214, v220, v221
v_cvt_pk_bf16_f32 v215, v222, v223
v_cvt_pk_bf16_f32 v224, v224, v225
v_cvt_pk_bf16_f32 v225, v226, v227
v_cvt_pk_bf16_f32 v226, v232, v233
v_cvt_pk_bf16_f32 v227, v234, v235
v_cvt_pk_bf16_f32 v228, v228, v229
v_cvt_pk_bf16_f32 v229, v230, v231
v_cvt_pk_bf16_f32 v230, v236, v237
v_cvt_pk_bf16_f32 v231, v238, v239
v_cvt_pk_bf16_f32 v240, v240, v241
v_cvt_pk_bf16_f32 v241, v242, v243
v_cvt_pk_bf16_f32 v242, v248, v249
v_cvt_pk_bf16_f32 v243, v250, v251
v_cvt_pk_bf16_f32 v244, v244, v245
v_cvt_pk_bf16_f32 v245, v246, v247
v_cvt_pk_bf16_f32 v246, v252, v253
v_cvt_pk_bf16_f32 v247, v254, v255
s_cmp_eq_u32 s31, -1
s_cbranch_scc1 at_done
v_accvgpr_write_b32 a128, v128
v_accvgpr_write_b32 a129, v129
v_accvgpr_write_b32 a130, v130
v_accvgpr_write_b32 a131, v131
v_accvgpr_write_b32 a132, v144
v_accvgpr_write_b32 a133, v145
v_accvgpr_write_b32 a134, v146
v_accvgpr_write_b32 a135, v147
v_accvgpr_write_b32 a136, v160
v_accvgpr_write_b32 a137, v161
v_accvgpr_write_b32 a138, v162
v_accvgpr_write_b32 a139, v163
v_accvgpr_write_b32 a140, v176
v_accvgpr_write_b32 a141, v177
v_accvgpr_write_b32 a142, v178
v_accvgpr_write_b32 a143, v179
v_accvgpr_write_b32 a144, v192
v_accvgpr_write_b32 a145, v193
v_accvgpr_write_b32 a146, v194
v_accvgpr_write_b32 a147, v195
v_accvgpr_write_b32 a148, v208
v_accvgpr_write_b32 a149, v209
v_accvgpr_write_b32 a150, v210
v_accvgpr_write_b32 a151, v211
v_accvgpr_write_b32 a152, v224
v_accvgpr_write_b32 a153, v225
v_accvgpr_write_b32 a154, v226
v_accvgpr_write_b32 a155, v227
v_accvgpr_write_b32 a156, v240
v_accvgpr_write_b32 a157, v241
v_accvgpr_write_b32 a158, v242
v_accvgpr_write_b32 a159, v243
v_accvgpr_write_b32 a160, v132
v_accvgpr_write_b32 a161, v133
v_accvgpr_write_b32 a162, v134
v_accvgpr_write_b32 a163, v135
v_accvgpr_write_b32 a164, v148
v_accvgpr_write_b32 a165, v149
v_accvgpr_write_b32 a166, v150
v_accvgpr_write_b32 a167, v151
v_accvgpr_write_b32 a168, v164
v_accvgpr_write_b32 a169, v165
v_accvgpr_write_b32 a170, v166
v_accvgpr_write_b32 a171, v167
v_accvgpr_write_b32 a172, v180
v_accvgpr_write_b32 a173, v181
v_accvgpr_write_b32 a174, v182
v_accvgpr_write_b32 a175, v183
v_accvgpr_write_b32 a176, v196
v_accvgpr_write_b32 a177, v197
v_accvgpr_write_b32 a178, v198
v_accvgpr_write_b32 a179, v199
v_accvgpr_write_b32 a180, v212
v_accvgpr_write_b32 a181, v213
v_accvgpr_write_b32 a182, v214
v_accvgpr_write_b32 a183, v215
v_accvgpr_write_b32 a184, v228
v_accvgpr_write_b32 a185, v229
v_accvgpr_write_b32 a186, v230
v_accvgpr_write_b32 a187, v231
v_accvgpr_write_b32 a188, v244
v_accvgpr_write_b32 a189, v245
v_accvgpr_write_b32 a190, v246
v_accvgpr_write_b32 a191, v247
v_accvgpr_write_b32 a192, v30
v_accvgpr_write_b32 a193, v31
v_mov_b64 v[128:129], 0
v_mov_b64 v[130:131], 0
v_mov_b64 v[132:133], 0
v_mov_b64 v[134:135], 0
v_mov_b64 v[136:137], 0
v_mov_b64 v[138:139], 0
v_mov_b64 v[140:141], 0
v_mov_b64 v[142:143], 0
v_mov_b64 v[144:145], 0
v_mov_b64 v[146:147], 0
v_mov_b64 v[148:149], 0
v_mov_b64 v[150:151], 0
v_mov_b64 v[152:153], 0
v_mov_b64 v[154:155], 0
v_mov_b64 v[156:157], 0
v_mov_b64 v[158:159], 0
v_mov_b64 v[160:161], 0
v_mov_b64 v[162:163], 0
v_mov_b64 v[164:165], 0
v_mov_b64 v[166:167], 0
v_mov_b64 v[168:169], 0
v_mov_b64 v[170:171], 0
v_mov_b64 v[172:173], 0
v_mov_b64 v[174:175], 0
v_mov_b64 v[176:177], 0
v_mov_b64 v[178:179], 0
v_mov_b64 v[180:181], 0
v_mov_b64 v[182:183], 0
v_mov_b64 v[184:185], 0
v_mov_b64 v[186:187], 0
v_mov_b64 v[188:189], 0
v_mov_b64 v[190:191], 0
v_mov_b64 v[192:193], 0
v_mov_b64 v[194:195], 0
v_mov_b64 v[196:197], 0
v_mov_b64 v[198:199], 0
v_mov_b64 v[200:201], 0
v_mov_b64 v[202:203], 0
v_mov_b64 v[204:205], 0
v_mov_b64 v[206:207], 0
v_mov_b64 v[208:209], 0
v_mov_b64 v[210:211], 0
v_mov_b64 v[212:213], 0
v_mov_b64 v[214:215], 0
v_mov_b64 v[216:217], 0
v_mov_b64 v[218:219], 0
v_mov_b64 v[220:221], 0
v_mov_b64 v[222:223], 0
v_mov_b64 v[224:225], 0
v_mov_b64 v[226:227], 0
v_mov_b64 v[228:229], 0
v_mov_b64 v[230:231], 0
v_mov_b64 v[232:233], 0
v_mov_b64 v[234:235], 0
v_mov_b64 v[236:237], 0
v_mov_b64 v[238:239], 0
v_mov_b64 v[240:241], 0
v_mov_b64 v[242:243], 0
v_mov_b64 v[244:245], 0
v_mov_b64 v[246:247], 0
v_mov_b64 v[248:249], 0
v_mov_b64 v[250:251], 0
v_mov_b64 v[252:253], 0
v_mov_b64 v[254:255], 0
s_mov_b32 s27, s31
s_mov_b32 s28, s3
s_lshl_b32 s29, s27, 2
s_add_u32 s29, s29, 4
s_sub_u32 s29, s29, s3
s_mov_b32 s30, 1
s_mov_b32 s31, -1
s_mov_b32 s32, s34
s_mov_b32 s33, s35
s_mov_b32 s22, 0
s_waitcnt vmcnt(0) lgkmcnt(0)
s_barrier
ds_read_b128 a[64:67], v4 offset:49152
ds_read_b128 a[68:71], v4 offset:50176
ds_read_b128 a[72:75], v4 offset:51200
ds_read_b128 a[76:79], v4 offset:52224
ds_read_b128 a[80:83], v4 offset:53248
ds_read_b128 a[84:87], v4 offset:54272
ds_read_b128 a[88:91], v4 offset:55296
ds_read_b128 a[92:95], v4 offset:56320
s_branch at_att
at_part:
s_waitcnt vmcnt(32)
v_mov_b32 v104, v80
v_mov_b32 v105, v84
v_mov_b32 v106, v28
v_mov_b32 v107, v29
buffer_store_dwordx4 v[104:107], v2, s[12:15], s65 offen sc1
v_cvt_pk_bf16_f32 v128, v128, v129
v_cvt_pk_bf16_f32 v129, v130, v131
v_cvt_pk_bf16_f32 v130, v136, v137
v_cvt_pk_bf16_f32 v131, v138, v139
buffer_store_dwordx4 v[128:131], v2, s[12:15], s44 offen offset:0 sc1
v_cvt_pk_bf16_f32 v144, v144, v145
v_cvt_pk_bf16_f32 v145, v146, v147
v_cvt_pk_bf16_f32 v146, v152, v153
v_cvt_pk_bf16_f32 v147, v154, v155
buffer_store_dwordx4 v[144:147], v2, s[12:15], s44 offen offset:1024 sc1
v_cvt_pk_bf16_f32 v160, v160, v161
v_cvt_pk_bf16_f32 v161, v162, v163
v_cvt_pk_bf16_f32 v162, v168, v169
v_cvt_pk_bf16_f32 v163, v170, v171
buffer_store_dwordx4 v[160:163], v2, s[12:15], s44 offen offset:2048 sc1
v_cvt_pk_bf16_f32 v176, v176, v177
v_cvt_pk_bf16_f32 v177, v178, v179
v_cvt_pk_bf16_f32 v178, v184, v185
v_cvt_pk_bf16_f32 v179, v186, v187
buffer_store_dwordx4 v[176:179], v2, s[12:15], s44 offen offset:3072 sc1
v_cvt_pk_bf16_f32 v192, v192, v193
v_cvt_pk_bf16_f32 v193, v194, v195
v_cvt_pk_bf16_f32 v194, v200, v201
v_cvt_pk_bf16_f32 v195, v202, v203
buffer_store_dwordx4 v[192:195], v2, s[12:15], s46 offen offset:0 sc1
v_cvt_pk_bf16_f32 v208, v208, v209
v_cvt_pk_bf16_f32 v209, v210, v211
v_cvt_pk_bf16_f32 v210, v216, v217
v_cvt_pk_bf16_f32 v211, v218, v219
buffer_store_dwordx4 v[208:211], v2, s[12:15], s46 offen offset:1024 sc1
v_cvt_pk_bf16_f32 v224, v224, v225
v_cvt_pk_bf16_f32 v225, v226, v227
v_cvt_pk_bf16_f32 v226, v232, v233
v_cvt_pk_bf16_f32 v227, v234, v235
buffer_store_dwordx4 v[224:227], v2, s[12:15], s46 offen offset:2048 sc1
v_cvt_pk_bf16_f32 v240, v240, v241
v_cvt_pk_bf16_f32 v241, v242, v243
v_cvt_pk_bf16_f32 v242, v248, v249
v_cvt_pk_bf16_f32 v243, v250, v251
buffer_store_dwordx4 v[240:243], v2, s[12:15], s46 offen offset:3072 sc1
v_cvt_pk_bf16_f32 v132, v132, v133
v_cvt_pk_bf16_f32 v133, v134, v135
v_cvt_pk_bf16_f32 v134, v140, v141
v_cvt_pk_bf16_f32 v135, v142, v143
buffer_store_dwordx4 v[132:135], v2, s[12:15], s45 offen offset:0 sc1
v_cvt_pk_bf16_f32 v148, v148, v149
v_cvt_pk_bf16_f32 v149, v150, v151
v_cvt_pk_bf16_f32 v150, v156, v157
v_cvt_pk_bf16_f32 v151, v158, v159
buffer_store_dwordx4 v[148:151], v2, s[12:15], s45 offen offset:1024 sc1
v_cvt_pk_bf16_f32 v164, v164, v165
v_cvt_pk_bf16_f32 v165, v166, v167
v_cvt_pk_bf16_f32 v166, v172, v173
v_cvt_pk_bf16_f32 v167, v174, v175
buffer_store_dwordx4 v[164:167], v2, s[12:15], s45 offen offset:2048 sc1
v_cvt_pk_bf16_f32 v180, v180, v181
v_cvt_pk_bf16_f32 v181, v182, v183
v_cvt_pk_bf16_f32 v182, v188, v189
v_cvt_pk_bf16_f32 v183, v190, v191
buffer_store_dwordx4 v[180:183], v2, s[12:15], s45 offen offset:3072 sc1
v_cvt_pk_bf16_f32 v196, v196, v197
v_cvt_pk_bf16_f32 v197, v198, v199
v_cvt_pk_bf16_f32 v198, v204, v205
v_cvt_pk_bf16_f32 v199, v206, v207
buffer_store_dwordx4 v[196:199], v2, s[12:15], s47 offen offset:0 sc1
v_cvt_pk_bf16_f32 v212, v212, v213
v_cvt_pk_bf16_f32 v213, v214, v215
v_cvt_pk_bf16_f32 v214, v220, v221
v_cvt_pk_bf16_f32 v215, v222, v223
buffer_store_dwordx4 v[212:215], v2, s[12:15], s47 offen offset:1024 sc1
v_cvt_pk_bf16_f32 v228, v228, v229
v_cvt_pk_bf16_f32 v229, v230, v231
v_cvt_pk_bf16_f32 v230, v236, v237
v_cvt_pk_bf16_f32 v231, v238, v239
buffer_store_dwordx4 v[228:231], v2, s[12:15], s47 offen offset:2048 sc1
v_cvt_pk_bf16_f32 v244, v244, v245
v_cvt_pk_bf16_f32 v245, v246, v247
v_cvt_pk_bf16_f32 v246, v252, v253
v_cvt_pk_bf16_f32 v247, v254, v255
buffer_store_dwordx4 v[244:247], v2, s[12:15], s47 offen offset:3072 sc1
v_accvgpr_read_b32 v128, a128
v_accvgpr_read_b32 v129, a129
v_accvgpr_read_b32 v130, a130
v_accvgpr_read_b32 v131, a131
v_accvgpr_read_b32 v144, a132
v_accvgpr_read_b32 v145, a133
v_accvgpr_read_b32 v146, a134
v_accvgpr_read_b32 v147, a135
v_accvgpr_read_b32 v160, a136
v_accvgpr_read_b32 v161, a137
v_accvgpr_read_b32 v162, a138
v_accvgpr_read_b32 v163, a139
v_accvgpr_read_b32 v176, a140
v_accvgpr_read_b32 v177, a141
v_accvgpr_read_b32 v178, a142
v_accvgpr_read_b32 v179, a143
v_accvgpr_read_b32 v192, a144
v_accvgpr_read_b32 v193, a145
v_accvgpr_read_b32 v194, a146
v_accvgpr_read_b32 v195, a147
v_accvgpr_read_b32 v208, a148
v_accvgpr_read_b32 v209, a149
v_accvgpr_read_b32 v210, a150
v_accvgpr_read_b32 v211, a151
v_accvgpr_read_b32 v224, a152
v_accvgpr_read_b32 v225, a153
v_accvgpr_read_b32 v226, a154
v_accvgpr_read_b32 v227, a155
v_accvgpr_read_b32 v240, a156
v_accvgpr_read_b32 v241, a157
v_accvgpr_read_b32 v242, a158
v_accvgpr_read_b32 v243, a159
v_accvgpr_read_b32 v132, a160
v_accvgpr_read_b32 v133, a161
v_accvgpr_read_b32 v134, a162
v_accvgpr_read_b32 v135, a163
v_accvgpr_read_b32 v148, a164
v_accvgpr_read_b32 v149, a165
v_accvgpr_read_b32 v150, a166
v_accvgpr_read_b32 v151, a167
v_accvgpr_read_b32 v164, a168
v_accvgpr_read_b32 v165, a169
v_accvgpr_read_b32 v166, a170
v_accvgpr_read_b32 v167, a171
v_accvgpr_read_b32 v180, a172
v_accvgpr_read_b32 v181, a173
v_accvgpr_read_b32 v182, a174
v_accvgpr_read_b32 v183, a175
v_accvgpr_read_b32 v196, a176
v_accvgpr_read_b32 v197, a177
v_accvgpr_read_b32 v198, a178
v_accvgpr_read_b32 v199, a179
v_accvgpr_read_b32 v212, a180
v_accvgpr_read_b32 v213, a181
v_accvgpr_read_b32 v214, a182
v_accvgpr_read_b32 v215, a183
v_accvgpr_read_b32 v228, a184
v_accvgpr_read_b32 v229, a185
v_accvgpr_read_b32 v230, a186
v_accvgpr_read_b32 v231, a187
v_accvgpr_read_b32 v244, a188
v_accvgpr_read_b32 v245, a189
v_accvgpr_read_b32 v246, a190
v_accvgpr_read_b32 v247, a191
v_accvgpr_read_b32 v30, a192
v_accvgpr_read_b32 v31, a193
s_waitcnt vmcnt(0)
s_mov_b32 s27, s63
v_mov_b32 v108, 1
buffer_atomic_or v108, v109, s[12:15], s58 offen sc1
at_done:
s_lshl_b32 s44, s27, 7
s_lshl_b32 s60, s24, 5
s_add_u32 s44, s44, s60
s_add_u32 s44, s44, s25
s_mul_i32 s44, s44, 14336
s_add_u32 s44, s44, 104857600
s_add_u32 s45, s44, 229376
s_waitcnt lgkmcnt(8)
ds_read_b64_tr_b16 a[88:89], v8 offset:24576
v_mfma_f32_16x16x32_bf16 v[32:35], a[64:67], v[128:131], 0
ds_read_b64_tr_b16 a[90:91], v8 offset:26624
v_mfma_f32_16x16x32_bf16 v[32:35], a[68:71], v[144:147], v[32:35]
ds_read_b64_tr_b16 a[92:93], v8 offset:28672
s_add_u32 m0, s7, 32768
v_mfma_f32_16x16x32_bf16 v[36:39], a[64:67], v[132:135], 0
ds_read_b64_tr_b16 a[94:95], v8 offset:30720
buffer_load_dwordx4 v12, s[16:19], s34 offen offset:0 sc1 lds
v_mfma_f32_16x16x32_bf16 v[36:39], a[68:71], v[148:151], v[36:39]
s_waitcnt lgkmcnt(8)
ds_read_b64_tr_b16 a[96:97], v9 offset:0
v_mfma_f32_16x16x32_bf16 v[32:35], a[72:75], v[160:163], v[32:35]
ds_read_b64_tr_b16 a[98:99], v9 offset:2048
v_mfma_f32_16x16x32_bf16 v[32:35], a[76:79], v[176:179], v[32:35]
ds_read_b64_tr_b16 a[100:101], v9 offset:4096
buffer_load_dwordx4 v13, s[16:19], s34 offen offset:1024 sc1 lds
v_mfma_f32_16x16x32_bf16 v[36:39], a[72:75], v[164:167], v[36:39]
ds_read_b64_tr_b16 a[102:103], v9 offset:6144
v_mfma_f32_16x16x32_bf16 v[36:39], a[76:79], v[180:183], v[36:39]
s_waitcnt lgkmcnt(8)
ds_read_b64_tr_b16 a[104:105], v9 offset:8192
v_mfma_f32_16x16x32_bf16 v[32:35], a[80:83], v[192:195], v[32:35]
ds_read_b64_tr_b16 a[106:107], v9 offset:10240
buffer_load_dwordx4 v14, s[16:19], s34 offen offset:2048 sc1 lds
v_mfma_f32_16x16x32_bf16 v[32:35], a[84:87], v[208:211], v[32:35]
ds_read_b64_tr_b16 a[108:109], v9 offset:12288
v_mfma_f32_16x16x32_bf16 v[36:39], a[80:83], v[196:199], v[36:39]
ds_read_b64_tr_b16 a[110:111], v9 offset:14336
v_mfma_f32_16x16x32_bf16 v[36:39], a[84:87], v[212:215], v[36:39]
s_waitcnt lgkmcnt(8)
ds_read_b64_tr_b16 a[112:113], v9 offset:16384
buffer_load_dwordx4 v15, s[16:19], s34 offen offset:3072 sc1 lds
s_add_u32 s34, s34, s37
v_mfma_f32_16x16x32_bf16 v[32:35], a[88:91], v[224:227], v[32:35]
ds_read_b64_tr_b16 a[114:115], v9 offset:18432
v_mfma_f32_16x16x32_bf16 v[32:35], a[92:95], v[240:243], v[32:35]
ds_read_b64_tr_b16 a[116:117], v9 offset:20480
v_mfma_f32_16x16x32_bf16 v[36:39], a[88:91], v[228:231], v[36:39]
ds_read_b64_tr_b16 a[118:119], v9 offset:22528
s_add_u32 m0, s7, 49152
v_mfma_f32_16x16x32_bf16 v[36:39], a[92:95], v[244:247], v[36:39]
s_waitcnt lgkmcnt(8)
ds_read_b64_tr_b16 a[120:121], v9 offset:24576
buffer_load_dwordx4 v12, s[16:19], s35 offen offset:0 sc1 lds
v_mfma_f32_16x16x32_bf16 v[40:43], a[96:99], v[128:131], 0
ds_read_b64_tr_b16 a[122:123], v9 offset:26624
v_mfma_f32_16x16x32_bf16 v[40:43], a[100:103], v[144:147], v[40:43]
ds_read_b64_tr_b16 a[124:125], v9 offset:28672
v_mfma_f32_16x16x32_bf16 v[44:47], a[96:99], v[132:135], 0
ds_read_b64_tr_b16 a[126:127], v9 offset:30720
buffer_load_dwordx4 v13, s[16:19], s35 offen offset:1024 sc1 lds
v_mfma_f32_16x16x32_bf16 v[44:47], a[100:103], v[148:151], v[44:47]
s_waitcnt lgkmcnt(8)
ds_read_b64_tr_b16 a[64:65], v10 offset:0
v_mfma_f32_16x16x32_bf16 v[40:43], a[104:107], v[160:163], v[40:43]
ds_read_b64_tr_b16 a[66:67], v10 offset:2048
v_mfma_f32_16x16x32_bf16 v[40:43], a[108:111], v[176:179], v[40:43]
ds_read_b64_tr_b16 a[68:69], v10 offset:4096
buffer_load_dwordx4 v14, s[16:19], s35 offen offset:2048 sc1 lds
v_mfma_f32_16x16x32_bf16 v[44:47], a[104:107], v[164:167], v[44:47]
ds_read_b64_tr_b16 a[70:71], v10 offset:6144
v_mfma_f32_16x16x32_bf16 v[44:47], a[108:111], v[180:183], v[44:47]
s_waitcnt lgkmcnt(8)
ds_read_b64_tr_b16 a[72:73], v10 offset:8192
v_mfma_f32_16x16x32_bf16 v[40:43], a[112:115], v[192:195], v[40:43]
ds_read_b64_tr_b16 a[74:75], v10 offset:10240
buffer_load_dwordx4 v15, s[16:19], s35 offen offset:3072 sc1 lds
s_add_u32 s35, s35, s37
v_mfma_f32_16x16x32_bf16 v[40:43], a[116:119], v[208:211], v[40:43]
ds_read_b64_tr_b16 a[76:77], v10 offset:12288
v_mfma_f32_16x16x32_bf16 v[44:47], a[112:115], v[196:199], v[44:47]
ds_read_b64_tr_b16 a[78:79], v10 offset:14336
v_mfma_f32_16x16x32_bf16 v[44:47], a[116:119], v[212:215], v[44:47]
s_waitcnt lgkmcnt(8)
ds_read_b64_tr_b16 a[80:81], v10 offset:16384
v_mfma_f32_16x16x32_bf16 v[40:43], a[120:123], v[224:227], v[40:43]
ds_read_b64_tr_b16 a[82:83], v10 offset:18432
v_mfma_f32_16x16x32_bf16 v[40:43], a[124:127], v[240:243], v[40:43]
ds_read_b64_tr_b16 a[84:85], v10 offset:20480
v_subrev_u32 v152, s78, v20
v_mfma_f32_16x16x32_bf16 v[44:47], a[120:123], v[228:231], v[44:47]
ds_read_b64_tr_b16 a[86:87], v10 offset:22528
v_subrev_u32 v153, s78, v21
v_mfma_f32_16x16x32_bf16 v[44:47], a[124:127], v[244:247], v[44:47]
s_waitcnt lgkmcnt(8)
ds_read_b64_tr_b16 a[88:89], v10 offset:24576
v_mfma_f32_16x16x32_bf16 v[48:51], a[64:67], v[128:131], 0
ds_read_b64_tr_b16 a[90:91], v10 offset:26624
v_subrev_u32 v154, s78, v22
v_mfma_f32_16x16x32_bf16 v[48:51], a[68:71], v[144:147], v[48:51]
ds_read_b64_tr_b16 a[92:93], v10 offset:28672
v_subrev_u32 v155, s78, v23
v_mfma_f32_16x16x32_bf16 v[52:55], a[64:67], v[132:135], 0
ds_read_b64_tr_b16 a[94:95], v10 offset:30720
v_mfma_f32_16x16x32_bf16 v[52:55], a[68:71], v[148:151], v[52:55]
s_waitcnt lgkmcnt(8)
ds_read_b64_tr_b16 a[96:97], v11 offset:0
v_mfma_f32_16x16x32_bf16 v[48:51], a[72:75], v[160:163], v[48:51]
ds_read_b64_tr_b16 a[98:99], v11 offset:2048
v_mfma_f32_16x16x32_bf16 v[48:51], a[76:79], v[176:179], v[48:51]
ds_read_b64_tr_b16 a[100:101], v11 offset:4096
v_mfma_f32_16x16x32_bf16 v[52:55], a[72:75], v[164:167], v[52:55]
ds_read_b64_tr_b16 a[102:103], v11 offset:6144
v_mfma_f32_16x16x32_bf16 v[52:55], a[76:79], v[180:183], v[52:55]
s_waitcnt lgkmcnt(8)
ds_read_b64_tr_b16 a[104:105], v11 offset:8192
v_mfma_f32_16x16x32_bf16 v[48:51], a[80:83], v[192:195], v[48:51]
ds_read_b64_tr_b16 a[106:107], v11 offset:10240
v_mfma_f32_16x16x32_bf16 v[48:51], a[84:87], v[208:211], v[48:51]
ds_read_b64_tr_b16 a[108:109], v11 offset:12288
v_mfma_f32_16x16x32_bf16 v[52:55], a[80:83], v[196:199], v[52:55]
ds_read_b64_tr_b16 a[110:111], v11 offset:14336
v_mfma_f32_16x16x32_bf16 v[52:55], a[84:87], v[212:215], v[52:55]
s_waitcnt lgkmcnt(8)
ds_read_b64_tr_b16 a[112:113], v11 offset:16384
v_mfma_f32_16x16x32_bf16 v[48:51], a[88:91], v[224:227], v[48:51]
ds_read_b64_tr_b16 a[114:115], v11 offset:18432
v_mfma_f32_16x16x32_bf16 v[48:51], a[92:95], v[240:243], v[48:51]
ds_read_b64_tr_b16 a[116:117], v11 offset:20480
v_mfma_f32_16x16x32_bf16 v[52:55], a[88:91], v[228:231], v[52:55]
ds_read_b64_tr_b16 a[118:119], v11 offset:22528
v_mfma_f32_16x16x32_bf16 v[52:55], a[92:95], v[244:247], v[52:55]
s_waitcnt vmcnt(16)
s_barrier
s_waitcnt lgkmcnt(8)
ds_read_b64_tr_b16 a[120:121], v11 offset:24576
v_mfma_f32_16x16x32_bf16 v[56:59], a[96:99], v[128:131], 0
ds_read_b64_tr_b16 a[122:123], v11 offset:26624
v_mfma_f32_16x16x32_bf16 v[56:59], a[100:103], v[144:147], v[56:59]
ds_read_b64_tr_b16 a[124:125], v11 offset:28672
v_mfma_f32_16x16x32_bf16 v[60:63], a[96:99], v[132:135], 0
ds_read_b64_tr_b16 a[126:127], v11 offset:30720
v_mfma_f32_16x16x32_bf16 v[60:63], a[100:103], v[148:151], v[60:63]
s_waitcnt lgkmcnt(8)
ds_read_b64_tr_b16 a[64:65], v8 offset:32768
v_mfma_f32_16x16x32_bf16 v[56:59], a[104:107], v[160:163], v[56:59]
ds_read_b64_tr_b16 a[66:67], v8 offset:34816
v_mfma_f32_16x16x32_bf16 v[56:59], a[108:111], v[176:179], v[56:59]
ds_read_b64_tr_b16 a[68:69], v8 offset:36864
v_mfma_f32_16x16x32_bf16 v[60:63], a[104:107], v[164:167], v[60:63]
ds_read_b64_tr_b16 a[70:71], v8 offset:38912
v_mfma_f32_16x16x32_bf16 v[60:63], a[108:111], v[180:183], v[60:63]
s_waitcnt lgkmcnt(8)
ds_read_b64_tr_b16 a[72:73], v8 offset:40960
v_mfma_f32_16x16x32_bf16 v[56:59], a[112:115], v[192:195], v[56:59]
ds_read_b64_tr_b16 a[74:75], v8 offset:43008
v_mfma_f32_16x16x32_bf16 v[56:59], a[116:119], v[208:211], v[56:59]
ds_read_b64_tr_b16 a[76:77], v8 offset:45056
v_mfma_f32_16x16x32_bf16 v[60:63], a[112:115], v[196:199], v[60:63]
ds_read_b64_tr_b16 a[78:79], v8 offset:47104
v_mfma_f32_16x16x32_bf16 v[60:63], a[116:119], v[212:215], v[60:63]
s_waitcnt lgkmcnt(8)
ds_read_b64_tr_b16 a[80:81], v8 offset:49152
v_mfma_f32_16x16x32_bf16 v[56:59], a[120:123], v[224:227], v[56:59]
ds_read_b64_tr_b16 a[82:83], v8 offset:51200
v_mfma_f32_16x16x32_bf16 v[56:59], a[124:127], v[240:243], v[56:59]
ds_read_b64_tr_b16 a[84:85], v8 offset:53248
v_mfma_f32_16x16x32_bf16 v[60:63], a[120:123], v[228:231], v[60:63]
ds_read_b64_tr_b16 a[86:87], v8 offset:55296
v_mfma_f32_16x16x32_bf16 v[60:63], a[124:127], v[244:247], v[60:63]
s_lshl_b32 s52, s27, 2
s_add_u32 s52, s52, s24
s_lshl_b32 s52, s52, 7
s_add_u32 s52, s52, 36849664
s_lshl_b32 s53, 1, s25
s_and_b32 s28, s25, 1
s_lshr_b32 s27, s25, 1
s_cmp_ge_u32 s26, 6
s_cselect_b32 s60, 6, 0
s_cselect_b32 s61, 0, 8
s_sub_u32 s29, s26, s60
s_cmp_eq_u32 s26, 12
s_cselect_b32 s61, 8, s61
s_min_u32 s29, s29, 6
s_add_u32 s27, s27, s61
s_lshl_b32 s30, s27, 1
s_add_u32 s30, s30, s28
s_mul_i32 s31, s28, 7
s_add_u32 s31, s31, s29
s_mul_i32 s77, s24, 28672
s_lshl_b32 s38, s30, 2
s_add_u32 s38, s38, s24
s_mul_i32 s39, s38, 14336
s_lshl_b32 s60, s29, 7
s_barrier
s_waitcnt lgkmcnt(8)
ds_read_b64_tr_b16 a[88:89], v8 offset:57344
v_mfma_f32_16x16x32_bf16 v[64:67], a[64:67], v[128:131], 0
ds_read_b64_tr_b16 a[90:91], v8 offset:59392
v_mfma_f32_16x16x32_bf16 v[64:67], a[68:71], v[144:147], v[64:67]
ds_read_b64_tr_b16 a[92:93], v8 offset:61440
s_add_u32 m0, s36, 0
v_mfma_f32_16x16x32_bf16 v[68:71], a[64:67], v[132:135], 0
ds_read_b64_tr_b16 a[94:95], v8 offset:63488
buffer_load_dwordx4 v12, s[16:19], s34 offen offset:0 sc1 lds
v_mfma_f32_16x16x32_bf16 v[68:71], a[68:71], v[148:151], v[68:71]
s_waitcnt lgkmcnt(8)
ds_read_b64_tr_b16 a[96:97], v9 offset:32768
v_mfma_f32_16x16x32_bf16 v[64:67], a[72:75], v[160:163], v[64:67]
ds_read_b64_tr_b16 a[98:99], v9 offset:34816
v_mfma_f32_16x16x32_bf16 v[64:67], a[76:79], v[176:179], v[64:67]
ds_read_b64_tr_b16 a[100:101], v9 offset:36864
buffer_load_dwordx4 v13, s[16:19], s34 offen offset:1024 sc1 lds
v_mul_f32 v32, v32, v30
v_mfma_f32_16x16x32_bf16 v[68:71], a[72:75], v[164:167], v[68:71]
ds_read_b64_tr_b16 a[102:103], v9 offset:38912
v_mul_f32 v33, v33, v30
v_mul_f32 v34, v34, v30
v_mfma_f32_16x16x32_bf16 v[68:71], a[76:79], v[180:183], v[68:71]
s_waitcnt lgkmcnt(8)
ds_read_b64_tr_b16 a[104:105], v9 offset:40960
v_mul_f32 v35, v35, v30
v_mfma_f32_16x16x32_bf16 v[64:67], a[80:83], v[192:195], v[64:67]
ds_read_b64_tr_b16 a[106:107], v9 offset:43008
buffer_load_dwordx4 v14, s[16:19], s34 offen offset:2048 sc1 lds
v_cvt_pk_bf16_f32 v96, v32, v33
v_mfma_f32_16x16x32_bf16 v[64:67], a[84:87], v[208:211], v[64:67]
ds_read_b64_tr_b16 a[108:109], v9 offset:45056
v_cvt_pk_bf16_f32 v97, v34, v35
v_mul_f32 v40, v40, v30
v_mfma_f32_16x16x32_bf16 v[68:71], a[80:83], v[196:199], v[68:71]
ds_read_b64_tr_b16 a[110:111], v9 offset:47104
v_mul_f32 v41, v41, v30
v_mul_f32 v42, v42, v30
v_mfma_f32_16x16x32_bf16 v[68:71], a[84:87], v[212:215], v[68:71]
s_waitcnt lgkmcnt(8)
ds_read_b64_tr_b16 a[112:113], v9 offset:49152
buffer_load_dwordx4 v15, s[16:19], s34 offen offset:3072 sc1 lds
s_add_u32 s34, s34, s37
v_mfma_f32_16x16x32_bf16 v[64:67], a[88:91], v[224:227], v[64:67]
ds_read_b64_tr_b16 a[114:115], v9 offset:51200
v_mul_f32 v43, v43, v30
v_cvt_pk_bf16_f32 v98, v40, v41
v_mfma_f32_16x16x32_bf16 v[64:67], a[92:95], v[240:243], v[64:67]
ds_read_b64_tr_b16 a[116:117], v9 offset:53248
v_cvt_pk_bf16_f32 v99, v42, v43
buffer_store_dwordx4 v[96:99], v2, s[12:15], s44 offen offset:0 sc1
v_mfma_f32_16x16x32_bf16 v[68:71], a[88:91], v[228:231], v[68:71]
ds_read_b64_tr_b16 a[118:119], v9 offset:55296
s_add_u32 m0, s36, 16384
v_mul_f32 v36, v36, v31
v_mfma_f32_16x16x32_bf16 v[68:71], a[92:95], v[244:247], v[68:71]
s_waitcnt lgkmcnt(8)
ds_read_b64_tr_b16 a[120:121], v9 offset:57344
buffer_load_dwordx4 v12, s[16:19], s35 offen offset:0 sc1 lds
v_mfma_f32_16x16x32_bf16 v[72:75], a[96:99], v[128:131], 0
ds_read_b64_tr_b16 a[122:123], v9 offset:59392
v_mul_f32 v37, v37, v31
v_mul_f32 v38, v38, v31
v_mfma_f32_16x16x32_bf16 v[72:75], a[100:103], v[144:147], v[72:75]
ds_read_b64_tr_b16 a[124:125], v9 offset:61440
v_mul_f32 v39, v39, v31
v_cvt_pk_bf16_f32 v100, v36, v37
v_mfma_f32_16x16x32_bf16 v[76:79], a[96:99], v[132:135], 0
ds_read_b64_tr_b16 a[126:127], v9 offset:63488
buffer_load_dwordx4 v13, s[16:19], s35 offen offset:1024 sc1 lds
v_cvt_pk_bf16_f32 v101, v38, v39
v_mfma_f32_16x16x32_bf16 v[76:79], a[100:103], v[148:151], v[76:79]
s_waitcnt lgkmcnt(8)
ds_read_b64_tr_b16 a[64:65], v10 offset:32768
v_mul_f32 v44, v44, v31
v_mfma_f32_16x16x32_bf16 v[72:75], a[104:107], v[160:163], v[72:75]
ds_read_b64_tr_b16 a[66:67], v10 offset:34816
v_mul_f32 v45, v45, v31
v_mul_f32 v46, v46, v31
v_mfma_f32_16x16x32_bf16 v[72:75], a[108:111], v[176:179], v[72:75]
ds_read_b64_tr_b16 a[68:69], v10 offset:36864
buffer_load_dwordx4 v14, s[16:19], s35 offen offset:2048 sc1 lds
v_mul_f32 v47, v47, v31
v_mfma_f32_16x16x32_bf16 v[76:79], a[104:107], v[164:167], v[76:79]
ds_read_b64_tr_b16 a[70:71], v10 offset:38912
v_cvt_pk_bf16_f32 v102, v44, v45
v_cvt_pk_bf16_f32 v103, v46, v47
v_mfma_f32_16x16x32_bf16 v[76:79], a[108:111], v[180:183], v[76:79]
s_waitcnt lgkmcnt(8)
ds_read_b64_tr_b16 a[72:73], v10 offset:40960
buffer_store_dwordx4 v[100:103], v2, s[12:15], s45 offen offset:0 sc1
v_mfma_f32_16x16x32_bf16 v[72:75], a[112:115], v[192:195], v[72:75]
ds_read_b64_tr_b16 a[74:75], v10 offset:43008
buffer_load_dwordx4 v15, s[16:19], s35 offen offset:3072 sc1 lds
s_add_u32 s35, s35, s37
v_mfma_f32_16x16x32_bf16 v[72:75], a[116:119], v[208:211], v[72:75]
ds_read_b64_tr_b16 a[76:77], v10 offset:45056
v_mul_f32 v48, v48, v30
v_mul_f32 v49, v49, v30
v_mfma_f32_16x16x32_bf16 v[76:79], a[112:115], v[196:199], v[76:79]
ds_read_b64_tr_b16 a[78:79], v10 offset:47104
v_mul_f32 v50, v50, v30
v_mul_f32 v51, v51, v30
v_mfma_f32_16x16x32_bf16 v[76:79], a[116:119], v[212:215], v[76:79]
s_waitcnt lgkmcnt(8)
ds_read_b64_tr_b16 a[80:81], v10 offset:49152
v_cvt_pk_bf16_f32 v104, v48, v49
v_mfma_f32_16x16x32_bf16 v[72:75], a[120:123], v[224:227], v[72:75]
ds_read_b64_tr_b16 a[82:83], v10 offset:51200
v_cvt_pk_bf16_f32 v105, v50, v51
v_mul_f32 v56, v56, v30
v_mfma_f32_16x16x32_bf16 v[72:75], a[124:127], v[240:243], v[72:75]
ds_read_b64_tr_b16 a[84:85], v10 offset:53248
v_mul_f32 v57, v57, v30
v_mul_f32 v58, v58, v30
v_mfma_f32_16x16x32_bf16 v[76:79], a[120:123], v[228:231], v[76:79]
ds_read_b64_tr_b16 a[86:87], v10 offset:55296
v_mul_f32 v59, v59, v30
v_cvt_pk_bf16_f32 v106, v56, v57
v_mfma_f32_16x16x32_bf16 v[76:79], a[124:127], v[244:247], v[76:79]
s_waitcnt lgkmcnt(8)
ds_read_b64_tr_b16 a[88:89], v10 offset:57344
v_cvt_pk_bf16_f32 v107, v58, v59
v_mfma_f32_16x16x32_bf16 v[80:83], a[64:67], v[128:131], 0
ds_read_b64_tr_b16 a[90:91], v10 offset:59392
buffer_store_dwordx4 v[104:107], v2, s[12:15], s44 offen offset:1024 sc1
v_mul_f32 v52, v52, v31
v_mfma_f32_16x16x32_bf16 v[80:83], a[68:71], v[144:147], v[80:83]
ds_read_b64_tr_b16 a[92:93], v10 offset:61440
v_mul_f32 v53, v53, v31
v_mul_f32 v54, v54, v31
v_mfma_f32_16x16x32_bf16 v[84:87], a[64:67], v[132:135], 0
ds_read_b64_tr_b16 a[94:95], v10 offset:63488
v_mul_f32 v55, v55, v31
v_cvt_pk_bf16_f32 v108, v52, v53
v_mfma_f32_16x16x32_bf16 v[84:87], a[68:71], v[148:151], v[84:87]
s_waitcnt lgkmcnt(8)
ds_read_b64_tr_b16 a[96:97], v11 offset:32768
v_cvt_pk_bf16_f32 v109, v54, v55
v_mfma_f32_16x16x32_bf16 v[80:83], a[72:75], v[160:163], v[80:83]
ds_read_b64_tr_b16 a[98:99], v11 offset:34816
v_mul_f32 v60, v60, v31
v_mul_f32 v61, v61, v31
v_mfma_f32_16x16x32_bf16 v[80:83], a[76:79], v[176:179], v[80:83]
ds_read_b64_tr_b16 a[100:101], v11 offset:36864
v_mul_f32 v62, v62, v31
v_mul_f32 v63, v63, v31
v_mfma_f32_16x16x32_bf16 v[84:87], a[72:75], v[164:167], v[84:87]
ds_read_b64_tr_b16 a[102:103], v11 offset:38912
v_cvt_pk_bf16_f32 v110, v60, v61
v_cvt_pk_bf16_f32 v111, v62, v63
v_mfma_f32_16x16x32_bf16 v[84:87], a[76:79], v[180:183], v[84:87]
s_waitcnt lgkmcnt(8)
ds_read_b64_tr_b16 a[104:105], v11 offset:40960
buffer_store_dwordx4 v[108:111], v2, s[12:15], s45 offen offset:1024 sc1
v_mfma_f32_16x16x32_bf16 v[80:83], a[80:83], v[192:195], v[80:83]
ds_read_b64_tr_b16 a[106:107], v11 offset:43008
s_add_u32 s39, s39, s60
v_mfma_f32_16x16x32_bf16 v[80:83], a[84:87], v[208:211], v[80:83]
ds_read_b64_tr_b16 a[108:109], v11 offset:45056
s_mul_i32 s40, s38, 14336
v_mfma_f32_16x16x32_bf16 v[84:87], a[80:83], v[196:199], v[84:87]
ds_read_b64_tr_b16 a[110:111], v11 offset:47104
s_lshl_b32 s60, s29, 11
v_mfma_f32_16x16x32_bf16 v[84:87], a[84:87], v[212:215], v[84:87]
s_waitcnt lgkmcnt(8)
ds_read_b64_tr_b16 a[112:113], v11 offset:49152
v_mfma_f32_16x16x32_bf16 v[80:83], a[88:91], v[224:227], v[80:83]
ds_read_b64_tr_b16 a[114:115], v11 offset:51200
s_lshl_b32 s43, s40, 4
v_mfma_f32_16x16x32_bf16 v[80:83], a[92:95], v[240:243], v[80:83]
ds_read_b64_tr_b16 a[116:117], v11 offset:53248
s_add_u32 s43, s43, s60
v_mfma_f32_16x16x32_bf16 v[84:87], a[88:91], v[228:231], v[84:87]
ds_read_b64_tr_b16 a[118:119], v11 offset:55296
s_add_u32 s40, s40, s60
v_mfma_f32_16x16x32_bf16 v[84:87], a[92:95], v[244:247], v[84:87]
s_waitcnt lgkmcnt(8)
ds_read_b64_tr_b16 a[120:121], v11 offset:57344
v_mfma_f32_16x16x32_bf16 v[88:91], a[96:99], v[128:131], 0
ds_read_b64_tr_b16 a[122:123], v11 offset:59392
s_add_u32 s43, s43, 104857600
v_mfma_f32_16x16x32_bf16 v[88:91], a[100:103], v[144:147], v[88:91]
ds_read_b64_tr_b16 a[124:125], v11 offset:61440
s_add_u32 s40, s40, 62914560
v_mfma_f32_16x16x32_bf16 v[92:95], a[96:99], v[132:135], 0
ds_read_b64_tr_b16 a[126:127], v11 offset:63488
s_lshr_b32 s54, s38, 1
v_mfma_f32_16x16x32_bf16 v[92:95], a[100:103], v[148:151], v[92:95]
s_waitcnt lgkmcnt(8)
ds_read_b64_tr_b16 a[64:65], v152 offset:0
v_mfma_f32_16x16x32_bf16 v[88:91], a[104:107], v[160:163], v[88:91]
ds_read_b64_tr_b16 a[66:67], v152 offset:2048
s_lshl_b32 s54, s54, 7
v_mfma_f32_16x16x32_bf16 v[88:91], a[108:111], v[176:179], v[88:91]
ds_read_b64_tr_b16 a[68:69], v152 offset:4096
s_add_u32 s54, s54, 36849664
v_mfma_f32_16x16x32_bf16 v[92:95], a[104:107], v[164:167], v[92:95]
ds_read_b64_tr_b16 a[70:71], v152 offset:6144
s_mov_b32 s55, 0xffff
v_mfma_f32_16x16x32_bf16 v[92:95], a[108:111], v[180:183], v[92:95]
s_waitcnt lgkmcnt(8)
ds_read_b64_tr_b16 a[72:73], v152 offset:8192
v_mfma_f32_16x16x32_bf16 v[88:91], a[112:115], v[192:195], v[88:91]
ds_read_b64_tr_b16 a[74:75], v152 offset:10240
s_mul_i32 s62, s24, 401408
v_mfma_f32_16x16x32_bf16 v[88:91], a[116:119], v[208:211], v[88:91]
ds_read_b64_tr_b16 a[76:77], v152 offset:12288
s_lshl_b32 s60, s31, 8
v_mfma_f32_16x16x32_bf16 v[92:95], a[112:115], v[196:199], v[92:95]
ds_read_b64_tr_b16 a[78:79], v152 offset:14336
s_add_u32 s62, s62, s60
v_mfma_f32_16x16x32_bf16 v[92:95], a[116:119], v[212:215], v[92:95]
s_waitcnt lgkmcnt(8)
ds_read_b64_tr_b16 a[80:81], v152 offset:16384
v_mfma_f32_16x16x32_bf16 v[88:91], a[120:123], v[224:227], v[88:91]
ds_read_b64_tr_b16 a[82:83], v152 offset:18432
s_load_dwordx4 s[68:71], s[0:1], 56
v_mfma_f32_16x16x32_bf16 v[88:91], a[124:127], v[240:243], v[88:91]
ds_read_b64_tr_b16 a[84:85], v152 offset:20480
v_mfma_f32_16x16x32_bf16 v[92:95], a[120:123], v[228:231], v[92:95]
ds_read_b64_tr_b16 a[86:87], v152 offset:22528
v_mfma_f32_16x16x32_bf16 v[92:95], a[124:127], v[244:247], v[92:95]
s_waitcnt vmcnt(20)
s_barrier
s_waitcnt lgkmcnt(0)
ds_read_b64_tr_b16 a[88:89], v152 offset:24576
v_mfma_f32_16x16x32_bf16 v[32:35], a[64:67], v[128:131], 0
ds_read_b64_tr_b16 a[90:91], v152 offset:26624
v_mfma_f32_16x16x32_bf16 v[32:35], a[68:71], v[144:147], v[32:35]
ds_read_b64_tr_b16 a[92:93], v152 offset:28672
s_add_u32 m0, s36, 32768
v_mfma_f32_16x16x32_bf16 v[36:39], a[64:67], v[132:135], 0
ds_read_b64_tr_b16 a[94:95], v152 offset:30720
buffer_load_dwordx4 v12, s[16:19], s34 offen offset:0 sc1 lds
v_mfma_f32_16x16x32_bf16 v[36:39], a[68:71], v[148:151], v[36:39]
ds_read_b64_tr_b16 a[96:97], v153 offset:0
v_mfma_f32_16x16x32_bf16 v[32:35], a[72:75], v[160:163], v[32:35]
ds_read_b64_tr_b16 a[98:99], v153 offset:2048
v_mfma_f32_16x16x32_bf16 v[32:35], a[76:79], v[176:179], v[32:35]
ds_read_b64_tr_b16 a[100:101], v153 offset:4096
buffer_load_dwordx4 v13, s[16:19], s34 offen offset:1024 sc1 lds
v_mul_f32 v64, v64, v30
v_mfma_f32_16x16x32_bf16 v[36:39], a[72:75], v[164:167], v[36:39]
ds_read_b64_tr_b16 a[102:103], v153 offset:6144
v_mul_f32 v65, v65, v30
v_mul_f32 v66, v66, v30
v_mfma_f32_16x16x32_bf16 v[36:39], a[76:79], v[180:183], v[36:39]
ds_read_b64_tr_b16 a[104:105], v153 offset:8192
v_mul_f32 v67, v67, v30
v_mfma_f32_16x16x32_bf16 v[32:35], a[80:83], v[192:195], v[32:35]
ds_read_b64_tr_b16 a[106:107], v153 offset:10240
buffer_load_dwordx4 v14, s[16:19], s34 offen offset:2048 sc1 lds
v_cvt_pk_bf16_f32 v96, v64, v65
v_mfma_f32_16x16x32_bf16 v[32:35], a[84:87], v[208:211], v[32:35]
ds_read_b64_tr_b16 a[108:109], v153 offset:12288
v_cvt_pk_bf16_f32 v97, v66, v67
v_mul_f32 v72, v72, v30
v_mfma_f32_16x16x32_bf16 v[36:39], a[80:83], v[196:199], v[36:39]
ds_read_b64_tr_b16 a[110:111], v153 offset:14336
v_mul_f32 v73, v73, v30
v_mul_f32 v74, v74, v30
v_mfma_f32_16x16x32_bf16 v[36:39], a[84:87], v[212:215], v[36:39]
s_waitcnt lgkmcnt(8)
ds_read_b64_tr_b16 a[112:113], v153 offset:16384
buffer_load_dwordx4 v15, s[16:19], s34 offen offset:3072 sc1 lds
s_add_u32 s34, s34, s37
v_mfma_f32_16x16x32_bf16 v[32:35], a[88:91], v[224:227], v[32:35]
ds_read_b64_tr_b16 a[114:115], v153 offset:18432
v_mul_f32 v75, v75, v30
v_cvt_pk_bf16_f32 v98, v72, v73
v_mfma_f32_16x16x32_bf16 v[32:35], a[92:95], v[240:243], v[32:35]
ds_read_b64_tr_b16 a[116:117], v153 offset:20480
v_cvt_pk_bf16_f32 v99, v74, v75
buffer_store_dwordx4 v[96:99], v2, s[12:15], s44 offen offset:2048 sc1
v_mfma_f32_16x16x32_bf16 v[36:39], a[88:91], v[228:231], v[36:39]
ds_read_b64_tr_b16 a[118:119], v153 offset:22528
s_add_u32 m0, s36, 49152
v_mul_f32 v68, v68, v31
v_mfma_f32_16x16x32_bf16 v[36:39], a[92:95], v[244:247], v[36:39]
s_waitcnt lgkmcnt(8)
ds_read_b64_tr_b16 a[120:121], v153 offset:24576
buffer_load_dwordx4 v12, s[16:19], s35 offen offset:0 sc1 lds
v_mfma_f32_16x16x32_bf16 v[40:43], a[96:99], v[128:131], 0
ds_read_b64_tr_b16 a[122:123], v153 offset:26624
v_mul_f32 v69, v69, v31
v_mul_f32 v70, v70, v31
v_mfma_f32_16x16x32_bf16 v[40:43], a[100:103], v[144:147], v[40:43]
ds_read_b64_tr_b16 a[124:125], v153 offset:28672
v_mul_f32 v71, v71, v31
v_cvt_pk_bf16_f32 v100, v68, v69
v_mfma_f32_16x16x32_bf16 v[44:47], a[96:99], v[132:135], 0
ds_read_b64_tr_b16 a[126:127], v153 offset:30720
buffer_load_dwordx4 v13, s[16:19], s35 offen offset:1024 sc1 lds
v_cvt_pk_bf16_f32 v101, v70, v71
v_mfma_f32_16x16x32_bf16 v[44:47], a[100:103], v[148:151], v[44:47]
s_waitcnt lgkmcnt(8)
ds_read_b64_tr_b16 a[64:65], v154 offset:0
v_mul_f32 v76, v76, v31
v_mfma_f32_16x16x32_bf16 v[40:43], a[104:107], v[160:163], v[40:43]
ds_read_b64_tr_b16 a[66:67], v154 offset:2048
v_mul_f32 v77, v77, v31
v_mul_f32 v78, v78, v31
v_mfma_f32_16x16x32_bf16 v[40:43], a[108:111], v[176:179], v[40:43]
ds_read_b64_tr_b16 a[68:69], v154 offset:4096
buffer_load_dwordx4 v14, s[16:19], s35 offen offset:2048 sc1 lds
v_mul_f32 v79, v79, v31
v_mfma_f32_16x16x32_bf16 v[44:47], a[104:107], v[164:167], v[44:47]
ds_read_b64_tr_b16 a[70:71], v154 offset:6144
v_cvt_pk_bf16_f32 v102, v76, v77
v_cvt_pk_bf16_f32 v103, v78, v79
v_mfma_f32_16x16x32_bf16 v[44:47], a[108:111], v[180:183], v[44:47]
s_waitcnt lgkmcnt(8)
ds_read_b64_tr_b16 a[72:73], v154 offset:8192
buffer_store_dwordx4 v[100:103], v2, s[12:15], s45 offen offset:2048 sc1
v_mfma_f32_16x16x32_bf16 v[40:43], a[112:115], v[192:195], v[40:43]
ds_read_b64_tr_b16 a[74:75], v154 offset:10240
buffer_load_dwordx4 v15, s[16:19], s35 offen offset:3072 sc1 lds
s_add_u32 s35, s35, s37
v_mfma_f32_16x16x32_bf16 v[40:43], a[116:119], v[208:211], v[40:43]
ds_read_b64_tr_b16 a[76:77], v154 offset:12288
v_mul_f32 v80, v80, v30
v_mul_f32 v81, v81, v30
v_mfma_f32_16x16x32_bf16 v[44:47], a[112:115], v[196:199], v[44:47]
ds_read_b64_tr_b16 a[78:79], v154 offset:14336
v_mul_f32 v82, v82, v30
v_mul_f32 v83, v83, v30
v_mfma_f32_16x16x32_bf16 v[44:47], a[116:119], v[212:215], v[44:47]
s_waitcnt lgkmcnt(8)
ds_read_b64_tr_b16 a[80:81], v154 offset:16384
v_cvt_pk_bf16_f32 v104, v80, v81
v_mfma_f32_16x16x32_bf16 v[40:43], a[120:123], v[224:227], v[40:43]
ds_read_b64_tr_b16 a[82:83], v154 offset:18432
v_cvt_pk_bf16_f32 v105, v82, v83
v_mul_f32 v88, v88, v30
v_mfma_f32_16x16x32_bf16 v[40:43], a[124:127], v[240:243], v[40:43]
ds_read_b64_tr_b16 a[84:85], v154 offset:20480
v_mul_f32 v89, v89, v30
v_mul_f32 v90, v90, v30
v_mfma_f32_16x16x32_bf16 v[44:47], a[120:123], v[228:231], v[44:47]
ds_read_b64_tr_b16 a[86:87], v154 offset:22528
v_mul_f32 v91, v91, v30
v_cvt_pk_bf16_f32 v106, v88, v89
v_mfma_f32_16x16x32_bf16 v[44:47], a[124:127], v[244:247], v[44:47]
s_waitcnt lgkmcnt(8)
ds_read_b64_tr_b16 a[88:89], v154 offset:24576
v_cvt_pk_bf16_f32 v107, v90, v91
v_mfma_f32_16x16x32_bf16 v[48:51], a[64:67], v[128:131], 0
ds_read_b64_tr_b16 a[90:91], v154 offset:26624
buffer_store_dwordx4 v[104:107], v2, s[12:15], s44 offen offset:3072 sc1
v_mul_f32 v84, v84, v31
v_mfma_f32_16x16x32_bf16 v[48:51], a[68:71], v[144:147], v[48:51]
ds_read_b64_tr_b16 a[92:93], v154 offset:28672
v_mul_f32 v85, v85, v31
v_mul_f32 v86, v86, v31
v_mfma_f32_16x16x32_bf16 v[52:55], a[64:67], v[132:135], 0
ds_read_b64_tr_b16 a[94:95], v154 offset:30720
v_mul_f32 v87, v87, v31
v_cvt_pk_bf16_f32 v108, v84, v85
v_mfma_f32_16x16x32_bf16 v[52:55], a[68:71], v[148:151], v[52:55]
s_waitcnt lgkmcnt(8)
ds_read_b64_tr_b16 a[96:97], v155 offset:0
v_cvt_pk_bf16_f32 v109, v86, v87
v_mfma_f32_16x16x32_bf16 v[48:51], a[72:75], v[160:163], v[48:51]
ds_read_b64_tr_b16 a[98:99], v155 offset:2048
v_mul_f32 v92, v92, v31
v_mul_f32 v93, v93, v31
v_mfma_f32_16x16x32_bf16 v[48:51], a[76:79], v[176:179], v[48:51]
ds_read_b64_tr_b16 a[100:101], v155 offset:4096
v_mul_f32 v94, v94, v31
v_mul_f32 v95, v95, v31
v_mfma_f32_16x16x32_bf16 v[52:55], a[72:75], v[164:167], v[52:55]
ds_read_b64_tr_b16 a[102:103], v155 offset:6144
v_cvt_pk_bf16_f32 v110, v92, v93
v_cvt_pk_bf16_f32 v111, v94, v95
v_mfma_f32_16x16x32_bf16 v[52:55], a[76:79], v[180:183], v[52:55]
s_waitcnt lgkmcnt(8)
ds_read_b64_tr_b16 a[104:105], v155 offset:8192
buffer_store_dwordx4 v[108:111], v2, s[12:15], s45 offen offset:3072 sc1
v_mfma_f32_16x16x32_bf16 v[48:51], a[80:83], v[192:195], v[48:51]
ds_read_b64_tr_b16 a[106:107], v155 offset:10240
s_add_u32 s44, s44, 4096
s_add_u32 s45, s45, 4096
v_mfma_f32_16x16x32_bf16 v[48:51], a[84:87], v[208:211], v[48:51]
ds_read_b64_tr_b16 a[108:109], v155 offset:12288
s_mov_b32 s61, 26624
v_lshrrev_b32 v120, 4, v1
v_mfma_f32_16x16x32_bf16 v[52:55], a[80:83], v[196:199], v[52:55]
ds_read_b64_tr_b16 a[110:111], v155 offset:14336
v_bfe_u32 v121, v1, 1, 3
v_xor_b32 v121, v121, v120
v_mfma_f32_16x16x32_bf16 v[52:55], a[84:87], v[212:215], v[52:55]
s_waitcnt lgkmcnt(8)
ds_read_b64_tr_b16 a[112:113], v155 offset:16384
v_lshlrev_b32 v121, 5, v121
v_mfma_f32_16x16x32_bf16 v[48:51], a[88:91], v[224:227], v[48:51]
ds_read_b64_tr_b16 a[114:115], v155 offset:18432
v_and_b32 v122, 1, v1
v_lshl_add_u32 v121, v122, 4, v121
v_mfma_f32_16x16x32_bf16 v[48:51], a[92:95], v[240:243], v[48:51]
ds_read_b64_tr_b16 a[116:117], v155 offset:20480
v_mul_u32_u24 v120, 3584, v120
v_add_u32 v124, v120, v121
v_mfma_f32_16x16x32_bf16 v[52:55], a[88:91], v[228:231], v[52:55]
ds_read_b64_tr_b16 a[118:119], v155 offset:22528
v_add_u32 v125, 13312, v124
v_xor_b32 v121, 128, v121
v_mfma_f32_16x16x32_bf16 v[52:55], a[92:95], v[244:247], v[52:55]
s_waitcnt lgkmcnt(8)
ds_read_b64_tr_b16 a[120:121], v155 offset:24576
v_add3_u32 v126, v120, v121, s61
v_mfma_f32_16x16x32_bf16 v[56:59], a[96:99], v[128:131], 0
ds_read_b64_tr_b16 a[122:123], v155 offset:26624
v_add_u32 v127, 13312, v126
s_waitcnt lgkmcnt(0)
v_mfma_f32_16x16x32_bf16 v[56:59], a[100:103], v[144:147], v[56:59]
ds_read_b64_tr_b16 a[124:125], v155 offset:28672
s_mov_b32 s72, s68
s_mov_b32 s73, s69
v_mfma_f32_16x16x32_bf16 v[60:63], a[96:99], v[132:135], 0
ds_read_b64_tr_b16 a[126:127], v155 offset:30720
s_mul_i32 s63, s24, 57344
s_lshl_b32 s60, s31, 8
v_mfma_f32_16x16x32_bf16 v[60:63], a[100:103], v[148:151], v[60:63]
ds_read_b64_tr_b16 a[64:65], v20 offset:0
s_add_u32 s63, s63, s60
v_mfma_f32_16x16x32_bf16 v[56:59], a[104:107], v[160:163], v[56:59]
ds_read_b64_tr_b16 a[66:67], v20 offset:2048
s_cmp_ge_u32 s26, 14
s_cselect_b32 s74, 0, 1605632
v_mfma_f32_16x16x32_bf16 v[56:59], a[108:111], v[176:179], v[56:59]
ds_read_b64_tr_b16 a[68:69], v20 offset:4096
s_mov_b32 s75, 0x00020000
v_and_b32 v120, 1, v1
v_mfma_f32_16x16x32_bf16 v[60:63], a[104:107], v[164:167], v[60:63]
ds_read_b64_tr_b16 a[70:71], v20 offset:6144
v_lshlrev_b32 v120, 4, v120
v_mov_b32 v121, 0x3f80
v_mfma_f32_16x16x32_bf16 v[60:63], a[108:111], v[180:183], v[60:63]
ds_read_b64_tr_b16 a[72:73], v20 offset:8192
v_lshlrev_b32 v120, v120, v121
v_mfma_f32_16x16x32_bf16 v[56:59], a[112:115], v[192:195], v[56:59]
ds_read_b64_tr_b16 a[74:75], v20 offset:10240
v_bfe_u32 v121, v1, 1, 1
v_bfe_u32 v122, v1, 3, 1
v_mfma_f32_16x16x32_bf16 v[56:59], a[116:119], v[208:211], v[56:59]
ds_read_b64_tr_b16 a[76:77], v20 offset:12288
v_lshl_or_b32 v121, v122, 1, v121
v_bfe_u32 v122, v1, 2, 1
v_mfma_f32_16x16x32_bf16 v[60:63], a[112:115], v[196:199], v[60:63]
ds_read_b64_tr_b16 a[78:79], v20 offset:14336
v_lshlrev_b32 v122, 1, v122
v_lshrrev_b32 v123, 4, v1
v_mfma_f32_16x16x32_bf16 v[60:63], a[116:119], v[212:215], v[60:63]
s_waitcnt lgkmcnt(8)
ds_read_b64_tr_b16 a[80:81], v20 offset:16384
v_sub_u32 v122, v123, v122
v_mfma_f32_16x16x32_bf16 v[56:59], a[120:123], v[224:227], v[56:59]
ds_read_b64_tr_b16 a[82:83], v20 offset:18432
v_lshl_add_u32 v121, v122, 2, v121
v_mfma_f32_16x16x32_bf16 v[56:59], a[124:127], v[240:243], v[56:59]
ds_read_b64_tr_b16 a[84:85], v20 offset:20480
v_mfma_f32_16x16x32_bf16 v[60:63], a[120:123], v[228:231], v[60:63]
ds_read_b64_tr_b16 a[86:87], v20 offset:22528
v_mfma_f32_16x16x32_bf16 v[60:63], a[124:127], v[244:247], v[60:63]
s_waitcnt vmcnt(24)
s_barrier
s_waitcnt lgkmcnt(8)
ds_read_b64_tr_b16 a[88:89], v20 offset:24576
v_mfma_f32_16x16x32_bf16 v[64:67], a[64:67], v[128:131], 0
ds_read_b64_tr_b16 a[90:91], v20 offset:26624
v_mfma_f32_16x16x32_bf16 v[64:67], a[68:71], v[144:147], v[64:67]
ds_read_b64_tr_b16 a[92:93], v20 offset:28672
v_mfma_f32_16x16x32_bf16 v[68:71], a[64:67], v[132:135], 0
ds_read_b64_tr_b16 a[94:95], v20 offset:30720
v_mfma_f32_16x16x32_bf16 v[68:71], a[68:71], v[148:151], v[68:71]
s_waitcnt lgkmcnt(8)
ds_read_b64_tr_b16 a[96:97], v21 offset:0
v_mfma_f32_16x16x32_bf16 v[64:67], a[72:75], v[160:163], v[64:67]
ds_read_b64_tr_b16 a[98:99], v21 offset:2048
v_mfma_f32_16x16x32_bf16 v[64:67], a[76:79], v[176:179], v[64:67]
ds_read_b64_tr_b16 a[100:101], v21 offset:4096
v_mul_f32 v32, v32, v30
v_mul_f32 v33, v33, v30
v_mfma_f32_16x16x32_bf16 v[68:71], a[72:75], v[164:167], v[68:71]
ds_read_b64_tr_b16 a[102:103], v21 offset:6144
v_mul_f32 v34, v34, v30
v_mul_f32 v35, v35, v30
v_mfma_f32_16x16x32_bf16 v[68:71], a[76:79], v[180:183], v[68:71]
s_waitcnt lgkmcnt(8)
ds_read_b64_tr_b16 a[104:105], v21 offset:8192
v_cvt_pk_bf16_f32 v96, v32, v33
v_mfma_f32_16x16x32_bf16 v[64:67], a[80:83], v[192:195], v[64:67]
ds_read_b64_tr_b16 a[106:107], v21 offset:10240
v_cvt_pk_bf16_f32 v97, v34, v35
v_mul_f32 v40, v40, v30
v_mfma_f32_16x16x32_bf16 v[64:67], a[84:87], v[208:211], v[64:67]
ds_read_b64_tr_b16 a[108:109], v21 offset:12288
v_mul_f32 v41, v41, v30
v_mul_f32 v42, v42, v30
v_mfma_f32_16x16x32_bf16 v[68:71], a[80:83], v[196:199], v[68:71]
ds_read_b64_tr_b16 a[110:111], v21 offset:14336
v_mul_f32 v43, v43, v30
v_cvt_pk_bf16_f32 v98, v40, v41
v_mfma_f32_16x16x32_bf16 v[68:71], a[84:87], v[212:215], v[68:71]
s_waitcnt lgkmcnt(8)
ds_read_b64_tr_b16 a[112:113], v21 offset:16384
v_cvt_pk_bf16_f32 v99, v42, v43
v_mfma_f32_16x16x32_bf16 v[64:67], a[88:91], v[224:227], v[64:67]
ds_read_b64_tr_b16 a[114:115], v21 offset:18432
buffer_store_dwordx4 v[96:99], v2, s[12:15], s44 offen offset:0 sc1
v_mul_f32 v36, v36, v31
v_mfma_f32_16x16x32_bf16 v[64:67], a[92:95], v[240:243], v[64:67]
ds_read_b64_tr_b16 a[116:117], v21 offset:20480
v_mul_f32 v37, v37, v31
v_mul_f32 v38, v38, v31
v_mfma_f32_16x16x32_bf16 v[68:71], a[88:91], v[228:231], v[68:71]
ds_read_b64_tr_b16 a[118:119], v21 offset:22528
v_mul_f32 v39, v39, v31
v_cvt_pk_bf16_f32 v100, v36, v37
v_mfma_f32_16x16x32_bf16 v[68:71], a[92:95], v[244:247], v[68:71]
s_waitcnt lgkmcnt(8)
ds_read_b64_tr_b16 a[120:121], v21 offset:24576
v_cvt_pk_bf16_f32 v101, v38, v39
v_mfma_f32_16x16x32_bf16 v[72:75], a[96:99], v[128:131], 0
ds_read_b64_tr_b16 a[122:123], v21 offset:26624
v_mul_f32 v44, v44, v31
v_mul_f32 v45, v45, v31
v_mfma_f32_16x16x32_bf16 v[72:75], a[100:103], v[144:147], v[72:75]
ds_read_b64_tr_b16 a[124:125], v21 offset:28672
v_mul_f32 v46, v46, v31
v_mul_f32 v47, v47, v31
v_mfma_f32_16x16x32_bf16 v[76:79], a[96:99], v[132:135], 0
ds_read_b64_tr_b16 a[126:127], v21 offset:30720
v_cvt_pk_bf16_f32 v102, v44, v45
v_cvt_pk_bf16_f32 v103, v46, v47
v_mfma_f32_16x16x32_bf16 v[76:79], a[100:103], v[148:151], v[76:79]
s_waitcnt lgkmcnt(8)
ds_read_b64_tr_b16 a[64:65], v22 offset:0
buffer_store_dwordx4 v[100:103], v2, s[12:15], s45 offen offset:0 sc1
v_mfma_f32_16x16x32_bf16 v[72:75], a[104:107], v[160:163], v[72:75]
ds_read_b64_tr_b16 a[66:67], v22 offset:2048
v_mul_f32 v48, v48, v30
v_mul_f32 v49, v49, v30
v_mfma_f32_16x16x32_bf16 v[72:75], a[108:111], v[176:179], v[72:75]
ds_read_b64_tr_b16 a[68:69], v22 offset:4096
v_mul_f32 v50, v50, v30
v_mul_f32 v51, v51, v30
v_mfma_f32_16x16x32_bf16 v[76:79], a[104:107], v[164:167], v[76:79]
ds_read_b64_tr_b16 a[70:71], v22 offset:6144
v_cvt_pk_bf16_f32 v104, v48, v49
v_cvt_pk_bf16_f32 v105, v50, v51
v_mfma_f32_16x16x32_bf16 v[76:79], a[108:111], v[180:183], v[76:79]
s_waitcnt lgkmcnt(8)
ds_read_b64_tr_b16 a[72:73], v22 offset:8192
v_mul_f32 v56, v56, v30
v_mfma_f32_16x16x32_bf16 v[72:75], a[112:115], v[192:195], v[72:75]
ds_read_b64_tr_b16 a[74:75], v22 offset:10240
v_mul_f32 v57, v57, v30
v_mul_f32 v58, v58, v30
v_mfma_f32_16x16x32_bf16 v[72:75], a[116:119], v[208:211], v[72:75]
ds_read_b64_tr_b16 a[76:77], v22 offset:12288
v_mul_f32 v59, v59, v30
v_cvt_pk_bf16_f32 v106, v56, v57
v_mfma_f32_16x16x32_bf16 v[76:79], a[112:115], v[196:199], v[76:79]
ds_read_b64_tr_b16 a[78:79], v22 offset:14336
v_cvt_pk_bf16_f32 v107, v58, v59
buffer_store_dwordx4 v[104:107], v2, s[12:15], s44 offen offset:1024 sc1
v_mfma_f32_16x16x32_bf16 v[76:79], a[116:119], v[212:215], v[76:79]
s_waitcnt lgkmcnt(8)
ds_read_b64_tr_b16 a[80:81], v22 offset:16384
v_mul_f32 v52, v52, v31
v_mfma_f32_16x16x32_bf16 v[72:75], a[120:123], v[224:227], v[72:75]
ds_read_b64_tr_b16 a[82:83], v22 offset:18432
v_mul_f32 v53, v53, v31
v_mul_f32 v54, v54, v31
v_mfma_f32_16x16x32_bf16 v[72:75], a[124:127], v[240:243], v[72:75]
ds_read_b64_tr_b16 a[84:85], v22 offset:20480
v_mul_f32 v55, v55, v31
v_cvt_pk_bf16_f32 v108, v52, v53
v_mfma_f32_16x16x32_bf16 v[76:79], a[120:123], v[228:231], v[76:79]
ds_read_b64_tr_b16 a[86:87], v22 offset:22528
v_cvt_pk_bf16_f32 v109, v54, v55
v_mul_f32 v60, v60, v31
v_mfma_f32_16x16x32_bf16 v[76:79], a[124:127], v[244:247], v[76:79]
s_waitcnt lgkmcnt(8)
ds_read_b64_tr_b16 a[88:89], v22 offset:24576
v_mul_f32 v61, v61, v31
v_mfma_f32_16x16x32_bf16 v[80:83], a[64:67], v[128:131], 0
ds_read_b64_tr_b16 a[90:91], v22 offset:26624
v_mul_f32 v62, v62, v31
v_mul_f32 v63, v63, v31
v_mfma_f32_16x16x32_bf16 v[80:83], a[68:71], v[144:147], v[80:83]
ds_read_b64_tr_b16 a[92:93], v22 offset:28672
v_cvt_pk_bf16_f32 v110, v60, v61
v_cvt_pk_bf16_f32 v111, v62, v63
v_mfma_f32_16x16x32_bf16 v[84:87], a[64:67], v[132:135], 0
ds_read_b64_tr_b16 a[94:95], v22 offset:30720
buffer_store_dwordx4 v[108:111], v2, s[12:15], s45 offen offset:1024 sc1
v_mfma_f32_16x16x32_bf16 v[84:87], a[68:71], v[148:151], v[84:87]
s_waitcnt lgkmcnt(8)
ds_read_b64_tr_b16 a[96:97], v23 offset:0
v_mfma_f32_16x16x32_bf16 v[80:83], a[72:75], v[160:163], v[80:83]
ds_read_b64_tr_b16 a[98:99], v23 offset:2048
v_mfma_f32_16x16x32_bf16 v[80:83], a[76:79], v[176:179], v[80:83]
ds_read_b64_tr_b16 a[100:101], v23 offset:4096
v_mfma_f32_16x16x32_bf16 v[84:87], a[72:75], v[164:167], v[84:87]
ds_read_b64_tr_b16 a[102:103], v23 offset:6144
v_mfma_f32_16x16x32_bf16 v[84:87], a[76:79], v[180:183], v[84:87]
s_waitcnt lgkmcnt(8)
ds_read_b64_tr_b16 a[104:105], v23 offset:8192
v_mfma_f32_16x16x32_bf16 v[80:83], a[80:83], v[192:195], v[80:83]
ds_read_b64_tr_b16 a[106:107], v23 offset:10240
v_mfma_f32_16x16x32_bf16 v[80:83], a[84:87], v[208:211], v[80:83]
ds_read_b64_tr_b16 a[108:109], v23 offset:12288
v_mfma_f32_16x16x32_bf16 v[84:87], a[80:83], v[196:199], v[84:87]
ds_read_b64_tr_b16 a[110:111], v23 offset:14336
v_mfma_f32_16x16x32_bf16 v[84:87], a[84:87], v[212:215], v[84:87]
s_waitcnt lgkmcnt(8)
ds_read_b64_tr_b16 a[112:113], v23 offset:16384
v_mfma_f32_16x16x32_bf16 v[80:83], a[88:91], v[224:227], v[80:83]
ds_read_b64_tr_b16 a[114:115], v23 offset:18432
v_mfma_f32_16x16x32_bf16 v[80:83], a[92:95], v[240:243], v[80:83]
ds_read_b64_tr_b16 a[116:117], v23 offset:20480
v_mfma_f32_16x16x32_bf16 v[84:87], a[88:91], v[228:231], v[84:87]
ds_read_b64_tr_b16 a[118:119], v23 offset:22528
v_mfma_f32_16x16x32_bf16 v[84:87], a[92:95], v[244:247], v[84:87]
s_waitcnt lgkmcnt(8)
ds_read_b64_tr_b16 a[120:121], v23 offset:24576
v_mfma_f32_16x16x32_bf16 v[88:91], a[96:99], v[128:131], 0
ds_read_b64_tr_b16 a[122:123], v23 offset:26624
v_mfma_f32_16x16x32_bf16 v[88:91], a[100:103], v[144:147], v[88:91]
ds_read_b64_tr_b16 a[124:125], v23 offset:28672
v_mfma_f32_16x16x32_bf16 v[92:95], a[96:99], v[132:135], 0
ds_read_b64_tr_b16 a[126:127], v23 offset:30720
v_mfma_f32_16x16x32_bf16 v[92:95], a[100:103], v[148:151], v[92:95]
s_waitcnt lgkmcnt(8)
ds_read_b64_tr_b16 a[64:65], v20 offset:32768
v_mfma_f32_16x16x32_bf16 v[88:91], a[104:107], v[160:163], v[88:91]
ds_read_b64_tr_b16 a[66:67], v20 offset:34816
v_mfma_f32_16x16x32_bf16 v[88:91], a[108:111], v[176:179], v[88:91]
ds_read_b64_tr_b16 a[68:69], v20 offset:36864
v_mfma_f32_16x16x32_bf16 v[92:95], a[104:107], v[164:167], v[92:95]
ds_read_b64_tr_b16 a[70:71], v20 offset:38912
v_mfma_f32_16x16x32_bf16 v[92:95], a[108:111], v[180:183], v[92:95]
s_waitcnt lgkmcnt(8)
ds_read_b64_tr_b16 a[72:73], v20 offset:40960
v_mfma_f32_16x16x32_bf16 v[88:91], a[112:115], v[192:195], v[88:91]
ds_read_b64_tr_b16 a[74:75], v20 offset:43008
v_mfma_f32_16x16x32_bf16 v[88:91], a[116:119], v[208:211], v[88:91]
ds_read_b64_tr_b16 a[76:77], v20 offset:45056
v_mfma_f32_16x16x32_bf16 v[92:95], a[112:115], v[196:199], v[92:95]
ds_read_b64_tr_b16 a[78:79], v20 offset:47104
v_mfma_f32_16x16x32_bf16 v[92:95], a[116:119], v[212:215], v[92:95]
s_waitcnt lgkmcnt(8)
ds_read_b64_tr_b16 a[80:81], v20 offset:49152
v_mfma_f32_16x16x32_bf16 v[88:91], a[120:123], v[224:227], v[88:91]
ds_read_b64_tr_b16 a[82:83], v20 offset:51200
v_mfma_f32_16x16x32_bf16 v[88:91], a[124:127], v[240:243], v[88:91]
ds_read_b64_tr_b16 a[84:85], v20 offset:53248
v_mfma_f32_16x16x32_bf16 v[92:95], a[120:123], v[228:231], v[92:95]
ds_read_b64_tr_b16 a[86:87], v20 offset:55296
v_mfma_f32_16x16x32_bf16 v[92:95], a[124:127], v[244:247], v[92:95]
s_mov_b32 m0, 20480
s_mov_b32 s42, 35669632
buffer_load_dwordx4 v2, s[12:15], s42 offen offset:1024 sc1 lds
buffer_load_dwordx4 v2, s[12:15], s42 offen offset:2048 sc1 lds
v_and_b32 v27, 15, v1
v_and_b32 v28, 48, v1
v_mul_u32_u24 v29, 896, v27
v_add_u32 v24, v29, v28
v_accvgpr_read_b32 v168, a200
v_accvgpr_read_b32 v169, a201
v_accvgpr_read_b32 v170, a202
v_accvgpr_read_b32 v171, a203
v_accvgpr_read_b32 v172, a204
v_accvgpr_read_b32 v173, a205
v_accvgpr_read_b32 v174, a206
v_accvgpr_read_b32 v175, a207
v_accvgpr_read_b32 v184, a208
v_accvgpr_read_b32 v185, a209
v_accvgpr_read_b32 v186, a210
v_accvgpr_read_b32 v187, a211
v_accvgpr_read_b32 v188, a212
v_accvgpr_read_b32 v189, a213
v_accvgpr_read_b32 v190, a214
v_accvgpr_read_b32 v191, a215
v_accvgpr_read_b32 v200, a216
v_accvgpr_read_b32 v201, a217
v_accvgpr_read_b32 v202, a218
v_accvgpr_read_b32 v203, a219
s_waitcnt vmcnt(20)
s_barrier
s_waitcnt lgkmcnt(8)
ds_read_b64_tr_b16 a[88:89], v20 offset:57344
v_mfma_f32_16x16x32_bf16 v[32:35], a[64:67], v[128:131], 0
ds_read_b64_tr_b16 a[90:91], v20 offset:59392
v_mfma_f32_16x16x32_bf16 v[32:35], a[68:71], v[144:147], v[32:35]
ds_read_b64_tr_b16 a[92:93], v20 offset:61440
s_add_u32 m0, s6, 0
v_mfma_f32_16x16x32_bf16 v[36:39], a[64:67], v[132:135], 0
ds_read_b64_tr_b16 a[94:95], v20 offset:63488
v_mfma_f32_16x16x32_bf16 v[36:39], a[68:71], v[148:151], v[36:39]
s_waitcnt lgkmcnt(8)
ds_read_b64_tr_b16 a[96:97], v21 offset:32768
v_mfma_f32_16x16x32_bf16 v[32:35], a[72:75], v[160:163], v[32:35]
ds_read_b64_tr_b16 a[98:99], v21 offset:34816
v_mfma_f32_16x16x32_bf16 v[32:35], a[76:79], v[176:179], v[32:35]
ds_read_b64_tr_b16 a[100:101], v21 offset:36864
s_add_u32 s60, s63, 0
v_mul_f32 v64, v64, v30
v_mfma_f32_16x16x32_bf16 v[36:39], a[72:75], v[164:167], v[36:39]
ds_read_b64_tr_b16 a[102:103], v21 offset:38912
v_mul_f32 v65, v65, v30
v_mul_f32 v66, v66, v30
v_mfma_f32_16x16x32_bf16 v[36:39], a[76:79], v[180:183], v[36:39]
s_waitcnt lgkmcnt(8)
ds_read_b64_tr_b16 a[104:105], v21 offset:40960
v_mul_f32 v67, v67, v30
v_mfma_f32_16x16x32_bf16 v[32:35], a[80:83], v[192:195], v[32:35]
ds_read_b64_tr_b16 a[106:107], v21 offset:43008
v_cvt_pk_bf16_f32 v96, v64, v65
v_cvt_pk_bf16_f32 v97, v66, v67
v_mfma_f32_16x16x32_bf16 v[32:35], a[84:87], v[208:211], v[32:35]
ds_read_b64_tr_b16 a[108:109], v21 offset:45056
v_mul_f32 v72, v72, v30
v_mul_f32 v73, v73, v30
v_mfma_f32_16x16x32_bf16 v[36:39], a[80:83], v[196:199], v[36:39]
ds_read_b64_tr_b16 a[110:111], v21 offset:47104
buffer_load_dwordx4 v124, s[72:75], s60 offen offset:0 lds
v_mul_f32 v74, v74, v30
v_mfma_f32_16x16x32_bf16 v[36:39], a[84:87], v[212:215], v[36:39]
s_waitcnt lgkmcnt(8)
ds_read_b64_tr_b16 a[112:113], v21 offset:49152
v_mul_f32 v75, v75, v30
v_mfma_f32_16x16x32_bf16 v[32:35], a[88:91], v[224:227], v[32:35]
ds_read_b64_tr_b16 a[114:115], v21 offset:51200
v_cvt_pk_bf16_f32 v98, v72, v73
v_cvt_pk_bf16_f32 v99, v74, v75
v_mfma_f32_16x16x32_bf16 v[32:35], a[92:95], v[240:243], v[32:35]
ds_read_b64_tr_b16 a[116:117], v21 offset:53248
buffer_store_dwordx4 v[96:99], v2, s[12:15], s44 offen offset:2048 sc1
v_mul_f32 v68, v68, v31
v_mfma_f32_16x16x32_bf16 v[36:39], a[88:91], v[228:231], v[36:39]
ds_read_b64_tr_b16 a[118:119], v21 offset:55296
buffer_load_dwordx4 v125, s[72:75], s60 offen offset:1024 lds
v_mul_f32 v69, v69, v31
v_mfma_f32_16x16x32_bf16 v[36:39], a[92:95], v[244:247], v[36:39]
s_waitcnt lgkmcnt(8)
ds_read_b64_tr_b16 a[120:121], v21 offset:57344
v_mul_f32 v70, v70, v31
v_mfma_f32_16x16x32_bf16 v[40:43], a[96:99], v[128:131], 0
ds_read_b64_tr_b16 a[122:123], v21 offset:59392
v_mul_f32 v71, v71, v31
v_cvt_pk_bf16_f32 v100, v68, v69
v_mfma_f32_16x16x32_bf16 v[40:43], a[100:103], v[144:147], v[40:43]
ds_read_b64_tr_b16 a[124:125], v21 offset:61440
v_cvt_pk_bf16_f32 v101, v70, v71
v_mul_f32 v76, v76, v31
v_mfma_f32_16x16x32_bf16 v[44:47], a[96:99], v[132:135], 0
ds_read_b64_tr_b16 a[126:127], v21 offset:63488
v_mul_f32 v77, v77, v31
v_mul_f32 v78, v78, v31
v_mfma_f32_16x16x32_bf16 v[44:47], a[100:103], v[148:151], v[44:47]
s_waitcnt lgkmcnt(8)
ds_read_b64_tr_b16 a[64:65], v22 offset:32768
buffer_load_dwordx4 v126, s[72:75], s60 offen offset:2048 lds
v_mfma_f32_16x16x32_bf16 v[40:43], a[104:107], v[160:163], v[40:43]
ds_read_b64_tr_b16 a[66:67], v22 offset:34816
v_mul_f32 v79, v79, v31
v_cvt_pk_bf16_f32 v102, v76, v77
v_mfma_f32_16x16x32_bf16 v[40:43], a[108:111], v[176:179], v[40:43]
ds_read_b64_tr_b16 a[68:69], v22 offset:36864
v_cvt_pk_bf16_f32 v103, v78, v79
buffer_store_dwordx4 v[100:103], v2, s[12:15], s45 offen offset:2048 sc1
v_mfma_f32_16x16x32_bf16 v[44:47], a[104:107], v[164:167], v[44:47]
ds_read_b64_tr_b16 a[70:71], v22 offset:38912
v_mul_f32 v80, v80, v30
v_mul_f32 v81, v81, v30
v_mfma_f32_16x16x32_bf16 v[44:47], a[108:111], v[180:183], v[44:47]
s_waitcnt lgkmcnt(8)
ds_read_b64_tr_b16 a[72:73], v22 offset:40960
buffer_load_dwordx4 v127, s[72:75], s60 offen offset:3072 lds
v_mfma_f32_16x16x32_bf16 v[40:43], a[112:115], v[192:195], v[40:43]
ds_read_b64_tr_b16 a[74:75], v22 offset:43008
v_mul_f32 v82, v82, v30
v_mul_f32 v83, v83, v30
v_mfma_f32_16x16x32_bf16 v[40:43], a[116:119], v[208:211], v[40:43]
ds_read_b64_tr_b16 a[76:77], v22 offset:45056
v_cvt_pk_bf16_f32 v104, v80, v81
v_cvt_pk_bf16_f32 v105, v82, v83
v_mfma_f32_16x16x32_bf16 v[44:47], a[112:115], v[196:199], v[44:47]
ds_read_b64_tr_b16 a[78:79], v22 offset:47104
v_mul_f32 v88, v88, v30
v_mul_f32 v89, v89, v30
v_mfma_f32_16x16x32_bf16 v[44:47], a[116:119], v[212:215], v[44:47]
s_waitcnt lgkmcnt(8)
ds_read_b64_tr_b16 a[80:81], v22 offset:49152
v_mul_f32 v90, v90, v30
v_mfma_f32_16x16x32_bf16 v[40:43], a[120:123], v[224:227], v[40:43]
ds_read_b64_tr_b16 a[82:83], v22 offset:51200
s_add_u32 m0, s6, 32768
v_mul_f32 v91, v91, v30
v_mfma_f32_16x16x32_bf16 v[40:43], a[124:127], v[240:243], v[40:43]
ds_read_b64_tr_b16 a[84:85], v22 offset:53248
v_cvt_pk_bf16_f32 v106, v88, v89
v_cvt_pk_bf16_f32 v107, v90, v91
v_mfma_f32_16x16x32_bf16 v[44:47], a[120:123], v[228:231], v[44:47]
ds_read_b64_tr_b16 a[86:87], v22 offset:55296
buffer_store_dwordx4 v[104:107], v2, s[12:15], s44 offen offset:3072 sc1
v_mul_f32 v84, v84, v31
v_mfma_f32_16x16x32_bf16 v[44:47], a[124:127], v[244:247], v[44:47]
s_waitcnt lgkmcnt(8)
ds_read_b64_tr_b16 a[88:89], v22 offset:57344
v_mul_f32 v85, v85, v31
v_mfma_f32_16x16x32_bf16 v[48:51], a[64:67], v[128:131], 0
ds_read_b64_tr_b16 a[90:91], v22 offset:59392
s_add_u32 s60, s63, 458752
v_mul_f32 v86, v86, v31
v_mfma_f32_16x16x32_bf16 v[48:51], a[68:71], v[144:147], v[48:51]
ds_read_b64_tr_b16 a[92:93], v22 offset:61440
v_mul_f32 v87, v87, v31
v_cvt_pk_bf16_f32 v108, v84, v85
v_mfma_f32_16x16x32_bf16 v[52:55], a[64:67], v[132:135], 0
ds_read_b64_tr_b16 a[94:95], v22 offset:63488
v_cvt_pk_bf16_f32 v109, v86, v87
v_mul_f32 v92, v92, v31
v_mfma_f32_16x16x32_bf16 v[52:55], a[68:71], v[148:151], v[52:55]
s_waitcnt lgkmcnt(8)
ds_read_b64_tr_b16 a[96:97], v23 offset:32768
v_mul_f32 v93, v93, v31
v_mfma_f32_16x16x32_bf16 v[48:51], a[72:75], v[160:163], v[48:51]
ds_read_b64_tr_b16 a[98:99], v23 offset:34816
v_mul_f32 v94, v94, v31
v_mul_f32 v95, v95, v31
v_mfma_f32_16x16x32_bf16 v[48:51], a[76:79], v[176:179], v[48:51]
ds_read_b64_tr_b16 a[100:101], v23 offset:36864
buffer_load_dwordx4 v124, s[72:75], s60 offen offset:0 lds
v_cvt_pk_bf16_f32 v110, v92, v93
v_mfma_f32_16x16x32_bf16 v[52:55], a[72:75], v[164:167], v[52:55]
ds_read_b64_tr_b16 a[102:103], v23 offset:38912
v_cvt_pk_bf16_f32 v111, v94, v95
buffer_store_dwordx4 v[108:111], v2, s[12:15], s45 offen offset:3072 sc1
v_mfma_f32_16x16x32_bf16 v[52:55], a[76:79], v[180:183], v[52:55]
s_waitcnt lgkmcnt(8)
ds_read_b64_tr_b16 a[104:105], v23 offset:40960
s_add_u32 s44, s44, 4096
v_mfma_f32_16x16x32_bf16 v[48:51], a[80:83], v[192:195], v[48:51]
ds_read_b64_tr_b16 a[106:107], v23 offset:43008
s_add_u32 s45, s45, 4096
v_mfma_f32_16x16x32_bf16 v[48:51], a[84:87], v[208:211], v[48:51]
ds_read_b64_tr_b16 a[108:109], v23 offset:45056
buffer_load_dwordx4 v125, s[72:75], s60 offen offset:1024 lds
v_mfma_f32_16x16x32_bf16 v[52:55], a[80:83], v[196:199], v[52:55]
ds_read_b64_tr_b16 a[110:111], v23 offset:47104
v_accvgpr_read_b32 v204, a220
v_mfma_f32_16x16x32_bf16 v[52:55], a[84:87], v[212:215], v[52:55]
s_waitcnt lgkmcnt(8)
ds_read_b64_tr_b16 a[112:113], v23 offset:49152
v_mfma_f32_16x16x32_bf16 v[48:51], a[88:91], v[224:227], v[48:51]
ds_read_b64_tr_b16 a[114:115], v23 offset:51200
v_accvgpr_read_b32 v205, a221
v_mfma_f32_16x16x32_bf16 v[48:51], a[92:95], v[240:243], v[48:51]
ds_read_b64_tr_b16 a[116:117], v23 offset:53248
v_accvgpr_read_b32 v206, a222
v_mfma_f32_16x16x32_bf16 v[52:55], a[88:91], v[228:231], v[52:55]
ds_read_b64_tr_b16 a[118:119], v23 offset:55296
buffer_load_dwordx4 v126, s[72:75], s60 offen offset:2048 lds
v_mfma_f32_16x16x32_bf16 v[52:55], a[92:95], v[244:247], v[52:55]
s_waitcnt lgkmcnt(8)
ds_read_b64_tr_b16 a[120:121], v23 offset:57344
v_mfma_f32_16x16x32_bf16 v[56:59], a[96:99], v[128:131], 0
ds_read_b64_tr_b16 a[122:123], v23 offset:59392
v_accvgpr_read_b32 v207, a223
v_mfma_f32_16x16x32_bf16 v[56:59], a[100:103], v[144:147], v[56:59]
ds_read_b64_tr_b16 a[124:125], v23 offset:61440
v_accvgpr_read_b32 v216, a224
v_mfma_f32_16x16x32_bf16 v[60:63], a[96:99], v[132:135], 0
ds_read_b64_tr_b16 a[126:127], v23 offset:63488
buffer_load_dwordx4 v127, s[72:75], s60 offen offset:3072 lds
v_mfma_f32_16x16x32_bf16 v[60:63], a[100:103], v[148:151], v[60:63]
s_waitcnt lgkmcnt(8)
ds_read_b64_tr_b16 a[64:65], v8 offset:0
v_mfma_f32_16x16x32_bf16 v[56:59], a[104:107], v[160:163], v[56:59]
ds_read_b64_tr_b16 a[66:67], v8 offset:2048
v_accvgpr_read_b32 v217, a225
v_mfma_f32_16x16x32_bf16 v[56:59], a[108:111], v[176:179], v[56:59]
ds_read_b64_tr_b16 a[68:69], v8 offset:4096
v_accvgpr_read_b32 v218, a226
v_mfma_f32_16x16x32_bf16 v[60:63], a[104:107], v[164:167], v[60:63]
ds_read_b64_tr_b16 a[70:71], v8 offset:6144
v_accvgpr_read_b32 v219, a227
v_mfma_f32_16x16x32_bf16 v[60:63], a[108:111], v[180:183], v[60:63]
s_waitcnt lgkmcnt(8)
ds_read_b64_tr_b16 a[72:73], v8 offset:8192
v_mfma_f32_16x16x32_bf16 v[56:59], a[112:115], v[192:195], v[56:59]
ds_read_b64_tr_b16 a[74:75], v8 offset:10240
v_accvgpr_read_b32 v220, a228
v_mfma_f32_16x16x32_bf16 v[56:59], a[116:119], v[208:211], v[56:59]
ds_read_b64_tr_b16 a[76:77], v8 offset:12288
v_accvgpr_read_b32 v221, a229
v_mfma_f32_16x16x32_bf16 v[60:63], a[112:115], v[196:199], v[60:63]
ds_read_b64_tr_b16 a[78:79], v8 offset:14336
v_accvgpr_read_b32 v222, a230
v_mfma_f32_16x16x32_bf16 v[60:63], a[116:119], v[212:215], v[60:63]
s_waitcnt lgkmcnt(8)
ds_read_b64_tr_b16 a[80:81], v8 offset:16384
v_mfma_f32_16x16x32_bf16 v[56:59], a[120:123], v[224:227], v[56:59]
ds_read_b64_tr_b16 a[82:83], v8 offset:18432
v_accvgpr_read_b32 v223, a231
v_mfma_f32_16x16x32_bf16 v[56:59], a[124:127], v[240:243], v[56:59]
ds_read_b64_tr_b16 a[84:85], v8 offset:20480
v_accvgpr_read_b32 v232, a232
v_mfma_f32_16x16x32_bf16 v[60:63], a[120:123], v[228:231], v[60:63]
ds_read_b64_tr_b16 a[86:87], v8 offset:22528
v_accvgpr_read_b32 v233, a233
v_mfma_f32_16x16x32_bf16 v[60:63], a[124:127], v[244:247], v[60:63]
v_accvgpr_read_b32 v234, a234
v_accvgpr_read_b32 v235, a235
v_accvgpr_read_b32 v236, a236
v_accvgpr_read_b32 v237, a237
v_accvgpr_read_b32 v238, a238
v_accvgpr_read_b32 v239, a239
s_waitcnt vmcnt(20)
s_barrier
s_waitcnt lgkmcnt(8)
ds_read_b64_tr_b16 a[88:89], v8 offset:24576
v_mfma_f32_16x16x32_bf16 v[64:67], a[64:67], v[128:131], 0
ds_read_b64_tr_b16 a[90:91], v8 offset:26624
v_mfma_f32_16x16x32_bf16 v[64:67], a[68:71], v[144:147], v[64:67]
ds_read_b64_tr_b16 a[92:93], v8 offset:28672
s_add_u32 m0, s6, 49152
v_mfma_f32_16x16x32_bf16 v[68:71], a[64:67], v[132:135], 0
ds_read_b64_tr_b16 a[94:95], v8 offset:30720
v_mfma_f32_16x16x32_bf16 v[68:71], a[68:71], v[148:151], v[68:71]
s_waitcnt lgkmcnt(8)
ds_read_b64_tr_b16 a[96:97], v9 offset:0
v_mfma_f32_16x16x32_bf16 v[64:67], a[72:75], v[160:163], v[64:67]
ds_read_b64_tr_b16 a[98:99], v9 offset:2048
v_mfma_f32_16x16x32_bf16 v[64:67], a[76:79], v[176:179], v[64:67]
ds_read_b64_tr_b16 a[100:101], v9 offset:4096
s_add_u32 s60, s63, 688128
v_mul_f32 v32, v32, v30
v_mfma_f32_16x16x32_bf16 v[68:71], a[72:75], v[164:167], v[68:71]
ds_read_b64_tr_b16 a[102:103], v9 offset:6144
v_mul_f32 v33, v33, v30
v_mul_f32 v34, v34, v30
v_mfma_f32_16x16x32_bf16 v[68:71], a[76:79], v[180:183], v[68:71]
s_waitcnt lgkmcnt(8)
ds_read_b64_tr_b16 a[104:105], v9 offset:8192
v_mul_f32 v35, v35, v30
v_mfma_f32_16x16x32_bf16 v[64:67], a[80:83], v[192:195], v[64:67]
ds_read_b64_tr_b16 a[106:107], v9 offset:10240
v_cvt_pk_bf16_f32 v96, v32, v33
v_cvt_pk_bf16_f32 v97, v34, v35
v_mfma_f32_16x16x32_bf16 v[64:67], a[84:87], v[208:211], v[64:67]
ds_read_b64_tr_b16 a[108:109], v9 offset:12288
v_mul_f32 v40, v40, v30
v_mul_f32 v41, v41, v30
v_mfma_f32_16x16x32_bf16 v[68:71], a[80:83], v[196:199], v[68:71]
ds_read_b64_tr_b16 a[110:111], v9 offset:14336
buffer_load_dwordx4 v124, s[72:75], s60 offen offset:0 lds
v_mul_f32 v42, v42, v30
v_mfma_f32_16x16x32_bf16 v[68:71], a[84:87], v[212:215], v[68:71]
s_waitcnt lgkmcnt(8)
ds_read_b64_tr_b16 a[112:113], v9 offset:16384
v_mul_f32 v43, v43, v30
v_mfma_f32_16x16x32_bf16 v[64:67], a[88:91], v[224:227], v[64:67]
ds_read_b64_tr_b16 a[114:115], v9 offset:18432
v_cvt_pk_bf16_f32 v98, v40, v41
v_cvt_pk_bf16_f32 v99, v42, v43
v_mfma_f32_16x16x32_bf16 v[64:67], a[92:95], v[240:243], v[64:67]
ds_read_b64_tr_b16 a[116:117], v9 offset:20480
buffer_store_dwordx4 v[96:99], v2, s[12:15], s44 offen offset:0 sc1
v_mul_f32 v36, v36, v31
v_mfma_f32_16x16x32_bf16 v[68:71], a[88:91], v[228:231], v[68:71]
ds_read_b64_tr_b16 a[118:119], v9 offset:22528
buffer_load_dwordx4 v125, s[72:75], s60 offen offset:1024 lds
v_mul_f32 v37, v37, v31
v_mfma_f32_16x16x32_bf16 v[68:71], a[92:95], v[244:247], v[68:71]
s_waitcnt lgkmcnt(8)
ds_read_b64_tr_b16 a[120:121], v9 offset:24576
v_mul_f32 v38, v38, v31
v_mfma_f32_16x16x32_bf16 v[72:75], a[96:99], v[128:131], 0
ds_read_b64_tr_b16 a[122:123], v9 offset:26624
v_mul_f32 v39, v39, v31
v_cvt_pk_bf16_f32 v100, v36, v37
v_mfma_f32_16x16x32_bf16 v[72:75], a[100:103], v[144:147], v[72:75]
ds_read_b64_tr_b16 a[124:125], v9 offset:28672
v_cvt_pk_bf16_f32 v101, v38, v39
v_mul_f32 v44, v44, v31
v_mfma_f32_16x16x32_bf16 v[76:79], a[96:99], v[132:135], 0
ds_read_b64_tr_b16 a[126:127], v9 offset:30720
v_mul_f32 v45, v45, v31
v_mul_f32 v46, v46, v31
v_mfma_f32_16x16x32_bf16 v[76:79], a[100:103], v[148:151], v[76:79]
s_waitcnt lgkmcnt(8)
ds_read_b64_tr_b16 a[64:65], v10 offset:0
buffer_load_dwordx4 v126, s[72:75], s60 offen offset:2048 lds
v_mfma_f32_16x16x32_bf16 v[72:75], a[104:107], v[160:163], v[72:75]
ds_read_b64_tr_b16 a[66:67], v10 offset:2048
v_mul_f32 v47, v47, v31
v_cvt_pk_bf16_f32 v102, v44, v45
v_mfma_f32_16x16x32_bf16 v[72:75], a[108:111], v[176:179], v[72:75]
ds_read_b64_tr_b16 a[68:69], v10 offset:4096
v_cvt_pk_bf16_f32 v103, v46, v47
buffer_store_dwordx4 v[100:103], v2, s[12:15], s45 offen offset:0 sc1
v_mfma_f32_16x16x32_bf16 v[76:79], a[104:107], v[164:167], v[76:79]
ds_read_b64_tr_b16 a[70:71], v10 offset:6144
v_mul_f32 v48, v48, v30
v_mul_f32 v49, v49, v30
v_mfma_f32_16x16x32_bf16 v[76:79], a[108:111], v[180:183], v[76:79]
s_waitcnt lgkmcnt(8)
ds_read_b64_tr_b16 a[72:73], v10 offset:8192
buffer_load_dwordx4 v127, s[72:75], s60 offen offset:3072 lds
v_mfma_f32_16x16x32_bf16 v[72:75], a[112:115], v[192:195], v[72:75]
ds_read_b64_tr_b16 a[74:75], v10 offset:10240
v_mul_f32 v50, v50, v30
v_mul_f32 v51, v51, v30
v_mfma_f32_16x16x32_bf16 v[72:75], a[116:119], v[208:211], v[72:75]
ds_read_b64_tr_b16 a[76:77], v10 offset:12288
v_cvt_pk_bf16_f32 v104, v48, v49
v_cvt_pk_bf16_f32 v105, v50, v51
v_mfma_f32_16x16x32_bf16 v[76:79], a[112:115], v[196:199], v[76:79]
ds_read_b64_tr_b16 a[78:79], v10 offset:14336
v_mul_f32 v56, v56, v30
v_mul_f32 v57, v57, v30
v_mfma_f32_16x16x32_bf16 v[76:79], a[116:119], v[212:215], v[76:79]
s_waitcnt lgkmcnt(8)
ds_read_b64_tr_b16 a[80:81], v10 offset:16384
v_mul_f32 v58, v58, v30
v_mfma_f32_16x16x32_bf16 v[72:75], a[120:123], v[224:227], v[72:75]
ds_read_b64_tr_b16 a[82:83], v10 offset:18432
s_add_u32 m0, s6, 65536
v_mul_f32 v59, v59, v30
v_mfma_f32_16x16x32_bf16 v[72:75], a[124:127], v[240:243], v[72:75]
ds_read_b64_tr_b16 a[84:85], v10 offset:20480
v_cvt_pk_bf16_f32 v106, v56, v57
v_cvt_pk_bf16_f32 v107, v58, v59
v_mfma_f32_16x16x32_bf16 v[76:79], a[120:123], v[228:231], v[76:79]
ds_read_b64_tr_b16 a[86:87], v10 offset:22528
buffer_store_dwordx4 v[104:107], v2, s[12:15], s44 offen offset:1024 sc1
v_mul_f32 v52, v52, v31
v_mfma_f32_16x16x32_bf16 v[76:79], a[124:127], v[244:247], v[76:79]
s_waitcnt lgkmcnt(8)
ds_read_b64_tr_b16 a[88:89], v10 offset:24576
v_mul_f32 v53, v53, v31
v_mfma_f32_16x16x32_bf16 v[80:83], a[64:67], v[128:131], 0
ds_read_b64_tr_b16 a[90:91], v10 offset:26624
s_add_u32 s60, s63, 917504
v_mul_f32 v54, v54, v31
v_mfma_f32_16x16x32_bf16 v[80:83], a[68:71], v[144:147], v[80:83]
ds_read_b64_tr_b16 a[92:93], v10 offset:28672
v_mul_f32 v55, v55, v31
v_cvt_pk_bf16_f32 v108, v52, v53
v_mfma_f32_16x16x32_bf16 v[84:87], a[64:67], v[132:135], 0
ds_read_b64_tr_b16 a[94:95], v10 offset:30720
v_cvt_pk_bf16_f32 v109, v54, v55
v_mul_f32 v60, v60, v31
v_mfma_f32_16x16x32_bf16 v[84:87], a[68:71], v[148:151], v[84:87]
s_waitcnt lgkmcnt(8)
ds_read_b64_tr_b16 a[96:97], v11 offset:0
v_mul_f32 v61, v61, v31
v_mfma_f32_16x16x32_bf16 v[80:83], a[72:75], v[160:163], v[80:83]
ds_read_b64_tr_b16 a[98:99], v11 offset:2048
v_mul_f32 v62, v62, v31
v_mul_f32 v63, v63, v31
v_mfma_f32_16x16x32_bf16 v[80:83], a[76:79], v[176:179], v[80:83]
ds_read_b64_tr_b16 a[100:101], v11 offset:4096
buffer_load_dwordx4 v124, s[72:75], s60 offen offset:0 lds
v_cvt_pk_bf16_f32 v110, v60, v61
v_mfma_f32_16x16x32_bf16 v[84:87], a[72:75], v[164:167], v[84:87]
ds_read_b64_tr_b16 a[102:103], v11 offset:6144
v_cvt_pk_bf16_f32 v111, v62, v63
buffer_store_dwordx4 v[108:111], v2, s[12:15], s45 offen offset:1024 sc1
v_mfma_f32_16x16x32_bf16 v[84:87], a[76:79], v[180:183], v[84:87]
s_waitcnt lgkmcnt(8)
ds_read_b64_tr_b16 a[104:105], v11 offset:8192
v_and_b32 v29, 1, v1
v_mfma_f32_16x16x32_bf16 v[80:83], a[80:83], v[192:195], v[80:83]
ds_read_b64_tr_b16 a[106:107], v11 offset:10240
v_mul_u32_u24 v29, 896, v29
v_sub_u32 v28, v28, v29
v_mfma_f32_16x16x32_bf16 v[80:83], a[84:87], v[208:211], v[80:83]
ds_read_b64_tr_b16 a[108:109], v11 offset:12288
buffer_load_dwordx4 v125, s[72:75], s60 offen offset:1024 lds
v_add_u32 v28, 22400, v28
v_mfma_f32_16x16x32_bf16 v[84:87], a[80:83], v[196:199], v[84:87]
ds_read_b64_tr_b16 a[110:111], v11 offset:14336
s_waitcnt vmcnt(22)
ds_read_b128 a[192:195], v28 offset:0
v_mfma_f32_16x16x32_bf16 v[84:87], a[84:87], v[212:215], v[84:87]
s_waitcnt lgkmcnt(9)
ds_read_b64_tr_b16 a[112:113], v11 offset:16384
ds_read_b128 a[196:199], v28 offset:64
v_mfma_f32_16x16x32_bf16 v[80:83], a[88:91], v[224:227], v[80:83]
ds_read_b64_tr_b16 a[114:115], v11 offset:18432
ds_read_b128 a[200:203], v28 offset:128
ds_read_b128 a[204:207], v28 offset:192
v_mfma_f32_16x16x32_bf16 v[80:83], a[92:95], v[240:243], v[80:83]
ds_read_b64_tr_b16 a[116:117], v11 offset:20480
ds_read_b128 a[208:211], v28 offset:256
ds_read_b128 a[212:215], v28 offset:320
v_mfma_f32_16x16x32_bf16 v[84:87], a[88:91], v[228:231], v[84:87]
ds_read_b64_tr_b16 a[118:119], v11 offset:22528
buffer_load_dwordx4 v126, s[72:75], s60 offen offset:2048 lds
ds_read_b128 a[216:219], v28 offset:384
v_mfma_f32_16x16x32_bf16 v[84:87], a[92:95], v[244:247], v[84:87]
s_waitcnt lgkmcnt(15)
ds_read_b64_tr_b16 a[120:121], v11 offset:24576
ds_read_b128 a[220:223], v28 offset:448
v_mfma_f32_16x16x32_bf16 v[88:91], a[96:99], v[128:131], 0
ds_read_b64_tr_b16 a[122:123], v11 offset:26624
ds_read_b128 a[224:227], v28 offset:512
ds_read_b128 a[228:231], v28 offset:576
v_mfma_f32_16x16x32_bf16 v[88:91], a[100:103], v[144:147], v[88:91]
ds_read_b64_tr_b16 a[124:125], v11 offset:28672
ds_read_b128 a[232:235], v28 offset:640
ds_read_b128 a[236:239], v28 offset:704
v_mfma_f32_16x16x32_bf16 v[92:95], a[96:99], v[132:135], 0
ds_read_b64_tr_b16 a[126:127], v11 offset:30720
buffer_load_dwordx4 v127, s[72:75], s60 offen offset:3072 lds
ds_read_b128 a[240:243], v28 offset:768
v_mfma_f32_16x16x32_bf16 v[92:95], a[100:103], v[148:151], v[92:95]
s_waitcnt lgkmcnt(15)
ds_read_b64_tr_b16 a[64:65], v8 offset:32768
ds_read_b128 a[244:247], v28 offset:832
v_mfma_f32_16x16x32_bf16 v[88:91], a[104:107], v[160:163], v[88:91]
ds_read_b64_tr_b16 a[66:67], v8 offset:34816
v_lshlrev_b32 v25, 2, v1
v_lshrrev_b32 v26, 5, v1
v_mfma_f32_16x16x32_bf16 v[88:91], a[108:111], v[176:179], v[88:91]
ds_read_b64_tr_b16 a[68:69], v8 offset:36864
v_lshl_or_b32 v25, v26, 30, v25
s_mov_b32 s56, 0
v_mfma_f32_16x16x32_bf16 v[92:95], a[104:107], v[164:167], v[92:95]
ds_read_b64_tr_b16 a[70:71], v8 offset:38912
s_mov_b32 s57, 0
v_mfma_f32_16x16x32_bf16 v[92:95], a[108:111], v[180:183], v[92:95]
s_waitcnt lgkmcnt(15)
ds_read_b64_tr_b16 a[72:73], v8 offset:40960
v_mfma_f32_16x16x32_bf16 v[88:91], a[112:115], v[192:195], v[88:91]
ds_read_b64_tr_b16 a[74:75], v8 offset:43008
v_mfma_f32_16x16x32_bf16 v[88:91], a[116:119], v[208:211], v[88:91]
ds_read_b64_tr_b16 a[76:77], v8 offset:45056
v_mfma_f32_16x16x32_bf16 v[92:95], a[112:115], v[196:199], v[92:95]
ds_read_b64_tr_b16 a[78:79], v8 offset:47104
v_mfma_f32_16x16x32_bf16 v[92:95], a[116:119], v[212:215], v[92:95]
s_waitcnt lgkmcnt(10)
ds_read_b64_tr_b16 a[80:81], v8 offset:49152
v_mfma_f32_16x16x32_bf16 v[88:91], a[120:123], v[224:227], v[88:91]
ds_read_b64_tr_b16 a[82:83], v8 offset:51200
v_mfma_f32_16x16x32_bf16 v[88:91], a[124:127], v[240:243], v[88:91]
ds_read_b64_tr_b16 a[84:85], v8 offset:53248
v_mfma_f32_16x16x32_bf16 v[92:95], a[120:123], v[228:231], v[92:95]
ds_read_b64_tr_b16 a[86:87], v8 offset:55296
v_mfma_f32_16x16x32_bf16 v[92:95], a[124:127], v[244:247], v[92:95]
s_barrier
s_waitcnt lgkmcnt(8)
ds_read_b64_tr_b16 a[88:89], v8 offset:57344
v_mfma_f32_16x16x32_bf16 v[32:35], a[64:67], v[128:131], 0
ds_read_b64_tr_b16 a[90:91], v8 offset:59392
v_mfma_f32_16x16x32_bf16 v[32:35], a[68:71], v[144:147], v[32:35]
ds_read_b64_tr_b16 a[92:93], v8 offset:61440
s_add_u32 m0, s6, 81920
v_mfma_f32_16x16x32_bf16 v[36:39], a[64:67], v[132:135], 0
ds_read_b64_tr_b16 a[94:95], v8 offset:63488
v_mfma_f32_16x16x32_bf16 v[36:39], a[68:71], v[148:151], v[36:39]
s_waitcnt lgkmcnt(8)
ds_read_b64_tr_b16 a[96:97], v9 offset:32768
v_mfma_f32_16x16x32_bf16 v[32:35], a[72:75], v[160:163], v[32:35]
ds_read_b64_tr_b16 a[98:99], v9 offset:34816
v_mfma_f32_16x16x32_bf16 v[32:35], a[76:79], v[176:179], v[32:35]
ds_read_b64_tr_b16 a[100:101], v9 offset:36864
v_mul_f32 v64, v64, v30
v_mul_f32 v65, v65, v30
v_mfma_f32_16x16x32_bf16 v[36:39], a[72:75], v[164:167], v[36:39]
ds_read_b64_tr_b16 a[102:103], v9 offset:38912
v_mul_f32 v66, v66, v30
v_mul_f32 v67, v67, v30
v_mfma_f32_16x16x32_bf16 v[36:39], a[76:79], v[180:183], v[36:39]
s_waitcnt lgkmcnt(8)
ds_read_b64_tr_b16 a[104:105], v9 offset:40960
v_cvt_pk_bf16_f32 v96, v64, v65
v_mfma_f32_16x16x32_bf16 v[32:35], a[80:83], v[192:195], v[32:35]
ds_read_b64_tr_b16 a[106:107], v9 offset:43008
v_cvt_pk_bf16_f32 v97, v66, v67
v_mul_f32 v72, v72, v30
v_mfma_f32_16x16x32_bf16 v[32:35], a[84:87], v[208:211], v[32:35]
ds_read_b64_tr_b16 a[108:109], v9 offset:45056
v_mul_f32 v73, v73, v30
v_mul_f32 v74, v74, v30
v_mfma_f32_16x16x32_bf16 v[36:39], a[80:83], v[196:199], v[36:39]
ds_read_b64_tr_b16 a[110:111], v9 offset:47104
s_add_u32 s60, s63, 1146880
v_mul_f32 v75, v75, v30
v_mfma_f32_16x16x32_bf16 v[36:39], a[84:87], v[212:215], v[36:39]
s_waitcnt lgkmcnt(8)
ds_read_b64_tr_b16 a[112:113], v9 offset:49152
v_cvt_pk_bf16_f32 v98, v72, v73
v_mfma_f32_16x16x32_bf16 v[32:35], a[88:91], v[224:227], v[32:35]
ds_read_b64_tr_b16 a[114:115], v9 offset:51200
v_cvt_pk_bf16_f32 v99, v74, v75
buffer_store_dwordx4 v[96:99], v2, s[12:15], s44 offen offset:2048 sc1
v_mfma_f32_16x16x32_bf16 v[32:35], a[92:95], v[240:243], v[32:35]
ds_read_b64_tr_b16 a[116:117], v9 offset:53248
v_mul_f32 v68, v68, v31
v_mul_f32 v69, v69, v31
v_mfma_f32_16x16x32_bf16 v[36:39], a[88:91], v[228:231], v[36:39]
ds_read_b64_tr_b16 a[118:119], v9 offset:55296
v_mul_f32 v70, v70, v31
v_mul_f32 v71, v71, v31
v_mfma_f32_16x16x32_bf16 v[36:39], a[92:95], v[244:247], v[36:39]
s_waitcnt lgkmcnt(8)
ds_read_b64_tr_b16 a[120:121], v9 offset:57344
v_cvt_pk_bf16_f32 v100, v68, v69
v_mfma_f32_16x16x32_bf16 v[40:43], a[96:99], v[128:131], 0
ds_read_b64_tr_b16 a[122:123], v9 offset:59392
v_cvt_pk_bf16_f32 v101, v70, v71
v_mul_f32 v76, v76, v31
v_mfma_f32_16x16x32_bf16 v[40:43], a[100:103], v[144:147], v[40:43]
ds_read_b64_tr_b16 a[124:125], v9 offset:61440
v_mul_f32 v77, v77, v31
v_mul_f32 v78, v78, v31
v_mfma_f32_16x16x32_bf16 v[44:47], a[96:99], v[132:135], 0
ds_read_b64_tr_b16 a[126:127], v9 offset:63488
v_mul_f32 v79, v79, v31
v_cvt_pk_bf16_f32 v102, v76, v77
v_mfma_f32_16x16x32_bf16 v[44:47], a[100:103], v[148:151], v[44:47]
s_waitcnt lgkmcnt(8)
ds_read_b64_tr_b16 a[64:65], v10 offset:32768
buffer_load_dwordx4 v124, s[72:75], s60 offen offset:0 lds
v_mfma_f32_16x16x32_bf16 v[40:43], a[104:107], v[160:163], v[40:43]
ds_read_b64_tr_b16 a[66:67], v10 offset:34816
v_cvt_pk_bf16_f32 v103, v78, v79
buffer_store_dwordx4 v[100:103], v2, s[12:15], s45 offen offset:2048 sc1
v_mfma_f32_16x16x32_bf16 v[40:43], a[108:111], v[176:179], v[40:43]
ds_read_b64_tr_b16 a[68:69], v10 offset:36864
v_mul_f32 v80, v80, v30
v_mul_f32 v81, v81, v30
v_mfma_f32_16x16x32_bf16 v[44:47], a[104:107], v[164:167], v[44:47]
ds_read_b64_tr_b16 a[70:71], v10 offset:38912
v_mul_f32 v82, v82, v30
v_mul_f32 v83, v83, v30
v_mfma_f32_16x16x32_bf16 v[44:47], a[108:111], v[180:183], v[44:47]
s_waitcnt lgkmcnt(8)
ds_read_b64_tr_b16 a[72:73], v10 offset:40960
v_cvt_pk_bf16_f32 v104, v80, v81
v_mfma_f32_16x16x32_bf16 v[40:43], a[112:115], v[192:195], v[40:43]
ds_read_b64_tr_b16 a[74:75], v10 offset:43008
v_cvt_pk_bf16_f32 v105, v82, v83
v_mul_f32 v88, v88, v30
v_mfma_f32_16x16x32_bf16 v[40:43], a[116:119], v[208:211], v[40:43]
ds_read_b64_tr_b16 a[76:77], v10 offset:45056
v_mul_f32 v89, v89, v30
v_mul_f32 v90, v90, v30
v_mfma_f32_16x16x32_bf16 v[44:47], a[112:115], v[196:199], v[44:47]
ds_read_b64_tr_b16 a[78:79], v10 offset:47104
v_mul_f32 v91, v91, v30
v_cvt_pk_bf16_f32 v106, v88, v89
v_mfma_f32_16x16x32_bf16 v[44:47], a[116:119], v[212:215], v[44:47]
s_waitcnt lgkmcnt(8)
ds_read_b64_tr_b16 a[80:81], v10 offset:49152
v_cvt_pk_bf16_f32 v107, v90, v91
v_mfma_f32_16x16x32_bf16 v[40:43], a[120:123], v[224:227], v[40:43]
ds_read_b64_tr_b16 a[82:83], v10 offset:51200
buffer_load_dwordx4 v125, s[72:75], s60 offen offset:1024 lds
buffer_store_dwordx4 v[104:107], v2, s[12:15], s44 offen offset:3072 sc1
v_mfma_f32_16x16x32_bf16 v[40:43], a[124:127], v[240:243], v[40:43]
ds_read_b64_tr_b16 a[84:85], v10 offset:53248
v_mul_f32 v84, v84, v31
v_mul_f32 v85, v85, v31
v_mfma_f32_16x16x32_bf16 v[44:47], a[120:123], v[228:231], v[44:47]
ds_read_b64_tr_b16 a[86:87], v10 offset:55296
v_mul_f32 v86, v86, v31
v_mul_f32 v87, v87, v31
v_mfma_f32_16x16x32_bf16 v[44:47], a[124:127], v[244:247], v[44:47]
s_waitcnt lgkmcnt(8)
ds_read_b64_tr_b16 a[88:89], v10 offset:57344
v_cvt_pk_bf16_f32 v108, v84, v85
v_mfma_f32_16x16x32_bf16 v[48:51], a[64:67], v[128:131], 0
ds_read_b64_tr_b16 a[90:91], v10 offset:59392
v_cvt_pk_bf16_f32 v109, v86, v87
v_mul_f32 v92, v92, v31
v_mfma_f32_16x16x32_bf16 v[48:51], a[68:71], v[144:147], v[48:51]
ds_read_b64_tr_b16 a[92:93], v10 offset:61440
v_mul_f32 v93, v93, v31
v_mul_f32 v94, v94, v31
v_mfma_f32_16x16x32_bf16 v[52:55], a[64:67], v[132:135], 0
ds_read_b64_tr_b16 a[94:95], v10 offset:63488
v_mul_f32 v95, v95, v31
v_cvt_pk_bf16_f32 v110, v92, v93
v_mfma_f32_16x16x32_bf16 v[52:55], a[68:71], v[148:151], v[52:55]
s_waitcnt lgkmcnt(8)
ds_read_b64_tr_b16 a[96:97], v11 offset:32768
v_cvt_pk_bf16_f32 v111, v94, v95
v_mfma_f32_16x16x32_bf16 v[48:51], a[72:75], v[160:163], v[48:51]
ds_read_b64_tr_b16 a[98:99], v11 offset:34816
buffer_store_dwordx4 v[108:111], v2, s[12:15], s45 offen offset:3072 sc1
s_add_u32 s44, s44, 4096
v_mfma_f32_16x16x32_bf16 v[48:51], a[76:79], v[176:179], v[48:51]
ds_read_b64_tr_b16 a[100:101], v11 offset:36864
buffer_load_dwordx4 v126, s[72:75], s60 offen offset:2048 lds
s_add_u32 s45, s45, 4096
v_mfma_f32_16x16x32_bf16 v[52:55], a[72:75], v[164:167], v[52:55]
ds_read_b64_tr_b16 a[102:103], v11 offset:38912
v_mfma_f32_16x16x32_bf16 v[52:55], a[76:79], v[180:183], v[52:55]
s_waitcnt lgkmcnt(8)
ds_read_b64_tr_b16 a[104:105], v11 offset:40960
v_mul_f32 v32, v32, v30
v_mfma_f32_16x16x32_bf16 v[48:51], a[80:83], v[192:195], v[48:51]
ds_read_b64_tr_b16 a[106:107], v11 offset:43008
v_mul_f32 v33, v33, v30
v_mul_f32 v34, v34, v30
v_mfma_f32_16x16x32_bf16 v[48:51], a[84:87], v[208:211], v[48:51]
ds_read_b64_tr_b16 a[108:109], v11 offset:45056
v_mul_f32 v35, v35, v30
v_cvt_pk_bf16_f32 v96, v32, v33
v_mfma_f32_16x16x32_bf16 v[52:55], a[80:83], v[196:199], v[52:55]
ds_read_b64_tr_b16 a[110:111], v11 offset:47104
v_cvt_pk_bf16_f32 v97, v34, v35
v_mul_f32 v40, v40, v30
v_mfma_f32_16x16x32_bf16 v[52:55], a[84:87], v[212:215], v[52:55]
s_waitcnt lgkmcnt(8)
ds_read_b64_tr_b16 a[112:113], v11 offset:49152
v_mul_f32 v41, v41, v30
v_mfma_f32_16x16x32_bf16 v[48:51], a[88:91], v[224:227], v[48:51]
ds_read_b64_tr_b16 a[114:115], v11 offset:51200
v_mul_f32 v42, v42, v30
v_mul_f32 v43, v43, v30
v_mfma_f32_16x16x32_bf16 v[48:51], a[92:95], v[240:243], v[48:51]
ds_read_b64_tr_b16 a[116:117], v11 offset:53248
v_cvt_pk_bf16_f32 v98, v40, v41
v_cvt_pk_bf16_f32 v99, v42, v43
v_mfma_f32_16x16x32_bf16 v[52:55], a[88:91], v[228:231], v[52:55]
ds_read_b64_tr_b16 a[118:119], v11 offset:55296
buffer_load_dwordx4 v127, s[72:75], s60 offen offset:3072 lds
buffer_store_dwordx4 v[96:99], v2, s[12:15], s44 offen offset:0 sc1
v_mfma_f32_16x16x32_bf16 v[52:55], a[92:95], v[244:247], v[52:55]
s_waitcnt lgkmcnt(8)
ds_read_b64_tr_b16 a[120:121], v11 offset:57344
v_mul_f32 v36, v36, v31
v_mfma_f32_16x16x32_bf16 v[56:59], a[96:99], v[128:131], 0
ds_read_b64_tr_b16 a[122:123], v11 offset:59392
v_mul_f32 v37, v37, v31
v_mul_f32 v38, v38, v31
v_mfma_f32_16x16x32_bf16 v[56:59], a[100:103], v[144:147], v[56:59]
ds_read_b64_tr_b16 a[124:125], v11 offset:61440
v_mul_f32 v39, v39, v31
v_cvt_pk_bf16_f32 v100, v36, v37
v_mfma_f32_16x16x32_bf16 v[60:63], a[96:99], v[132:135], 0
ds_read_b64_tr_b16 a[126:127], v11 offset:63488
v_cvt_pk_bf16_f32 v101, v38, v39
v_mul_f32 v44, v44, v31
v_mfma_f32_16x16x32_bf16 v[60:63], a[100:103], v[148:151], v[60:63]
s_waitcnt lgkmcnt(8)
v_mul_f32 v45, v45, v31
v_mul_f32 v46, v46, v31
v_mfma_f32_16x16x32_bf16 v[56:59], a[104:107], v[160:163], v[56:59]
v_mul_f32 v47, v47, v31
v_cvt_pk_bf16_f32 v102, v44, v45
v_cvt_pk_bf16_f32 v103, v46, v47
v_mfma_f32_16x16x32_bf16 v[56:59], a[108:111], v[176:179], v[56:59]
buffer_store_dwordx4 v[100:103], v2, s[12:15], s45 offen offset:0 sc1
v_mfma_f32_16x16x32_bf16 v[60:63], a[104:107], v[164:167], v[60:63]
v_cmp_eq_u32 vcc, 0, v121
s_nop 1
v_cndmask_b32 v112, 0, v120, vcc
v_mfma_f32_16x16x32_bf16 v[60:63], a[108:111], v[180:183], v[60:63]
s_waitcnt lgkmcnt(4)
v_mfma_f32_16x16x32_bf16 v[56:59], a[112:115], v[192:195], v[56:59]
v_cmp_eq_u32 vcc, 1, v121
s_nop 1
v_cndmask_b32 v113, 0, v120, vcc
v_mfma_f32_16x16x32_bf16 v[56:59], a[116:119], v[208:211], v[56:59]
v_cmp_eq_u32 vcc, 2, v121
s_nop 1
v_cndmask_b32 v114, 0, v120, vcc
v_mfma_f32_16x16x32_bf16 v[60:63], a[112:115], v[196:199], v[60:63]
v_cmp_eq_u32 vcc, 3, v121
s_nop 1
v_cndmask_b32 v115, 0, v120, vcc
v_mfma_f32_16x16x32_bf16 v[60:63], a[116:119], v[212:215], v[60:63]
s_waitcnt lgkmcnt(0)
v_mfma_f32_16x16x32_bf16 v[56:59], a[120:123], v[224:227], v[56:59]
v_cmp_eq_u32 vcc, 4, v121
s_nop 1
v_cndmask_b32 v116, 0, v120, vcc
v_mfma_f32_16x16x32_bf16 v[56:59], a[124:127], v[240:243], v[56:59]
v_cmp_eq_u32 vcc, 5, v121
s_nop 1
v_cndmask_b32 v117, 0, v120, vcc
v_mfma_f32_16x16x32_bf16 v[60:63], a[120:123], v[228:231], v[60:63]
v_cmp_eq_u32 vcc, 6, v121
s_nop 1
v_cndmask_b32 v118, 0, v120, vcc
v_mfma_f32_16x16x32_bf16 v[60:63], a[124:127], v[244:247], v[60:63]
v_cmp_eq_u32 vcc, 7, v121
s_nop 1
v_cndmask_b32 v119, 0, v120, vcc
v_mul_f32 v48, v48, v30
v_mul_f32 v49, v49, v30
v_mul_f32 v50, v50, v30
v_mul_f32 v51, v51, v30
v_cvt_pk_bf16_f32 v104, v48, v49
v_cvt_pk_bf16_f32 v105, v50, v51
v_mul_f32 v56, v56, v30
v_mul_f32 v57, v57, v30
v_mul_f32 v58, v58, v30
v_mul_f32 v59, v59, v30
v_cvt_pk_bf16_f32 v106, v56, v57
v_cvt_pk_bf16_f32 v107, v58, v59
buffer_store_dwordx4 v[104:107], v2, s[12:15], s44 offen offset:1024 sc1
v_mul_f32 v52, v52, v31
v_mul_f32 v53, v53, v31
v_mul_f32 v54, v54, v31
v_mul_f32 v55, v55, v31
v_cvt_pk_bf16_f32 v108, v52, v53
v_cvt_pk_bf16_f32 v109, v54, v55
v_mul_f32 v60, v60, v31
v_mul_f32 v61, v61, v31
v_mul_f32 v62, v62, v31
v_mul_f32 v63, v63, v31
v_cvt_pk_bf16_f32 v110, v60, v61
v_cvt_pk_bf16_f32 v111, v62, v63
buffer_store_dwordx4 v[108:111], v2, s[12:15], s45 offen offset:1024 sc1
v_lshlrev_b32 v62, 6, v7
v_mov_b32 v60, v25
v_mov_b32 v57, v24
s_waitcnt lgkmcnt(0)
s_barrier
s_cmp_ge_u32 s26, 14
s_cbranch_scc1 tl_prep
s_mov_b32 s74, 1605632
s_mov_b32 s75, 0x00020000
s_sub_u32 s60, s77, s78
v_add_u32 v20, s60, v20
v_add_u32 v21, s60, v21
v_add_u32 v22, s60, v22
v_add_u32 v23, s60, v23
v_mov_b32 v63, 0
buffer_atomic_or v63, v62, s[12:15], s54 offen sc0 sc1
s_mov_b32 s16, s70
s_mov_b32 s17, s71
s_mov_b32 s18, 1605632
s_mov_b32 s19, 0x00020000
s_mul_i32 s76, s24, 401408
s_lshl_b32 s60, s29, 7
s_add_u32 s76, s76, s60
s_lshl_b32 s58, s24, 13
s_add_u32 s58, s58, 118784
s_sub_u32 s60, s58, s77
v_add_u32 v12, s60, v20
v_add_u32 v13, s60, v21
v_add_u32 v14, s60, v22
v_add_u32 v15, s60, v23
v_lshlrev_b32 v144, 16, v168
v_and_b32 v145, 0xffff0000, v168
v_lshlrev_b32 v146, 16, v169
v_and_b32 v147, 0xffff0000, v169
v_lshlrev_b32 v148, 16, v170
v_and_b32 v149, 0xffff0000, v170
v_lshlrev_b32 v150, 16, v171
v_and_b32 v151, 0xffff0000, v171
v_lshlrev_b32 v152, 16, v172
v_and_b32 v153, 0xffff0000, v172
v_lshlrev_b32 v154, 16, v173
v_and_b32 v155, 0xffff0000, v173
v_lshlrev_b32 v156, 16, v174
v_and_b32 v157, 0xffff0000, v174
v_lshlrev_b32 v158, 16, v175
v_and_b32 v159, 0xffff0000, v175
v_and_b32 v56, 15, v1
v_lshlrev_b32 v56, 3, v56
s_lshl_b32 s46, s29, 14
s_lshl_b32 s47, s38, 7
s_add_u32 s46, s46, s47
s_add_u32 s46, s46, 65011712
v_mov_b32 v61, s53
s_waitcnt vmcnt(1)
buffer_atomic_or v61, v62, s[12:15], s52 offen sc1
s_lshr_b32 s52, s38, 1
s_lshl_b32 s52, s52, 7
s_add_u32 s52, s52, 36835328
s_lshl_b32 s53, s29, 1
s_and_b32 s60, s24, 1
s_add_u32 s53, s53, s60
s_lshl_b32 s53, 1, s53
s_waitcnt vmcnt(1)
v_readfirstlane_b32 vcc_lo, v63
s_nop 0
s_mov_b32 s57, vcc_lo
s_mov_b32 s56, s57
s_bitcmp1_b32 s57, 0
s_cbranch_scc0 tl_e0
s_add_u32 s60, s43, 0
buffer_load_dwordx4 a[0:3], v2, s[12:15], s60 offen offset:0 sc1
buffer_load_dwordx4 a[4:7], v2, s[12:15], s60 offen offset:1024 sc1
tl_e0:
s_bitcmp1_b32 s57, 1
s_cbranch_scc0 tl_e1
s_add_u32 s60, s43, 14336
buffer_load_dwordx4 a[8:11], v2, s[12:15], s60 offen offset:0 sc1
buffer_load_dwordx4 a[12:15], v2, s[12:15], s60 offen offset:1024 sc1
tl_e1:
s_bitcmp1_b32 s57, 2
s_cbranch_scc0 tl_e2
s_add_u32 s60, s43, 28672
buffer_load_dwordx4 a[16:19], v2, s[12:15], s60 offen offset:0 sc1
buffer_load_dwordx4 a[20:23], v2, s[12:15], s60 offen offset:1024 sc1
tl_e2:
s_bitcmp1_b32 s57, 3
s_cbranch_scc0 tl_e3
s_add_u32 s60, s43, 43008
buffer_load_dwordx4 a[24:27], v2, s[12:15], s60 offen offset:0 sc1
buffer_load_dwordx4 a[28:31], v2, s[12:15], s60 offen offset:1024 sc1
tl_e3:
s_bitcmp1_b32 s57, 4
s_cbranch_scc0 tl_e4
s_add_u32 s60, s43, 57344
buffer_load_dwordx4 a[32:35], v2, s[12:15], s60 offen offset:0 sc1
buffer_load_dwordx4 a[36:39], v2, s[12:15], s60 offen offset:1024 sc1
tl_e4:
s_bitcmp1_b32 s57, 5
s_cbranch_scc0 tl_e5
s_add_u32 s60, s43, 71680
buffer_load_dwordx4 a[40:43], v2, s[12:15], s60 offen offset:0 sc1
buffer_load_dwordx4 a[44:47], v2, s[12:15], s60 offen offset:1024 sc1
tl_e5:
s_bitcmp1_b32 s57, 6
s_cbranch_scc0 tl_e6
s_add_u32 s60, s43, 86016
buffer_load_dwordx4 a[48:51], v2, s[12:15], s60 offen offset:0 sc1
buffer_load_dwordx4 a[52:55], v2, s[12:15], s60 offen offset:1024 sc1
tl_e6:
s_bitcmp1_b32 s57, 7
s_cbranch_scc0 tl_e7
s_add_u32 s60, s43, 100352
buffer_load_dwordx4 a[56:59], v2, s[12:15], s60 offen offset:0 sc1
buffer_load_dwordx4 a[60:63], v2, s[12:15], s60 offen offset:1024 sc1
tl_e7:
s_bitcmp1_b32 s57, 8
s_cbranch_scc0 tl_e8
s_add_u32 s60, s43, 114688
buffer_load_dwordx4 a[128:131], v2, s[12:15], s60 offen offset:0 sc1
buffer_load_dwordx4 a[132:135], v2, s[12:15], s60 offen offset:1024 sc1
tl_e8:
s_bitcmp1_b32 s57, 9
s_cbranch_scc0 tl_e9
s_add_u32 s60, s43, 129024
buffer_load_dwordx4 a[136:139], v2, s[12:15], s60 offen offset:0 sc1
buffer_load_dwordx4 a[140:143], v2, s[12:15], s60 offen offset:1024 sc1
tl_e9:
s_bitcmp1_b32 s57, 10
s_cbranch_scc0 tl_e10
s_add_u32 s60, s43, 143360
buffer_load_dwordx4 a[144:147], v2, s[12:15], s60 offen offset:0 sc1
buffer_load_dwordx4 a[148:151], v2, s[12:15], s60 offen offset:1024 sc1
tl_e10:
s_bitcmp1_b32 s57, 11
s_cbranch_scc0 tl_e11
s_add_u32 s60, s43, 157696
buffer_load_dwordx4 a[152:155], v2, s[12:15], s60 offen offset:0 sc1
buffer_load_dwordx4 a[156:159], v2, s[12:15], s60 offen offset:1024 sc1
tl_e11:
s_bitcmp1_b32 s57, 12
s_cbranch_scc0 tl_e12
s_add_u32 s60, s43, 172032
buffer_load_dwordx4 a[160:163], v2, s[12:15], s60 offen offset:0 sc1
buffer_load_dwordx4 a[164:167], v2, s[12:15], s60 offen offset:1024 sc1
tl_e12:
s_bitcmp1_b32 s57, 13
s_cbranch_scc0 tl_e13
s_add_u32 s60, s43, 186368
buffer_load_dwordx4 a[168:171], v2, s[12:15], s60 offen offset:0 sc1
buffer_load_dwordx4 a[172:175], v2, s[12:15], s60 offen offset:1024 sc1
tl_e13:
s_bitcmp1_b32 s57, 14
s_cbranch_scc0 tl_e14
s_add_u32 s60, s43, 200704
buffer_load_dwordx4 a[176:179], v2, s[12:15], s60 offen offset:0 sc1
buffer_load_dwordx4 a[180:183], v2, s[12:15], s60 offen offset:1024 sc1
tl_e14:
s_bitcmp1_b32 s57, 15
s_cbranch_scc0 tl_e15
s_add_u32 s60, s43, 215040
buffer_load_dwordx4 a[184:187], v2, s[12:15], s60 offen offset:0 sc1
buffer_load_dwordx4 a[188:191], v2, s[12:15], s60 offen offset:1024 sc1
tl_e15:
s_mov_b32 s61, 0x200000
s_cmp_eq_u32 s56, s55
s_cbranch_scc1 tl_y2
tl_y:
v_mov_b32 v63, 0
buffer_atomic_or v63, v62, s[12:15], s54 offen sc0 sc1
s_waitcnt vmcnt(0)
v_readfirstlane_b32 vcc_lo, v63
s_sub_u32 s61, s61, 1
s_cmp_eq_u32 s61, 0
s_cselect_b32 s57, s55, vcc_lo
s_andn2_b32 s57, s57, s56
s_cbranch_scc1 tl_y1
s_sleep 1
s_branch tl_y
tl_y1:
s_or_b32 s56, s56, s57
s_bitcmp1_b32 s57, 0
s_cbranch_scc0 tl_z0
s_add_u32 s60, s43, 0
buffer_load_dwordx4 a[0:3], v2, s[12:15], s60 offen offset:0 sc1
buffer_load_dwordx4 a[4:7], v2, s[12:15], s60 offen offset:1024 sc1
tl_z0:
s_bitcmp1_b32 s57, 1
s_cbranch_scc0 tl_z1
s_add_u32 s60, s43, 14336
buffer_load_dwordx4 a[8:11], v2, s[12:15], s60 offen offset:0 sc1
buffer_load_dwordx4 a[12:15], v2, s[12:15], s60 offen offset:1024 sc1
tl_z1:
s_bitcmp1_b32 s57, 2
s_cbranch_scc0 tl_z2
s_add_u32 s60, s43, 28672
buffer_load_dwordx4 a[16:19], v2, s[12:15], s60 offen offset:0 sc1
buffer_load_dwordx4 a[20:23], v2, s[12:15], s60 offen offset:1024 sc1
tl_z2:
s_bitcmp1_b32 s57, 3
s_cbranch_scc0 tl_z3
s_add_u32 s60, s43, 43008
buffer_load_dwordx4 a[24:27], v2, s[12:15], s60 offen offset:0 sc1
buffer_load_dwordx4 a[28:31], v2, s[12:15], s60 offen offset:1024 sc1
tl_z3:
s_bitcmp1_b32 s57, 4
s_cbranch_scc0 tl_z4
s_add_u32 s60, s43, 57344
buffer_load_dwordx4 a[32:35], v2, s[12:15], s60 offen offset:0 sc1
buffer_load_dwordx4 a[36:39], v2, s[12:15], s60 offen offset:1024 sc1
tl_z4:
s_bitcmp1_b32 s57, 5
s_cbranch_scc0 tl_z5
s_add_u32 s60, s43, 71680
buffer_load_dwordx4 a[40:43], v2, s[12:15], s60 offen offset:0 sc1
buffer_load_dwordx4 a[44:47], v2, s[12:15], s60 offen offset:1024 sc1
tl_z5:
s_bitcmp1_b32 s57, 6
s_cbranch_scc0 tl_z6
s_add_u32 s60, s43, 86016
buffer_load_dwordx4 a[48:51], v2, s[12:15], s60 offen offset:0 sc1
buffer_load_dwordx4 a[52:55], v2, s[12:15], s60 offen offset:1024 sc1
tl_z6:
s_bitcmp1_b32 s57, 7
s_cbranch_scc0 tl_z7
s_add_u32 s60, s43, 100352
buffer_load_dwordx4 a[56:59], v2, s[12:15], s60 offen offset:0 sc1
buffer_load_dwordx4 a[60:63], v2, s[12:15], s60 offen offset:1024 sc1
tl_z7:
s_bitcmp1_b32 s57, 8
s_cbranch_scc0 tl_z8
s_add_u32 s60, s43, 114688
buffer_load_dwordx4 a[128:131], v2, s[12:15], s60 offen offset:0 sc1
buffer_load_dwordx4 a[132:135], v2, s[12:15], s60 offen offset:1024 sc1
tl_z8:
s_bitcmp1_b32 s57, 9
s_cbranch_scc0 tl_z9
s_add_u32 s60, s43, 129024
buffer_load_dwordx4 a[136:139], v2, s[12:15], s60 offen offset:0 sc1
buffer_load_dwordx4 a[140:143], v2, s[12:15], s60 offen offset:1024 sc1
tl_z9:
s_bitcmp1_b32 s57, 10
s_cbranch_scc0 tl_z10
s_add_u32 s60, s43, 143360
buffer_load_dwordx4 a[144:147], v2, s[12:15], s60 offen offset:0 sc1
buffer_load_dwordx4 a[148:151], v2, s[12:15], s60 offen offset:1024 sc1
tl_z10:
s_bitcmp1_b32 s57, 11
s_cbranch_scc0 tl_z11
s_add_u32 s60, s43, 157696
buffer_load_dwordx4 a[152:155], v2, s[12:15], s60 offen offset:0 sc1
buffer_load_dwordx4 a[156:159], v2, s[12:15], s60 offen offset:1024 sc1
tl_z11:
s_bitcmp1_b32 s57, 12
s_cbranch_scc0 tl_z12
s_add_u32 s60, s43, 172032
buffer_load_dwordx4 a[160:163], v2, s[12:15], s60 offen offset:0 sc1
buffer_load_dwordx4 a[164:167], v2, s[12:15], s60 offen offset:1024 sc1
tl_z12:
s_bitcmp1_b32 s57, 13
s_cbranch_scc0 tl_z13
s_add_u32 s60, s43, 186368
buffer_load_dwordx4 a[168:171], v2, s[12:15], s60 offen offset:0 sc1
buffer_load_dwordx4 a[172:175], v2, s[12:15], s60 offen offset:1024 sc1
tl_z13:
s_bitcmp1_b32 s57, 14
s_cbranch_scc0 tl_z14
s_add_u32 s60, s43, 200704
buffer_load_dwordx4 a[176:179], v2, s[12:15], s60 offen offset:0 sc1
buffer_load_dwordx4 a[180:183], v2, s[12:15], s60 offen offset:1024 sc1
tl_z14:
s_bitcmp1_b32 s57, 15
s_cbranch_scc0 tl_z15
s_add_u32 s60, s43, 215040
buffer_load_dwordx4 a[184:187], v2, s[12:15], s60 offen offset:0 sc1
buffer_load_dwordx4 a[188:191], v2, s[12:15], s60 offen offset:1024 sc1
tl_z15:
s_cmp_eq_u32 s56, s55
s_cbranch_scc0 tl_y
tl_y2:
s_add_u32 m0, s6, 16384
s_add_u32 s60, s63, 229376
buffer_load_dwordx4 v124, s[72:75], s60 offen offset:0 lds
buffer_load_dwordx4 v125, s[72:75], s60 offen offset:1024 lds
buffer_load_dwordx4 v126, s[72:75], s60 offen offset:2048 lds
buffer_load_dwordx4 v127, s[72:75], s60 offen offset:3072 lds
s_add_u32 m0, s6, 98304
s_add_u32 s60, s63, 1376256
buffer_load_dwordx4 v124, s[72:75], s60 offen offset:0 lds
buffer_load_dwordx4 v125, s[72:75], s60 offen offset:1024 lds
buffer_load_dwordx4 v126, s[72:75], s60 offen offset:2048 lds
buffer_load_dwordx4 v127, s[72:75], s60 offen offset:3072 lds
s_add_u32 m0, s58, 0
s_nop 0
buffer_load_dwordx4 v16, s[16:19], s76 offen offset:0 lds
buffer_load_dwordx4 v17, s[16:19], s76 offen offset:1024 lds
buffer_load_dwordx4 v18, s[16:19], s76 offen offset:2048 lds
buffer_load_dwordx4 v19, s[16:19], s76 offen offset:3072 lds
s_add_u32 s76, s76, 28672
s_add_u32 m0, s58, 4096
s_nop 0
buffer_load_dwordx4 v16, s[16:19], s76 offen offset:0 lds
buffer_load_dwordx4 v17, s[16:19], s76 offen offset:1024 lds
buffer_load_dwordx4 v18, s[16:19], s76 offen offset:2048 lds
buffer_load_dwordx4 v19, s[16:19], s76 offen offset:3072 lds
s_add_u32 s76, s76, 28672
s_waitcnt vmcnt(16)
v_mfma_f32_16x16x32_bf16 v[128:131], v[112:115], a[0:3], 0
v_mfma_f32_16x16x32_bf16 v[132:135], v[116:119], a[0:3], 0
v_mfma_f32_16x16x32_bf16 v[136:139], v[112:115], a[4:7], 0
v_mfma_f32_16x16x32_bf16 v[140:143], v[116:119], a[4:7], 0
v_mfma_f32_16x16x32_bf16 v[128:131], v[112:115], a[8:11], v[128:131]
v_mfma_f32_16x16x32_bf16 v[132:135], v[116:119], a[8:11], v[132:135]
v_mfma_f32_16x16x32_bf16 v[136:139], v[112:115], a[12:15], v[136:139]
v_mfma_f32_16x16x32_bf16 v[140:143], v[116:119], a[12:15], v[140:143]
v_mfma_f32_16x16x32_bf16 v[128:131], v[112:115], a[16:19], v[128:131]
v_mfma_f32_16x16x32_bf16 v[132:135], v[116:119], a[16:19], v[132:135]
v_mfma_f32_16x16x32_bf16 v[136:139], v[112:115], a[20:23], v[136:139]
v_mfma_f32_16x16x32_bf16 v[140:143], v[116:119], a[20:23], v[140:143]
v_mfma_f32_16x16x32_bf16 v[128:131], v[112:115], a[24:27], v[128:131]
v_mfma_f32_16x16x32_bf16 v[132:135], v[116:119], a[24:27], v[132:135]
v_mfma_f32_16x16x32_bf16 v[136:139], v[112:115], a[28:31], v[136:139]
v_mfma_f32_16x16x32_bf16 v[140:143], v[116:119], a[28:31], v[140:143]
v_mfma_f32_16x16x32_bf16 v[128:131], v[112:115], a[32:35], v[128:131]
v_mfma_f32_16x16x32_bf16 v[132:135], v[116:119], a[32:35], v[132:135]
v_mfma_f32_16x16x32_bf16 v[136:139], v[112:115], a[36:39], v[136:139]
v_mfma_f32_16x16x32_bf16 v[140:143], v[116:119], a[36:39], v[140:143]
v_mfma_f32_16x16x32_bf16 v[128:131], v[112:115], a[40:43], v[128:131]
v_mfma_f32_16x16x32_bf16 v[132:135], v[116:119], a[40:43], v[132:135]
v_mfma_f32_16x16x32_bf16 v[136:139], v[112:115], a[44:47], v[136:139]
v_mfma_f32_16x16x32_bf16 v[140:143], v[116:119], a[44:47], v[140:143]
v_mfma_f32_16x16x32_bf16 v[128:131], v[112:115], a[48:51], v[128:131]
v_mfma_f32_16x16x32_bf16 v[132:135], v[116:119], a[48:51], v[132:135]
v_mfma_f32_16x16x32_bf16 v[136:139], v[112:115], a[52:55], v[136:139]
v_mfma_f32_16x16x32_bf16 v[140:143], v[116:119], a[52:55], v[140:143]
v_mfma_f32_16x16x32_bf16 v[128:131], v[112:115], a[56:59], v[128:131]
v_mfma_f32_16x16x32_bf16 v[132:135], v[116:119], a[56:59], v[132:135]
v_mfma_f32_16x16x32_bf16 v[136:139], v[112:115], a[60:63], v[136:139]
v_mfma_f32_16x16x32_bf16 v[140:143], v[116:119], a[60:63], v[140:143]
v_mfma_f32_16x16x32_bf16 v[128:131], v[112:115], a[128:131], v[128:131]
v_mfma_f32_16x16x32_bf16 v[132:135], v[116:119], a[128:131], v[132:135]
v_mfma_f32_16x16x32_bf16 v[136:139], v[112:115], a[132:135], v[136:139]
v_mfma_f32_16x16x32_bf16 v[140:143], v[116:119], a[132:135], v[140:143]
v_mfma_f32_16x16x32_bf16 v[128:131], v[112:115], a[136:139], v[128:131]
v_mfma_f32_16x16x32_bf16 v[132:135], v[116:119], a[136:139], v[132:135]
v_mfma_f32_16x16x32_bf16 v[136:139], v[112:115], a[140:143], v[136:139]
v_mfma_f32_16x16x32_bf16 v[140:143], v[116:119], a[140:143], v[140:143]
v_mfma_f32_16x16x32_bf16 v[128:131], v[112:115], a[144:147], v[128:131]
v_mfma_f32_16x16x32_bf16 v[132:135], v[116:119], a[144:147], v[132:135]
v_mfma_f32_16x16x32_bf16 v[136:139], v[112:115], a[148:151], v[136:139]
v_mfma_f32_16x16x32_bf16 v[140:143], v[116:119], a[148:151], v[140:143]
v_mfma_f32_16x16x32_bf16 v[128:131], v[112:115], a[152:155], v[128:131]
v_mfma_f32_16x16x32_bf16 v[132:135], v[116:119], a[152:155], v[132:135]
v_mfma_f32_16x16x32_bf16 v[136:139], v[112:115], a[156:159], v[136:139]
v_mfma_f32_16x16x32_bf16 v[140:143], v[116:119], a[156:159], v[140:143]
v_mfma_f32_16x16x32_bf16 v[128:131], v[112:115], a[160:163], v[128:131]
v_mfma_f32_16x16x32_bf16 v[132:135], v[116:119], a[160:163], v[132:135]
v_mfma_f32_16x16x32_bf16 v[136:139], v[112:115], a[164:167], v[136:139]
v_mfma_f32_16x16x32_bf16 v[140:143], v[116:119], a[164:167], v[140:143]
v_mfma_f32_16x16x32_bf16 v[128:131], v[112:115], a[168:171], v[128:131]
v_mfma_f32_16x16x32_bf16 v[132:135], v[116:119], a[168:171], v[132:135]
v_mfma_f32_16x16x32_bf16 v[136:139], v[112:115], a[172:175], v[136:139]
v_mfma_f32_16x16x32_bf16 v[140:143], v[116:119], a[172:175], v[140:143]
v_mfma_f32_16x16x32_bf16 v[128:131], v[112:115], a[176:179], v[128:131]
v_mfma_f32_16x16x32_bf16 v[132:135], v[116:119], a[176:179], v[132:135]
v_mfma_f32_16x16x32_bf16 v[136:139], v[112:115], a[180:183], v[136:139]
v_mfma_f32_16x16x32_bf16 v[140:143], v[116:119], a[180:183], v[140:143]
v_mfma_f32_16x16x32_bf16 v[128:131], v[112:115], a[184:187], v[128:131]
v_mfma_f32_16x16x32_bf16 v[132:135], v[116:119], a[184:187], v[132:135]
v_mfma_f32_16x16x32_bf16 v[136:139], v[112:115], a[188:191], v[136:139]
v_mfma_f32_16x16x32_bf16 v[140:143], v[116:119], a[188:191], v[140:143]
s_nop 4
v_fmac_f32 v144, v128, v184
v_fmac_f32 v145, v129, v185
v_fmac_f32 v146, v130, v186
v_fmac_f32 v147, v131, v187
v_fmac_f32 v148, v132, v188
v_fmac_f32 v149, v133, v189
v_fmac_f32 v150, v134, v190
v_fmac_f32 v151, v135, v191
v_fmac_f32 v152, v136, v200
v_fmac_f32 v153, v137, v201
v_fmac_f32 v154, v138, v202
v_fmac_f32 v155, v139, v203
v_fmac_f32 v156, v140, v204
v_fmac_f32 v157, v141, v205
v_fmac_f32 v158, v142, v206
v_fmac_f32 v159, v143, v207
v_cvt_pk_bf16_f32 v64, v144, v145
v_cvt_pk_bf16_f32 v65, v146, v147
v_cvt_pk_bf16_f32 v66, v148, v149
v_cvt_pk_bf16_f32 v67, v150, v151
v_cvt_pk_bf16_f32 v68, v152, v153
v_cvt_pk_bf16_f32 v69, v154, v155
v_cvt_pk_bf16_f32 v70, v156, v157
v_cvt_pk_bf16_f32 v71, v158, v159
v_lshlrev_b32 v128, 16, v64
v_and_b32 v129, 0xffff0000, v64
v_lshlrev_b32 v130, 16, v65
v_and_b32 v131, 0xffff0000, v65
v_lshlrev_b32 v132, 16, v66
v_and_b32 v133, 0xffff0000, v66
v_lshlrev_b32 v134, 16, v67
v_and_b32 v135, 0xffff0000, v67
v_lshlrev_b32 v136, 16, v68
v_and_b32 v137, 0xffff0000, v68
v_lshlrev_b32 v138, 16, v69
v_and_b32 v139, 0xffff0000, v69
v_lshlrev_b32 v140, 16, v70
v_and_b32 v141, 0xffff0000, v70
v_lshlrev_b32 v142, 16, v71
v_and_b32 v143, 0xffff0000, v71
v_pk_mul_f32 v[216:217], v[216:217], v[128:129]
v_pk_mul_f32 v[218:219], v[218:219], v[130:131]
v_pk_mul_f32 v[220:221], v[220:221], v[132:133]
v_pk_mul_f32 v[222:223], v[222:223], v[134:135]
v_pk_mul_f32 v[232:233], v[232:233], v[136:137]
v_pk_mul_f32 v[234:235], v[234:235], v[138:139]
v_pk_mul_f32 v[236:237], v[236:237], v[140:141]
v_pk_mul_f32 v[238:239], v[238:239], v[142:143]
v_cvt_pk_bf16_f32 v88, v216, v217
v_cvt_pk_bf16_f32 v89, v218, v219
v_cvt_pk_bf16_f32 v90, v220, v221
v_cvt_pk_bf16_f32 v91, v222, v223
v_cvt_pk_bf16_f32 v92, v232, v233
v_cvt_pk_bf16_f32 v93, v234, v235
v_cvt_pk_bf16_f32 v94, v236, v237
v_cvt_pk_bf16_f32 v95, v238, v239
buffer_store_dwordx4 v[88:91], v2, s[12:15], s40 offen offset:0 sc1
buffer_store_dwordx4 v[92:95], v2, s[12:15], s40 offen offset:1024 sc1
v_add_f32 v52, v128, v129
v_add_f32 v53, v130, v131
v_add_f32 v52, v52, v132
v_add_f32 v53, v53, v133
v_add_f32 v52, v52, v134
v_add_f32 v53, v53, v135
v_add_f32 v52, v52, v136
v_add_f32 v53, v53, v137
v_add_f32 v52, v52, v138
v_add_f32 v53, v53, v139
v_add_f32 v52, v52, v140
v_add_f32 v53, v53, v141
v_add_f32 v52, v52, v142
v_add_f32 v53, v53, v143
v_add_f32 v52, v52, v53
v_mov_b32 v54, v52
s_nop 1
v_permlane16_swap_b32 v52, v54
v_add_f32 v52, v52, v54
v_mov_b32 v54, v52
s_nop 1
v_permlane32_swap_b32 v52, v54
v_add_f32 v52, v52, v54
v_mul_f32 v54, 0x3c800000, v52
v_sub_f32 v128, v128, v54
v_sub_f32 v129, v129, v54
v_sub_f32 v130, v130, v54
v_sub_f32 v131, v131, v54
v_sub_f32 v132, v132, v54
v_sub_f32 v133, v133, v54
v_sub_f32 v134, v134, v54
v_sub_f32 v135, v135, v54
v_sub_f32 v136, v136, v54
v_sub_f32 v137, v137, v54
v_sub_f32 v138, v138, v54
v_sub_f32 v139, v139, v54
v_sub_f32 v140, v140, v54
v_sub_f32 v141, v141, v54
v_sub_f32 v142, v142, v54
v_sub_f32 v143, v143, v54
v_mul_f32 v53, v128, v128
v_mul_f32 v55, v129, v129
v_fmac_f32 v53, v130, v130
v_fmac_f32 v55, v131, v131
v_fmac_f32 v53, v132, v132
v_fmac_f32 v55, v133, v133
v_fmac_f32 v53, v134, v134
v_fmac_f32 v55, v135, v135
v_fmac_f32 v53, v136, v136
v_fmac_f32 v55, v137, v137
v_fmac_f32 v53, v138, v138
v_fmac_f32 v55, v139, v139
v_fmac_f32 v53, v140, v140
v_fmac_f32 v55, v141, v141
v_fmac_f32 v53, v142, v142
v_fmac_f32 v55, v143, v143
v_add_f32 v53, v53, v55
v_mov_b32 v54, v53
s_nop 1
v_permlane16_swap_b32 v53, v54
v_add_f32 v53, v53, v54
v_mov_b32 v54, v53
s_nop 1
v_permlane32_swap_b32 v53, v54
v_add_f32 v53, v53, v54
s_mov_b64 exec, 0xffff
buffer_store_dwordx2 v[52:53], v56, s[12:15], s46 offen sc1
s_mov_b64 exec, -1
v_accvgpr_write_b32 a248, v64
v_accvgpr_write_b32 a249, v65
v_accvgpr_write_b32 a250, v66
v_accvgpr_write_b32 a251, v67
v_accvgpr_write_b32 a252, v68
v_accvgpr_write_b32 a253, v69
v_accvgpr_write_b32 a254, v70
v_accvgpr_write_b32 a255, v71
s_lshl_b32 s38, s27, 3
s_lshl_b32 s60, s24, 1
s_add_u32 s38, s38, s60
s_mul_i32 s33, s38, 14336
s_add_u32 s33, s33, 62914560
s_add_u32 s34, s33, 14336
v_and_b32 v40, 31, v1
v_lshlrev_b32 v40, 3, v40
s_lshl_b32 s35, s38, 7
s_add_u32 s35, s35, 65011712
v_lshrrev_b32 v41, 4, v1
v_lshlrev_b32 v41, 4, v41
v_add_u32 v41, 114688, v41
s_mov_b32 s40, 0x3c800000
s_mov_b32 s41, 0x42800000
s_mov_b32 s42, 0xbfb8aa3b
s_mov_b32 s43, s42
s_mul_i32 s56, s38, 57344
s_lshl_b32 s60, s31, 12
s_add_u32 s56, s56, s60
s_add_u32 s56, s56, 69206016
s_add_u32 s57, s56, 57344
s_load_dwordx2 s[20:21], s[0:1], 88
s_mov_b32 s22, 1835008
s_mov_b32 s23, 0x00020000
s_lshl_b32 s54, s27, 2
s_add_u32 s54, s54, s24
s_lshl_b32 s54, s54, 7
s_add_u32 s54, s54, 36835328
s_mov_b32 s55, 0x3fff
v_lshrrev_b32 v44, 4, v1
v_bfe_u32 v45, v1, 2, 2
v_lshl_add_u32 v46, v44, 3, v45
v_lshlrev_b32 v46, 8, v46
v_and_b32 v47, 3, v1
v_lshl_add_u32 v46, v47, 3, v46
v_and_b32 v44, 1, v44
v_lshl_or_b32 v44, v44, 2, v45
v_lshl_add_u32 v4, v44, 5, v46
v_xor_b32 v5, 32, v4
v_xor_b32 v6, 64, v4
v_xor_b32 v7, 96, v4
v_xor_b32 v8, 128, v4
v_xor_b32 v9, 160, v4
v_xor_b32 v10, 192, v4
v_xor_b32 v11, 224, v4
s_lshl_b32 s60, s24, 6
v_xor_b32 v44, s60, v4
v_xor_b32 v45, 32, v44
v_add_u32 v46, 0x10000, v44
v_add_u32 v47, 0x10000, v45
v_mov_b32 v61, s53
s_waitcnt vmcnt(0)
buffer_atomic_or v61, v62, s[12:15], s52 offen sc1
s_waitcnt lgkmcnt(0)
s_barrier
ds_read_b64_tr_b16 a[0:1], v44 offset:0
ds_read_b64_tr_b16 a[2:3], v44 offset:1024
ds_read_b64_tr_b16 a[4:5], v45 offset:0
ds_read_b64_tr_b16 a[6:7], v45 offset:1024
ds_read_b64_tr_b16 a[8:9], v44 offset:8192
ds_read_b64_tr_b16 a[10:11], v44 offset:9216
ds_read_b64_tr_b16 a[12:13], v45 offset:8192
ds_read_b64_tr_b16 a[14:15], v45 offset:9216
ds_read_b64_tr_b16 a[16:17], v44 offset:16384
ds_read_b64_tr_b16 a[18:19], v44 offset:17408
ds_read_b64_tr_b16 a[20:21], v45 offset:16384
ds_read_b64_tr_b16 a[22:23], v45 offset:17408
ds_read_b64_tr_b16 a[24:25], v44 offset:24576
ds_read_b64_tr_b16 a[26:27], v44 offset:25600
ds_read_b64_tr_b16 a[28:29], v45 offset:24576
ds_read_b64_tr_b16 a[30:31], v45 offset:25600
ds_read_b64_tr_b16 a[32:33], v44 offset:32768
ds_read_b64_tr_b16 a[34:35], v44 offset:33792
ds_read_b64_tr_b16 a[36:37], v45 offset:32768
ds_read_b64_tr_b16 a[38:39], v45 offset:33792
ds_read_b64_tr_b16 a[40:41], v44 offset:40960
ds_read_b64_tr_b16 a[42:43], v44 offset:41984
ds_read_b64_tr_b16 a[44:45], v45 offset:40960
ds_read_b64_tr_b16 a[46:47], v45 offset:41984
ds_read_b64_tr_b16 a[48:49], v44 offset:49152
ds_read_b64_tr_b16 a[50:51], v44 offset:50176
ds_read_b64_tr_b16 a[52:53], v45 offset:49152
ds_read_b64_tr_b16 a[54:55], v45 offset:50176
ds_read_b64_tr_b16 a[56:57], v44 offset:57344
ds_read_b64_tr_b16 a[58:59], v44 offset:58368
ds_read_b64_tr_b16 a[60:61], v45 offset:57344
ds_read_b64_tr_b16 a[62:63], v45 offset:58368
ds_read_b64_tr_b16 a[128:129], v46 offset:0
ds_read_b64_tr_b16 a[130:131], v46 offset:1024
ds_read_b64_tr_b16 a[132:133], v47 offset:0
ds_read_b64_tr_b16 a[134:135], v47 offset:1024
ds_read_b64_tr_b16 a[136:137], v46 offset:8192
ds_read_b64_tr_b16 a[138:139], v46 offset:9216
ds_read_b64_tr_b16 a[140:141], v47 offset:8192
ds_read_b64_tr_b16 a[142:143], v47 offset:9216
ds_read_b64_tr_b16 a[144:145], v46 offset:16384
ds_read_b64_tr_b16 a[146:147], v46 offset:17408
ds_read_b64_tr_b16 a[148:149], v47 offset:16384
ds_read_b64_tr_b16 a[150:151], v47 offset:17408
ds_read_b64_tr_b16 a[152:153], v46 offset:24576
ds_read_b64_tr_b16 a[154:155], v46 offset:25600
ds_read_b64_tr_b16 a[156:157], v47 offset:24576
ds_read_b64_tr_b16 a[158:159], v47 offset:25600
ds_read_b64_tr_b16 a[160:161], v46 offset:32768
ds_read_b64_tr_b16 a[162:163], v46 offset:33792
ds_read_b64_tr_b16 a[164:165], v47 offset:32768
ds_read_b64_tr_b16 a[166:167], v47 offset:33792
ds_read_b64_tr_b16 a[168:169], v46 offset:40960
ds_read_b64_tr_b16 a[170:171], v46 offset:41984
ds_read_b64_tr_b16 a[172:173], v47 offset:40960
ds_read_b64_tr_b16 a[174:175], v47 offset:41984
s_waitcnt lgkmcnt(15)
v_mov_b32 v63, 0
buffer_atomic_or v63, v62, s[12:15], s54 offen sc0 sc1
v_mfma_f32_16x16x32_bf16 v[64:67], a[0:3], a[192:195], 0
v_mfma_f32_16x16x32_bf16 v[68:71], a[4:7], a[192:195], 0
v_mfma_f32_16x16x32_bf16 v[64:67], a[8:11], a[196:199], v[64:67]
v_mfma_f32_16x16x32_bf16 v[68:71], a[12:15], a[196:199], v[68:71]
v_mfma_f32_16x16x32_bf16 v[64:67], a[16:19], a[200:203], v[64:67]
v_mfma_f32_16x16x32_bf16 v[68:71], a[20:23], a[200:203], v[68:71]
v_mfma_f32_16x16x32_bf16 v[64:67], a[24:27], a[204:207], v[64:67]
v_mfma_f32_16x16x32_bf16 v[68:71], a[28:31], a[204:207], v[68:71]
v_mfma_f32_16x16x32_bf16 v[64:67], a[32:35], a[208:211], v[64:67]
v_mfma_f32_16x16x32_bf16 v[68:71], a[36:39], a[208:211], v[68:71]
v_mfma_f32_16x16x32_bf16 v[64:67], a[40:43], a[212:215], v[64:67]
v_mfma_f32_16x16x32_bf16 v[68:71], a[44:47], a[212:215], v[68:71]
v_mfma_f32_16x16x32_bf16 v[64:67], a[48:51], a[216:219], v[64:67]
v_mfma_f32_16x16x32_bf16 v[68:71], a[52:55], a[216:219], v[68:71]
v_mfma_f32_16x16x32_bf16 v[64:67], a[56:59], a[220:223], v[64:67]
v_mfma_f32_16x16x32_bf16 v[68:71], a[60:63], a[220:223], v[68:71]
v_mfma_f32_16x16x32_bf16 v[64:67], a[128:131], a[224:227], v[64:67]
v_mfma_f32_16x16x32_bf16 v[68:71], a[132:135], a[224:227], v[68:71]
v_mfma_f32_16x16x32_bf16 v[64:67], a[136:139], a[228:231], v[64:67]
v_mfma_f32_16x16x32_bf16 v[68:71], a[140:143], a[228:231], v[68:71]
s_waitcnt lgkmcnt(12)
v_mfma_f32_16x16x32_bf16 v[64:67], a[144:147], a[232:235], v[64:67]
v_mfma_f32_16x16x32_bf16 v[68:71], a[148:151], a[232:235], v[68:71]
s_waitcnt lgkmcnt(8)
v_mfma_f32_16x16x32_bf16 v[64:67], a[152:155], a[236:239], v[64:67]
v_mfma_f32_16x16x32_bf16 v[68:71], a[156:159], a[236:239], v[68:71]
s_waitcnt lgkmcnt(4)
v_mfma_f32_16x16x32_bf16 v[64:67], a[160:163], a[240:243], v[64:67]
v_mfma_f32_16x16x32_bf16 v[68:71], a[164:167], a[240:243], v[68:71]
s_waitcnt lgkmcnt(0)
v_mfma_f32_16x16x32_bf16 v[64:67], a[168:171], a[244:247], v[64:67]
v_mfma_f32_16x16x32_bf16 v[68:71], a[172:175], a[244:247], v[68:71]
v_and_b32 v44, 1, v1
v_lshlrev_b32 v44, 9, v44
s_lshl_b32 s60, s24, 7
v_add3_u32 v44, v44, s60, v41
s_mov_b32 exec_lo, 0x00020002
s_mov_b32 exec_hi, 0x00020002
s_nop 0
v_mul_f32 v64, s42, v64
v_mul_f32 v65, s42, v65
v_mul_f32 v66, s42, v66
v_mul_f32 v67, s42, v67
v_mul_f32 v68, s42, v68
v_mul_f32 v69, s42, v69
v_mul_f32 v70, s42, v70
v_mul_f32 v71, s42, v71
s_mov_b32 exec_lo, 0x00030003
s_mov_b32 exec_hi, 0x00030003
ds_write_b128 v44, v[64:67]
ds_write_b128 v44, v[68:71] offset:64
s_mov_b64 exec, -1
ds_read_b64_tr_b16 a[64:65], v12 offset:0
ds_read_b64_tr_b16 a[66:67], v12 offset:2048
ds_read_b64_tr_b16 a[68:69], v13 offset:0
ds_read_b64_tr_b16 a[70:71], v13 offset:2048
ds_read_b64_tr_b16 a[72:73], v14 offset:0
ds_read_b64_tr_b16 a[74:75], v14 offset:2048
ds_read_b64_tr_b16 a[76:77], v15 offset:0
ds_read_b64_tr_b16 a[78:79], v15 offset:2048
ds_read_b64_tr_b16 a[80:81], v12 offset:4096
ds_read_b64_tr_b16 a[82:83], v12 offset:6144
ds_read_b64_tr_b16 a[84:85], v13 offset:4096
ds_read_b64_tr_b16 a[86:87], v13 offset:6144
ds_read_b64_tr_b16 a[88:89], v14 offset:4096
ds_read_b64_tr_b16 a[90:91], v14 offset:6144
ds_read_b64_tr_b16 a[92:93], v15 offset:4096
ds_read_b64_tr_b16 a[94:95], v15 offset:6144
ds_read_b64_tr_b16 a[0:1], v4 offset:0
ds_read_b64_tr_b16 a[2:3], v4 offset:1024
ds_read_b64_tr_b16 a[4:5], v5 offset:0
ds_read_b64_tr_b16 a[6:7], v5 offset:1024
ds_read_b64_tr_b16 a[8:9], v6 offset:0
ds_read_b64_tr_b16 a[10:11], v6 offset:1024
ds_read_b64_tr_b16 a[12:13], v7 offset:0
ds_read_b64_tr_b16 a[14:15], v7 offset:1024
ds_read_b64_tr_b16 a[16:17], v8 offset:0
ds_read_b64_tr_b16 a[18:19], v8 offset:1024
ds_read_b64_tr_b16 a[20:21], v9 offset:0
ds_read_b64_tr_b16 a[22:23], v9 offset:1024
s_waitcnt vmcnt(0)
v_readfirstlane_b32 vcc_lo, v63
s_nop 0
s_and_b32 s60, vcc_lo, s55
s_cmp_eq_u32 s60, s55
s_cbranch_scc1 tl_x1
s_mov_b32 s61, 0x200000
tl_p0:
v_mov_b32 v63, 0
buffer_atomic_or v63, v62, s[12:15], s54 offen sc0 sc1
s_waitcnt vmcnt(0)
v_readfirstlane_b32 vcc_lo, v63
s_nop 0
s_and_b32 s60, vcc_lo, s55
s_cmp_eq_u32 s60, s55
s_cbranch_scc1 tl_q0
s_sleep 1
s_sub_u32 s61, s61, 1
s_cmp_lg_u32 s61, 0
s_cbranch_scc1 tl_p0
tl_q0:
tl_x1:
buffer_load_dwordx4 v[128:131], v2, s[12:15], s33 offen offset:0 sc1
buffer_load_dwordx4 v[132:135], v2, s[12:15], s34 offen offset:0 sc1
buffer_load_dwordx4 v[136:139], v2, s[12:15], s33 offen offset:1024 sc1
buffer_load_dwordx4 v[140:143], v2, s[12:15], s34 offen offset:1024 sc1
buffer_load_dwordx4 v[144:147], v2, s[12:15], s33 offen offset:2048 sc1
buffer_load_dwordx4 v[148:151], v2, s[12:15], s34 offen offset:2048 sc1
buffer_load_dwordx4 v[152:155], v2, s[12:15], s33 offen offset:3072 sc1
buffer_load_dwordx4 v[156:159], v2, s[12:15], s34 offen offset:3072 sc1
s_add_u32 s33, s33, 4096
s_add_u32 s34, s34, 4096
buffer_load_dwordx4 v[160:163], v2, s[12:15], s33 offen offset:0 sc1
buffer_load_dwordx4 v[164:167], v2, s[12:15], s34 offen offset:0 sc1
s_waitcnt vmcnt(8) lgkmcnt(8)
ds_read_b64_tr_b16 a[24:25], v10 offset:0
v_mfma_f32_16x16x32_bf16 v[64:67], a[0:3], v[128:131], 0
ds_read_b64_tr_b16 a[26:27], v10 offset:1024
v_mfma_f32_16x16x32_bf16 v[68:71], a[0:3], v[132:135], 0
ds_read_b64_tr_b16 a[28:29], v11 offset:0
buffer_load_dwordx4 v[168:171], v2, s[12:15], s33 offen offset:1024 sc1
v_mfma_f32_16x16x32_bf16 v[72:75], a[4:7], v[128:131], 0
ds_read_b64_tr_b16 a[30:31], v11 offset:1024
buffer_load_dwordx4 v[172:175], v2, s[12:15], s34 offen offset:1024 sc1
v_mfma_f32_16x16x32_bf16 v[76:79], a[4:7], v[132:135], 0
s_waitcnt lgkmcnt(8)
ds_read_b64_tr_b16 a[32:33], v4 offset:8192
v_mfma_f32_16x16x32_bf16 v[80:83], a[8:11], v[128:131], 0
ds_read_b64_tr_b16 a[34:35], v4 offset:9216
buffer_load_dwordx2 v[24:25], v40, s[12:15], s35 offen sc1
v_mfma_f32_16x16x32_bf16 v[84:87], a[8:11], v[132:135], 0
ds_read_b64_tr_b16 a[36:37], v5 offset:8192
s_add_u32 s35, s35, 16384
v_mfma_f32_16x16x32_bf16 v[88:91], a[12:15], v[128:131], 0
ds_read_b64_tr_b16 a[38:39], v5 offset:9216
buffer_load_dwordx2 v[26:27], v40, s[12:15], s35 offen sc1
v_mfma_f32_16x16x32_bf16 v[92:95], a[12:15], v[132:135], 0
s_waitcnt lgkmcnt(8)
ds_read_b64_tr_b16 a[40:41], v6 offset:8192
v_mfma_f32_16x16x32_bf16 v[96:99], a[16:19], v[128:131], 0
ds_read_b64_tr_b16 a[42:43], v6 offset:9216
s_add_u32 s35, s35, 16384
v_mfma_f32_16x16x32_bf16 v[100:103], a[16:19], v[132:135], 0
ds_read_b64_tr_b16 a[44:45], v7 offset:8192
buffer_load_dwordx4 v[176:179], v2, s[12:15], s33 offen offset:2048 sc1
v_mfma_f32_16x16x32_bf16 v[104:107], a[20:23], v[128:131], 0
ds_read_b64_tr_b16 a[46:47], v7 offset:9216
buffer_load_dwordx4 v[180:183], v2, s[12:15], s34 offen offset:2048 sc1
v_mfma_f32_16x16x32_bf16 v[108:111], a[20:23], v[132:135], 0
s_waitcnt lgkmcnt(8)
ds_read_b64_tr_b16 a[48:49], v8 offset:8192
v_mfma_f32_16x16x32_bf16 v[112:115], a[24:27], v[128:131], 0
ds_read_b64_tr_b16 a[50:51], v8 offset:9216
buffer_load_dwordx2 v[28:29], v40, s[12:15], s35 offen sc1
v_mfma_f32_16x16x32_bf16 v[116:119], a[24:27], v[132:135], 0
ds_read_b64_tr_b16 a[52:53], v9 offset:8192
s_add_u32 s35, s35, 16384
v_mfma_f32_16x16x32_bf16 v[120:123], a[28:31], v[128:131], 0
ds_read_b64_tr_b16 a[54:55], v9 offset:9216
buffer_load_dwordx2 v[30:31], v40, s[12:15], s35 offen sc1
v_mfma_f32_16x16x32_bf16 v[124:127], a[28:31], v[132:135], 0
s_waitcnt vmcnt(14) lgkmcnt(8)
ds_read_b64_tr_b16 a[56:57], v10 offset:8192
v_mfma_f32_16x16x32_bf16 v[64:67], a[32:35], v[136:139], v[64:67]
ds_read_b64_tr_b16 a[58:59], v10 offset:9216
s_add_u32 s35, s35, 16384
v_mfma_f32_16x16x32_bf16 v[68:71], a[32:35], v[140:143], v[68:71]
ds_read_b64_tr_b16 a[60:61], v11 offset:8192
buffer_load_dwordx4 v[184:187], v2, s[12:15], s33 offen offset:3072 sc1
v_mfma_f32_16x16x32_bf16 v[72:75], a[36:39], v[136:139], v[72:75]
ds_read_b64_tr_b16 a[62:63], v11 offset:9216
buffer_load_dwordx4 v[188:191], v2, s[12:15], s34 offen offset:3072 sc1
v_mfma_f32_16x16x32_bf16 v[76:79], a[36:39], v[140:143], v[76:79]
s_waitcnt lgkmcnt(8)
ds_read_b64_tr_b16 a[0:1], v4 offset:16384
v_mfma_f32_16x16x32_bf16 v[80:83], a[40:43], v[136:139], v[80:83]
ds_read_b64_tr_b16 a[2:3], v4 offset:17408
s_add_u32 s33, s33, 4096
v_mfma_f32_16x16x32_bf16 v[84:87], a[40:43], v[140:143], v[84:87]
ds_read_b64_tr_b16 a[4:5], v5 offset:16384
s_add_u32 s34, s34, 4096
v_mfma_f32_16x16x32_bf16 v[88:91], a[44:47], v[136:139], v[88:91]
ds_read_b64_tr_b16 a[6:7], v5 offset:17408
buffer_load_dwordx2 v[32:33], v40, s[12:15], s35 offen sc1
v_mfma_f32_16x16x32_bf16 v[92:95], a[44:47], v[140:143], v[92:95]
s_waitcnt lgkmcnt(8)
ds_read_b64_tr_b16 a[8:9], v6 offset:16384
v_mfma_f32_16x16x32_bf16 v[96:99], a[48:51], v[136:139], v[96:99]
ds_read_b64_tr_b16 a[10:11], v6 offset:17408
s_add_u32 s35, s35, 16384
v_mfma_f32_16x16x32_bf16 v[100:103], a[48:51], v[140:143], v[100:103]
ds_read_b64_tr_b16 a[12:13], v7 offset:16384
buffer_load_dwordx4 v[192:195], v2, s[12:15], s33 offen offset:0 sc1
v_mfma_f32_16x16x32_bf16 v[104:107], a[52:55], v[136:139], v[104:107]
ds_read_b64_tr_b16 a[14:15], v7 offset:17408
buffer_load_dwordx4 v[196:199], v2, s[12:15], s34 offen offset:0 sc1
v_mfma_f32_16x16x32_bf16 v[108:111], a[52:55], v[140:143], v[108:111]
s_waitcnt lgkmcnt(8)
ds_read_b64_tr_b16 a[16:17], v8 offset:16384
v_mfma_f32_16x16x32_bf16 v[112:115], a[56:59], v[136:139], v[112:115]
ds_read_b64_tr_b16 a[18:19], v8 offset:17408
buffer_load_dwordx2 v[34:35], v40, s[12:15], s35 offen sc1
v_mfma_f32_16x16x32_bf16 v[116:119], a[56:59], v[140:143], v[116:119]
ds_read_b64_tr_b16 a[20:21], v9 offset:16384
s_add_u32 s35, s35, 16384
v_mfma_f32_16x16x32_bf16 v[120:123], a[60:63], v[136:139], v[120:123]
ds_read_b64_tr_b16 a[22:23], v9 offset:17408
buffer_load_dwordx2 v[36:37], v40, s[12:15], s35 offen sc1
v_mfma_f32_16x16x32_bf16 v[124:127], a[60:63], v[140:143], v[124:127]
s_waitcnt vmcnt(19) lgkmcnt(8)
ds_read_b64_tr_b16 a[24:25], v10 offset:16384
v_mfma_f32_16x16x32_bf16 v[64:67], a[0:3], v[144:147], v[64:67]
ds_read_b64_tr_b16 a[26:27], v10 offset:17408
v_mfma_f32_16x16x32_bf16 v[68:71], a[0:3], v[148:151], v[68:71]
ds_read_b64_tr_b16 a[28:29], v11 offset:16384
buffer_load_dwordx4 v[200:203], v2, s[12:15], s33 offen offset:1024 sc1
v_mfma_f32_16x16x32_bf16 v[72:75], a[4:7], v[144:147], v[72:75]
ds_read_b64_tr_b16 a[30:31], v11 offset:17408
buffer_load_dwordx4 v[204:207], v2, s[12:15], s34 offen offset:1024 sc1
v_mfma_f32_16x16x32_bf16 v[76:79], a[4:7], v[148:151], v[76:79]
s_waitcnt lgkmcnt(8)
ds_read_b64_tr_b16 a[32:33], v4 offset:24576
v_mfma_f32_16x16x32_bf16 v[80:83], a[8:11], v[144:147], v[80:83]
ds_read_b64_tr_b16 a[34:35], v4 offset:25600
v_mfma_f32_16x16x32_bf16 v[84:87], a[8:11], v[148:151], v[84:87]
ds_read_b64_tr_b16 a[36:37], v5 offset:24576
v_mfma_f32_16x16x32_bf16 v[88:91], a[12:15], v[144:147], v[88:91]
ds_read_b64_tr_b16 a[38:39], v5 offset:25600
v_mfma_f32_16x16x32_bf16 v[92:95], a[12:15], v[148:151], v[92:95]
s_waitcnt lgkmcnt(8)
ds_read_b64_tr_b16 a[40:41], v6 offset:24576
v_mfma_f32_16x16x32_bf16 v[96:99], a[16:19], v[144:147], v[96:99]
ds_read_b64_tr_b16 a[42:43], v6 offset:25600
v_mfma_f32_16x16x32_bf16 v[100:103], a[16:19], v[148:151], v[100:103]
ds_read_b64_tr_b16 a[44:45], v7 offset:24576
buffer_load_dwordx4 v[208:211], v2, s[12:15], s33 offen offset:2048 sc1
v_mfma_f32_16x16x32_bf16 v[104:107], a[20:23], v[144:147], v[104:107]
ds_read_b64_tr_b16 a[46:47], v7 offset:25600
buffer_load_dwordx4 v[212:215], v2, s[12:15], s34 offen offset:2048 sc1
v_mfma_f32_16x16x32_bf16 v[108:111], a[20:23], v[148:151], v[108:111]
s_waitcnt lgkmcnt(8)
ds_read_b64_tr_b16 a[48:49], v8 offset:24576
v_mfma_f32_16x16x32_bf16 v[112:115], a[24:27], v[144:147], v[112:115]
ds_read_b64_tr_b16 a[50:51], v8 offset:25600
v_mfma_f32_16x16x32_bf16 v[116:119], a[24:27], v[148:151], v[116:119]
ds_read_b64_tr_b16 a[52:53], v9 offset:24576
v_mfma_f32_16x16x32_bf16 v[120:123], a[28:31], v[144:147], v[120:123]
ds_read_b64_tr_b16 a[54:55], v9 offset:25600
v_mfma_f32_16x16x32_bf16 v[124:127], a[28:31], v[148:151], v[124:127]
s_waitcnt vmcnt(21) lgkmcnt(8)
ds_read_b64_tr_b16 a[56:57], v10 offset:24576
v_mfma_f32_16x16x32_bf16 v[64:67], a[32:35], v[152:155], v[64:67]
ds_read_b64_tr_b16 a[58:59], v10 offset:25600
v_mfma_f32_16x16x32_bf16 v[68:71], a[32:35], v[156:159], v[68:71]
ds_read_b64_tr_b16 a[60:61], v11 offset:24576
buffer_load_dwordx4 v[216:219], v2, s[12:15], s33 offen offset:3072 sc1
v_mfma_f32_16x16x32_bf16 v[72:75], a[36:39], v[152:155], v[72:75]
ds_read_b64_tr_b16 a[62:63], v11 offset:25600
buffer_load_dwordx4 v[220:223], v2, s[12:15], s34 offen offset:3072 sc1
v_mfma_f32_16x16x32_bf16 v[76:79], a[36:39], v[156:159], v[76:79]
s_waitcnt lgkmcnt(8)
ds_read_b64_tr_b16 a[0:1], v4 offset:32768
v_mfma_f32_16x16x32_bf16 v[80:83], a[40:43], v[152:155], v[80:83]
ds_read_b64_tr_b16 a[2:3], v4 offset:33792
s_add_u32 s33, s33, 4096
v_mfma_f32_16x16x32_bf16 v[84:87], a[40:43], v[156:159], v[84:87]
ds_read_b64_tr_b16 a[4:5], v5 offset:32768
s_add_u32 s34, s34, 4096
v_mfma_f32_16x16x32_bf16 v[88:91], a[44:47], v[152:155], v[88:91]
ds_read_b64_tr_b16 a[6:7], v5 offset:33792
v_mfma_f32_16x16x32_bf16 v[92:95], a[44:47], v[156:159], v[92:95]
s_waitcnt lgkmcnt(8)
ds_read_b64_tr_b16 a[8:9], v6 offset:32768
v_mfma_f32_16x16x32_bf16 v[96:99], a[48:51], v[152:155], v[96:99]
ds_read_b64_tr_b16 a[10:11], v6 offset:33792
s_waitcnt vmcnt(6)
v_mfma_f32_16x16x32_bf16 v[100:103], a[48:51], v[156:159], v[100:103]
ds_read_b64_tr_b16 a[12:13], v7 offset:32768
buffer_load_dwordx4 v[224:227], v2, s[12:15], s33 offen offset:0 sc1
v_mfma_f32_16x16x32_bf16 v[104:107], a[52:55], v[152:155], v[104:107]
ds_read_b64_tr_b16 a[14:15], v7 offset:33792
buffer_load_dwordx4 v[228:231], v2, s[12:15], s34 offen offset:0 sc1
v_mfma_f32_16x16x32_bf16 v[108:111], a[52:55], v[156:159], v[108:111]
s_waitcnt lgkmcnt(8)
ds_read_b64_tr_b16 a[16:17], v8 offset:32768
v_mfma_f32_16x16x32_bf16 v[112:115], a[56:59], v[152:155], v[112:115]
ds_read_b64_tr_b16 a[18:19], v8 offset:33792
v_add_f32 v44, v24, v26
v_mfma_f32_16x16x32_bf16 v[116:119], a[56:59], v[156:159], v[116:119]
ds_read_b64_tr_b16 a[20:21], v9 offset:32768
v_add_f32 v44, v44, v28
v_mfma_f32_16x16x32_bf16 v[120:123], a[60:63], v[152:155], v[120:123]
ds_read_b64_tr_b16 a[22:23], v9 offset:33792
v_add_f32 v44, v44, v30
v_mfma_f32_16x16x32_bf16 v[124:127], a[60:63], v[156:159], v[124:127]
s_waitcnt lgkmcnt(8)
ds_read_b64_tr_b16 a[24:25], v10 offset:32768
v_mfma_f32_16x16x32_bf16 v[64:67], a[0:3], v[160:163], v[64:67]
ds_read_b64_tr_b16 a[26:27], v10 offset:33792
v_add_f32 v44, v44, v32
v_mfma_f32_16x16x32_bf16 v[68:71], a[0:3], v[164:167], v[68:71]
ds_read_b64_tr_b16 a[28:29], v11 offset:32768
buffer_load_dwordx4 v[232:235], v2, s[12:15], s33 offen offset:1024 sc1
v_mfma_f32_16x16x32_bf16 v[72:75], a[4:7], v[160:163], v[72:75]
ds_read_b64_tr_b16 a[30:31], v11 offset:33792
buffer_load_dwordx4 v[236:239], v2, s[12:15], s34 offen offset:1024 sc1
v_mfma_f32_16x16x32_bf16 v[76:79], a[4:7], v[164:167], v[76:79]
s_waitcnt lgkmcnt(8)
ds_read_b64_tr_b16 a[32:33], v4 offset:40960
v_mfma_f32_16x16x32_bf16 v[80:83], a[8:11], v[160:163], v[80:83]
ds_read_b64_tr_b16 a[34:35], v4 offset:41984
v_add_f32 v44, v44, v34
v_mfma_f32_16x16x32_bf16 v[84:87], a[8:11], v[164:167], v[84:87]
ds_read_b64_tr_b16 a[36:37], v5 offset:40960
v_add_f32 v44, v44, v36
v_mfma_f32_16x16x32_bf16 v[88:91], a[12:15], v[160:163], v[88:91]
ds_read_b64_tr_b16 a[38:39], v5 offset:41984
v_add_f32 v45, v25, v27
v_mfma_f32_16x16x32_bf16 v[92:95], a[12:15], v[164:167], v[92:95]
s_waitcnt lgkmcnt(8)
ds_read_b64_tr_b16 a[40:41], v6 offset:40960
v_mfma_f32_16x16x32_bf16 v[96:99], a[16:19], v[160:163], v[96:99]
ds_read_b64_tr_b16 a[42:43], v6 offset:41984
v_add_f32 v45, v45, v29
v_mfma_f32_16x16x32_bf16 v[100:103], a[16:19], v[164:167], v[100:103]
ds_read_b64_tr_b16 a[44:45], v7 offset:40960
v_add_f32 v45, v45, v31
v_mfma_f32_16x16x32_bf16 v[104:107], a[20:23], v[160:163], v[104:107]
ds_read_b64_tr_b16 a[46:47], v7 offset:41984
v_add_f32 v45, v45, v33
v_mfma_f32_16x16x32_bf16 v[108:111], a[20:23], v[164:167], v[108:111]
s_waitcnt lgkmcnt(8)
ds_read_b64_tr_b16 a[48:49], v8 offset:40960
v_mfma_f32_16x16x32_bf16 v[112:115], a[24:27], v[160:163], v[112:115]
ds_read_b64_tr_b16 a[50:51], v8 offset:41984
v_add_f32 v45, v45, v35
v_mfma_f32_16x16x32_bf16 v[116:119], a[24:27], v[164:167], v[116:119]
ds_read_b64_tr_b16 a[52:53], v9 offset:40960
v_add_f32 v45, v45, v37
v_mfma_f32_16x16x32_bf16 v[120:123], a[28:31], v[160:163], v[120:123]
ds_read_b64_tr_b16 a[54:55], v9 offset:41984
v_mul_f32 v44, 0x3b124925, v44
v_mfma_f32_16x16x32_bf16 v[124:127], a[28:31], v[164:167], v[124:127]
s_waitcnt lgkmcnt(8)
ds_read_b64_tr_b16 a[56:57], v10 offset:40960
v_mfma_f32_16x16x32_bf16 v[64:67], a[32:35], v[168:171], v[64:67]
ds_read_b64_tr_b16 a[58:59], v10 offset:41984
v_mov_b32 v47, 0
v_mfma_f32_16x16x32_bf16 v[68:71], a[32:35], v[172:175], v[68:71]
ds_read_b64_tr_b16 a[60:61], v11 offset:40960
v_fma_f32 v46, v24, s40, -v44
v_mfma_f32_16x16x32_bf16 v[72:75], a[36:39], v[168:171], v[72:75]
ds_read_b64_tr_b16 a[62:63], v11 offset:41984
v_fmac_f32 v47, v46, v46
v_mfma_f32_16x16x32_bf16 v[76:79], a[36:39], v[172:175], v[76:79]
s_waitcnt lgkmcnt(8)
ds_read_b64_tr_b16 a[0:1], v4 offset:49152
v_mfma_f32_16x16x32_bf16 v[80:83], a[40:43], v[168:171], v[80:83]
ds_read_b64_tr_b16 a[2:3], v4 offset:50176
v_fma_f32 v46, v26, s40, -v44
v_mfma_f32_16x16x32_bf16 v[84:87], a[40:43], v[172:175], v[84:87]
ds_read_b64_tr_b16 a[4:5], v5 offset:49152
v_fmac_f32 v47, v46, v46
v_mfma_f32_16x16x32_bf16 v[88:91], a[44:47], v[168:171], v[88:91]
ds_read_b64_tr_b16 a[6:7], v5 offset:50176
v_fma_f32 v46, v28, s40, -v44
v_mfma_f32_16x16x32_bf16 v[92:95], a[44:47], v[172:175], v[92:95]
s_waitcnt lgkmcnt(8)
ds_read_b64_tr_b16 a[8:9], v6 offset:49152
v_mfma_f32_16x16x32_bf16 v[96:99], a[48:51], v[168:171], v[96:99]
ds_read_b64_tr_b16 a[10:11], v6 offset:50176
v_fmac_f32 v47, v46, v46
v_mfma_f32_16x16x32_bf16 v[100:103], a[48:51], v[172:175], v[100:103]
ds_read_b64_tr_b16 a[12:13], v7 offset:49152
v_fma_f32 v46, v30, s40, -v44
v_mfma_f32_16x16x32_bf16 v[104:107], a[52:55], v[168:171], v[104:107]
ds_read_b64_tr_b16 a[14:15], v7 offset:50176
v_fmac_f32 v47, v46, v46
v_mfma_f32_16x16x32_bf16 v[108:111], a[52:55], v[172:175], v[108:111]
s_waitcnt lgkmcnt(8)
ds_read_b64_tr_b16 a[16:17], v8 offset:49152
v_mfma_f32_16x16x32_bf16 v[112:115], a[56:59], v[168:171], v[112:115]
ds_read_b64_tr_b16 a[18:19], v8 offset:50176
v_fma_f32 v46, v32, s40, -v44
v_mfma_f32_16x16x32_bf16 v[116:119], a[56:59], v[172:175], v[116:119]
ds_read_b64_tr_b16 a[20:21], v9 offset:49152
v_fmac_f32 v47, v46, v46
v_mfma_f32_16x16x32_bf16 v[120:123], a[60:63], v[168:171], v[120:123]
ds_read_b64_tr_b16 a[22:23], v9 offset:50176
v_fma_f32 v46, v34, s40, -v44
v_mfma_f32_16x16x32_bf16 v[124:127], a[60:63], v[172:175], v[124:127]
s_waitcnt lgkmcnt(8)
ds_read_b64_tr_b16 a[24:25], v10 offset:49152
v_mfma_f32_16x16x32_bf16 v[64:67], a[0:3], v[176:179], v[64:67]
ds_read_b64_tr_b16 a[26:27], v10 offset:50176
v_fmac_f32 v47, v46, v46
v_mfma_f32_16x16x32_bf16 v[68:71], a[0:3], v[180:183], v[68:71]
ds_read_b64_tr_b16 a[28:29], v11 offset:49152
v_fma_f32 v46, v36, s40, -v44
v_mfma_f32_16x16x32_bf16 v[72:75], a[4:7], v[176:179], v[72:75]
ds_read_b64_tr_b16 a[30:31], v11 offset:50176
v_fmac_f32 v47, v46, v46
v_mfma_f32_16x16x32_bf16 v[76:79], a[4:7], v[180:183], v[76:79]
s_waitcnt lgkmcnt(8)
ds_read_b64_tr_b16 a[32:33], v4 offset:57344
v_mfma_f32_16x16x32_bf16 v[80:83], a[8:11], v[176:179], v[80:83]
ds_read_b64_tr_b16 a[34:35], v4 offset:58368
v_add_u32 v4, 0x10000, v4
v_mfma_f32_16x16x32_bf16 v[84:87], a[8:11], v[180:183], v[84:87]
ds_read_b64_tr_b16 a[36:37], v5 offset:57344
v_fma_f32 v45, v47, s41, v45
v_mfma_f32_16x16x32_bf16 v[88:91], a[12:15], v[176:179], v[88:91]
ds_read_b64_tr_b16 a[38:39], v5 offset:58368
v_add_u32 v5, 0x10000, v5
v_mfma_f32_16x16x32_bf16 v[92:95], a[12:15], v[180:183], v[92:95]
s_waitcnt lgkmcnt(8)
ds_read_b64_tr_b16 a[40:41], v6 offset:57344
v_mfma_f32_16x16x32_bf16 v[96:99], a[16:19], v[176:179], v[96:99]
ds_read_b64_tr_b16 a[42:43], v6 offset:58368
v_add_u32 v6, 0x10000, v6
v_mfma_f32_16x16x32_bf16 v[100:103], a[16:19], v[180:183], v[100:103]
ds_read_b64_tr_b16 a[44:45], v7 offset:57344
v_mul_f32 v45, 0x3b124925, v45
v_mfma_f32_16x16x32_bf16 v[104:107], a[20:23], v[176:179], v[104:107]
ds_read_b64_tr_b16 a[46:47], v7 offset:58368
v_add_u32 v7, 0x10000, v7
v_mfma_f32_16x16x32_bf16 v[108:111], a[20:23], v[180:183], v[108:111]
s_waitcnt lgkmcnt(8)
ds_read_b64_tr_b16 a[48:49], v8 offset:57344
v_mfma_f32_16x16x32_bf16 v[112:115], a[24:27], v[176:179], v[112:115]
ds_read_b64_tr_b16 a[50:51], v8 offset:58368
v_add_u32 v8, 0x10000, v8
v_mfma_f32_16x16x32_bf16 v[116:119], a[24:27], v[180:183], v[116:119]
ds_read_b64_tr_b16 a[52:53], v9 offset:57344
v_cvt_pk_bf16_f32 v45, v45, v45
v_mfma_f32_16x16x32_bf16 v[120:123], a[28:31], v[176:179], v[120:123]
ds_read_b64_tr_b16 a[54:55], v9 offset:58368
v_add_u32 v9, 0x10000, v9
v_mfma_f32_16x16x32_bf16 v[124:127], a[28:31], v[180:183], v[124:127]
s_waitcnt lgkmcnt(8)
ds_read_b64_tr_b16 a[56:57], v10 offset:57344
v_mfma_f32_16x16x32_bf16 v[64:67], a[32:35], v[184:187], v[64:67]
ds_read_b64_tr_b16 a[58:59], v10 offset:58368
v_add_u32 v10, 0x10000, v10
v_mfma_f32_16x16x32_bf16 v[68:71], a[32:35], v[188:191], v[68:71]
ds_read_b64_tr_b16 a[60:61], v11 offset:57344
v_and_b32 v45, 0xffff0000, v45
v_mfma_f32_16x16x32_bf16 v[72:75], a[36:39], v[184:187], v[72:75]
ds_read_b64_tr_b16 a[62:63], v11 offset:58368
v_add_u32 v11, 0x10000, v11
v_mfma_f32_16x16x32_bf16 v[76:79], a[36:39], v[188:191], v[76:79]
s_waitcnt lgkmcnt(8)
ds_read_b64_tr_b16 a[0:1], v4 offset:0
v_mfma_f32_16x16x32_bf16 v[80:83], a[40:43], v[184:187], v[80:83]
ds_read_b64_tr_b16 a[2:3], v4 offset:1024
v_add_f32 v45, 0x3727c5ac, v45
v_mfma_f32_16x16x32_bf16 v[84:87], a[40:43], v[188:191], v[84:87]
ds_read_b64_tr_b16 a[4:5], v5 offset:0
v_cvt_pk_bf16_f32 v45, v45, v45
v_mfma_f32_16x16x32_bf16 v[88:91], a[44:47], v[184:187], v[88:91]
ds_read_b64_tr_b16 a[6:7], v5 offset:1024
v_and_b32 v45, 0xffff0000, v45
v_mfma_f32_16x16x32_bf16 v[92:95], a[44:47], v[188:191], v[92:95]
s_waitcnt lgkmcnt(8)
ds_read_b64_tr_b16 a[8:9], v6 offset:0
v_mfma_f32_16x16x32_bf16 v[96:99], a[48:51], v[184:187], v[96:99]
ds_read_b64_tr_b16 a[10:11], v6 offset:1024
v_sqrt_f32 v45, v45
v_mfma_f32_16x16x32_bf16 v[100:103], a[48:51], v[188:191], v[100:103]
ds_read_b64_tr_b16 a[12:13], v7 offset:0
v_cvt_pk_bf16_f32 v45, v45, v45
v_mfma_f32_16x16x32_bf16 v[104:107], a[52:55], v[184:187], v[104:107]
ds_read_b64_tr_b16 a[14:15], v7 offset:1024
v_and_b32 v45, 0xffff0000, v45
v_mfma_f32_16x16x32_bf16 v[108:111], a[52:55], v[188:191], v[108:111]
s_waitcnt lgkmcnt(8)
ds_read_b64_tr_b16 a[16:17], v8 offset:0
v_mfma_f32_16x16x32_bf16 v[112:115], a[56:59], v[184:187], v[112:115]
ds_read_b64_tr_b16 a[18:19], v8 offset:1024
v_rcp_f32 v48, v45
v_mfma_f32_16x16x32_bf16 v[116:119], a[56:59], v[188:191], v[116:119]
ds_read_b64_tr_b16 a[20:21], v9 offset:0
v_cvt_pk_bf16_f32 v44, v44, v44
v_mfma_f32_16x16x32_bf16 v[120:123], a[60:63], v[184:187], v[120:123]
ds_read_b64_tr_b16 a[22:23], v9 offset:1024
v_and_b32 v44, 0xffff0000, v44
v_mfma_f32_16x16x32_bf16 v[124:127], a[60:63], v[188:191], v[124:127]
s_waitcnt lgkmcnt(8)
ds_read_b64_tr_b16 a[24:25], v10 offset:0
v_mfma_f32_16x16x32_bf16 v[64:67], a[0:3], v[192:195], v[64:67]
ds_read_b64_tr_b16 a[26:27], v10 offset:1024
v_mul_f32 v48, s42, v48
v_mfma_f32_16x16x32_bf16 v[68:71], a[0:3], v[196:199], v[68:71]
ds_read_b64_tr_b16 a[28:29], v11 offset:0
v_mul_f32 v52, -v44, v48
v_mfma_f32_16x16x32_bf16 v[72:75], a[4:7], v[192:195], v[72:75]
ds_read_b64_tr_b16 a[30:31], v11 offset:1024
v_mov_b32 v50, v48
v_mfma_f32_16x16x32_bf16 v[76:79], a[4:7], v[196:199], v[76:79]
s_waitcnt lgkmcnt(8)
ds_read_b64_tr_b16 a[32:33], v4 offset:8192
v_mfma_f32_16x16x32_bf16 v[80:83], a[8:11], v[192:195], v[80:83]
ds_read_b64_tr_b16 a[34:35], v4 offset:9216
v_mov_b32 v54, v52
v_mfma_f32_16x16x32_bf16 v[84:87], a[8:11], v[196:199], v[84:87]
ds_read_b64_tr_b16 a[36:37], v5 offset:8192
v_permlane16_swap_b32 v48, v50
v_mfma_f32_16x16x32_bf16 v[88:91], a[12:15], v[192:195], v[88:91]
ds_read_b64_tr_b16 a[38:39], v5 offset:9216
v_permlane16_swap_b32 v52, v54
v_mfma_f32_16x16x32_bf16 v[92:95], a[12:15], v[196:199], v[92:95]
s_waitcnt lgkmcnt(8)
ds_read_b64_tr_b16 a[40:41], v6 offset:8192
v_mfma_f32_16x16x32_bf16 v[96:99], a[16:19], v[192:195], v[96:99]
ds_read_b64_tr_b16 a[42:43], v6 offset:9216
v_mov_b32 v49, v48
v_mfma_f32_16x16x32_bf16 v[100:103], a[16:19], v[196:199], v[100:103]
ds_read_b64_tr_b16 a[44:45], v7 offset:8192
v_mov_b32 v51, v50
v_mfma_f32_16x16x32_bf16 v[104:107], a[20:23], v[192:195], v[104:107]
ds_read_b64_tr_b16 a[46:47], v7 offset:9216
v_mov_b32 v53, v52
v_mfma_f32_16x16x32_bf16 v[108:111], a[20:23], v[196:199], v[108:111]
s_waitcnt lgkmcnt(8)
ds_read_b64_tr_b16 a[48:49], v8 offset:8192
v_mfma_f32_16x16x32_bf16 v[112:115], a[24:27], v[192:195], v[112:115]
ds_read_b64_tr_b16 a[50:51], v8 offset:9216
v_mov_b32 v55, v54
v_mfma_f32_16x16x32_bf16 v[116:119], a[24:27], v[196:199], v[116:119]
ds_read_b64_tr_b16 a[52:53], v9 offset:8192
v_mfma_f32_16x16x32_bf16 v[120:123], a[28:31], v[192:195], v[120:123]
ds_read_b64_tr_b16 a[54:55], v9 offset:9216
v_mfma_f32_16x16x32_bf16 v[124:127], a[28:31], v[196:199], v[124:127]
s_waitcnt vmcnt(8) lgkmcnt(8)
ds_read_b64_tr_b16 a[56:57], v10 offset:8192
v_mfma_f32_16x16x32_bf16 v[64:67], a[32:35], v[200:203], v[64:67]
ds_read_b64_tr_b16 a[58:59], v10 offset:9216
v_mfma_f32_16x16x32_bf16 v[68:71], a[32:35], v[204:207], v[68:71]
ds_read_b64_tr_b16 a[60:61], v11 offset:8192
v_mfma_f32_16x16x32_bf16 v[72:75], a[36:39], v[200:203], v[72:75]
ds_read_b64_tr_b16 a[62:63], v11 offset:9216
v_mfma_f32_16x16x32_bf16 v[76:79], a[36:39], v[204:207], v[76:79]
s_waitcnt lgkmcnt(8)
ds_read_b64_tr_b16 a[0:1], v4 offset:16384
v_mfma_f32_16x16x32_bf16 v[80:83], a[40:43], v[200:203], v[80:83]
ds_read_b64_tr_b16 a[2:3], v4 offset:17408
v_mfma_f32_16x16x32_bf16 v[84:87], a[40:43], v[204:207], v[84:87]
ds_read_b64_tr_b16 a[4:5], v5 offset:16384
s_add_u32 m0, s58, 0
v_mfma_f32_16x16x32_bf16 v[88:91], a[44:47], v[200:203], v[88:91]
ds_read_b64_tr_b16 a[6:7], v5 offset:17408
buffer_load_dwordx4 v16, s[16:19], s76 offen offset:0 lds
v_mfma_f32_16x16x32_bf16 v[92:95], a[44:47], v[204:207], v[92:95]
s_waitcnt lgkmcnt(8)
ds_read_b64_tr_b16 a[8:9], v6 offset:16384
v_mfma_f32_16x16x32_bf16 v[96:99], a[48:51], v[200:203], v[96:99]
ds_read_b64_tr_b16 a[10:11], v6 offset:17408
buffer_load_dwordx4 v17, s[16:19], s76 offen offset:1024 lds
v_mfma_f32_16x16x32_bf16 v[100:103], a[48:51], v[204:207], v[100:103]
ds_read_b64_tr_b16 a[12:13], v7 offset:16384
buffer_load_dwordx4 v18, s[16:19], s76 offen offset:2048 lds
v_mfma_f32_16x16x32_bf16 v[104:107], a[52:55], v[200:203], v[104:107]
ds_read_b64_tr_b16 a[14:15], v7 offset:17408
buffer_load_dwordx4 v19, s[16:19], s76 offen offset:3072 lds
v_mfma_f32_16x16x32_bf16 v[108:111], a[52:55], v[204:207], v[108:111]
s_waitcnt lgkmcnt(8)
ds_read_b64_tr_b16 a[16:17], v8 offset:16384
v_mfma_f32_16x16x32_bf16 v[112:115], a[56:59], v[200:203], v[112:115]
ds_read_b64_tr_b16 a[18:19], v8 offset:17408
s_add_u32 s76, s76, 28672
v_mfma_f32_16x16x32_bf16 v[116:119], a[56:59], v[204:207], v[116:119]
ds_read_b64_tr_b16 a[20:21], v9 offset:16384
s_add_u32 m0, s58, 4096
v_mfma_f32_16x16x32_bf16 v[120:123], a[60:63], v[200:203], v[120:123]
ds_read_b64_tr_b16 a[22:23], v9 offset:17408
buffer_load_dwordx4 v16, s[16:19], s76 offen offset:0 lds
v_mfma_f32_16x16x32_bf16 v[124:127], a[60:63], v[204:207], v[124:127]
s_waitcnt vmcnt(11) lgkmcnt(8)
ds_read_b64_tr_b16 a[24:25], v10 offset:16384
v_mfma_f32_16x16x32_bf16 v[64:67], a[0:3], v[208:211], v[64:67]
ds_read_b64_tr_b16 a[26:27], v10 offset:17408
buffer_load_dwordx4 v17, s[16:19], s76 offen offset:1024 lds
v_mfma_f32_16x16x32_bf16 v[68:71], a[0:3], v[212:215], v[68:71]
ds_read_b64_tr_b16 a[28:29], v11 offset:16384
buffer_load_dwordx4 v18, s[16:19], s76 offen offset:2048 lds
v_mfma_f32_16x16x32_bf16 v[72:75], a[4:7], v[208:211], v[72:75]
ds_read_b64_tr_b16 a[30:31], v11 offset:17408
buffer_load_dwordx4 v19, s[16:19], s76 offen offset:3072 lds
v_mfma_f32_16x16x32_bf16 v[76:79], a[4:7], v[212:215], v[76:79]
s_waitcnt lgkmcnt(8)
ds_read_b64_tr_b16 a[32:33], v4 offset:24576
v_mfma_f32_16x16x32_bf16 v[80:83], a[8:11], v[208:211], v[80:83]
ds_read_b64_tr_b16 a[34:35], v4 offset:25600
s_add_u32 s76, s76, 28672
v_mfma_f32_16x16x32_bf16 v[84:87], a[8:11], v[212:215], v[84:87]
ds_read_b64_tr_b16 a[36:37], v5 offset:24576
v_mfma_f32_16x16x32_bf16 v[88:91], a[12:15], v[208:211], v[88:91]
ds_read_b64_tr_b16 a[38:39], v5 offset:25600
v_mfma_f32_16x16x32_bf16 v[92:95], a[12:15], v[212:215], v[92:95]
s_waitcnt lgkmcnt(8)
ds_read_b64_tr_b16 a[40:41], v6 offset:24576
v_mfma_f32_16x16x32_bf16 v[96:99], a[16:19], v[208:211], v[96:99]
ds_read_b64_tr_b16 a[42:43], v6 offset:25600
v_mfma_f32_16x16x32_bf16 v[100:103], a[16:19], v[212:215], v[100:103]
ds_read_b64_tr_b16 a[44:45], v7 offset:24576
v_mfma_f32_16x16x32_bf16 v[104:107], a[20:23], v[208:211], v[104:107]
ds_read_b64_tr_b16 a[46:47], v7 offset:25600
v_mfma_f32_16x16x32_bf16 v[108:111], a[20:23], v[212:215], v[108:111]
s_waitcnt lgkmcnt(8)
ds_read_b64_tr_b16 a[48:49], v8 offset:24576
v_mfma_f32_16x16x32_bf16 v[112:115], a[24:27], v[208:211], v[112:115]
ds_read_b64_tr_b16 a[50:51], v8 offset:25600
v_mfma_f32_16x16x32_bf16 v[116:119], a[24:27], v[212:215], v[116:119]
ds_read_b64_tr_b16 a[52:53], v9 offset:24576
v_mfma_f32_16x16x32_bf16 v[120:123], a[28:31], v[208:211], v[120:123]
ds_read_b64_tr_b16 a[54:55], v9 offset:25600
v_mfma_f32_16x16x32_bf16 v[124:127], a[28:31], v[212:215], v[124:127]
s_waitcnt vmcnt(12) lgkmcnt(8)
ds_read_b64_tr_b16 a[56:57], v10 offset:24576
v_mfma_f32_16x16x32_bf16 v[64:67], a[32:35], v[216:219], v[64:67]
ds_read_b64_tr_b16 a[58:59], v10 offset:25600
v_mfma_f32_16x16x32_bf16 v[68:71], a[32:35], v[220:223], v[68:71]
ds_read_b64_tr_b16 a[60:61], v11 offset:24576
v_mfma_f32_16x16x32_bf16 v[72:75], a[36:39], v[216:219], v[72:75]
ds_read_b64_tr_b16 a[62:63], v11 offset:25600
v_mfma_f32_16x16x32_bf16 v[76:79], a[36:39], v[220:223], v[76:79]
s_waitcnt lgkmcnt(8)
ds_read_b64_tr_b16 a[0:1], v4 offset:32768
v_mfma_f32_16x16x32_bf16 v[80:83], a[40:43], v[216:219], v[80:83]
ds_read_b64_tr_b16 a[2:3], v4 offset:33792
v_mfma_f32_16x16x32_bf16 v[84:87], a[40:43], v[220:223], v[84:87]
ds_read_b64_tr_b16 a[4:5], v5 offset:32768
v_mfma_f32_16x16x32_bf16 v[88:91], a[44:47], v[216:219], v[88:91]
ds_read_b64_tr_b16 a[6:7], v5 offset:33792
v_mfma_f32_16x16x32_bf16 v[92:95], a[44:47], v[220:223], v[92:95]
s_waitcnt lgkmcnt(8)
ds_read_b64_tr_b16 a[8:9], v6 offset:32768
v_mfma_f32_16x16x32_bf16 v[96:99], a[48:51], v[216:219], v[96:99]
ds_read_b64_tr_b16 a[10:11], v6 offset:33792
v_mfma_f32_16x16x32_bf16 v[100:103], a[48:51], v[220:223], v[100:103]
ds_read_b64_tr_b16 a[12:13], v7 offset:32768
v_mfma_f32_16x16x32_bf16 v[104:107], a[52:55], v[216:219], v[104:107]
ds_read_b64_tr_b16 a[14:15], v7 offset:33792
v_mfma_f32_16x16x32_bf16 v[108:111], a[52:55], v[220:223], v[108:111]
s_waitcnt lgkmcnt(8)
ds_read_b64_tr_b16 a[16:17], v8 offset:32768
v_mfma_f32_16x16x32_bf16 v[112:115], a[56:59], v[216:219], v[112:115]
ds_read_b64_tr_b16 a[18:19], v8 offset:33792
v_mfma_f32_16x16x32_bf16 v[116:119], a[56:59], v[220:223], v[116:119]
ds_read_b64_tr_b16 a[20:21], v9 offset:32768
v_mfma_f32_16x16x32_bf16 v[120:123], a[60:63], v[216:219], v[120:123]
ds_read_b64_tr_b16 a[22:23], v9 offset:33792
v_mfma_f32_16x16x32_bf16 v[124:127], a[60:63], v[220:223], v[124:127]
s_waitcnt vmcnt(10) lgkmcnt(8)
ds_read_b64_tr_b16 a[24:25], v10 offset:32768
v_mfma_f32_16x16x32_bf16 v[64:67], a[0:3], v[224:227], v[64:67]
ds_read_b64_tr_b16 a[26:27], v10 offset:33792
v_mfma_f32_16x16x32_bf16 v[68:71], a[0:3], v[228:231], v[68:71]
ds_read_b64_tr_b16 a[28:29], v11 offset:32768
v_mfma_f32_16x16x32_bf16 v[72:75], a[4:7], v[224:227], v[72:75]
ds_read_b64_tr_b16 a[30:31], v11 offset:33792
v_mfma_f32_16x16x32_bf16 v[76:79], a[4:7], v[228:231], v[76:79]
s_waitcnt lgkmcnt(8)
ds_read_b64_tr_b16 a[32:33], v4 offset:40960
v_mfma_f32_16x16x32_bf16 v[80:83], a[8:11], v[224:227], v[80:83]
ds_read_b64_tr_b16 a[34:35], v4 offset:41984
v_mfma_f32_16x16x32_bf16 v[84:87], a[8:11], v[228:231], v[84:87]
ds_read_b64_tr_b16 a[36:37], v5 offset:40960
v_mfma_f32_16x16x32_bf16 v[88:91], a[12:15], v[224:227], v[88:91]
ds_read_b64_tr_b16 a[38:39], v5 offset:41984
v_mfma_f32_16x16x32_bf16 v[92:95], a[12:15], v[228:231], v[92:95]
s_waitcnt lgkmcnt(8)
ds_read_b64_tr_b16 a[40:41], v6 offset:40960
s_barrier
v_mfma_f32_16x16x32_bf16 v[96:99], a[16:19], v[224:227], v[96:99]
ds_read_b64_tr_b16 a[42:43], v6 offset:41984
v_mfma_f32_16x16x32_bf16 v[100:103], a[16:19], v[228:231], v[100:103]
ds_read_b64_tr_b16 a[44:45], v7 offset:40960
v_mfma_f32_16x16x32_bf16 v[104:107], a[20:23], v[224:227], v[104:107]
ds_read_b64_tr_b16 a[46:47], v7 offset:41984
v_mfma_f32_16x16x32_bf16 v[108:111], a[20:23], v[228:231], v[108:111]
s_waitcnt lgkmcnt(8)
ds_read_b64_tr_b16 a[48:49], v8 offset:40960
v_mfma_f32_16x16x32_bf16 v[112:115], a[24:27], v[224:227], v[112:115]
ds_read_b64_tr_b16 a[50:51], v8 offset:41984
v_mfma_f32_16x16x32_bf16 v[116:119], a[24:27], v[228:231], v[116:119]
ds_read_b64_tr_b16 a[52:53], v9 offset:40960
v_mfma_f32_16x16x32_bf16 v[120:123], a[28:31], v[224:227], v[120:123]
ds_read_b64_tr_b16 a[54:55], v9 offset:41984
v_mfma_f32_16x16x32_bf16 v[124:127], a[28:31], v[228:231], v[124:127]
s_waitcnt vmcnt(8) lgkmcnt(8)
ds_read_b64_tr_b16 a[56:57], v10 offset:40960
ds_read_b128 v[128:131], v41 offset:0
v_mfma_f32_16x16x32_bf16 v[64:67], a[32:35], v[232:235], v[64:67]
ds_read_b64_tr_b16 a[58:59], v10 offset:41984
ds_read_b128 v[132:135], v41 offset:64
v_mfma_f32_16x16x32_bf16 v[68:71], a[32:35], v[236:239], v[68:71]
ds_read_b64_tr_b16 a[60:61], v11 offset:40960
ds_read_b128 v[136:139], v41 offset:128
v_mfma_f32_16x16x32_bf16 v[72:75], a[36:39], v[232:235], v[72:75]
ds_read_b64_tr_b16 a[62:63], v11 offset:41984
ds_read_b128 v[140:143], v41 offset:192
v_mfma_f32_16x16x32_bf16 v[76:79], a[36:39], v[236:239], v[76:79]
s_waitcnt lgkmcnt(12)
ds_read_b128 v[144:147], v41 offset:256
v_mfma_f32_16x16x32_bf16 v[80:83], a[40:43], v[232:235], v[80:83]
ds_read_b128 v[148:151], v41 offset:320
v_mfma_f32_16x16x32_bf16 v[84:87], a[40:43], v[236:239], v[84:87]
ds_read_b128 v[152:155], v41 offset:384
v_mfma_f32_16x16x32_bf16 v[88:91], a[44:47], v[232:235], v[88:91]
ds_read_b128 v[156:159], v41 offset:448
v_mfma_f32_16x16x32_bf16 v[92:95], a[44:47], v[236:239], v[92:95]
s_waitcnt lgkmcnt(12)
ds_read_b128 v[160:163], v41 offset:512
v_mfma_f32_16x16x32_bf16 v[96:99], a[48:51], v[232:235], v[96:99]
ds_read_b128 v[164:167], v41 offset:576
v_mfma_f32_16x16x32_bf16 v[100:103], a[48:51], v[236:239], v[100:103]
ds_read_b128 v[168:171], v41 offset:640
v_mfma_f32_16x16x32_bf16 v[104:107], a[52:55], v[232:235], v[104:107]
ds_read_b128 v[172:175], v41 offset:704
v_mfma_f32_16x16x32_bf16 v[108:111], a[52:55], v[236:239], v[108:111]
s_waitcnt lgkmcnt(9)
ds_read_b128 v[176:179], v41 offset:768
v_mfma_f32_16x16x32_bf16 v[112:115], a[56:59], v[232:235], v[112:115]
ds_read_b128 v[180:183], v41 offset:832
v_mfma_f32_16x16x32_bf16 v[116:119], a[56:59], v[236:239], v[116:119]
ds_read_b128 v[184:187], v41 offset:896
v_mfma_f32_16x16x32_bf16 v[120:123], a[60:63], v[232:235], v[120:123]
ds_read_b128 v[188:191], v41 offset:960
v_mfma_f32_16x16x32_bf16 v[124:127], a[60:63], v[236:239], v[124:127]
s_waitcnt lgkmcnt(0)
s_barrier
s_add_u32 m0, s77, 16384
s_nop 0
buffer_load_dwordx4 v16, s[16:19], s76 offen offset:0 lds
buffer_load_dwordx4 v17, s[16:19], s76 offen offset:1024 lds
buffer_load_dwordx4 v18, s[16:19], s76 offen offset:2048 lds
buffer_load_dwordx4 v19, s[16:19], s76 offen offset:3072 lds
s_add_u32 s76, s76, 28672
s_add_u32 m0, s77, 20480
s_nop 0
buffer_load_dwordx4 v16, s[16:19], s76 offen offset:0 lds
buffer_load_dwordx4 v17, s[16:19], s76 offen offset:1024 lds
buffer_load_dwordx4 v18, s[16:19], s76 offen offset:2048 lds
buffer_load_dwordx4 v19, s[16:19], s76 offen offset:3072 lds
s_add_u32 s76, s76, 28672
s_add_u32 m0, s77, 24576
s_nop 0
buffer_load_dwordx4 v16, s[16:19], s76 offen offset:0 lds
buffer_load_dwordx4 v17, s[16:19], s76 offen offset:1024 lds
buffer_load_dwordx4 v18, s[16:19], s76 offen offset:2048 lds
buffer_load_dwordx4 v19, s[16:19], s76 offen offset:3072 lds
s_add_u32 s76, s76, 28672
v_pk_fma_f32 v[192:193], v[52:53], v[128:129], v[160:161]
v_pk_fma_f32 v[194:195], v[52:53], v[130:131], v[162:163]
v_pk_fma_f32 v[196:197], v[52:53], v[132:133], v[164:165]
v_pk_fma_f32 v[198:199], v[52:53], v[134:135], v[166:167]
v_pk_fma_f32 v[64:65], v[64:65], v[48:49], v[192:193]
v_pk_fma_f32 v[66:67], v[66:67], v[48:49], v[194:195]
v_pk_fma_f32 v[72:73], v[72:73], v[48:49], v[196:197]
v_pk_fma_f32 v[74:75], v[74:75], v[48:49], v[198:199]
v_exp_f32 v192, v64
v_exp_f32 v193, v65
v_exp_f32 v194, v66
v_exp_f32 v195, v67
v_exp_f32 v196, v72
v_exp_f32 v197, v73
v_exp_f32 v198, v74
v_exp_f32 v199, v75
v_pk_fma_f32 v[192:193], v[192:193], s[42:43], s[42:43]
v_pk_fma_f32 v[194:195], v[194:195], s[42:43], s[42:43]
v_pk_fma_f32 v[196:197], v[196:197], s[42:43], s[42:43]
v_pk_fma_f32 v[198:199], v[198:199], s[42:43], s[42:43]
v_rcp_f32 v192, v192
v_rcp_f32 v193, v193
v_rcp_f32 v194, v194
v_rcp_f32 v195, v195
v_rcp_f32 v196, v196
v_rcp_f32 v197, v197
v_rcp_f32 v198, v198
v_rcp_f32 v199, v199
v_pk_mul_f32 v[64:65], v[64:65], v[192:193]
v_pk_mul_f32 v[66:67], v[66:67], v[194:195]
v_pk_mul_f32 v[72:73], v[72:73], v[196:197]
v_pk_mul_f32 v[74:75], v[74:75], v[198:199]
v_cvt_pk_bf16_f32 v24, v64, v65
v_cvt_pk_bf16_f32 v25, v66, v67
v_cvt_pk_bf16_f32 v26, v72, v73
v_cvt_pk_bf16_f32 v27, v74, v75
buffer_store_dwordx4 v[24:27], v2, s[12:15], s56 offen offset:0 sc1
s_add_u32 m0, s77, 0
s_nop 0
buffer_load_dwordx4 v16, s[16:19], s76 offen offset:0 lds
buffer_load_dwordx4 v17, s[16:19], s76 offen offset:1024 lds
buffer_load_dwordx4 v18, s[16:19], s76 offen offset:2048 lds
buffer_load_dwordx4 v19, s[16:19], s76 offen offset:3072 lds
s_add_u32 s76, s76, 28672
v_pk_fma_f32 v[200:201], v[54:55], v[128:129], v[160:161]
v_pk_fma_f32 v[202:203], v[54:55], v[130:131], v[162:163]
v_pk_fma_f32 v[204:205], v[54:55], v[132:133], v[164:165]
v_pk_fma_f32 v[206:207], v[54:55], v[134:135], v[166:167]
v_pk_fma_f32 v[68:69], v[68:69], v[50:51], v[200:201]
v_pk_fma_f32 v[70:71], v[70:71], v[50:51], v[202:203]
v_pk_fma_f32 v[76:77], v[76:77], v[50:51], v[204:205]
v_pk_fma_f32 v[78:79], v[78:79], v[50:51], v[206:207]
v_exp_f32 v200, v68
v_exp_f32 v201, v69
v_exp_f32 v202, v70
v_exp_f32 v203, v71
v_exp_f32 v204, v76
v_exp_f32 v205, v77
v_exp_f32 v206, v78
v_exp_f32 v207, v79
v_pk_fma_f32 v[200:201], v[200:201], s[42:43], s[42:43]
v_pk_fma_f32 v[202:203], v[202:203], s[42:43], s[42:43]
v_pk_fma_f32 v[204:205], v[204:205], s[42:43], s[42:43]
v_pk_fma_f32 v[206:207], v[206:207], s[42:43], s[42:43]
v_rcp_f32 v200, v200
v_rcp_f32 v201, v201
v_rcp_f32 v202, v202
v_rcp_f32 v203, v203
v_rcp_f32 v204, v204
v_rcp_f32 v205, v205
v_rcp_f32 v206, v206
v_rcp_f32 v207, v207
v_pk_mul_f32 v[68:69], v[68:69], v[200:201]
v_pk_mul_f32 v[70:71], v[70:71], v[202:203]
v_pk_mul_f32 v[76:77], v[76:77], v[204:205]
v_pk_mul_f32 v[78:79], v[78:79], v[206:207]
v_cvt_pk_bf16_f32 v28, v68, v69
v_cvt_pk_bf16_f32 v29, v70, v71
v_cvt_pk_bf16_f32 v30, v76, v77
v_cvt_pk_bf16_f32 v31, v78, v79
buffer_store_dwordx4 v[28:31], v2, s[12:15], s57 offen offset:0 sc1
s_add_u32 m0, s77, 4096
s_nop 0
buffer_load_dwordx4 v16, s[16:19], s76 offen offset:0 lds
buffer_load_dwordx4 v17, s[16:19], s76 offen offset:1024 lds
buffer_load_dwordx4 v18, s[16:19], s76 offen offset:2048 lds
buffer_load_dwordx4 v19, s[16:19], s76 offen offset:3072 lds
s_add_u32 s76, s76, 28672
s_waitcnt vmcnt(22)
ds_read_b64_tr_b16 a[32:33], v12 offset:0
ds_read_b64_tr_b16 a[34:35], v12 offset:2048
ds_read_b64_tr_b16 a[36:37], v13 offset:0
ds_read_b64_tr_b16 a[38:39], v13 offset:2048
ds_read_b64_tr_b16 a[40:41], v14 offset:0
ds_read_b64_tr_b16 a[42:43], v14 offset:2048
ds_read_b64_tr_b16 a[44:45], v15 offset:0
ds_read_b64_tr_b16 a[46:47], v15 offset:2048
ds_read_b64_tr_b16 a[48:49], v12 offset:4096
ds_read_b64_tr_b16 a[50:51], v12 offset:6144
ds_read_b64_tr_b16 a[52:53], v13 offset:4096
ds_read_b64_tr_b16 a[54:55], v13 offset:6144
ds_read_b64_tr_b16 a[56:57], v14 offset:4096
ds_read_b64_tr_b16 a[58:59], v14 offset:6144
ds_read_b64_tr_b16 a[60:61], v15 offset:4096
ds_read_b64_tr_b16 a[62:63], v15 offset:6144
v_pk_fma_f32 v[208:209], v[52:53], v[136:137], v[168:169]
v_pk_fma_f32 v[210:211], v[52:53], v[138:139], v[170:171]
v_pk_fma_f32 v[212:213], v[52:53], v[140:141], v[172:173]
v_pk_fma_f32 v[214:215], v[52:53], v[142:143], v[174:175]
v_pk_fma_f32 v[80:81], v[80:81], v[48:49], v[208:209]
v_pk_fma_f32 v[82:83], v[82:83], v[48:49], v[210:211]
v_pk_fma_f32 v[88:89], v[88:89], v[48:49], v[212:213]
v_pk_fma_f32 v[90:91], v[90:91], v[48:49], v[214:215]
v_exp_f32 v208, v80
v_exp_f32 v209, v81
v_exp_f32 v210, v82
v_exp_f32 v211, v83
v_exp_f32 v212, v88
v_exp_f32 v213, v89
v_exp_f32 v214, v90
v_exp_f32 v215, v91
v_pk_fma_f32 v[208:209], v[208:209], s[42:43], s[42:43]
v_pk_fma_f32 v[210:211], v[210:211], s[42:43], s[42:43]
v_pk_fma_f32 v[212:213], v[212:213], s[42:43], s[42:43]
v_pk_fma_f32 v[214:215], v[214:215], s[42:43], s[42:43]
v_rcp_f32 v208, v208
v_rcp_f32 v209, v209
v_rcp_f32 v210, v210
v_rcp_f32 v211, v211
v_rcp_f32 v212, v212
v_rcp_f32 v213, v213
v_rcp_f32 v214, v214
v_rcp_f32 v215, v215
v_pk_mul_f32 v[80:81], v[80:81], v[208:209]
v_pk_mul_f32 v[82:83], v[82:83], v[210:211]
v_pk_mul_f32 v[88:89], v[88:89], v[212:213]
v_pk_mul_f32 v[90:91], v[90:91], v[214:215]
v_cvt_pk_bf16_f32 v32, v80, v81
v_cvt_pk_bf16_f32 v33, v82, v83
v_cvt_pk_bf16_f32 v34, v88, v89
v_cvt_pk_bf16_f32 v35, v90, v91
buffer_store_dwordx4 v[32:35], v2, s[12:15], s56 offen offset:1024 sc1
s_waitcnt vmcnt(19)
ds_read_b64_tr_b16 a[0:1], v20 offset:16384
ds_read_b64_tr_b16 a[2:3], v20 offset:18432
ds_read_b64_tr_b16 a[4:5], v21 offset:16384
ds_read_b64_tr_b16 a[6:7], v21 offset:18432
ds_read_b64_tr_b16 a[8:9], v22 offset:16384
ds_read_b64_tr_b16 a[10:11], v22 offset:18432
ds_read_b64_tr_b16 a[12:13], v23 offset:16384
ds_read_b64_tr_b16 a[14:15], v23 offset:18432
v_pk_fma_f32 v[216:217], v[54:55], v[136:137], v[168:169]
v_pk_fma_f32 v[218:219], v[54:55], v[138:139], v[170:171]
v_pk_fma_f32 v[220:221], v[54:55], v[140:141], v[172:173]
v_pk_fma_f32 v[222:223], v[54:55], v[142:143], v[174:175]
v_pk_fma_f32 v[84:85], v[84:85], v[50:51], v[216:217]
v_pk_fma_f32 v[86:87], v[86:87], v[50:51], v[218:219]
v_pk_fma_f32 v[92:93], v[92:93], v[50:51], v[220:221]
v_pk_fma_f32 v[94:95], v[94:95], v[50:51], v[222:223]
v_exp_f32 v216, v84
v_exp_f32 v217, v85
v_exp_f32 v218, v86
v_exp_f32 v219, v87
v_exp_f32 v220, v92
v_exp_f32 v221, v93
v_exp_f32 v222, v94
v_exp_f32 v223, v95
v_pk_fma_f32 v[216:217], v[216:217], s[42:43], s[42:43]
v_pk_fma_f32 v[218:219], v[218:219], s[42:43], s[42:43]
v_pk_fma_f32 v[220:221], v[220:221], s[42:43], s[42:43]
v_pk_fma_f32 v[222:223], v[222:223], s[42:43], s[42:43]
v_rcp_f32 v216, v216
v_rcp_f32 v217, v217
v_rcp_f32 v218, v218
v_rcp_f32 v219, v219
v_rcp_f32 v220, v220
v_rcp_f32 v221, v221
v_rcp_f32 v222, v222
v_rcp_f32 v223, v223
v_pk_mul_f32 v[84:85], v[84:85], v[216:217]
v_pk_mul_f32 v[86:87], v[86:87], v[218:219]
v_pk_mul_f32 v[92:93], v[92:93], v[220:221]
v_pk_mul_f32 v[94:95], v[94:95], v[222:223]
v_cvt_pk_bf16_f32 v36, v84, v85
v_cvt_pk_bf16_f32 v37, v86, v87
v_cvt_pk_bf16_f32 v38, v92, v93
v_cvt_pk_bf16_f32 v39, v94, v95
buffer_store_dwordx4 v[36:39], v2, s[12:15], s57 offen offset:1024 sc1
s_waitcnt vmcnt(16)
ds_read_b64_tr_b16 a[16:17], v20 offset:20480
ds_read_b64_tr_b16 a[18:19], v20 offset:22528
ds_read_b64_tr_b16 a[20:21], v21 offset:20480
ds_read_b64_tr_b16 a[22:23], v21 offset:22528
ds_read_b64_tr_b16 a[24:25], v22 offset:20480
ds_read_b64_tr_b16 a[26:27], v22 offset:22528
ds_read_b64_tr_b16 a[28:29], v23 offset:20480
ds_read_b64_tr_b16 a[30:31], v23 offset:22528
v_pk_fma_f32 v[192:193], v[52:53], v[144:145], v[176:177]
v_pk_fma_f32 v[194:195], v[52:53], v[146:147], v[178:179]
v_pk_fma_f32 v[196:197], v[52:53], v[148:149], v[180:181]
v_pk_fma_f32 v[198:199], v[52:53], v[150:151], v[182:183]
v_pk_fma_f32 v[96:97], v[96:97], v[48:49], v[192:193]
v_pk_fma_f32 v[98:99], v[98:99], v[48:49], v[194:195]
v_pk_fma_f32 v[104:105], v[104:105], v[48:49], v[196:197]
v_pk_fma_f32 v[106:107], v[106:107], v[48:49], v[198:199]
v_exp_f32 v192, v96
v_exp_f32 v193, v97
v_exp_f32 v194, v98
v_exp_f32 v195, v99
v_exp_f32 v196, v104
v_exp_f32 v197, v105
v_exp_f32 v198, v106
v_exp_f32 v199, v107
v_pk_fma_f32 v[192:193], v[192:193], s[42:43], s[42:43]
v_pk_fma_f32 v[194:195], v[194:195], s[42:43], s[42:43]
v_pk_fma_f32 v[196:197], v[196:197], s[42:43], s[42:43]
v_pk_fma_f32 v[198:199], v[198:199], s[42:43], s[42:43]
v_rcp_f32 v192, v192
v_rcp_f32 v193, v193
v_rcp_f32 v194, v194
v_rcp_f32 v195, v195
v_rcp_f32 v196, v196
v_rcp_f32 v197, v197
v_rcp_f32 v198, v198
v_rcp_f32 v199, v199
v_pk_mul_f32 v[96:97], v[96:97], v[192:193]
v_pk_mul_f32 v[98:99], v[98:99], v[194:195]
v_pk_mul_f32 v[104:105], v[104:105], v[196:197]
v_pk_mul_f32 v[106:107], v[106:107], v[198:199]
v_cvt_pk_bf16_f32 v24, v96, v97
v_cvt_pk_bf16_f32 v25, v98, v99
v_cvt_pk_bf16_f32 v26, v104, v105
v_cvt_pk_bf16_f32 v27, v106, v107
buffer_store_dwordx4 v[24:27], v2, s[12:15], s56 offen offset:2048 sc1
s_waitcnt vmcnt(13)
ds_read_b64_tr_b16 a[96:97], v20 offset:24576
ds_read_b64_tr_b16 a[98:99], v20 offset:26624
ds_read_b64_tr_b16 a[100:101], v21 offset:24576
ds_read_b64_tr_b16 a[102:103], v21 offset:26624
ds_read_b64_tr_b16 a[104:105], v22 offset:24576
ds_read_b64_tr_b16 a[106:107], v22 offset:26624
ds_read_b64_tr_b16 a[108:109], v23 offset:24576
ds_read_b64_tr_b16 a[110:111], v23 offset:26624
v_pk_fma_f32 v[200:201], v[54:55], v[144:145], v[176:177]
v_pk_fma_f32 v[202:203], v[54:55], v[146:147], v[178:179]
v_pk_fma_f32 v[204:205], v[54:55], v[148:149], v[180:181]
v_pk_fma_f32 v[206:207], v[54:55], v[150:151], v[182:183]
v_pk_fma_f32 v[100:101], v[100:101], v[50:51], v[200:201]
v_pk_fma_f32 v[102:103], v[102:103], v[50:51], v[202:203]
v_pk_fma_f32 v[108:109], v[108:109], v[50:51], v[204:205]
v_pk_fma_f32 v[110:111], v[110:111], v[50:51], v[206:207]
v_exp_f32 v200, v100
v_exp_f32 v201, v101
v_exp_f32 v202, v102
v_exp_f32 v203, v103
v_exp_f32 v204, v108
v_exp_f32 v205, v109
v_exp_f32 v206, v110
v_exp_f32 v207, v111
v_pk_fma_f32 v[200:201], v[200:201], s[42:43], s[42:43]
v_pk_fma_f32 v[202:203], v[202:203], s[42:43], s[42:43]
v_pk_fma_f32 v[204:205], v[204:205], s[42:43], s[42:43]
v_pk_fma_f32 v[206:207], v[206:207], s[42:43], s[42:43]
v_rcp_f32 v200, v200
v_rcp_f32 v201, v201
v_rcp_f32 v202, v202
v_rcp_f32 v203, v203
v_rcp_f32 v204, v204
v_rcp_f32 v205, v205
v_rcp_f32 v206, v206
v_rcp_f32 v207, v207
v_pk_mul_f32 v[100:101], v[100:101], v[200:201]
v_pk_mul_f32 v[102:103], v[102:103], v[202:203]
v_pk_mul_f32 v[108:109], v[108:109], v[204:205]
v_pk_mul_f32 v[110:111], v[110:111], v[206:207]
v_cvt_pk_bf16_f32 v28, v100, v101
v_cvt_pk_bf16_f32 v29, v102, v103
v_cvt_pk_bf16_f32 v30, v108, v109
v_cvt_pk_bf16_f32 v31, v110, v111
buffer_store_dwordx4 v[28:31], v2, s[12:15], s57 offen offset:2048 sc1
v_pk_fma_f32 v[208:209], v[52:53], v[152:153], v[184:185]
v_pk_fma_f32 v[210:211], v[52:53], v[154:155], v[186:187]
v_pk_fma_f32 v[212:213], v[52:53], v[156:157], v[188:189]
v_pk_fma_f32 v[214:215], v[52:53], v[158:159], v[190:191]
v_pk_fma_f32 v[112:113], v[112:113], v[48:49], v[208:209]
v_pk_fma_f32 v[114:115], v[114:115], v[48:49], v[210:211]
v_pk_fma_f32 v[120:121], v[120:121], v[48:49], v[212:213]
v_pk_fma_f32 v[122:123], v[122:123], v[48:49], v[214:215]
v_exp_f32 v208, v112
v_exp_f32 v209, v113
v_exp_f32 v210, v114
v_exp_f32 v211, v115
v_exp_f32 v212, v120
v_exp_f32 v213, v121
v_exp_f32 v214, v122
v_exp_f32 v215, v123
v_pk_fma_f32 v[208:209], v[208:209], s[42:43], s[42:43]
v_pk_fma_f32 v[210:211], v[210:211], s[42:43], s[42:43]
v_pk_fma_f32 v[212:213], v[212:213], s[42:43], s[42:43]
v_pk_fma_f32 v[214:215], v[214:215], s[42:43], s[42:43]
v_rcp_f32 v208, v208
v_rcp_f32 v209, v209
v_rcp_f32 v210, v210
v_rcp_f32 v211, v211
v_rcp_f32 v212, v212
v_rcp_f32 v213, v213
v_rcp_f32 v214, v214
v_rcp_f32 v215, v215
v_pk_mul_f32 v[112:113], v[112:113], v[208:209]
v_pk_mul_f32 v[114:115], v[114:115], v[210:211]
v_pk_mul_f32 v[120:121], v[120:121], v[212:213]
v_pk_mul_f32 v[122:123], v[122:123], v[214:215]
v_cvt_pk_bf16_f32 v32, v112, v113
v_cvt_pk_bf16_f32 v33, v114, v115
v_cvt_pk_bf16_f32 v34, v120, v121
v_cvt_pk_bf16_f32 v35, v122, v123
buffer_store_dwordx4 v[32:35], v2, s[12:15], s56 offen offset:3072 sc1
v_pk_fma_f32 v[216:217], v[54:55], v[152:153], v[184:185]
v_pk_fma_f32 v[218:219], v[54:55], v[154:155], v[186:187]
v_pk_fma_f32 v[220:221], v[54:55], v[156:157], v[188:189]
v_pk_fma_f32 v[222:223], v[54:55], v[158:159], v[190:191]
v_pk_fma_f32 v[116:117], v[116:117], v[50:51], v[216:217]
v_pk_fma_f32 v[118:119], v[118:119], v[50:51], v[218:219]
v_pk_fma_f32 v[124:125], v[124:125], v[50:51], v[220:221]
v_pk_fma_f32 v[126:127], v[126:127], v[50:51], v[222:223]
v_exp_f32 v216, v116
v_exp_f32 v217, v117
v_exp_f32 v218, v118
v_exp_f32 v219, v119
v_exp_f32 v220, v124
v_exp_f32 v221, v125
v_exp_f32 v222, v126
v_exp_f32 v223, v127
v_pk_fma_f32 v[216:217], v[216:217], s[42:43], s[42:43]
v_pk_fma_f32 v[218:219], v[218:219], s[42:43], s[42:43]
v_pk_fma_f32 v[220:221], v[220:221], s[42:43], s[42:43]
v_pk_fma_f32 v[222:223], v[222:223], s[42:43], s[42:43]
v_rcp_f32 v216, v216
v_rcp_f32 v217, v217
v_rcp_f32 v218, v218
v_rcp_f32 v219, v219
v_rcp_f32 v220, v220
v_rcp_f32 v221, v221
v_rcp_f32 v222, v222
v_rcp_f32 v223, v223
v_pk_mul_f32 v[116:117], v[116:117], v[216:217]
v_pk_mul_f32 v[118:119], v[118:119], v[218:219]
v_pk_mul_f32 v[124:125], v[124:125], v[220:221]
v_pk_mul_f32 v[126:127], v[126:127], v[222:223]
v_cvt_pk_bf16_f32 v36, v116, v117
v_cvt_pk_bf16_f32 v37, v118, v119
v_cvt_pk_bf16_f32 v38, v124, v125
v_cvt_pk_bf16_f32 v39, v126, v127
buffer_store_dwordx4 v[36:39], v2, s[12:15], s57 offen offset:3072 sc1
s_lshl_b32 s52, s27, 1
s_lshr_b32 s60, s24, 1
s_add_u32 s52, s52, s60
s_lshl_b32 s52, s52, 7
s_add_u32 s52, s52, 36843520
s_lshl_b32 s53, s31, 1
s_and_b32 s60, s24, 1
s_add_u32 s53, s53, s60
s_lshl_b32 s53, 1, s53
s_add_u32 m0, s77, 8192
s_nop 0
buffer_load_dwordx4 v16, s[16:19], s76 offen offset:0 lds
buffer_load_dwordx4 v17, s[16:19], s76 offen offset:1024 lds
buffer_load_dwordx4 v18, s[16:19], s76 offen offset:2048 lds
buffer_load_dwordx4 v19, s[16:19], s76 offen offset:3072 lds
s_add_u32 s76, s76, 28672
s_add_u32 m0, s77, 12288
s_nop 0
buffer_load_dwordx4 v16, s[16:19], s76 offen offset:0 lds
buffer_load_dwordx4 v17, s[16:19], s76 offen offset:1024 lds
buffer_load_dwordx4 v18, s[16:19], s76 offen offset:2048 lds
buffer_load_dwordx4 v19, s[16:19], s76 offen offset:3072 lds
s_add_u32 s76, s76, 28672
s_mul_i32 s33, s30, 229376
s_mul_i32 s60, s24, 14336
s_add_u32 s33, s33, s60
s_add_u32 s33, s33, 69206016
s_add_u32 s34, s33, 57344
s_add_u32 s35, s33, 114688
s_add_u32 s36, s33, 172032
s_mov_b32 s55, 255
s_cmp_eq_u32 s24, 1
s_cselect_b32 s55, 16320, s55
s_cmp_eq_u32 s24, 2
s_cselect_b32 s55, 4177920, s55
s_cmp_eq_u32 s24, 3
s_cselect_b32 s55, 267386880, s55
s_lshl_b32 s54, s30, 7
s_add_u32 s54, s54, 36843520
v_mov_b32 v61, s53
s_waitcnt vmcnt(8)
buffer_atomic_or v61, v62, s[12:15], s52 offen sc1
s_waitcnt lgkmcnt(15)
s_add_u32 m0, s77, 16384
s_nop 0
buffer_load_dwordx4 v16, s[16:19], s76 offen offset:0 lds
buffer_load_dwordx4 v17, s[16:19], s76 offen offset:1024 lds
buffer_load_dwordx4 v18, s[16:19], s76 offen offset:2048 lds
buffer_load_dwordx4 v19, s[16:19], s76 offen offset:3072 lds
s_add_u32 s76, s76, 28672
s_waitcnt lgkmcnt(8)
s_add_u32 m0, s77, 20480
s_nop 0
buffer_load_dwordx4 v16, s[16:19], s76 offen offset:0 lds
buffer_load_dwordx4 v17, s[16:19], s76 offen offset:1024 lds
buffer_load_dwordx4 v18, s[16:19], s76 offen offset:2048 lds
buffer_load_dwordx4 v19, s[16:19], s76 offen offset:3072 lds
s_add_u32 s76, s76, 28672
s_waitcnt lgkmcnt(0)
s_add_u32 m0, s77, 24576
s_nop 0
buffer_load_dwordx4 v16, s[16:19], s76 offen offset:0 lds
buffer_load_dwordx4 v17, s[16:19], s76 offen offset:1024 lds
buffer_load_dwordx4 v18, s[16:19], s76 offen offset:2048 lds
buffer_load_dwordx4 v19, s[16:19], s76 offen offset:3072 lds
s_add_u32 s76, s76, 28672
s_mov_b32 s61, 0x200000
tl_p1:
v_mov_b32 v63, 0
buffer_atomic_or v63, v62, s[12:15], s54 offen sc0 sc1
s_waitcnt vmcnt(0)
v_readfirstlane_b32 vcc_lo, v63
s_nop 0
s_and_b32 s60, vcc_lo, s55
s_cmp_eq_u32 s60, s55
s_cbranch_scc1 tl_q1
s_sleep 1
s_sub_u32 s61, s61, 1
s_cmp_lg_u32 s61, 0
s_cbranch_scc1 tl_p1
tl_q1:
buffer_load_dwordx4 v[128:131], v2, s[12:15], s33 offen offset:0 sc1
buffer_load_dwordx4 v[132:135], v2, s[12:15], s34 offen offset:0 sc1
buffer_load_dwordx4 v[136:139], v2, s[12:15], s35 offen offset:0 sc1
buffer_load_dwordx4 v[140:143], v2, s[12:15], s36 offen offset:0 sc1
buffer_load_dwordx4 v[144:147], v2, s[12:15], s33 offen offset:1024 sc1
buffer_load_dwordx4 v[148:151], v2, s[12:15], s34 offen offset:1024 sc1
buffer_load_dwordx4 v[152:155], v2, s[12:15], s35 offen offset:1024 sc1
buffer_load_dwordx4 v[156:159], v2, s[12:15], s36 offen offset:1024 sc1
buffer_load_dwordx4 v[160:163], v2, s[12:15], s33 offen offset:2048 sc1
buffer_load_dwordx4 v[164:167], v2, s[12:15], s34 offen offset:2048 sc1
buffer_load_dwordx4 v[168:171], v2, s[12:15], s35 offen offset:2048 sc1
buffer_load_dwordx4 v[172:175], v2, s[12:15], s36 offen offset:2048 sc1
buffer_load_dwordx4 v[176:179], v2, s[12:15], s33 offen offset:3072 sc1
buffer_load_dwordx4 v[180:183], v2, s[12:15], s34 offen offset:3072 sc1
buffer_load_dwordx4 v[184:187], v2, s[12:15], s35 offen offset:3072 sc1
buffer_load_dwordx4 v[188:191], v2, s[12:15], s36 offen offset:3072 sc1
s_add_u32 s33, s33, 4096
s_add_u32 s34, s34, 4096
s_add_u32 s35, s35, 4096
s_add_u32 s36, s36, 4096
buffer_load_dwordx4 v[192:195], v2, s[12:15], s33 offen offset:0 sc1
buffer_load_dwordx4 v[196:199], v2, s[12:15], s34 offen offset:0 sc1
buffer_load_dwordx4 v[200:203], v2, s[12:15], s35 offen offset:0 sc1
buffer_load_dwordx4 v[204:207], v2, s[12:15], s36 offen offset:0 sc1
s_waitcnt vmcnt(16)
v_mfma_f32_16x16x32_bf16 v[64:67], a[64:67], v[128:131], 0
buffer_load_dwordx4 v[208:211], v2, s[12:15], s33 offen offset:1024 sc1
buffer_load_dwordx4 v[212:215], v2, s[12:15], s34 offen offset:1024 sc1
v_mfma_f32_16x16x32_bf16 v[68:71], a[64:67], v[132:135], 0
buffer_load_dwordx4 v[216:219], v2, s[12:15], s35 offen offset:1024 sc1
buffer_load_dwordx4 v[220:223], v2, s[12:15], s36 offen offset:1024 sc1
v_mfma_f32_16x16x32_bf16 v[72:75], a[64:67], v[136:139], 0
v_mfma_f32_16x16x32_bf16 v[76:79], a[64:67], v[140:143], 0
v_mfma_f32_16x16x32_bf16 v[80:83], a[68:71], v[128:131], 0
v_mfma_f32_16x16x32_bf16 v[84:87], a[68:71], v[132:135], 0
v_mfma_f32_16x16x32_bf16 v[88:91], a[68:71], v[136:139], 0
v_mfma_f32_16x16x32_bf16 v[92:95], a[68:71], v[140:143], 0
ds_read_b64_tr_b16 a[112:113], v20 offset:0
v_mfma_f32_16x16x32_bf16 v[96:99], a[72:75], v[128:131], 0
ds_read_b64_tr_b16 a[114:115], v20 offset:2048
v_mfma_f32_16x16x32_bf16 v[100:103], a[72:75], v[132:135], 0
ds_read_b64_tr_b16 a[116:117], v21 offset:0
v_mfma_f32_16x16x32_bf16 v[104:107], a[72:75], v[136:139], 0
ds_read_b64_tr_b16 a[118:119], v21 offset:2048
v_mfma_f32_16x16x32_bf16 v[108:111], a[72:75], v[140:143], 0
ds_read_b64_tr_b16 a[120:121], v22 offset:0
v_mfma_f32_16x16x32_bf16 v[112:115], a[76:79], v[128:131], 0
ds_read_b64_tr_b16 a[122:123], v22 offset:2048
v_mfma_f32_16x16x32_bf16 v[116:119], a[76:79], v[132:135], 0
ds_read_b64_tr_b16 a[124:125], v23 offset:0
v_mfma_f32_16x16x32_bf16 v[120:123], a[76:79], v[136:139], 0
ds_read_b64_tr_b16 a[126:127], v23 offset:2048
v_mfma_f32_16x16x32_bf16 v[124:127], a[76:79], v[140:143], 0
s_waitcnt vmcnt(16)
v_mfma_f32_16x16x32_bf16 v[64:67], a[80:83], v[144:147], v[64:67]
buffer_load_dwordx4 v[224:227], v2, s[12:15], s33 offen offset:2048 sc1
buffer_load_dwordx4 v[228:231], v2, s[12:15], s34 offen offset:2048 sc1
v_mfma_f32_16x16x32_bf16 v[68:71], a[80:83], v[148:151], v[68:71]
buffer_load_dwordx4 v[232:235], v2, s[12:15], s35 offen offset:2048 sc1
buffer_load_dwordx4 v[236:239], v2, s[12:15], s36 offen offset:2048 sc1
v_mfma_f32_16x16x32_bf16 v[72:75], a[80:83], v[152:155], v[72:75]
v_mfma_f32_16x16x32_bf16 v[76:79], a[80:83], v[156:159], v[76:79]
v_accvgpr_read_b32 v4, a248
v_accvgpr_read_b32 v5, a249
v_mfma_f32_16x16x32_bf16 v[80:83], a[84:87], v[144:147], v[80:83]
v_accvgpr_read_b32 v6, a250
v_accvgpr_read_b32 v7, a251
v_mfma_f32_16x16x32_bf16 v[84:87], a[84:87], v[148:151], v[84:87]
v_accvgpr_read_b32 v8, a252
v_accvgpr_read_b32 v9, a253
v_mfma_f32_16x16x32_bf16 v[88:91], a[84:87], v[152:155], v[88:91]
v_mfma_f32_16x16x32_bf16 v[92:95], a[84:87], v[156:159], v[92:95]
ds_read_b64_tr_b16 a[128:129], v20 offset:4096
v_mfma_f32_16x16x32_bf16 v[96:99], a[88:91], v[144:147], v[96:99]
ds_read_b64_tr_b16 a[130:131], v20 offset:6144
v_mfma_f32_16x16x32_bf16 v[100:103], a[88:91], v[148:151], v[100:103]
ds_read_b64_tr_b16 a[132:133], v21 offset:4096
v_mfma_f32_16x16x32_bf16 v[104:107], a[88:91], v[152:155], v[104:107]
ds_read_b64_tr_b16 a[134:135], v21 offset:6144
v_mfma_f32_16x16x32_bf16 v[108:111], a[88:91], v[156:159], v[108:111]
ds_read_b64_tr_b16 a[136:137], v22 offset:4096
v_mfma_f32_16x16x32_bf16 v[112:115], a[92:95], v[144:147], v[112:115]
ds_read_b64_tr_b16 a[138:139], v22 offset:6144
v_mfma_f32_16x16x32_bf16 v[116:119], a[92:95], v[148:151], v[116:119]
ds_read_b64_tr_b16 a[140:141], v23 offset:4096
v_mfma_f32_16x16x32_bf16 v[120:123], a[92:95], v[152:155], v[120:123]
ds_read_b64_tr_b16 a[142:143], v23 offset:6144
v_mfma_f32_16x16x32_bf16 v[124:127], a[92:95], v[156:159], v[124:127]
s_waitcnt vmcnt(16)
v_mfma_f32_16x16x32_bf16 v[64:67], a[32:35], v[160:163], v[64:67]
buffer_load_dwordx4 v[240:243], v2, s[12:15], s33 offen offset:3072 sc1
buffer_load_dwordx4 v[244:247], v2, s[12:15], s34 offen offset:3072 sc1
v_mfma_f32_16x16x32_bf16 v[68:71], a[32:35], v[164:167], v[68:71]
buffer_load_dwordx4 v[248:251], v2, s[12:15], s35 offen offset:3072 sc1
buffer_load_dwordx4 v[252:255], v2, s[12:15], s36 offen offset:3072 sc1
v_mfma_f32_16x16x32_bf16 v[72:75], a[32:35], v[168:171], v[72:75]
s_add_u32 s33, s33, 4096
s_add_u32 s34, s34, 4096
v_mfma_f32_16x16x32_bf16 v[76:79], a[32:35], v[172:175], v[76:79]
s_add_u32 s35, s35, 4096
s_add_u32 s36, s36, 4096
v_mfma_f32_16x16x32_bf16 v[80:83], a[36:39], v[160:163], v[80:83]
v_accvgpr_read_b32 v10, a254
v_accvgpr_read_b32 v11, a255
v_mfma_f32_16x16x32_bf16 v[84:87], a[36:39], v[164:167], v[84:87]
v_and_b32 v40, 15, v1
v_lshrrev_b32 v41, 4, v1
v_lshlrev_b32 v42, 8, v40
v_mfma_f32_16x16x32_bf16 v[88:91], a[36:39], v[168:171], v[88:91]
v_add_u32 v43, 0, v41
v_xor_b32 v43, v43, v40
v_lshl_add_u32 v44, v43, 4, v42
v_add_u32 v44, s77, v44
v_mfma_f32_16x16x32_bf16 v[92:95], a[36:39], v[172:175], v[92:95]
ds_read_b64_tr_b16 a[144:145], v20 offset:8192
v_mfma_f32_16x16x32_bf16 v[96:99], a[40:43], v[160:163], v[96:99]
ds_read_b64_tr_b16 a[146:147], v20 offset:10240
v_mfma_f32_16x16x32_bf16 v[100:103], a[40:43], v[164:167], v[100:103]
ds_read_b64_tr_b16 a[148:149], v21 offset:8192
v_mfma_f32_16x16x32_bf16 v[104:107], a[40:43], v[168:171], v[104:107]
ds_read_b64_tr_b16 a[150:151], v21 offset:10240
v_mfma_f32_16x16x32_bf16 v[108:111], a[40:43], v[172:175], v[108:111]
ds_read_b64_tr_b16 a[152:153], v22 offset:8192
v_mfma_f32_16x16x32_bf16 v[112:115], a[44:47], v[160:163], v[112:115]
ds_read_b64_tr_b16 a[154:155], v22 offset:10240
v_mfma_f32_16x16x32_bf16 v[116:119], a[44:47], v[164:167], v[116:119]
ds_read_b64_tr_b16 a[156:157], v23 offset:8192
v_mfma_f32_16x16x32_bf16 v[120:123], a[44:47], v[168:171], v[120:123]
ds_read_b64_tr_b16 a[158:159], v23 offset:10240
v_mfma_f32_16x16x32_bf16 v[124:127], a[44:47], v[172:175], v[124:127]
s_waitcnt vmcnt(16)
v_mfma_f32_16x16x32_bf16 v[64:67], a[48:51], v[176:179], v[64:67]
buffer_load_dwordx4 v[128:131], v2, s[12:15], s33 offen offset:0 sc1
buffer_load_dwordx4 v[132:135], v2, s[12:15], s34 offen offset:0 sc1
v_mfma_f32_16x16x32_bf16 v[68:71], a[48:51], v[180:183], v[68:71]
buffer_load_dwordx4 v[136:139], v2, s[12:15], s35 offen offset:0 sc1
buffer_load_dwordx4 v[140:143], v2, s[12:15], s36 offen offset:0 sc1
v_mfma_f32_16x16x32_bf16 v[72:75], a[48:51], v[184:187], v[72:75]
v_mfma_f32_16x16x32_bf16 v[76:79], a[48:51], v[188:191], v[76:79]
v_add_u32 v43, 4, v41
v_xor_b32 v43, v43, v40
v_lshl_add_u32 v45, v43, 4, v42
v_add_u32 v45, s77, v45
v_mfma_f32_16x16x32_bf16 v[80:83], a[52:55], v[176:179], v[80:83]
v_add_u32 v43, 8, v41
v_xor_b32 v43, v43, v40
v_lshl_add_u32 v46, v43, 4, v42
v_add_u32 v46, s77, v46
v_mfma_f32_16x16x32_bf16 v[84:87], a[52:55], v[180:183], v[84:87]
v_add_u32 v43, 12, v41
v_xor_b32 v43, v43, v40
v_lshl_add_u32 v47, v43, 4, v42
v_add_u32 v47, s77, v47
v_mfma_f32_16x16x32_bf16 v[88:91], a[52:55], v[184:187], v[88:91]
v_mfma_f32_16x16x32_bf16 v[92:95], a[52:55], v[188:191], v[92:95]
ds_read_b64_tr_b16 a[160:161], v20 offset:12288
v_mfma_f32_16x16x32_bf16 v[96:99], a[56:59], v[176:179], v[96:99]
ds_read_b64_tr_b16 a[162:163], v20 offset:14336
v_mfma_f32_16x16x32_bf16 v[100:103], a[56:59], v[180:183], v[100:103]
ds_read_b64_tr_b16 a[164:165], v21 offset:12288
v_mfma_f32_16x16x32_bf16 v[104:107], a[56:59], v[184:187], v[104:107]
ds_read_b64_tr_b16 a[166:167], v21 offset:14336
v_mfma_f32_16x16x32_bf16 v[108:111], a[56:59], v[188:191], v[108:111]
ds_read_b64_tr_b16 a[168:169], v22 offset:12288
v_mfma_f32_16x16x32_bf16 v[112:115], a[60:63], v[176:179], v[112:115]
ds_read_b64_tr_b16 a[170:171], v22 offset:14336
v_mfma_f32_16x16x32_bf16 v[116:119], a[60:63], v[180:183], v[116:119]
ds_read_b64_tr_b16 a[172:173], v23 offset:12288
v_mfma_f32_16x16x32_bf16 v[120:123], a[60:63], v[184:187], v[120:123]
ds_read_b64_tr_b16 a[174:175], v23 offset:14336
v_mfma_f32_16x16x32_bf16 v[124:127], a[60:63], v[188:191], v[124:127]
s_waitcnt vmcnt(16)
v_mfma_f32_16x16x32_bf16 v[64:67], a[0:3], v[192:195], v[64:67]
buffer_load_dwordx4 v[144:147], v2, s[12:15], s33 offen offset:1024 sc1
buffer_load_dwordx4 v[148:151], v2, s[12:15], s34 offen offset:1024 sc1
v_mfma_f32_16x16x32_bf16 v[68:71], a[0:3], v[196:199], v[68:71]
buffer_load_dwordx4 v[152:155], v2, s[12:15], s35 offen offset:1024 sc1
buffer_load_dwordx4 v[156:159], v2, s[12:15], s36 offen offset:1024 sc1
v_mfma_f32_16x16x32_bf16 v[72:75], a[0:3], v[200:203], v[72:75]
v_mfma_f32_16x16x32_bf16 v[76:79], a[0:3], v[204:207], v[76:79]
v_lshl_add_u32 v43, v41, 1, 0
v_xor_b32 v43, v43, v40
v_lshl_add_u32 v48, v43, 4, v42
v_add_u32 v48, s6, v48
v_add_u32 v52, 57344, v48
v_mfma_f32_16x16x32_bf16 v[80:83], a[4:7], v[192:195], v[80:83]
v_lshl_add_u32 v43, v41, 1, 1
v_xor_b32 v43, v43, v40
v_lshl_add_u32 v49, v43, 4, v42
v_add_u32 v49, s6, v49
v_add_u32 v53, 57344, v49
v_mfma_f32_16x16x32_bf16 v[84:87], a[4:7], v[196:199], v[84:87]
v_lshl_add_u32 v43, v41, 1, 8
v_xor_b32 v43, v43, v40
v_lshl_add_u32 v50, v43, 4, v42
v_add_u32 v50, s6, v50
v_add_u32 v54, 57344, v50
v_mfma_f32_16x16x32_bf16 v[88:91], a[4:7], v[200:203], v[88:91]
v_mfma_f32_16x16x32_bf16 v[92:95], a[4:7], v[204:207], v[92:95]
ds_read_b64_tr_b16 a[176:177], v20 offset:16384
v_mfma_f32_16x16x32_bf16 v[96:99], a[8:11], v[192:195], v[96:99]
ds_read_b64_tr_b16 a[178:179], v20 offset:18432
v_mfma_f32_16x16x32_bf16 v[100:103], a[8:11], v[196:199], v[100:103]
ds_read_b64_tr_b16 a[180:181], v21 offset:16384
v_mfma_f32_16x16x32_bf16 v[104:107], a[8:11], v[200:203], v[104:107]
ds_read_b64_tr_b16 a[182:183], v21 offset:18432
v_mfma_f32_16x16x32_bf16 v[108:111], a[8:11], v[204:207], v[108:111]
ds_read_b64_tr_b16 a[184:185], v22 offset:16384
v_mfma_f32_16x16x32_bf16 v[112:115], a[12:15], v[192:195], v[112:115]
ds_read_b64_tr_b16 a[186:187], v22 offset:18432
v_mfma_f32_16x16x32_bf16 v[116:119], a[12:15], v[196:199], v[116:119]
ds_read_b64_tr_b16 a[188:189], v23 offset:16384
v_mfma_f32_16x16x32_bf16 v[120:123], a[12:15], v[200:203], v[120:123]
ds_read_b64_tr_b16 a[190:191], v23 offset:18432
v_mfma_f32_16x16x32_bf16 v[124:127], a[12:15], v[204:207], v[124:127]
s_waitcnt vmcnt(16)
v_mfma_f32_16x16x32_bf16 v[64:67], a[16:19], v[208:211], v[64:67]
buffer_load_dwordx4 v[160:163], v2, s[12:15], s33 offen offset:2048 sc1
buffer_load_dwordx4 v[164:167], v2, s[12:15], s34 offen offset:2048 sc1
v_mfma_f32_16x16x32_bf16 v[68:71], a[16:19], v[212:215], v[68:71]
buffer_load_dwordx4 v[168:171], v2, s[12:15], s35 offen offset:2048 sc1
buffer_load_dwordx4 v[172:175], v2, s[12:15], s36 offen offset:2048 sc1
v_mfma_f32_16x16x32_bf16 v[72:75], a[16:19], v[216:219], v[72:75]
v_mfma_f32_16x16x32_bf16 v[76:79], a[16:19], v[220:223], v[76:79]
v_lshl_add_u32 v43, v41, 1, 9
v_xor_b32 v43, v43, v40
v_lshl_add_u32 v51, v43, 4, v42
v_add_u32 v51, s6, v51
v_add_u32 v55, 57344, v51
v_mfma_f32_16x16x32_bf16 v[80:83], a[20:23], v[208:211], v[80:83]
v_mfma_f32_16x16x32_bf16 v[84:87], a[20:23], v[212:215], v[84:87]
v_mfma_f32_16x16x32_bf16 v[88:91], a[20:23], v[216:219], v[88:91]
v_mfma_f32_16x16x32_bf16 v[92:95], a[20:23], v[220:223], v[92:95]
ds_read_b64_tr_b16 a[192:193], v20 offset:20480
v_mfma_f32_16x16x32_bf16 v[96:99], a[24:27], v[208:211], v[96:99]
ds_read_b64_tr_b16 a[194:195], v20 offset:22528
v_mfma_f32_16x16x32_bf16 v[100:103], a[24:27], v[212:215], v[100:103]
ds_read_b64_tr_b16 a[196:197], v21 offset:20480
v_mfma_f32_16x16x32_bf16 v[104:107], a[24:27], v[216:219], v[104:107]
ds_read_b64_tr_b16 a[198:199], v21 offset:22528
v_mfma_f32_16x16x32_bf16 v[108:111], a[24:27], v[220:223], v[108:111]
ds_read_b64_tr_b16 a[200:201], v22 offset:20480
v_mfma_f32_16x16x32_bf16 v[112:115], a[28:31], v[208:211], v[112:115]
ds_read_b64_tr_b16 a[202:203], v22 offset:22528
v_mfma_f32_16x16x32_bf16 v[116:119], a[28:31], v[212:215], v[116:119]
ds_read_b64_tr_b16 a[204:205], v23 offset:20480
v_mfma_f32_16x16x32_bf16 v[120:123], a[28:31], v[216:219], v[120:123]
ds_read_b64_tr_b16 a[206:207], v23 offset:22528
v_mfma_f32_16x16x32_bf16 v[124:127], a[28:31], v[220:223], v[124:127]
s_waitcnt vmcnt(16)
v_mfma_f32_16x16x32_bf16 v[64:67], a[96:99], v[224:227], v[64:67]
buffer_load_dwordx4 v[176:179], v2, s[12:15], s33 offen offset:3072 sc1
buffer_load_dwordx4 v[180:183], v2, s[12:15], s34 offen offset:3072 sc1
v_mfma_f32_16x16x32_bf16 v[68:71], a[96:99], v[228:231], v[68:71]
buffer_load_dwordx4 v[184:187], v2, s[12:15], s35 offen offset:3072 sc1
buffer_load_dwordx4 v[188:191], v2, s[12:15], s36 offen offset:3072 sc1
v_mfma_f32_16x16x32_bf16 v[72:75], a[96:99], v[232:235], v[72:75]
s_add_u32 s33, s33, 4096
s_add_u32 s34, s34, 4096
v_mfma_f32_16x16x32_bf16 v[76:79], a[96:99], v[236:239], v[76:79]
s_add_u32 s35, s35, 4096
s_add_u32 s36, s36, 4096
v_mfma_f32_16x16x32_bf16 v[80:83], a[100:103], v[224:227], v[80:83]
v_mfma_f32_16x16x32_bf16 v[84:87], a[100:103], v[228:231], v[84:87]
v_mfma_f32_16x16x32_bf16 v[88:91], a[100:103], v[232:235], v[88:91]
v_mfma_f32_16x16x32_bf16 v[92:95], a[100:103], v[236:239], v[92:95]
ds_read_b64_tr_b16 a[208:209], v20 offset:24576
v_mfma_f32_16x16x32_bf16 v[96:99], a[104:107], v[224:227], v[96:99]
ds_read_b64_tr_b16 a[210:211], v20 offset:26624
v_mfma_f32_16x16x32_bf16 v[100:103], a[104:107], v[228:231], v[100:103]
ds_read_b64_tr_b16 a[212:213], v21 offset:24576
v_mfma_f32_16x16x32_bf16 v[104:107], a[104:107], v[232:235], v[104:107]
ds_read_b64_tr_b16 a[214:215], v21 offset:26624
v_mfma_f32_16x16x32_bf16 v[108:111], a[104:107], v[236:239], v[108:111]
ds_read_b64_tr_b16 a[216:217], v22 offset:24576
v_mfma_f32_16x16x32_bf16 v[112:115], a[108:111], v[224:227], v[112:115]
ds_read_b64_tr_b16 a[218:219], v22 offset:26624
v_mfma_f32_16x16x32_bf16 v[116:119], a[108:111], v[228:231], v[116:119]
ds_read_b64_tr_b16 a[220:221], v23 offset:24576
v_mfma_f32_16x16x32_bf16 v[120:123], a[108:111], v[232:235], v[120:123]
ds_read_b64_tr_b16 a[222:223], v23 offset:26624
v_mfma_f32_16x16x32_bf16 v[124:127], a[108:111], v[236:239], v[124:127]
s_waitcnt vmcnt(16) lgkmcnt(15)
v_mfma_f32_16x16x32_bf16 v[64:67], a[112:115], v[240:243], v[64:67]
buffer_load_dwordx4 v[192:195], v2, s[12:15], s33 offen offset:0 sc1
buffer_load_dwordx4 v[196:199], v2, s[12:15], s34 offen offset:0 sc1
v_mfma_f32_16x16x32_bf16 v[68:71], a[112:115], v[244:247], v[68:71]
buffer_load_dwordx4 v[200:203], v2, s[12:15], s35 offen offset:0 sc1
buffer_load_dwordx4 v[204:207], v2, s[12:15], s36 offen offset:0 sc1
v_mfma_f32_16x16x32_bf16 v[72:75], a[112:115], v[248:251], v[72:75]
v_mfma_f32_16x16x32_bf16 v[76:79], a[112:115], v[252:255], v[76:79]
v_mfma_f32_16x16x32_bf16 v[80:83], a[116:119], v[240:243], v[80:83]
v_mfma_f32_16x16x32_bf16 v[84:87], a[116:119], v[244:247], v[84:87]
v_mfma_f32_16x16x32_bf16 v[88:91], a[116:119], v[248:251], v[88:91]
v_mfma_f32_16x16x32_bf16 v[92:95], a[116:119], v[252:255], v[92:95]
v_mfma_f32_16x16x32_bf16 v[96:99], a[120:123], v[240:243], v[96:99]
v_mfma_f32_16x16x32_bf16 v[100:103], a[120:123], v[244:247], v[100:103]
v_mfma_f32_16x16x32_bf16 v[104:107], a[120:123], v[248:251], v[104:107]
v_mfma_f32_16x16x32_bf16 v[108:111], a[120:123], v[252:255], v[108:111]
v_mfma_f32_16x16x32_bf16 v[112:115], a[124:127], v[240:243], v[112:115]
v_mfma_f32_16x16x32_bf16 v[116:119], a[124:127], v[244:247], v[116:119]
v_mfma_f32_16x16x32_bf16 v[120:123], a[124:127], v[248:251], v[120:123]
v_mfma_f32_16x16x32_bf16 v[124:127], a[124:127], v[252:255], v[124:127]
s_waitcnt vmcnt(16)
v_mfma_f32_16x16x32_bf16 v[64:67], a[128:131], v[128:131], v[64:67]
buffer_load_dwordx4 v[208:211], v2, s[12:15], s33 offen offset:1024 sc1
buffer_load_dwordx4 v[212:215], v2, s[12:15], s34 offen offset:1024 sc1
v_mfma_f32_16x16x32_bf16 v[68:71], a[128:131], v[132:135], v[68:71]
buffer_load_dwordx4 v[216:219], v2, s[12:15], s35 offen offset:1024 sc1
buffer_load_dwordx4 v[220:223], v2, s[12:15], s36 offen offset:1024 sc1
v_mfma_f32_16x16x32_bf16 v[72:75], a[128:131], v[136:139], v[72:75]
v_mfma_f32_16x16x32_bf16 v[76:79], a[128:131], v[140:143], v[76:79]
v_mfma_f32_16x16x32_bf16 v[80:83], a[132:135], v[128:131], v[80:83]
v_mfma_f32_16x16x32_bf16 v[84:87], a[132:135], v[132:135], v[84:87]
v_mfma_f32_16x16x32_bf16 v[88:91], a[132:135], v[136:139], v[88:91]
v_mfma_f32_16x16x32_bf16 v[92:95], a[132:135], v[140:143], v[92:95]
v_mfma_f32_16x16x32_bf16 v[96:99], a[136:139], v[128:131], v[96:99]
v_mfma_f32_16x16x32_bf16 v[100:103], a[136:139], v[132:135], v[100:103]
v_mfma_f32_16x16x32_bf16 v[104:107], a[136:139], v[136:139], v[104:107]
v_mfma_f32_16x16x32_bf16 v[108:111], a[136:139], v[140:143], v[108:111]
v_mfma_f32_16x16x32_bf16 v[112:115], a[140:143], v[128:131], v[112:115]
v_mfma_f32_16x16x32_bf16 v[116:119], a[140:143], v[132:135], v[116:119]
v_mfma_f32_16x16x32_bf16 v[120:123], a[140:143], v[136:139], v[120:123]
v_mfma_f32_16x16x32_bf16 v[124:127], a[140:143], v[140:143], v[124:127]
s_waitcnt vmcnt(16)
v_mfma_f32_16x16x32_bf16 v[64:67], a[144:147], v[144:147], v[64:67]
v_mfma_f32_16x16x32_bf16 v[68:71], a[144:147], v[148:151], v[68:71]
v_mfma_f32_16x16x32_bf16 v[72:75], a[144:147], v[152:155], v[72:75]
v_mfma_f32_16x16x32_bf16 v[76:79], a[144:147], v[156:159], v[76:79]
v_lshrrev_b32 v56, 4, v1
v_lshlrev_b32 v56, 5, v56
v_mfma_f32_16x16x32_bf16 v[80:83], a[148:151], v[144:147], v[80:83]
s_lshl_b32 s41, s29, 8
s_add_u32 s41, s41, 35660544
v_mfma_f32_16x16x32_bf16 v[84:87], a[148:151], v[148:151], v[84:87]
buffer_load_dwordx4 v[24:27], v56, s[12:15], s41 offen offset:0 sc1
buffer_load_dwordx4 v[28:31], v56, s[12:15], s41 offen offset:16 sc1
v_mfma_f32_16x16x32_bf16 v[88:91], a[148:151], v[152:155], v[88:91]
buffer_load_dwordx4 v[32:35], v56, s[12:15], s41 offen offset:128 sc1
buffer_load_dwordx4 v[36:39], v56, s[12:15], s41 offen offset:144 sc1
v_mfma_f32_16x16x32_bf16 v[92:95], a[148:151], v[156:159], v[92:95]
v_mfma_f32_16x16x32_bf16 v[96:99], a[152:155], v[144:147], v[96:99]
v_mfma_f32_16x16x32_bf16 v[100:103], a[152:155], v[148:151], v[100:103]
v_mfma_f32_16x16x32_bf16 v[104:107], a[152:155], v[152:155], v[104:107]
v_mfma_f32_16x16x32_bf16 v[108:111], a[152:155], v[156:159], v[108:111]
v_mfma_f32_16x16x32_bf16 v[112:115], a[156:159], v[144:147], v[112:115]
v_mfma_f32_16x16x32_bf16 v[116:119], a[156:159], v[148:151], v[116:119]
v_mfma_f32_16x16x32_bf16 v[120:123], a[156:159], v[152:155], v[120:123]
v_mfma_f32_16x16x32_bf16 v[124:127], a[156:159], v[156:159], v[124:127]
s_waitcnt vmcnt(16)
v_mfma_f32_16x16x32_bf16 v[64:67], a[160:163], v[160:163], v[64:67]
v_mfma_f32_16x16x32_bf16 v[68:71], a[160:163], v[164:167], v[68:71]
v_mfma_f32_16x16x32_bf16 v[72:75], a[160:163], v[168:171], v[72:75]
v_mfma_f32_16x16x32_bf16 v[76:79], a[160:163], v[172:175], v[76:79]
v_mfma_f32_16x16x32_bf16 v[80:83], a[164:167], v[160:163], v[80:83]
v_mfma_f32_16x16x32_bf16 v[84:87], a[164:167], v[164:167], v[84:87]
v_mfma_f32_16x16x32_bf16 v[88:91], a[164:167], v[168:171], v[88:91]
v_mfma_f32_16x16x32_bf16 v[92:95], a[164:167], v[172:175], v[92:95]
v_mfma_f32_16x16x32_bf16 v[96:99], a[168:171], v[160:163], v[96:99]
v_mfma_f32_16x16x32_bf16 v[100:103], a[168:171], v[164:167], v[100:103]
v_mfma_f32_16x16x32_bf16 v[104:107], a[168:171], v[168:171], v[104:107]
v_mfma_f32_16x16x32_bf16 v[108:111], a[168:171], v[172:175], v[108:111]
v_mfma_f32_16x16x32_bf16 v[112:115], a[172:175], v[160:163], v[112:115]
v_mfma_f32_16x16x32_bf16 v[116:119], a[172:175], v[164:167], v[116:119]
v_mfma_f32_16x16x32_bf16 v[120:123], a[172:175], v[168:171], v[120:123]
v_mfma_f32_16x16x32_bf16 v[124:127], a[172:175], v[172:175], v[124:127]
s_waitcnt vmcnt(12)
v_mfma_f32_16x16x32_bf16 v[64:67], a[176:179], v[176:179], v[64:67]
v_mfma_f32_16x16x32_bf16 v[68:71], a[176:179], v[180:183], v[68:71]
v_mfma_f32_16x16x32_bf16 v[72:75], a[176:179], v[184:187], v[72:75]
v_mfma_f32_16x16x32_bf16 v[76:79], a[176:179], v[188:191], v[76:79]
v_mfma_f32_16x16x32_bf16 v[80:83], a[180:183], v[176:179], v[80:83]
v_mfma_f32_16x16x32_bf16 v[84:87], a[180:183], v[180:183], v[84:87]
v_mfma_f32_16x16x32_bf16 v[88:91], a[180:183], v[184:187], v[88:91]
v_mfma_f32_16x16x32_bf16 v[92:95], a[180:183], v[188:191], v[92:95]
v_mfma_f32_16x16x32_bf16 v[96:99], a[184:187], v[176:179], v[96:99]
v_mfma_f32_16x16x32_bf16 v[100:103], a[184:187], v[180:183], v[100:103]
v_mfma_f32_16x16x32_bf16 v[104:107], a[184:187], v[184:187], v[104:107]
v_mfma_f32_16x16x32_bf16 v[108:111], a[184:187], v[188:191], v[108:111]
v_mfma_f32_16x16x32_bf16 v[112:115], a[188:191], v[176:179], v[112:115]
v_mfma_f32_16x16x32_bf16 v[116:119], a[188:191], v[180:183], v[116:119]
v_mfma_f32_16x16x32_bf16 v[120:123], a[188:191], v[184:187], v[120:123]
v_mfma_f32_16x16x32_bf16 v[124:127], a[188:191], v[188:191], v[124:127]
s_waitcnt vmcnt(8) lgkmcnt(8)
v_mfma_f32_16x16x32_bf16 v[64:67], a[192:195], v[192:195], v[64:67]
v_mfma_f32_16x16x32_bf16 v[68:71], a[192:195], v[196:199], v[68:71]
v_mfma_f32_16x16x32_bf16 v[72:75], a[192:195], v[200:203], v[72:75]
v_mfma_f32_16x16x32_bf16 v[76:79], a[192:195], v[204:207], v[76:79]
v_mfma_f32_16x16x32_bf16 v[80:83], a[196:199], v[192:195], v[80:83]
v_mfma_f32_16x16x32_bf16 v[84:87], a[196:199], v[196:199], v[84:87]
v_mfma_f32_16x16x32_bf16 v[88:91], a[196:199], v[200:203], v[88:91]
v_mfma_f32_16x16x32_bf16 v[92:95], a[196:199], v[204:207], v[92:95]
v_mfma_f32_16x16x32_bf16 v[96:99], a[200:203], v[192:195], v[96:99]
v_mfma_f32_16x16x32_bf16 v[100:103], a[200:203], v[196:199], v[100:103]
v_mfma_f32_16x16x32_bf16 v[104:107], a[200:203], v[200:203], v[104:107]
v_mfma_f32_16x16x32_bf16 v[108:111], a[200:203], v[204:207], v[108:111]
v_mfma_f32_16x16x32_bf16 v[112:115], a[204:207], v[192:195], v[112:115]
v_mfma_f32_16x16x32_bf16 v[116:119], a[204:207], v[196:199], v[116:119]
v_mfma_f32_16x16x32_bf16 v[120:123], a[204:207], v[200:203], v[120:123]
v_mfma_f32_16x16x32_bf16 v[124:127], a[204:207], v[204:207], v[124:127]
s_waitcnt vmcnt(4) lgkmcnt(0)
v_mfma_f32_16x16x32_bf16 v[64:67], a[208:211], v[208:211], v[64:67]
v_mfma_f32_16x16x32_bf16 v[68:71], a[208:211], v[212:215], v[68:71]
v_mfma_f32_16x16x32_bf16 v[72:75], a[208:211], v[216:219], v[72:75]
v_mfma_f32_16x16x32_bf16 v[76:79], a[208:211], v[220:223], v[76:79]
v_mfma_f32_16x16x32_bf16 v[80:83], a[212:215], v[208:211], v[80:83]
v_mfma_f32_16x16x32_bf16 v[84:87], a[212:215], v[212:215], v[84:87]
v_mfma_f32_16x16x32_bf16 v[88:91], a[212:215], v[216:219], v[88:91]
v_mfma_f32_16x16x32_bf16 v[92:95], a[212:215], v[220:223], v[92:95]
v_mfma_f32_16x16x32_bf16 v[96:99], a[216:219], v[208:211], v[96:99]
v_mfma_f32_16x16x32_bf16 v[100:103], a[216:219], v[212:215], v[100:103]
v_mfma_f32_16x16x32_bf16 v[104:107], a[216:219], v[216:219], v[104:107]
v_mfma_f32_16x16x32_bf16 v[108:111], a[216:219], v[220:223], v[108:111]
v_mfma_f32_16x16x32_bf16 v[112:115], a[220:223], v[208:211], v[112:115]
v_mfma_f32_16x16x32_bf16 v[116:119], a[220:223], v[212:215], v[116:119]
v_mfma_f32_16x16x32_bf16 v[120:123], a[220:223], v[216:219], v[120:123]
v_mfma_f32_16x16x32_bf16 v[124:127], a[220:223], v[220:223], v[124:127]
ds_write_b128 v44, v[64:67] offset:0
ds_write_b128 v44, v[68:71] offset:4096
ds_write_b128 v44, v[72:75] offset:8192
ds_write_b128 v44, v[76:79] offset:12288
ds_write_b128 v45, v[80:83] offset:0
ds_write_b128 v45, v[84:87] offset:4096
ds_write_b128 v45, v[88:91] offset:8192
ds_write_b128 v45, v[92:95] offset:12288
ds_write_b128 v46, v[96:99] offset:0
ds_write_b128 v46, v[100:103] offset:4096
ds_write_b128 v46, v[104:107] offset:8192
ds_write_b128 v46, v[108:111] offset:12288
ds_write_b128 v47, v[112:115] offset:0
ds_write_b128 v47, v[116:119] offset:4096
ds_write_b128 v47, v[120:123] offset:8192
ds_write_b128 v47, v[124:127] offset:12288
s_waitcnt lgkmcnt(0)
s_barrier
ds_read_b128 v[128:131], v48 offset:0
ds_read_b128 v[132:135], v49 offset:0
ds_read_b128 v[136:139], v50 offset:0
ds_read_b128 v[140:143], v51 offset:0
ds_read_b128 v[144:147], v48 offset:28672
ds_read_b128 v[148:151], v49 offset:28672
ds_read_b128 v[152:155], v50 offset:28672
ds_read_b128 v[156:159], v51 offset:28672
ds_read_b128 v[160:163], v52 offset:0
ds_read_b128 v[164:167], v53 offset:0
ds_read_b128 v[168:171], v54 offset:0
ds_read_b128 v[172:175], v55 offset:0
ds_read_b128 v[176:179], v52 offset:28672
ds_read_b128 v[180:183], v53 offset:28672
ds_read_b128 v[184:187], v54 offset:28672
ds_read_b128 v[188:191], v55 offset:28672
v_lshlrev_b32 v192, 16, v4
v_and_b32 v193, 0xffff0000, v4
v_lshlrev_b32 v194, 16, v5
v_and_b32 v195, 0xffff0000, v5
v_lshlrev_b32 v196, 16, v6
v_and_b32 v197, 0xffff0000, v6
v_lshlrev_b32 v198, 16, v7
v_and_b32 v199, 0xffff0000, v7
v_lshlrev_b32 v200, 16, v8
v_and_b32 v201, 0xffff0000, v8
v_lshlrev_b32 v202, 16, v9
v_and_b32 v203, 0xffff0000, v9
v_lshlrev_b32 v204, 16, v10
v_and_b32 v205, 0xffff0000, v10
v_lshlrev_b32 v206, 16, v11
v_and_b32 v207, 0xffff0000, v11
s_waitcnt lgkmcnt(8)
v_pk_add_f32 v[128:129], v[128:129], v[144:145]
v_pk_add_f32 v[130:131], v[130:131], v[146:147]
v_pk_add_f32 v[132:133], v[132:133], v[148:149]
v_pk_add_f32 v[134:135], v[134:135], v[150:151]
v_pk_add_f32 v[136:137], v[136:137], v[152:153]
v_pk_add_f32 v[138:139], v[138:139], v[154:155]
v_pk_add_f32 v[140:141], v[140:141], v[156:157]
v_pk_add_f32 v[142:143], v[142:143], v[158:159]
s_waitcnt lgkmcnt(0)
v_pk_add_f32 v[160:161], v[160:161], v[176:177]
v_pk_add_f32 v[162:163], v[162:163], v[178:179]
v_pk_add_f32 v[164:165], v[164:165], v[180:181]
v_pk_add_f32 v[166:167], v[166:167], v[182:183]
v_pk_add_f32 v[168:169], v[168:169], v[184:185]
v_pk_add_f32 v[170:171], v[170:171], v[186:187]
v_pk_add_f32 v[172:173], v[172:173], v[188:189]
v_pk_add_f32 v[174:175], v[174:175], v[190:191]
v_pk_add_f32 v[128:129], v[128:129], v[160:161]
v_pk_add_f32 v[130:131], v[130:131], v[162:163]
v_pk_add_f32 v[132:133], v[132:133], v[164:165]
v_pk_add_f32 v[134:135], v[134:135], v[166:167]
v_pk_add_f32 v[136:137], v[136:137], v[168:169]
v_pk_add_f32 v[138:139], v[138:139], v[170:171]
v_pk_add_f32 v[140:141], v[140:141], v[172:173]
v_pk_add_f32 v[142:143], v[142:143], v[174:175]
s_waitcnt vmcnt(0)
v_fmac_f32 v192, v128, v24
v_fmac_f32 v193, v129, v25
v_fmac_f32 v194, v130, v26
v_fmac_f32 v195, v131, v27
v_fmac_f32 v196, v132, v28
v_fmac_f32 v197, v133, v29
v_fmac_f32 v198, v134, v30
v_fmac_f32 v199, v135, v31
v_fmac_f32 v200, v136, v32
v_fmac_f32 v201, v137, v33
v_fmac_f32 v202, v138, v34
v_fmac_f32 v203, v139, v35
v_fmac_f32 v204, v140, v36
v_fmac_f32 v205, v141, v37
v_fmac_f32 v206, v142, v38
v_fmac_f32 v207, v143, v39
v_cvt_pk_bf16_f32 v64, v192, v193
v_cvt_pk_bf16_f32 v65, v194, v195
v_cvt_pk_bf16_f32 v66, v196, v197
v_cvt_pk_bf16_f32 v67, v198, v199
v_cvt_pk_bf16_f32 v68, v200, v201
v_cvt_pk_bf16_f32 v69, v202, v203
v_cvt_pk_bf16_f32 v70, v204, v205
v_cvt_pk_bf16_f32 v71, v206, v207
buffer_store_dwordx4 v[64:67], v57, s[20:23], s39 offen offset:0 sc1
buffer_store_dwordx4 v[68:71], v57, s[20:23], s39 offen offset:64 sc1
s_branch tl_end
tl_prep:
v_mov_b32 v61, s53
s_waitcnt vmcnt(0)
buffer_atomic_or v61, v62, s[12:15], s52 offen sc1
tl_end:
at_end:
s_endpgm
at_half:
v_xor_b32 v4, 0x10000, v4
v_xor_b32 v5, 0x10000, v5
s_xor_b32 s36, s36, 0x10000
s_xor_b32 s7, s7, 0x10000
s_branch at_tail
at_qflag:
v_mov_b32 v6, 0
buffer_atomic_or v6, v20, s[12:15], s68 offen sc0 sc1
s_cmp_lt_u32 s66, 2
s_mov_b32 s66, 0
s_cbranch_scc1 at_qret
v_mov_b32 v108, 1
buffer_atomic_or v108, v109, s[12:15], s59 offen sc1
s_branch at_qret
at_w0spin:
s_mov_b32 s61, 0x200000
at_w0spin1:
s_sleep 4
v_mov_b32 v108, 0
buffer_atomic_or v108, v109, s[20:23], s69 offen sc0 sc1
s_waitcnt vmcnt(0)
v_readfirstlane_b32 s60, v108
s_nop 0
s_cmp_eq_u32 s60, 1
s_cbranch_scc1 at_w0spun
s_sub_u32 s61, s61, 1
s_cmp_lg_u32 s61, 0
s_cbranch_scc1 at_w0spin1
s_branch at_w0spun
at_w1spin:
s_mov_b32 s61, 0x200000
at_w1spin1:
s_sleep 4
v_mov_b32 v108, 0
buffer_atomic_or v108, v109, s[20:23], s69 offen sc0 sc1
s_waitcnt vmcnt(0)
v_readfirstlane_b32 s60, v108
s_nop 0
s_cmp_eq_u32 s60, 1
s_cbranch_scc1 at_w1spun
s_sub_u32 s61, s61, 1
s_cmp_lg_u32 s61, 0
s_cbranch_scc1 at_w1spin1
s_branch at_w1spun
at_w2spin:
s_mov_b32 s61, 0x200000
at_w2spin1:
s_sleep 4
v_mov_b32 v108, 0
buffer_atomic_or v108, v109, s[20:23], s69 offen sc0 sc1
s_waitcnt vmcnt(0)
v_readfirstlane_b32 s60, v108
s_nop 0
s_cmp_eq_u32 s60, 1
s_cbranch_scc1 at_w2spun
s_sub_u32 s61, s61, 1
s_cmp_lg_u32 s61, 0
s_cbranch_scc1 at_w2spin1
s_branch at_w2spun
at_w3spin:
s_mov_b32 s61, 0x200000
at_w3spin1:
s_sleep 4
v_mov_b32 v108, 0
buffer_atomic_or v108, v109, s[20:23], s69 offen sc0 sc1
s_waitcnt vmcnt(0)
v_readfirstlane_b32 s60, v108
s_nop 0
s_cmp_eq_u32 s60, 1
s_cbranch_scc1 at_w3spun
s_sub_u32 s61, s61, 1
s_cmp_lg_u32 s61, 0
s_cbranch_scc1 at_w3spin1
s_branch at_w3spun
at_wfspin:
s_mov_b32 s61, 0x200000
at_wfspin1:
s_sleep 4
v_mov_b32 v108, 0
buffer_atomic_or v108, v109, s[20:23], s69 offen sc0 sc1
s_waitcnt vmcnt(0)
v_readfirstlane_b32 s60, v108
s_nop 0
s_cmp_eq_u32 s60, 1
s_cbranch_scc1 at_wfspun
s_sub_u32 s61, s61, 1
s_cmp_lg_u32 s61, 0
s_cbranch_scc1 at_wfspin1
s_branch at_wfspun
at_kspin:
at_k2spin:
s_mov_b32 s61, 0x200000
at_k2spin1:
s_sleep 4
v_mov_b32 v6, 0
buffer_atomic_or v6, v20, s[12:15], s69 offen sc0 sc1
s_waitcnt vmcnt(0)
v_readfirstlane_b32 s60, v6
s_nop 0
s_and_b32 s51, s60, 0xffff
s_cmp_eq_u32 s51, 0xffff
s_cbranch_scc1 at_k2spun
s_sub_u32 s61, s61, 1
s_cmp_lg_u32 s61, 0
s_cbranch_scc1 at_k2spin1
s_branch at_k2spun
at_k2spun:
s_branch at_kspun
at_h0spin:
s_mov_b32 s61, 0x200000
at_h0spin1:
s_sleep 4
v_mov_b32 v6, 0
buffer_atomic_or v6, v20, s[12:15], s67 offen sc0 sc1
s_waitcnt vmcnt(0)
v_readfirstlane_b32 s60, v6
s_nop 0
s_lshr_b32 s51, s60, 16
s_cmp_eq_u32 s51, 0xff
s_cbranch_scc1 at_h0spun
s_sub_u32 s61, s61, 1
s_cmp_lg_u32 s61, 0
s_cbranch_scc1 at_h0spin1
s_branch at_h0spun
at_h1spin:
s_mov_b32 s61, 0x200000
at_h1spin1:
s_sleep 4
v_mov_b32 v6, 0
buffer_atomic_or v6, v20, s[12:15], s67 offen sc0 sc1
s_waitcnt vmcnt(0)
v_readfirstlane_b32 s60, v6
s_nop 0
s_lshr_b32 s51, s60, 16
s_cmp_eq_u32 s51, 0xff
s_cbranch_scc1 at_h1spun
s_sub_u32 s61, s61, 1
s_cmp_lg_u32 s61, 0
s_cbranch_scc1 at_h1spin1
s_branch at_h1spun
at_m0:
s_mov_b32 s40, 0x200000
at_m0l:
s_sleep 4
buffer_load_dword v6, v7, s[8:11], 0 offen offset:4 sc1
buffer_load_dword v21, v7, s[8:11], 0 offen offset:132 sc1
s_waitcnt vmcnt(0)
v_readfirstlane_b32 s39, v6
v_readfirstlane_b32 s38, v21
s_nop 0
s_add_u32 s39, s39, s38
s_cmp_ge_u32 s39, 336
s_cbranch_scc1 at_m0r
s_sub_u32 s40, s40, 1
s_cmp_lg_u32 s40, 0
s_cbranch_scc1 at_m0l
s_branch at_m0r
at_m1:
s_mov_b32 s40, 0x200000
at_m1l:
s_sleep 4
buffer_load_dword v6, v7, s[8:11], 0 offen offset:4 sc1
buffer_load_dword v21, v7, s[8:11], 0 offen offset:132 sc1
s_waitcnt vmcnt(0)
v_readfirstlane_b32 s39, v6
v_readfirstlane_b32 s38, v21
s_nop 0
s_add_u32 s39, s39, s38
s_cmp_ge_u32 s39, 336
s_cbranch_scc1 at_m1r
s_sub_u32 s40, s40, 1
s_cmp_lg_u32 s40, 0
s_cbranch_scc1 at_m1l
s_branch at_m1r
at_f:
s_mov_b32 s71, 0
v_readfirstlane_b32 s60, v6
s_nop 0
s_and_b32 s51, s60, 0xffff
s_cmp_eq_u32 s51, 0xffff
s_cbranch_scc1 at_fspun
at_fspin:
s_mov_b32 s61, 0x200000
at_fspin1:
s_sleep 4
v_mov_b32 v6, 0
buffer_atomic_or v6, v20, s[12:15], s68 offen sc0 sc1
s_waitcnt vmcnt(0)
v_readfirstlane_b32 s60, v6
s_nop 0
s_and_b32 s51, s60, 0xffff
s_cmp_eq_u32 s51, 0xffff
s_cbranch_scc1 at_fspun
s_sub_u32 s61, s61, 1
s_cmp_lg_u32 s61, 0
s_cbranch_scc1 at_fspin1
s_branch at_fspun
at_g:
s_mov_b32 s71, 0
s_mov_b32 s66, 0
s_waitcnt vmcnt(0)
at_gspin:
s_mov_b32 s61, 0x200000
at_gspin1:
s_sleep 4
v_mov_b32 v6, 0
buffer_atomic_or v6, v20, s[12:15], s68 offen sc0 sc1
s_waitcnt vmcnt(0)
v_readfirstlane_b32 s60, v6
s_nop 0
s_and_b32 s51, s60, 0xffff
s_cmp_eq_u32 s51, 0xffff
s_cbranch_scc1 at_gspun
s_sub_u32 s61, s61, 1
s_cmp_lg_u32 s61, 0
s_cbranch_scc1 at_gspin1
s_branch at_gspun
at_slow:
v_min_f32 v100, v80, v104
v_sub_f32 v96, v100, v80
v_sub_f32 v98, v100, v104
v_exp_f32 v96, v96
v_exp_f32 v98, v98
v_mul_f32 v28, v28, v96
v_fmac_f32 v28, v106, v98
v_min_f32 v101, v84, v105
v_sub_f32 v97, v101, v84
v_sub_f32 v99, v101, v105
v_exp_f32 v97, v97
v_exp_f32 v99, v99
v_mul_f32 v29, v29, v97
v_fmac_f32 v29, v107, v99
s_waitcnt vmcnt(16)
v_accvgpr_read_b32 v88, a0
v_mul_f32 v128, v128, v96
v_mul_f32 v129, v129, v96
v_lshlrev_b32 v89, 16, v88
v_and_b32 v90, 0xffff0000, v88
v_fmac_f32 v128, v89, v98
v_fmac_f32 v129, v90, v98
v_accvgpr_read_b32 v88, a1
v_mul_f32 v130, v130, v96
v_mul_f32 v131, v131, v96
v_lshlrev_b32 v89, 16, v88
v_and_b32 v90, 0xffff0000, v88
v_fmac_f32 v130, v89, v98
v_fmac_f32 v131, v90, v98
v_accvgpr_read_b32 v88, a2
v_mul_f32 v136, v136, v96
v_mul_f32 v137, v137, v96
v_lshlrev_b32 v89, 16, v88
v_and_b32 v90, 0xffff0000, v88
v_fmac_f32 v136, v89, v98
v_fmac_f32 v137, v90, v98
v_accvgpr_read_b32 v88, a3
v_mul_f32 v138, v138, v96
v_mul_f32 v139, v139, v96
v_lshlrev_b32 v89, 16, v88
v_and_b32 v90, 0xffff0000, v88
v_fmac_f32 v138, v89, v98
v_fmac_f32 v139, v90, v98
v_accvgpr_read_b32 v88, a4
v_mul_f32 v144, v144, v96
v_mul_f32 v145, v145, v96
v_lshlrev_b32 v89, 16, v88
v_and_b32 v90, 0xffff0000, v88
v_fmac_f32 v144, v89, v98
v_fmac_f32 v145, v90, v98
v_accvgpr_read_b32 v88, a5
v_mul_f32 v146, v146, v96
v_mul_f32 v147, v147, v96
v_lshlrev_b32 v89, 16, v88
v_and_b32 v90, 0xffff0000, v88
v_fmac_f32 v146, v89, v98
v_fmac_f32 v147, v90, v98
v_accvgpr_read_b32 v88, a6
v_mul_f32 v152, v152, v96
v_mul_f32 v153, v153, v96
v_lshlrev_b32 v89, 16, v88
v_and_b32 v90, 0xffff0000, v88
v_fmac_f32 v152, v89, v98
v_fmac_f32 v153, v90, v98
v_accvgpr_read_b32 v88, a7
v_mul_f32 v154, v154, v96
v_mul_f32 v155, v155, v96
v_lshlrev_b32 v89, 16, v88
v_and_b32 v90, 0xffff0000, v88
v_fmac_f32 v154, v89, v98
v_fmac_f32 v155, v90, v98
v_accvgpr_read_b32 v88, a8
v_mul_f32 v160, v160, v96
v_mul_f32 v161, v161, v96
v_lshlrev_b32 v89, 16, v88
v_and_b32 v90, 0xffff0000, v88
v_fmac_f32 v160, v89, v98
v_fmac_f32 v161, v90, v98
v_accvgpr_read_b32 v88, a9
v_mul_f32 v162, v162, v96
v_mul_f32 v163, v163, v96
v_lshlrev_b32 v89, 16, v88
v_and_b32 v90, 0xffff0000, v88
v_fmac_f32 v162, v89, v98
v_fmac_f32 v163, v90, v98
v_accvgpr_read_b32 v88, a10
v_mul_f32 v168, v168, v96
v_mul_f32 v169, v169, v96
v_lshlrev_b32 v89, 16, v88
v_and_b32 v90, 0xffff0000, v88
v_fmac_f32 v168, v89, v98
v_fmac_f32 v169, v90, v98
v_accvgpr_read_b32 v88, a11
v_mul_f32 v170, v170, v96
v_mul_f32 v171, v171, v96
v_lshlrev_b32 v89, 16, v88
v_and_b32 v90, 0xffff0000, v88
v_fmac_f32 v170, v89, v98
v_fmac_f32 v171, v90, v98
v_accvgpr_read_b32 v88, a12
v_mul_f32 v176, v176, v96
v_mul_f32 v177, v177, v96
v_lshlrev_b32 v89, 16, v88
v_and_b32 v90, 0xffff0000, v88
v_fmac_f32 v176, v89, v98
v_fmac_f32 v177, v90, v98
v_accvgpr_read_b32 v88, a13
v_mul_f32 v178, v178, v96
v_mul_f32 v179, v179, v96
v_lshlrev_b32 v89, 16, v88
v_and_b32 v90, 0xffff0000, v88
v_fmac_f32 v178, v89, v98
v_fmac_f32 v179, v90, v98
v_accvgpr_read_b32 v88, a14
v_mul_f32 v184, v184, v96
v_mul_f32 v185, v185, v96
v_lshlrev_b32 v89, 16, v88
v_and_b32 v90, 0xffff0000, v88
v_fmac_f32 v184, v89, v98
v_fmac_f32 v185, v90, v98
v_accvgpr_read_b32 v88, a15
v_mul_f32 v186, v186, v96
v_mul_f32 v187, v187, v96
v_lshlrev_b32 v89, 16, v88
v_and_b32 v90, 0xffff0000, v88
v_fmac_f32 v186, v89, v98
v_fmac_f32 v187, v90, v98
v_accvgpr_read_b32 v88, a16
v_mul_f32 v192, v192, v96
v_mul_f32 v193, v193, v96
v_lshlrev_b32 v89, 16, v88
v_and_b32 v90, 0xffff0000, v88
v_fmac_f32 v192, v89, v98
v_fmac_f32 v193, v90, v98
v_accvgpr_read_b32 v88, a17
v_mul_f32 v194, v194, v96
v_mul_f32 v195, v195, v96
v_lshlrev_b32 v89, 16, v88
v_and_b32 v90, 0xffff0000, v88
v_fmac_f32 v194, v89, v98
v_fmac_f32 v195, v90, v98
v_accvgpr_read_b32 v88, a18
v_mul_f32 v200, v200, v96
v_mul_f32 v201, v201, v96
v_lshlrev_b32 v89, 16, v88
v_and_b32 v90, 0xffff0000, v88
v_fmac_f32 v200, v89, v98
v_fmac_f32 v201, v90, v98
v_accvgpr_read_b32 v88, a19
v_mul_f32 v202, v202, v96
v_mul_f32 v203, v203, v96
v_lshlrev_b32 v89, 16, v88
v_and_b32 v90, 0xffff0000, v88
v_fmac_f32 v202, v89, v98
v_fmac_f32 v203, v90, v98
v_accvgpr_read_b32 v88, a20
v_mul_f32 v208, v208, v96
v_mul_f32 v209, v209, v96
v_lshlrev_b32 v89, 16, v88
v_and_b32 v90, 0xffff0000, v88
v_fmac_f32 v208, v89, v98
v_fmac_f32 v209, v90, v98
v_accvgpr_read_b32 v88, a21
v_mul_f32 v210, v210, v96
v_mul_f32 v211, v211, v96
v_lshlrev_b32 v89, 16, v88
v_and_b32 v90, 0xffff0000, v88
v_fmac_f32 v210, v89, v98
v_fmac_f32 v211, v90, v98
v_accvgpr_read_b32 v88, a22
v_mul_f32 v216, v216, v96
v_mul_f32 v217, v217, v96
v_lshlrev_b32 v89, 16, v88
v_and_b32 v90, 0xffff0000, v88
v_fmac_f32 v216, v89, v98
v_fmac_f32 v217, v90, v98
v_accvgpr_read_b32 v88, a23
v_mul_f32 v218, v218, v96
v_mul_f32 v219, v219, v96
v_lshlrev_b32 v89, 16, v88
v_and_b32 v90, 0xffff0000, v88
v_fmac_f32 v218, v89, v98
v_fmac_f32 v219, v90, v98
v_accvgpr_read_b32 v88, a24
v_mul_f32 v224, v224, v96
v_mul_f32 v225, v225, v96
v_lshlrev_b32 v89, 16, v88
v_and_b32 v90, 0xffff0000, v88
v_fmac_f32 v224, v89, v98
v_fmac_f32 v225, v90, v98
v_accvgpr_read_b32 v88, a25
v_mul_f32 v226, v226, v96
v_mul_f32 v227, v227, v96
v_lshlrev_b32 v89, 16, v88
v_and_b32 v90, 0xffff0000, v88
v_fmac_f32 v226, v89, v98
v_fmac_f32 v227, v90, v98
v_accvgpr_read_b32 v88, a26
v_mul_f32 v232, v232, v96
v_mul_f32 v233, v233, v96
v_lshlrev_b32 v89, 16, v88
v_and_b32 v90, 0xffff0000, v88
v_fmac_f32 v232, v89, v98
v_fmac_f32 v233, v90, v98
v_accvgpr_read_b32 v88, a27
v_mul_f32 v234, v234, v96
v_mul_f32 v235, v235, v96
v_lshlrev_b32 v89, 16, v88
v_and_b32 v90, 0xffff0000, v88
v_fmac_f32 v234, v89, v98
v_fmac_f32 v235, v90, v98
v_accvgpr_read_b32 v88, a28
v_mul_f32 v240, v240, v96
v_mul_f32 v241, v241, v96
v_lshlrev_b32 v89, 16, v88
v_and_b32 v90, 0xffff0000, v88
v_fmac_f32 v240, v89, v98
v_fmac_f32 v241, v90, v98
v_accvgpr_read_b32 v88, a29
v_mul_f32 v242, v242, v96
v_mul_f32 v243, v243, v96
v_lshlrev_b32 v89, 16, v88
v_and_b32 v90, 0xffff0000, v88
v_fmac_f32 v242, v89, v98
v_fmac_f32 v243, v90, v98
v_accvgpr_read_b32 v88, a30
v_mul_f32 v248, v248, v96
v_mul_f32 v249, v249, v96
v_lshlrev_b32 v89, 16, v88
v_and_b32 v90, 0xffff0000, v88
v_fmac_f32 v248, v89, v98
v_fmac_f32 v249, v90, v98
v_accvgpr_read_b32 v88, a31
v_mul_f32 v250, v250, v96
v_mul_f32 v251, v251, v96
v_lshlrev_b32 v89, 16, v88
v_and_b32 v90, 0xffff0000, v88
v_fmac_f32 v250, v89, v98
v_fmac_f32 v251, v90, v98
v_accvgpr_read_b32 v88, a32
v_mul_f32 v132, v132, v97
v_mul_f32 v133, v133, v97
v_lshlrev_b32 v89, 16, v88
v_and_b32 v90, 0xffff0000, v88
v_fmac_f32 v132, v89, v99
v_fmac_f32 v133, v90, v99
v_accvgpr_read_b32 v88, a33
v_mul_f32 v134, v134, v97
v_mul_f32 v135, v135, v97
v_lshlrev_b32 v89, 16, v88
v_and_b32 v90, 0xffff0000, v88
v_fmac_f32 v134, v89, v99
v_fmac_f32 v135, v90, v99
v_accvgpr_read_b32 v88, a34
v_mul_f32 v140, v140, v97
v_mul_f32 v141, v141, v97
v_lshlrev_b32 v89, 16, v88
v_and_b32 v90, 0xffff0000, v88
v_fmac_f32 v140, v89, v99
v_fmac_f32 v141, v90, v99
v_accvgpr_read_b32 v88, a35
v_mul_f32 v142, v142, v97
v_mul_f32 v143, v143, v97
v_lshlrev_b32 v89, 16, v88
v_and_b32 v90, 0xffff0000, v88
v_fmac_f32 v142, v89, v99
v_fmac_f32 v143, v90, v99
v_accvgpr_read_b32 v88, a36
v_mul_f32 v148, v148, v97
v_mul_f32 v149, v149, v97
v_lshlrev_b32 v89, 16, v88
v_and_b32 v90, 0xffff0000, v88
v_fmac_f32 v148, v89, v99
v_fmac_f32 v149, v90, v99
v_accvgpr_read_b32 v88, a37
v_mul_f32 v150, v150, v97
v_mul_f32 v151, v151, v97
v_lshlrev_b32 v89, 16, v88
v_and_b32 v90, 0xffff0000, v88
v_fmac_f32 v150, v89, v99
v_fmac_f32 v151, v90, v99
v_accvgpr_read_b32 v88, a38
v_mul_f32 v156, v156, v97
v_mul_f32 v157, v157, v97
v_lshlrev_b32 v89, 16, v88
v_and_b32 v90, 0xffff0000, v88
v_fmac_f32 v156, v89, v99
v_fmac_f32 v157, v90, v99
v_accvgpr_read_b32 v88, a39
v_mul_f32 v158, v158, v97
v_mul_f32 v159, v159, v97
v_lshlrev_b32 v89, 16, v88
v_and_b32 v90, 0xffff0000, v88
v_fmac_f32 v158, v89, v99
v_fmac_f32 v159, v90, v99
v_accvgpr_read_b32 v88, a40
v_mul_f32 v164, v164, v97
v_mul_f32 v165, v165, v97
v_lshlrev_b32 v89, 16, v88
v_and_b32 v90, 0xffff0000, v88
v_fmac_f32 v164, v89, v99
v_fmac_f32 v165, v90, v99
v_accvgpr_read_b32 v88, a41
v_mul_f32 v166, v166, v97
v_mul_f32 v167, v167, v97
v_lshlrev_b32 v89, 16, v88
v_and_b32 v90, 0xffff0000, v88
v_fmac_f32 v166, v89, v99
v_fmac_f32 v167, v90, v99
v_accvgpr_read_b32 v88, a42
v_mul_f32 v172, v172, v97
v_mul_f32 v173, v173, v97
v_lshlrev_b32 v89, 16, v88
v_and_b32 v90, 0xffff0000, v88
v_fmac_f32 v172, v89, v99
v_fmac_f32 v173, v90, v99
v_accvgpr_read_b32 v88, a43
v_mul_f32 v174, v174, v97
v_mul_f32 v175, v175, v97
v_lshlrev_b32 v89, 16, v88
v_and_b32 v90, 0xffff0000, v88
v_fmac_f32 v174, v89, v99
v_fmac_f32 v175, v90, v99
v_accvgpr_read_b32 v88, a44
v_mul_f32 v180, v180, v97
v_mul_f32 v181, v181, v97
v_lshlrev_b32 v89, 16, v88
v_and_b32 v90, 0xffff0000, v88
v_fmac_f32 v180, v89, v99
v_fmac_f32 v181, v90, v99
v_accvgpr_read_b32 v88, a45
v_mul_f32 v182, v182, v97
v_mul_f32 v183, v183, v97
v_lshlrev_b32 v89, 16, v88
v_and_b32 v90, 0xffff0000, v88
v_fmac_f32 v182, v89, v99
v_fmac_f32 v183, v90, v99
v_accvgpr_read_b32 v88, a46
v_mul_f32 v188, v188, v97
v_mul_f32 v189, v189, v97
v_lshlrev_b32 v89, 16, v88
v_and_b32 v90, 0xffff0000, v88
v_fmac_f32 v188, v89, v99
v_fmac_f32 v189, v90, v99
v_accvgpr_read_b32 v88, a47
v_mul_f32 v190, v190, v97
v_mul_f32 v191, v191, v97
v_lshlrev_b32 v89, 16, v88
v_and_b32 v90, 0xffff0000, v88
v_fmac_f32 v190, v89, v99
v_fmac_f32 v191, v90, v99
v_accvgpr_read_b32 v88, a48
v_mul_f32 v196, v196, v97
v_mul_f32 v197, v197, v97
v_lshlrev_b32 v89, 16, v88
v_and_b32 v90, 0xffff0000, v88
v_fmac_f32 v196, v89, v99
v_fmac_f32 v197, v90, v99
v_accvgpr_read_b32 v88, a49
v_mul_f32 v198, v198, v97
v_mul_f32 v199, v199, v97
v_lshlrev_b32 v89, 16, v88
v_and_b32 v90, 0xffff0000, v88
v_fmac_f32 v198, v89, v99
v_fmac_f32 v199, v90, v99
v_accvgpr_read_b32 v88, a50
v_mul_f32 v204, v204, v97
v_mul_f32 v205, v205, v97
v_lshlrev_b32 v89, 16, v88
v_and_b32 v90, 0xffff0000, v88
v_fmac_f32 v204, v89, v99
v_fmac_f32 v205, v90, v99
v_accvgpr_read_b32 v88, a51
v_mul_f32 v206, v206, v97
v_mul_f32 v207, v207, v97
v_lshlrev_b32 v89, 16, v88
v_and_b32 v90, 0xffff0000, v88
v_fmac_f32 v206, v89, v99
v_fmac_f32 v207, v90, v99
v_accvgpr_read_b32 v88, a52
v_mul_f32 v212, v212, v97
v_mul_f32 v213, v213, v97
v_lshlrev_b32 v89, 16, v88
v_and_b32 v90, 0xffff0000, v88
v_fmac_f32 v212, v89, v99
v_fmac_f32 v213, v90, v99
v_accvgpr_read_b32 v88, a53
v_mul_f32 v214, v214, v97
v_mul_f32 v215, v215, v97
v_lshlrev_b32 v89, 16, v88
v_and_b32 v90, 0xffff0000, v88
v_fmac_f32 v214, v89, v99
v_fmac_f32 v215, v90, v99
v_accvgpr_read_b32 v88, a54
v_mul_f32 v220, v220, v97
v_mul_f32 v221, v221, v97
v_lshlrev_b32 v89, 16, v88
v_and_b32 v90, 0xffff0000, v88
v_fmac_f32 v220, v89, v99
v_fmac_f32 v221, v90, v99
v_accvgpr_read_b32 v88, a55
v_mul_f32 v222, v222, v97
v_mul_f32 v223, v223, v97
v_lshlrev_b32 v89, 16, v88
v_and_b32 v90, 0xffff0000, v88
v_fmac_f32 v222, v89, v99
v_fmac_f32 v223, v90, v99
v_accvgpr_read_b32 v88, a56
v_mul_f32 v228, v228, v97
v_mul_f32 v229, v229, v97
v_lshlrev_b32 v89, 16, v88
v_and_b32 v90, 0xffff0000, v88
v_fmac_f32 v228, v89, v99
v_fmac_f32 v229, v90, v99
v_accvgpr_read_b32 v88, a57
v_mul_f32 v230, v230, v97
v_mul_f32 v231, v231, v97
v_lshlrev_b32 v89, 16, v88
v_and_b32 v90, 0xffff0000, v88
v_fmac_f32 v230, v89, v99
v_fmac_f32 v231, v90, v99
v_accvgpr_read_b32 v88, a58
v_mul_f32 v236, v236, v97
v_mul_f32 v237, v237, v97
v_lshlrev_b32 v89, 16, v88
v_and_b32 v90, 0xffff0000, v88
v_fmac_f32 v236, v89, v99
v_fmac_f32 v237, v90, v99
v_accvgpr_read_b32 v88, a59
v_mul_f32 v238, v238, v97
v_mul_f32 v239, v239, v97
v_lshlrev_b32 v89, 16, v88
v_and_b32 v90, 0xffff0000, v88
v_fmac_f32 v238, v89, v99
v_fmac_f32 v239, v90, v99
v_accvgpr_read_b32 v88, a60
v_mul_f32 v244, v244, v97
v_mul_f32 v245, v245, v97
v_lshlrev_b32 v89, 16, v88
v_and_b32 v90, 0xffff0000, v88
v_fmac_f32 v244, v89, v99
v_fmac_f32 v245, v90, v99
v_accvgpr_read_b32 v88, a61
v_mul_f32 v246, v246, v97
v_mul_f32 v247, v247, v97
v_lshlrev_b32 v89, 16, v88
v_and_b32 v90, 0xffff0000, v88
v_fmac_f32 v246, v89, v99
v_fmac_f32 v247, v90, v99
v_accvgpr_read_b32 v88, a62
v_mul_f32 v252, v252, v97
v_mul_f32 v253, v253, v97
v_lshlrev_b32 v89, 16, v88
v_and_b32 v90, 0xffff0000, v88
v_fmac_f32 v252, v89, v99
v_fmac_f32 v253, v90, v99
v_accvgpr_read_b32 v88, a63
v_mul_f32 v254, v254, v97
v_mul_f32 v255, v255, v97
v_lshlrev_b32 v89, 16, v88
v_and_b32 v90, 0xffff0000, v88
v_fmac_f32 v254, v89, v99
v_fmac_f32 v255, v90, v99
s_branch at_norm
at_stub0:
s_mov_b32 s39, 0
s_branch at_rare0
at_stub1:
s_mov_b32 s39, 1
s_branch at_rare1
at_stub2:
s_mov_b32 s39, 2
s_branch at_rare0
at_stub3:
s_mov_b32 s39, 3
s_branch at_rare1
at_stub4:
s_mov_b32 s39, 4
s_branch at_rare0
at_stub5:
s_mov_b32 s39, 5
s_branch at_rare0
at_stub6:
s_mov_b32 s39, 6
s_branch at_rare1
at_stub7:
s_mov_b32 s39, 7
s_branch at_rare0
at_stub8:
s_mov_b32 s39, 8
s_branch at_rare1
at_stub9:
s_mov_b32 s39, 9
s_branch at_rare0
at_stub10:
s_mov_b32 s39, 10
s_branch at_rare0
at_stub11:
s_mov_b32 s39, 11
s_branch at_rare1
at_stub12:
s_mov_b32 s39, 12
s_branch at_rare0
at_stub13:
s_mov_b32 s39, 13
s_branch at_rare1
at_stub14:
s_mov_b32 s39, 14
s_branch at_rare0
at_stub15:
s_mov_b32 s39, 15
s_branch at_rare1
at_stub16:
s_mov_b32 s39, 16
s_branch at_rare0
at_stub17:
s_mov_b32 s39, 17
s_branch at_rare1
at_rare0:
s_waitcnt vmcnt(0) lgkmcnt(0)
v_max3_f32 v96, v32, v33, v34
v_max3_f32 v96, v96, v35, v40
v_max3_f32 v96, v96, v41, v42
v_max_f32 v96, v96, v43
v_max3_f32 v97, v36, v37, v38
v_max3_f32 v97, v97, v39, v44
v_max3_f32 v97, v97, v45, v46
v_max_f32 v97, v97, v47
v_mov_b32 v98, v96
v_mov_b32 v99, v97
s_nop 0
v_permlane16_swap_b32 v96, v98
v_permlane16_swap_b32 v97, v99
v_max_f32 v96, v96, v98
v_max_f32 v97, v97, v99
v_mov_b32 v98, v96
v_mov_b32 v99, v97
s_nop 0
v_permlane32_swap_b32 v96, v98
v_permlane32_swap_b32 v97, v99
v_max_f32 v96, v96, v98
v_max_f32 v97, v97, v99
v_max_f32 v96, 0, v96
v_sub_f32 v100, 0, v96
v_max_f32 v97, 0, v97
v_sub_f32 v101, 0, v97
v_exp_f32 v100, v100
v_exp_f32 v101, v101
v_sub_f32 v80, v80, v96
v_sub_f32 v81, v81, v96
v_sub_f32 v82, v82, v96
v_sub_f32 v83, v83, v96
v_sub_f32 v32, v32, v96
v_sub_f32 v33, v33, v96
v_sub_f32 v34, v34, v96
v_sub_f32 v35, v35, v96
v_sub_f32 v40, v40, v96
v_sub_f32 v41, v41, v96
v_sub_f32 v42, v42, v96
v_sub_f32 v43, v43, v96
v_sub_f32 v48, v48, v96
v_sub_f32 v49, v49, v96
v_sub_f32 v50, v50, v96
v_sub_f32 v51, v51, v96
v_sub_f32 v56, v56, v96
v_sub_f32 v57, v57, v96
v_sub_f32 v58, v58, v96
v_sub_f32 v59, v59, v96
v_mul_f32 v28, v28, v100
v_sub_f32 v84, v84, v97
v_sub_f32 v85, v85, v97
v_sub_f32 v86, v86, v97
v_sub_f32 v87, v87, v97
v_sub_f32 v36, v36, v97
v_sub_f32 v37, v37, v97
v_sub_f32 v38, v38, v97
v_sub_f32 v39, v39, v97
v_sub_f32 v44, v44, v97
v_sub_f32 v45, v45, v97
v_sub_f32 v46, v46, v97
v_sub_f32 v47, v47, v97
v_sub_f32 v52, v52, v97
v_sub_f32 v53, v53, v97
v_sub_f32 v54, v54, v97
v_sub_f32 v55, v55, v97
v_sub_f32 v60, v60, v97
v_sub_f32 v61, v61, v97
v_sub_f32 v62, v62, v97
v_sub_f32 v63, v63, v97
v_mul_f32 v29, v29, v101
v_mul_f32 v128, v128, v100
v_mul_f32 v129, v129, v100
v_mul_f32 v130, v130, v100
v_mul_f32 v131, v131, v100
v_mul_f32 v132, v132, v101
v_mul_f32 v133, v133, v101
v_mul_f32 v134, v134, v101
v_mul_f32 v135, v135, v101
v_mul_f32 v136, v136, v100
v_mul_f32 v137, v137, v100
v_mul_f32 v138, v138, v100
v_mul_f32 v139, v139, v100
v_mul_f32 v140, v140, v101
v_mul_f32 v141, v141, v101
v_mul_f32 v142, v142, v101
v_mul_f32 v143, v143, v101
v_mul_f32 v144, v144, v100
v_mul_f32 v145, v145, v100
v_mul_f32 v146, v146, v100
v_mul_f32 v147, v147, v100
v_mul_f32 v148, v148, v101
v_mul_f32 v149, v149, v101
v_mul_f32 v150, v150, v101
v_mul_f32 v151, v151, v101
v_mul_f32 v152, v152, v100
v_mul_f32 v153, v153, v100
v_mul_f32 v154, v154, v100
v_mul_f32 v155, v155, v100
v_mul_f32 v156, v156, v101
v_mul_f32 v157, v157, v101
v_mul_f32 v158, v158, v101
v_mul_f32 v159, v159, v101
v_mul_f32 v160, v160, v100
v_mul_f32 v161, v161, v100
v_mul_f32 v162, v162, v100
v_mul_f32 v163, v163, v100
v_mul_f32 v164, v164, v101
v_mul_f32 v165, v165, v101
v_mul_f32 v166, v166, v101
v_mul_f32 v167, v167, v101
v_mul_f32 v168, v168, v100
v_mul_f32 v169, v169, v100
v_mul_f32 v170, v170, v100
v_mul_f32 v171, v171, v100
v_mul_f32 v172, v172, v101
v_mul_f32 v173, v173, v101
v_mul_f32 v174, v174, v101
v_mul_f32 v175, v175, v101
v_mul_f32 v176, v176, v100
v_mul_f32 v177, v177, v100
v_mul_f32 v178, v178, v100
v_mul_f32 v179, v179, v100
v_mul_f32 v180, v180, v101
v_mul_f32 v181, v181, v101
v_mul_f32 v182, v182, v101
v_mul_f32 v183, v183, v101
v_mul_f32 v184, v184, v100
v_mul_f32 v185, v185, v100
v_mul_f32 v186, v186, v100
v_mul_f32 v187, v187, v100
v_mul_f32 v188, v188, v101
v_mul_f32 v189, v189, v101
v_mul_f32 v190, v190, v101
v_mul_f32 v191, v191, v101
v_mul_f32 v192, v192, v100
v_mul_f32 v193, v193, v100
v_mul_f32 v194, v194, v100
v_mul_f32 v195, v195, v100
v_mul_f32 v196, v196, v101
v_mul_f32 v197, v197, v101
v_mul_f32 v198, v198, v101
v_mul_f32 v199, v199, v101
v_mul_f32 v200, v200, v100
v_mul_f32 v201, v201, v100
v_mul_f32 v202, v202, v100
v_mul_f32 v203, v203, v100
v_mul_f32 v204, v204, v101
v_mul_f32 v205, v205, v101
v_mul_f32 v206, v206, v101
v_mul_f32 v207, v207, v101
v_mul_f32 v208, v208, v100
v_mul_f32 v209, v209, v100
v_mul_f32 v210, v210, v100
v_mul_f32 v211, v211, v100
v_mul_f32 v212, v212, v101
v_mul_f32 v213, v213, v101
v_mul_f32 v214, v214, v101
v_mul_f32 v215, v215, v101
v_mul_f32 v216, v216, v100
v_mul_f32 v217, v217, v100
v_mul_f32 v218, v218, v100
v_mul_f32 v219, v219, v100
v_mul_f32 v220, v220, v101
v_mul_f32 v221, v221, v101
v_mul_f32 v222, v222, v101
v_mul_f32 v223, v223, v101
v_mul_f32 v224, v224, v100
v_mul_f32 v225, v225, v100
v_mul_f32 v226, v226, v100
v_mul_f32 v227, v227, v100
v_mul_f32 v228, v228, v101
v_mul_f32 v229, v229, v101
v_mul_f32 v230, v230, v101
v_mul_f32 v231, v231, v101
v_mul_f32 v232, v232, v100
v_mul_f32 v233, v233, v100
v_mul_f32 v234, v234, v100
v_mul_f32 v235, v235, v100
v_mul_f32 v236, v236, v101
v_mul_f32 v237, v237, v101
v_mul_f32 v238, v238, v101
v_mul_f32 v239, v239, v101
v_mul_f32 v240, v240, v100
v_mul_f32 v241, v241, v100
v_mul_f32 v242, v242, v100
v_mul_f32 v243, v243, v100
v_mul_f32 v244, v244, v101
v_mul_f32 v245, v245, v101
v_mul_f32 v246, v246, v101
v_mul_f32 v247, v247, v101
v_mul_f32 v248, v248, v100
v_mul_f32 v249, v249, v100
v_mul_f32 v250, v250, v100
v_mul_f32 v251, v251, v100
v_mul_f32 v252, v252, v101
v_mul_f32 v253, v253, v101
v_mul_f32 v254, v254, v101
v_mul_f32 v255, v255, v101
v_exp_f32 v88, v32
v_exp_f32 v89, v33
v_exp_f32 v90, v34
v_exp_f32 v91, v35
v_add_f32 v30, v88, v89
v_cvt_pk_bf16_f32 v64, v88, v89
v_add_f32 v30, v30, v90
v_add_f32 v30, v30, v91
v_cvt_pk_bf16_f32 v65, v90, v91
v_exp_f32 v92, v36
v_exp_f32 v93, v37
v_exp_f32 v94, v38
v_exp_f32 v95, v39
v_add_f32 v31, v92, v93
v_cvt_pk_bf16_f32 v68, v92, v93
v_add_f32 v31, v31, v94
v_add_f32 v31, v31, v95
v_cvt_pk_bf16_f32 v69, v94, v95
v_exp_f32 v88, v40
v_exp_f32 v89, v41
v_exp_f32 v90, v42
v_exp_f32 v91, v43
v_add_f32 v30, v30, v88
v_add_f32 v30, v30, v89
v_cvt_pk_bf16_f32 v66, v88, v89
v_add_f32 v30, v30, v90
v_add_f32 v30, v30, v91
v_cvt_pk_bf16_f32 v67, v90, v91
v_exp_f32 v92, v44
v_exp_f32 v93, v45
v_exp_f32 v94, v46
v_exp_f32 v95, v47
v_add_f32 v31, v31, v92
v_add_f32 v31, v31, v93
v_cvt_pk_bf16_f32 v70, v92, v93
v_add_f32 v31, v31, v94
v_add_f32 v31, v31, v95
v_cvt_pk_bf16_f32 v71, v94, v95
s_cmp_eq_u32 s39, 0
s_cbranch_scc1 at_ret0
s_cmp_eq_u32 s39, 2
s_cbranch_scc1 at_ret2
s_cmp_eq_u32 s39, 4
s_cbranch_scc1 at_ret4
s_cmp_eq_u32 s39, 5
s_cbranch_scc1 at_ret5
s_cmp_eq_u32 s39, 7
s_cbranch_scc1 at_ret7
s_cmp_eq_u32 s39, 9
s_cbranch_scc1 at_ret9
s_cmp_eq_u32 s39, 10
s_cbranch_scc1 at_ret10
s_cmp_eq_u32 s39, 12
s_cbranch_scc1 at_ret12
s_cmp_eq_u32 s39, 14
s_cbranch_scc1 at_ret14
s_branch at_ret16
at_rare1:
s_waitcnt vmcnt(0) lgkmcnt(0)
v_max3_f32 v96, v48, v49, v50
v_max3_f32 v96, v96, v51, v56
v_max3_f32 v96, v96, v57, v58
v_max_f32 v96, v96, v59
v_max3_f32 v97, v52, v53, v54
v_max3_f32 v97, v97, v55, v60
v_max3_f32 v97, v97, v61, v62
v_max_f32 v97, v97, v63
v_mov_b32 v98, v96
v_mov_b32 v99, v97
s_nop 0
v_permlane16_swap_b32 v96, v98
v_permlane16_swap_b32 v97, v99
v_max_f32 v96, v96, v98
v_max_f32 v97, v97, v99
v_mov_b32 v98, v96
v_mov_b32 v99, v97
s_nop 0
v_permlane32_swap_b32 v96, v98
v_permlane32_swap_b32 v97, v99
v_max_f32 v96, v96, v98
v_max_f32 v97, v97, v99
v_max_f32 v96, 0, v96
v_sub_f32 v100, 0, v96
v_max_f32 v97, 0, v97
v_sub_f32 v101, 0, v97
v_exp_f32 v100, v100
v_exp_f32 v101, v101
v_sub_f32 v80, v80, v96
v_sub_f32 v81, v81, v96
v_sub_f32 v82, v82, v96
v_sub_f32 v83, v83, v96
v_sub_f32 v32, v32, v96
v_sub_f32 v33, v33, v96
v_sub_f32 v34, v34, v96
v_sub_f32 v35, v35, v96
v_sub_f32 v40, v40, v96
v_sub_f32 v41, v41, v96
v_sub_f32 v42, v42, v96
v_sub_f32 v43, v43, v96
v_sub_f32 v48, v48, v96
v_sub_f32 v49, v49, v96
v_sub_f32 v50, v50, v96
v_sub_f32 v51, v51, v96
v_sub_f32 v56, v56, v96
v_sub_f32 v57, v57, v96
v_sub_f32 v58, v58, v96
v_sub_f32 v59, v59, v96
v_mul_f32 v28, v28, v100
v_sub_f32 v84, v84, v97
v_sub_f32 v85, v85, v97
v_sub_f32 v86, v86, v97
v_sub_f32 v87, v87, v97
v_sub_f32 v36, v36, v97
v_sub_f32 v37, v37, v97
v_sub_f32 v38, v38, v97
v_sub_f32 v39, v39, v97
v_sub_f32 v44, v44, v97
v_sub_f32 v45, v45, v97
v_sub_f32 v46, v46, v97
v_sub_f32 v47, v47, v97
v_sub_f32 v52, v52, v97
v_sub_f32 v53, v53, v97
v_sub_f32 v54, v54, v97
v_sub_f32 v55, v55, v97
v_sub_f32 v60, v60, v97
v_sub_f32 v61, v61, v97
v_sub_f32 v62, v62, v97
v_sub_f32 v63, v63, v97
v_mul_f32 v29, v29, v101
v_mul_f32 v128, v128, v100
v_mul_f32 v129, v129, v100
v_mul_f32 v130, v130, v100
v_mul_f32 v131, v131, v100
v_mul_f32 v132, v132, v101
v_mul_f32 v133, v133, v101
v_mul_f32 v134, v134, v101
v_mul_f32 v135, v135, v101
v_mul_f32 v136, v136, v100
v_mul_f32 v137, v137, v100
v_mul_f32 v138, v138, v100
v_mul_f32 v139, v139, v100
v_mul_f32 v140, v140, v101
v_mul_f32 v141, v141, v101
v_mul_f32 v142, v142, v101
v_mul_f32 v143, v143, v101
v_mul_f32 v144, v144, v100
v_mul_f32 v145, v145, v100
v_mul_f32 v146, v146, v100
v_mul_f32 v147, v147, v100
v_mul_f32 v148, v148, v101
v_mul_f32 v149, v149, v101
v_mul_f32 v150, v150, v101
v_mul_f32 v151, v151, v101
v_mul_f32 v152, v152, v100
v_mul_f32 v153, v153, v100
v_mul_f32 v154, v154, v100
v_mul_f32 v155, v155, v100
v_mul_f32 v156, v156, v101
v_mul_f32 v157, v157, v101
v_mul_f32 v158, v158, v101
v_mul_f32 v159, v159, v101
v_mul_f32 v160, v160, v100
v_mul_f32 v161, v161, v100
v_mul_f32 v162, v162, v100
v_mul_f32 v163, v163, v100
v_mul_f32 v164, v164, v101
v_mul_f32 v165, v165, v101
v_mul_f32 v166, v166, v101
v_mul_f32 v167, v167, v101
v_mul_f32 v168, v168, v100
v_mul_f32 v169, v169, v100
v_mul_f32 v170, v170, v100
v_mul_f32 v171, v171, v100
v_mul_f32 v172, v172, v101
v_mul_f32 v173, v173, v101
v_mul_f32 v174, v174, v101
v_mul_f32 v175, v175, v101
v_mul_f32 v176, v176, v100
v_mul_f32 v177, v177, v100
v_mul_f32 v178, v178, v100
v_mul_f32 v179, v179, v100
v_mul_f32 v180, v180, v101
v_mul_f32 v181, v181, v101
v_mul_f32 v182, v182, v101
v_mul_f32 v183, v183, v101
v_mul_f32 v184, v184, v100
v_mul_f32 v185, v185, v100
v_mul_f32 v186, v186, v100
v_mul_f32 v187, v187, v100
v_mul_f32 v188, v188, v101
v_mul_f32 v189, v189, v101
v_mul_f32 v190, v190, v101
v_mul_f32 v191, v191, v101
v_mul_f32 v192, v192, v100
v_mul_f32 v193, v193, v100
v_mul_f32 v194, v194, v100
v_mul_f32 v195, v195, v100
v_mul_f32 v196, v196, v101
v_mul_f32 v197, v197, v101
v_mul_f32 v198, v198, v101
v_mul_f32 v199, v199, v101
v_mul_f32 v200, v200, v100
v_mul_f32 v201, v201, v100
v_mul_f32 v202, v202, v100
v_mul_f32 v203, v203, v100
v_mul_f32 v204, v204, v101
v_mul_f32 v205, v205, v101
v_mul_f32 v206, v206, v101
v_mul_f32 v207, v207, v101
v_mul_f32 v208, v208, v100
v_mul_f32 v209, v209, v100
v_mul_f32 v210, v210, v100
v_mul_f32 v211, v211, v100
v_mul_f32 v212, v212, v101
v_mul_f32 v213, v213, v101
v_mul_f32 v214, v214, v101
v_mul_f32 v215, v215, v101
v_mul_f32 v216, v216, v100
v_mul_f32 v217, v217, v100
v_mul_f32 v218, v218, v100
v_mul_f32 v219, v219, v100
v_mul_f32 v220, v220, v101
v_mul_f32 v221, v221, v101
v_mul_f32 v222, v222, v101
v_mul_f32 v223, v223, v101
v_mul_f32 v224, v224, v100
v_mul_f32 v225, v225, v100
v_mul_f32 v226, v226, v100
v_mul_f32 v227, v227, v100
v_mul_f32 v228, v228, v101
v_mul_f32 v229, v229, v101
v_mul_f32 v230, v230, v101
v_mul_f32 v231, v231, v101
v_mul_f32 v232, v232, v100
v_mul_f32 v233, v233, v100
v_mul_f32 v234, v234, v100
v_mul_f32 v235, v235, v100
v_mul_f32 v236, v236, v101
v_mul_f32 v237, v237, v101
v_mul_f32 v238, v238, v101
v_mul_f32 v239, v239, v101
v_mul_f32 v240, v240, v100
v_mul_f32 v241, v241, v100
v_mul_f32 v242, v242, v100
v_mul_f32 v243, v243, v100
v_mul_f32 v244, v244, v101
v_mul_f32 v245, v245, v101
v_mul_f32 v246, v246, v101
v_mul_f32 v247, v247, v101
v_mul_f32 v248, v248, v100
v_mul_f32 v249, v249, v100
v_mul_f32 v250, v250, v100
v_mul_f32 v251, v251, v100
v_mul_f32 v252, v252, v101
v_mul_f32 v253, v253, v101
v_mul_f32 v254, v254, v101
v_mul_f32 v255, v255, v101
v_exp_f32 v88, v48
v_exp_f32 v89, v49
v_exp_f32 v90, v50
v_exp_f32 v91, v51
v_add_f32 v30, v88, v89
v_cvt_pk_bf16_f32 v72, v88, v89
v_add_f32 v30, v30, v90
v_add_f32 v30, v30, v91
v_cvt_pk_bf16_f32 v73, v90, v91
v_exp_f32 v92, v52
v_exp_f32 v93, v53
v_exp_f32 v94, v54
v_exp_f32 v95, v55
v_add_f32 v31, v92, v93
v_cvt_pk_bf16_f32 v76, v92, v93
v_add_f32 v31, v31, v94
v_add_f32 v31, v31, v95
v_cvt_pk_bf16_f32 v77, v94, v95
v_exp_f32 v88, v56
v_exp_f32 v89, v57
v_exp_f32 v90, v58
v_exp_f32 v91, v59
v_add_f32 v30, v30, v88
v_add_f32 v30, v30, v89
v_cvt_pk_bf16_f32 v74, v88, v89
v_add_f32 v30, v30, v90
v_add_f32 v30, v30, v91
v_cvt_pk_bf16_f32 v75, v90, v91
v_exp_f32 v92, v60
v_exp_f32 v93, v61
v_exp_f32 v94, v62
v_exp_f32 v95, v63
v_add_f32 v31, v31, v92
v_add_f32 v31, v31, v93
v_cvt_pk_bf16_f32 v78, v92, v93
v_add_f32 v31, v31, v94
v_add_f32 v31, v31, v95
v_cvt_pk_bf16_f32 v79, v94, v95
s_cmp_eq_u32 s39, 1
s_cbranch_scc1 at_ret1
s_cmp_eq_u32 s39, 3
s_cbranch_scc1 at_ret3
s_cmp_eq_u32 s39, 6
s_cbranch_scc1 at_ret6
s_cmp_eq_u32 s39, 8
s_cbranch_scc1 at_ret8
s_cmp_eq_u32 s39, 11
s_cbranch_scc1 at_ret11
s_cmp_eq_u32 s39, 13
s_cbranch_scc1 at_ret13
s_cmp_eq_u32 s39, 15
s_cbranch_scc1 at_ret15
s_branch at_ret17
kv_end:
s_endpgm
kv_spin:
s_mov_b32 s71, 0x200000
kv_spin1:
s_sleep 4
buffer_load_dword v31, v30, s[8:11], 0 offen offset:4 sc1
s_waitcnt vmcnt(0)
v_readfirstlane_b32 s70, v31
s_nop 0
s_cmp_ge_u32 s70, 112
s_cbranch_scc1 kv_spun
s_sub_u32 s71, s71, 1
s_cmp_lg_u32 s71, 0
s_cbranch_scc1 kv_spin1
s_branch kv_spun
.p2align 2
all_code_end:
s_endpgm
.section .rodata,"a"
.p2align 6
.amdhsa_kernel kvattn_kernel
  .amdhsa_next_free_vgpr 512
  .amdhsa_next_free_sgpr 84
  .amdhsa_accum_offset 256
  .amdhsa_group_segment_fixed_size 0
  .amdhsa_kernarg_size 112
  .amdhsa_user_sgpr_count 2
  .amdhsa_user_sgpr_kernarg_segment_ptr 1
  .amdhsa_system_sgpr_workgroup_id_x 1
  .amdhsa_float_denorm_mode_32 3
.end_amdhsa_kernel
```
